```python
import torch

def _softmax(x, axis=-1):
    return torch.softmax(x, dim=axis)
def _gelu(x):
    return torch.nn.functional.gelu(x, approximate="tanh")
def _silu(x):
    return torch.nn.functional.silu(x)
def _sigmoid(x):
    return torch.sigmoid(x)
def _layernorm(x, axis=-1, eps=1e-5):
    m = x.mean(dim=axis, keepdim=True)
    v = x.var(dim=axis, keepdim=True, unbiased=False)
    return (x - m) / torch.sqrt(v + eps)
def _scatter_add(tgt, idx, src, axis=0):
    return tgt.clone().index_add_(axis, idx, src)
def _segment_sum(src, seg, n):
    out = torch.zeros((n,) + src.shape[1:], dtype=src.dtype)
    return out.index_add_(0, seg, src)
def _pad(x, pw):
    flat = tuple(v for pair in reversed(pw) for v in pair)
    return torch.nn.functional.pad(x, flat)

kernel_name = 'interleave_layers__sliding_block_cached__dense_activation_gelu__decode'

def setup_inputs():

    _w = (lambda a: (lambda t: t.to(torch.bfloat16) if t.is_floating_point() else t)(torch.as_tensor(a)))
    def _A_setup():
        B, Sq, D = 1, 1, 640
        Hq, Hkv, Sk, Dh = 32, 32, 32768, 192
        assert Hq % Hkv == 0, (Hq, Hkv)
        return {
            "x": _w((lambda *s: torch.randn(*s, dtype=torch.bfloat16) * 0.1)(B, Sq, D)),
            "k_cache": _w((lambda *s: torch.randn(*s, dtype=torch.bfloat16) * 0.8)(B, Hkv, Sk, Dh)),
            "v_cache": _w((lambda *s: torch.randn(*s, dtype=torch.bfloat16) * 1.6)(B, Hkv, Sk, Dh)),
            "wq": _w((lambda *s: torch.randn(*s, dtype=torch.bfloat16) * 0.8)(D, Hq * Dh) * (D ** -0.5)),
            "wo": _w((lambda *s: torch.randn(*s, dtype=torch.bfloat16) * 1.6)(Hq * Dh, D) * ((Hq * Dh) ** -0.5)),
        }
    _A_in = _A_setup()

    def _B_setup():
        B, S, D, F = 1, 1, 640, 1536
        return {
            "x": _w((lambda *s: torch.randn(*s, dtype=torch.bfloat16) * 0.1)(B, S, D)),
            "w1": _w((lambda *s: torch.randn(*s, dtype=torch.bfloat16) * 0.4)(D, F) * (D ** -0.5)),
            "b1": _w((lambda *s: torch.randn(*s, dtype=torch.bfloat16) * 0.4)(F) * 0.01),
            "w2": _w((lambda *s: torch.randn(*s, dtype=torch.bfloat16) * 0.4)(F, D) * (F ** -0.5)),
            "b2": _w((lambda *s: torch.randn(*s, dtype=torch.bfloat16) * 0.4)(D) * 0.01),
        }
    _B_in = _B_setup()

    return {
        "A_x": _A_in["x"],
        "A_k_cache": _A_in["k_cache"],
        "A_v_cache": _A_in["v_cache"],
        "A_wq": _A_in["wq"],
        "A_wo": _A_in["wo"],
        "B_x": _B_in["x"],
        "B_w1": _B_in["w1"],
        "B_b1": _B_in["b1"],
        "B_w2": _B_in["w2"],
        "B_b2": _B_in["b2"],
    }

def reference(A_x, A_k_cache, A_v_cache, A_wq, A_wo, B_x, B_w1, B_b1, B_w2, B_b2):
    def _A_ref(x, k_cache, v_cache, wq, wo):
        B, Sq, D = x.shape
        Hq, Dh = 32, 192
        Hkv, Sk = k_cache.shape[1], k_cache.shape[2]
        W = min(4096, max(256, Sk // 4))
        rep = Hq // Hkv
        q = (lambda x, *d: x.permute(*d))((x @ wq).reshape(B, Sq, Hq, Dh), 0, 2, 1, 3)
        k = (lambda x, n, axis: torch.repeat_interleave(x, n, dim=axis))(k_cache[:, :, Sk - W:, :], rep, axis=1)
        v = (lambda x, n, axis: torch.repeat_interleave(x, n, dim=axis))(v_cache[:, :, Sk - W:, :], rep, axis=1)
        scores = torch.einsum("bhqd,bhkd->bhqk", q, k) * (Dh ** -0.5)
        p = _softmax(scores, axis=-1)
        o = torch.einsum("bhqk,bhkd->bhqd", p, v)
        return (lambda x, *d: x.permute(*d))(o, 0, 2, 1, 3).reshape(B, Sq, Hq * Dh) @ wo

    def _B_ref(x, w1, b1, w2, b2):
        h = torch.einsum("bsd,df->bsf", x, w1) + b1
        h = _gelu(h)
        return torch.einsum("bsf,fd->bsd", h, w2) + b2

    x = A_x
    x = x + _A_ref(_layernorm(x, axis=-1), A_k_cache, A_v_cache, A_wq, A_wo)
    x = x + _B_ref(_layernorm(x, axis=-1), B_w1, B_b1, B_w2, B_b2)
    x = x + _A_ref(_layernorm(x, axis=-1), A_k_cache, A_v_cache, A_wq, A_wo)
    x = x + _B_ref(_layernorm(x, axis=-1), B_w1, B_b1, B_w2, B_b2)
    return x
```

```asm
; @launch grid=(256,1,1) block=(512,1,1) lds=162944
.amdgcn_target "amdgcn-amd-amdhsa--gfx950"
.text
.globl interleave_layers__sliding_block_cached__dense_activation_gelu__decode_kernel
.p2align 8
.type interleave_layers__sliding_block_cached__dense_activation_gelu__decode_kernel,@function
interleave_layers__sliding_block_cached__dense_activation_gelu__decode_kernel:
    s_load_dwordx16 s[4:19], s[0:1], 0
    s_load_dwordx8 s[20:27], s[0:1], 64
    s_load_dwordx2 s[28:29], s[0:1], 96
    s_cmp_ge_u32 s2, 256
    s_cbranch_scc1 L_exit
    v_lshrrev_b32 v5, 6, v0
    v_and_b32 v0, 63, v0
    v_readfirstlane_b32 s30, v5
    s_and_b32 s31, s2, 7
    s_lshr_b32 s52, s2, 3
    s_and_b32 s53, s52, 3
    s_lshr_b32 s54, s52, 2
    v_lshrrev_b32 v8, 5, v0
    v_lshlrev_b32 v8, 2, v8
    v_bfe_u32 v60, v0, 4, 1
    v_lshl_add_u32 v8, v60, 0, v8
    v_and_b32 v9, 7, v0
    v_xor_b32 v8, v8, v9
    v_lshrrev_b32 v10, 3, v0
    v_mul_u32_u24 v10, 384, v10
    v_lshl_add_u32 v5, v8, 4, v10
    v_xor_b32 v6, 32, v5
    v_lshrrev_b32 v8, 4, v0
    v_lshlrev_b32 v8, 1, v8
    v_xor_b32 v8, v8, v9
    v_lshl_add_u32 v7, v8, 4, v10
    s_lshl_b32 s57, s31, 2
    s_add_u32 s57, s57, s53
    s_mul_i32 s57, s57, 12582912
    s_lshl_b32 s58, s54, 3
    s_add_u32 s58, s58, s30
    s_mul_i32 s58, s58, 3072
    s_add_u32 s57, s57, s58
    s_add_u32 s57, s57, 11010048
    s_sub_u32 s58, 1572864, s58
    s_mul_i32 s61, s30, 8192
    s_add_u32 s61, s61, 92160
    s_lshl_b32 s62, s31, 15
    s_mov_b32 s56, 0x40000
    s_mov_b32 s55, 0
    s_getreg_b32 s63, hwreg(20, 0, 3)
    v_mov_b32 v11, 0
    v_mov_b32 v14, 0
    v_mov_b32 v63, 0
    s_waitcnt lgkmcnt(0)
    s_add_u32 s32, s6, s57
    s_addc_u32 s33, s7, 0
    s_mov_b32 s34, s58
    s_mov_b32 s35, 0x20000
    s_add_u32 s36, s8, s57
    s_addc_u32 s37, s9, 0
    s_mov_b32 s38, s58
    s_mov_b32 s39, 0x20000
    s_mov_b32 s40, s28
    s_mov_b32 s41, s29
    s_mov_b32 s42, 356352
    s_mov_b32 s43, 0x20000
    s_cmp_eq_u32 s30, 5
    s_cbranch_scc0 L_skip_1
    v_mov_b32 v12, -1
    v_mov_b32 v13, -1
    v_mov_b32 v14, -1
    v_mov_b32 v15, -1
    v_lshlrev_b32 v10, 4, v0
    s_lshl_b32 s57, s52, 10
    s_add_u32 s57, s57, s62
    buffer_store_dwordx4 v[12:15], v10, s[40:43], s57 offen sc1
    s_mul_i32 s57, s2, 320
    s_add_u32 s57, s57, 262144
    s_mov_b64 exec, 0xfffff
    buffer_store_dwordx4 v[12:15], v10, s[40:43], s57 offen sc1
    s_mov_b64 exec, -1
    s_mul_i32 s57, s54, 12
    v_lshrrev_b32 v60, 1, v0
    v_add_u32 v60, s57, v60
    v_bfe_u32 v11, v60, 3, 4
    v_lshlrev_b32 v11, 5, v11
    v_and_b32 v61, 1, v60
    v_lshl_add_u32 v11, v61, 4, v11
    v_bfe_u32 v61, v60, 1, 2
    v_lshl_add_u32 v11, v61, 2, v11
    s_lshl_b32 s59, s31, 2
    s_add_u32 s59, s59, s53
    s_mul_i32 s59, s59, 384
    s_add_u32 s59, s59, 344064
    s_mov_b64 exec, 0x555555
    buffer_store_dword v12, v11, s[40:43], s59 offen sc1
    s_mov_b64 exec, -1
L_skip_1:
    s_add_u32 m0, s61, 0
    s_mov_b32 s57, 0
    buffer_load_dwordx4 v5, s[32:35], s57 offen offset:0 nt lds
    s_mov_b32 s58, 195584
    buffer_load_dwordx4 v6, s[32:35], s58 offen offset:1024 nt lds
    s_add_u32 m0, s61, 2048
    s_mov_b32 s57, 128
    buffer_load_dwordx4 v5, s[32:35], s57 offen offset:0 nt lds
    s_mov_b32 s58, 195712
    buffer_load_dwordx4 v6, s[32:35], s58 offen offset:1024 nt lds
    s_add_u32 m0, s61, 4096
    s_mov_b32 s57, 256
    buffer_load_dwordx4 v5, s[32:35], s57 offen offset:0 nt lds
    s_mov_b32 s58, 195840
    buffer_load_dwordx4 v6, s[32:35], s58 offen offset:1024 nt lds
    s_add_u32 m0, s61, 6144
    s_mov_b32 s57, 393216
    buffer_load_dwordx4 v5, s[32:35], s57 offen offset:0 nt lds
    s_mov_b32 s58, 588800
    buffer_load_dwordx4 v6, s[32:35], s58 offen offset:1024 nt lds
    v_bfe_u32 v8, v0, 1, 3
    v_lshrrev_b32 v9, 4, v0
    v_xor_b32 v9, v8, v9
    v_bfe_u32 v8, v0, 2, 1
    v_lshlrev_b32 v8, 10, v8
    v_bfe_u32 v60, v0, 3, 1
    v_lshl_add_u32 v8, v60, 9, v8
    v_and_b32 v60, 3, v0
    v_lshl_add_u32 v8, v60, 7, v8
    v_add_u32 v8, s61, v8
    v_lshl_add_u32 v8, v9, 4, v8
    v_xor_b32 v9, 64, v8
    v_bfe_u32 v1, v0, 1, 1
    v_mul_u32_u24 v1, 43690, v1
    v_add_u32 v1, 17476, v1
    s_cmp_lt_u32 s30, 5
    s_cbranch_scc0 L_skip_2
    s_mov_b32 s44, s10
    s_mov_b32 s45, s11
    s_mov_b32 s46, 7864320
    s_mov_b32 s47, 0x20000
    s_lshl_b32 s59, s31, 2
    s_add_u32 s59, s59, s53
    s_mul_i32 s59, s59, 384
    s_mul_i32 s60, s54, 48
    s_add_u32 s59, s59, s60
    s_mul_i32 s60, s30, 1572864
    s_add_u32 s59, s59, s60
    s_add_u32 s60, s59, 783360
    s_mul_i32 s57, s30, 6144
    v_add_u32 v12, 0, v0
    v_mul_u32_u24 v13, 0xAAAB, v12
    v_lshrrev_b32 v13, 17, v13
    v_mul_u32_u24 v14, 12240, v13
    v_lshl_add_u32 v14, v12, 4, v14
    s_add_u32 m0, s57, 0
    s_nop 0
    buffer_load_dwordx4 v14, s[44:47], s59 offen nt lds
    buffer_load_dwordx4 v14, s[44:47], s60 offen offset:3072 nt lds
    v_add_u32 v12, 64, v0
    v_mul_u32_u24 v13, 0xAAAB, v12
    v_lshrrev_b32 v13, 17, v13
    v_mul_u32_u24 v14, 12240, v13
    v_lshl_add_u32 v14, v12, 4, v14
    s_add_u32 m0, s57, 1024
    s_nop 0
    buffer_load_dwordx4 v14, s[44:47], s59 offen nt lds
    buffer_load_dwordx4 v14, s[44:47], s60 offen offset:3072 nt lds
    v_add_u32 v12, 128, v0
    v_mul_u32_u24 v13, 0xAAAB, v12
    v_lshrrev_b32 v13, 17, v13
    v_mul_u32_u24 v14, 12240, v13
    v_lshl_add_u32 v14, v12, 4, v14
    s_add_u32 m0, s57, 2048
    s_nop 0
    buffer_load_dwordx4 v14, s[44:47], s59 offen nt lds
    buffer_load_dwordx4 v14, s[44:47], s60 offen offset:3072 nt lds
    s_lshl_b32 s57, s30, 8
    v_and_b32 v12, 31, v0
    v_lshlrev_b32 v12, 3, v12
    v_lshrrev_b32 v60, 5, v0
    v_lshl_add_u32 v12, v60, 2, v12
    v_add_u32 v12, s57, v12
    global_load_dword v28, v12, s[4:5]
    global_load_dword v4, v12, s[22:23]
L_skip_2:
    s_cmp_eq_u32 s30, 5
    s_cbranch_scc0 L_skip_3
    s_lshl_b32 s57, s63, 3
    s_lshl_b64 s[72:73], 1, s57
    v_mov_b32 v12, s72
    v_mov_b32 v13, s73
    s_lshl_b32 s57, s31, 3
    v_mov_b32 v14, s57
    s_waitcnt vmcnt(8)
    s_mov_b64 exec, 0x1
    global_atomic_add_x2 v14, v[12:13], s[26:27] sc1
    s_mov_b64 exec, -1
    s_max_u32 s57, s52, 20
    s_sub_u32 s57, s57, 20
    s_lshl_b32 s57, s57, 5
    s_mul_i32 s58, s31, 384
    s_add_u32 s57, s57, s58
    v_and_b32 v12, 15, v0
    v_lshlrev_b32 v12, 1, v12
    v_add_u32 v12, s57, v12
    global_load_ushort v4, v12, s[18:19]
    v_and_b32 v10, 7, v0
    v_lshlrev_b32 v10, 4, v10
    v_bfe_u32 v60, v0, 3, 2
    v_lshl_add_u32 v10, v60, 2, v10
    v_lshrrev_b32 v60, 5, v0
    v_lshl_add_u32 v10, v60, 8, v10
    v_add_u32 v10, 157696, v10
    v_mov_b32 v60, 158220
    v_cmp_eq_u32 vcc, 25, v0
    s_nop 1
    v_cndmask_b32 v10, v10, v60, vcc
L_skip_3:
    s_waitcnt vmcnt(6)
    ds_read_b128 v[64:67], v8 offset:0
    ds_read_b128 v[68:71], v9 offset:0
    s_waitcnt lgkmcnt(0)
    s_add_u32 m0, s61, 0
    s_mov_b32 s57, 393344
    buffer_load_dwordx4 v5, s[32:35], s57 offen offset:0 nt lds
    s_mov_b32 s58, 588928
    buffer_load_dwordx4 v6, s[32:35], s58 offen offset:1024 nt lds
    s_waitcnt vmcnt(6)
    ds_read_b128 v[72:75], v8 offset:2048
    ds_read_b128 v[76:79], v9 offset:2048
    s_waitcnt lgkmcnt(0)
    s_add_u32 m0, s61, 2048
    s_mov_b32 s57, 393472
    buffer_load_dwordx4 v5, s[32:35], s57 offen offset:0 nt lds
    s_mov_b32 s58, 589056
    buffer_load_dwordx4 v6, s[32:35], s58 offen offset:1024 nt lds
    s_waitcnt vmcnt(6)
    ds_read_b128 v[80:83], v8 offset:4096
    ds_read_b128 v[84:87], v9 offset:4096
    s_waitcnt lgkmcnt(0)
    s_add_u32 m0, s61, 4096
    s_mov_b32 s57, 786432
    buffer_load_dwordx4 v5, s[32:35], s57 offen offset:0 nt lds
    s_mov_b32 s58, 982016
    buffer_load_dwordx4 v6, s[32:35], s58 offen offset:1024 nt lds
    s_waitcnt vmcnt(6)
    ds_read_b128 v[88:91], v8 offset:6144
    ds_read_b128 v[92:95], v9 offset:6144
    s_waitcnt lgkmcnt(0)
    s_add_u32 m0, s61, 6144
    s_mov_b32 s57, 786560
    buffer_load_dwordx4 v5, s[32:35], s57 offen offset:0 nt lds
    s_mov_b32 s58, 982144
    buffer_load_dwordx4 v6, s[32:35], s58 offen offset:1024 nt lds
    s_waitcnt vmcnt(6)
    ds_read_b128 v[96:99], v8 offset:0
    ds_read_b128 v[100:103], v9 offset:0
    s_waitcnt lgkmcnt(0)
    s_add_u32 m0, s61, 0
    s_mov_b32 s57, 786688
    buffer_load_dwordx4 v5, s[32:35], s57 offen offset:0 nt lds
    s_mov_b32 s58, 982272
    buffer_load_dwordx4 v6, s[32:35], s58 offen offset:1024 nt lds
    s_cmp_lt_u32 s30, 5
    s_cbranch_scc0 L_skip_4
    s_mul_i32 s57, s30, 6144
    v_lshrrev_b32 v10, 4, v0
    v_mul_u32_u24 v10, 1536, v10
    v_bfe_u32 v60, v0, 3, 1
    v_mul_u32_u24 v60, 384, v60
    v_add_u32 v10, v60, v10
    v_bfe_u32 v60, v0, 1, 1
    v_mul_u32_u24 v60, 192, v60
    v_add_u32 v10, v60, v10
    v_bfe_u32 v60, v0, 2, 1
    v_mul_u32_u24 v60, 48, v60
    v_add_u32 v10, v60, v10
    v_and_b32 v60, 1, v0
    v_lshl_add_u32 v10, v60, 3, v10
    v_add_u32 v10, s57, v10
    ds_read_b64_tr_b16 v[36:37], v10 offset:0
    ds_read_b64_tr_b16 v[38:39], v10 offset:768
    ds_read_b64_tr_b16 v[40:41], v10 offset:96
    ds_read_b64_tr_b16 v[42:43], v10 offset:864
    ds_read_b64_tr_b16 v[44:45], v10 offset:16
    ds_read_b64_tr_b16 v[46:47], v10 offset:784
    ds_read_b64_tr_b16 v[48:49], v10 offset:112
    ds_read_b64_tr_b16 v[50:51], v10 offset:880
    ds_read_b64_tr_b16 v[52:53], v10 offset:32
    ds_read_b64_tr_b16 v[54:55], v10 offset:800
    ds_read_b64_tr_b16 v[56:57], v10 offset:128
    ds_read_b64_tr_b16 v[58:59], v10 offset:896
    s_lshl_b32 s57, s30, 10
    v_lshlrev_b32 v11, 4, v0
    v_add_u32 v11, s57, v11
    v_add_u32 v11, 157696, v11
    v_mov_b32 v32, 0x3f803f80
    v_mov_b32 v33, 0x3f803f80
    v_mov_b32 v34, 0x3f803f80
    v_mov_b32 v35, 0x3f803f80
    v_mov_b32 v61, 0x3f803f80
    v_mov_b64 v[12:13], 0
    v_mov_b64 v[14:15], 0
    v_mov_b32_dpp v32, v28 quad_perm:[0,1,2,3] row_mask:0xf bank_mask:0x1
    v_mov_b32_dpp v33, v28 row_shl:4 row_mask:0xf bank_mask:0x1
    v_mov_b32_dpp v34, v28 row_shl:8 row_mask:0xf bank_mask:0x1
    v_mov_b32_dpp v35, v28 row_shl:12 row_mask:0xf bank_mask:0x1
    v_dot2_f32_bf16 v27, v28, v61, 0
    v_dot2_f32_bf16 v62, v28, v28, 0
    s_waitcnt lgkmcnt(0)
    v_smfmac_f32_16x16x64_bf16 v[12:15], v[32:35], v[36:43], v1
    v_mov_b64 v[16:17], 0
    v_mov_b64 v[18:19], 0
    v_permlane32_swap_b32 v27, v62
    s_nop 0
    v_smfmac_f32_16x16x64_bf16 v[16:19], v[32:35], v[44:51], v1
    v_mov_b64 v[20:21], 0
    v_mov_b64 v[22:23], 0
    v_add_f32 v27, v27, v62
    v_mov_b32 v62, v27
    v_smfmac_f32_16x16x64_bf16 v[20:23], v[32:35], v[52:59], v1
    s_nop 0
    v_permlane16_swap_b32 v27, v62
    v_add_f32 v27, v27, v62
    v_lshlrev_b32 v2, 16, v28
    v_and_b32 v3, 0xffff0000, v28
    v_add_f32_dpp v27, v27, v27 row_ror:8 row_mask:0xf bank_mask:0xf
    v_pk_add_f32 v[12:13], v[12:13], v[14:15]
    v_pk_add_f32 v[16:17], v[16:17], v[18:19]
    v_add_f32_dpp v27, v27, v27 row_ror:4 row_mask:0xf bank_mask:0xf
    v_pk_add_f32 v[20:21], v[20:21], v[22:23]
    v_add_f32_dpp v24, v13, v12 row_shl:8 row_mask:0xf bank_mask:0xf bound_ctrl:0
    v_add_f32_dpp v27, v27, v27 row_ror:2 row_mask:0xf bank_mask:0xf
    v_add_f32_dpp v25, v17, v16 row_shl:8 row_mask:0xf bank_mask:0xf bound_ctrl:0
    v_add_f32_dpp v26, v21, v20 row_shl:8 row_mask:0xf bank_mask:0xf bound_ctrl:0
    v_add_f32_dpp v27, v27, v27 row_ror:1 row_mask:0xf bank_mask:0xf
    ds_write_b128 v11, v[24:27]
    s_waitcnt lgkmcnt(0)
L_skip_4:
    s_barrier
    s_cmp_eq_u32 s30, 5
    s_cbranch_scc0 L_skip_5
    s_lshl_b32 s59, s31, 2
    s_add_u32 s59, s59, s53
    s_mul_i32 s59, s59, 384
    s_add_u32 s59, s59, 344064
    ds_read2st64_b32 v[12:13], v10 offset0:0 offset1:4
    ds_read2st64_b32 v[14:15], v10 offset0:8 offset1:12
    ds_read_b32 v16, v10 offset:4096
    s_waitcnt lgkmcnt(1)
    v_pk_add_f32 v[12:13], v[12:13], v[14:15]
    s_waitcnt lgkmcnt(0)
    v_add_f32 v12, v12, v16
    v_add_f32 v12, v12, v13
    v_mov_b32 v14, 0x3acccccd
    v_readlane_b32 s57, v12, 24
    v_readlane_b32 s58, v12, 25
    v_permlane32_swap_b32 v12, v13
    v_mul_f32 v15, s57, v14
    v_mul_f32 v16, s58, v14
    v_fma_f32 v16, -v15, v15, v16
    v_max_f32 v16, 0, v16
    v_add_f32 v16, 0x3727c5ac, v16
    v_rsq_f32 v16, v16
    v_fma_f32 v12, -v15, v13, v12
    v_mul_f32 v12, v12, v16
    s_nop 1
    v_mov_b32_dpp v13, v12 row_shl:1 row_mask:0xf bank_mask:0xf bound_ctrl:0
    v_cvt_pk_bf16_f32 v12, v12, v13
    v_min_u32 v12, -2, v12
    s_mov_b64 exec, 0x555555
    buffer_store_dword v12, v11, s[40:43], s59 offen sc1
    s_mov_b64 exec, -1
    v_lshlrev_b32 v4, 16, v4
    v_and_b32 v14, 7, v0
    v_lshlrev_b32 v14, 3, v14
    global_load_dwordx2 v[12:13], v14, s[26:27] sc1
L_skip_5:
    s_waitcnt vmcnt(6)
    ds_read_b128 v[104:107], v8 offset:2048
    ds_read_b128 v[108:111], v9 offset:2048
    s_waitcnt lgkmcnt(0)
    s_add_u32 m0, s61, 2048
    s_mov_b32 s57, 1179648
    buffer_load_dwordx4 v5, s[32:35], s57 offen offset:0 nt lds
    s_mov_b32 s58, 1375232
    buffer_load_dwordx4 v6, s[32:35], s58 offen offset:1024 nt lds
    s_waitcnt vmcnt(6)
    ds_read_b128 v[112:115], v8 offset:4096
    ds_read_b128 v[116:119], v9 offset:4096
    s_waitcnt lgkmcnt(0)
    s_add_u32 m0, s61, 4096
    s_mov_b32 s57, 1179776
    buffer_load_dwordx4 v5, s[32:35], s57 offen offset:0 nt lds
    s_mov_b32 s58, 1375360
    buffer_load_dwordx4 v6, s[32:35], s58 offen offset:1024 nt lds
    s_waitcnt vmcnt(6)
    ds_read_b128 v[120:123], v8 offset:6144
    ds_read_b128 v[124:127], v9 offset:6144
    s_waitcnt lgkmcnt(0)
    s_add_u32 m0, s61, 6144
    s_mov_b32 s57, 1179904
    buffer_load_dwordx4 v5, s[32:35], s57 offen offset:0 nt lds
    s_mov_b32 s58, 1375488
    buffer_load_dwordx4 v6, s[32:35], s58 offen offset:1024 nt lds
    s_waitcnt vmcnt(6)
    ds_read_b128 v[128:131], v8 offset:0
    ds_read_b128 v[132:135], v9 offset:0
    s_waitcnt lgkmcnt(0)
    s_add_u32 m0, s61, 0
    s_mov_b32 s57, 0
    buffer_load_dwordx4 v7, s[36:39], s57 offen offset:0 nt lds
    s_mov_b32 s58, 392192
    buffer_load_dwordx4 v7, s[36:39], s58 offen offset:1024 nt lds
    s_waitcnt vmcnt(6)
    ds_read_b128 v[136:139], v8 offset:2048
    ds_read_b128 v[140:143], v9 offset:2048
    s_waitcnt lgkmcnt(0)
    s_add_u32 m0, s61, 2048
    s_mov_b32 s57, 128
    buffer_load_dwordx4 v7, s[36:39], s57 offen offset:0 nt lds
    s_mov_b32 s58, 392320
    buffer_load_dwordx4 v7, s[36:39], s58 offen offset:1024 nt lds
    s_cmp_eq_u32 s30, 5
    s_cbranch_scc0 L_skip_6
L_cw_7:
    v_sad_u8 v15, v12, 0, 0
    v_sad_u8 v15, v13, 0, v15
    v_cmp_ne_u32 vcc, 32, v15
    s_cbranch_vccnz L_cr_8
    v_readlane_b32 s74, v12, s31
    v_readlane_b32 s75, v13, s31
    s_lshl_b64 s[72:73], s[72:73], 5
    s_cmp_eq_u64 s[72:73], s[74:75]
    s_cselect_b32 s57, 1, 0
    v_mov_b32 v12, s57
    v_mov_b32 v13, 162880
    ds_write_b32 v13, v12
    s_waitcnt lgkmcnt(0)
L_skip_6:
    s_barrier
    v_mov_b32 v13, 162880
    ds_read_b32 v24, v13
    s_lshl_b32 s60, s31, 2
    s_add_u32 s60, s60, s53
    s_mul_i32 s60, s60, 384
    s_add_u32 s60, s60, 344064
    v_lshrrev_b32 v63, 4, v0
    v_lshlrev_b32 v63, 5, v63
    v_bfe_u32 v60, v0, 1, 1
    v_lshl_add_u32 v63, v60, 4, v63
    v_add_u32 v63, s60, v63
    buffer_load_dwordx4 v[12:15], v63, s[40:43], 0 offen offset:0 sc1
    buffer_load_dwordx4 v[16:19], v63, s[40:43], 0 offen offset:128 sc1
    buffer_load_dwordx4 v[20:23], v63, s[40:43], 0 offen offset:256 sc1
    s_waitcnt lgkmcnt(0)
    v_readfirstlane_b32 s55, v24
    s_waitcnt vmcnt(9)
    ds_read_b128 v[144:147], v8 offset:4096
    ds_read_b128 v[148:151], v9 offset:4096
    s_waitcnt lgkmcnt(0)
    s_add_u32 m0, s61, 4096
    s_mov_b32 s57, 256
    buffer_load_dwordx4 v7, s[36:39], s57 offen offset:0 nt lds
    s_mov_b32 s58, 392448
    buffer_load_dwordx4 v7, s[36:39], s58 offen offset:1024 nt lds
    s_waitcnt vmcnt(9)
    ds_read_b128 v[152:155], v8 offset:6144
    ds_read_b128 v[156:159], v9 offset:6144
    s_waitcnt lgkmcnt(0)
    s_add_u32 m0, s61, 6144
    s_mov_b32 s57, 196608
    buffer_load_dwordx4 v7, s[36:39], s57 offen offset:0 nt lds
    s_mov_b32 s58, 588800
    buffer_load_dwordx4 v7, s[36:39], s58 offen offset:1024 nt lds
    v_lshrrev_b32 v8, 2, v0
    v_lshlrev_b32 v8, 7, v8
    v_bfe_u32 v60, v0, 3, 2
    v_lshl_add_u32 v8, v60, 5, v8
    v_and_b32 v60, 3, v0
    v_lshl_add_u32 v8, v60, 3, v8
    v_add_u32 v8, s61, v8
    v_xor_b32 v9, 32, v8
    v_xor_b32 v10, 64, v8
    v_xor_b32 v11, 96, v8
    s_waitcnt vmcnt(9)
    ds_read_b64_tr_b16 v[160:161], v8 offset:0
    ds_read_b64_tr_b16 v[168:169], v9 offset:0
    ds_read_b64_tr_b16 v[176:177], v10 offset:0
    ds_read_b64_tr_b16 v[184:185], v11 offset:0
    s_waitcnt lgkmcnt(0)
    s_add_u32 m0, s61, 0
    s_mov_b32 s57, 196736
    buffer_load_dwordx4 v7, s[36:39], s57 offen offset:0 nt lds
    s_mov_b32 s58, 588928
    buffer_load_dwordx4 v7, s[36:39], s58 offen offset:1024 nt lds
    s_waitcnt vmcnt(9)
    ds_read_b64_tr_b16 v[192:193], v8 offset:2048
    ds_read_b64_tr_b16 v[200:201], v9 offset:2048
    ds_read_b64_tr_b16 v[208:209], v10 offset:2048
    ds_read_b64_tr_b16 v[216:217], v11 offset:2048
    s_waitcnt lgkmcnt(0)
    s_add_u32 m0, s61, 2048
    s_mov_b32 s57, 196864
    buffer_load_dwordx4 v7, s[36:39], s57 offen offset:0 nt lds
    s_mov_b32 s58, 589056
    buffer_load_dwordx4 v7, s[36:39], s58 offen offset:1024 nt lds
    s_cmp_eq_u32 s30, 6
    s_cbranch_scc0 L_skip_9
    s_mov_b64 exec, 0
    s_cbranch_execz L_pad0
L_padback:
    s_mov_b64 exec, -1
L_skip_9:
    s_waitcnt vmcnt(6)
    ds_read_b64_tr_b16 v[224:225], v8 offset:4096
    ds_read_b64_tr_b16 v[232:233], v9 offset:4096
    ds_read_b64_tr_b16 v[240:241], v10 offset:4096
    ds_read_b64_tr_b16 v[248:249], v11 offset:4096
    s_waitcnt lgkmcnt(0)
    s_add_u32 m0, s61, 4096
    s_mov_b32 s57, 786432
    buffer_load_dwordx4 v7, s[36:39], s57 offen offset:0 nt lds
    s_mov_b32 s58, 1178624
    buffer_load_dwordx4 v7, s[36:39], s58 offen offset:1024 nt lds
L_pw_10:
    v_max3_u32 v24, v12, v13, v14
    v_max3_u32 v24, v24, v15, v16
    v_max3_u32 v24, v24, v17, v18
    v_max3_u32 v24, v24, v19, v20
    v_max3_u32 v24, v24, v21, v22
    v_max_u32 v24, v24, v23
    v_cmp_eq_u32 vcc, -1, v24
    s_cbranch_vccnz L_pr_11
    v_mov_b64 v[24:25], 0
    v_mov_b64 v[26:27], 0
    v_mov_b64 v[28:29], 0
    v_mov_b64 v[30:31], 0
    v_mov_b64 v[32:33], 0
    v_mov_b64 v[34:35], 0
    v_mov_b64 v[36:37], 0
    v_mov_b64 v[38:39], 0
    v_mov_b64 v[40:41], 0
    v_mov_b64 v[42:43], 0
    v_mov_b64 v[44:45], 0
    v_mov_b64 v[46:47], 0
    v_mov_b64 v[48:49], 0
    v_mov_b64 v[50:51], 0
    v_mov_b64 v[52:53], 0
    v_mov_b64 v[54:55], 0
    v_mov_b64 v[56:57], 0
    v_mov_b64 v[58:59], 0
    v_mov_b64 v[60:61], 0
    v_mov_b64 v[62:63], 0
    s_lshl_b32 s58, s30, 3
    s_add_u32 s58, s58, 162816
    v_mov_b32 v6, s58
    v_smfmac_f32_16x16x64_bf16 v[24:27], v[12:15], v[64:71], v1
    v_smfmac_f32_16x16x64_bf16 v[24:27], v[16:19], v[72:79], v1
    v_smfmac_f32_16x16x64_bf16 v[24:27], v[20:23], v[80:87], v1
    v_smfmac_f32_16x16x64_bf16 v[28:31], v[12:15], v[88:95], v1
    v_smfmac_f32_16x16x64_bf16 v[28:31], v[16:19], v[96:103], v1
    v_smfmac_f32_16x16x64_bf16 v[28:31], v[20:23], v[104:111], v1
    v_smfmac_f32_16x16x64_bf16 v[32:35], v[12:15], v[112:119], v1
    v_smfmac_f32_16x16x64_bf16 v[32:35], v[16:19], v[120:127], v1
    v_smfmac_f32_16x16x64_bf16 v[32:35], v[20:23], v[128:135], v1
    v_smfmac_f32_16x16x64_bf16 v[36:39], v[12:15], v[136:143], v1
    v_smfmac_f32_16x16x64_bf16 v[36:39], v[16:19], v[144:151], v1
    v_smfmac_f32_16x16x64_bf16 v[36:39], v[20:23], v[152:159], v1
    s_mov_b32 s57, 0x3dd53b95
    s_mov_b32 vcc_lo, 0x55555555
    s_mov_b32 vcc_hi, 0x55555555
    v_add_f32 v24, v24, v26
    v_add_f32 v28, v28, v30
    v_add_f32 v32, v32, v34
    s_nop 1
    v_add_f32 v36, v36, v38
    v_max3_f32 v21, v24, v28, v32
    v_max_f32 v21, v21, v36
    v_mov_b32_dpp v24, v28 quad_perm:[0,1,2,3] row_mask:0x2 bank_mask:0xf
    s_nop 0
    v_max_f32_dpp v21, v21, v21 row_ror:8 row_mask:0xf bank_mask:0xf
    v_mov_b32_dpp v24, v32 quad_perm:[0,1,2,3] row_mask:0x4 bank_mask:0xf
    s_nop 0
    v_max_f32_dpp v21, v21, v21 row_ror:4 row_mask:0xf bank_mask:0xf
    v_mov_b32_dpp v24, v36 quad_perm:[0,1,2,3] row_mask:0x8 bank_mask:0xf
    s_nop 0
    v_max_f32_dpp v21, v21, v21 row_ror:2 row_mask:0xf bank_mask:0xf
    s_nop 1
    v_max_f32_dpp v21, v21, v21 row_ror:1 row_mask:0xf bank_mask:0xf
    v_sub_f32 v24, v24, v21
    v_mul_f32 v24, s57, v24
    v_exp_f32 v22, v24
    v_mul_f32 v20, s57, v21
    s_nop 0
    v_mov_b32_dpp v23, v22 row_shl:1 row_mask:0xf bank_mask:0xf bound_ctrl:0
    v_cvt_pk_bf16_f32 v23, v22, v23
    v_cndmask_b32 v12, 0, v23, vcc
    v_mov_b32 v21, v22
    s_nop 0
    v_mov_b32_dpp v13, v12 row_shl:4 row_mask:0xf bank_mask:0xf bound_ctrl:0
    v_mov_b32_dpp v14, v12 row_shl:8 row_mask:0xf bank_mask:0xf bound_ctrl:0
    v_mov_b32_dpp v15, v12 row_shl:12 row_mask:0xf bank_mask:0xf bound_ctrl:0
    v_mov_b32_dpp v16, v12 row_shr:1 row_mask:0xf bank_mask:0xf bound_ctrl:0
    v_mov_b32_dpp v17, v12 row_shl:3 row_mask:0xf bank_mask:0xf bound_ctrl:0
    v_mov_b32_dpp v18, v12 row_shl:7 row_mask:0xf bank_mask:0xf bound_ctrl:0
    v_mov_b32_dpp v19, v12 row_shl:11 row_mask:0xf bank_mask:0xf bound_ctrl:0
    v_permlane32_swap_b32 v21, v22
    v_add_f32 v21, v21, v22
    v_mov_b32 v22, v21
    s_nop 1
    v_permlane16_swap_b32 v21, v22
    v_add_f32 v21, v21, v22
    s_nop 1
    v_add_f32_dpp v21, v21, v21 row_ror:8 row_mask:0xf bank_mask:0xf
    s_nop 1
    v_add_f32_dpp v21, v21, v21 row_ror:4 row_mask:0xf bank_mask:0xf
    s_nop 1
    v_add_f32_dpp v21, v21, v21 row_ror:2 row_mask:0xf bank_mask:0xf
    s_nop 1
    v_add_f32_dpp v21, v21, v21 row_ror:1 row_mask:0xf bank_mask:0xf
    ds_write_b64 v6, v[20:21]
    s_waitcnt lgkmcnt(0)
    s_barrier
    s_cmp_lt_u32 s30, 2
    s_cbranch_scc0 L_skip_12
    v_and_b32 v37, 7, v0
    v_lshlrev_b32 v37, 3, v37
    v_add_u32 v37, 162816, v37
    ds_read_b64 v[38:39], v37
    s_lshl_b32 s57, s53, 3
    s_add_u32 s57, s57, s54
    s_lshl_b32 s57, s57, 2
    v_mov_b32 v23, s57
    s_add_u32 s57, s62, 26880
    s_waitcnt lgkmcnt(0)
    v_max_f32_dpp v37, v38, v38 row_ror:4 row_mask:0xf bank_mask:0xf
    s_nop 1
    v_max_f32_dpp v37, v37, v37 row_ror:2 row_mask:0xf bank_mask:0xf
    s_nop 1
    v_max_f32_dpp v37, v37, v37 row_ror:1 row_mask:0xf bank_mask:0xf
    v_sub_f32 v38, v38, v37
    v_exp_f32 v38, v38
    s_nop 0
    v_mul_f32 v39, v38, v39
    s_nop 1
    v_add_f32_dpp v39, v39, v39 row_ror:4 row_mask:0xf bank_mask:0xf
    s_nop 1
    v_add_f32_dpp v39, v39, v39 row_ror:2 row_mask:0xf bank_mask:0xf
    s_nop 1
    v_add_f32_dpp v39, v39, v39 row_ror:1 row_mask:0xf bank_mask:0xf
    v_log_f32 v22, v39
    v_rcp_f32 v39, v39
    v_add_f32 v22, v22, v37
    v_min_u32 v22, -2, v22
    v_mul_f32 v38, v38, v39
    s_cmp_eq_u32 s30, 0
    s_cbranch_scc0 L_skip_13
    s_mov_b64 exec, 0x1
    s_cmp_eq_u32 s55, 0
    s_cbranch_scc1 L_gs_14
    buffer_store_dword v22, v23, s[40:43], s57 offen
L_gb_15:
    s_mov_b64 exec, -1
L_skip_13:
    v_readlane_b32 s64, v38, 0
    v_readlane_b32 s65, v38, 1
    v_readlane_b32 s66, v38, 2
    v_readlane_b32 s67, v38, 3
    v_readlane_b32 s68, v38, 4
    v_readlane_b32 s69, v38, 5
    v_readlane_b32 s70, v38, 6
    v_readlane_b32 s71, v38, 7
    s_mul_i32 s57, s30, 48
    v_add_u32 v38, s57, v0
    v_bfe_u32 v5, v38, 5, 2
    v_lshlrev_b32 v5, 8, v5
    v_and_b32 v39, 15, v38
    v_lshl_add_u32 v5, v39, 4, v5
    v_bfe_u32 v39, v38, 4, 1
    v_lshl_add_u32 v5, v39, 3, v5
    v_add_u32 v5, 92160, v5
    s_lshr_b32 s57, s54, 1
    s_lshl_b32 s57, s57, 2
    s_and_b32 s58, s54, 1
    s_add_u32 s57, s57, s58
    s_lshl_b32 s58, s57, 4
    s_lshl_b32 s57, s57, 3
    v_bfe_u32 v6, v0, 3, 2
    v_lshlrev_b32 v6, 8, v6
    v_bfe_u32 v39, v0, 2, 1
    v_lshl_add_u32 v6, v39, 5, v6
    v_and_b32 v39, 3, v0
    v_lshl_add_u32 v6, v39, 2, v6
    v_add_u32 v6, s58, v6
    v_bfe_u32 v38, v0, 3, 1
    v_lshlrev_b32 v38, 8, v38
    v_bfe_u32 v39, v0, 1, 1
    v_lshl_add_u32 v38, v39, 7, v38
    v_bfe_u32 v39, v0, 2, 1
    v_lshl_add_u32 v38, v39, 4, v38
    v_and_b32 v39, 1, v0
    v_lshl_add_u32 v38, v39, 2, v38
    v_add_u32 v38, s57, v38
    v_add_u32 v38, 1024, v38
    v_cmp_gt_u32 vcc, 32, v0
    s_nop 1
    v_cndmask_b32 v6, v38, v6, vcc
    s_lshl_b32 s57, s53, 1
    s_add_u32 s57, s57, s30
    s_mul_i32 s57, s57, 1536
    s_add_u32 s57, s57, s62
    s_add_u32 s57, s57, 0
    v_add_u32 v6, s57, v6
L_skip_12:
    v_and_b32 v36, 15, v0
    v_lshlrev_b32 v36, 4, v36
    v_add_u32 v36, s61, v36
    s_waitcnt vmcnt(6)
    ds_read_b64_tr_b16 v[162:163], v8 offset:6144
    ds_read_b64_tr_b16 v[170:171], v9 offset:6144
    ds_read_b64_tr_b16 v[178:179], v10 offset:6144
    ds_read_b64_tr_b16 v[186:187], v11 offset:6144
    s_waitcnt lgkmcnt(0)
    s_add_u32 m0, s61, 6144
    s_mov_b32 s57, 786560
    buffer_load_dwordx4 v7, s[36:39], s57 offen offset:0 nt lds
    s_mov_b32 s58, 1178752
    buffer_load_dwordx4 v7, s[36:39], s58 offen offset:1024 nt lds
    s_waitcnt vmcnt(6)
    ds_read_b64_tr_b16 v[194:195], v8 offset:0
    ds_read_b64_tr_b16 v[202:203], v9 offset:0
    ds_read_b64_tr_b16 v[210:211], v10 offset:0
    ds_read_b64_tr_b16 v[218:219], v11 offset:0
    s_waitcnt lgkmcnt(0)
    s_add_u32 m0, s61, 0
    s_mov_b32 s57, 786688
    buffer_load_dwordx4 v7, s[36:39], s57 offen offset:0 nt lds
    s_mov_b32 s58, 1178880
    buffer_load_dwordx4 v7, s[36:39], s58 offen offset:1024 nt lds
    s_waitcnt vmcnt(6)
    ds_read_b64_tr_b16 v[226:227], v8 offset:2048
    ds_read_b64_tr_b16 v[234:235], v9 offset:2048
    ds_read_b64_tr_b16 v[242:243], v10 offset:2048
    ds_read_b64_tr_b16 v[250:251], v11 offset:2048
    s_waitcnt lgkmcnt(0)
    s_add_u32 m0, s61, 2048
    s_mov_b32 s57, 983040
    buffer_load_dwordx4 v7, s[36:39], s57 offen offset:0 nt lds
    s_mov_b32 s58, 1375232
    buffer_load_dwordx4 v7, s[36:39], s58 offen offset:1024 nt lds
    s_waitcnt vmcnt(6)
    ds_read_b64_tr_b16 v[164:165], v8 offset:4096
    ds_read_b64_tr_b16 v[172:173], v9 offset:4096
    ds_read_b64_tr_b16 v[180:181], v10 offset:4096
    ds_read_b64_tr_b16 v[188:189], v11 offset:4096
    s_waitcnt lgkmcnt(0)
    s_add_u32 m0, s61, 4096
    s_mov_b32 s57, 983168
    buffer_load_dwordx4 v7, s[36:39], s57 offen offset:0 nt lds
    s_mov_b32 s58, 1375360
    buffer_load_dwordx4 v7, s[36:39], s58 offen offset:1024 nt lds
    s_waitcnt vmcnt(6)
    ds_read_b64_tr_b16 v[196:197], v8 offset:6144
    ds_read_b64_tr_b16 v[204:205], v9 offset:6144
    ds_read_b64_tr_b16 v[212:213], v10 offset:6144
    ds_read_b64_tr_b16 v[220:221], v11 offset:6144
    s_waitcnt lgkmcnt(0)
    s_add_u32 m0, s61, 6144
    s_mov_b32 s57, 983296
    buffer_load_dwordx4 v7, s[36:39], s57 offen offset:0 nt lds
    s_mov_b32 s58, 1375488
    buffer_load_dwordx4 v7, s[36:39], s58 offen offset:1024 nt lds
    s_cmp_eq_u32 s30, 7
    s_cbranch_scc0 L_skip_16
    s_lshl_b32 s57, s52, 10
    s_add_u32 s57, s57, s62
    v_lshlrev_b32 v37, 4, v0
    buffer_load_dword v37, v37, s[40:43], s57 offen sc1
L_skip_16:
    s_mul_i32 s59, s30, 6144
    s_add_u32 s59, s59, 30720
    s_cmp_lt_u32 s52, 20
    s_cbranch_scc0 L_wb_17
    s_mov_b32 s48, s12
    s_mov_b32 s49, s13
    s_mov_b32 s50, 7864320
    s_mov_b32 s51, 0x20000
    s_mul_i32 s57, s31, 768
    s_mul_i32 s58, s30, 96
    s_add_u32 s57, s57, s58
    s_mul_i32 s57, s57, 1280
    s_lshl_b32 s58, s52, 6
    s_add_u32 s57, s57, s58
    v_bfe_u32 v38, v0, 4, 1
    v_lshlrev_b32 v38, 1, v38
    v_xor_b32 v38, v38, v0
    v_and_b32 v38, 3, v38
    v_lshrrev_b32 v7, 5, v0
    v_mul_u32_u24 v7, 10240, v7
    v_bfe_u32 v39, v0, 4, 1
    v_mul_u32_u24 v39, 2560, v39
    v_add_u32 v7, v39, v7
    v_bfe_u32 v39, v0, 3, 1
    v_mul_u32_u24 v39, 5120, v39
    v_add_u32 v7, v39, v7
    v_bfe_u32 v39, v0, 2, 1
    v_mul_u32_u24 v39, 20480, v39
    v_add_u32 v7, v39, v7
    v_add_u32 v7, s57, v7
    v_lshl_add_u32 v7, v38, 4, v7
    s_add_u32 m0, s59, 0
    s_mov_b32 s57, 0
    buffer_load_dwordx4 v7, s[48:51], s57 offen nt lds
    s_add_u32 m0, s59, 1024
    s_mov_b32 s57, 1280
    buffer_load_dwordx4 v7, s[48:51], s57 offen nt lds
    s_add_u32 m0, s59, 2048
    s_mov_b32 s57, 40960
    buffer_load_dwordx4 v7, s[48:51], s57 offen nt lds
    s_add_u32 m0, s59, 3072
    s_mov_b32 s57, 42240
    buffer_load_dwordx4 v7, s[48:51], s57 offen nt lds
    s_add_u32 m0, s59, 4096
    s_mov_b32 s57, 81920
    buffer_load_dwordx4 v7, s[48:51], s57 offen nt lds
    s_add_u32 m0, s59, 5120
    s_mov_b32 s57, 83200
    buffer_load_dwordx4 v7, s[48:51], s57 offen nt lds
    s_branch L_we_18
L_wb_17:
    s_mov_b32 s48, s16
    s_mov_b32 s49, s17
    s_mov_b32 s50, 1966080
    s_mov_b32 s51, 0x20000
    s_mul_i32 s57, s31, 384
    s_sub_u32 s58, s52, 20
    s_lshl_b32 s58, s58, 5
    s_add_u32 s57, s57, s58
    s_mul_i32 s58, s30, 393216
    s_add_u32 s57, s57, s58
    v_lshrrev_b32 v7, 1, v0
    v_mul_u32_u24 v7, 3072, v7
    v_and_b32 v39, 1, v0
    v_lshl_add_u32 v7, v39, 4, v7
    v_add_u32 v7, s57, v7
    v_mov_b32 v38, 0x7ffffff0
    s_add_u32 m0, s59, 0
    s_mov_b32 s57, 0
    buffer_load_dwordx4 v7, s[48:51], s57 offen nt lds
    s_add_u32 m0, s59, 1024
    s_mov_b32 s57, 98304
    buffer_load_dwordx4 v7, s[48:51], s57 offen nt lds
    s_add_u32 m0, s59, 2048
    s_mov_b32 s57, 196608
    buffer_load_dwordx4 v7, s[48:51], s57 offen nt lds
    s_add_u32 m0, s59, 3072
    s_mov_b32 s57, 294912
    buffer_load_dwordx4 v7, s[48:51], s57 offen nt lds
    s_add_u32 m0, s59, 4096
    s_mov_b32 s57, 0
    buffer_load_dwordx4 v38, s[48:51], s57 offen nt lds
    s_add_u32 m0, s59, 5120
    s_mov_b32 s57, 0
    buffer_load_dwordx4 v38, s[48:51], s57 offen nt lds
L_we_18:
    s_waitcnt vmcnt(12)
    ds_read_b64_tr_b16 v[228:229], v8 offset:0
    ds_read_b64_tr_b16 v[236:237], v9 offset:0
    ds_read_b64_tr_b16 v[244:245], v10 offset:0
    ds_read_b64_tr_b16 v[252:253], v11 offset:0
    s_waitcnt lgkmcnt(0)
    s_branch L_tail
.p2align 10
L_tail:
L_pad0:
    s_cbranch_execz L_pad1
    s_waitcnt vmcnt(10)
    ds_read_b64_tr_b16 v[166:167], v8 offset:2048
    ds_read_b64_tr_b16 v[174:175], v9 offset:2048
    ds_read_b64_tr_b16 v[182:183], v10 offset:2048
    ds_read_b64_tr_b16 v[190:191], v11 offset:2048
    s_waitcnt lgkmcnt(0)
    v_smfmac_f32_16x16x64_bf16 v[40:43], v[12:15], v[160:167], v1
    v_smfmac_f32_16x16x64_bf16 v[40:43], v[16:19], v[168:175], v1
    v_smfmac_f32_16x16x64_bf16 v[44:47], v[12:15], v[176:183], v1
    v_smfmac_f32_16x16x64_bf16 v[44:47], v[16:19], v[184:191], v1
    s_nop 5
    v_pk_add_f32 v[24:25], v[40:41], v[42:43]
    s_nop 0
    v_pk_add_f32 v[26:27], v[44:45], v[46:47]
    s_waitcnt vmcnt(8)
    ds_read_b64_tr_b16 v[198:199], v8 offset:4096
    ds_read_b64_tr_b16 v[206:207], v9 offset:4096
    ds_read_b64_tr_b16 v[214:215], v10 offset:4096
    ds_read_b64_tr_b16 v[222:223], v11 offset:4096
    s_waitcnt lgkmcnt(0)
    v_smfmac_f32_16x16x64_bf16 v[48:51], v[12:15], v[192:199], v1
    v_smfmac_f32_16x16x64_bf16 v[48:51], v[16:19], v[200:207], v1
    v_smfmac_f32_16x16x64_bf16 v[52:55], v[12:15], v[208:215], v1
    v_smfmac_f32_16x16x64_bf16 v[52:55], v[16:19], v[216:223], v1
    s_nop 5
    v_pk_add_f32 v[28:29], v[48:49], v[50:51]
    s_nop 0
    v_pk_add_f32 v[30:31], v[52:53], v[54:55]
    s_waitcnt vmcnt(6)
    ds_read_b64_tr_b16 v[230:231], v8 offset:6144
    ds_read_b64_tr_b16 v[238:239], v9 offset:6144
    ds_read_b64_tr_b16 v[246:247], v10 offset:6144
    ds_read_b64_tr_b16 v[254:255], v11 offset:6144
    s_waitcnt lgkmcnt(0)
    v_smfmac_f32_16x16x64_bf16 v[56:59], v[12:15], v[224:231], v1
    v_smfmac_f32_16x16x64_bf16 v[56:59], v[16:19], v[232:239], v1
    v_smfmac_f32_16x16x64_bf16 v[60:63], v[12:15], v[240:247], v1
    v_smfmac_f32_16x16x64_bf16 v[60:63], v[16:19], v[248:255], v1
    s_nop 5
    v_pk_add_f32 v[32:33], v[56:57], v[58:59]
    s_nop 0
    v_pk_add_f32 v[34:35], v[60:61], v[62:63]
    s_mov_b64 exec, 0xffff
    ds_write_b128 v36, v[24:27] offset:0
    ds_write_b128 v36, v[28:31] offset:256
    ds_write_b128 v36, v[32:35] offset:512
    s_mov_b64 exec, -1
    s_waitcnt lgkmcnt(0)
L_b2_0:
    s_barrier
    s_cmp_lt_u32 s30, 2
    s_cbranch_scc0 L_skip_19
    s_mov_b32 exec_lo, 0xffffffff
    s_mov_b32 exec_hi, 0xffff
    ds_read_b64 v[40:41], v5 offset:0
    ds_read_b64 v[42:43], v5 offset:8192
    ds_read_b64 v[44:45], v5 offset:16384
    ds_read_b64 v[46:47], v5 offset:24576
    ds_read_b64 v[48:49], v5 offset:32768
    ds_read_b64 v[50:51], v5 offset:40960
    ds_read_b64 v[52:53], v5 offset:49152
    ds_read_b64 v[54:55], v5 offset:57344
    s_waitcnt lgkmcnt(7)
    v_mul_f32 v56, s64, v40
    v_mul_f32 v57, s64, v41
    s_waitcnt lgkmcnt(6)
    v_fmac_f32 v56, s65, v42
    v_fmac_f32 v57, s65, v43
    s_waitcnt lgkmcnt(5)
    v_fmac_f32 v56, s66, v44
    v_fmac_f32 v57, s66, v45
    s_waitcnt lgkmcnt(4)
    v_fmac_f32 v56, s67, v46
    v_fmac_f32 v57, s67, v47
    s_waitcnt lgkmcnt(3)
    v_fmac_f32 v56, s68, v48
    v_fmac_f32 v57, s68, v49
    s_waitcnt lgkmcnt(2)
    v_fmac_f32 v56, s69, v50
    v_fmac_f32 v57, s69, v51
    s_waitcnt lgkmcnt(1)
    v_fmac_f32 v56, s70, v52
    v_fmac_f32 v57, s70, v53
    s_waitcnt lgkmcnt(0)
    v_fmac_f32 v56, s71, v54
L_pad1:
    s_cbranch_execz L_pad2
    v_fmac_f32 v57, s71, v55
    v_cvt_pk_bf16_f32 v56, v56, v57
    v_min_u32 v56, -2, v56
    s_cmp_eq_u32 s55, 0
    s_cbranch_scc1 L_gs_20
    buffer_store_dword v56, v6, s[40:43], 0 offen
L_gb_21:
    s_mov_b64 exec, -1
L_skip_19:
    s_cmp_lt_u32 s52, 20
    s_cbranch_scc0 L_typeB_0
    s_lshr_b32 s57, s30, 1
    s_lshl_b32 s57, s57, 5
    s_add_u32 s57, s57, s62
    s_add_u32 s59, s57, 26880
    v_and_b32 v5, 7, v0
    v_lshlrev_b32 v5, 2, v5
    v_lshrrev_b32 v6, 4, v0
    v_lshlrev_b32 v6, 3, v6
    buffer_load_dword v18, v5, s[40:43], s59 offen sc1
    buffer_load_dwordx2 v[20:21], v6, s[40:43], s59 offen sc1
    s_mul_i32 s57, s30, 6144
    v_lshrrev_b32 v7, 2, v0
    v_lshlrev_b32 v7, 6, v7
    v_bfe_u32 v60, v0, 4, 1
    v_lshl_add_u32 v7, v60, 5, v7
    v_and_b32 v60, 3, v0
    v_lshl_add_u32 v7, v60, 3, v7
    v_add_u32 v7, s57, v7
    v_add_u32 v7, 30720, v7
    v_xor_b32 v8, 32, v7
    s_mul_i32 s60, s30, 1536
    s_add_u32 s60, s60, s62
    s_add_u32 s60, s60, 0
    v_lshlrev_b32 v9, 4, v0
    v_lshlrev_b32 v10, 3, v0
    s_waitcnt vmcnt(2)
    ds_read_b64_tr_b16 v[36:37], v7 offset:0
    ds_read_b64_tr_b16 v[38:39], v7 offset:1024
    ds_read_b64_tr_b16 v[40:41], v7 offset:2048
    ds_read_b64_tr_b16 v[42:43], v7 offset:3072
    ds_read_b64_tr_b16 v[44:45], v7 offset:4096
    ds_read_b64_tr_b16 v[46:47], v7 offset:5120
    ds_read_b64_tr_b16 v[48:49], v8 offset:0
    ds_read_b64_tr_b16 v[50:51], v8 offset:1024
    ds_read_b64_tr_b16 v[52:53], v8 offset:2048
    ds_read_b64_tr_b16 v[54:55], v8 offset:3072
    ds_read_b64_tr_b16 v[56:57], v8 offset:4096
    ds_read_b64_tr_b16 v[58:59], v8 offset:5120
    v_mov_b64 v[24:25], 0
    v_mov_b64 v[26:27], 0
    v_mov_b64 v[28:29], 0
    v_mov_b64 v[30:31], 0
    s_lshl_b32 s57, s30, 8
    v_lshlrev_b32 v11, 2, v0
    v_add_u32 v11, s57, v11
    v_add_u32 v11, 157696, v11
    s_waitcnt vmcnt(0)
L_pw_22:
    v_max3_u32 v19, v18, v20, v21
    v_cmp_eq_u32 vcc, -1, v19
    s_cbranch_vccnz L_pr_23
    buffer_load_dwordx4 v[12:15], v9, s[40:43], s60 offen sc1
    buffer_load_dwordx2 v[16:17], v10, s[40:43], s60 offen offset:1024 sc1
    v_max_f32_dpp v19, v18, v18 row_ror:4 row_mask:0xf bank_mask:0xf
    s_nop 1
    v_max_f32_dpp v19, v19, v19 row_ror:2 row_mask:0xf bank_mask:0xf
    s_nop 1
    v_max_f32_dpp v19, v19, v19 row_ror:1 row_mask:0xf bank_mask:0xf
    v_sub_f32 v18, v18, v19
    v_sub_f32 v20, v20, v19
    v_sub_f32 v21, v21, v19
    v_exp_f32 v18, v18
    v_exp_f32 v20, v20
    v_exp_f32 v21, v21
    v_add_f32_dpp v18, v18, v18 row_ror:4 row_mask:0xf bank_mask:0xf
    s_nop 1
    v_add_f32_dpp v18, v18, v18 row_ror:2 row_mask:0xf bank_mask:0xf
    s_nop 1
    v_add_f32_dpp v18, v18, v18 row_ror:1 row_mask:0xf bank_mask:0xf
    v_rcp_f32 v18, v18
    s_nop 0
    v_mul_f32 v20, v20, v18
    v_mul_f32 v21, v21, v18
    s_waitcnt lgkmcnt(0)
    s_waitcnt vmcnt(0)
L_pw_24:
    v_max3_u32 v19, v12, v13, v14
    v_max3_u32 v19, v19, v15, v16
    v_max_u32 v19, v19, v17
    v_cmp_eq_u32 vcc, -1, v19
    s_cbranch_vccnz L_pr_25
    v_smfmac_f32_16x16x64_bf16 v[24:27], v[12:15], v[36:43], v1
    v_smfmac_f32_16x16x64_bf16 v[28:31], v[12:15], v[48:55], v1
L_pad2:
    s_cbranch_execz L_pad3
    v_smfmac_f32_16x16x32_bf16 v[24:27], v[16:17], v[44:47], v1
    v_smfmac_f32_16x16x32_bf16 v[28:31], v[16:17], v[56:59], v1
    s_nop 6
    v_pk_add_f32 v[24:25], v[24:25], v[26:27]
    v_pk_add_f32 v[28:29], v[28:29], v[30:31]
    v_mul_f32 v24, v24, v20
    v_mul_f32 v28, v28, v20
    v_fmac_f32 v24, v25, v21
    v_fmac_f32 v28, v29, v21
    s_nop 1
    v_permlane32_swap_b32 v24, v28
    v_add_f32 v24, v24, v28
    ds_write_b32 v11, v24
    v_lshlrev_b32 v5, 2, v0
    v_add_u32 v5, 157696, v5
    s_mul_i32 s59, s31, 2560
    s_lshl_b32 s58, s52, 7
    s_add_u32 s59, s59, s58
    s_add_u32 s59, s59, 262080
    v_lshlrev_b32 v6, 2, v0
    s_waitcnt lgkmcnt(0)
    s_barrier
    s_cmp_eq_u32 s30, 2
    s_cbranch_scc0 L_skip_26
    ds_read2st64_b32 v[12:13], v5 offset0:0 offset1:1
    ds_read2st64_b32 v[14:15], v5 offset0:2 offset1:3
    ds_read2st64_b32 v[16:17], v5 offset0:4 offset1:5
    ds_read2st64_b32 v[18:19], v5 offset0:6 offset1:7
    s_waitcnt lgkmcnt(2)
    v_pk_add_f32 v[12:13], v[12:13], v[14:15]
    s_waitcnt lgkmcnt(0)
    v_pk_add_f32 v[16:17], v[16:17], v[18:19]
    v_pk_add_f32 v[12:13], v[12:13], v[16:17]
    v_add_f32 v12, v12, v13
    v_mov_b32 v13, v12
    s_nop 1
    v_permlane16_swap_b32 v12, v13
    v_add_f32 v12, v12, v13
    v_min_u32 v12, -2, v12
    s_mov_b32 exec_lo, 0xffff0000
    s_mov_b32 exec_hi, 0xffff
    buffer_store_dword v12, v6, s[40:43], s59 offen sc1
    s_lshl_b32 s57, s52, 2
    s_add_u32 s57, s57, s62
    s_add_u32 s57, s57, 27136
    s_mov_b64 exec, 0x1
    s_cmp_eq_u32 s55, 0
    s_cbranch_scc1 L_gs_27
    buffer_store_dword v0, v0, s[40:43], s57 offen
L_gb_28:
    s_mov_b64 exec, -1
L_skip_26:
    s_sub_u32 s57, s30, 5
    s_cmp_lt_u32 s57, 2
    s_cbranch_scc0 L_skip_29
    s_sub_u32 s60, s30, 5
    s_mul_i32 s59, s60, 6144
    s_add_u32 s59, s59, 79872
    s_mov_b32 s44, s20
    s_mov_b32 s45, s21
    s_mov_b32 s46, 1966080
    s_mov_b32 s47, 0x20000
    s_mul_i32 s57, s31, 245760
    s_lshl_b32 s58, s52, 6
    s_add_u32 s57, s57, s58
    s_lshl_b32 s58, s60, 5
    s_add_u32 s57, s57, s58
    v_lshrrev_b32 v5, 1, v0
    v_mul_u32_u24 v5, 1280, v5
    v_and_b32 v60, 1, v0
    v_lshl_add_u32 v5, v60, 4, v5
    v_add_u32 v5, s57, v5
    s_add_u32 m0, s59, 0
    s_mov_b32 s57, 0
    buffer_load_dwordx4 v5, s[44:47], s57 offen nt lds
    s_add_u32 m0, s59, 1024
    s_mov_b32 s57, 40960
    buffer_load_dwordx4 v5, s[44:47], s57 offen nt lds
    s_add_u32 m0, s59, 2048
    s_mov_b32 s57, 81920
    buffer_load_dwordx4 v5, s[44:47], s57 offen nt lds
    s_add_u32 m0, s59, 3072
    s_mov_b32 s57, 122880
    buffer_load_dwordx4 v5, s[44:47], s57 offen nt lds
    s_add_u32 m0, s59, 4096
    s_mov_b32 s57, 163840
    buffer_load_dwordx4 v5, s[44:47], s57 offen nt lds
    s_add_u32 m0, s59, 5120
L_pad3:
    s_cbranch_execz L_pad4
    s_mov_b32 s57, 204800
    buffer_load_dwordx4 v5, s[44:47], s57 offen nt lds
    v_lshrrev_b32 v7, 5, v0
    v_lshlrev_b32 v7, 9, v7
    v_bfe_u32 v60, v0, 4, 1
    v_lshl_add_u32 v7, v60, 7, v7
    v_bfe_u32 v60, v0, 3, 1
    v_lshl_add_u32 v7, v60, 8, v7
    v_bfe_u32 v60, v0, 2, 1
    v_lshl_add_u32 v7, v60, 5, v7
    v_and_b32 v60, 3, v0
    v_lshl_add_u32 v7, v60, 3, v7
    v_add_u32 v7, s59, v7
    s_add_u32 s59, s62, 26112
    v_lshrrev_b32 v5, 4, v0
    v_lshlrev_b32 v5, 5, v5
    v_bfe_u32 v60, v0, 1, 1
    v_lshl_add_u32 v5, v60, 4, v5
    v_mov_b64 v[24:25], 0
    v_mov_b64 v[26:27], 0
    s_mul_i32 s57, s31, 2560
    s_lshl_b32 s58, s52, 7
    s_add_u32 s57, s57, s58
    s_lshl_b32 s60, s60, 6
    s_add_u32 s60, s60, s57
    s_add_u32 s60, s60, 282624
    v_lshlrev_b32 v6, 2, v0
    s_waitcnt vmcnt(0)
    ds_read_b64_tr_b16 v[36:37], v7 offset:0
    ds_read_b64_tr_b16 v[38:39], v7 offset:64
    ds_read_b64_tr_b16 v[40:41], v7 offset:1024
    ds_read_b64_tr_b16 v[42:43], v7 offset:1088
    ds_read_b64_tr_b16 v[44:45], v7 offset:2048
    ds_read_b64_tr_b16 v[46:47], v7 offset:2112
    ds_read_b64_tr_b16 v[48:49], v7 offset:3072
    ds_read_b64_tr_b16 v[50:51], v7 offset:3136
    ds_read_b64_tr_b16 v[52:53], v7 offset:4096
    ds_read_b64_tr_b16 v[54:55], v7 offset:4160
    ds_read_b64_tr_b16 v[56:57], v7 offset:5120
    ds_read_b64_tr_b16 v[58:59], v7 offset:5184
    buffer_load_dwordx4 v[12:15], v5, s[40:43], s59 offen offset:0 sc1
    buffer_load_dwordx4 v[16:19], v5, s[40:43], s59 offen offset:128 sc1
    buffer_load_dwordx4 v[20:23], v5, s[40:43], s59 offen offset:256 sc1
    s_waitcnt lgkmcnt(0)
    s_waitcnt vmcnt(0)
L_pw_30:
    v_max3_u32 v28, v12, v13, v14
    v_max3_u32 v28, v28, v15, v16
    v_max3_u32 v28, v28, v17, v18
    v_max3_u32 v28, v28, v19, v20
    v_max3_u32 v28, v28, v21, v22
    v_max_u32 v28, v28, v23
    v_cmp_eq_u32 vcc, -1, v28
    s_cbranch_vccnz L_pr_31
    v_smfmac_f32_16x16x64_bf16 v[24:27], v[12:15], v[36:43], v1
    v_smfmac_f32_16x16x64_bf16 v[24:27], v[16:19], v[44:51], v1
    v_smfmac_f32_16x16x64_bf16 v[24:27], v[20:23], v[52:59], v1
    s_nop 7
    v_add_f32 v24, v24, v26
    v_min_u32 v24, -2, v24
    s_mov_b64 exec, 0xffff
    buffer_store_dword v24, v6, s[40:43], s60 offen sc1
    s_cmp_eq_u32 s30, 6
    s_cbranch_scc0 L_skip_32
    s_lshl_b32 s57, s52, 2
    s_add_u32 s57, s57, s62
    s_add_u32 s57, s57, 27264
    s_mov_b64 exec, 0x1
    s_cmp_eq_u32 s55, 0
    s_cbranch_scc1 L_gs_33
    buffer_store_dword v0, v0, s[40:43], s57 offen
L_gb_34:
    s_mov_b64 exec, -1
L_skip_32:
    s_mov_b64 exec, -1
L_skip_29:
    s_cmp_lt_u32 s30, 5
    s_cbranch_scc0 L_skip_35
    s_mul_i32 s57, s30, 6144
    v_lshrrev_b32 v10, 4, v0
    v_mul_u32_u24 v10, 1536, v10
    v_bfe_u32 v60, v0, 3, 1
    v_mul_u32_u24 v60, 384, v60
    v_add_u32 v10, v60, v10
    v_bfe_u32 v60, v0, 1, 1
L_pad4:
    s_cbranch_execz L_pad5
    v_mul_u32_u24 v60, 192, v60
    v_add_u32 v10, v60, v10
    v_bfe_u32 v60, v0, 2, 1
    v_mul_u32_u24 v60, 48, v60
    v_add_u32 v10, v60, v10
    v_and_b32 v60, 1, v0
    v_lshl_add_u32 v10, v60, 3, v10
    v_add_u32 v10, s57, v10
    ds_read_b64_tr_b16 v[36:37], v10 offset:0
    ds_read_b64_tr_b16 v[38:39], v10 offset:768
    ds_read_b64_tr_b16 v[40:41], v10 offset:96
    ds_read_b64_tr_b16 v[42:43], v10 offset:864
    ds_read_b64_tr_b16 v[44:45], v10 offset:16
    ds_read_b64_tr_b16 v[46:47], v10 offset:784
    ds_read_b64_tr_b16 v[48:49], v10 offset:112
    ds_read_b64_tr_b16 v[50:51], v10 offset:880
    ds_read_b64_tr_b16 v[52:53], v10 offset:32
    ds_read_b64_tr_b16 v[54:55], v10 offset:800
    ds_read_b64_tr_b16 v[56:57], v10 offset:128
    ds_read_b64_tr_b16 v[58:59], v10 offset:896
    s_lshl_b32 s57, s30, 10
    v_lshlrev_b32 v11, 4, v0
    v_add_u32 v11, s57, v11
    v_add_u32 v11, 157696, v11
    v_mov_b32 v32, 0x3f803f80
    v_mov_b32 v33, 0x3f803f80
    v_mov_b32 v34, 0x3f803f80
    v_mov_b32 v35, 0x3f803f80
    v_mov_b32 v61, 0x3f803f80
    s_lshl_b32 s57, s30, 9
    v_lshrrev_b32 v5, 5, v0
    v_mul_u32_u24 v5, 2560, v5
    v_and_b32 v60, 31, v0
    v_lshl_add_u32 v5, v60, 4, v5
    v_add_u32 v5, s57, v5
L_skip_35:
    s_barrier
    s_cmp_lt_u32 s30, 5
    s_cbranch_scc0 L_p1_skip
    s_mov_b32 s57, 262144
    buffer_load_dwordx4 v[12:15], v5, s[40:43], s57 offen sc1
    s_mov_b32 s58, 267264
    buffer_load_dwordx4 v[16:19], v5, s[40:43], s58 offen sc1
    s_mov_b32 s59, 272384
    buffer_load_dwordx4 v[20:23], v5, s[40:43], s59 offen sc1
    s_mov_b32 s60, 277504
    buffer_load_dwordx4 v[24:27], v5, s[40:43], s60 offen sc1
L_gw_36:
    s_waitcnt vmcnt(2)
    v_pk_add_f32 v[28:29], v[12:13], v[16:17]
    v_pk_add_f32 v[30:31], v[14:15], v[18:19]
    s_waitcnt vmcnt(1)
    v_pk_add_f32 v[28:29], v[28:29], v[20:21]
    v_pk_add_f32 v[30:31], v[30:31], v[22:23]
    s_waitcnt vmcnt(0)
    v_pk_add_f32 v[28:29], v[28:29], v[24:25]
    v_pk_add_f32 v[30:31], v[30:31], v[26:27]
    s_nop 1
    v_permlane32_swap_b32 v28, v30
    v_permlane32_swap_b32 v29, v31
    v_pk_add_f32 v[28:29], v[28:29], v[30:31]
    v_pk_add_f32 v[28:29], v[28:29], v[2:3]
    v_cmp_u_f32 vcc, v28, v29
    s_cbranch_vccnz L_gr_37
L_gk_38:
    v_cvt_pk_bf16_f32 v28, v28, v29
    v_lshlrev_b32 v2, 16, v28
    v_and_b32 v3, 0xffff0000, v28
    v_lshlrev_b32 v60, 16, v4
    v_add_f32 v2, v2, v60
    v_and_b32 v60, 0xffff0000, v4
    v_add_f32 v3, v3, v60
    s_branch L_p1
L_typeB_0:
    s_cmp_lt_u32 s30, 5
    s_cbranch_scc0 L_skip_43
    s_waitcnt vmcnt(0)
    s_mul_i32 s57, s30, 6144
    v_lshrrev_b32 v10, 4, v0
    v_lshlrev_b32 v10, 10, v10
    v_bfe_u32 v60, v0, 3, 1
    v_lshl_add_u32 v10, v60, 8, v10
    v_bfe_u32 v60, v0, 1, 1
    v_lshl_add_u32 v10, v60, 7, v10
L_pad5:
    s_cbranch_execz L_pad6
    v_bfe_u32 v60, v0, 2, 1
    v_lshl_add_u32 v10, v60, 5, v10
    v_and_b32 v60, 1, v0
    v_lshl_add_u32 v10, v60, 3, v10
    v_add_u32 v10, s57, v10
    v_add_u32 v10, 30720, v10
    ds_read_b64_tr_b16 v[36:37], v10 offset:0
    ds_read_b64_tr_b16 v[38:39], v10 offset:512
    ds_read_b64_tr_b16 v[40:41], v10 offset:64
    ds_read_b64_tr_b16 v[42:43], v10 offset:576
    ds_read_b64_tr_b16 v[44:45], v10 offset:16
    ds_read_b64_tr_b16 v[46:47], v10 offset:528
    ds_read_b64_tr_b16 v[48:49], v10 offset:80
    ds_read_b64_tr_b16 v[50:51], v10 offset:592
    s_lshl_b32 s57, s30, 10
    v_lshlrev_b32 v11, 4, v0
    v_add_u32 v11, s57, v11
    v_add_u32 v11, 157696, v11
    v_mov_b32 v32, 0x3f803f80
    v_mov_b32 v33, 0x3f803f80
    v_mov_b32 v34, 0x3f803f80
    v_mov_b32 v35, 0x3f803f80
    v_mov_b32 v61, 0x3f803f80
    s_lshl_b32 s57, s30, 9
    v_lshrrev_b32 v5, 5, v0
    v_mul_u32_u24 v5, 2560, v5
    v_and_b32 v60, 31, v0
    v_lshl_add_u32 v5, v60, 4, v5
    v_add_u32 v5, s57, v5
    s_add_u32 s57, s62, 27136
    v_min_u32 v6, 19, v0
    v_lshlrev_b32 v6, 2, v6
    buffer_load_dword v12, v6, s[40:43], s57 offen sc1
    s_waitcnt vmcnt(0)
L_pw_44:
    v_cmp_eq_u32 vcc, -1, v12
    s_cbranch_vccnz L_pr_45
    s_mov_b32 s57, 262144
    buffer_load_dwordx4 v[12:15], v5, s[40:43], s57 offen sc1
    s_mov_b32 s58, 267264
    buffer_load_dwordx4 v[16:19], v5, s[40:43], s58 offen sc1
    s_mov_b32 s59, 272384
    buffer_load_dwordx4 v[20:23], v5, s[40:43], s59 offen sc1
    s_mov_b32 s60, 277504
    buffer_load_dwordx4 v[24:27], v5, s[40:43], s60 offen sc1
L_gw_46:
    s_waitcnt vmcnt(2)
    v_pk_add_f32 v[28:29], v[12:13], v[16:17]
    v_pk_add_f32 v[30:31], v[14:15], v[18:19]
    s_waitcnt vmcnt(1)
    v_pk_add_f32 v[28:29], v[28:29], v[20:21]
    v_pk_add_f32 v[30:31], v[30:31], v[22:23]
    s_waitcnt vmcnt(0)
    v_pk_add_f32 v[28:29], v[28:29], v[24:25]
    v_pk_add_f32 v[30:31], v[30:31], v[26:27]
    s_nop 1
    v_permlane32_swap_b32 v28, v30
    v_permlane32_swap_b32 v29, v31
    v_pk_add_f32 v[28:29], v[28:29], v[30:31]
    v_pk_add_f32 v[28:29], v[28:29], v[2:3]
    v_cmp_u_f32 vcc, v28, v29
    s_cbranch_vccnz L_gr_47
L_gk_48:
    v_cvt_pk_bf16_f32 v28, v28, v29
    v_mov_b64 v[12:13], 0
    v_mov_b64 v[14:15], 0
    v_mov_b32_dpp v32, v28 quad_perm:[0,1,2,3] row_mask:0xf bank_mask:0x1
    v_mov_b32_dpp v33, v28 row_shl:4 row_mask:0xf bank_mask:0x1
    v_mov_b32_dpp v34, v28 row_shl:8 row_mask:0xf bank_mask:0x1
    v_mov_b32_dpp v35, v28 row_shl:12 row_mask:0xf bank_mask:0x1
    v_dot2_f32_bf16 v27, v28, v61, 0
    v_dot2_f32_bf16 v62, v28, v28, 0
    s_waitcnt lgkmcnt(0)
    v_smfmac_f32_16x16x64_bf16 v[12:15], v[32:35], v[36:43], v1
    v_mov_b64 v[16:17], 0
    v_mov_b64 v[18:19], 0
    v_permlane32_swap_b32 v27, v62
    s_nop 0
    v_smfmac_f32_16x16x64_bf16 v[16:19], v[32:35], v[44:51], v1
    v_add_f32 v27, v27, v62
    v_mov_b32 v62, v27
    s_nop 1
    v_permlane16_swap_b32 v27, v62
L_pad6:
    s_cbranch_execz L_pad7
    v_add_f32 v27, v27, v62
    v_lshlrev_b32 v2, 16, v28
    v_and_b32 v3, 0xffff0000, v28
    v_add_f32_dpp v27, v27, v27 row_ror:8 row_mask:0xf bank_mask:0xf
    v_pk_add_f32 v[12:13], v[12:13], v[14:15]
    v_pk_add_f32 v[16:17], v[16:17], v[18:19]
    v_add_f32_dpp v27, v27, v27 row_ror:4 row_mask:0xf bank_mask:0xf
    v_add_f32_dpp v24, v13, v12 row_shl:8 row_mask:0xf bank_mask:0xf bound_ctrl:0
    v_add_f32_dpp v25, v17, v16 row_shl:8 row_mask:0xf bank_mask:0xf bound_ctrl:0
    v_add_f32_dpp v27, v27, v27 row_ror:2 row_mask:0xf bank_mask:0xf
    s_nop 1
    v_add_f32_dpp v27, v27, v27 row_ror:1 row_mask:0xf bank_mask:0xf
    ds_write_b128 v11, v[24:27]
    s_waitcnt lgkmcnt(0)
L_skip_43:
    s_cmp_eq_u32 s30, 5
    s_cbranch_scc0 L_skip_53
    v_and_b32 v10, 7, v0
    v_lshlrev_b32 v10, 4, v10
    v_bfe_u32 v60, v0, 3, 2
    v_lshl_add_u32 v10, v60, 2, v10
    v_lshrrev_b32 v60, 5, v0
    v_lshl_add_u32 v10, v60, 8, v10
    v_add_u32 v10, 157696, v10
    v_mov_b32 v60, 158220
    v_cmp_eq_u32 vcc, 25, v0
    s_nop 1
    v_cndmask_b32 v10, v10, v60, vcc
    s_sub_u32 s59, s52, 20
    s_lshl_b32 s59, s59, 5
    s_add_u32 s59, s59, s62
    s_add_u32 s59, s59, 26112
    v_lshlrev_b32 v11, 1, v0
    v_mov_b32 v18, 0xc0135761
    v_mov_b32 v19, 0xbdd2d3e8
L_skip_53:
    s_barrier
    s_cmp_eq_u32 s30, 5
    s_cbranch_scc0 L_skip_54
    ds_read2st64_b32 v[12:13], v10 offset0:0 offset1:4
    ds_read2st64_b32 v[14:15], v10 offset0:8 offset1:12
    ds_read_b32 v16, v10 offset:4096
    s_waitcnt lgkmcnt(1)
    v_pk_add_f32 v[12:13], v[12:13], v[14:15]
    s_waitcnt lgkmcnt(0)
    v_add_f32 v12, v12, v16
    v_add_f32 v12, v12, v13
    v_mov_b32 v14, 0x3acccccd
    v_readlane_b32 s57, v12, 24
    v_readlane_b32 s58, v12, 25
    v_permlane32_swap_b32 v12, v13
    v_mul_f32 v15, s57, v14
    v_mul_f32 v16, s58, v14
    v_fma_f32 v16, -v15, v15, v16
    v_max_f32 v16, 0, v16
    v_add_f32 v16, 0x3727c5ac, v16
    v_rsq_f32 v16, v16
    v_fma_f32 v12, -v15, v13, v12
    v_mul_f32 v12, v12, v16
    v_add_f32 v12, v12, v4
    v_mul_f32 v13, v12, v12
    v_fma_f32 v13, v13, v19, v18
    v_mul_f32 v13, v13, v12
    v_exp_f32 v13, v13
    s_nop 0
    v_add_f32 v13, 1.0, v13
    v_rcp_f32 v13, v13
    s_nop 0
    v_mul_f32 v12, v12, v13
    s_nop 1
    v_mov_b32_dpp v13, v12 row_shl:1 row_mask:0xf bank_mask:0xf bound_ctrl:0
    v_cvt_pk_bf16_f32 v12, v12, v13
    v_min_u32 v12, -2, v12
    s_mov_b64 exec, 0x5555
    s_cmp_eq_u32 s55, 0
    s_cbranch_scc1 L_gs_55
    buffer_store_dword v12, v11, s[40:43], s59 offen
L_gb_56:
    s_mov_b64 exec, -1
L_skip_54:
    s_cmp_lt_u32 s30, 5
    s_cbranch_scc0 L_p1_skip
    s_mul_i32 s57, s30, 6144
    v_lshrrev_b32 v10, 4, v0
    v_mul_u32_u24 v10, 1536, v10
    v_bfe_u32 v60, v0, 3, 1
    v_mul_u32_u24 v60, 384, v60
    v_add_u32 v10, v60, v10
    v_bfe_u32 v60, v0, 1, 1
    v_mul_u32_u24 v60, 192, v60
    v_add_u32 v10, v60, v10
    v_bfe_u32 v60, v0, 2, 1
L_pad7:
    s_cbranch_execz L_pad8
    v_mul_u32_u24 v60, 48, v60
    v_add_u32 v10, v60, v10
    v_and_b32 v60, 1, v0
    v_lshl_add_u32 v10, v60, 3, v10
    v_add_u32 v10, s57, v10
    ds_read_b64_tr_b16 v[36:37], v10 offset:0
    ds_read_b64_tr_b16 v[38:39], v10 offset:768
    ds_read_b64_tr_b16 v[40:41], v10 offset:96
    ds_read_b64_tr_b16 v[42:43], v10 offset:864
    ds_read_b64_tr_b16 v[44:45], v10 offset:16
    ds_read_b64_tr_b16 v[46:47], v10 offset:784
    ds_read_b64_tr_b16 v[48:49], v10 offset:112
    ds_read_b64_tr_b16 v[50:51], v10 offset:880
    ds_read_b64_tr_b16 v[52:53], v10 offset:32
    ds_read_b64_tr_b16 v[54:55], v10 offset:800
    ds_read_b64_tr_b16 v[56:57], v10 offset:128
    ds_read_b64_tr_b16 v[58:59], v10 offset:896
    s_lshl_b32 s57, s30, 10
    v_lshlrev_b32 v11, 4, v0
    v_add_u32 v11, s57, v11
    v_add_u32 v11, 157696, v11
    v_mov_b32 v32, 0x3f803f80
    v_mov_b32 v33, 0x3f803f80
    v_mov_b32 v34, 0x3f803f80
    v_mov_b32 v35, 0x3f803f80
    v_mov_b32 v61, 0x3f803f80
    v_lshlrev_b32 v60, 16, v4
    v_add_f32 v2, v2, v60
    v_and_b32 v60, 0xffff0000, v4
    v_add_f32 v3, v3, v60
    s_add_u32 s57, s62, 27264
    v_min_u32 v6, 19, v0
    v_lshlrev_b32 v6, 2, v6
    buffer_load_dword v12, v6, s[40:43], s57 offen sc1
    s_waitcnt vmcnt(0)
L_pw_57:
    v_cmp_eq_u32 vcc, -1, v12
    s_cbranch_vccnz L_pr_58
L_p1:
    s_mov_b32 s57, 282624
    buffer_load_dwordx4 v[12:15], v5, s[40:43], s57 offen sc1
    s_mov_b32 s58, 287744
    buffer_load_dwordx4 v[16:19], v5, s[40:43], s58 offen sc1
    s_mov_b32 s59, 292864
    buffer_load_dwordx4 v[20:23], v5, s[40:43], s59 offen sc1
    s_mov_b32 s60, 297984
    buffer_load_dwordx4 v[24:27], v5, s[40:43], s60 offen sc1
L_gw_59:
    s_waitcnt vmcnt(2)
    v_pk_add_f32 v[28:29], v[12:13], v[16:17]
    v_pk_add_f32 v[30:31], v[14:15], v[18:19]
    s_waitcnt vmcnt(1)
    v_pk_add_f32 v[28:29], v[28:29], v[20:21]
    v_pk_add_f32 v[30:31], v[30:31], v[22:23]
    s_waitcnt vmcnt(0)
    v_pk_add_f32 v[28:29], v[28:29], v[24:25]
    v_pk_add_f32 v[30:31], v[30:31], v[26:27]
    s_nop 1
    v_permlane32_swap_b32 v28, v30
    v_permlane32_swap_b32 v29, v31
    v_pk_add_f32 v[28:29], v[28:29], v[30:31]
    v_pk_add_f32 v[28:29], v[28:29], v[2:3]
    v_cmp_u_f32 vcc, v28, v29
    s_cbranch_vccnz L_gr_60
L_gk_61:
    v_cvt_pk_bf16_f32 v28, v28, v29
    v_mov_b64 v[12:13], 0
    v_mov_b64 v[14:15], 0
    v_mov_b32_dpp v32, v28 quad_perm:[0,1,2,3] row_mask:0xf bank_mask:0x1
    v_mov_b32_dpp v33, v28 row_shl:4 row_mask:0xf bank_mask:0x1
    v_mov_b32_dpp v34, v28 row_shl:8 row_mask:0xf bank_mask:0x1
    v_mov_b32_dpp v35, v28 row_shl:12 row_mask:0xf bank_mask:0x1
    v_dot2_f32_bf16 v27, v28, v61, 0
    v_dot2_f32_bf16 v62, v28, v28, 0
    s_waitcnt lgkmcnt(0)
    v_smfmac_f32_16x16x64_bf16 v[12:15], v[32:35], v[36:43], v1
    v_mov_b64 v[16:17], 0
    v_mov_b64 v[18:19], 0
    v_permlane32_swap_b32 v27, v62
    s_nop 0
    v_smfmac_f32_16x16x64_bf16 v[16:19], v[32:35], v[44:51], v1
    v_mov_b64 v[20:21], 0
    v_mov_b64 v[22:23], 0
L_pad8:
    s_cbranch_execz L_pad9
    v_add_f32 v27, v27, v62
    v_mov_b32 v62, v27
    v_smfmac_f32_16x16x64_bf16 v[20:23], v[32:35], v[52:59], v1
    s_nop 0
    v_permlane16_swap_b32 v27, v62
    v_add_f32 v27, v27, v62
    v_lshlrev_b32 v2, 16, v28
    v_and_b32 v3, 0xffff0000, v28
    v_add_f32_dpp v27, v27, v27 row_ror:8 row_mask:0xf bank_mask:0xf
    v_pk_add_f32 v[12:13], v[12:13], v[14:15]
    v_pk_add_f32 v[16:17], v[16:17], v[18:19]
    v_add_f32_dpp v27, v27, v27 row_ror:4 row_mask:0xf bank_mask:0xf
    v_pk_add_f32 v[20:21], v[20:21], v[22:23]
    v_add_f32_dpp v24, v13, v12 row_shl:8 row_mask:0xf bank_mask:0xf bound_ctrl:0
    v_add_f32_dpp v27, v27, v27 row_ror:2 row_mask:0xf bank_mask:0xf
    v_add_f32_dpp v25, v17, v16 row_shl:8 row_mask:0xf bank_mask:0xf bound_ctrl:0
    v_add_f32_dpp v26, v21, v20 row_shl:8 row_mask:0xf bank_mask:0xf bound_ctrl:0
    v_add_f32_dpp v27, v27, v27 row_ror:1 row_mask:0xf bank_mask:0xf
    ds_write_b128 v11, v[24:27]
    s_waitcnt lgkmcnt(0)
L_p1_skip:
    s_cmp_eq_u32 s30, 5
    s_cbranch_scc0 L_skip_66
    v_and_b32 v10, 7, v0
    v_lshlrev_b32 v10, 4, v10
    v_bfe_u32 v60, v0, 3, 2
    v_lshl_add_u32 v10, v60, 2, v10
    v_lshrrev_b32 v60, 5, v0
    v_lshl_add_u32 v10, v60, 8, v10
    v_add_u32 v10, 157696, v10
    v_mov_b32 v60, 158220
    v_cmp_eq_u32 vcc, 25, v0
    s_nop 1
    v_cndmask_b32 v10, v10, v60, vcc
    s_mul_i32 s57, s54, 12
    v_lshrrev_b32 v60, 1, v0
    v_add_u32 v60, s57, v60
    v_bfe_u32 v11, v60, 3, 4
    v_lshlrev_b32 v11, 5, v11
    v_and_b32 v61, 1, v60
    v_lshl_add_u32 v11, v61, 4, v11
    v_bfe_u32 v61, v60, 1, 2
    v_lshl_add_u32 v11, v61, 2, v11
    s_mul_i32 s59, s53, 384
    s_add_u32 s59, s59, s62
    s_add_u32 s59, s59, 24576
L_skip_66:
    s_barrier
    s_cmp_eq_u32 s30, 5
    s_cbranch_scc0 L_skip_67
    ds_read2st64_b32 v[12:13], v10 offset0:0 offset1:4
    ds_read2st64_b32 v[14:15], v10 offset0:8 offset1:12
    ds_read_b32 v16, v10 offset:4096
    s_waitcnt lgkmcnt(1)
    v_pk_add_f32 v[12:13], v[12:13], v[14:15]
    s_waitcnt lgkmcnt(0)
    v_add_f32 v12, v12, v16
    v_add_f32 v12, v12, v13
    v_mov_b32 v14, 0x3acccccd
    v_readlane_b32 s57, v12, 24
    v_readlane_b32 s58, v12, 25
    v_permlane32_swap_b32 v12, v13
    v_mul_f32 v15, s57, v14
    v_mul_f32 v16, s58, v14
    v_fma_f32 v16, -v15, v15, v16
    v_max_f32 v16, 0, v16
    v_add_f32 v16, 0x3727c5ac, v16
    v_rsq_f32 v16, v16
    v_fma_f32 v12, -v15, v13, v12
    v_mul_f32 v12, v12, v16
    s_nop 1
    v_mov_b32_dpp v13, v12 row_shl:1 row_mask:0xf bank_mask:0xf bound_ctrl:0
    v_cvt_pk_bf16_f32 v12, v12, v13
    v_min_u32 v12, -2, v12
    s_mov_b64 exec, 0x555555
    s_cmp_eq_u32 s55, 0
    s_cbranch_scc1 L_gs_68
    buffer_store_dword v12, v11, s[40:43], s59 offen
L_gb_69:
    s_mov_b64 exec, -1
L_skip_67:
    s_mul_i32 s60, s53, 384
    s_add_u32 s60, s60, s62
    s_add_u32 s60, s60, 24576
    v_lshrrev_b32 v5, 4, v0
    v_lshlrev_b32 v5, 5, v5
    v_bfe_u32 v60, v0, 1, 1
    v_lshl_add_u32 v5, v60, 4, v5
    v_add_u32 v5, s60, v5
L_pad9:
    s_cbranch_execz L_pad10
    buffer_load_dwordx4 v[12:15], v5, s[40:43], 0 offen offset:0 sc1
    buffer_load_dwordx4 v[16:19], v5, s[40:43], 0 offen offset:128 sc1
    buffer_load_dwordx4 v[20:23], v5, s[40:43], 0 offen offset:256 sc1
    v_mov_b64 v[24:25], 0
    v_mov_b64 v[26:27], 0
    v_mov_b64 v[28:29], 0
    v_mov_b64 v[30:31], 0
    v_mov_b64 v[32:33], 0
    v_mov_b64 v[34:35], 0
    v_mov_b64 v[36:37], 0
    v_mov_b64 v[38:39], 0
    v_mov_b64 v[40:41], 0
    v_mov_b64 v[42:43], 0
    v_mov_b64 v[44:45], 0
    v_mov_b64 v[46:47], 0
    v_mov_b64 v[48:49], 0
    v_mov_b64 v[50:51], 0
    v_mov_b64 v[52:53], 0
    v_mov_b64 v[54:55], 0
    v_mov_b64 v[56:57], 0
    v_mov_b64 v[58:59], 0
    v_mov_b64 v[60:61], 0
    v_mov_b64 v[62:63], 0
    s_lshl_b32 s58, s30, 3
    s_add_u32 s58, s58, 162816
    v_mov_b32 v6, s58
    s_waitcnt vmcnt(0)
L_pw_70:
    v_max3_u32 v7, v12, v13, v14
    v_max3_u32 v7, v7, v15, v16
    v_max3_u32 v7, v7, v17, v18
    v_max3_u32 v7, v7, v19, v20
    v_max3_u32 v7, v7, v21, v22
    v_max_u32 v7, v7, v23
    v_cmp_eq_u32 vcc, -1, v7
    s_cbranch_vccnz L_pr_71
    v_smfmac_f32_16x16x64_bf16 v[24:27], v[12:15], v[64:71], v1
    v_smfmac_f32_16x16x64_bf16 v[24:27], v[16:19], v[72:79], v1
    v_smfmac_f32_16x16x64_bf16 v[24:27], v[20:23], v[80:87], v1
    v_smfmac_f32_16x16x64_bf16 v[28:31], v[12:15], v[88:95], v1
    v_smfmac_f32_16x16x64_bf16 v[28:31], v[16:19], v[96:103], v1
    v_smfmac_f32_16x16x64_bf16 v[28:31], v[20:23], v[104:111], v1
    v_smfmac_f32_16x16x64_bf16 v[32:35], v[12:15], v[112:119], v1
    v_smfmac_f32_16x16x64_bf16 v[32:35], v[16:19], v[120:127], v1
    v_smfmac_f32_16x16x64_bf16 v[32:35], v[20:23], v[128:135], v1
    v_smfmac_f32_16x16x64_bf16 v[36:39], v[12:15], v[136:143], v1
    v_smfmac_f32_16x16x64_bf16 v[36:39], v[16:19], v[144:151], v1
    v_smfmac_f32_16x16x64_bf16 v[36:39], v[20:23], v[152:159], v1
    s_mov_b32 s57, 0x3dd53b95
    s_mov_b32 vcc_lo, 0x55555555
    s_mov_b32 vcc_hi, 0x55555555
    v_add_f32 v24, v24, v26
    v_add_f32 v28, v28, v30
    v_add_f32 v32, v32, v34
    s_nop 1
    v_add_f32 v36, v36, v38
    v_max3_f32 v21, v24, v28, v32
    v_max_f32 v21, v21, v36
    v_mov_b32_dpp v24, v28 quad_perm:[0,1,2,3] row_mask:0x2 bank_mask:0xf
    s_nop 0
    v_max_f32_dpp v21, v21, v21 row_ror:8 row_mask:0xf bank_mask:0xf
    v_mov_b32_dpp v24, v32 quad_perm:[0,1,2,3] row_mask:0x4 bank_mask:0xf
    s_nop 0
    v_max_f32_dpp v21, v21, v21 row_ror:4 row_mask:0xf bank_mask:0xf
    v_mov_b32_dpp v24, v36 quad_perm:[0,1,2,3] row_mask:0x8 bank_mask:0xf
    s_nop 0
    v_max_f32_dpp v21, v21, v21 row_ror:2 row_mask:0xf bank_mask:0xf
    s_nop 1
    v_max_f32_dpp v21, v21, v21 row_ror:1 row_mask:0xf bank_mask:0xf
    v_sub_f32 v24, v24, v21
    v_mul_f32 v24, s57, v24
    v_exp_f32 v22, v24
    v_mul_f32 v20, s57, v21
    s_nop 0
    v_mov_b32_dpp v23, v22 row_shl:1 row_mask:0xf bank_mask:0xf bound_ctrl:0
    v_cvt_pk_bf16_f32 v23, v22, v23
    v_cndmask_b32 v12, 0, v23, vcc
    v_mov_b32 v21, v22
    s_nop 0
    v_mov_b32_dpp v13, v12 row_shl:4 row_mask:0xf bank_mask:0xf bound_ctrl:0
    v_mov_b32_dpp v14, v12 row_shl:8 row_mask:0xf bank_mask:0xf bound_ctrl:0
    v_mov_b32_dpp v15, v12 row_shl:12 row_mask:0xf bank_mask:0xf bound_ctrl:0
    s_nop 1
    v_smfmac_f32_16x16x64_bf16 v[40:43], v[12:15], v[160:167], v1
    v_mov_b32_dpp v16, v12 row_shr:1 row_mask:0xf bank_mask:0xf bound_ctrl:0
    v_mov_b32_dpp v17, v12 row_shl:3 row_mask:0xf bank_mask:0xf bound_ctrl:0
    v_smfmac_f32_16x16x64_bf16 v[44:47], v[12:15], v[176:183], v1
L_pad10:
    s_cbranch_execz L_pad11
    v_mov_b32_dpp v18, v12 row_shl:7 row_mask:0xf bank_mask:0xf bound_ctrl:0
    v_mov_b32_dpp v19, v12 row_shl:11 row_mask:0xf bank_mask:0xf bound_ctrl:0
    v_smfmac_f32_16x16x64_bf16 v[48:51], v[12:15], v[192:199], v1
    v_permlane32_swap_b32 v21, v22
    v_add_f32 v21, v21, v22
    v_smfmac_f32_16x16x64_bf16 v[52:55], v[12:15], v[208:215], v1
    v_mov_b32 v22, v21
    s_nop 1
    v_permlane16_swap_b32 v21, v22
    v_smfmac_f32_16x16x64_bf16 v[56:59], v[12:15], v[224:231], v1
    v_add_f32 v21, v21, v22
    s_nop 1
    v_add_f32_dpp v21, v21, v21 row_ror:8 row_mask:0xf bank_mask:0xf
    v_smfmac_f32_16x16x64_bf16 v[60:63], v[12:15], v[240:247], v1
    s_nop 0
    v_add_f32_dpp v21, v21, v21 row_ror:4 row_mask:0xf bank_mask:0xf
    s_nop 1
    v_add_f32_dpp v21, v21, v21 row_ror:2 row_mask:0xf bank_mask:0xf
    v_smfmac_f32_16x16x64_bf16 v[40:43], v[16:19], v[168:175], v1
    s_nop 0
    v_add_f32_dpp v21, v21, v21 row_ror:1 row_mask:0xf bank_mask:0xf
    ds_write_b64 v6, v[20:21]
    v_smfmac_f32_16x16x64_bf16 v[44:47], v[16:19], v[184:191], v1
    v_and_b32 v36, 15, v0
    v_lshlrev_b32 v36, 4, v36
    v_add_u32 v36, s61, v36
    v_smfmac_f32_16x16x64_bf16 v[48:51], v[16:19], v[200:207], v1
    v_smfmac_f32_16x16x64_bf16 v[52:55], v[16:19], v[216:223], v1
    s_cmp_ge_u32 s30, 4
    s_cbranch_scc0 L_skip_72
    s_waitcnt lgkmcnt(0)
    s_barrier
L_skip_72:
    v_smfmac_f32_16x16x64_bf16 v[56:59], v[16:19], v[232:239], v1
    v_smfmac_f32_16x16x64_bf16 v[60:63], v[16:19], v[248:255], v1
    v_pk_add_f32 v[24:25], v[40:41], v[42:43]
    v_pk_add_f32 v[26:27], v[44:45], v[46:47]
    s_nop 0
    v_pk_add_f32 v[28:29], v[48:49], v[50:51]
    v_pk_add_f32 v[30:31], v[52:53], v[54:55]
    s_nop 1
    v_pk_add_f32 v[32:33], v[56:57], v[58:59]
    v_pk_add_f32 v[34:35], v[60:61], v[62:63]
    s_mov_b64 exec, 0xffff
    ds_write_b128 v36, v[24:27] offset:0
    ds_write_b128 v36, v[28:31] offset:256
    ds_write_b128 v36, v[32:35] offset:512
    s_mov_b64 exec, -1
    s_cmp_lt_u32 s30, 4
    s_cbranch_scc1 L_old
    s_waitcnt lgkmcnt(0)
L_b2_1:
    s_barrier
    s_cmp_lt_u32 s30, 2
    s_cbranch_scc0 L_skip_76
    s_mov_b32 exec_lo, 0xffffffff
    s_mov_b32 exec_hi, 0xffff
    ds_read_b64 v[40:41], v5 offset:0
    ds_read_b64 v[42:43], v5 offset:8192
    ds_read_b64 v[44:45], v5 offset:16384
    ds_read_b64 v[46:47], v5 offset:24576
    ds_read_b64 v[48:49], v5 offset:32768
    ds_read_b64 v[50:51], v5 offset:40960
    ds_read_b64 v[52:53], v5 offset:49152
    ds_read_b64 v[54:55], v5 offset:57344
    s_waitcnt lgkmcnt(7)
    v_mul_f32 v56, s64, v40
    v_mul_f32 v57, s64, v41
    s_waitcnt lgkmcnt(6)
    v_fmac_f32 v56, s65, v42
    v_fmac_f32 v57, s65, v43
    s_waitcnt lgkmcnt(5)
    v_fmac_f32 v56, s66, v44
    v_fmac_f32 v57, s66, v45
    s_waitcnt lgkmcnt(4)
    v_fmac_f32 v56, s67, v46
    v_fmac_f32 v57, s67, v47
    s_waitcnt lgkmcnt(3)
    v_fmac_f32 v56, s68, v48
    v_fmac_f32 v57, s68, v49
    s_waitcnt lgkmcnt(2)
    v_fmac_f32 v56, s69, v50
    v_fmac_f32 v57, s69, v51
    s_waitcnt lgkmcnt(1)
    v_fmac_f32 v56, s70, v52
    v_fmac_f32 v57, s70, v53
    s_waitcnt lgkmcnt(0)
    v_fmac_f32 v56, s71, v54
    v_fmac_f32 v57, s71, v55
    v_cvt_pk_bf16_f32 v56, v56, v57
    v_min_u32 v56, -2, v56
    s_cmp_eq_u32 s55, 0
L_pad11:
    s_cbranch_execz L_pad12
    s_cbranch_scc1 L_gs_77
    buffer_store_dword v56, v6, s[40:43], 0 offen
L_gb_78:
    s_mov_b64 exec, -1
L_skip_76:
    s_cmp_lt_u32 s52, 20
    s_cbranch_scc0 L_typeB_1
    s_lshr_b32 s57, s30, 1
    s_lshl_b32 s57, s57, 5
    s_add_u32 s57, s57, s62
    s_add_u32 s59, s57, 27008
    v_and_b32 v5, 7, v0
    v_lshlrev_b32 v5, 2, v5
    v_lshrrev_b32 v6, 4, v0
    v_lshlrev_b32 v6, 3, v6
    buffer_load_dword v18, v5, s[40:43], s59 offen sc1
    buffer_load_dwordx2 v[20:21], v6, s[40:43], s59 offen sc1
    s_mul_i32 s57, s30, 6144
    v_lshrrev_b32 v7, 2, v0
    v_lshlrev_b32 v7, 6, v7
    v_bfe_u32 v60, v0, 4, 1
    v_lshl_add_u32 v7, v60, 5, v7
    v_and_b32 v60, 3, v0
    v_lshl_add_u32 v7, v60, 3, v7
    v_add_u32 v7, s57, v7
    v_add_u32 v7, 30720, v7
    v_xor_b32 v8, 32, v7
    s_mul_i32 s60, s30, 1536
    s_add_u32 s60, s60, s62
    s_add_u32 s60, s60, 12288
    v_lshlrev_b32 v9, 4, v0
    v_lshlrev_b32 v10, 3, v0
    ds_read_b64_tr_b16 v[36:37], v7 offset:0
    ds_read_b64_tr_b16 v[38:39], v7 offset:1024
    ds_read_b64_tr_b16 v[40:41], v7 offset:2048
    ds_read_b64_tr_b16 v[42:43], v7 offset:3072
    ds_read_b64_tr_b16 v[44:45], v7 offset:4096
    ds_read_b64_tr_b16 v[46:47], v7 offset:5120
    ds_read_b64_tr_b16 v[48:49], v8 offset:0
    ds_read_b64_tr_b16 v[50:51], v8 offset:1024
    ds_read_b64_tr_b16 v[52:53], v8 offset:2048
    ds_read_b64_tr_b16 v[54:55], v8 offset:3072
    ds_read_b64_tr_b16 v[56:57], v8 offset:4096
    ds_read_b64_tr_b16 v[58:59], v8 offset:5120
    v_mov_b64 v[24:25], 0
    v_mov_b64 v[26:27], 0
    v_mov_b64 v[28:29], 0
    v_mov_b64 v[30:31], 0
    s_lshl_b32 s57, s30, 8
    v_lshlrev_b32 v11, 2, v0
    v_add_u32 v11, s57, v11
    v_add_u32 v11, 157696, v11
    s_waitcnt vmcnt(0)
L_pw_79:
    v_max3_u32 v19, v18, v20, v21
    v_cmp_eq_u32 vcc, -1, v19
    s_cbranch_vccnz L_pr_80
    buffer_load_dwordx4 v[12:15], v9, s[40:43], s60 offen sc1
    buffer_load_dwordx2 v[16:17], v10, s[40:43], s60 offen offset:1024 sc1
    v_max_f32_dpp v19, v18, v18 row_ror:4 row_mask:0xf bank_mask:0xf
    s_nop 1
    v_max_f32_dpp v19, v19, v19 row_ror:2 row_mask:0xf bank_mask:0xf
    s_nop 1
    v_max_f32_dpp v19, v19, v19 row_ror:1 row_mask:0xf bank_mask:0xf
    v_sub_f32 v18, v18, v19
    v_sub_f32 v20, v20, v19
    v_sub_f32 v21, v21, v19
    v_exp_f32 v18, v18
    v_exp_f32 v20, v20
    v_exp_f32 v21, v21
    v_add_f32_dpp v18, v18, v18 row_ror:4 row_mask:0xf bank_mask:0xf
    s_nop 1
    v_add_f32_dpp v18, v18, v18 row_ror:2 row_mask:0xf bank_mask:0xf
    s_nop 1
    v_add_f32_dpp v18, v18, v18 row_ror:1 row_mask:0xf bank_mask:0xf
    v_rcp_f32 v18, v18
    s_nop 0
    v_mul_f32 v20, v20, v18
    v_mul_f32 v21, v21, v18
    s_waitcnt lgkmcnt(0)
    s_waitcnt vmcnt(0)
L_pw_81:
    v_max3_u32 v19, v12, v13, v14
    v_max3_u32 v19, v19, v15, v16
    v_max_u32 v19, v19, v17
    v_cmp_eq_u32 vcc, -1, v19
    s_cbranch_vccnz L_pr_82
    v_smfmac_f32_16x16x64_bf16 v[24:27], v[12:15], v[36:43], v1
    v_smfmac_f32_16x16x64_bf16 v[28:31], v[12:15], v[48:55], v1
    v_smfmac_f32_16x16x32_bf16 v[24:27], v[16:17], v[44:47], v1
    v_smfmac_f32_16x16x32_bf16 v[28:31], v[16:17], v[56:59], v1
    s_nop 6
L_pad12:
    s_cbranch_execz L_pad13
    v_pk_add_f32 v[24:25], v[24:25], v[26:27]
    v_pk_add_f32 v[28:29], v[28:29], v[30:31]
    v_mul_f32 v24, v24, v20
    v_mul_f32 v28, v28, v20
    v_fmac_f32 v24, v25, v21
    v_fmac_f32 v28, v29, v21
    s_nop 1
    v_permlane32_swap_b32 v24, v28
    v_add_f32 v24, v24, v28
    ds_write_b32 v11, v24
    v_lshlrev_b32 v5, 2, v0
    v_add_u32 v5, 157696, v5
    s_mul_i32 s59, s31, 2560
    s_lshl_b32 s58, s52, 7
    s_add_u32 s59, s59, s58
    s_add_u32 s59, s59, 303040
    v_lshlrev_b32 v6, 2, v0
    s_waitcnt lgkmcnt(0)
    s_barrier
    s_cmp_eq_u32 s30, 2
    s_cbranch_scc0 L_skip_83
    ds_read2st64_b32 v[12:13], v5 offset0:0 offset1:1
    ds_read2st64_b32 v[14:15], v5 offset0:2 offset1:3
    ds_read2st64_b32 v[16:17], v5 offset0:4 offset1:5
    ds_read2st64_b32 v[18:19], v5 offset0:6 offset1:7
    s_waitcnt lgkmcnt(2)
    v_pk_add_f32 v[12:13], v[12:13], v[14:15]
    s_waitcnt lgkmcnt(0)
    v_pk_add_f32 v[16:17], v[16:17], v[18:19]
    v_pk_add_f32 v[12:13], v[12:13], v[16:17]
    v_add_f32 v12, v12, v13
    v_mov_b32 v13, v12
    s_nop 1
    v_permlane16_swap_b32 v12, v13
    v_add_f32 v12, v12, v13
    v_min_u32 v12, -2, v12
    s_mov_b32 exec_lo, 0xffff0000
    s_mov_b32 exec_hi, 0xffff
    buffer_store_dword v12, v6, s[40:43], s59 offen sc1
    s_lshl_b32 s57, s52, 2
    s_add_u32 s57, s57, s62
    s_add_u32 s57, s57, 27392
    s_mov_b64 exec, 0x1
    s_cmp_eq_u32 s55, 0
    s_cbranch_scc1 L_gs_84
    buffer_store_dword v0, v0, s[40:43], s57 offen
L_gb_85:
    s_mov_b64 exec, -1
L_skip_83:
    s_sub_u32 s57, s30, 5
    s_cmp_lt_u32 s57, 2
    s_cbranch_scc0 L_skip_86
    s_sub_u32 s60, s30, 5
    s_mul_i32 s59, s60, 6144
    s_add_u32 s59, s59, 79872
    v_lshrrev_b32 v7, 5, v0
    v_lshlrev_b32 v7, 9, v7
    v_bfe_u32 v60, v0, 4, 1
    v_lshl_add_u32 v7, v60, 7, v7
    v_bfe_u32 v60, v0, 3, 1
    v_lshl_add_u32 v7, v60, 8, v7
    v_bfe_u32 v60, v0, 2, 1
    v_lshl_add_u32 v7, v60, 5, v7
    v_and_b32 v60, 3, v0
    v_lshl_add_u32 v7, v60, 3, v7
    v_add_u32 v7, s59, v7
    s_add_u32 s59, s62, 26496
    v_lshrrev_b32 v5, 4, v0
    v_lshlrev_b32 v5, 5, v5
    v_bfe_u32 v60, v0, 1, 1
    v_lshl_add_u32 v5, v60, 4, v5
    v_mov_b64 v[24:25], 0
    v_mov_b64 v[26:27], 0
    s_mul_i32 s57, s31, 2560
    s_lshl_b32 s58, s52, 7
    s_add_u32 s57, s57, s58
    s_lshl_b32 s60, s60, 6
    s_add_u32 s60, s60, s57
    s_add_u32 s60, s60, 323584
    v_lshlrev_b32 v6, 2, v0
    ds_read_b64_tr_b16 v[36:37], v7 offset:0
    ds_read_b64_tr_b16 v[38:39], v7 offset:64
    ds_read_b64_tr_b16 v[40:41], v7 offset:1024
    ds_read_b64_tr_b16 v[42:43], v7 offset:1088
    ds_read_b64_tr_b16 v[44:45], v7 offset:2048
    ds_read_b64_tr_b16 v[46:47], v7 offset:2112
    ds_read_b64_tr_b16 v[48:49], v7 offset:3072
    ds_read_b64_tr_b16 v[50:51], v7 offset:3136
    ds_read_b64_tr_b16 v[52:53], v7 offset:4096
L_pad13:
    s_cbranch_execz L_pad14
    ds_read_b64_tr_b16 v[54:55], v7 offset:4160
    ds_read_b64_tr_b16 v[56:57], v7 offset:5120
    ds_read_b64_tr_b16 v[58:59], v7 offset:5184
    buffer_load_dwordx4 v[12:15], v5, s[40:43], s59 offen offset:0 sc1
    buffer_load_dwordx4 v[16:19], v5, s[40:43], s59 offen offset:128 sc1
    buffer_load_dwordx4 v[20:23], v5, s[40:43], s59 offen offset:256 sc1
    s_waitcnt lgkmcnt(0)
    s_waitcnt vmcnt(0)
L_pw_87:
    v_max3_u32 v28, v12, v13, v14
    v_max3_u32 v28, v28, v15, v16
    v_max3_u32 v28, v28, v17, v18
    v_max3_u32 v28, v28, v19, v20
    v_max3_u32 v28, v28, v21, v22
    v_max_u32 v28, v28, v23
    v_cmp_eq_u32 vcc, -1, v28
    s_cbranch_vccnz L_pr_88
    v_smfmac_f32_16x16x64_bf16 v[24:27], v[12:15], v[36:43], v1
    v_smfmac_f32_16x16x64_bf16 v[24:27], v[16:19], v[44:51], v1
    v_smfmac_f32_16x16x64_bf16 v[24:27], v[20:23], v[52:59], v1
    s_nop 7
    v_add_f32 v24, v24, v26
    v_min_u32 v24, -2, v24
    s_mov_b64 exec, 0xffff
    buffer_store_dword v24, v6, s[40:43], s60 offen sc1
    s_cmp_eq_u32 s30, 6
    s_cbranch_scc0 L_skip_89
    s_lshl_b32 s57, s52, 2
    s_add_u32 s57, s57, s62
    s_add_u32 s57, s57, 27520
    s_mov_b64 exec, 0x1
    s_cmp_eq_u32 s55, 0
    s_cbranch_scc1 L_gs_90
    buffer_store_dword v0, v0, s[40:43], s57 offen
L_gb_91:
    s_mov_b64 exec, -1
L_skip_89:
    s_mov_b64 exec, -1
L_skip_86:
    s_branch L_done
L_typeB_1:
    s_cmp_lt_u32 s30, 5
    s_cbranch_scc0 L_skip_92
    s_mul_i32 s57, s30, 6144
    v_lshrrev_b32 v10, 4, v0
    v_lshlrev_b32 v10, 10, v10
    v_bfe_u32 v60, v0, 3, 1
    v_lshl_add_u32 v10, v60, 8, v10
    v_bfe_u32 v60, v0, 1, 1
    v_lshl_add_u32 v10, v60, 7, v10
    v_bfe_u32 v60, v0, 2, 1
    v_lshl_add_u32 v10, v60, 5, v10
    v_and_b32 v60, 1, v0
    v_lshl_add_u32 v10, v60, 3, v10
    v_add_u32 v10, s57, v10
    v_add_u32 v10, 30720, v10
    ds_read_b64_tr_b16 v[36:37], v10 offset:0
    ds_read_b64_tr_b16 v[38:39], v10 offset:512
    ds_read_b64_tr_b16 v[40:41], v10 offset:64
    ds_read_b64_tr_b16 v[42:43], v10 offset:576
    ds_read_b64_tr_b16 v[44:45], v10 offset:16
    ds_read_b64_tr_b16 v[46:47], v10 offset:528
    ds_read_b64_tr_b16 v[48:49], v10 offset:80
    ds_read_b64_tr_b16 v[50:51], v10 offset:592
    s_lshl_b32 s57, s30, 10
    v_lshlrev_b32 v11, 4, v0
    v_add_u32 v11, s57, v11
    v_add_u32 v11, 157696, v11
    v_mov_b32 v32, 0x3f803f80
    v_mov_b32 v33, 0x3f803f80
    v_mov_b32 v34, 0x3f803f80
    v_mov_b32 v35, 0x3f803f80
    v_mov_b32 v61, 0x3f803f80
    s_lshl_b32 s57, s30, 9
    v_lshrrev_b32 v5, 5, v0
    v_mul_u32_u24 v5, 2560, v5
    v_and_b32 v60, 31, v0
    v_lshl_add_u32 v5, v60, 4, v5
    v_add_u32 v5, s57, v5
    s_add_u32 s57, s62, 27392
    v_min_u32 v6, 19, v0
    v_lshlrev_b32 v6, 2, v6
    buffer_load_dword v12, v6, s[40:43], s57 offen sc1
    s_waitcnt vmcnt(0)
L_pw_93:
    v_cmp_eq_u32 vcc, -1, v12
    s_cbranch_vccnz L_pr_94
L_pad14:
    s_cbranch_execz L_pad15
    s_mov_b32 s57, 303104
    buffer_load_dwordx4 v[12:15], v5, s[40:43], s57 offen sc1
    s_mov_b32 s58, 308224
    buffer_load_dwordx4 v[16:19], v5, s[40:43], s58 offen sc1
    s_mov_b32 s59, 313344
    buffer_load_dwordx4 v[20:23], v5, s[40:43], s59 offen sc1
    s_mov_b32 s60, 318464
    buffer_load_dwordx4 v[24:27], v5, s[40:43], s60 offen sc1
L_gw_95:
    s_waitcnt vmcnt(2)
    v_pk_add_f32 v[28:29], v[12:13], v[16:17]
    v_pk_add_f32 v[30:31], v[14:15], v[18:19]
    s_waitcnt vmcnt(1)
    v_pk_add_f32 v[28:29], v[28:29], v[20:21]
    v_pk_add_f32 v[30:31], v[30:31], v[22:23]
    s_waitcnt vmcnt(0)
    v_pk_add_f32 v[28:29], v[28:29], v[24:25]
    v_pk_add_f32 v[30:31], v[30:31], v[26:27]
    s_nop 1
    v_permlane32_swap_b32 v28, v30
    v_permlane32_swap_b32 v29, v31
    v_pk_add_f32 v[28:29], v[28:29], v[30:31]
    v_pk_add_f32 v[28:29], v[28:29], v[2:3]
    v_cmp_u_f32 vcc, v28, v29
    s_cbranch_vccnz L_gr_96
L_gk_97:
    v_cvt_pk_bf16_f32 v28, v28, v29
    v_mov_b64 v[12:13], 0
    v_mov_b64 v[14:15], 0
    v_mov_b32_dpp v32, v28 quad_perm:[0,1,2,3] row_mask:0xf bank_mask:0x1
    v_mov_b32_dpp v33, v28 row_shl:4 row_mask:0xf bank_mask:0x1
    v_mov_b32_dpp v34, v28 row_shl:8 row_mask:0xf bank_mask:0x1
    v_mov_b32_dpp v35, v28 row_shl:12 row_mask:0xf bank_mask:0x1
    v_dot2_f32_bf16 v27, v28, v61, 0
    v_dot2_f32_bf16 v62, v28, v28, 0
    s_waitcnt lgkmcnt(0)
    v_smfmac_f32_16x16x64_bf16 v[12:15], v[32:35], v[36:43], v1
    v_mov_b64 v[16:17], 0
    v_mov_b64 v[18:19], 0
    v_permlane32_swap_b32 v27, v62
    s_nop 0
    v_smfmac_f32_16x16x64_bf16 v[16:19], v[32:35], v[44:51], v1
    v_add_f32 v27, v27, v62
    v_mov_b32 v62, v27
    s_nop 1
    v_permlane16_swap_b32 v27, v62
    v_add_f32 v27, v27, v62
    v_lshlrev_b32 v2, 16, v28
    v_and_b32 v3, 0xffff0000, v28
    v_add_f32_dpp v27, v27, v27 row_ror:8 row_mask:0xf bank_mask:0xf
    v_pk_add_f32 v[12:13], v[12:13], v[14:15]
    v_pk_add_f32 v[16:17], v[16:17], v[18:19]
    v_add_f32_dpp v27, v27, v27 row_ror:4 row_mask:0xf bank_mask:0xf
    v_add_f32_dpp v24, v13, v12 row_shl:8 row_mask:0xf bank_mask:0xf bound_ctrl:0
    v_add_f32_dpp v25, v17, v16 row_shl:8 row_mask:0xf bank_mask:0xf bound_ctrl:0
    v_add_f32_dpp v27, v27, v27 row_ror:2 row_mask:0xf bank_mask:0xf
    s_nop 1
    v_add_f32_dpp v27, v27, v27 row_ror:1 row_mask:0xf bank_mask:0xf
    ds_write_b128 v11, v[24:27]
    s_waitcnt lgkmcnt(0)
L_skip_92:
    s_cmp_eq_u32 s30, 5
    s_cbranch_scc0 L_skip_102
    v_and_b32 v10, 7, v0
    v_lshlrev_b32 v10, 4, v10
    v_bfe_u32 v60, v0, 3, 2
    v_lshl_add_u32 v10, v60, 2, v10
    v_lshrrev_b32 v60, 5, v0
    v_lshl_add_u32 v10, v60, 8, v10
    v_add_u32 v10, 157696, v10
    v_mov_b32 v60, 158220
    v_cmp_eq_u32 vcc, 25, v0
    s_nop 1
    v_cndmask_b32 v10, v10, v60, vcc
    s_sub_u32 s59, s52, 20
    s_lshl_b32 s59, s59, 5
    s_add_u32 s59, s59, s62
    s_add_u32 s59, s59, 26496
    v_lshlrev_b32 v11, 1, v0
    v_mov_b32 v18, 0xc0135761
    v_mov_b32 v19, 0xbdd2d3e8
L_skip_102:
    s_barrier
    s_cmp_eq_u32 s30, 5
    s_cbranch_scc0 L_skip_103
    ds_read2st64_b32 v[12:13], v10 offset0:0 offset1:4
    ds_read2st64_b32 v[14:15], v10 offset0:8 offset1:12
L_pad15:
    s_cbranch_execz L_pad16
    ds_read_b32 v16, v10 offset:4096
    s_waitcnt lgkmcnt(1)
    v_pk_add_f32 v[12:13], v[12:13], v[14:15]
    s_waitcnt lgkmcnt(0)
    v_add_f32 v12, v12, v16
    v_add_f32 v12, v12, v13
    v_mov_b32 v14, 0x3acccccd
    v_readlane_b32 s57, v12, 24
    v_readlane_b32 s58, v12, 25
    v_permlane32_swap_b32 v12, v13
    v_mul_f32 v15, s57, v14
    v_mul_f32 v16, s58, v14
    v_fma_f32 v16, -v15, v15, v16
    v_max_f32 v16, 0, v16
    v_add_f32 v16, 0x3727c5ac, v16
    v_rsq_f32 v16, v16
    v_fma_f32 v12, -v15, v13, v12
    v_mul_f32 v12, v12, v16
    v_add_f32 v12, v12, v4
    v_mul_f32 v13, v12, v12
    v_fma_f32 v13, v13, v19, v18
    v_mul_f32 v13, v13, v12
    v_exp_f32 v13, v13
    s_nop 0
    v_add_f32 v13, 1.0, v13
    v_rcp_f32 v13, v13
    s_nop 0
    v_mul_f32 v12, v12, v13
    s_nop 1
    v_mov_b32_dpp v13, v12 row_shl:1 row_mask:0xf bank_mask:0xf bound_ctrl:0
    v_cvt_pk_bf16_f32 v12, v12, v13
    v_min_u32 v12, -2, v12
    s_mov_b64 exec, 0x5555
    s_cmp_eq_u32 s55, 0
    s_cbranch_scc1 L_gs_104
    buffer_store_dword v12, v11, s[40:43], s59 offen
L_gb_105:
    s_mov_b64 exec, -1
L_skip_103:
    s_sub_u32 s57, s52, 20
    s_cmp_eq_u32 s57, s30
    s_cbranch_scc0 L_done
    s_cmp_lt_u32 s30, 5
    s_cbranch_scc0 L_done
    s_cmp_eq_u32 s31, 0
    s_cbranch_scc0 L_done
    v_lshlrev_b32 v60, 16, v4
    v_add_f32 v2, v2, v60
    v_and_b32 v60, 0xffff0000, v4
    v_add_f32 v3, v3, v60
    s_lshl_b32 s57, s30, 8
    v_and_b32 v7, 31, v0
    v_lshlrev_b32 v7, 3, v7
    v_lshrrev_b32 v60, 5, v0
    v_lshl_add_u32 v7, v60, 2, v7
    v_add_u32 v7, s57, v7
    s_add_u32 s57, s62, 27520
    v_min_u32 v6, 19, v0
    v_lshlrev_b32 v6, 2, v6
    buffer_load_dword v12, v6, s[40:43], s57 offen sc1
    s_waitcnt vmcnt(0)
L_pw_106:
    v_cmp_eq_u32 vcc, -1, v12
    s_cbranch_vccnz L_pr_107
    s_mov_b32 s57, 323584
    buffer_load_dwordx4 v[12:15], v5, s[40:43], s57 offen sc1
    s_mov_b32 s58, 328704
    buffer_load_dwordx4 v[16:19], v5, s[40:43], s58 offen sc1
    s_mov_b32 s59, 333824
    buffer_load_dwordx4 v[20:23], v5, s[40:43], s59 offen sc1
    s_mov_b32 s60, 338944
    buffer_load_dwordx4 v[24:27], v5, s[40:43], s60 offen sc1
L_gw_108:
    s_waitcnt vmcnt(2)
    v_pk_add_f32 v[28:29], v[12:13], v[16:17]
    v_pk_add_f32 v[30:31], v[14:15], v[18:19]
    s_waitcnt vmcnt(1)
    v_pk_add_f32 v[28:29], v[28:29], v[20:21]
    v_pk_add_f32 v[30:31], v[30:31], v[22:23]
    s_waitcnt vmcnt(0)
    v_pk_add_f32 v[28:29], v[28:29], v[24:25]
    v_pk_add_f32 v[30:31], v[30:31], v[26:27]
    s_nop 1
    v_permlane32_swap_b32 v28, v30
    v_permlane32_swap_b32 v29, v31
    v_pk_add_f32 v[28:29], v[28:29], v[30:31]
    v_pk_add_f32 v[28:29], v[28:29], v[2:3]
    v_cmp_u_f32 vcc, v28, v29
    s_cbranch_vccnz L_gr_109
L_gk_110:
    v_cvt_pk_bf16_f32 v28, v28, v29
    global_store_dword v7, v28, s[24:25]
    s_branch L_done
L_cr_8:
    s_sub_u32 s56, s56, 1
    s_cbranch_scc1 L_done
    global_load_dwordx2 v[12:13], v14, s[26:27] sc1
L_pad16:
    s_cbranch_execz L_pad17
    s_waitcnt vmcnt(0)
    s_branch L_cw_7
L_pr_11:
    s_sub_u32 s56, s56, 1
    s_cbranch_scc1 L_done
    buffer_load_dwordx4 v[12:15], v63, s[40:43], 0 offen offset:0 sc1
    buffer_load_dwordx4 v[16:19], v63, s[40:43], 0 offen offset:128 sc1
    buffer_load_dwordx4 v[20:23], v63, s[40:43], 0 offen offset:256 sc1
    s_waitcnt vmcnt(0)
    s_branch L_pw_10
L_gs_14:
    buffer_store_dword v22, v23, s[40:43], s57 offen sc1
    s_branch L_gb_15
L_gs_20:
    buffer_store_dword v56, v6, s[40:43], 0 offen sc1
    s_branch L_gb_21
L_pr_23:
    s_sub_u32 s56, s56, 1
    s_cbranch_scc1 L_done
    buffer_load_dword v18, v5, s[40:43], s59 offen sc1
    buffer_load_dwordx2 v[20:21], v6, s[40:43], s59 offen sc1
    s_waitcnt vmcnt(0)
    s_branch L_pw_22
L_pr_25:
    s_sub_u32 s56, s56, 1
    s_cbranch_scc1 L_done
    buffer_load_dwordx4 v[12:15], v9, s[40:43], s60 offen sc1
    buffer_load_dwordx2 v[16:17], v10, s[40:43], s60 offen offset:1024 sc1
    s_waitcnt vmcnt(0)
    s_branch L_pw_24
L_gs_27:
    buffer_store_dword v0, v0, s[40:43], s57 offen sc1
    s_branch L_gb_28
L_pr_31:
    s_sub_u32 s56, s56, 1
    s_cbranch_scc1 L_done
    buffer_load_dwordx4 v[12:15], v5, s[40:43], s59 offen offset:0 sc1
    buffer_load_dwordx4 v[16:19], v5, s[40:43], s59 offen offset:128 sc1
    buffer_load_dwordx4 v[20:23], v5, s[40:43], s59 offen offset:256 sc1
    s_waitcnt vmcnt(0)
    s_branch L_pw_30
L_gs_33:
    buffer_store_dword v0, v0, s[40:43], s57 offen sc1
    s_branch L_gb_34
L_gr_37:
    s_sub_u32 s56, s56, 1
    s_cbranch_scc1 L_done
    s_mov_b64 s[74:75], 0
    v_max3_u32 v30, v12, v13, v14
    v_max_u32 v30, v30, v15
    v_cmp_eq_u32 vcc, -1, v30
    s_cbranch_vccz L_gn_39
    s_or_b64 s[74:75], s[74:75], vcc
    s_mov_b64 exec, vcc
    buffer_load_dwordx4 v[12:15], v5, s[40:43], s57 offen sc1
    s_mov_b64 exec, -1
L_gn_39:
    v_max3_u32 v30, v16, v17, v18
    v_max_u32 v30, v30, v19
    v_cmp_eq_u32 vcc, -1, v30
    s_cbranch_vccz L_gn_40
    s_or_b64 s[74:75], s[74:75], vcc
    s_mov_b64 exec, vcc
    buffer_load_dwordx4 v[16:19], v5, s[40:43], s58 offen sc1
    s_mov_b64 exec, -1
L_gn_40:
    v_max3_u32 v30, v20, v21, v22
    v_max_u32 v30, v30, v23
    v_cmp_eq_u32 vcc, -1, v30
    s_cbranch_vccz L_gn_41
    s_or_b64 s[74:75], s[74:75], vcc
    s_mov_b64 exec, vcc
    buffer_load_dwordx4 v[20:23], v5, s[40:43], s59 offen sc1
    s_mov_b64 exec, -1
L_gn_41:
    v_max3_u32 v30, v24, v25, v26
    v_max_u32 v30, v30, v27
    v_cmp_eq_u32 vcc, -1, v30
    s_cbranch_vccz L_gn_42
    s_or_b64 s[74:75], s[74:75], vcc
    s_mov_b64 exec, vcc
    buffer_load_dwordx4 v[24:27], v5, s[40:43], s60 offen sc1
    s_mov_b64 exec, -1
L_gn_42:
    s_cmp_eq_u64 s[74:75], 0
    s_cbranch_scc1 L_gk_38
    s_waitcnt vmcnt(0)
    s_branch L_gw_36
L_pr_45:
    s_sub_u32 s56, s56, 1
    s_cbranch_scc1 L_done
    buffer_load_dword v12, v6, s[40:43], s57 offen sc1
    s_waitcnt vmcnt(0)
    s_branch L_pw_44
L_gr_47:
    s_sub_u32 s56, s56, 1
    s_cbranch_scc1 L_done
    s_mov_b64 s[74:75], 0
    v_max3_u32 v30, v12, v13, v14
    v_max_u32 v30, v30, v15
    v_cmp_eq_u32 vcc, -1, v30
    s_cbranch_vccz L_gn_49
    s_or_b64 s[74:75], s[74:75], vcc
    s_mov_b64 exec, vcc
    buffer_load_dwordx4 v[12:15], v5, s[40:43], s57 offen sc1
    s_mov_b64 exec, -1
L_gn_49:
    v_max3_u32 v30, v16, v17, v18
    v_max_u32 v30, v30, v19
    v_cmp_eq_u32 vcc, -1, v30
    s_cbranch_vccz L_gn_50
    s_or_b64 s[74:75], s[74:75], vcc
    s_mov_b64 exec, vcc
    buffer_load_dwordx4 v[16:19], v5, s[40:43], s58 offen sc1
    s_mov_b64 exec, -1
L_gn_50:
L_pad17:
    s_cbranch_execz L_pad18
    v_max3_u32 v30, v20, v21, v22
    v_max_u32 v30, v30, v23
    v_cmp_eq_u32 vcc, -1, v30
    s_cbranch_vccz L_gn_51
    s_or_b64 s[74:75], s[74:75], vcc
    s_mov_b64 exec, vcc
    buffer_load_dwordx4 v[20:23], v5, s[40:43], s59 offen sc1
    s_mov_b64 exec, -1
L_gn_51:
    v_max3_u32 v30, v24, v25, v26
    v_max_u32 v30, v30, v27
    v_cmp_eq_u32 vcc, -1, v30
    s_cbranch_vccz L_gn_52
    s_or_b64 s[74:75], s[74:75], vcc
    s_mov_b64 exec, vcc
    buffer_load_dwordx4 v[24:27], v5, s[40:43], s60 offen sc1
    s_mov_b64 exec, -1
L_gn_52:
    s_cmp_eq_u64 s[74:75], 0
    s_cbranch_scc1 L_gk_48
    s_waitcnt vmcnt(0)
    s_branch L_gw_46
L_gs_55:
    buffer_store_dword v12, v11, s[40:43], s59 offen sc1
    s_branch L_gb_56
L_pr_58:
    s_sub_u32 s56, s56, 1
    s_cbranch_scc1 L_done
    buffer_load_dword v12, v6, s[40:43], s57 offen sc1
    s_waitcnt vmcnt(0)
    s_branch L_pw_57
L_gr_60:
    s_sub_u32 s56, s56, 1
    s_cbranch_scc1 L_done
    s_mov_b64 s[74:75], 0
    v_max3_u32 v30, v12, v13, v14
    v_max_u32 v30, v30, v15
    v_cmp_eq_u32 vcc, -1, v30
    s_cbranch_vccz L_gn_62
    s_or_b64 s[74:75], s[74:75], vcc
    s_mov_b64 exec, vcc
    buffer_load_dwordx4 v[12:15], v5, s[40:43], s57 offen sc1
    s_mov_b64 exec, -1
L_gn_62:
    v_max3_u32 v30, v16, v17, v18
    v_max_u32 v30, v30, v19
    v_cmp_eq_u32 vcc, -1, v30
    s_cbranch_vccz L_gn_63
    s_or_b64 s[74:75], s[74:75], vcc
    s_mov_b64 exec, vcc
    buffer_load_dwordx4 v[16:19], v5, s[40:43], s58 offen sc1
    s_mov_b64 exec, -1
L_gn_63:
    v_max3_u32 v30, v20, v21, v22
    v_max_u32 v30, v30, v23
    v_cmp_eq_u32 vcc, -1, v30
    s_cbranch_vccz L_gn_64
    s_or_b64 s[74:75], s[74:75], vcc
    s_mov_b64 exec, vcc
    buffer_load_dwordx4 v[20:23], v5, s[40:43], s59 offen sc1
    s_mov_b64 exec, -1
L_gn_64:
    v_max3_u32 v30, v24, v25, v26
    v_max_u32 v30, v30, v27
    v_cmp_eq_u32 vcc, -1, v30
    s_cbranch_vccz L_gn_65
    s_or_b64 s[74:75], s[74:75], vcc
    s_mov_b64 exec, vcc
    buffer_load_dwordx4 v[24:27], v5, s[40:43], s60 offen sc1
    s_mov_b64 exec, -1
L_gn_65:
    s_cmp_eq_u64 s[74:75], 0
    s_cbranch_scc1 L_gk_61
    s_waitcnt vmcnt(0)
    s_branch L_gw_59
L_gs_68:
    buffer_store_dword v12, v11, s[40:43], s59 offen sc1
    s_branch L_gb_69
L_pr_71:
    s_sub_u32 s56, s56, 1
    s_cbranch_scc1 L_done
    buffer_load_dwordx4 v[12:15], v5, s[40:43], 0 offen offset:0 sc1
    buffer_load_dwordx4 v[16:19], v5, s[40:43], 0 offen offset:128 sc1
    buffer_load_dwordx4 v[20:23], v5, s[40:43], 0 offen offset:256 sc1
    s_waitcnt vmcnt(0)
    s_branch L_pw_70
L_gs_74:
    buffer_store_dword v22, v23, s[40:43], s57 offen sc1
    s_branch L_gb_75
L_old:
    s_waitcnt lgkmcnt(0)
    s_barrier
    s_cmp_lt_u32 s30, 2
    s_cbranch_scc0 L_b2_1
    v_and_b32 v37, 7, v0
    v_lshlrev_b32 v37, 3, v37
    v_add_u32 v37, 162816, v37
    ds_read_b64 v[38:39], v37
    s_lshl_b32 s57, s53, 3
    s_add_u32 s57, s57, s54
    s_lshl_b32 s57, s57, 2
    v_mov_b32 v23, s57
    s_add_u32 s57, s62, 27008
    s_waitcnt lgkmcnt(0)
    v_max_f32_dpp v37, v38, v38 row_ror:4 row_mask:0xf bank_mask:0xf
    s_nop 1
    v_max_f32_dpp v37, v37, v37 row_ror:2 row_mask:0xf bank_mask:0xf
    s_nop 1
    v_max_f32_dpp v37, v37, v37 row_ror:1 row_mask:0xf bank_mask:0xf
    v_sub_f32 v38, v38, v37
    v_exp_f32 v38, v38
    s_nop 0
    v_mul_f32 v39, v38, v39
    s_nop 1
    v_add_f32_dpp v39, v39, v39 row_ror:4 row_mask:0xf bank_mask:0xf
L_pad18:
    s_cbranch_execz L_pad19
    s_nop 1
    v_add_f32_dpp v39, v39, v39 row_ror:2 row_mask:0xf bank_mask:0xf
    s_nop 1
    v_add_f32_dpp v39, v39, v39 row_ror:1 row_mask:0xf bank_mask:0xf
    v_log_f32 v22, v39
    v_rcp_f32 v39, v39
    v_add_f32 v22, v22, v37
    v_min_u32 v22, -2, v22
    v_mul_f32 v38, v38, v39
    s_cmp_eq_u32 s30, 0
    s_cbranch_scc0 L_skip_73
    s_mov_b64 exec, 0x1
    s_cmp_eq_u32 s55, 0
    s_cbranch_scc1 L_gs_74
    buffer_store_dword v22, v23, s[40:43], s57 offen
L_gb_75:
    s_mov_b64 exec, -1
L_skip_73:
    v_readlane_b32 s64, v38, 0
    v_readlane_b32 s65, v38, 1
    v_readlane_b32 s66, v38, 2
    v_readlane_b32 s67, v38, 3
    v_readlane_b32 s68, v38, 4
    v_readlane_b32 s69, v38, 5
    v_readlane_b32 s70, v38, 6
    v_readlane_b32 s71, v38, 7
    s_mul_i32 s57, s30, 48
    v_add_u32 v38, s57, v0
    v_bfe_u32 v5, v38, 5, 2
    v_lshlrev_b32 v5, 8, v5
    v_and_b32 v39, 15, v38
    v_lshl_add_u32 v5, v39, 4, v5
    v_bfe_u32 v39, v38, 4, 1
    v_lshl_add_u32 v5, v39, 3, v5
    v_add_u32 v5, 92160, v5
    s_lshr_b32 s57, s54, 1
    s_lshl_b32 s57, s57, 2
    s_and_b32 s58, s54, 1
    s_add_u32 s57, s57, s58
    s_lshl_b32 s58, s57, 4
    s_lshl_b32 s57, s57, 3
    v_bfe_u32 v6, v0, 3, 2
    v_lshlrev_b32 v6, 8, v6
    v_bfe_u32 v39, v0, 2, 1
    v_lshl_add_u32 v6, v39, 5, v6
    v_and_b32 v39, 3, v0
    v_lshl_add_u32 v6, v39, 2, v6
    v_add_u32 v6, s58, v6
    v_bfe_u32 v38, v0, 3, 1
    v_lshlrev_b32 v38, 8, v38
    v_bfe_u32 v39, v0, 1, 1
    v_lshl_add_u32 v38, v39, 7, v38
    v_bfe_u32 v39, v0, 2, 1
    v_lshl_add_u32 v38, v39, 4, v38
    v_and_b32 v39, 1, v0
    v_lshl_add_u32 v38, v39, 2, v38
    v_add_u32 v38, s57, v38
    v_add_u32 v38, 1024, v38
    v_cmp_gt_u32 vcc, 32, v0
    s_nop 1
    v_cndmask_b32 v6, v38, v6, vcc
    s_lshl_b32 s57, s53, 1
    s_add_u32 s57, s57, s30
    s_mul_i32 s57, s57, 1536
    s_add_u32 s57, s57, s62
    s_add_u32 s57, s57, 12288
    v_add_u32 v6, s57, v6
    s_branch L_b2_1
L_gs_77:
    buffer_store_dword v56, v6, s[40:43], 0 offen sc1
    s_branch L_gb_78
L_pr_80:
    s_sub_u32 s56, s56, 1
    s_cbranch_scc1 L_done
    buffer_load_dword v18, v5, s[40:43], s59 offen sc1
    buffer_load_dwordx2 v[20:21], v6, s[40:43], s59 offen sc1
    s_waitcnt vmcnt(0)
    s_branch L_pw_79
L_pr_82:
    s_sub_u32 s56, s56, 1
    s_cbranch_scc1 L_done
    buffer_load_dwordx4 v[12:15], v9, s[40:43], s60 offen sc1
    buffer_load_dwordx2 v[16:17], v10, s[40:43], s60 offen offset:1024 sc1
    s_waitcnt vmcnt(0)
    s_branch L_pw_81
L_gs_84:
    buffer_store_dword v0, v0, s[40:43], s57 offen sc1
    s_branch L_gb_85
L_pr_88:
    s_sub_u32 s56, s56, 1
    s_cbranch_scc1 L_done
    buffer_load_dwordx4 v[12:15], v5, s[40:43], s59 offen offset:0 sc1
    buffer_load_dwordx4 v[16:19], v5, s[40:43], s59 offen offset:128 sc1
    buffer_load_dwordx4 v[20:23], v5, s[40:43], s59 offen offset:256 sc1
    s_waitcnt vmcnt(0)
L_pad19:
    s_cbranch_execz L_padback
    s_branch L_pw_87
L_gs_90:
    buffer_store_dword v0, v0, s[40:43], s57 offen sc1
    s_branch L_gb_91
L_pr_94:
    s_sub_u32 s56, s56, 1
    s_cbranch_scc1 L_done
    buffer_load_dword v12, v6, s[40:43], s57 offen sc1
    s_waitcnt vmcnt(0)
    s_branch L_pw_93
L_gr_96:
    s_sub_u32 s56, s56, 1
    s_cbranch_scc1 L_done
    s_mov_b64 s[74:75], 0
    v_max3_u32 v30, v12, v13, v14
    v_max_u32 v30, v30, v15
    v_cmp_eq_u32 vcc, -1, v30
    s_cbranch_vccz L_gn_98
    s_or_b64 s[74:75], s[74:75], vcc
    s_mov_b64 exec, vcc
    buffer_load_dwordx4 v[12:15], v5, s[40:43], s57 offen sc1
    s_mov_b64 exec, -1
L_gn_98:
    v_max3_u32 v30, v16, v17, v18
    v_max_u32 v30, v30, v19
    v_cmp_eq_u32 vcc, -1, v30
    s_cbranch_vccz L_gn_99
    s_or_b64 s[74:75], s[74:75], vcc
    s_mov_b64 exec, vcc
    buffer_load_dwordx4 v[16:19], v5, s[40:43], s58 offen sc1
    s_mov_b64 exec, -1
L_gn_99:
    v_max3_u32 v30, v20, v21, v22
    v_max_u32 v30, v30, v23
    v_cmp_eq_u32 vcc, -1, v30
    s_cbranch_vccz L_gn_100
    s_or_b64 s[74:75], s[74:75], vcc
    s_mov_b64 exec, vcc
    buffer_load_dwordx4 v[20:23], v5, s[40:43], s59 offen sc1
    s_mov_b64 exec, -1
L_gn_100:
    v_max3_u32 v30, v24, v25, v26
    v_max_u32 v30, v30, v27
    v_cmp_eq_u32 vcc, -1, v30
    s_cbranch_vccz L_gn_101
    s_or_b64 s[74:75], s[74:75], vcc
    s_mov_b64 exec, vcc
    buffer_load_dwordx4 v[24:27], v5, s[40:43], s60 offen sc1
    s_mov_b64 exec, -1
L_gn_101:
    s_cmp_eq_u64 s[74:75], 0
    s_cbranch_scc1 L_gk_97
    s_waitcnt vmcnt(0)
    s_branch L_gw_95
L_gs_104:
    buffer_store_dword v12, v11, s[40:43], s59 offen sc1
    s_branch L_gb_105
L_pr_107:
    s_sub_u32 s56, s56, 1
    s_cbranch_scc1 L_done
    buffer_load_dword v12, v6, s[40:43], s57 offen sc1
    s_waitcnt vmcnt(0)
    s_branch L_pw_106
L_gr_109:
    s_sub_u32 s56, s56, 1
    s_cbranch_scc1 L_done
    s_mov_b64 s[74:75], 0
    v_max3_u32 v30, v12, v13, v14
    v_max_u32 v30, v30, v15
    v_cmp_eq_u32 vcc, -1, v30
    s_cbranch_vccz L_gn_111
    s_or_b64 s[74:75], s[74:75], vcc
    s_mov_b64 exec, vcc
    buffer_load_dwordx4 v[12:15], v5, s[40:43], s57 offen sc1
    s_mov_b64 exec, -1
L_gn_111:
    v_max3_u32 v30, v16, v17, v18
    v_max_u32 v30, v30, v19
    v_cmp_eq_u32 vcc, -1, v30
    s_cbranch_vccz L_gn_112
    s_or_b64 s[74:75], s[74:75], vcc
    s_mov_b64 exec, vcc
    buffer_load_dwordx4 v[16:19], v5, s[40:43], s58 offen sc1
    s_mov_b64 exec, -1
L_gn_112:
    v_max3_u32 v30, v20, v21, v22
    v_max_u32 v30, v30, v23
    v_cmp_eq_u32 vcc, -1, v30
    s_cbranch_vccz L_gn_113
    s_or_b64 s[74:75], s[74:75], vcc
    s_mov_b64 exec, vcc
    buffer_load_dwordx4 v[20:23], v5, s[40:43], s59 offen sc1
    s_mov_b64 exec, -1
L_gn_113:
    v_max3_u32 v30, v24, v25, v26
    v_max_u32 v30, v30, v27
    v_cmp_eq_u32 vcc, -1, v30
    s_cbranch_vccz L_gn_114
    s_or_b64 s[74:75], s[74:75], vcc
    s_mov_b64 exec, vcc
    buffer_load_dwordx4 v[24:27], v5, s[40:43], s60 offen sc1
    s_mov_b64 exec, -1
L_gn_114:
    s_cmp_eq_u64 s[74:75], 0
    s_cbranch_scc1 L_gk_110
    s_waitcnt vmcnt(0)
    s_branch L_gw_108
L_tail_end:
L_done:
L_exit:
    s_endpgm
.section .rodata,"a"
.p2align 6
.amdhsa_kernel interleave_layers__sliding_block_cached__dense_activation_gelu__decode_kernel
  .amdhsa_next_free_vgpr 256
  .amdhsa_next_free_sgpr 102
  .amdhsa_accum_offset 256
  .amdhsa_group_segment_fixed_size 0
  .amdhsa_kernarg_size 104
  .amdhsa_user_sgpr_count 2
  .amdhsa_user_sgpr_kernarg_segment_ptr 1
  .amdhsa_system_sgpr_workgroup_id_x 1
  .amdhsa_float_denorm_mode_32 3
.end_amdhsa_kernel
```

```asm
; @launch grid=(256,1,1) block=(512,1,1) lds=130560
.amdgcn_target "amdgcn-amd-amdhsa--gfx950"
.text
.fill 64, 4, 0xbf800000
.globl interleave_layers__sliding_block_cached__dense_activation_gelu__decode_kernel
.p2align 8
.type interleave_layers__sliding_block_cached__dense_activation_gelu__decode_kernel,@function
interleave_layers__sliding_block_cached__dense_activation_gelu__decode_kernel:
    s_load_dwordx16 s[4:19], s[0:1], 0
    s_load_dwordx8 s[20:27], s[0:1], 64
    s_load_dwordx2 s[28:29], s[0:1], 96
    s_cmp_ge_u32 s2, 256
    s_cbranch_scc1 L_exit
    s_getpc_b64 s[74:75]
L_pc:
    v_lshlrev_b32 v5, 6, v0
    v_min_u32 v5, L_exit-L_pc, v5
    global_load_dword v59, v5, s[74:75]
    v_lshrrev_b32 v5, 6, v0
    v_and_b32 v0, 63, v0
    v_readfirstlane_b32 s30, v5
    s_and_b32 s31, s2, 7
    s_lshr_b32 s52, s2, 3
    s_and_b32 s53, s52, 3
    s_lshr_b32 s54, s52, 2
    v_lshrrev_b32 v8, 5, v0
    v_lshlrev_b32 v8, 2, v8
    v_bfe_u32 v60, v0, 4, 1
    v_lshl_add_u32 v8, v60, 0, v8
    v_and_b32 v9, 7, v0
    v_xor_b32 v8, v8, v9
    v_lshrrev_b32 v10, 3, v0
    v_mul_u32_u24 v10, 384, v10
    v_lshl_add_u32 v5, v8, 4, v10
    v_xor_b32 v6, 32, v5
    v_lshrrev_b32 v8, 4, v0
    v_lshlrev_b32 v8, 1, v8
    v_xor_b32 v8, v8, v9
    v_lshl_add_u32 v7, v8, 4, v10
    s_lshl_b32 s57, s31, 2
    s_add_u32 s57, s57, s53
    s_mul_i32 s57, s57, 12582912
    s_lshl_b32 s58, s54, 3
    s_add_u32 s58, s58, s30
    s_mul_i32 s58, s58, 3072
    s_add_u32 s57, s57, s58
    s_add_u32 s57, s57, 11010048
    s_sub_u32 s58, 1572864, s58
    s_mul_i32 s61, s30, 4096
    s_add_u32 s61, s61, 92160
    s_mul_i32 s62, s31, 40960
    s_lshl_b32 s73, s31, 2
    s_add_u32 s73, s73, s53
    s_mul_i32 s72, s73, 6400
    s_add_u32 s72, s72, 409600
    s_mov_b32 s56, 65536
    s_mov_b32 s55, 0
    s_getreg_b32 s63, hwreg(20, 0, 3)
    v_mov_b32 v11, 0
    v_mov_b32 v3, 0
    v_mov_b32 v21, 0
    v_mov_b32 v34, 0
    v_mov_b32 v62, 0
    v_mov_b32 v63, 0
    v_mov_b64 v[12:13], -1
    v_mov_b64 v[14:15], -1
    v_lshlrev_b32 v10, 4, v0
    s_waitcnt lgkmcnt(0)
    s_add_u32 s32, s6, s57
    s_addc_u32 s33, s7, 0
    s_mov_b32 s34, s58
    s_mov_b32 s35, 0x20000
    s_add_u32 s36, s8, s57
    s_addc_u32 s37, s9, 0
    s_mov_b32 s38, s58
    s_mov_b32 s39, 0x20000
    s_mov_b32 s40, s28
    s_mov_b32 s41, s29
    s_mov_b32 s42, 614400
    s_mov_b32 s43, 0x20000
    s_cmp_eq_u32 s30, 6
    s_cbranch_scc0 L_skip_1
    s_cmp_eq_u32 s54, 7
    s_cbranch_scc0 L_skip_2
    s_add_u32 s57, s72, 3072
    buffer_store_dwordx4 v[12:15], v10, s[40:43], s72 offen offset:0 sc1
    buffer_store_dwordx4 v[12:15], v10, s[40:43], s57 offen offset:0 sc1
    buffer_store_dwordx4 v[12:15], v10, s[40:43], s72 offen offset:1024 sc1
    buffer_store_dwordx4 v[12:15], v10, s[40:43], s57 offen offset:1024 sc1
    buffer_store_dwordx4 v[12:15], v10, s[40:43], s72 offen offset:2048 sc1
    buffer_store_dwordx4 v[12:15], v10, s[40:43], s57 offen offset:2048 sc1
    s_mov_b64 exec, 0xff
    buffer_store_dwordx4 v[12:15], v10, s[40:43], s57 offen offset:3072 sc1
    s_mov_b64 exec, -1
L_skip_2:
    s_mul_i32 s57, s52, 1280
    s_add_u32 s57, s57, s62
    buffer_store_dwordx4 v[12:15], v10, s[40:43], s57 offen sc1
    s_add_u32 s57, s57, 1024
    s_mul_i32 s58, s2, 320
    s_add_u32 s58, s58, 327424
    v_mov_b32 v16, s57
    v_mov_b32 v17, s58
    v_cmp_gt_u32 vcc, 16, v0
    s_nop 1
    v_cndmask_b32 v16, v17, v16, vcc
    v_add_u32 v16, v16, v10
    s_mov_b32 exec_lo, 0xffffffff
    s_mov_b32 exec_hi, 0xf
    buffer_store_dwordx4 v[12:15], v16, s[40:43], 0 offen sc1
    s_mov_b64 exec, -1
    s_cmp_eq_u32 s54, 7
    s_cbranch_scc0 L_skip_3
    s_lshl_b32 s57, s73, 3
    v_mov_b32 v16, s57
    s_waitcnt vmcnt(2)
    s_mov_b64 exec, 0x1
    global_store_dword v16, v12, s[26:27] sc1
    s_mov_b64 exec, -1
L_skip_3:
L_skip_1:
    s_add_u32 m0, s61, 0
    s_mov_b32 s57, 0
    buffer_load_dwordx4 v5, s[32:35], s57 offen offset:0 nt lds
    s_mov_b32 s58, 195584
    buffer_load_dwordx4 v6, s[32:35], s58 offen offset:1024 nt lds
    s_add_u32 m0, s61, 2048
    s_mov_b32 s57, 128
    buffer_load_dwordx4 v5, s[32:35], s57 offen offset:0 nt lds
    s_mov_b32 s58, 195712
    buffer_load_dwordx4 v6, s[32:35], s58 offen offset:1024 nt lds
    s_mov_b32 s44, s10
    s_mov_b32 s45, s11
    s_mov_b32 s46, 7864320
    s_mov_b32 s47, 0x20000
    s_mul_i32 s59, s73, 384
    s_mul_i32 s60, s54, 983040
    s_add_u32 s59, s59, s60
    v_lshrrev_b32 v17, 3, v0
    v_mul_u32_u24 v17, 12288, v17
    v_and_b32 v60, 7, v0
    v_lshl_add_u32 v17, v60, 4, v17
    v_add_u32 v17, s59, v17
    s_lshl_b32 s57, s30, 2
    s_add_u32 s57, s57, 0
    s_lshl_b32 m0, s57, 10
    s_mul_i32 s58, s57, 0xAAAB
    s_lshr_b32 s58, s58, 17
    s_mul_i32 s58, s58, 97920
    s_lshl_b32 s57, s57, 7
    s_add_u32 s57, s57, s58
    buffer_load_dwordx4 v17, s[44:47], s57 offen nt lds
    s_lshl_b32 s57, s30, 8
    v_and_b32 v16, 31, v0
    v_lshlrev_b32 v16, 3, v16
    v_lshrrev_b32 v60, 5, v0
    v_lshl_add_u32 v16, v60, 2, v16
    v_add_u32 v16, s57, v16
    s_cmp_ge_u32 s30, 5
    s_cbranch_scc0 L_skip_4
    v_and_b32 v60, 31, v0
    v_min_u32 v60, 19, v60
    s_mul_i32 s57, s54, 160
    v_lshrrev_b32 v16, 5, v0
    v_lshlrev_b32 v16, 2, v16
    v_add_u32 v16, s57, v16
    v_lshl_add_u32 v16, v60, 3, v16
L_skip_4:
    global_load_dword v28, v16, s[4:5]
    global_load_dword v4, v16, s[22:23]
    s_max_u32 s57, s52, 20
    s_sub_u32 s57, s57, 20
    s_lshl_b32 s57, s57, 5
    s_mul_i32 s58, s31, 384
    s_add_u32 s57, s57, s58
    v_and_b32 v16, 15, v0
    v_lshlrev_b32 v16, 1, v16
    v_add_u32 v16, s57, v16
    global_load_ushort v29, v16, s[18:19]
    v_bfe_u32 v8, v0, 1, 3
    v_lshrrev_b32 v9, 4, v0
    v_xor_b32 v9, v8, v9
    v_bfe_u32 v8, v0, 2, 1
    v_lshlrev_b32 v8, 10, v8
    v_bfe_u32 v60, v0, 3, 1
    v_lshl_add_u32 v8, v60, 9, v8
    v_and_b32 v60, 3, v0
    v_lshl_add_u32 v8, v60, 7, v8
    v_add_u32 v8, s61, v8
    v_lshl_add_u32 v8, v9, 4, v8
    v_xor_b32 v9, 64, v8
    v_bfe_u32 v1, v0, 1, 1
    v_mul_u32_u24 v1, 43690, v1
    v_add_u32 v1, 17476, v1
    s_cmp_eq_u32 s30, 6
    s_cbranch_scc0 L_skip_5
    v_and_b32 v16, 31, v0
    v_lshlrev_b32 v16, 2, v16
    v_add_u32 v16, 130048, v16
    ds_write_b32 v16, v12
    v_subrev_u32 v16, 8, v0
    v_cmp_gt_u32 vcc, 40, v16
    v_mov_b32 v16, 0x3f803f80
    s_nop 0
    v_cndmask_b32 v18, 0, v16, vcc
    v_min_u32 v16, 55, v0
    v_lshlrev_b32 v16, 2, v16
    v_add_u32 v16, 130336, v16
    ds_write_b32 v16, v18
    v_and_b32 v3, 31, v0
    v_lshlrev_b32 v3, 3, v3
L_skip_5:
    s_waitcnt vmcnt(6)
    ds_read_b128 v[64:67], v8 offset:0
    ds_read_b128 v[68:71], v9 offset:0
    s_waitcnt lgkmcnt(0)
    s_add_u32 m0, s61, 0
    s_mov_b32 s57, 256
    buffer_load_dwordx4 v5, s[32:35], s57 offen offset:0 nt lds
    s_mov_b32 s58, 195840
    buffer_load_dwordx4 v6, s[32:35], s58 offen offset:1024 nt lds
    s_lshl_b32 s57, s30, 2
    s_add_u32 s57, s57, 1
    s_lshl_b32 m0, s57, 10
    s_mul_i32 s58, s57, 0xAAAB
    s_lshr_b32 s58, s58, 17
    s_mul_i32 s58, s58, 97920
    s_lshl_b32 s57, s57, 7
    s_add_u32 s57, s57, s58
    buffer_load_dwordx4 v17, s[44:47], s57 offen nt lds
    s_waitcnt vmcnt(7)
    ds_read_b128 v[72:75], v8 offset:2048
    ds_read_b128 v[76:79], v9 offset:2048
    s_waitcnt lgkmcnt(0)
    s_add_u32 m0, s61, 2048
    s_mov_b32 s57, 393216
    buffer_load_dwordx4 v5, s[32:35], s57 offen offset:0 nt lds
    s_mov_b32 s58, 588800
    buffer_load_dwordx4 v6, s[32:35], s58 offen offset:1024 nt lds
    s_cmp_eq_u32 s30, 7
    s_cselect_b32 s57, 0x7f000000, 0
    v_or_b32 v17, s57, v17
    s_lshl_b32 s57, s30, 2
    s_add_u32 s57, s57, 2
    s_lshl_b32 m0, s57, 10
    s_mul_i32 s58, s57, 0xAAAB
    s_lshr_b32 s58, s58, 17
    s_mul_i32 s58, s58, 97920
    s_lshl_b32 s57, s57, 7
    s_add_u32 s57, s57, s58
    buffer_load_dwordx4 v17, s[44:47], s57 offen nt lds
    s_waitcnt vmcnt(4)
    ds_read_b128 v[80:83], v8 offset:0
    ds_read_b128 v[84:87], v9 offset:0
    s_waitcnt lgkmcnt(0)
    s_add_u32 m0, s61, 0
    s_mov_b32 s57, 393344
    buffer_load_dwordx4 v5, s[32:35], s57 offen offset:0 nt lds
    s_mov_b32 s58, 588928
    buffer_load_dwordx4 v6, s[32:35], s58 offen offset:1024 nt lds
    s_lshl_b32 s57, s30, 2
    s_add_u32 s57, s57, 3
    s_lshl_b32 m0, s57, 10
    s_mul_i32 s58, s57, 0xAAAB
    s_lshr_b32 s58, s58, 17
    s_mul_i32 s58, s58, 97920
    s_lshl_b32 s57, s57, 7
    s_add_u32 s57, s57, s58
    buffer_load_dwordx4 v17, s[44:47], s57 offen nt lds
    s_cmp_eq_u32 s30, 6
    s_cbranch_scc0 L_skip_6
    global_load_dword v2, v3, s[26:27] sc1
L_skip_6:
    s_waitcnt vmcnt(4)
    ds_read_b128 v[88:91], v8 offset:2048
    ds_read_b128 v[92:95], v9 offset:2048
    s_waitcnt lgkmcnt(0)
    s_add_u32 m0, s61, 2048
    s_mov_b32 s57, 393472
    buffer_load_dwordx4 v5, s[32:35], s57 offen offset:0 nt lds
    s_mov_b32 s58, 589056
    buffer_load_dwordx4 v6, s[32:35], s58 offen offset:1024 nt lds
    s_waitcnt vmcnt(3)
    ds_read_b128 v[96:99], v8 offset:0
    ds_read_b128 v[100:103], v9 offset:0
    s_waitcnt lgkmcnt(0)
    s_add_u32 m0, s61, 0
    s_mov_b32 s57, 786432
    buffer_load_dwordx4 v5, s[32:35], s57 offen offset:0 nt lds
    s_mov_b32 s58, 982016
    buffer_load_dwordx4 v6, s[32:35], s58 offen offset:1024 nt lds
    s_waitcnt vmcnt(2)
    ds_read_b128 v[104:107], v8 offset:2048
    ds_read_b128 v[108:111], v9 offset:2048
    s_waitcnt lgkmcnt(0)
    s_add_u32 m0, s61, 2048
    s_mov_b32 s57, 786560
    buffer_load_dwordx4 v5, s[32:35], s57 offen offset:0 nt lds
    s_mov_b32 s58, 982144
    buffer_load_dwordx4 v6, s[32:35], s58 offen offset:1024 nt lds
    s_cmp_eq_u32 s30, 6
    s_cbranch_scc0 L_skip_7
L_cw_8:
    v_readlane_b32 s57, v2, s73
    s_cmp_eq_u32 s57, 0
    s_cbranch_scc1 L_cr_9
    s_lshl_b32 s57, s54, 2
    s_add_u32 s57, s57, s72
    s_add_u32 s57, s57, 6208
    v_mov_b32 v13, s63
    s_mov_b64 exec, 0x1
    buffer_store_dword v13, v0, s[40:43], s57 offen sc1
    s_mov_b64 exec, -1
L_skip_7:
    s_cmp_eq_u32 s30, 7
    s_cbranch_scc0 L_skip_10
    v_and_b32 v60, 31, v0
    v_cmp_gt_u32 s[64:65], 20, v60
    v_min_u32 v60, 19, v60
    v_lshrrev_b32 v11, 5, v0
    v_lshlrev_b32 v11, 2, v11
    v_add_u32 v11, 130176, v11
    v_lshl_add_u32 v11, v60, 3, v11
    s_mov_b32 s66, s72
    s_add_u32 s67, s72, 6144
    s_lshl_b32 s57, s54, 3
    v_lshrrev_b32 v10, 5, v0
    v_lshlrev_b32 v10, 2, v10
    v_add_u32 v10, s57, v10
    v_mov_b32 v61, 0x3f803f80
    ds_write_b32 v11, v28
    s_waitcnt lgkmcnt(0)
L_skip_10:
    s_barrier
    s_cmp_eq_u32 s30, 7
    s_cbranch_scc0 L_skip_11
    v_lshlrev_b32 v2, 16, v28
    v_and_b32 v3, 0xffff0000, v28
    v_cndmask_b32 v28, 0, v28, s[64:65]
    v_dot2_f32_bf16 v27, v28, v61, 0
    v_dot2_f32_bf16 v62, v28, v28, 0
    s_nop 2
    v_permlane32_swap_b32 v27, v62
    v_add_f32 v27, v27, v62
    v_mov_b32 v62, v27
    s_nop 1
    v_permlane16_swap_b32 v27, v62
    v_add_f32 v27, v27, v62
    s_nop 1
    v_add_f32_dpp v27, v27, v27 row_ror:8 row_mask:0xf bank_mask:0xf
    s_nop 1
    v_add_f32_dpp v27, v27, v27 row_ror:4 row_mask:0xf bank_mask:0xf
    s_nop 1
    v_add_f32_dpp v27, v27, v27 row_ror:2 row_mask:0xf bank_mask:0xf
    s_nop 1
    v_add_f32_dpp v27, v27, v27 row_ror:1 row_mask:0xf bank_mask:0xf
    v_min_u32 v27, -2, v27
    s_mov_b32 exec_lo, 0x1
    s_mov_b32 exec_hi, 0x1
    buffer_store_dword v27, v10, s[40:43], s67 offen sc1
    s_mov_b64 exec, -1
L_skip_11:
    s_cmp_eq_u32 s30, 5
    s_cbranch_scc0 L_skip_12
    v_lshlrev_b32 v4, 16, v29
L_skip_12:
    s_cmp_lt_u32 s30, 6
    s_cbranch_scc0 L_skip_13
    v_lshlrev_b32 v2, 16, v28
    v_and_b32 v3, 0xffff0000, v28
    s_lshr_b32 s57, s30, 1
    s_lshl_b32 s57, s57, 10
    s_and_b32 s58, s30, 1
    s_lshl_b32 s58, s58, 6
    s_add_u32 s57, s57, s58
    v_lshrrev_b32 v10, 5, v0
    v_mul_u32_u24 v10, 6144, v10
    v_bfe_u32 v60, v0, 3, 1
    v_mul_u32_u24 v60, 3072, v60
    v_add_u32 v10, v60, v10
    v_bfe_u32 v60, v0, 4, 1
    v_lshl_add_u32 v10, v60, 9, v10
    v_bfe_u32 v60, v0, 2, 1
    v_lshl_add_u32 v10, v60, 7, v10
    v_and_b32 v60, 3, v0
    v_lshl_add_u32 v10, v60, 3, v10
    v_add_u32 v10, s57, v10
    v_bfe_u32 v11, v0, 4, 1
    v_mul_u32_u24 v11, 3072, v11
    v_bfe_u32 v60, v0, 3, 1
    v_lshl_add_u32 v11, v60, 9, v11
    v_bfe_u32 v60, v0, 2, 1
    v_lshl_add_u32 v11, v60, 7, v11
    v_and_b32 v60, 3, v0
    v_lshl_add_u32 v11, v60, 3, v11
    v_add_u32 v11, s57, v11
    v_add_u32 v11, 24576, v11
    ds_read_b64_tr_b16 v[36:37], v10 offset:0
    ds_read_b64_tr_b16 v[38:39], v10 offset:256
    ds_read_b64_tr_b16 v[40:41], v10 offset:12288
    ds_read_b64_tr_b16 v[42:43], v10 offset:12544
    ds_read_b64_tr_b16 v[44:45], v11 offset:0
    ds_read_b64_tr_b16 v[46:47], v11 offset:256
    ds_read_b64_tr_b16 v[48:49], v10 offset:32
    ds_read_b64_tr_b16 v[50:51], v10 offset:288
    ds_read_b64_tr_b16 v[52:53], v10 offset:12320
    ds_read_b64_tr_b16 v[54:55], v10 offset:12576
    ds_read_b64_tr_b16 v[56:57], v11 offset:32
    ds_read_b64_tr_b16 v[58:59], v11 offset:288
    v_lshrrev_b32 v32, 4, v0
    v_lshlrev_b32 v32, 5, v32
    v_bfe_u32 v60, v0, 1, 1
    v_lshl_add_u32 v32, v60, 4, v32
    v_and_b32 v60, 1, v0
    v_mul_u32_u24 v60, 192, v60
    v_add_u32 v32, v60, v32
    v_add_u32 v32, 130176, v32
    v_lshrrev_b32 v33, 4, v0
    v_lshlrev_b32 v33, 4, v33
    v_bfe_u32 v60, v0, 1, 1
    v_lshl_add_u32 v33, v60, 3, v33
    v_and_b32 v60, 1, v0
    v_mul_u32_u24 v60, 192, v60
    v_add_u32 v33, v60, v33
    v_add_u32 v33, 130304, v33
    v_mov_b64 v[24:25], 0
    v_mov_b64 v[26:27], 0
    v_mov_b64 v[28:29], 0
    v_mov_b64 v[30:31], 0
    s_lshr_b32 s57, s54, 1
    s_lshl_b32 s57, s57, 2
    s_and_b32 s58, s54, 1
    s_add_u32 s57, s57, s58
    s_lshl_b32 s57, s57, 4
    s_lshl_b32 s58, s30, 9
    s_add_u32 s57, s57, s58
    v_bfe_u32 v34, v0, 4, 1
    v_lshlrev_b32 v34, 8, v34
    v_bfe_u32 v60, v0, 1, 1
    v_lshl_add_u32 v34, v60, 5, v34
    v_bfe_u32 v60, v0, 2, 2
    v_lshl_add_u32 v34, v60, 2, v34
    v_lshrrev_b32 v60, 5, v0
    v_mul_u32_u24 v60, 3072, v60
    v_add_u32 v34, v60, v34
    v_add_u32 v34, s57, v34
    s_mov_b32 s59, s72
    s_add_u32 s60, s72, 6144
    ds_read_b128 v[12:15], v32
    ds_read_b64 v[16:17], v33
    s_waitcnt lgkmcnt(1)
    v_smfmac_f32_16x16x64_bf16 v[24:27], v[12:15], v[36:43], v1
    v_smfmac_f32_16x16x64_bf16 v[28:31], v[12:15], v[48:55], v1
    s_waitcnt lgkmcnt(0)
    v_smfmac_f32_16x16x32_bf16 v[24:27], v[16:17], v[44:47], v1
    v_smfmac_f32_16x16x32_bf16 v[28:31], v[16:17], v[56:59], v1
    s_nop 6
    v_add_f32 v12, v24, v26
    s_nop 1
    v_add_f32_dpp v12, v28, v30 quad_perm:[0,1,2,3] row_mask:0x2 bank_mask:0xf
    s_nop 1
    v_add_f32_dpp v12, v25, v27 quad_perm:[0,1,2,3] row_mask:0x4 bank_mask:0xf
    s_nop 1
    v_add_f32_dpp v12, v29, v31 quad_perm:[0,1,2,3] row_mask:0x8 bank_mask:0xf
    s_nop 1
    v_mov_b32_dpp v13, v12 row_shl:1 row_mask:0xf bank_mask:0xf bound_ctrl:0
    v_cvt_pk_bf16_f32 v12, v12, v13
    v_min_u32 v12, -2, v12
    s_mov_b32 exec_lo, 0x55555555
    s_mov_b32 exec_hi, 0x55555555
    buffer_store_dword v12, v34, s[40:43], s59 offen sc1
    s_mov_b64 exec, -1
L_skip_13:
    s_waitcnt vmcnt(2)
    ds_read_b128 v[112:115], v8 offset:0
    ds_read_b128 v[116:119], v9 offset:0
    s_waitcnt lgkmcnt(0)
    s_add_u32 m0, s61, 0
    s_mov_b32 s57, 786688
    buffer_load_dwordx4 v5, s[32:35], s57 offen offset:0 nt lds
    s_mov_b32 s58, 982272
    buffer_load_dwordx4 v6, s[32:35], s58 offen offset:1024 nt lds
    s_waitcnt vmcnt(2)
    ds_read_b128 v[120:123], v8 offset:2048
    ds_read_b128 v[124:127], v9 offset:2048
    s_waitcnt lgkmcnt(0)
    s_add_u32 m0, s61, 2048
    s_mov_b32 s57, 1179648
    buffer_load_dwordx4 v5, s[32:35], s57 offen offset:0 nt lds
    s_mov_b32 s58, 1375232
    buffer_load_dwordx4 v6, s[32:35], s58 offen offset:1024 nt lds
    s_waitcnt vmcnt(2)
    ds_read_b128 v[128:131], v8 offset:0
    ds_read_b128 v[132:135], v9 offset:0
    s_waitcnt lgkmcnt(0)
    s_add_u32 m0, s61, 0
    s_mov_b32 s57, 1179776
    buffer_load_dwordx4 v5, s[32:35], s57 offen offset:0 nt lds
    s_mov_b32 s58, 1375360
    buffer_load_dwordx4 v6, s[32:35], s58 offen offset:1024 nt lds
    s_mov_b32 s59, s72
    s_add_u32 s60, s72, 6144
    v_lshlrev_b32 v63, 4, v0
    v_add_u32 v63, s59, v63
    v_and_b32 v62, 7, v0
    v_lshlrev_b32 v62, 3, v62
    v_add_u32 v62, s60, v62
    s_mov_b32 s75, 3072
    buffer_load_dwordx2 v[52:53], v62, s[40:43], 0 offen sc1
    buffer_load_dwordx4 v[12:15], v63, s[40:43], 0 offen offset:0 sc1
    buffer_load_dwordx4 v[16:19], v63, s[40:43], 0 offen offset:1024 sc1
    buffer_load_dwordx4 v[20:23], v63, s[40:43], 0 offen offset:2048 sc1
    buffer_load_dwordx4 v[40:43], v63, s[40:43], s75 offen offset:0 sc1
    buffer_load_dwordx4 v[44:47], v63, s[40:43], s75 offen offset:1024 sc1
    buffer_load_dwordx4 v[48:51], v63, s[40:43], s75 offen offset:2048 sc1
    s_waitcnt vmcnt(9)
    ds_read_b128 v[136:139], v8 offset:2048
    ds_read_b128 v[140:143], v9 offset:2048
    s_waitcnt lgkmcnt(0)
    s_add_u32 m0, s61, 2048
    s_mov_b32 s57, 1179904
    buffer_load_dwordx4 v5, s[32:35], s57 offen offset:0 nt lds
    s_mov_b32 s58, 1375488
    buffer_load_dwordx4 v6, s[32:35], s58 offen offset:1024 nt lds
    s_cmp_eq_u32 s30, 6
    s_cbranch_scc0 L_skip_14
    global_load_dword v2, v3, s[26:27] sc1
L_skip_14:
    s_waitcnt vmcnt(9)
    ds_read_b128 v[144:147], v8 offset:0
    ds_read_b128 v[148:151], v9 offset:0
    s_waitcnt lgkmcnt(0)
    s_add_u32 m0, s61, 0
    s_mov_b32 s57, 0
    buffer_load_dwordx4 v7, s[36:39], s57 offen offset:0 nt lds
    s_mov_b32 s58, 392192
    buffer_load_dwordx4 v7, s[36:39], s58 offen offset:1024 nt lds
    s_waitcnt vmcnt(2)
    ds_read_b128 v[152:155], v8 offset:2048
    ds_read_b128 v[156:159], v9 offset:2048
    s_waitcnt lgkmcnt(0)
    s_add_u32 m0, s61, 2048
    s_mov_b32 s57, 128
    buffer_load_dwordx4 v7, s[36:39], s57 offen offset:0 nt lds
    s_mov_b32 s58, 392320
    buffer_load_dwordx4 v7, s[36:39], s58 offen offset:1024 nt lds
    v_lshrrev_b32 v8, 2, v0
    v_lshlrev_b32 v8, 7, v8
    v_bfe_u32 v60, v0, 3, 2
    v_lshl_add_u32 v8, v60, 5, v8
    v_and_b32 v60, 3, v0
    v_lshl_add_u32 v8, v60, 3, v8
    v_add_u32 v8, s61, v8
    v_xor_b32 v9, 32, v8
    v_xor_b32 v10, 64, v8
    v_xor_b32 v11, 96, v8
    s_waitcnt vmcnt(2)
    ds_read_b64_tr_b16 v[160:161], v8 offset:0
    ds_read_b64_tr_b16 v[168:169], v9 offset:0
    ds_read_b64_tr_b16 v[176:177], v10 offset:0
    ds_read_b64_tr_b16 v[184:185], v11 offset:0
    s_waitcnt lgkmcnt(0)
    s_add_u32 m0, s61, 0
    s_mov_b32 s57, 256
    buffer_load_dwordx4 v7, s[36:39], s57 offen offset:0 nt lds
    s_mov_b32 s58, 392448
    buffer_load_dwordx4 v7, s[36:39], s58 offen offset:1024 nt lds
    s_cmp_lt_u32 s52, 20
    s_cbranch_scc0 L_wb_15
    s_mov_b32 s48, s12
    s_mov_b32 s49, s13
    s_mov_b32 s50, 7864320
    s_mov_b32 s51, 0x20000
    s_mul_i32 s57, s31, 768
    s_mul_i32 s58, s30, 96
    s_add_u32 s57, s57, s58
    s_mul_i32 s57, s57, 1280
    s_lshl_b32 s58, s52, 6
    s_add_u32 s57, s57, s58
    v_bfe_u32 v38, v0, 4, 1
    v_lshlrev_b32 v38, 1, v38
    v_xor_b32 v38, v38, v0
    v_and_b32 v38, 3, v38
    v_lshrrev_b32 v5, 5, v0
    v_mul_u32_u24 v5, 10240, v5
    v_bfe_u32 v39, v0, 4, 1
    v_mul_u32_u24 v39, 2560, v39
    v_add_u32 v5, v39, v5
    v_bfe_u32 v39, v0, 3, 1
    v_mul_u32_u24 v39, 5120, v39
    v_add_u32 v5, v39, v5
    v_bfe_u32 v39, v0, 2, 1
    v_mul_u32_u24 v39, 20480, v39
    v_add_u32 v5, v39, v5
    v_add_u32 v5, s57, v5
    v_lshl_add_u32 v5, v38, 4, v5
    s_mov_b32 s14, 40960
    s_mov_b32 s15, 1280
    s_mov_b32 s3, 0
    s_branch L_we_16
L_wb_15:
    s_mov_b32 s48, s16
    s_mov_b32 s49, s17
    s_mov_b32 s50, 1966080
    s_mov_b32 s51, 0x20000
    s_mul_i32 s57, s31, 384
    s_sub_u32 s58, s52, 20
    s_lshl_b32 s58, s58, 5
    s_add_u32 s57, s57, s58
    s_mul_i32 s58, s30, 393216
    s_add_u32 s57, s57, s58
    v_lshrrev_b32 v5, 1, v0
    v_mul_u32_u24 v5, 3072, v5
    v_and_b32 v39, 1, v0
    v_lshl_add_u32 v5, v39, 4, v5
    v_add_u32 v5, s57, v5
    s_mov_b32 s14, 196608
    s_mov_b32 s15, 98304
    s_mov_b32 s3, 0x7f000000
L_we_16:
    s_mul_i32 s57, s30, 6144
    s_add_u32 m0, s57, 30720
    s_mul_i32 s57, s14, 0
    buffer_load_dwordx4 v5, s[48:51], s57 offen nt lds
L_pw_17:
    v_max3_u32 v39, v12, v13, v14
    v_max3_u32 v39, v39, v15, v16
    v_max3_u32 v39, v39, v17, v18
    v_max3_u32 v39, v39, v19, v20
    v_max3_u32 v39, v39, v21, v22
    v_max3_u32 v39, v39, v23, v40
    v_max3_u32 v39, v39, v41, v42
    v_max3_u32 v39, v39, v43, v44
    v_max3_u32 v39, v39, v45, v46
    v_max3_u32 v39, v39, v47, v48
    v_max3_u32 v39, v39, v49, v50
    v_max3_u32 v39, v39, v51, v52
    v_max_u32 v39, v39, v53
    v_cmp_eq_u32 vcc, -1, v39
    s_cbranch_vccnz L_pr_18
    v_mov_b64 v[24:25], 0
    v_mov_b64 v[26:27], 0
    v_mov_b64 v[28:29], 0
    v_mov_b64 v[30:31], 0
    v_mov_b64 v[32:33], 0
    v_mov_b64 v[34:35], 0
    v_mov_b64 v[36:37], 0
    v_mov_b64 v[38:39], 0
    v_smfmac_f32_16x16x64_bf16 v[24:27], v[40:43], v[64:71], v1
    v_smfmac_f32_16x16x64_bf16 v[24:27], v[44:47], v[72:79], v1
    v_smfmac_f32_16x16x64_bf16 v[24:27], v[48:51], v[80:87], v1
    v_smfmac_f32_16x16x64_bf16 v[32:35], v[40:43], v[112:119], v1
    v_smfmac_f32_16x16x64_bf16 v[32:35], v[44:47], v[120:127], v1
    v_smfmac_f32_16x16x64_bf16 v[32:35], v[48:51], v[128:135], v1
    v_smfmac_f32_16x16x64_bf16 v[28:31], v[40:43], v[88:95], v1
    v_smfmac_f32_16x16x64_bf16 v[28:31], v[44:47], v[96:103], v1
    v_smfmac_f32_16x16x64_bf16 v[28:31], v[48:51], v[104:111], v1
    v_smfmac_f32_16x16x64_bf16 v[36:39], v[40:43], v[136:143], v1
    s_nop 0
    v_pk_add_f32 v[24:25], v[24:25], v[26:27]
    v_add_f32 v24, v24, v25
    v_smfmac_f32_16x16x64_bf16 v[36:39], v[44:47], v[144:151], v1
    v_pk_add_f32 v[32:33], v[32:33], v[34:35]
    v_add_f32 v32, v32, v33
    v_smfmac_f32_16x16x64_bf16 v[36:39], v[48:51], v[152:159], v1
    s_nop 0
    v_permlane32_swap_b32 v24, v32
    v_add_f32 v24, v24, v32
    v_pk_add_f32 v[28:29], v[28:29], v[30:31]
    v_add_f32 v28, v28, v29
    s_nop 2
    v_pk_add_f32 v[36:37], v[36:37], v[38:39]
    v_add_f32 v36, v36, v37
    s_nop 1
    v_permlane32_swap_b32 v28, v36
    v_add_f32 v28, v28, v36
    s_nop 1
    v_permlane16_swap_b32 v24, v28
    v_add_f32 v6, v24, v28
    v_mov_b64 v[24:25], 0
    v_mov_b64 v[26:27], 0
    v_mov_b64 v[28:29], 0
    v_mov_b64 v[30:31], 0
    v_mov_b64 v[32:33], 0
    v_mov_b64 v[34:35], 0
    v_mov_b64 v[36:37], 0
    v_mov_b64 v[38:39], 0
    v_smfmac_f32_16x16x64_bf16 v[24:27], v[12:15], v[64:71], v1
    v_add_f32_dpp v52, v52, v52 row_ror:4 row_mask:0xf bank_mask:0xf
    v_add_f32_dpp v53, v53, v53 row_ror:4 row_mask:0xf bank_mask:0xf
    v_smfmac_f32_16x16x64_bf16 v[24:27], v[16:19], v[72:79], v1
    v_add_f32_dpp v52, v52, v52 row_ror:2 row_mask:0xf bank_mask:0xf
    v_add_f32_dpp v53, v53, v53 row_ror:2 row_mask:0xf bank_mask:0xf
    v_smfmac_f32_16x16x64_bf16 v[24:27], v[20:23], v[80:87], v1
    v_add_f32_dpp v52, v52, v52 row_ror:1 row_mask:0xf bank_mask:0xf
    v_add_f32_dpp v53, v53, v53 row_ror:1 row_mask:0xf bank_mask:0xf
    v_smfmac_f32_16x16x64_bf16 v[32:35], v[12:15], v[112:119], v1
    v_mul_f32 v52, 0x3acccccd, v52
    v_mul_f32 v53, 0x3acccccd, v53
    v_smfmac_f32_16x16x64_bf16 v[32:35], v[16:19], v[120:127], v1
    v_fma_f32 v53, -v52, v52, v53
    v_max_f32 v53, 0, v53
    v_smfmac_f32_16x16x64_bf16 v[32:35], v[20:23], v[128:135], v1
    v_add_f32 v53, 0x3727c5ac, v53
    v_rsq_f32 v53, v53
    v_smfmac_f32_16x16x64_bf16 v[28:31], v[12:15], v[88:95], v1
    s_mov_b32 vcc_lo, 0x55555555
    v_mul_f32 v53, 0x3dd53b95, v53
    v_smfmac_f32_16x16x64_bf16 v[28:31], v[16:19], v[96:103], v1
    s_mov_b32 vcc_hi, 0x55555555
    v_smfmac_f32_16x16x64_bf16 v[28:31], v[20:23], v[104:111], v1
    v_smfmac_f32_16x16x64_bf16 v[36:39], v[12:15], v[136:143], v1
    v_pk_add_f32 v[24:25], v[24:25], v[26:27]
    v_add_f32 v24, v24, v25
    v_smfmac_f32_16x16x64_bf16 v[36:39], v[16:19], v[144:151], v1
    v_pk_add_f32 v[32:33], v[32:33], v[34:35]
    v_add_f32 v32, v32, v33
    v_smfmac_f32_16x16x64_bf16 v[36:39], v[20:23], v[152:159], v1
    s_nop 0
    v_permlane32_swap_b32 v24, v32
    v_add_f32 v24, v24, v32
    v_pk_add_f32 v[28:29], v[28:29], v[30:31]
    v_add_f32 v28, v28, v29
    s_nop 2
    v_pk_add_f32 v[36:37], v[36:37], v[38:39]
    v_add_f32 v36, v36, v37
    s_nop 1
    v_permlane32_swap_b32 v28, v36
    v_add_f32 v28, v28, v36
    s_nop 1
    v_permlane16_swap_b32 v24, v28
    v_add_f32 v24, v24, v28
    v_fma_f32 v24, -v52, v6, v24
    s_nop 1
    v_max_f32_dpp v21, v24, v24 row_ror:8 row_mask:0xf bank_mask:0xf
    s_nop 1
    v_max_f32_dpp v21, v21, v21 row_ror:4 row_mask:0xf bank_mask:0xf
    s_nop 1
    v_max_f32_dpp v21, v21, v21 row_ror:2 row_mask:0xf bank_mask:0xf
    s_nop 1
    v_max_f32_dpp v21, v21, v21 row_ror:1 row_mask:0xf bank_mask:0xf
    s_nop 1
    v_max_f32_dpp v21, v21, v21 row_bcast:15 row_mask:0xa bank_mask:0xf
    s_nop 1
    v_max_f32_dpp v21, v21, v21 row_bcast:31 row_mask:0xc bank_mask:0xf
    s_nop 0
    v_readlane_b32 s57, v21, 63
    s_nop 1
    v_subrev_f32 v24, s57, v24
    v_mul_f32 v24, v24, v53
    v_exp_f32 v22, v24
    v_mul_f32 v20, s57, v53
    s_nop 0
    v_mov_b32_dpp v23, v22 row_shl:1 row_mask:0xf bank_mask:0xf bound_ctrl:0
    v_cvt_pk_bf16_f32 v23, v22, v23
    v_cndmask_b32 v12, 0, v23, vcc
    v_mov_b32 v21, v22
    s_nop 0
    v_mov_b32_dpp v13, v12 row_shl:4 row_mask:0xf bank_mask:0xf bound_ctrl:0
    v_mov_b32_dpp v14, v12 row_shl:8 row_mask:0xf bank_mask:0xf bound_ctrl:0
    v_mov_b32_dpp v15, v12 row_shl:12 row_mask:0xf bank_mask:0xf bound_ctrl:0
    v_mov_b64 v[40:41], 0
    v_mov_b64 v[42:43], 0
    v_mov_b64 v[44:45], 0
    v_mov_b64 v[46:47], 0
    v_mov_b64 v[48:49], 0
    v_mov_b64 v[50:51], 0
    v_mov_b64 v[52:53], 0
    v_mov_b64 v[54:55], 0
    v_mov_b64 v[56:57], 0
    v_mov_b64 v[58:59], 0
    v_mov_b64 v[60:61], 0
    v_mov_b64 v[62:63], 0
    s_lshl_b32 s58, s30, 3
    s_add_u32 s58, s58, 130048
    v_mov_b32 v37, s58
    v_mov_b32_dpp v16, v12 row_shr:1 row_mask:0xf bank_mask:0xf bound_ctrl:0
    v_mov_b32_dpp v17, v12 row_shl:3 row_mask:0xf bank_mask:0xf bound_ctrl:0
    v_mov_b32_dpp v18, v12 row_shl:7 row_mask:0xf bank_mask:0xf bound_ctrl:0
    v_mov_b32_dpp v19, v12 row_shl:11 row_mask:0xf bank_mask:0xf bound_ctrl:0
    v_permlane32_swap_b32 v21, v22
    v_add_f32 v21, v21, v22
    v_mov_b32 v22, v21
    s_nop 1
    v_permlane16_swap_b32 v21, v22
    v_add_f32 v21, v21, v22
    s_nop 1
    v_add_f32_dpp v21, v21, v21 row_ror:8 row_mask:0xf bank_mask:0xf
    s_nop 1
    v_add_f32_dpp v21, v21, v21 row_ror:4 row_mask:0xf bank_mask:0xf
    s_nop 1
    v_add_f32_dpp v21, v21, v21 row_ror:2 row_mask:0xf bank_mask:0xf
    s_nop 1
    v_add_f32_dpp v21, v21, v21 row_ror:1 row_mask:0xf bank_mask:0xf
    ds_write_b64 v37, v[20:21]
    v_and_b32 v36, 15, v0
    v_lshlrev_b32 v36, 4, v36
    v_add_u32 v36, s61, v36
    s_cmp_eq_u32 s30, 6
    s_cbranch_scc0 L_skip_19
L_cw_20:
    v_cmp_eq_u32 vcc, 0, v2
    s_cbranch_vccnz L_cr_21
    v_lshrrev_b32 v3, 1, v0
    v_mul_u32_u24 v3, 6400, v3
    v_and_b32 v2, 1, v0
    v_lshl_add_u32 v3, v2, 4, v3
    v_add_u32 v3, 415808, v3
    s_mov_b32 m0, 124928
    s_nop 0
    buffer_load_dwordx4 v3, s[40:43], 0 offen sc1 lds
L_skip_19:
    s_waitcnt vmcnt(3)
    ds_read_b64_tr_b16 v[192:193], v8 offset:2048
    ds_read_b64_tr_b16 v[200:201], v9 offset:2048
    ds_read_b64_tr_b16 v[208:209], v10 offset:2048
    ds_read_b64_tr_b16 v[216:217], v11 offset:2048
    s_waitcnt lgkmcnt(0)
    s_add_u32 m0, s61, 2048
    s_mov_b32 s57, 196608
    buffer_load_dwordx4 v7, s[36:39], s57 offen offset:0 nt lds
    s_mov_b32 s58, 588800
    buffer_load_dwordx4 v7, s[36:39], s58 offen offset:1024 nt lds
    s_mul_i32 s57, s30, 6144
    s_add_u32 m0, s57, 31744
    s_mul_i32 s57, s14, 0
    s_add_u32 s57, s57, s15
    buffer_load_dwordx4 v5, s[48:51], s57 offen nt lds
    s_cmp_eq_u32 s30, 3
    s_cbranch_scc0 L_skip_22
    s_mov_b64 exec, 0
    s_cbranch_execz L_pad0
L_padback:
    s_mov_b64 exec, -1
L_skip_22:
    s_waitcnt vmcnt(4)
    ds_read_b64_tr_b16 v[224:225], v8 offset:0
    ds_read_b64_tr_b16 v[232:233], v9 offset:0
    ds_read_b64_tr_b16 v[240:241], v10 offset:0
    ds_read_b64_tr_b16 v[248:249], v11 offset:0
    s_waitcnt lgkmcnt(0)
    s_add_u32 m0, s61, 0
    s_mov_b32 s57, 196736
    buffer_load_dwordx4 v7, s[36:39], s57 offen offset:0 nt lds
    s_mov_b32 s58, 588928
    buffer_load_dwordx4 v7, s[36:39], s58 offen offset:1024 nt lds
    s_mul_i32 s57, s30, 6144
    s_add_u32 m0, s57, 32768
    s_mul_i32 s57, s14, 1
    buffer_load_dwordx4 v5, s[48:51], s57 offen nt lds
    s_waitcnt vmcnt(4)
    ds_read_b64_tr_b16 v[162:163], v8 offset:2048
    ds_read_b64_tr_b16 v[170:171], v9 offset:2048
    ds_read_b64_tr_b16 v[178:179], v10 offset:2048
    ds_read_b64_tr_b16 v[186:187], v11 offset:2048
    s_waitcnt lgkmcnt(0)
    s_add_u32 m0, s61, 2048
    s_mov_b32 s57, 196864
    buffer_load_dwordx4 v7, s[36:39], s57 offen offset:0 nt lds
    s_mov_b32 s58, 589056
    buffer_load_dwordx4 v7, s[36:39], s58 offen offset:1024 nt lds
    s_mul_i32 s57, s30, 6144
    s_add_u32 m0, s57, 33792
    s_mul_i32 s57, s14, 1
    s_add_u32 s57, s57, s15
    buffer_load_dwordx4 v5, s[48:51], s57 offen nt lds
    s_cmp_eq_u32 s30, 6
    s_cbranch_scc0 L_skip_23
    v_lshlrev_b32 v2, 4, v0
    v_add_u32 v2, 124928, v2
    ds_read_b128 v[24:27], v2
    s_waitcnt lgkmcnt(0)
L_cw_24:
    v_max3_u32 v28, v24, v25, v26
    v_max_u32 v28, v28, v27
    v_cmp_eq_u32 vcc, -1, v28
    s_cbranch_vccnz L_cr_25
    v_xor_b32 v24, s63, v24
    v_xor_b32 v25, s63, v25
    v_xor_b32 v26, s63, v26
    v_xor_b32 v27, s63, v27
    v_or3_b32 v24, v24, v25, v26
    v_or_b32 v24, v24, v27
    v_cmp_ne_u32 vcc, 0, v24
    s_lshl_b32 s57, s31, 3
    s_lshr_b64 vcc, vcc, s57
    s_and_b32 s57, vcc_lo, 0xff
    s_cselect_b32 s57, 0, 1
    v_mov_b32 v37, 130112
    v_mov_b32 v38, s57
    ds_write_b32 v37, v38
L_skip_23:
    s_waitcnt vmcnt(4)
    ds_read_b64_tr_b16 v[194:195], v8 offset:0
    ds_read_b64_tr_b16 v[202:203], v9 offset:0
    ds_read_b64_tr_b16 v[210:211], v10 offset:0
    ds_read_b64_tr_b16 v[218:219], v11 offset:0
    s_waitcnt lgkmcnt(0)
    s_add_u32 m0, s61, 0
    s_mov_b32 s57, 786432
    buffer_load_dwordx4 v7, s[36:39], s57 offen offset:0 nt lds
    s_mov_b32 s58, 1178624
    buffer_load_dwordx4 v7, s[36:39], s58 offen offset:1024 nt lds
    v_or_b32 v5, s3, v5
    s_mul_i32 s57, s30, 6144
    s_add_u32 m0, s57, 34816
    s_mul_i32 s57, s14, 2
    buffer_load_dwordx4 v5, s[48:51], s57 offen nt lds
    v_mov_b32 v37, 130112
L_lw_26:
    ds_read_b32 v38, v37
    s_waitcnt lgkmcnt(0)
    v_cmp_eq_u32 vcc, -1, v38
    s_cbranch_vccnz L_lr_27
    v_readfirstlane_b32 s55, v38
    s_cmp_lt_u32 s30, 2
    s_cbranch_scc0 L_skip_28
    v_and_b32 v37, 7, v0
    v_lshlrev_b32 v37, 3, v37
    v_add_u32 v37, 130048, v37
L_lw_29:
    ds_read_b64 v[38:39], v37
    s_waitcnt lgkmcnt(0)
    v_max_u32 v23, v38, v39
    v_cmp_eq_u32 vcc, -1, v23
    s_cbranch_vccnz L_lr_30
    s_lshl_b32 s57, s53, 3
    s_add_u32 s57, s57, s54
    s_lshl_b32 s57, s57, 2
    v_mov_b32 v23, s57
    s_add_u32 s57, s62, 37888
    s_waitcnt lgkmcnt(0)
    v_max_f32_dpp v37, v38, v38 row_ror:4 row_mask:0xf bank_mask:0xf
    s_nop 1
    v_max_f32_dpp v37, v37, v37 row_ror:2 row_mask:0xf bank_mask:0xf
    s_nop 1
    v_max_f32_dpp v37, v37, v37 row_ror:1 row_mask:0xf bank_mask:0xf
    v_sub_f32 v38, v38, v37
    v_exp_f32 v38, v38
    s_nop 0
    v_mul_f32 v39, v38, v39
    s_nop 1
    v_add_f32_dpp v39, v39, v39 row_ror:4 row_mask:0xf bank_mask:0xf
    s_nop 1
    v_add_f32_dpp v39, v39, v39 row_ror:2 row_mask:0xf bank_mask:0xf
    s_nop 1
    v_add_f32_dpp v39, v39, v39 row_ror:1 row_mask:0xf bank_mask:0xf
    v_log_f32 v22, v39
    v_rcp_f32 v39, v39
    v_add_f32 v22, v22, v37
    v_min_u32 v22, -2, v22
    v_mul_f32 v38, v38, v39
    s_cmp_eq_u32 s30, 0
    s_cbranch_scc0 L_skip_31
    s_mov_b64 exec, 0x1
    s_cmp_eq_u32 s55, 0
    s_cbranch_scc1 L_gs_32
    buffer_store_dword v22, v23, s[40:43], s57 offen
L_gb_33:
    s_mov_b64 exec, -1
L_skip_31:
    v_readlane_b32 s64, v38, 0
    v_readlane_b32 s65, v38, 1
    v_readlane_b32 s66, v38, 2
    v_readlane_b32 s67, v38, 3
    v_readlane_b32 s68, v38, 4
    v_readlane_b32 s69, v38, 5
    v_readlane_b32 s70, v38, 6
    v_readlane_b32 s71, v38, 7
    s_mul_i32 s57, s30, 48
    v_add_u32 v38, s57, v0
    v_bfe_u32 v20, v38, 5, 2
    v_lshlrev_b32 v20, 8, v20
    v_and_b32 v39, 15, v38
    v_lshl_add_u32 v20, v39, 4, v20
    v_bfe_u32 v39, v38, 4, 1
    v_lshl_add_u32 v20, v39, 3, v20
    v_add_u32 v20, 92160, v20
    s_lshr_b32 s57, s54, 1
    s_lshl_b32 s57, s57, 2
    s_and_b32 s58, s54, 1
    s_add_u32 s57, s57, s58
    s_lshl_b32 s58, s57, 4
    s_lshl_b32 s57, s57, 3
    v_bfe_u32 v21, v0, 3, 2
    v_lshlrev_b32 v21, 8, v21
    v_bfe_u32 v39, v0, 2, 1
    v_lshl_add_u32 v21, v39, 5, v21
    v_and_b32 v39, 3, v0
    v_lshl_add_u32 v21, v39, 2, v21
    v_add_u32 v21, s58, v21
    v_bfe_u32 v38, v0, 3, 1
    v_lshlrev_b32 v38, 8, v38
    v_bfe_u32 v39, v0, 1, 1
    v_lshl_add_u32 v38, v39, 7, v38
    v_bfe_u32 v39, v0, 2, 1
    v_lshl_add_u32 v38, v39, 4, v38
    v_and_b32 v39, 1, v0
    v_lshl_add_u32 v38, v39, 2, v38
    v_add_u32 v38, s57, v38
    v_add_u32 v38, 1024, v38
    v_cmp_gt_u32 vcc, 32, v0
    s_nop 1
    v_cndmask_b32 v21, v38, v21, vcc
    s_lshl_b32 s57, s53, 1
    s_add_u32 s57, s57, s30
    s_mul_i32 s57, s57, 1536
    s_add_u32 s57, s57, s62
    s_add_u32 s57, s57, 0
    v_add_u32 v21, s57, v21
L_skip_28:
    s_waitcnt vmcnt(4)
    ds_read_b64_tr_b16 v[226:227], v8 offset:2048
    ds_read_b64_tr_b16 v[234:235], v9 offset:2048
    ds_read_b64_tr_b16 v[242:243], v10 offset:2048
    ds_read_b64_tr_b16 v[250:251], v11 offset:2048
    s_waitcnt lgkmcnt(0)
    s_add_u32 m0, s61, 2048
    s_mov_b32 s57, 786560
    buffer_load_dwordx4 v7, s[36:39], s57 offen offset:0 nt lds
    s_mov_b32 s58, 1178752
    buffer_load_dwordx4 v7, s[36:39], s58 offen offset:1024 nt lds
    s_mul_i32 s57, s30, 6144
    s_add_u32 m0, s57, 35840
    s_mul_i32 s57, s14, 2
    s_add_u32 s57, s57, s15
    buffer_load_dwordx4 v5, s[48:51], s57 offen nt lds
    s_waitcnt vmcnt(4)
    ds_read_b64_tr_b16 v[164:165], v8 offset:0
    ds_read_b64_tr_b16 v[172:173], v9 offset:0
    ds_read_b64_tr_b16 v[180:181], v10 offset:0
    ds_read_b64_tr_b16 v[188:189], v11 offset:0
    s_waitcnt lgkmcnt(0)
    s_add_u32 m0, s61, 0
    s_mov_b32 s57, 786688
    buffer_load_dwordx4 v7, s[36:39], s57 offen offset:0 nt lds
    s_mov_b32 s58, 1178880
    buffer_load_dwordx4 v7, s[36:39], s58 offen offset:1024 nt lds
    s_waitcnt vmcnt(3)
    ds_read_b64_tr_b16 v[196:197], v8 offset:2048
    ds_read_b64_tr_b16 v[204:205], v9 offset:2048
    ds_read_b64_tr_b16 v[212:213], v10 offset:2048
    ds_read_b64_tr_b16 v[220:221], v11 offset:2048
    s_waitcnt lgkmcnt(0)
    s_add_u32 m0, s61, 2048
    s_mov_b32 s57, 983040
    buffer_load_dwordx4 v7, s[36:39], s57 offen offset:0 nt lds
    s_mov_b32 s58, 1375232
    buffer_load_dwordx4 v7, s[36:39], s58 offen offset:1024 nt lds
    s_cmp_eq_u32 s30, 2
    s_cbranch_scc0 L_skip_34
    s_mul_i32 s57, s52, 1280
    s_add_u32 s57, s57, s62
    v_min_u32 v37, 9, v0
    v_lshlrev_b32 v37, 7, v37
    buffer_load_dword v37, v37, s[40:43], s57 offen sc1
L_skip_34:
    s_waitcnt vmcnt(2)
    ds_read_b64_tr_b16 v[228:229], v8 offset:0
    ds_read_b64_tr_b16 v[236:237], v9 offset:0
    ds_read_b64_tr_b16 v[244:245], v10 offset:0
    ds_read_b64_tr_b16 v[252:253], v11 offset:0
    s_waitcnt lgkmcnt(0)
    s_add_u32 m0, s61, 0
    s_mov_b32 s57, 983168
    buffer_load_dwordx4 v7, s[36:39], s57 offen offset:0 nt lds
    s_mov_b32 s58, 1375360
    buffer_load_dwordx4 v7, s[36:39], s58 offen offset:1024 nt lds
    s_branch L_tail
.p2align 10
L_tail:
L_pad0:
    s_cbranch_execz L_pad1
    s_waitcnt vmcnt(2)
    ds_read_b64_tr_b16 v[166:167], v8 offset:2048
    ds_read_b64_tr_b16 v[174:175], v9 offset:2048
    ds_read_b64_tr_b16 v[182:183], v10 offset:2048
    ds_read_b64_tr_b16 v[190:191], v11 offset:2048
    s_waitcnt lgkmcnt(0)
    s_add_u32 m0, s61, 2048
    s_mov_b32 s57, 983296
    buffer_load_dwordx4 v7, s[36:39], s57 offen offset:0 nt lds
    s_mov_b32 s58, 1375488
    buffer_load_dwordx4 v7, s[36:39], s58 offen offset:1024 nt lds
    v_smfmac_f32_16x16x64_bf16 v[40:43], v[12:15], v[160:167], v1
    v_smfmac_f32_16x16x64_bf16 v[40:43], v[16:19], v[168:175], v1
    v_smfmac_f32_16x16x64_bf16 v[44:47], v[12:15], v[176:183], v1
    v_smfmac_f32_16x16x64_bf16 v[44:47], v[16:19], v[184:191], v1
    s_nop 5
    v_pk_add_f32 v[24:25], v[40:41], v[42:43]
    s_nop 0
    v_pk_add_f32 v[26:27], v[44:45], v[46:47]
    s_waitcnt vmcnt(2)
    ds_read_b64_tr_b16 v[198:199], v8 offset:0
    ds_read_b64_tr_b16 v[206:207], v9 offset:0
    ds_read_b64_tr_b16 v[214:215], v10 offset:0
    ds_read_b64_tr_b16 v[222:223], v11 offset:0
    s_waitcnt lgkmcnt(0)
    v_smfmac_f32_16x16x64_bf16 v[48:51], v[12:15], v[192:199], v1
    v_smfmac_f32_16x16x64_bf16 v[48:51], v[16:19], v[200:207], v1
    v_smfmac_f32_16x16x64_bf16 v[52:55], v[12:15], v[208:215], v1
    v_smfmac_f32_16x16x64_bf16 v[52:55], v[16:19], v[216:223], v1
    s_nop 5
    v_pk_add_f32 v[28:29], v[48:49], v[50:51]
    s_nop 0
    v_pk_add_f32 v[30:31], v[52:53], v[54:55]
    s_waitcnt vmcnt(0)
    ds_read_b64_tr_b16 v[230:231], v8 offset:2048
    ds_read_b64_tr_b16 v[238:239], v9 offset:2048
    ds_read_b64_tr_b16 v[246:247], v10 offset:2048
    ds_read_b64_tr_b16 v[254:255], v11 offset:2048
    s_waitcnt lgkmcnt(0)
    v_smfmac_f32_16x16x64_bf16 v[56:59], v[12:15], v[224:231], v1
    v_smfmac_f32_16x16x64_bf16 v[56:59], v[16:19], v[232:239], v1
    v_smfmac_f32_16x16x64_bf16 v[60:63], v[12:15], v[240:247], v1
    v_smfmac_f32_16x16x64_bf16 v[60:63], v[16:19], v[248:255], v1
    s_nop 5
    v_pk_add_f32 v[32:33], v[56:57], v[58:59]
    s_nop 0
    v_pk_add_f32 v[34:35], v[60:61], v[62:63]
    s_mov_b64 exec, 0xffff
    ds_write_b128 v36, v[24:27] offset:0
    ds_write_b128 v36, v[28:31] offset:256
    ds_write_b128 v36, v[32:35] offset:512
    s_mov_b64 exec, -1
    s_waitcnt lgkmcnt(0)
L_b2_0:
    s_barrier
    s_cmp_lt_u32 s30, 2
    s_cbranch_scc0 L_skip_35
    s_mov_b32 exec_lo, 0xffffffff
    s_mov_b32 exec_hi, 0xffff
    ds_read_b64 v[40:41], v20 offset:0
    ds_read_b64 v[42:43], v20 offset:4096
    ds_read_b64 v[44:45], v20 offset:8192
    ds_read_b64 v[46:47], v20 offset:12288
    ds_read_b64 v[48:49], v20 offset:16384
    ds_read_b64 v[50:51], v20 offset:20480
    ds_read_b64 v[52:53], v20 offset:24576
    ds_read_b64 v[54:55], v20 offset:28672
    s_waitcnt lgkmcnt(7)
    v_mul_f32 v56, s64, v40
    v_mul_f32 v57, s64, v41
    s_waitcnt lgkmcnt(6)
    v_fmac_f32 v56, s65, v42
    v_fmac_f32 v57, s65, v43
    s_waitcnt lgkmcnt(5)
    v_fmac_f32 v56, s66, v44
    v_fmac_f32 v57, s66, v45
    s_waitcnt lgkmcnt(4)
    v_fmac_f32 v56, s67, v46
    v_fmac_f32 v57, s67, v47
    s_waitcnt lgkmcnt(3)
L_pad1:
    s_cbranch_execz L_pad2
    v_fmac_f32 v56, s68, v48
    v_fmac_f32 v57, s68, v49
    s_waitcnt lgkmcnt(2)
    v_fmac_f32 v56, s69, v50
    v_fmac_f32 v57, s69, v51
    s_waitcnt lgkmcnt(1)
    v_fmac_f32 v56, s70, v52
    v_fmac_f32 v57, s70, v53
    s_waitcnt lgkmcnt(0)
    v_fmac_f32 v56, s71, v54
    v_fmac_f32 v57, s71, v55
    v_cvt_pk_bf16_f32 v56, v56, v57
    v_min_u32 v56, -2, v56
    s_cmp_eq_u32 s55, 0
    s_cbranch_scc1 L_gs_36
    buffer_store_dword v56, v21, s[40:43], 0 offen
L_gb_37:
    s_mov_b64 exec, -1
L_skip_35:
    s_cmp_lt_u32 s52, 20
    s_cbranch_scc0 L_typeB_0
    s_lshr_b32 s57, s30, 1
    s_lshl_b32 s57, s57, 5
    s_add_u32 s57, s57, s62
    s_add_u32 s59, s57, 37888
    v_and_b32 v5, 7, v0
    v_lshlrev_b32 v5, 2, v5
    v_lshrrev_b32 v22, 4, v0
    v_lshlrev_b32 v22, 3, v22
    buffer_load_dword v18, v5, s[40:43], s59 offen sc1
    buffer_load_dwordx2 v[20:21], v22, s[40:43], s59 offen sc1
    s_mul_i32 s57, s30, 6144
    v_lshrrev_b32 v7, 2, v0
    v_lshlrev_b32 v7, 6, v7
    v_bfe_u32 v60, v0, 4, 1
    v_lshl_add_u32 v7, v60, 5, v7
    v_and_b32 v60, 3, v0
    v_lshl_add_u32 v7, v60, 3, v7
    v_add_u32 v7, s57, v7
    v_add_u32 v7, 30720, v7
    v_xor_b32 v8, 32, v7
    s_mul_i32 s60, s30, 1536
    s_add_u32 s60, s60, s62
    s_add_u32 s60, s60, 0
    v_lshlrev_b32 v9, 4, v0
    v_lshlrev_b32 v10, 3, v0
    s_waitcnt vmcnt(2)
    ds_read_b64_tr_b16 v[36:37], v7 offset:0
    ds_read_b64_tr_b16 v[38:39], v7 offset:1024
    ds_read_b64_tr_b16 v[40:41], v7 offset:2048
    ds_read_b64_tr_b16 v[42:43], v7 offset:3072
    ds_read_b64_tr_b16 v[44:45], v7 offset:4096
    ds_read_b64_tr_b16 v[46:47], v7 offset:5120
    ds_read_b64_tr_b16 v[48:49], v8 offset:0
    ds_read_b64_tr_b16 v[50:51], v8 offset:1024
    ds_read_b64_tr_b16 v[52:53], v8 offset:2048
    ds_read_b64_tr_b16 v[54:55], v8 offset:3072
    ds_read_b64_tr_b16 v[56:57], v8 offset:4096
    ds_read_b64_tr_b16 v[58:59], v8 offset:5120
    v_mov_b64 v[24:25], 0
    v_mov_b64 v[26:27], 0
    v_mov_b64 v[28:29], 0
    v_mov_b64 v[30:31], 0
    s_lshl_b32 s57, s30, 8
    v_lshlrev_b32 v11, 2, v0
    v_add_u32 v11, s57, v11
    v_add_u32 v11, 124928, v11
    s_waitcnt vmcnt(0)
L_pw_38:
    v_max3_u32 v19, v18, v20, v21
    v_cmp_eq_u32 vcc, -1, v19
    s_cbranch_vccnz L_pr_39
    buffer_load_dwordx4 v[12:15], v9, s[40:43], s60 offen sc1
    buffer_load_dwordx2 v[16:17], v10, s[40:43], s60 offen offset:1024 sc1
    v_max_f32_dpp v19, v18, v18 row_ror:4 row_mask:0xf bank_mask:0xf
    s_nop 1
    v_max_f32_dpp v19, v19, v19 row_ror:2 row_mask:0xf bank_mask:0xf
    s_nop 1
    v_max_f32_dpp v19, v19, v19 row_ror:1 row_mask:0xf bank_mask:0xf
    v_sub_f32 v18, v18, v19
    v_sub_f32 v20, v20, v19
    v_sub_f32 v21, v21, v19
    v_exp_f32 v18, v18
    v_exp_f32 v20, v20
    v_exp_f32 v21, v21
    v_add_f32_dpp v18, v18, v18 row_ror:4 row_mask:0xf bank_mask:0xf
    s_nop 1
    v_add_f32_dpp v18, v18, v18 row_ror:2 row_mask:0xf bank_mask:0xf
    s_nop 1
    v_add_f32_dpp v18, v18, v18 row_ror:1 row_mask:0xf bank_mask:0xf
    v_rcp_f32 v18, v18
    s_nop 0
    v_mul_f32 v20, v20, v18
    v_mul_f32 v21, v21, v18
    s_waitcnt lgkmcnt(0)
    s_waitcnt vmcnt(0)
L_pw_40:
    v_max3_u32 v19, v12, v13, v14
L_pad2:
    s_cbranch_execz L_pad3
    v_max3_u32 v19, v19, v15, v16
    v_max_u32 v19, v19, v17
    v_cmp_eq_u32 vcc, -1, v19
    s_cbranch_vccnz L_pr_41
    v_smfmac_f32_16x16x64_bf16 v[24:27], v[12:15], v[36:43], v1
    v_smfmac_f32_16x16x64_bf16 v[28:31], v[12:15], v[48:55], v1
    v_smfmac_f32_16x16x32_bf16 v[24:27], v[16:17], v[44:47], v1
    v_smfmac_f32_16x16x32_bf16 v[28:31], v[16:17], v[56:59], v1
    s_nop 6
    v_pk_add_f32 v[24:25], v[24:25], v[26:27]
    v_pk_add_f32 v[28:29], v[28:29], v[30:31]
    v_mul_f32 v24, v24, v20
    v_mul_f32 v28, v28, v20
    v_fmac_f32 v24, v25, v21
    v_fmac_f32 v28, v29, v21
    s_nop 1
    v_permlane32_swap_b32 v24, v28
    v_add_f32 v24, v24, v28
    ds_write_b32 v11, v24
    v_lshlrev_b32 v5, 2, v0
    v_add_u32 v5, 124928, v5
    s_mul_i32 s59, s31, 2560
    s_lshl_b32 s58, s52, 7
    s_add_u32 s59, s59, s58
    s_add_u32 s59, s59, 327616
    v_lshlrev_b32 v9, 2, v0
    s_waitcnt lgkmcnt(0)
    s_barrier
    s_cmp_eq_u32 s30, 2
    s_cbranch_scc0 L_skip_42
    ds_read2st64_b32 v[12:13], v5 offset0:0 offset1:1
    ds_read2st64_b32 v[14:15], v5 offset0:2 offset1:3
    ds_read2st64_b32 v[16:17], v5 offset0:4 offset1:5
    ds_read2st64_b32 v[18:19], v5 offset0:6 offset1:7
    s_waitcnt lgkmcnt(2)
    v_pk_add_f32 v[12:13], v[12:13], v[14:15]
    s_waitcnt lgkmcnt(0)
    v_pk_add_f32 v[16:17], v[16:17], v[18:19]
    v_pk_add_f32 v[12:13], v[12:13], v[16:17]
    v_add_f32 v12, v12, v13
    v_mov_b32 v13, v12
    s_nop 1
    v_permlane16_swap_b32 v12, v13
    v_add_f32 v12, v12, v13
    v_min_u32 v12, -2, v12
    s_mov_b32 exec_lo, 0xffff0000
    s_mov_b32 exec_hi, 0xffff
    buffer_store_dword v12, v9, s[40:43], s59 offen sc1
    s_lshl_b32 s57, s52, 2
    s_add_u32 s57, s57, s62
    s_add_u32 s57, s57, 38144
    s_mov_b64 exec, 0x1
    s_cmp_eq_u32 s55, 0
    s_cbranch_scc1 L_gs_43
    buffer_store_dword v0, v0, s[40:43], s57 offen
L_gb_44:
    s_mov_b64 exec, -1
L_skip_42:
    s_sub_u32 s57, s30, 5
    s_cmp_lt_u32 s57, 2
    s_cbranch_scc0 L_skip_45
    s_sub_u32 s60, s30, 5
    s_mul_i32 s59, s60, 6144
    s_add_u32 s59, s59, 79872
    s_mov_b32 s44, s20
    s_mov_b32 s45, s21
    s_mov_b32 s46, 1966080
    s_mov_b32 s47, 0x20000
    s_mul_i32 s57, s31, 245760
    s_lshl_b32 s58, s52, 6
    s_add_u32 s57, s57, s58
    s_lshl_b32 s58, s60, 5
    s_add_u32 s57, s57, s58
    v_lshrrev_b32 v5, 1, v0
    v_mul_u32_u24 v5, 1280, v5
    v_and_b32 v60, 1, v0
    v_lshl_add_u32 v5, v60, 4, v5
    v_add_u32 v5, s57, v5
    s_add_u32 m0, s59, 0
    s_mov_b32 s57, 0
    buffer_load_dwordx4 v5, s[44:47], s57 offen nt lds
    s_add_u32 m0, s59, 1024
    s_mov_b32 s57, 40960
    buffer_load_dwordx4 v5, s[44:47], s57 offen nt lds
    s_add_u32 m0, s59, 2048
    s_mov_b32 s57, 81920
    buffer_load_dwordx4 v5, s[44:47], s57 offen nt lds
    s_add_u32 m0, s59, 3072
    s_mov_b32 s57, 122880
L_pad3:
    s_cbranch_execz L_pad4
    buffer_load_dwordx4 v5, s[44:47], s57 offen nt lds
    s_add_u32 m0, s59, 4096
    s_mov_b32 s57, 163840
    buffer_load_dwordx4 v5, s[44:47], s57 offen nt lds
    s_add_u32 m0, s59, 5120
    s_mov_b32 s57, 204800
    buffer_load_dwordx4 v5, s[44:47], s57 offen nt lds
    v_lshrrev_b32 v7, 5, v0
    v_lshlrev_b32 v7, 9, v7
    v_bfe_u32 v60, v0, 4, 1
    v_lshl_add_u32 v7, v60, 7, v7
    v_bfe_u32 v60, v0, 3, 1
    v_lshl_add_u32 v7, v60, 8, v7
    v_bfe_u32 v60, v0, 2, 1
    v_lshl_add_u32 v7, v60, 5, v7
    v_and_b32 v60, 3, v0
    v_lshl_add_u32 v7, v60, 3, v7
    v_add_u32 v7, s59, v7
    s_add_u32 s59, s62, 37120
    v_lshrrev_b32 v5, 4, v0
    v_lshlrev_b32 v5, 5, v5
    v_bfe_u32 v60, v0, 1, 1
    v_lshl_add_u32 v5, v60, 4, v5
    v_mov_b64 v[24:25], 0
    v_mov_b64 v[26:27], 0
    s_mul_i32 s57, s31, 2560
    s_lshl_b32 s58, s52, 7
    s_add_u32 s57, s57, s58
    s_lshl_b32 s60, s60, 6
    s_add_u32 s60, s60, s57
    s_add_u32 s60, s60, 348160
    v_lshlrev_b32 v9, 2, v0
    s_waitcnt vmcnt(0)
    ds_read_b64_tr_b16 v[36:37], v7 offset:0
    ds_read_b64_tr_b16 v[38:39], v7 offset:64
    ds_read_b64_tr_b16 v[40:41], v7 offset:1024
    ds_read_b64_tr_b16 v[42:43], v7 offset:1088
    ds_read_b64_tr_b16 v[44:45], v7 offset:2048
    ds_read_b64_tr_b16 v[46:47], v7 offset:2112
    ds_read_b64_tr_b16 v[48:49], v7 offset:3072
    ds_read_b64_tr_b16 v[50:51], v7 offset:3136
    ds_read_b64_tr_b16 v[52:53], v7 offset:4096
    ds_read_b64_tr_b16 v[54:55], v7 offset:4160
    ds_read_b64_tr_b16 v[56:57], v7 offset:5120
    ds_read_b64_tr_b16 v[58:59], v7 offset:5184
    buffer_load_dwordx4 v[12:15], v5, s[40:43], s59 offen offset:0 sc1
    buffer_load_dwordx4 v[16:19], v5, s[40:43], s59 offen offset:128 sc1
    buffer_load_dwordx4 v[20:23], v5, s[40:43], s59 offen offset:256 sc1
    s_waitcnt lgkmcnt(0)
    s_waitcnt vmcnt(0)
L_pw_46:
    v_max3_u32 v28, v12, v13, v14
    v_max3_u32 v28, v28, v15, v16
    v_max3_u32 v28, v28, v17, v18
    v_max3_u32 v28, v28, v19, v20
    v_max3_u32 v28, v28, v21, v22
    v_max_u32 v28, v28, v23
    v_cmp_eq_u32 vcc, -1, v28
    s_cbranch_vccnz L_pr_47
    v_smfmac_f32_16x16x64_bf16 v[24:27], v[12:15], v[36:43], v1
    v_smfmac_f32_16x16x64_bf16 v[24:27], v[16:19], v[44:51], v1
    v_smfmac_f32_16x16x64_bf16 v[24:27], v[20:23], v[52:59], v1
    s_nop 7
    v_add_f32 v24, v24, v26
    v_min_u32 v24, -2, v24
    s_mov_b64 exec, 0xffff
    buffer_store_dword v24, v9, s[40:43], s60 offen sc1
    s_cmp_eq_u32 s30, 6
    s_cbranch_scc0 L_skip_48
    s_lshl_b32 s57, s52, 2
    s_add_u32 s57, s57, s62
    s_add_u32 s57, s57, 38272
    s_mov_b64 exec, 0x1
    s_cmp_eq_u32 s55, 0
    s_cbranch_scc1 L_gs_49
    buffer_store_dword v0, v0, s[40:43], s57 offen
L_gb_50:
    s_mov_b64 exec, -1
L_skip_48:
    s_mov_b64 exec, -1
L_skip_45:
    s_branch L_p1
L_typeB_0:
    s_cmp_lt_u32 s30, 5
    s_cbranch_scc0 L_skip_51
    s_waitcnt vmcnt(0)
L_pad4:
    s_cbranch_execz L_pad5
    s_mul_i32 s57, s30, 6144
    v_lshrrev_b32 v10, 4, v0
    v_lshlrev_b32 v10, 10, v10
    v_bfe_u32 v60, v0, 3, 1
    v_lshl_add_u32 v10, v60, 8, v10
    v_bfe_u32 v60, v0, 1, 1
    v_lshl_add_u32 v10, v60, 7, v10
    v_bfe_u32 v60, v0, 2, 1
    v_lshl_add_u32 v10, v60, 5, v10
    v_and_b32 v60, 1, v0
    v_lshl_add_u32 v10, v60, 3, v10
    v_add_u32 v10, s57, v10
    v_add_u32 v10, 30720, v10
    ds_read_b64_tr_b16 v[36:37], v10 offset:0
    ds_read_b64_tr_b16 v[38:39], v10 offset:512
    ds_read_b64_tr_b16 v[40:41], v10 offset:64
    ds_read_b64_tr_b16 v[42:43], v10 offset:576
    ds_read_b64_tr_b16 v[44:45], v10 offset:16
    ds_read_b64_tr_b16 v[46:47], v10 offset:528
    ds_read_b64_tr_b16 v[48:49], v10 offset:80
    ds_read_b64_tr_b16 v[50:51], v10 offset:592
    s_lshl_b32 s57, s30, 10
    v_lshlrev_b32 v11, 4, v0
    v_add_u32 v11, s57, v11
    v_add_u32 v11, 124928, v11
    v_mov_b32 v32, 0x3f803f80
    v_mov_b32 v33, 0x3f803f80
    v_mov_b32 v34, 0x3f803f80
    v_mov_b32 v35, 0x3f803f80
    v_mov_b32 v61, 0x3f803f80
    s_lshl_b32 s57, s30, 9
    v_lshrrev_b32 v5, 5, v0
    v_mul_u32_u24 v5, 2560, v5
    v_and_b32 v60, 31, v0
    v_lshl_add_u32 v5, v60, 4, v5
    v_add_u32 v5, s57, v5
    s_add_u32 s57, s62, 38144
    v_min_u32 v9, 19, v0
    v_lshlrev_b32 v9, 2, v9
    buffer_load_dword v12, v9, s[40:43], s57 offen sc1
    s_waitcnt vmcnt(0)
L_pw_52:
    v_cmp_eq_u32 vcc, -1, v12
    s_cbranch_vccnz L_pr_53
    s_mov_b32 s57, 327680
    buffer_load_dwordx4 v[12:15], v5, s[40:43], s57 offen sc1
    s_mov_b32 s58, 332800
    buffer_load_dwordx4 v[16:19], v5, s[40:43], s58 offen sc1
    s_mov_b32 s59, 337920
    buffer_load_dwordx4 v[20:23], v5, s[40:43], s59 offen sc1
    s_mov_b32 s60, 343040
    buffer_load_dwordx4 v[24:27], v5, s[40:43], s60 offen sc1
L_gw_54:
    s_waitcnt vmcnt(2)
    v_pk_add_f32 v[28:29], v[12:13], v[16:17]
    v_pk_add_f32 v[30:31], v[14:15], v[18:19]
    s_waitcnt vmcnt(1)
    v_pk_add_f32 v[28:29], v[28:29], v[20:21]
    v_pk_add_f32 v[30:31], v[30:31], v[22:23]
    s_waitcnt vmcnt(0)
    v_pk_add_f32 v[28:29], v[28:29], v[24:25]
    v_pk_add_f32 v[30:31], v[30:31], v[26:27]
    s_nop 1
    v_permlane32_swap_b32 v28, v30
    v_permlane32_swap_b32 v29, v31
    v_pk_add_f32 v[28:29], v[28:29], v[30:31]
    v_pk_add_f32 v[28:29], v[28:29], v[2:3]
    v_cmp_u_f32 vcc, v28, v29
    s_cbranch_vccnz L_gr_55
L_gk_56:
    v_cvt_pk_bf16_f32 v28, v28, v29
    v_mov_b64 v[12:13], 0
    v_mov_b64 v[14:15], 0
    v_mov_b32_dpp v32, v28 quad_perm:[0,1,2,3] row_mask:0xf bank_mask:0x1
    v_mov_b32_dpp v33, v28 row_shl:4 row_mask:0xf bank_mask:0x1
    v_mov_b32_dpp v34, v28 row_shl:8 row_mask:0xf bank_mask:0x1
    v_mov_b32_dpp v35, v28 row_shl:12 row_mask:0xf bank_mask:0x1
    v_dot2_f32_bf16 v27, v28, v61, 0
    v_dot2_f32_bf16 v62, v28, v28, 0
    s_waitcnt lgkmcnt(0)
L_pad5:
    s_cbranch_execz L_pad6
    v_smfmac_f32_16x16x64_bf16 v[12:15], v[32:35], v[36:43], v1
    v_mov_b64 v[16:17], 0
    v_mov_b64 v[18:19], 0
    v_permlane32_swap_b32 v27, v62
    s_nop 0
    v_smfmac_f32_16x16x64_bf16 v[16:19], v[32:35], v[44:51], v1
    v_add_f32 v27, v27, v62
    v_mov_b32 v62, v27
    s_nop 1
    v_permlane16_swap_b32 v27, v62
    v_add_f32 v27, v27, v62
    v_lshlrev_b32 v2, 16, v28
    v_and_b32 v3, 0xffff0000, v28
    v_add_f32_dpp v27, v27, v27 row_ror:8 row_mask:0xf bank_mask:0xf
    v_pk_add_f32 v[12:13], v[12:13], v[14:15]
    v_pk_add_f32 v[16:17], v[16:17], v[18:19]
    v_add_f32_dpp v27, v27, v27 row_ror:4 row_mask:0xf bank_mask:0xf
    v_add_f32_dpp v24, v13, v12 row_shl:8 row_mask:0xf bank_mask:0xf bound_ctrl:0
    v_add_f32_dpp v25, v17, v16 row_shl:8 row_mask:0xf bank_mask:0xf bound_ctrl:0
    v_add_f32_dpp v27, v27, v27 row_ror:2 row_mask:0xf bank_mask:0xf
    s_nop 1
    v_add_f32_dpp v27, v27, v27 row_ror:1 row_mask:0xf bank_mask:0xf
    ds_write_b128 v11, v[24:27]
    s_waitcnt lgkmcnt(0)
L_skip_51:
    s_cmp_eq_u32 s30, 5
    s_cbranch_scc0 L_skip_61
    v_and_b32 v10, 7, v0
    v_lshlrev_b32 v10, 4, v10
    v_bfe_u32 v60, v0, 3, 2
    v_lshl_add_u32 v10, v60, 2, v10
    v_lshrrev_b32 v60, 5, v0
    v_lshl_add_u32 v10, v60, 8, v10
    v_add_u32 v10, 124928, v10
    v_mov_b32 v60, 125452
    v_cmp_eq_u32 vcc, 25, v0
    s_nop 1
    v_cndmask_b32 v10, v10, v60, vcc
    s_sub_u32 s59, s52, 20
    s_lshl_b32 s59, s59, 5
    s_add_u32 s59, s59, s62
    s_add_u32 s59, s59, 37120
    v_lshlrev_b32 v11, 1, v0
    v_mov_b32 v18, 0xc0135761
    v_mov_b32 v19, 0xbdd2d3e8
L_skip_61:
    s_barrier
    s_cmp_eq_u32 s30, 5
    s_cbranch_scc0 L_skip_62
    ds_read2st64_b32 v[12:13], v10 offset0:0 offset1:4
    ds_read2st64_b32 v[14:15], v10 offset0:8 offset1:12
    ds_read_b32 v16, v10 offset:4096
    s_waitcnt lgkmcnt(1)
    v_pk_add_f32 v[12:13], v[12:13], v[14:15]
    s_waitcnt lgkmcnt(0)
    v_add_f32 v12, v12, v16
    v_add_f32 v12, v12, v13
    v_mov_b32 v14, 0x3acccccd
    v_readlane_b32 s57, v12, 24
    v_readlane_b32 s58, v12, 25
    v_permlane32_swap_b32 v12, v13
    v_mul_f32 v15, s57, v14
    v_mul_f32 v16, s58, v14
    v_fma_f32 v16, -v15, v15, v16
    v_max_f32 v16, 0, v16
    v_add_f32 v16, 0x3727c5ac, v16
    v_rsq_f32 v16, v16
    v_fma_f32 v12, -v15, v13, v12
    v_mul_f32 v12, v12, v16
    v_add_f32 v12, v12, v4
    v_mul_f32 v13, v12, v12
    v_fma_f32 v13, v13, v19, v18
    v_mul_f32 v13, v13, v12
    v_exp_f32 v13, v13
    s_nop 0
    v_add_f32 v13, 1.0, v13
    v_rcp_f32 v13, v13
    s_nop 0
    v_mul_f32 v12, v12, v13
    s_nop 1
    v_mov_b32_dpp v13, v12 row_shl:1 row_mask:0xf bank_mask:0xf bound_ctrl:0
    v_cvt_pk_bf16_f32 v12, v12, v13
    v_min_u32 v12, -2, v12
    s_mov_b64 exec, 0x5555
    s_cmp_eq_u32 s55, 0
    s_cbranch_scc1 L_gs_63
    buffer_store_dword v12, v11, s[40:43], s59 offen
L_gb_64:
    s_mov_b64 exec, -1
L_skip_62:
L_p1:
    s_cmp_lt_u32 s30, 6
    s_cbranch_scc0 L_skip_65
    s_lshr_b32 s57, s30, 1
    s_lshl_b32 s57, s57, 10
    s_and_b32 s58, s30, 1
    s_lshl_b32 s58, s58, 6
L_pad6:
    s_cbranch_execz L_pad7
    s_add_u32 s57, s57, s58
    v_lshrrev_b32 v10, 5, v0
    v_mul_u32_u24 v10, 6144, v10
    v_bfe_u32 v60, v0, 3, 1
    v_mul_u32_u24 v60, 3072, v60
    v_add_u32 v10, v60, v10
    v_bfe_u32 v60, v0, 4, 1
    v_lshl_add_u32 v10, v60, 9, v10
    v_bfe_u32 v60, v0, 2, 1
    v_lshl_add_u32 v10, v60, 7, v10
    v_and_b32 v60, 3, v0
    v_lshl_add_u32 v10, v60, 3, v10
    v_add_u32 v10, s57, v10
    v_bfe_u32 v11, v0, 4, 1
    v_mul_u32_u24 v11, 3072, v11
    v_bfe_u32 v60, v0, 3, 1
    v_lshl_add_u32 v11, v60, 9, v11
    v_bfe_u32 v60, v0, 2, 1
    v_lshl_add_u32 v11, v60, 7, v11
    v_and_b32 v60, 3, v0
    v_lshl_add_u32 v11, v60, 3, v11
    v_add_u32 v11, s57, v11
    v_add_u32 v11, 24576, v11
    ds_read_b64_tr_b16 v[36:37], v10 offset:0
    ds_read_b64_tr_b16 v[38:39], v10 offset:256
    ds_read_b64_tr_b16 v[40:41], v10 offset:12288
    ds_read_b64_tr_b16 v[42:43], v10 offset:12544
    ds_read_b64_tr_b16 v[44:45], v11 offset:0
    ds_read_b64_tr_b16 v[46:47], v11 offset:256
    ds_read_b64_tr_b16 v[48:49], v10 offset:32
    ds_read_b64_tr_b16 v[50:51], v10 offset:288
    ds_read_b64_tr_b16 v[52:53], v10 offset:12320
    ds_read_b64_tr_b16 v[54:55], v10 offset:12576
    ds_read_b64_tr_b16 v[56:57], v11 offset:32
    ds_read_b64_tr_b16 v[58:59], v11 offset:288
    v_lshrrev_b32 v32, 4, v0
    v_lshlrev_b32 v32, 5, v32
    v_bfe_u32 v60, v0, 1, 1
    v_lshl_add_u32 v32, v60, 4, v32
    v_and_b32 v60, 1, v0
    v_mul_u32_u24 v60, 192, v60
    v_add_u32 v32, v60, v32
    v_add_u32 v32, 130176, v32
    v_lshrrev_b32 v33, 4, v0
    v_lshlrev_b32 v33, 4, v33
    v_bfe_u32 v60, v0, 1, 1
    v_lshl_add_u32 v33, v60, 3, v33
    v_and_b32 v60, 1, v0
    v_mul_u32_u24 v60, 192, v60
    v_add_u32 v33, v60, v33
    v_add_u32 v33, 130304, v33
    v_mov_b64 v[24:25], 0
    v_mov_b64 v[26:27], 0
    v_mov_b64 v[28:29], 0
    v_mov_b64 v[30:31], 0
    s_lshr_b32 s57, s54, 1
    s_lshl_b32 s57, s57, 2
    s_and_b32 s58, s54, 1
    s_add_u32 s57, s57, s58
    s_lshl_b32 s57, s57, 4
    s_lshl_b32 s58, s30, 9
    s_add_u32 s57, s57, s58
    v_bfe_u32 v34, v0, 4, 1
    v_lshlrev_b32 v34, 8, v34
    v_bfe_u32 v60, v0, 1, 1
    v_lshl_add_u32 v34, v60, 5, v34
    v_bfe_u32 v60, v0, 2, 2
    v_lshl_add_u32 v34, v60, 2, v34
    v_lshrrev_b32 v60, 5, v0
    v_mul_u32_u24 v60, 3072, v60
    v_add_u32 v34, v60, v34
    v_add_u32 v34, s57, v34
    s_mul_i32 s59, s53, 3072
    s_add_u32 s59, s59, s62
    s_add_u32 s59, s59, 24576
    s_lshl_b32 s60, s53, 6
    s_add_u32 s60, s60, s62
    s_add_u32 s60, s60, 36864
L_skip_65:
    s_cmp_eq_u32 s30, 7
    s_cbranch_scc0 L_skip_66
    v_and_b32 v60, 31, v0
    v_min_u32 v60, 19, v60
L_pad7:
    s_cbranch_execz L_pad8
    s_mul_i32 s57, s54, 320
    v_lshrrev_b32 v5, 5, v0
    v_mul_u32_u24 v5, 2560, v5
    v_add_u32 v5, s57, v5
    v_lshl_add_u32 v5, v60, 4, v5
    v_and_b32 v60, 31, v0
    v_cmp_gt_u32 s[64:65], 20, v60
    v_min_u32 v60, 19, v60
    v_lshrrev_b32 v11, 5, v0
    v_lshlrev_b32 v11, 2, v11
    v_add_u32 v11, 130176, v11
    v_lshl_add_u32 v11, v60, 3, v11
    s_mul_i32 s66, s53, 3072
    s_add_u32 s66, s66, s62
    s_add_u32 s66, s66, 24576
    s_lshl_b32 s67, s53, 6
    s_add_u32 s67, s67, s62
    s_add_u32 s67, s67, 36864
    s_lshl_b32 s57, s54, 3
    v_lshrrev_b32 v10, 5, v0
    v_lshlrev_b32 v10, 2, v10
    v_add_u32 v10, s57, v10
    v_mov_b32 v61, 0x3f803f80
    s_add_u32 s57, s62, 37120
    v_mov_b32 v9, 0
    buffer_load_dword v12, v9, s[40:43], s57 offen sc1
    s_waitcnt vmcnt(0)
L_pw_67:
    v_cmp_eq_u32 vcc, -1, v12
    s_cbranch_vccnz L_pr_68
    s_mov_b32 s57, 327680
    buffer_load_dwordx4 v[12:15], v5, s[40:43], s57 offen sc1
    s_mov_b32 s58, 332800
    buffer_load_dwordx4 v[16:19], v5, s[40:43], s58 offen sc1
    s_mov_b32 s59, 337920
    buffer_load_dwordx4 v[20:23], v5, s[40:43], s59 offen sc1
    s_mov_b32 s60, 343040
    buffer_load_dwordx4 v[24:27], v5, s[40:43], s60 offen sc1
L_gw_69:
    s_waitcnt vmcnt(2)
    v_pk_add_f32 v[28:29], v[12:13], v[16:17]
    v_pk_add_f32 v[30:31], v[14:15], v[18:19]
    s_waitcnt vmcnt(1)
    v_pk_add_f32 v[28:29], v[28:29], v[20:21]
    v_pk_add_f32 v[30:31], v[30:31], v[22:23]
    s_waitcnt vmcnt(0)
    v_pk_add_f32 v[28:29], v[28:29], v[24:25]
    v_pk_add_f32 v[30:31], v[30:31], v[26:27]
    s_nop 1
    v_permlane32_swap_b32 v28, v30
    v_permlane32_swap_b32 v29, v31
    v_pk_add_f32 v[28:29], v[28:29], v[30:31]
    v_pk_add_f32 v[28:29], v[28:29], v[2:3]
    v_cmp_u_f32 vcc, v28, v29
    s_cbranch_vccnz L_gr_70
L_gk_71:
    v_cvt_pk_bf16_f32 v28, v28, v29
    v_lshlrev_b32 v2, 16, v28
    v_and_b32 v3, 0xffff0000, v28
    v_lshlrev_b32 v60, 16, v4
    v_add_f32 v2, v2, v60
    v_and_b32 v60, 0xffff0000, v4
    v_add_f32 v3, v3, v60
    s_add_u32 s57, s62, 38272
    v_min_u32 v9, 19, v0
    v_lshlrev_b32 v9, 2, v9
    buffer_load_dword v12, v9, s[40:43], s57 offen sc1
    s_waitcnt vmcnt(0)
L_pw_76:
    v_cmp_eq_u32 vcc, -1, v12
    s_cbranch_vccnz L_pr_77
    s_mov_b32 s57, 348160
    buffer_load_dwordx4 v[12:15], v5, s[40:43], s57 offen sc1
    s_mov_b32 s58, 353280
    buffer_load_dwordx4 v[16:19], v5, s[40:43], s58 offen sc1
    s_mov_b32 s59, 358400
    buffer_load_dwordx4 v[20:23], v5, s[40:43], s59 offen sc1
    s_mov_b32 s60, 363520
    buffer_load_dwordx4 v[24:27], v5, s[40:43], s60 offen sc1
L_gw_78:
    s_waitcnt vmcnt(2)
    v_pk_add_f32 v[28:29], v[12:13], v[16:17]
    v_pk_add_f32 v[30:31], v[14:15], v[18:19]
    s_waitcnt vmcnt(1)
    v_pk_add_f32 v[28:29], v[28:29], v[20:21]
    v_pk_add_f32 v[30:31], v[30:31], v[22:23]
    s_waitcnt vmcnt(0)
L_pad8:
    s_cbranch_execz L_pad9
    v_pk_add_f32 v[28:29], v[28:29], v[24:25]
    v_pk_add_f32 v[30:31], v[30:31], v[26:27]
    s_nop 1
    v_permlane32_swap_b32 v28, v30
    v_permlane32_swap_b32 v29, v31
    v_pk_add_f32 v[28:29], v[28:29], v[30:31]
    v_pk_add_f32 v[28:29], v[28:29], v[2:3]
    v_cmp_u_f32 vcc, v28, v29
    s_cbranch_vccnz L_gr_79
L_gk_80:
    v_cvt_pk_bf16_f32 v28, v28, v29
    ds_write_b32 v11, v28
    s_waitcnt lgkmcnt(0)
L_skip_66:
    s_barrier
    s_cmp_lt_u32 s30, 6
    s_cbranch_scc0 L_skip_85
    ds_read_b128 v[12:15], v32
    ds_read_b64 v[16:17], v33
    s_waitcnt lgkmcnt(1)
    v_smfmac_f32_16x16x64_bf16 v[24:27], v[12:15], v[36:43], v1
    v_smfmac_f32_16x16x64_bf16 v[28:31], v[12:15], v[48:55], v1
    s_waitcnt lgkmcnt(0)
    v_smfmac_f32_16x16x32_bf16 v[24:27], v[16:17], v[44:47], v1
    v_smfmac_f32_16x16x32_bf16 v[28:31], v[16:17], v[56:59], v1
    s_nop 6
    v_add_f32 v12, v24, v26
    s_nop 1
    v_add_f32_dpp v12, v28, v30 quad_perm:[0,1,2,3] row_mask:0x2 bank_mask:0xf
    s_nop 1
    v_mov_b32_dpp v13, v12 row_shl:1 row_mask:0xf bank_mask:0xf bound_ctrl:0
    v_cvt_pk_bf16_f32 v12, v12, v13
    v_min_u32 v12, -2, v12
    s_mov_b64 exec, 0x55555555
    s_cmp_eq_u32 s55, 0
    s_cbranch_scc1 L_gs_86
    buffer_store_dword v12, v34, s[40:43], s59 offen
L_gb_87:
    s_mov_b64 exec, -1
L_skip_85:
    s_cmp_eq_u32 s30, 7
    s_cbranch_scc0 L_skip_88
    v_lshlrev_b32 v2, 16, v28
    v_and_b32 v3, 0xffff0000, v28
    v_cndmask_b32 v28, 0, v28, s[64:65]
    v_dot2_f32_bf16 v27, v28, v61, 0
    v_dot2_f32_bf16 v62, v28, v28, 0
    s_nop 2
    v_permlane32_swap_b32 v27, v62
    v_add_f32 v27, v27, v62
    v_mov_b32 v62, v27
    s_nop 1
    v_permlane16_swap_b32 v27, v62
    v_add_f32 v27, v27, v62
    s_nop 1
    v_add_f32_dpp v27, v27, v27 row_ror:8 row_mask:0xf bank_mask:0xf
    s_nop 1
    v_add_f32_dpp v27, v27, v27 row_ror:4 row_mask:0xf bank_mask:0xf
    s_nop 1
    v_add_f32_dpp v27, v27, v27 row_ror:2 row_mask:0xf bank_mask:0xf
    s_nop 1
    v_add_f32_dpp v27, v27, v27 row_ror:1 row_mask:0xf bank_mask:0xf
    v_min_u32 v27, -2, v27
    s_mov_b32 exec_lo, 0x1
    s_mov_b32 exec_hi, 0x1
    s_cmp_eq_u32 s55, 0
    s_cbranch_scc1 L_gs_89
    buffer_store_dword v27, v10, s[40:43], s67 offen
L_gb_90:
    s_mov_b64 exec, -1
L_skip_88:
    s_mul_i32 s59, s53, 3072
    s_add_u32 s59, s59, s62
    s_add_u32 s59, s59, 24576
    s_lshl_b32 s60, s53, 6
    s_add_u32 s60, s60, s62
    s_add_u32 s60, s60, 36864
    v_lshlrev_b32 v5, 4, v0
    v_add_u32 v5, s59, v5
    v_and_b32 v7, 7, v0
    v_lshlrev_b32 v7, 3, v7
    v_add_u32 v7, s60, v7
    buffer_load_dwordx2 v[8:9], v7, s[40:43], 0 offen sc1
    buffer_load_dwordx4 v[12:15], v5, s[40:43], 0 offen offset:0 sc1
    buffer_load_dwordx4 v[16:19], v5, s[40:43], 0 offen offset:1024 sc1
    buffer_load_dwordx4 v[20:23], v5, s[40:43], 0 offen offset:2048 sc1
    v_mov_b64 v[24:25], 0
    v_mov_b64 v[26:27], 0
    v_mov_b64 v[28:29], 0
    v_mov_b64 v[30:31], 0
    v_mov_b64 v[32:33], 0
    v_mov_b64 v[34:35], 0
    v_mov_b64 v[36:37], 0
    v_mov_b64 v[38:39], 0
    v_mov_b64 v[40:41], 0
    v_mov_b64 v[42:43], 0
    v_mov_b64 v[44:45], 0
    v_mov_b64 v[46:47], 0
    v_mov_b64 v[48:49], 0
    v_mov_b64 v[50:51], 0
L_pad9:
    s_cbranch_execz L_pad10
    v_mov_b64 v[52:53], 0
    v_mov_b64 v[54:55], 0
    v_mov_b64 v[56:57], 0
    v_mov_b64 v[58:59], 0
    v_mov_b64 v[60:61], 0
    v_mov_b64 v[62:63], 0
    s_lshl_b32 s58, s30, 3
    s_add_u32 s58, s58, 130048
    v_mov_b32 v10, s58
    s_waitcnt vmcnt(0)
L_pw_91:
    v_max3_u32 v11, v8, v9, v12
    v_max3_u32 v11, v11, v13, v14
    v_max3_u32 v11, v11, v15, v16
    v_max3_u32 v11, v11, v17, v18
    v_max3_u32 v11, v11, v19, v20
    v_max3_u32 v11, v11, v21, v22
    v_max_u32 v11, v11, v23
    v_cmp_eq_u32 vcc, -1, v11
    s_cbranch_vccnz L_pr_92
    v_smfmac_f32_16x16x64_bf16 v[24:27], v[12:15], v[64:71], v1
    v_add_f32_dpp v8, v8, v8 row_ror:4 row_mask:0xf bank_mask:0xf
    v_add_f32_dpp v9, v9, v9 row_ror:4 row_mask:0xf bank_mask:0xf
    v_smfmac_f32_16x16x64_bf16 v[24:27], v[16:19], v[72:79], v1
    v_add_f32_dpp v8, v8, v8 row_ror:2 row_mask:0xf bank_mask:0xf
    v_add_f32_dpp v9, v9, v9 row_ror:2 row_mask:0xf bank_mask:0xf
    v_smfmac_f32_16x16x64_bf16 v[24:27], v[20:23], v[80:87], v1
    v_add_f32_dpp v8, v8, v8 row_ror:1 row_mask:0xf bank_mask:0xf
    v_add_f32_dpp v9, v9, v9 row_ror:1 row_mask:0xf bank_mask:0xf
    v_smfmac_f32_16x16x64_bf16 v[32:35], v[12:15], v[112:119], v1
    v_mul_f32 v8, 0x3acccccd, v8
    v_mul_f32 v9, 0x3acccccd, v9
    v_smfmac_f32_16x16x64_bf16 v[32:35], v[16:19], v[120:127], v1
    v_fma_f32 v9, -v8, v8, v9
    v_max_f32 v9, 0, v9
    v_smfmac_f32_16x16x64_bf16 v[32:35], v[20:23], v[128:135], v1
    v_add_f32 v9, 0x3727c5ac, v9
    v_rsq_f32 v9, v9
    v_smfmac_f32_16x16x64_bf16 v[28:31], v[12:15], v[88:95], v1
    s_mov_b32 vcc_lo, 0x55555555
    v_mul_f32 v9, 0x3dd53b95, v9
    v_smfmac_f32_16x16x64_bf16 v[28:31], v[16:19], v[96:103], v1
    s_mov_b32 vcc_hi, 0x55555555
    v_smfmac_f32_16x16x64_bf16 v[28:31], v[20:23], v[104:111], v1
    v_smfmac_f32_16x16x64_bf16 v[36:39], v[12:15], v[136:143], v1
    v_pk_add_f32 v[24:25], v[24:25], v[26:27]
    v_add_f32 v24, v24, v25
    v_smfmac_f32_16x16x64_bf16 v[36:39], v[16:19], v[144:151], v1
    v_pk_add_f32 v[32:33], v[32:33], v[34:35]
    v_add_f32 v32, v32, v33
    v_smfmac_f32_16x16x64_bf16 v[36:39], v[20:23], v[152:159], v1
    s_nop 0
    v_permlane32_swap_b32 v24, v32
    v_add_f32 v24, v24, v32
    v_pk_add_f32 v[28:29], v[28:29], v[30:31]
    v_add_f32 v28, v28, v29
    s_nop 2
    v_pk_add_f32 v[36:37], v[36:37], v[38:39]
    v_add_f32 v36, v36, v37
    s_nop 1
    v_permlane32_swap_b32 v28, v36
    v_add_f32 v28, v28, v36
    s_nop 1
    v_permlane16_swap_b32 v24, v28
    v_add_f32 v24, v24, v28
    v_fma_f32 v24, -v8, v6, v24
    s_nop 1
    v_max_f32_dpp v21, v24, v24 row_ror:8 row_mask:0xf bank_mask:0xf
    s_nop 1
    v_max_f32_dpp v21, v21, v21 row_ror:4 row_mask:0xf bank_mask:0xf
    s_nop 1
    v_max_f32_dpp v21, v21, v21 row_ror:2 row_mask:0xf bank_mask:0xf
    s_nop 1
    v_max_f32_dpp v21, v21, v21 row_ror:1 row_mask:0xf bank_mask:0xf
    s_nop 1
    v_max_f32_dpp v21, v21, v21 row_bcast:15 row_mask:0xa bank_mask:0xf
    s_nop 1
    v_max_f32_dpp v21, v21, v21 row_bcast:31 row_mask:0xc bank_mask:0xf
    s_nop 0
    v_readlane_b32 s57, v21, 63
    s_nop 1
    v_subrev_f32 v24, s57, v24
    v_mul_f32 v24, v24, v9
    v_exp_f32 v22, v24
L_pad10:
    s_cbranch_execz L_pad11
    v_mul_f32 v20, s57, v9
    s_nop 0
    v_mov_b32_dpp v23, v22 row_shl:1 row_mask:0xf bank_mask:0xf bound_ctrl:0
    v_cvt_pk_bf16_f32 v23, v22, v23
    v_cndmask_b32 v12, 0, v23, vcc
    v_mov_b32 v21, v22
    s_nop 0
    v_mov_b32_dpp v13, v12 row_shl:4 row_mask:0xf bank_mask:0xf bound_ctrl:0
    v_mov_b32_dpp v14, v12 row_shl:8 row_mask:0xf bank_mask:0xf bound_ctrl:0
    v_mov_b32_dpp v15, v12 row_shl:12 row_mask:0xf bank_mask:0xf bound_ctrl:0
    s_nop 1
    v_smfmac_f32_16x16x64_bf16 v[40:43], v[12:15], v[160:167], v1
    v_mov_b32_dpp v16, v12 row_shr:1 row_mask:0xf bank_mask:0xf bound_ctrl:0
    v_mov_b32_dpp v17, v12 row_shl:3 row_mask:0xf bank_mask:0xf bound_ctrl:0
    v_smfmac_f32_16x16x64_bf16 v[44:47], v[12:15], v[176:183], v1
    v_mov_b32_dpp v18, v12 row_shl:7 row_mask:0xf bank_mask:0xf bound_ctrl:0
    v_mov_b32_dpp v19, v12 row_shl:11 row_mask:0xf bank_mask:0xf bound_ctrl:0
    v_smfmac_f32_16x16x64_bf16 v[48:51], v[12:15], v[192:199], v1
    v_permlane32_swap_b32 v21, v22
    v_add_f32 v21, v21, v22
    v_smfmac_f32_16x16x64_bf16 v[52:55], v[12:15], v[208:215], v1
    v_mov_b32 v22, v21
    s_nop 1
    v_permlane16_swap_b32 v21, v22
    v_smfmac_f32_16x16x64_bf16 v[56:59], v[12:15], v[224:231], v1
    v_add_f32 v21, v21, v22
    s_nop 1
    v_add_f32_dpp v21, v21, v21 row_ror:8 row_mask:0xf bank_mask:0xf
    v_smfmac_f32_16x16x64_bf16 v[60:63], v[12:15], v[240:247], v1
    s_nop 0
    v_add_f32_dpp v21, v21, v21 row_ror:4 row_mask:0xf bank_mask:0xf
    s_nop 1
    v_add_f32_dpp v21, v21, v21 row_ror:2 row_mask:0xf bank_mask:0xf
    v_smfmac_f32_16x16x64_bf16 v[40:43], v[16:19], v[168:175], v1
    s_nop 0
    v_add_f32_dpp v21, v21, v21 row_ror:1 row_mask:0xf bank_mask:0xf
    ds_write_b64 v10, v[20:21]
    v_smfmac_f32_16x16x64_bf16 v[44:47], v[16:19], v[184:191], v1
    v_and_b32 v36, 15, v0
    v_lshlrev_b32 v36, 4, v36
    v_add_u32 v36, s61, v36
    v_smfmac_f32_16x16x64_bf16 v[48:51], v[16:19], v[200:207], v1
    v_smfmac_f32_16x16x64_bf16 v[52:55], v[16:19], v[216:223], v1
    s_cmp_ge_u32 s30, 4
    s_cbranch_scc0 L_skip_93
    s_waitcnt lgkmcnt(0)
    s_barrier
L_skip_93:
    v_smfmac_f32_16x16x64_bf16 v[56:59], v[16:19], v[232:239], v1
    v_smfmac_f32_16x16x64_bf16 v[60:63], v[16:19], v[248:255], v1
    v_pk_add_f32 v[24:25], v[40:41], v[42:43]
    v_pk_add_f32 v[26:27], v[44:45], v[46:47]
    s_nop 0
    v_pk_add_f32 v[28:29], v[48:49], v[50:51]
    v_pk_add_f32 v[30:31], v[52:53], v[54:55]
    s_nop 1
    v_pk_add_f32 v[32:33], v[56:57], v[58:59]
    v_pk_add_f32 v[34:35], v[60:61], v[62:63]
    s_mov_b64 exec, 0xffff
    ds_write_b128 v36, v[24:27] offset:0
    ds_write_b128 v36, v[28:31] offset:256
    ds_write_b128 v36, v[32:35] offset:512
    s_mov_b64 exec, -1
    s_cmp_lt_u32 s30, 4
    s_cbranch_scc1 L_old
    s_waitcnt lgkmcnt(0)
L_b2_1:
    s_barrier
    s_cmp_lt_u32 s30, 2
    s_cbranch_scc0 L_skip_97
    s_mov_b32 exec_lo, 0xffffffff
    s_mov_b32 exec_hi, 0xffff
    ds_read_b64 v[40:41], v20 offset:0
    ds_read_b64 v[42:43], v20 offset:4096
    ds_read_b64 v[44:45], v20 offset:8192
    ds_read_b64 v[46:47], v20 offset:12288
    ds_read_b64 v[48:49], v20 offset:16384
    ds_read_b64 v[50:51], v20 offset:20480
    ds_read_b64 v[52:53], v20 offset:24576
    ds_read_b64 v[54:55], v20 offset:28672
    s_waitcnt lgkmcnt(7)
    v_mul_f32 v56, s64, v40
    v_mul_f32 v57, s64, v41
    s_waitcnt lgkmcnt(6)
L_pad11:
    s_cbranch_execz L_pad12
    v_fmac_f32 v56, s65, v42
    v_fmac_f32 v57, s65, v43
    s_waitcnt lgkmcnt(5)
    v_fmac_f32 v56, s66, v44
    v_fmac_f32 v57, s66, v45
    s_waitcnt lgkmcnt(4)
    v_fmac_f32 v56, s67, v46
    v_fmac_f32 v57, s67, v47
    s_waitcnt lgkmcnt(3)
    v_fmac_f32 v56, s68, v48
    v_fmac_f32 v57, s68, v49
    s_waitcnt lgkmcnt(2)
    v_fmac_f32 v56, s69, v50
    v_fmac_f32 v57, s69, v51
    s_waitcnt lgkmcnt(1)
    v_fmac_f32 v56, s70, v52
    v_fmac_f32 v57, s70, v53
    s_waitcnt lgkmcnt(0)
    v_fmac_f32 v56, s71, v54
    v_fmac_f32 v57, s71, v55
    v_cvt_pk_bf16_f32 v56, v56, v57
    v_min_u32 v56, -2, v56
    s_cmp_eq_u32 s55, 0
    s_cbranch_scc1 L_gs_98
    buffer_store_dword v56, v21, s[40:43], 0 offen
L_gb_99:
    s_mov_b64 exec, -1
L_skip_97:
    s_cmp_lt_u32 s52, 20
    s_cbranch_scc0 L_typeB_1
    s_lshr_b32 s57, s30, 1
    s_lshl_b32 s57, s57, 5
    s_add_u32 s57, s57, s62
    s_add_u32 s59, s57, 38016
    v_and_b32 v5, 7, v0
    v_lshlrev_b32 v5, 2, v5
    v_lshrrev_b32 v22, 4, v0
    v_lshlrev_b32 v22, 3, v22
    buffer_load_dword v18, v5, s[40:43], s59 offen sc1
    buffer_load_dwordx2 v[20:21], v22, s[40:43], s59 offen sc1
    s_mul_i32 s57, s30, 6144
    v_lshrrev_b32 v7, 2, v0
    v_lshlrev_b32 v7, 6, v7
    v_bfe_u32 v60, v0, 4, 1
    v_lshl_add_u32 v7, v60, 5, v7
    v_and_b32 v60, 3, v0
    v_lshl_add_u32 v7, v60, 3, v7
    v_add_u32 v7, s57, v7
    v_add_u32 v7, 30720, v7
    v_xor_b32 v8, 32, v7
    s_mul_i32 s60, s30, 1536
    s_add_u32 s60, s60, s62
    s_add_u32 s60, s60, 12288
    v_lshlrev_b32 v9, 4, v0
    v_lshlrev_b32 v10, 3, v0
    ds_read_b64_tr_b16 v[36:37], v7 offset:0
    ds_read_b64_tr_b16 v[38:39], v7 offset:1024
    ds_read_b64_tr_b16 v[40:41], v7 offset:2048
    ds_read_b64_tr_b16 v[42:43], v7 offset:3072
    ds_read_b64_tr_b16 v[44:45], v7 offset:4096
    ds_read_b64_tr_b16 v[46:47], v7 offset:5120
    ds_read_b64_tr_b16 v[48:49], v8 offset:0
    ds_read_b64_tr_b16 v[50:51], v8 offset:1024
    ds_read_b64_tr_b16 v[52:53], v8 offset:2048
    ds_read_b64_tr_b16 v[54:55], v8 offset:3072
    ds_read_b64_tr_b16 v[56:57], v8 offset:4096
    ds_read_b64_tr_b16 v[58:59], v8 offset:5120
    v_mov_b64 v[24:25], 0
    v_mov_b64 v[26:27], 0
    v_mov_b64 v[28:29], 0
    v_mov_b64 v[30:31], 0
    s_lshl_b32 s57, s30, 8
    v_lshlrev_b32 v11, 2, v0
    v_add_u32 v11, s57, v11
    v_add_u32 v11, 124928, v11
    s_waitcnt vmcnt(0)
L_pw_100:
    v_max3_u32 v19, v18, v20, v21
    v_cmp_eq_u32 vcc, -1, v19
    s_cbranch_vccnz L_pr_101
    buffer_load_dwordx4 v[12:15], v9, s[40:43], s60 offen sc1
    buffer_load_dwordx2 v[16:17], v10, s[40:43], s60 offen offset:1024 sc1
    v_max_f32_dpp v19, v18, v18 row_ror:4 row_mask:0xf bank_mask:0xf
    s_nop 1
    v_max_f32_dpp v19, v19, v19 row_ror:2 row_mask:0xf bank_mask:0xf
    s_nop 1
    v_max_f32_dpp v19, v19, v19 row_ror:1 row_mask:0xf bank_mask:0xf
    v_sub_f32 v18, v18, v19
    v_sub_f32 v20, v20, v19
    v_sub_f32 v21, v21, v19
    v_exp_f32 v18, v18
    v_exp_f32 v20, v20
    v_exp_f32 v21, v21
    v_add_f32_dpp v18, v18, v18 row_ror:4 row_mask:0xf bank_mask:0xf
    s_nop 1
    v_add_f32_dpp v18, v18, v18 row_ror:2 row_mask:0xf bank_mask:0xf
    s_nop 1
L_pad12:
    s_cbranch_execz L_pad13
    v_add_f32_dpp v18, v18, v18 row_ror:1 row_mask:0xf bank_mask:0xf
    v_rcp_f32 v18, v18
    s_nop 0
    v_mul_f32 v20, v20, v18
    v_mul_f32 v21, v21, v18
    s_waitcnt lgkmcnt(0)
    s_waitcnt vmcnt(0)
L_pw_102:
    v_max3_u32 v19, v12, v13, v14
    v_max3_u32 v19, v19, v15, v16
    v_max_u32 v19, v19, v17
    v_cmp_eq_u32 vcc, -1, v19
    s_cbranch_vccnz L_pr_103
    v_smfmac_f32_16x16x64_bf16 v[24:27], v[12:15], v[36:43], v1
    v_smfmac_f32_16x16x64_bf16 v[28:31], v[12:15], v[48:55], v1
    v_smfmac_f32_16x16x32_bf16 v[24:27], v[16:17], v[44:47], v1
    v_smfmac_f32_16x16x32_bf16 v[28:31], v[16:17], v[56:59], v1
    s_nop 6
    v_pk_add_f32 v[24:25], v[24:25], v[26:27]
    v_pk_add_f32 v[28:29], v[28:29], v[30:31]
    v_mul_f32 v24, v24, v20
    v_mul_f32 v28, v28, v20
    v_fmac_f32 v24, v25, v21
    v_fmac_f32 v28, v29, v21
    s_nop 1
    v_permlane32_swap_b32 v24, v28
    v_add_f32 v24, v24, v28
    ds_write_b32 v11, v24
    v_lshlrev_b32 v5, 2, v0
    v_add_u32 v5, 124928, v5
    s_mul_i32 s59, s31, 2560
    s_lshl_b32 s58, s52, 7
    s_add_u32 s59, s59, s58
    s_add_u32 s59, s59, 368576
    v_lshlrev_b32 v9, 2, v0
    s_waitcnt lgkmcnt(0)
    s_barrier
    s_cmp_eq_u32 s30, 2
    s_cbranch_scc0 L_skip_104
    ds_read2st64_b32 v[12:13], v5 offset0:0 offset1:1
    ds_read2st64_b32 v[14:15], v5 offset0:2 offset1:3
    ds_read2st64_b32 v[16:17], v5 offset0:4 offset1:5
    ds_read2st64_b32 v[18:19], v5 offset0:6 offset1:7
    s_waitcnt lgkmcnt(2)
    v_pk_add_f32 v[12:13], v[12:13], v[14:15]
    s_waitcnt lgkmcnt(0)
    v_pk_add_f32 v[16:17], v[16:17], v[18:19]
    v_pk_add_f32 v[12:13], v[12:13], v[16:17]
    v_add_f32 v12, v12, v13
    v_mov_b32 v13, v12
    s_nop 1
    v_permlane16_swap_b32 v12, v13
    v_add_f32 v12, v12, v13
    v_min_u32 v12, -2, v12
    s_mov_b32 exec_lo, 0xffff0000
    s_mov_b32 exec_hi, 0xffff
    buffer_store_dword v12, v9, s[40:43], s59 offen sc1
    s_lshl_b32 s57, s52, 2
    s_add_u32 s57, s57, s62
    s_add_u32 s57, s57, 38400
    s_mov_b64 exec, 0x1
    s_cmp_eq_u32 s55, 0
    s_cbranch_scc1 L_gs_105
    buffer_store_dword v0, v0, s[40:43], s57 offen
L_gb_106:
    s_mov_b64 exec, -1
L_skip_104:
    s_sub_u32 s57, s30, 5
    s_cmp_lt_u32 s57, 2
    s_cbranch_scc0 L_skip_107
    s_sub_u32 s60, s30, 5
    s_mul_i32 s59, s60, 6144
    s_add_u32 s59, s59, 79872
    v_lshrrev_b32 v7, 5, v0
    v_lshlrev_b32 v7, 9, v7
    v_bfe_u32 v60, v0, 4, 1
    v_lshl_add_u32 v7, v60, 7, v7
    v_bfe_u32 v60, v0, 3, 1
    v_lshl_add_u32 v7, v60, 8, v7
    v_bfe_u32 v60, v0, 2, 1
    v_lshl_add_u32 v7, v60, 5, v7
    v_and_b32 v60, 3, v0
    v_lshl_add_u32 v7, v60, 3, v7
    v_add_u32 v7, s59, v7
    s_add_u32 s59, s62, 37504
    v_lshrrev_b32 v5, 4, v0
    v_lshlrev_b32 v5, 5, v5
    v_bfe_u32 v60, v0, 1, 1
    v_lshl_add_u32 v5, v60, 4, v5
    v_mov_b64 v[24:25], 0
    v_mov_b64 v[26:27], 0
    s_mul_i32 s57, s31, 2560
L_pad13:
    s_cbranch_execz L_pad14
    s_lshl_b32 s58, s52, 7
    s_add_u32 s57, s57, s58
    s_lshl_b32 s60, s60, 6
    s_add_u32 s60, s60, s57
    s_add_u32 s60, s60, 389120
    v_lshlrev_b32 v9, 2, v0
    ds_read_b64_tr_b16 v[36:37], v7 offset:0
    ds_read_b64_tr_b16 v[38:39], v7 offset:64
    ds_read_b64_tr_b16 v[40:41], v7 offset:1024
    ds_read_b64_tr_b16 v[42:43], v7 offset:1088
    ds_read_b64_tr_b16 v[44:45], v7 offset:2048
    ds_read_b64_tr_b16 v[46:47], v7 offset:2112
    ds_read_b64_tr_b16 v[48:49], v7 offset:3072
    ds_read_b64_tr_b16 v[50:51], v7 offset:3136
    ds_read_b64_tr_b16 v[52:53], v7 offset:4096
    ds_read_b64_tr_b16 v[54:55], v7 offset:4160
    ds_read_b64_tr_b16 v[56:57], v7 offset:5120
    ds_read_b64_tr_b16 v[58:59], v7 offset:5184
    buffer_load_dwordx4 v[12:15], v5, s[40:43], s59 offen offset:0 sc1
    buffer_load_dwordx4 v[16:19], v5, s[40:43], s59 offen offset:128 sc1
    buffer_load_dwordx4 v[20:23], v5, s[40:43], s59 offen offset:256 sc1
    s_waitcnt lgkmcnt(0)
    s_waitcnt vmcnt(0)
L_pw_108:
    v_max3_u32 v28, v12, v13, v14
    v_max3_u32 v28, v28, v15, v16
    v_max3_u32 v28, v28, v17, v18
    v_max3_u32 v28, v28, v19, v20
    v_max3_u32 v28, v28, v21, v22
    v_max_u32 v28, v28, v23
    v_cmp_eq_u32 vcc, -1, v28
    s_cbranch_vccnz L_pr_109
    v_smfmac_f32_16x16x64_bf16 v[24:27], v[12:15], v[36:43], v1
    v_smfmac_f32_16x16x64_bf16 v[24:27], v[16:19], v[44:51], v1
    v_smfmac_f32_16x16x64_bf16 v[24:27], v[20:23], v[52:59], v1
    s_nop 7
    v_add_f32 v24, v24, v26
    v_min_u32 v24, -2, v24
    s_mov_b64 exec, 0xffff
    buffer_store_dword v24, v9, s[40:43], s60 offen sc1
    s_cmp_eq_u32 s30, 6
    s_cbranch_scc0 L_skip_110
    s_lshl_b32 s57, s52, 2
    s_add_u32 s57, s57, s62
    s_add_u32 s57, s57, 38528
    s_mov_b64 exec, 0x1
    s_cmp_eq_u32 s55, 0
    s_cbranch_scc1 L_gs_111
    buffer_store_dword v0, v0, s[40:43], s57 offen
L_gb_112:
    s_mov_b64 exec, -1
L_skip_110:
    s_mov_b64 exec, -1
L_skip_107:
    s_branch L_done
L_typeB_1:
    s_cmp_lt_u32 s30, 5
    s_cbranch_scc0 L_skip_113
    s_mul_i32 s57, s30, 6144
    v_lshrrev_b32 v10, 4, v0
    v_lshlrev_b32 v10, 10, v10
    v_bfe_u32 v60, v0, 3, 1
    v_lshl_add_u32 v10, v60, 8, v10
    v_bfe_u32 v60, v0, 1, 1
    v_lshl_add_u32 v10, v60, 7, v10
    v_bfe_u32 v60, v0, 2, 1
    v_lshl_add_u32 v10, v60, 5, v10
    v_and_b32 v60, 1, v0
    v_lshl_add_u32 v10, v60, 3, v10
    v_add_u32 v10, s57, v10
    v_add_u32 v10, 30720, v10
    ds_read_b64_tr_b16 v[36:37], v10 offset:0
    ds_read_b64_tr_b16 v[38:39], v10 offset:512
    ds_read_b64_tr_b16 v[40:41], v10 offset:64
    ds_read_b64_tr_b16 v[42:43], v10 offset:576
    ds_read_b64_tr_b16 v[44:45], v10 offset:16
    ds_read_b64_tr_b16 v[46:47], v10 offset:528
    ds_read_b64_tr_b16 v[48:49], v10 offset:80
    ds_read_b64_tr_b16 v[50:51], v10 offset:592
    s_lshl_b32 s57, s30, 10
    v_lshlrev_b32 v11, 4, v0
    v_add_u32 v11, s57, v11
    v_add_u32 v11, 124928, v11
    v_mov_b32 v32, 0x3f803f80
    v_mov_b32 v33, 0x3f803f80
L_pad14:
    s_cbranch_execz L_pad15
    v_mov_b32 v34, 0x3f803f80
    v_mov_b32 v35, 0x3f803f80
    v_mov_b32 v61, 0x3f803f80
    s_lshl_b32 s57, s30, 9
    v_lshrrev_b32 v5, 5, v0
    v_mul_u32_u24 v5, 2560, v5
    v_and_b32 v60, 31, v0
    v_lshl_add_u32 v5, v60, 4, v5
    v_add_u32 v5, s57, v5
    v_lshlrev_b32 v60, 16, v4
    v_add_f32 v2, v2, v60
    v_and_b32 v60, 0xffff0000, v4
    v_add_f32 v3, v3, v60
    s_mov_b32 s57, 348160
    buffer_load_dwordx4 v[12:15], v5, s[40:43], s57 offen sc1
    s_mov_b32 s58, 353280
    buffer_load_dwordx4 v[16:19], v5, s[40:43], s58 offen sc1
    s_mov_b32 s59, 358400
    buffer_load_dwordx4 v[20:23], v5, s[40:43], s59 offen sc1
    s_mov_b32 s60, 363520
    buffer_load_dwordx4 v[24:27], v5, s[40:43], s60 offen sc1
L_gw_114:
    s_waitcnt vmcnt(2)
    v_pk_add_f32 v[28:29], v[12:13], v[16:17]
    v_pk_add_f32 v[30:31], v[14:15], v[18:19]
    s_waitcnt vmcnt(1)
    v_pk_add_f32 v[28:29], v[28:29], v[20:21]
    v_pk_add_f32 v[30:31], v[30:31], v[22:23]
    s_waitcnt vmcnt(0)
    v_pk_add_f32 v[28:29], v[28:29], v[24:25]
    v_pk_add_f32 v[30:31], v[30:31], v[26:27]
    s_nop 1
    v_permlane32_swap_b32 v28, v30
    v_permlane32_swap_b32 v29, v31
    v_pk_add_f32 v[28:29], v[28:29], v[30:31]
    v_pk_add_f32 v[28:29], v[28:29], v[2:3]
    v_cmp_u_f32 vcc, v28, v29
    s_cbranch_vccnz L_gr_115
L_gk_116:
    v_cvt_pk_bf16_f32 v28, v28, v29
    v_lshlrev_b32 v2, 16, v28
    v_and_b32 v3, 0xffff0000, v28
    s_add_u32 s57, s62, 38400
    v_min_u32 v9, 19, v0
    v_lshlrev_b32 v9, 2, v9
    buffer_load_dword v12, v9, s[40:43], s57 offen sc1
    s_waitcnt vmcnt(0)
L_pw_121:
    v_cmp_eq_u32 vcc, -1, v12
    s_cbranch_vccnz L_pr_122
    s_mov_b32 s57, 368640
    buffer_load_dwordx4 v[12:15], v5, s[40:43], s57 offen sc1
    s_mov_b32 s58, 373760
    buffer_load_dwordx4 v[16:19], v5, s[40:43], s58 offen sc1
    s_mov_b32 s59, 378880
    buffer_load_dwordx4 v[20:23], v5, s[40:43], s59 offen sc1
    s_mov_b32 s60, 384000
    buffer_load_dwordx4 v[24:27], v5, s[40:43], s60 offen sc1
L_gw_123:
    s_waitcnt vmcnt(2)
    v_pk_add_f32 v[28:29], v[12:13], v[16:17]
    v_pk_add_f32 v[30:31], v[14:15], v[18:19]
    s_waitcnt vmcnt(1)
    v_pk_add_f32 v[28:29], v[28:29], v[20:21]
    v_pk_add_f32 v[30:31], v[30:31], v[22:23]
    s_waitcnt vmcnt(0)
    v_pk_add_f32 v[28:29], v[28:29], v[24:25]
    v_pk_add_f32 v[30:31], v[30:31], v[26:27]
    s_nop 1
    v_permlane32_swap_b32 v28, v30
    v_permlane32_swap_b32 v29, v31
    v_pk_add_f32 v[28:29], v[28:29], v[30:31]
    v_pk_add_f32 v[28:29], v[28:29], v[2:3]
    v_cmp_u_f32 vcc, v28, v29
    s_cbranch_vccnz L_gr_124
L_gk_125:
    v_cvt_pk_bf16_f32 v28, v28, v29
    v_mov_b64 v[12:13], 0
    v_mov_b64 v[14:15], 0
    v_mov_b32_dpp v32, v28 quad_perm:[0,1,2,3] row_mask:0xf bank_mask:0x1
    v_mov_b32_dpp v33, v28 row_shl:4 row_mask:0xf bank_mask:0x1
    v_mov_b32_dpp v34, v28 row_shl:8 row_mask:0xf bank_mask:0x1
    v_mov_b32_dpp v35, v28 row_shl:12 row_mask:0xf bank_mask:0x1
    v_dot2_f32_bf16 v27, v28, v61, 0
L_pad15:
    s_cbranch_execz L_pad16
    v_dot2_f32_bf16 v62, v28, v28, 0
    s_waitcnt lgkmcnt(0)
    v_smfmac_f32_16x16x64_bf16 v[12:15], v[32:35], v[36:43], v1
    v_mov_b64 v[16:17], 0
    v_mov_b64 v[18:19], 0
    v_permlane32_swap_b32 v27, v62
    s_nop 0
    v_smfmac_f32_16x16x64_bf16 v[16:19], v[32:35], v[44:51], v1
    v_add_f32 v27, v27, v62
    v_mov_b32 v62, v27
    s_nop 1
    v_permlane16_swap_b32 v27, v62
    v_add_f32 v27, v27, v62
    v_lshlrev_b32 v2, 16, v28
    v_and_b32 v3, 0xffff0000, v28
    v_add_f32_dpp v27, v27, v27 row_ror:8 row_mask:0xf bank_mask:0xf
    v_pk_add_f32 v[12:13], v[12:13], v[14:15]
    v_pk_add_f32 v[16:17], v[16:17], v[18:19]
    v_add_f32_dpp v27, v27, v27 row_ror:4 row_mask:0xf bank_mask:0xf
    v_add_f32_dpp v24, v13, v12 row_shl:8 row_mask:0xf bank_mask:0xf bound_ctrl:0
    v_add_f32_dpp v25, v17, v16 row_shl:8 row_mask:0xf bank_mask:0xf bound_ctrl:0
    v_add_f32_dpp v27, v27, v27 row_ror:2 row_mask:0xf bank_mask:0xf
    s_nop 1
    v_add_f32_dpp v27, v27, v27 row_ror:1 row_mask:0xf bank_mask:0xf
    ds_write_b128 v11, v[24:27]
    s_waitcnt lgkmcnt(0)
L_skip_113:
    s_cmp_eq_u32 s30, 5
    s_cbranch_scc0 L_skip_130
    v_and_b32 v10, 7, v0
    v_lshlrev_b32 v10, 4, v10
    v_bfe_u32 v60, v0, 3, 2
    v_lshl_add_u32 v10, v60, 2, v10
    v_lshrrev_b32 v60, 5, v0
    v_lshl_add_u32 v10, v60, 8, v10
    v_add_u32 v10, 124928, v10
    v_mov_b32 v60, 125452
    v_cmp_eq_u32 vcc, 25, v0
    s_nop 1
    v_cndmask_b32 v10, v10, v60, vcc
    s_sub_u32 s59, s52, 20
    s_lshl_b32 s59, s59, 5
    s_add_u32 s59, s59, s62
    s_add_u32 s59, s59, 37504
    v_lshlrev_b32 v11, 1, v0
    v_mov_b32 v18, 0xc0135761
    v_mov_b32 v19, 0xbdd2d3e8
L_skip_130:
    s_barrier
    s_cmp_eq_u32 s30, 5
    s_cbranch_scc0 L_skip_131
    ds_read2st64_b32 v[12:13], v10 offset0:0 offset1:4
    ds_read2st64_b32 v[14:15], v10 offset0:8 offset1:12
    ds_read_b32 v16, v10 offset:4096
    s_waitcnt lgkmcnt(1)
    v_pk_add_f32 v[12:13], v[12:13], v[14:15]
    s_waitcnt lgkmcnt(0)
    v_add_f32 v12, v12, v16
    v_add_f32 v12, v12, v13
    v_mov_b32 v14, 0x3acccccd
    v_readlane_b32 s57, v12, 24
    v_readlane_b32 s58, v12, 25
    v_permlane32_swap_b32 v12, v13
    v_mul_f32 v15, s57, v14
    v_mul_f32 v16, s58, v14
    v_fma_f32 v16, -v15, v15, v16
    v_max_f32 v16, 0, v16
    v_add_f32 v16, 0x3727c5ac, v16
    v_rsq_f32 v16, v16
    v_fma_f32 v12, -v15, v13, v12
    v_mul_f32 v12, v12, v16
    v_add_f32 v12, v12, v4
    v_mul_f32 v13, v12, v12
    v_fma_f32 v13, v13, v19, v18
    v_mul_f32 v13, v13, v12
    v_exp_f32 v13, v13
    s_nop 0
    v_add_f32 v13, 1.0, v13
    v_rcp_f32 v13, v13
    s_nop 0
    v_mul_f32 v12, v12, v13
    s_nop 1
    v_mov_b32_dpp v13, v12 row_shl:1 row_mask:0xf bank_mask:0xf bound_ctrl:0
    v_cvt_pk_bf16_f32 v12, v12, v13
    v_min_u32 v12, -2, v12
    s_mov_b64 exec, 0x5555
    s_cmp_eq_u32 s55, 0
    s_cbranch_scc1 L_gs_132
    buffer_store_dword v12, v11, s[40:43], s59 offen
L_gb_133:
    s_mov_b64 exec, -1
L_skip_131:
    s_sub_u32 s57, s52, 20
    s_cmp_eq_u32 s57, s30
L_pad16:
    s_cbranch_execz L_pad17
    s_cbranch_scc0 L_done
    s_cmp_lt_u32 s30, 5
    s_cbranch_scc0 L_done
    s_cmp_eq_u32 s31, 0
    s_cbranch_scc0 L_done
    v_lshlrev_b32 v60, 16, v4
    v_add_f32 v2, v2, v60
    v_and_b32 v60, 0xffff0000, v4
    v_add_f32 v3, v3, v60
    s_lshl_b32 s57, s30, 8
    v_and_b32 v7, 31, v0
    v_lshlrev_b32 v7, 3, v7
    v_lshrrev_b32 v60, 5, v0
    v_lshl_add_u32 v7, v60, 2, v7
    v_add_u32 v7, s57, v7
    s_add_u32 s57, s62, 38528
    v_min_u32 v9, 19, v0
    v_lshlrev_b32 v9, 2, v9
    buffer_load_dword v12, v9, s[40:43], s57 offen sc1
    s_waitcnt vmcnt(0)
L_pw_134:
    v_cmp_eq_u32 vcc, -1, v12
    s_cbranch_vccnz L_pr_135
    s_mov_b32 s57, 389120
    buffer_load_dwordx4 v[12:15], v5, s[40:43], s57 offen sc1
    s_mov_b32 s58, 394240
    buffer_load_dwordx4 v[16:19], v5, s[40:43], s58 offen sc1
    s_mov_b32 s59, 399360
    buffer_load_dwordx4 v[20:23], v5, s[40:43], s59 offen sc1
    s_mov_b32 s60, 404480
    buffer_load_dwordx4 v[24:27], v5, s[40:43], s60 offen sc1
L_gw_136:
    s_waitcnt vmcnt(2)
    v_pk_add_f32 v[28:29], v[12:13], v[16:17]
    v_pk_add_f32 v[30:31], v[14:15], v[18:19]
    s_waitcnt vmcnt(1)
    v_pk_add_f32 v[28:29], v[28:29], v[20:21]
    v_pk_add_f32 v[30:31], v[30:31], v[22:23]
    s_waitcnt vmcnt(0)
    v_pk_add_f32 v[28:29], v[28:29], v[24:25]
    v_pk_add_f32 v[30:31], v[30:31], v[26:27]
    s_nop 1
    v_permlane32_swap_b32 v28, v30
    v_permlane32_swap_b32 v29, v31
    v_pk_add_f32 v[28:29], v[28:29], v[30:31]
    v_pk_add_f32 v[28:29], v[28:29], v[2:3]
    v_cmp_u_f32 vcc, v28, v29
    s_cbranch_vccnz L_gr_137
L_gk_138:
    v_cvt_pk_bf16_f32 v28, v28, v29
    global_store_dword v7, v28, s[24:25]
    s_branch L_done
L_cr_9:
    s_sub_u32 s56, s56, 1
    s_cbranch_scc1 L_done
    global_load_dword v2, v3, s[26:27] sc1
    s_waitcnt vmcnt(0)
    s_branch L_cw_8
L_pr_18:
    s_sub_u32 s56, s56, 1
    s_cbranch_scc1 L_done
    buffer_load_dwordx2 v[52:53], v62, s[40:43], 0 offen sc1
    buffer_load_dwordx4 v[12:15], v63, s[40:43], 0 offen offset:0 sc1
    buffer_load_dwordx4 v[16:19], v63, s[40:43], 0 offen offset:1024 sc1
    buffer_load_dwordx4 v[20:23], v63, s[40:43], 0 offen offset:2048 sc1
    buffer_load_dwordx4 v[40:43], v63, s[40:43], s75 offen offset:0 sc1
    buffer_load_dwordx4 v[44:47], v63, s[40:43], s75 offen offset:1024 sc1
    buffer_load_dwordx4 v[48:51], v63, s[40:43], s75 offen offset:2048 sc1
    s_waitcnt vmcnt(0)
    s_branch L_pw_17
L_cr_21:
    s_sub_u32 s56, s56, 1
    s_cbranch_scc1 L_done
    global_load_dword v2, v3, s[26:27] sc1
    s_waitcnt vmcnt(0)
    s_branch L_cw_20
L_cr_25:
    s_sub_u32 s56, s56, 1
    s_cbranch_scc1 L_done
    buffer_load_dwordx4 v[24:27], v3, s[40:43], 0 offen sc1
    s_waitcnt vmcnt(0)
    s_branch L_cw_24
L_lr_27:
    s_sub_u32 s56, s56, 1
    s_cbranch_scc1 L_done
    s_branch L_lw_26
L_lr_30:
    s_sub_u32 s56, s56, 1
    s_cbranch_scc1 L_done
    s_branch L_lw_29
L_gs_32:
    buffer_store_dword v22, v23, s[40:43], s57 offen sc1
    s_branch L_gb_33
L_gs_36:
    buffer_store_dword v56, v21, s[40:43], 0 offen sc1
    s_branch L_gb_37
L_pr_39:
    s_sub_u32 s56, s56, 1
    s_cbranch_scc1 L_done
    buffer_load_dword v18, v5, s[40:43], s59 offen sc1
    buffer_load_dwordx2 v[20:21], v22, s[40:43], s59 offen sc1
    s_waitcnt vmcnt(0)
    s_branch L_pw_38
L_pr_41:
L_pad17:
    s_cbranch_execz L_pad18
    s_sub_u32 s56, s56, 1
    s_cbranch_scc1 L_done
    buffer_load_dwordx4 v[12:15], v9, s[40:43], s60 offen sc1
    buffer_load_dwordx2 v[16:17], v10, s[40:43], s60 offen offset:1024 sc1
    s_waitcnt vmcnt(0)
    s_branch L_pw_40
L_gs_43:
    buffer_store_dword v0, v0, s[40:43], s57 offen sc1
    s_branch L_gb_44
L_pr_47:
    s_sub_u32 s56, s56, 1
    s_cbranch_scc1 L_done
    buffer_load_dwordx4 v[12:15], v5, s[40:43], s59 offen offset:0 sc1
    buffer_load_dwordx4 v[16:19], v5, s[40:43], s59 offen offset:128 sc1
    buffer_load_dwordx4 v[20:23], v5, s[40:43], s59 offen offset:256 sc1
    s_waitcnt vmcnt(0)
    s_branch L_pw_46
L_gs_49:
    buffer_store_dword v0, v0, s[40:43], s57 offen sc1
    s_branch L_gb_50
L_pr_53:
    s_sub_u32 s56, s56, 1
    s_cbranch_scc1 L_done
    buffer_load_dword v12, v9, s[40:43], s57 offen sc1
    s_waitcnt vmcnt(0)
    s_branch L_pw_52
L_gr_55:
    s_sub_u32 s56, s56, 1
    s_cbranch_scc1 L_done
    s_mov_b64 s[74:75], 0
    v_max3_u32 v30, v12, v13, v14
    v_max_u32 v30, v30, v15
    v_cmp_eq_u32 vcc, -1, v30
    s_cbranch_vccz L_gn_57
    s_or_b64 s[74:75], s[74:75], vcc
    s_mov_b64 exec, vcc
    buffer_load_dwordx4 v[12:15], v5, s[40:43], s57 offen sc1
    s_mov_b64 exec, -1
L_gn_57:
    v_max3_u32 v30, v16, v17, v18
    v_max_u32 v30, v30, v19
    v_cmp_eq_u32 vcc, -1, v30
    s_cbranch_vccz L_gn_58
    s_or_b64 s[74:75], s[74:75], vcc
    s_mov_b64 exec, vcc
    buffer_load_dwordx4 v[16:19], v5, s[40:43], s58 offen sc1
    s_mov_b64 exec, -1
L_gn_58:
    v_max3_u32 v30, v20, v21, v22
    v_max_u32 v30, v30, v23
    v_cmp_eq_u32 vcc, -1, v30
    s_cbranch_vccz L_gn_59
    s_or_b64 s[74:75], s[74:75], vcc
    s_mov_b64 exec, vcc
    buffer_load_dwordx4 v[20:23], v5, s[40:43], s59 offen sc1
    s_mov_b64 exec, -1
L_gn_59:
    v_max3_u32 v30, v24, v25, v26
    v_max_u32 v30, v30, v27
    v_cmp_eq_u32 vcc, -1, v30
    s_cbranch_vccz L_gn_60
    s_or_b64 s[74:75], s[74:75], vcc
    s_mov_b64 exec, vcc
    buffer_load_dwordx4 v[24:27], v5, s[40:43], s60 offen sc1
    s_mov_b64 exec, -1
L_gn_60:
    s_cmp_eq_u64 s[74:75], 0
    s_cbranch_scc1 L_gk_56
    s_waitcnt vmcnt(0)
    s_branch L_gw_54
L_gs_63:
    buffer_store_dword v12, v11, s[40:43], s59 offen sc1
    s_branch L_gb_64
L_pr_68:
    s_sub_u32 s56, s56, 1
    s_cbranch_scc1 L_done
    buffer_load_dword v12, v9, s[40:43], s57 offen sc1
    s_waitcnt vmcnt(0)
    s_branch L_pw_67
L_gr_70:
    s_sub_u32 s56, s56, 1
    s_cbranch_scc1 L_done
    s_mov_b64 s[74:75], 0
    v_max3_u32 v30, v12, v13, v14
    v_max_u32 v30, v30, v15
    v_cmp_eq_u32 vcc, -1, v30
    s_cbranch_vccz L_gn_72
    s_or_b64 s[74:75], s[74:75], vcc
    s_mov_b64 exec, vcc
    buffer_load_dwordx4 v[12:15], v5, s[40:43], s57 offen sc1
    s_mov_b64 exec, -1
L_gn_72:
    v_max3_u32 v30, v16, v17, v18
    v_max_u32 v30, v30, v19
    v_cmp_eq_u32 vcc, -1, v30
    s_cbranch_vccz L_gn_73
    s_or_b64 s[74:75], s[74:75], vcc
    s_mov_b64 exec, vcc
    buffer_load_dwordx4 v[16:19], v5, s[40:43], s58 offen sc1
    s_mov_b64 exec, -1
L_gn_73:
    v_max3_u32 v30, v20, v21, v22
    v_max_u32 v30, v30, v23
    v_cmp_eq_u32 vcc, -1, v30
    s_cbranch_vccz L_gn_74
    s_or_b64 s[74:75], s[74:75], vcc
    s_mov_b64 exec, vcc
    buffer_load_dwordx4 v[20:23], v5, s[40:43], s59 offen sc1
    s_mov_b64 exec, -1
L_gn_74:
    v_max3_u32 v30, v24, v25, v26
    v_max_u32 v30, v30, v27
    v_cmp_eq_u32 vcc, -1, v30
    s_cbranch_vccz L_gn_75
    s_or_b64 s[74:75], s[74:75], vcc
    s_mov_b64 exec, vcc
    buffer_load_dwordx4 v[24:27], v5, s[40:43], s60 offen sc1
L_pad18:
    s_cbranch_execz L_pad19
    s_mov_b64 exec, -1
L_gn_75:
    s_cmp_eq_u64 s[74:75], 0
    s_cbranch_scc1 L_gk_71
    s_waitcnt vmcnt(0)
    s_branch L_gw_69
L_pr_77:
    s_sub_u32 s56, s56, 1
    s_cbranch_scc1 L_done
    buffer_load_dword v12, v9, s[40:43], s57 offen sc1
    s_waitcnt vmcnt(0)
    s_branch L_pw_76
L_gr_79:
    s_sub_u32 s56, s56, 1
    s_cbranch_scc1 L_done
    s_mov_b64 s[74:75], 0
    v_max3_u32 v30, v12, v13, v14
    v_max_u32 v30, v30, v15
    v_cmp_eq_u32 vcc, -1, v30
    s_cbranch_vccz L_gn_81
    s_or_b64 s[74:75], s[74:75], vcc
    s_mov_b64 exec, vcc
    buffer_load_dwordx4 v[12:15], v5, s[40:43], s57 offen sc1
    s_mov_b64 exec, -1
L_gn_81:
    v_max3_u32 v30, v16, v17, v18
    v_max_u32 v30, v30, v19
    v_cmp_eq_u32 vcc, -1, v30
    s_cbranch_vccz L_gn_82
    s_or_b64 s[74:75], s[74:75], vcc
    s_mov_b64 exec, vcc
    buffer_load_dwordx4 v[16:19], v5, s[40:43], s58 offen sc1
    s_mov_b64 exec, -1
L_gn_82:
    v_max3_u32 v30, v20, v21, v22
    v_max_u32 v30, v30, v23
    v_cmp_eq_u32 vcc, -1, v30
    s_cbranch_vccz L_gn_83
    s_or_b64 s[74:75], s[74:75], vcc
    s_mov_b64 exec, vcc
    buffer_load_dwordx4 v[20:23], v5, s[40:43], s59 offen sc1
    s_mov_b64 exec, -1
L_gn_83:
    v_max3_u32 v30, v24, v25, v26
    v_max_u32 v30, v30, v27
    v_cmp_eq_u32 vcc, -1, v30
    s_cbranch_vccz L_gn_84
    s_or_b64 s[74:75], s[74:75], vcc
    s_mov_b64 exec, vcc
    buffer_load_dwordx4 v[24:27], v5, s[40:43], s60 offen sc1
    s_mov_b64 exec, -1
L_gn_84:
    s_cmp_eq_u64 s[74:75], 0
    s_cbranch_scc1 L_gk_80
    s_waitcnt vmcnt(0)
    s_branch L_gw_78
L_gs_86:
    buffer_store_dword v12, v34, s[40:43], s59 offen sc1
    s_branch L_gb_87
L_gs_89:
    buffer_store_dword v27, v10, s[40:43], s67 offen sc1
    s_branch L_gb_90
L_pr_92:
    s_sub_u32 s56, s56, 1
    s_cbranch_scc1 L_done
    buffer_load_dwordx2 v[8:9], v7, s[40:43], 0 offen sc1
    buffer_load_dwordx4 v[12:15], v5, s[40:43], 0 offen offset:0 sc1
    buffer_load_dwordx4 v[16:19], v5, s[40:43], 0 offen offset:1024 sc1
    buffer_load_dwordx4 v[20:23], v5, s[40:43], 0 offen offset:2048 sc1
    s_waitcnt vmcnt(0)
    s_branch L_pw_91
L_gs_95:
    buffer_store_dword v22, v23, s[40:43], s57 offen sc1
    s_branch L_gb_96
L_old:
    s_waitcnt lgkmcnt(0)
    s_barrier
    s_cmp_lt_u32 s30, 2
    s_cbranch_scc0 L_b2_1
    v_and_b32 v37, 7, v0
    v_lshlrev_b32 v37, 3, v37
    v_add_u32 v37, 130048, v37
    ds_read_b64 v[38:39], v37
    s_lshl_b32 s57, s53, 3
    s_add_u32 s57, s57, s54
    s_lshl_b32 s57, s57, 2
    v_mov_b32 v23, s57
    s_add_u32 s57, s62, 38016
    s_waitcnt lgkmcnt(0)
    v_max_f32_dpp v37, v38, v38 row_ror:4 row_mask:0xf bank_mask:0xf
    s_nop 1
    v_max_f32_dpp v37, v37, v37 row_ror:2 row_mask:0xf bank_mask:0xf
    s_nop 1
    v_max_f32_dpp v37, v37, v37 row_ror:1 row_mask:0xf bank_mask:0xf
    v_sub_f32 v38, v38, v37
    v_exp_f32 v38, v38
    s_nop 0
    v_mul_f32 v39, v38, v39
    s_nop 1
    v_add_f32_dpp v39, v39, v39 row_ror:4 row_mask:0xf bank_mask:0xf
    s_nop 1
    v_add_f32_dpp v39, v39, v39 row_ror:2 row_mask:0xf bank_mask:0xf
    s_nop 1
    v_add_f32_dpp v39, v39, v39 row_ror:1 row_mask:0xf bank_mask:0xf
    v_log_f32 v22, v39
    v_rcp_f32 v39, v39
    v_add_f32 v22, v22, v37
    v_min_u32 v22, -2, v22
    v_mul_f32 v38, v38, v39
    s_cmp_eq_u32 s30, 0
    s_cbranch_scc0 L_skip_94
    s_mov_b64 exec, 0x1
    s_cmp_eq_u32 s55, 0
L_pad19:
    s_cbranch_execz L_pad20
    s_cbranch_scc1 L_gs_95
    buffer_store_dword v22, v23, s[40:43], s57 offen
L_gb_96:
    s_mov_b64 exec, -1
L_skip_94:
    v_readlane_b32 s64, v38, 0
    v_readlane_b32 s65, v38, 1
    v_readlane_b32 s66, v38, 2
    v_readlane_b32 s67, v38, 3
    v_readlane_b32 s68, v38, 4
    v_readlane_b32 s69, v38, 5
    v_readlane_b32 s70, v38, 6
    v_readlane_b32 s71, v38, 7
    s_mul_i32 s57, s30, 48
    v_add_u32 v38, s57, v0
    v_bfe_u32 v20, v38, 5, 2
    v_lshlrev_b32 v20, 8, v20
    v_and_b32 v39, 15, v38
    v_lshl_add_u32 v20, v39, 4, v20
    v_bfe_u32 v39, v38, 4, 1
    v_lshl_add_u32 v20, v39, 3, v20
    v_add_u32 v20, 92160, v20
    s_lshr_b32 s57, s54, 1
    s_lshl_b32 s57, s57, 2
    s_and_b32 s58, s54, 1
    s_add_u32 s57, s57, s58
    s_lshl_b32 s58, s57, 4
    s_lshl_b32 s57, s57, 3
    v_bfe_u32 v21, v0, 3, 2
    v_lshlrev_b32 v21, 8, v21
    v_bfe_u32 v39, v0, 2, 1
    v_lshl_add_u32 v21, v39, 5, v21
    v_and_b32 v39, 3, v0
    v_lshl_add_u32 v21, v39, 2, v21
    v_add_u32 v21, s58, v21
    v_bfe_u32 v38, v0, 3, 1
    v_lshlrev_b32 v38, 8, v38
    v_bfe_u32 v39, v0, 1, 1
    v_lshl_add_u32 v38, v39, 7, v38
    v_bfe_u32 v39, v0, 2, 1
    v_lshl_add_u32 v38, v39, 4, v38
    v_and_b32 v39, 1, v0
    v_lshl_add_u32 v38, v39, 2, v38
    v_add_u32 v38, s57, v38
    v_add_u32 v38, 1024, v38
    v_cmp_gt_u32 vcc, 32, v0
    s_nop 1
    v_cndmask_b32 v21, v38, v21, vcc
    s_lshl_b32 s57, s53, 1
    s_add_u32 s57, s57, s30
    s_mul_i32 s57, s57, 1536
    s_add_u32 s57, s57, s62
    s_add_u32 s57, s57, 12288
    v_add_u32 v21, s57, v21
    s_branch L_b2_1
L_gs_98:
    buffer_store_dword v56, v21, s[40:43], 0 offen sc1
    s_branch L_gb_99
L_pr_101:
    s_sub_u32 s56, s56, 1
    s_cbranch_scc1 L_done
    buffer_load_dword v18, v5, s[40:43], s59 offen sc1
    buffer_load_dwordx2 v[20:21], v22, s[40:43], s59 offen sc1
    s_waitcnt vmcnt(0)
    s_branch L_pw_100
L_pr_103:
    s_sub_u32 s56, s56, 1
    s_cbranch_scc1 L_done
    buffer_load_dwordx4 v[12:15], v9, s[40:43], s60 offen sc1
    buffer_load_dwordx2 v[16:17], v10, s[40:43], s60 offen offset:1024 sc1
    s_waitcnt vmcnt(0)
    s_branch L_pw_102
L_gs_105:
    buffer_store_dword v0, v0, s[40:43], s57 offen sc1
    s_branch L_gb_106
L_pr_109:
    s_sub_u32 s56, s56, 1
    s_cbranch_scc1 L_done
    buffer_load_dwordx4 v[12:15], v5, s[40:43], s59 offen offset:0 sc1
    buffer_load_dwordx4 v[16:19], v5, s[40:43], s59 offen offset:128 sc1
    buffer_load_dwordx4 v[20:23], v5, s[40:43], s59 offen offset:256 sc1
    s_waitcnt vmcnt(0)
    s_branch L_pw_108
L_gs_111:
    buffer_store_dword v0, v0, s[40:43], s57 offen sc1
    s_branch L_gb_112
L_gr_115:
    s_sub_u32 s56, s56, 1
    s_cbranch_scc1 L_done
    s_mov_b64 s[74:75], 0
    v_max3_u32 v30, v12, v13, v14
    v_max_u32 v30, v30, v15
    v_cmp_eq_u32 vcc, -1, v30
    s_cbranch_vccz L_gn_117
    s_or_b64 s[74:75], s[74:75], vcc
    s_mov_b64 exec, vcc
    buffer_load_dwordx4 v[12:15], v5, s[40:43], s57 offen sc1
L_pad20:
    s_cbranch_execz L_pad21
    s_mov_b64 exec, -1
L_gn_117:
    v_max3_u32 v30, v16, v17, v18
    v_max_u32 v30, v30, v19
    v_cmp_eq_u32 vcc, -1, v30
    s_cbranch_vccz L_gn_118
    s_or_b64 s[74:75], s[74:75], vcc
    s_mov_b64 exec, vcc
    buffer_load_dwordx4 v[16:19], v5, s[40:43], s58 offen sc1
    s_mov_b64 exec, -1
L_gn_118:
    v_max3_u32 v30, v20, v21, v22
    v_max_u32 v30, v30, v23
    v_cmp_eq_u32 vcc, -1, v30
    s_cbranch_vccz L_gn_119
    s_or_b64 s[74:75], s[74:75], vcc
    s_mov_b64 exec, vcc
    buffer_load_dwordx4 v[20:23], v5, s[40:43], s59 offen sc1
    s_mov_b64 exec, -1
L_gn_119:
    v_max3_u32 v30, v24, v25, v26
    v_max_u32 v30, v30, v27
    v_cmp_eq_u32 vcc, -1, v30
    s_cbranch_vccz L_gn_120
    s_or_b64 s[74:75], s[74:75], vcc
    s_mov_b64 exec, vcc
    buffer_load_dwordx4 v[24:27], v5, s[40:43], s60 offen sc1
    s_mov_b64 exec, -1
L_gn_120:
    s_cmp_eq_u64 s[74:75], 0
    s_cbranch_scc1 L_gk_116
    s_waitcnt vmcnt(0)
    s_branch L_gw_114
L_pr_122:
    s_sub_u32 s56, s56, 1
    s_cbranch_scc1 L_done
    buffer_load_dword v12, v9, s[40:43], s57 offen sc1
    s_waitcnt vmcnt(0)
    s_branch L_pw_121
L_gr_124:
    s_sub_u32 s56, s56, 1
    s_cbranch_scc1 L_done
    s_mov_b64 s[74:75], 0
    v_max3_u32 v30, v12, v13, v14
    v_max_u32 v30, v30, v15
    v_cmp_eq_u32 vcc, -1, v30
    s_cbranch_vccz L_gn_126
    s_or_b64 s[74:75], s[74:75], vcc
    s_mov_b64 exec, vcc
    buffer_load_dwordx4 v[12:15], v5, s[40:43], s57 offen sc1
    s_mov_b64 exec, -1
L_gn_126:
    v_max3_u32 v30, v16, v17, v18
    v_max_u32 v30, v30, v19
    v_cmp_eq_u32 vcc, -1, v30
    s_cbranch_vccz L_gn_127
    s_or_b64 s[74:75], s[74:75], vcc
    s_mov_b64 exec, vcc
    buffer_load_dwordx4 v[16:19], v5, s[40:43], s58 offen sc1
    s_mov_b64 exec, -1
L_gn_127:
    v_max3_u32 v30, v20, v21, v22
    v_max_u32 v30, v30, v23
    v_cmp_eq_u32 vcc, -1, v30
    s_cbranch_vccz L_gn_128
    s_or_b64 s[74:75], s[74:75], vcc
    s_mov_b64 exec, vcc
    buffer_load_dwordx4 v[20:23], v5, s[40:43], s59 offen sc1
    s_mov_b64 exec, -1
L_gn_128:
    v_max3_u32 v30, v24, v25, v26
    v_max_u32 v30, v30, v27
    v_cmp_eq_u32 vcc, -1, v30
    s_cbranch_vccz L_gn_129
    s_or_b64 s[74:75], s[74:75], vcc
    s_mov_b64 exec, vcc
    buffer_load_dwordx4 v[24:27], v5, s[40:43], s60 offen sc1
    s_mov_b64 exec, -1
L_gn_129:
    s_cmp_eq_u64 s[74:75], 0
    s_cbranch_scc1 L_gk_125
    s_waitcnt vmcnt(0)
    s_branch L_gw_123
L_gs_132:
    buffer_store_dword v12, v11, s[40:43], s59 offen sc1
    s_branch L_gb_133
L_pr_135:
    s_sub_u32 s56, s56, 1
    s_cbranch_scc1 L_done
    buffer_load_dword v12, v9, s[40:43], s57 offen sc1
    s_waitcnt vmcnt(0)
    s_branch L_pw_134
L_gr_137:
    s_sub_u32 s56, s56, 1
    s_cbranch_scc1 L_done
    s_mov_b64 s[74:75], 0
    v_max3_u32 v30, v12, v13, v14
    v_max_u32 v30, v30, v15
    v_cmp_eq_u32 vcc, -1, v30
    s_cbranch_vccz L_gn_139
    s_or_b64 s[74:75], s[74:75], vcc
    s_mov_b64 exec, vcc
    buffer_load_dwordx4 v[12:15], v5, s[40:43], s57 offen sc1
    s_mov_b64 exec, -1
L_gn_139:
    v_max3_u32 v30, v16, v17, v18
    v_max_u32 v30, v30, v19
    v_cmp_eq_u32 vcc, -1, v30
    s_cbranch_vccz L_gn_140
    s_or_b64 s[74:75], s[74:75], vcc
    s_mov_b64 exec, vcc
    buffer_load_dwordx4 v[16:19], v5, s[40:43], s58 offen sc1
    s_mov_b64 exec, -1
L_gn_140:
    v_max3_u32 v30, v20, v21, v22
    v_max_u32 v30, v30, v23
    v_cmp_eq_u32 vcc, -1, v30
    s_cbranch_vccz L_gn_141
    s_or_b64 s[74:75], s[74:75], vcc
    s_mov_b64 exec, vcc
L_pad21:
    s_cbranch_execz L_padback
    buffer_load_dwordx4 v[20:23], v5, s[40:43], s59 offen sc1
    s_mov_b64 exec, -1
L_gn_141:
    v_max3_u32 v30, v24, v25, v26
    v_max_u32 v30, v30, v27
    v_cmp_eq_u32 vcc, -1, v30
    s_cbranch_vccz L_gn_142
    s_or_b64 s[74:75], s[74:75], vcc
    s_mov_b64 exec, vcc
    buffer_load_dwordx4 v[24:27], v5, s[40:43], s60 offen sc1
    s_mov_b64 exec, -1
L_gn_142:
    s_cmp_eq_u64 s[74:75], 0
    s_cbranch_scc1 L_gk_138
    s_waitcnt vmcnt(0)
    s_branch L_gw_136
L_tail_end:
L_done:
L_exit:
    s_endpgm
.section .rodata,"a"
.p2align 6
.amdhsa_kernel interleave_layers__sliding_block_cached__dense_activation_gelu__decode_kernel
  .amdhsa_next_free_vgpr 256
  .amdhsa_next_free_sgpr 102
  .amdhsa_accum_offset 256
  .amdhsa_group_segment_fixed_size 0
  .amdhsa_kernarg_size 104
  .amdhsa_user_sgpr_count 2
  .amdhsa_user_sgpr_kernarg_segment_ptr 1
  .amdhsa_system_sgpr_workgroup_id_x 1
  .amdhsa_float_denorm_mode_32 3
.end_amdhsa_kernel
```

```asm
; @launch grid=(256,1,1) block=(512,1,1) lds=163328
.amdgcn_target "amdgcn-amd-amdhsa--gfx950"
.text
.fill 64, 4, 0xbf800000
.globl interleave_layers__sliding_block_cached__dense_activation_gelu__decode_kernel
.p2align 8
.type interleave_layers__sliding_block_cached__dense_activation_gelu__decode_kernel,@function
interleave_layers__sliding_block_cached__dense_activation_gelu__decode_kernel:
    s_load_dwordx16 s[4:19], s[0:1], 0
    s_load_dwordx8 s[20:27], s[0:1], 64
    s_load_dwordx2 s[28:29], s[0:1], 96
    s_cmp_ge_u32 s2, 256
    s_cbranch_scc1 L_exit
    s_getpc_b64 s[74:75]
L_pc:
    v_lshlrev_b32 v5, 6, v0
    v_min_u32 v5, L_exit-L_pc, v5
    global_load_dword v59, v5, s[74:75]
    v_lshrrev_b32 v5, 6, v0
    v_and_b32 v0, 63, v0
    v_readfirstlane_b32 s30, v5
    s_and_b32 s31, s2, 7
    s_lshr_b32 s52, s2, 3
    s_and_b32 s53, s52, 3
    s_lshr_b32 s54, s52, 2
    s_lshl_b32 s73, s31, 2
    s_add_u32 s73, s73, s53
    v_lshrrev_b32 v8, 5, v0
    v_lshlrev_b32 v8, 2, v8
    v_bfe_u32 v60, v0, 4, 1
    v_lshl_add_u32 v8, v60, 0, v8
    v_and_b32 v9, 7, v0
    v_xor_b32 v8, v8, v9
    v_lshrrev_b32 v10, 3, v0
    v_mul_u32_u24 v10, 384, v10
    v_lshl_add_u32 v5, v8, 4, v10
    v_xor_b32 v6, 32, v5
    v_lshrrev_b32 v8, 4, v0
    v_lshlrev_b32 v8, 1, v8
    v_xor_b32 v8, v8, v9
    v_lshl_add_u32 v7, v8, 4, v10
    v_lshrrev_b32 v2, 3, v0
    v_mul_u32_u24 v2, 12288, v2
    v_and_b32 v60, 7, v0
    v_lshl_add_u32 v2, v60, 4, v2
    s_mul_i32 s57, s73, 12582912
    s_mul_i32 s58, s54, 3072
    s_add_u32 s57, s57, s58
    s_add_u32 s57, s57, 11010048
    s_sub_u32 s58, 1572864, s58
    s_mul_i32 s59, s73, 384
    s_mul_i32 s60, s54, 983040
    s_add_u32 s59, s59, s60
    s_sub_u32 s60, 7866368, s59
    s_lshl_b32 s61, s30, 11
    s_add_u32 s61, s61, 92160
    s_mul_i32 s62, s31, 69632
    s_lshl_b32 s72, s31, 8
    s_add_u32 s72, s72, 1196032
    s_mov_b32 s56, 65536
    s_mov_b32 s55, 1
    s_getreg_b32 s63, hwreg(20, 0, 3)
    v_mov_b32 v11, 0
    v_mov_b32 v3, 0
    v_mov_b32 v21, 0
    v_mov_b32 v34, 0
    v_mov_b32 v62, 0
    v_mov_b32 v63, 0
    v_mov_b64 v[12:13], -1
    v_mov_b64 v[14:15], -1
    v_lshlrev_b32 v10, 4, v0
    s_waitcnt lgkmcnt(0)
    s_add_u32 s32, s6, s57
    s_addc_u32 s33, s7, 0
    s_mov_b32 s34, s58
    s_mov_b32 s35, 0x20000
    s_add_u32 s36, s8, s57
    s_addc_u32 s37, s9, 0
    s_mov_b32 s38, s58
    s_mov_b32 s39, 0x20000
    s_mov_b32 s40, s28
    s_mov_b32 s41, s29
    s_mov_b32 s42, 1198080
    s_mov_b32 s43, 0x20000
    s_add_u32 s44, s10, s59
    s_addc_u32 s45, s11, 0
    s_mov_b32 s46, s60
    s_mov_b32 s47, 0x20000
    s_sub_u32 s44, s44, 2048
    s_subb_u32 s45, s45, 0
    s_cmp_eq_u32 s30, 6
    s_cbranch_scc0 L_skip_1
    s_setprio 3
    s_mov_b32 s57, 0
    s_mov_b32 s58, 195584
    s_mov_b32 m0, 92160
L_dma_2:
    s_waitcnt vmcnt(27)
    buffer_load_dwordx4 v5, s[32:35], s57 offen offset:0 nt lds
    s_waitcnt vmcnt(27)
    buffer_load_dwordx4 v6, s[32:35], s58 offen offset:1024 nt lds
    s_add_u32 s57, s57, 24576
    s_add_u32 s58, s58, 24576
    s_add_u32 m0, m0, 2048
    s_cmp_lg_u32 m0, 108544
    s_cbranch_scc1 L_dma_2
    s_mov_b32 s57, 128
    s_mov_b32 s58, 195712
    s_mov_b32 m0, 108544
L_dma_3:
    s_waitcnt vmcnt(27)
    buffer_load_dwordx4 v5, s[32:35], s57 offen offset:0 nt lds
    s_waitcnt vmcnt(27)
    buffer_load_dwordx4 v6, s[32:35], s58 offen offset:1024 nt lds
    s_add_u32 s57, s57, 24576
    s_add_u32 s58, s58, 24576
    s_add_u32 m0, m0, 2048
    s_cmp_lg_u32 m0, 124928
    s_cbranch_scc1 L_dma_3
    s_mov_b32 s57, 2048
    s_mov_b32 s58, 1152
    s_mov_b32 s59, 256
    s_mov_b32 m0, 0
L_dma_4:
    s_waitcnt vmcnt(27)
    buffer_load_dwordx4 v2, s[44:47], s57 offen offset:0 nt lds
    s_waitcnt vmcnt(27)
    buffer_load_dwordx4 v2, s[44:47], s58 offen offset:1024 nt lds
    s_waitcnt vmcnt(27)
    buffer_load_dwordx4 v2, s[44:47], s59 offen offset:2048 nt lds
    s_add_u32 s57, s57, 98304
    s_add_u32 s58, s58, 98304
    s_add_u32 s59, s59, 98304
    s_add_u32 m0, m0, 3072
    s_cmp_lg_u32 m0, 15360
    s_cbranch_scc1 L_dma_4
L_skip_1:
    s_cmp_lt_u32 s52, 20
    s_cselect_b64 s[48:49], s[12:13], s[16:17]
    s_cselect_b32 s57, 4, 1
    s_mul_i32 s50, s57, 1966080
    s_mov_b32 s51, 0x20000
    s_cmp_eq_u32 s30, 5
    s_cbranch_scc0 L_skip_5
    s_cmp_eq_u32 s52, 31
    s_cbranch_scc0 L_skip_6
    s_mov_b64 exec, 0xffff
    buffer_store_dwordx4 v[12:15], v10, s[40:43], s72 offen sc1
L_skip_6:
    s_mul_i32 s58, s2, 320
    s_add_u32 s58, s58, 1114112
    s_mov_b64 exec, 0xfffff
    buffer_store_dwordx4 v[12:15], v10, s[40:43], s58 offen sc1
    s_mul_i32 s57, s52, 1280
    s_add_u32 s57, s57, s62
    s_mov_b64 exec, 0xffff
    buffer_store_dwordx4 v[12:15], v10, s[40:43], s57 offen offset:1024
    s_mov_b64 exec, -1
    buffer_store_dwordx4 v[12:15], v10, s[40:43], s57 offen
    s_max_u32 s57, s52, 20
    s_sub_u32 s57, s57, 20
    s_lshl_b32 s57, s57, 5
    s_mul_i32 s58, s31, 384
    s_add_u32 s57, s57, s58
    v_and_b32 v16, 15, v0
    v_lshlrev_b32 v16, 1, v16
    v_add_u32 v16, s57, v16
    global_load_ushort v4, v16, s[18:19]
    v_subrev_u32 v16, 8, v0
    v_cmp_gt_u32 vcc, 40, v16
    v_mov_b32 v16, 0x3f803f80
    s_nop 0
    v_cndmask_b32 v18, 0, v16, vcc
    v_min_u32 v16, 55, v0
    v_lshlrev_b32 v16, 2, v16
    v_add_u32 v16, 163104, v16
    ds_write_b32 v16, v18
    v_and_b32 v3, 7, v0
    v_lshlrev_b32 v3, 5, v3
L_skip_5:
    s_lshl_b32 s57, s30, 8
    v_and_b32 v16, 31, v0
    v_lshlrev_b32 v16, 3, v16
    v_lshrrev_b32 v60, 5, v0
    v_lshl_add_u32 v16, v60, 2, v16
    v_add_u32 v16, s57, v16
    s_cmp_eq_u32 s30, 7
    s_cbranch_scc0 L_skip_7
    v_and_b32 v60, 31, v0
    v_min_u32 v60, 19, v60
    s_mul_i32 s57, s54, 160
    v_lshrrev_b32 v16, 5, v0
    v_lshlrev_b32 v16, 2, v16
    v_add_u32 v16, s57, v16
    v_lshl_add_u32 v16, v60, 3, v16
L_skip_7:
    s_sub_u32 s57, s30, 5
    s_cmp_ge_u32 s57, 2
    s_cbranch_scc0 L_skip_8
    global_load_dword v28, v16, s[4:5]
    global_load_dword v4, v16, s[22:23]
L_skip_8:
    v_bfe_u32 v8, v0, 1, 3
    v_lshrrev_b32 v9, 4, v0
    v_xor_b32 v9, v8, v9
    v_bfe_u32 v8, v0, 2, 1
    v_lshlrev_b32 v8, 10, v8
    v_bfe_u32 v60, v0, 3, 1
    v_lshl_add_u32 v8, v60, 9, v8
    v_and_b32 v60, 3, v0
    v_lshl_add_u32 v8, v60, 7, v8
    v_add_u32 v8, s61, v8
    v_lshl_add_u32 v8, v9, 4, v8
    v_xor_b32 v9, 64, v8
    v_bfe_u32 v1, v0, 1, 1
    v_mul_u32_u24 v1, 43690, v1
    v_add_u32 v1, 17476, v1
    s_waitcnt vmcnt(31)
    s_barrier
    ds_read_b128 v[64:67], v8 offset:0
    ds_read_b128 v[68:71], v9 offset:0
    s_cmp_eq_u32 s30, 6
    s_cbranch_scc0 L_skip_9
    s_mov_b32 s57, 256
    s_mov_b32 s58, 195840
    s_mov_b32 m0, 124928
L_dma_10:
    s_waitcnt vmcnt(27)
    buffer_load_dwordx4 v5, s[32:35], s57 offen offset:0 nt lds
    s_waitcnt vmcnt(27)
    buffer_load_dwordx4 v6, s[32:35], s58 offen offset:1024 nt lds
    s_add_u32 s57, s57, 24576
    s_add_u32 s58, s58, 24576
    s_add_u32 m0, m0, 2048
    s_cmp_lg_u32 m0, 141312
    s_cbranch_scc1 L_dma_10
L_skip_9:
    s_waitcnt lgkmcnt(0)
    s_cmp_eq_u32 s30, 5
    s_cbranch_scc0 L_skip_11
    s_cmp_eq_u32 s52, 31
    s_cbranch_scc0 L_skip_12
    s_lshl_b32 s57, s31, 5
    v_mov_b32 v16, s57
    s_waitcnt vmcnt(4)
    s_mov_b64 exec, 0x1
    global_store_dword v16, v12, s[26:27] sc1
    s_mov_b64 exec, -1
L_skip_12:
L_skip_11:
    s_waitcnt vmcnt(31)
    s_barrier
    ds_read_b128 v[72:75], v8 offset:16384
    ds_read_b128 v[76:79], v9 offset:16384
    s_cmp_eq_u32 s30, 6
    s_cbranch_scc0 L_skip_13
    s_mov_b32 s57, 493568
    s_mov_b32 s58, 492672
    s_mov_b32 s59, 491776
    s_mov_b32 m0, 15360
L_dma_14:
    s_waitcnt vmcnt(27)
    buffer_load_dwordx4 v2, s[44:47], s57 offen offset:0 nt lds
    s_waitcnt vmcnt(27)
    buffer_load_dwordx4 v2, s[44:47], s58 offen offset:1024 nt lds
    s_waitcnt vmcnt(27)
    buffer_load_dwordx4 v2, s[44:47], s59 offen offset:2048 nt lds
    s_add_u32 s57, s57, 98304
    s_add_u32 s58, s58, 98304
    s_add_u32 s59, s59, 98304
    s_add_u32 m0, m0, 3072
    s_cmp_lg_u32 m0, 30720
    s_cbranch_scc1 L_dma_14
    s_mov_b32 s57, 393216
    s_mov_b32 s58, 588800
    s_mov_b32 m0, 141312
L_dma_15:
    s_waitcnt vmcnt(27)
    buffer_load_dwordx4 v5, s[32:35], s57 offen offset:0 nt lds
    s_waitcnt vmcnt(27)
    buffer_load_dwordx4 v6, s[32:35], s58 offen offset:1024 nt lds
    s_add_u32 s57, s57, 24576
    s_add_u32 s58, s58, 24576
    s_add_u32 m0, m0, 2048
    s_cmp_lg_u32 m0, 157696
    s_cbranch_scc1 L_dma_15
L_skip_13:
    s_waitcnt lgkmcnt(0)
    s_waitcnt vmcnt(31)
    s_barrier
    ds_read_b128 v[80:83], v8 offset:32768
    ds_read_b128 v[84:87], v9 offset:32768
    s_cmp_eq_u32 s30, 6
    s_cbranch_scc0 L_skip_16
    s_cmp_lt_u32 s52, 20
    s_cbranch_scc0 L_wb_17
    s_mul_i32 s57, s31, 983040
    s_lshl_b32 s58, s52, 6
    s_add_u32 s57, s57, s58
    v_bfe_u32 v38, v0, 4, 1
    v_lshlrev_b32 v38, 1, v38
    v_xor_b32 v38, v38, v0
    v_and_b32 v38, 3, v38
    v_lshrrev_b32 v3, 5, v0
    v_mul_u32_u24 v3, 10240, v3
    v_bfe_u32 v39, v0, 4, 1
    v_mul_u32_u24 v39, 2560, v39
    v_add_u32 v3, v39, v3
    v_bfe_u32 v39, v0, 3, 1
    v_mul_u32_u24 v39, 5120, v39
    v_add_u32 v3, v39, v3
    v_bfe_u32 v39, v0, 2, 1
    v_mul_u32_u24 v39, 20480, v39
    v_add_u32 v3, v39, v3
    v_add_u32 v3, s57, v3
    v_lshl_add_u32 v3, v38, 4, v3
    s_mov_b32 s14, 40960
    s_mov_b32 s15, 256
    s_branch L_we_18
L_wb_17:
    s_mul_i32 s57, s31, 384
    s_sub_u32 s58, s52, 20
    s_lshl_b32 s58, s58, 5
    s_add_u32 s57, s57, s58
    v_lshrrev_b32 v3, 1, v0
    v_mul_u32_u24 v3, 3072, v3
    v_and_b32 v39, 1, v0
    v_lshl_add_u32 v3, v39, 4, v3
    v_add_u32 v3, s57, v3
    s_mov_b32 s14, 196608
    s_mov_b32 s15, 97280
L_we_18:
    s_mul_i32 s57, s14, 0
    s_mov_b32 m0, 30720
    s_waitcnt vmcnt(27)
    buffer_load_dwordx4 v3, s[48:51], s57 offen offset:0 nt lds
    s_mov_b32 s57, 393344
    s_mov_b32 s58, 588928
    s_mov_b32 m0, 92160
L_dma_19:
    s_waitcnt vmcnt(27)
    buffer_load_dwordx4 v5, s[32:35], s57 offen offset:0 nt lds
    s_waitcnt vmcnt(27)
    buffer_load_dwordx4 v6, s[32:35], s58 offen offset:1024 nt lds
    s_add_u32 s57, s57, 24576
    s_add_u32 s58, s58, 24576
    s_add_u32 m0, m0, 2048
    s_cmp_lg_u32 m0, 108544
    s_cbranch_scc1 L_dma_19
    s_mul_i32 s57, s14, 0
    s_add_u32 s57, s57, s15
    s_mov_b32 m0, 30720
    s_waitcnt vmcnt(27)
    buffer_load_dwordx4 v3, s[48:51], s57 offen offset:1024 nt lds
    s_mov_b32 s57, 393472
    s_mov_b32 s58, 589056
    s_mov_b32 m0, 108544
L_dma_20:
    s_waitcnt vmcnt(27)
    buffer_load_dwordx4 v5, s[32:35], s57 offen offset:0 nt lds
    s_waitcnt vmcnt(27)
    buffer_load_dwordx4 v6, s[32:35], s58 offen offset:1024 nt lds
    s_add_u32 s57, s57, 24576
    s_add_u32 s58, s58, 24576
    s_add_u32 m0, m0, 2048
    s_cmp_lg_u32 m0, 124928
    s_cbranch_scc1 L_dma_20
L_skip_16:
    s_waitcnt lgkmcnt(0)
    s_cmp_eq_u32 s30, 7
    s_cbranch_scc0 L_skip_21
    v_and_b32 v60, 31, v0
    v_cmp_gt_u32 s[64:65], 20, v60
    v_min_u32 v60, 19, v60
    v_lshrrev_b32 v35, 5, v0
    v_lshlrev_b32 v35, 2, v35
    v_add_u32 v35, 162944, v35
    v_lshl_add_u32 v35, v60, 3, v35
    s_mul_i32 s66, s53, 6400
    s_add_u32 s66, s66, s62
    s_add_u32 s66, s66, 40960
    s_add_u32 s67, s66, 6144
    s_lshl_b32 s57, s54, 3
    v_lshrrev_b32 v34, 5, v0
    v_lshlrev_b32 v34, 2, v34
    v_add_u32 v34, s57, v34
    v_mov_b32 v61, 0x3f803f80
    s_waitcnt vmcnt(0)
    ds_write_b32 v35, v28
    s_waitcnt lgkmcnt(0)
L_skip_21:
    s_cmp_lt_u32 s30, 5
    s_cbranch_scc0 L_skip_22
    s_waitcnt vmcnt(0)
    v_lshlrev_b32 v2, 16, v28
    v_and_b32 v3, 0xffff0000, v28
L_skip_22:
    s_waitcnt vmcnt(34)
    s_barrier
    ds_read_b128 v[88:91], v8 offset:49152
    ds_read_b128 v[92:95], v9 offset:49152
    s_cmp_eq_u32 s30, 6
    s_cbranch_scc0 L_skip_23
    s_mul_i32 s57, s14, 1
    s_mov_b32 m0, 32768
    s_waitcnt vmcnt(27)
    buffer_load_dwordx4 v3, s[48:51], s57 offen offset:0 nt lds
    s_mov_b32 s57, 786432
    s_mov_b32 s58, 982016
    s_mov_b32 m0, 124928
L_dma_24:
    s_waitcnt vmcnt(27)
    buffer_load_dwordx4 v5, s[32:35], s57 offen offset:0 nt lds
    s_waitcnt vmcnt(27)
    buffer_load_dwordx4 v6, s[32:35], s58 offen offset:1024 nt lds
    s_add_u32 s57, s57, 24576
    s_add_u32 s58, s58, 24576
    s_add_u32 m0, m0, 2048
    s_cmp_lg_u32 m0, 141312
    s_cbranch_scc1 L_dma_24
L_skip_23:
    s_waitcnt lgkmcnt(0)
    s_cmp_eq_u32 s30, 3
    s_cbranch_scc0 L_skip_25
    s_mov_b64 exec, 0
    s_cbranch_execz L_pad0
L_padback:
    s_mov_b64 exec, -1
L_skip_25:
    s_cmp_eq_u32 s30, 7
    s_cbranch_scc0 L_skip_26
    v_lshlrev_b32 v2, 16, v28
    v_and_b32 v3, 0xffff0000, v28
    v_cndmask_b32 v28, 0, v28, s[64:65]
    v_dot2_f32_bf16 v27, v28, v61, 0
    v_dot2_f32_bf16 v62, v28, v28, 0
    s_nop 2
    v_permlane32_swap_b32 v27, v62
    v_add_f32 v27, v27, v62
    v_mov_b32 v62, v27
    s_nop 1
    v_permlane16_swap_b32 v27, v62
    v_add_f32 v27, v27, v62
    s_nop 1
    v_add_f32_dpp v27, v27, v27 row_ror:8 row_mask:0xf bank_mask:0xf
    s_nop 1
    v_add_f32_dpp v27, v27, v27 row_ror:4 row_mask:0xf bank_mask:0xf
    s_nop 1
    v_add_f32_dpp v27, v27, v27 row_ror:2 row_mask:0xf bank_mask:0xf
    s_nop 1
    v_add_f32_dpp v27, v27, v27 row_ror:1 row_mask:0xf bank_mask:0xf
    v_min_u32 v27, -2, v27
    s_mov_b32 exec_lo, 0x1
    s_mov_b32 exec_hi, 0x1
    s_cmp_eq_u32 s55, 0
    s_cbranch_scc1 L_gs_27
    buffer_store_dword v27, v34, s[40:43], s67 offen
L_gb_28:
    s_mov_b64 exec, -1
L_skip_26:
    s_cmp_lt_u32 s30, 6
    s_cbranch_scc0 L_skip_29
    s_lshr_b32 s57, s30, 1
    s_lshl_b32 s57, s57, 10
    s_and_b32 s58, s30, 1
    s_lshl_b32 s58, s58, 6
    s_add_u32 s57, s57, s58
    v_lshrrev_b32 v18, 5, v0
    v_mul_u32_u24 v18, 6144, v18
    v_bfe_u32 v60, v0, 3, 1
    v_mul_u32_u24 v60, 3072, v60
    v_add_u32 v18, v60, v18
    v_bfe_u32 v60, v0, 4, 1
    v_lshl_add_u32 v18, v60, 9, v18
    v_bfe_u32 v60, v0, 2, 1
    v_lshl_add_u32 v18, v60, 7, v18
    v_and_b32 v60, 3, v0
    v_lshl_add_u32 v18, v60, 3, v18
    v_add_u32 v18, s57, v18
    v_bfe_u32 v19, v0, 4, 1
    v_mul_u32_u24 v19, 3072, v19
    v_bfe_u32 v60, v0, 3, 1
    v_lshl_add_u32 v19, v60, 9, v19
    v_bfe_u32 v60, v0, 2, 1
    v_lshl_add_u32 v19, v60, 7, v19
    v_and_b32 v60, 3, v0
    v_lshl_add_u32 v19, v60, 3, v19
    v_add_u32 v19, s57, v19
    v_add_u32 v19, 24576, v19
    ds_read_b64_tr_b16 v[36:37], v18 offset:0
    ds_read_b64_tr_b16 v[38:39], v18 offset:256
    ds_read_b64_tr_b16 v[40:41], v18 offset:12288
    ds_read_b64_tr_b16 v[42:43], v18 offset:12544
    ds_read_b64_tr_b16 v[44:45], v19 offset:0
    ds_read_b64_tr_b16 v[46:47], v19 offset:256
    ds_read_b64_tr_b16 v[48:49], v18 offset:32
    ds_read_b64_tr_b16 v[50:51], v18 offset:288
    ds_read_b64_tr_b16 v[52:53], v18 offset:12320
    ds_read_b64_tr_b16 v[54:55], v18 offset:12576
    ds_read_b64_tr_b16 v[56:57], v19 offset:32
    ds_read_b64_tr_b16 v[58:59], v19 offset:288
    v_lshrrev_b32 v32, 4, v0
    v_lshlrev_b32 v32, 5, v32
    v_bfe_u32 v60, v0, 1, 1
    v_lshl_add_u32 v32, v60, 4, v32
    v_and_b32 v60, 1, v0
    v_mul_u32_u24 v60, 192, v60
    v_add_u32 v32, v60, v32
    v_add_u32 v32, 162944, v32
    v_lshrrev_b32 v33, 4, v0
    v_lshlrev_b32 v33, 4, v33
    v_bfe_u32 v60, v0, 1, 1
    v_lshl_add_u32 v33, v60, 3, v33
    v_and_b32 v60, 1, v0
    v_mul_u32_u24 v60, 192, v60
    v_add_u32 v33, v60, v33
    v_add_u32 v33, 163072, v33
    v_mov_b64 v[24:25], 0
    v_mov_b64 v[26:27], 0
    v_mov_b64 v[28:29], 0
    v_mov_b64 v[30:31], 0
    s_lshr_b32 s57, s54, 1
    s_lshl_b32 s57, s57, 2
    s_and_b32 s58, s54, 1
    s_add_u32 s57, s57, s58
    s_lshl_b32 s57, s57, 4
    s_lshl_b32 s58, s30, 9
    s_add_u32 s57, s57, s58
    v_bfe_u32 v34, v0, 4, 1
    v_lshlrev_b32 v34, 8, v34
    v_bfe_u32 v60, v0, 1, 1
    v_lshl_add_u32 v34, v60, 5, v34
    v_bfe_u32 v60, v0, 2, 2
    v_lshl_add_u32 v34, v60, 2, v34
    v_lshrrev_b32 v60, 5, v0
    v_mul_u32_u24 v60, 3072, v60
    v_add_u32 v34, v60, v34
    v_add_u32 v34, s57, v34
    s_mul_i32 s59, s53, 6400
    s_add_u32 s59, s59, s62
    s_add_u32 s59, s59, 40960
    s_add_u32 s60, s59, 6144
    ds_read_b128 v[12:15], v32
    ds_read_b64 v[16:17], v33
    s_waitcnt lgkmcnt(1)
    v_smfmac_f32_16x16x64_bf16 v[24:27], v[12:15], v[36:43], v1
    v_smfmac_f32_16x16x64_bf16 v[28:31], v[12:15], v[48:55], v1
    s_waitcnt lgkmcnt(0)
    v_smfmac_f32_16x16x32_bf16 v[24:27], v[16:17], v[44:47], v1
    v_smfmac_f32_16x16x32_bf16 v[28:31], v[16:17], v[56:59], v1
    s_nop 6
    v_add_f32 v12, v24, v26
    s_nop 1
    v_add_f32_dpp v12, v28, v30 quad_perm:[0,1,2,3] row_mask:0x2 bank_mask:0xf
    s_nop 1
    v_add_f32_dpp v12, v25, v27 quad_perm:[0,1,2,3] row_mask:0x4 bank_mask:0xf
    s_nop 1
    v_add_f32_dpp v12, v29, v31 quad_perm:[0,1,2,3] row_mask:0x8 bank_mask:0xf
    s_nop 1
    v_mov_b32_dpp v13, v12 row_shl:1 row_mask:0xf bank_mask:0xf bound_ctrl:0
    v_cvt_pk_bf16_f32 v12, v12, v13
    v_min_u32 v12, -2, v12
    s_mov_b32 exec_lo, 0x55555555
    s_mov_b32 exec_hi, 0x55555555
    s_cmp_eq_u32 s55, 0
    s_cbranch_scc1 L_gs_30
    buffer_store_dword v12, v34, s[40:43], s59 offen
L_gb_31:
    s_mov_b64 exec, -1
L_skip_29:
    s_cmp_eq_u32 s30, 5
    s_cbranch_scc0 L_skip_32
    global_load_dword v2, v3, s[26:27] sc1
L_skip_32:
    s_waitcnt vmcnt(34)
    s_barrier
    ds_read_b128 v[96:99], v8 offset:0
    ds_read_b128 v[100:103], v9 offset:0
    s_cmp_eq_u32 s30, 6
    s_cbranch_scc0 L_skip_33
    s_mul_i32 s57, s14, 1
    s_add_u32 s57, s57, s15
    s_mov_b32 m0, 32768
    s_waitcnt vmcnt(27)
    buffer_load_dwordx4 v3, s[48:51], s57 offen offset:1024 nt lds
    s_mov_b32 s57, 786560
    s_mov_b32 s58, 982144
    s_mov_b32 m0, 141312
L_dma_34:
    s_waitcnt vmcnt(27)
    buffer_load_dwordx4 v5, s[32:35], s57 offen offset:0 nt lds
    s_waitcnt vmcnt(27)
    buffer_load_dwordx4 v6, s[32:35], s58 offen offset:1024 nt lds
    s_add_u32 s57, s57, 24576
    s_add_u32 s58, s58, 24576
    s_add_u32 m0, m0, 2048
    s_cmp_lg_u32 m0, 157696
    s_cbranch_scc1 L_dma_34
L_skip_33:
    s_waitcnt lgkmcnt(0)
    s_waitcnt vmcnt(34)
    s_barrier
    ds_read_b128 v[104:107], v8 offset:16384
    ds_read_b128 v[108:111], v9 offset:16384
    s_cmp_eq_u32 s30, 6
    s_cbranch_scc0 L_skip_35
    s_mul_i32 s57, s14, 2
    s_mov_b32 m0, 34816
    s_waitcnt vmcnt(27)
    buffer_load_dwordx4 v3, s[48:51], s57 offen offset:0 nt lds
    s_mov_b32 s57, 786688
    s_mov_b32 s58, 982272
    s_mov_b32 m0, 92160
L_dma_36:
    s_waitcnt vmcnt(27)
    buffer_load_dwordx4 v5, s[32:35], s57 offen offset:0 nt lds
    s_waitcnt vmcnt(27)
    buffer_load_dwordx4 v6, s[32:35], s58 offen offset:1024 nt lds
    s_add_u32 s57, s57, 24576
    s_add_u32 s58, s58, 24576
    s_add_u32 m0, m0, 2048
    s_cmp_lg_u32 m0, 108544
    s_cbranch_scc1 L_dma_36
L_skip_35:
    s_waitcnt lgkmcnt(0)
    s_cmp_lg_u32 s30, 6
    s_cbranch_scc0 L_skip_37
    s_waitcnt vmcnt(0)
L_skip_37:
    s_waitcnt vmcnt(34)
    s_barrier
    ds_read_b128 v[112:115], v8 offset:32768
    ds_read_b128 v[116:119], v9 offset:32768
    s_cmp_eq_u32 s30, 6
    s_cbranch_scc0 L_skip_38
    s_mul_i32 s57, s14, 2
    s_add_u32 s57, s57, s15
    s_mov_b32 m0, 34816
    s_waitcnt vmcnt(27)
    buffer_load_dwordx4 v3, s[48:51], s57 offen offset:1024 nt lds
    s_mov_b32 s57, 1179648
    s_mov_b32 s58, 1375232
    s_mov_b32 m0, 108544
L_dma_39:
    s_waitcnt vmcnt(27)
    buffer_load_dwordx4 v5, s[32:35], s57 offen offset:0 nt lds
    s_waitcnt vmcnt(27)
    buffer_load_dwordx4 v6, s[32:35], s58 offen offset:1024 nt lds
    s_add_u32 s57, s57, 24576
    s_add_u32 s58, s58, 24576
    s_add_u32 m0, m0, 2048
    s_cmp_lg_u32 m0, 124928
    s_cbranch_scc1 L_dma_39
L_skip_38:
    s_waitcnt lgkmcnt(0)
    s_cmp_eq_u32 s30, 5
    s_cbranch_scc0 L_skip_40
L_cw_41:
    v_readlane_b32 s57, v2, s31
    s_cmp_eq_u32 s57, 0
    s_cbranch_scc1 L_cr_42
    s_lshl_b32 s57, s52, 2
    s_add_u32 s57, s57, s72
    v_mov_b32 v13, s63
    s_mov_b64 exec, 0x1
    buffer_store_dword v13, v0, s[40:43], s57 offen offset:0 sc1
    s_mov_b64 exec, -1
    v_lshlrev_b32 v4, 16, v4
L_skip_40:
    s_waitcnt vmcnt(34)
    s_barrier
    ds_read_b128 v[120:123], v8 offset:49152
    ds_read_b128 v[124:127], v9 offset:49152
    s_cmp_eq_u32 s30, 6
    s_cbranch_scc0 L_skip_43
    s_mul_i32 s57, s14, 3
    s_mov_b32 m0, 36864
    s_waitcnt vmcnt(27)
    buffer_load_dwordx4 v3, s[48:51], s57 offen offset:0 nt lds
    s_mov_b32 s57, 1179776
    s_mov_b32 s58, 1375360
    s_mov_b32 m0, 124928
L_dma_44:
    s_waitcnt vmcnt(27)
    buffer_load_dwordx4 v5, s[32:35], s57 offen offset:0 nt lds
    s_waitcnt vmcnt(27)
    buffer_load_dwordx4 v6, s[32:35], s58 offen offset:1024 nt lds
    s_add_u32 s57, s57, 24576
    s_add_u32 s58, s58, 24576
    s_add_u32 m0, m0, 2048
    s_cmp_lg_u32 m0, 141312
    s_cbranch_scc1 L_dma_44
L_skip_43:
    s_waitcnt lgkmcnt(0)
    s_waitcnt vmcnt(34)
    s_barrier
    ds_read_b128 v[128:131], v8 offset:0
    ds_read_b128 v[132:135], v9 offset:0
    s_cmp_eq_u32 s30, 6
    s_cbranch_scc0 L_skip_45
    s_mul_i32 s57, s14, 3
    s_add_u32 s57, s57, s15
    s_mov_b32 m0, 36864
    s_waitcnt vmcnt(27)
    buffer_load_dwordx4 v3, s[48:51], s57 offen offset:1024 nt lds
    s_mov_b32 s57, 1179904
    s_mov_b32 s58, 1375488
    s_mov_b32 m0, 141312
L_dma_46:
    s_waitcnt vmcnt(27)
    buffer_load_dwordx4 v5, s[32:35], s57 offen offset:0 nt lds
    s_waitcnt vmcnt(27)
    buffer_load_dwordx4 v6, s[32:35], s58 offen offset:1024 nt lds
    s_add_u32 s57, s57, 24576
    s_add_u32 s58, s58, 24576
    s_add_u32 m0, m0, 2048
    s_cmp_lg_u32 m0, 157696
    s_cbranch_scc1 L_dma_46
L_skip_45:
    s_waitcnt lgkmcnt(0)
    s_cmp_eq_u32 s30, 5
    s_cbranch_scc0 L_skip_47
    global_load_dword v2, v3, s[26:27] sc1
L_skip_47:
    s_waitcnt vmcnt(34)
    s_barrier
    ds_read_b128 v[136:139], v8 offset:16384
    ds_read_b128 v[140:143], v9 offset:16384
    s_cmp_eq_u32 s30, 6
    s_cbranch_scc0 L_skip_48
    s_mul_i32 s57, s14, 4
    s_mov_b32 m0, 38912
    s_waitcnt vmcnt(27)
    buffer_load_dwordx4 v3, s[48:51], s57 offen offset:0 nt lds
    s_mov_b32 s57, 0
    s_mov_b32 s58, 392192
    s_mov_b32 m0, 92160
L_dma_49:
    s_waitcnt vmcnt(27)
    buffer_load_dwordx4 v7, s[36:39], s57 offen offset:0 nt lds
    s_waitcnt vmcnt(27)
    buffer_load_dwordx4 v7, s[36:39], s58 offen offset:1024 nt lds
    s_add_u32 s57, s57, 24576
    s_add_u32 s58, s58, 24576
    s_add_u32 m0, m0, 2048
    s_cmp_lg_u32 m0, 108544
    s_cbranch_scc1 L_dma_49
L_skip_48:
    s_waitcnt lgkmcnt(0)
    s_waitcnt vmcnt(34)
    s_barrier
    ds_read_b128 v[144:147], v8 offset:32768
    ds_read_b128 v[148:151], v9 offset:32768
    s_cmp_eq_u32 s30, 6
    s_cbranch_scc0 L_skip_50
    s_mul_i32 s57, s14, 4
    s_add_u32 s57, s57, s15
    s_mov_b32 m0, 38912
    s_waitcnt vmcnt(27)
    buffer_load_dwordx4 v3, s[48:51], s57 offen offset:1024 nt lds
    s_mov_b32 s57, 128
    s_mov_b32 s58, 392320
    s_mov_b32 m0, 108544
L_dma_51:
    s_waitcnt vmcnt(27)
    buffer_load_dwordx4 v7, s[36:39], s57 offen offset:0 nt lds
    s_waitcnt vmcnt(27)
    buffer_load_dwordx4 v7, s[36:39], s58 offen offset:1024 nt lds
    s_add_u32 s57, s57, 24576
    s_add_u32 s58, s58, 24576
    s_add_u32 m0, m0, 2048
    s_cmp_lg_u32 m0, 124928
    s_cbranch_scc1 L_dma_51
L_skip_50:
    s_waitcnt lgkmcnt(0)
    s_cmp_eq_u32 s30, 5
    s_cbranch_scc0 L_skip_52
L_cw_53:
    s_waitcnt vmcnt(0)
    v_cmp_eq_u32 vcc, 0, v2
    s_cbranch_vccnz L_cr_54
    v_lshrrev_b32 v3, 3, v0
    v_lshlrev_b32 v3, 8, v3
    v_and_b32 v2, 7, v0
    v_lshl_add_u32 v3, v2, 4, v3
    v_add_u32 v3, 1196032, v3
    buffer_load_dwordx4 v[24:27], v3, s[40:43], 0 offen sc1
L_skip_52:
    s_waitcnt vmcnt(34)
    s_barrier
    ds_read_b128 v[152:155], v8 offset:49152
    ds_read_b128 v[156:159], v9 offset:49152
    s_cmp_eq_u32 s30, 6
    s_cbranch_scc0 L_skip_55
    s_mul_i32 s57, s14, 5
    s_mov_b32 m0, 40960
    s_waitcnt vmcnt(27)
    buffer_load_dwordx4 v3, s[48:51], s57 offen offset:0 nt lds
    s_mov_b32 s57, 256
    s_mov_b32 s58, 392448
    s_mov_b32 m0, 124928
L_dma_56:
    s_waitcnt vmcnt(27)
    buffer_load_dwordx4 v7, s[36:39], s57 offen offset:0 nt lds
    s_waitcnt vmcnt(27)
    buffer_load_dwordx4 v7, s[36:39], s58 offen offset:1024 nt lds
    s_add_u32 s57, s57, 24576
    s_add_u32 s58, s58, 24576
    s_add_u32 m0, m0, 2048
    s_cmp_lg_u32 m0, 141312
    s_cbranch_scc1 L_dma_56
L_skip_55:
    s_waitcnt lgkmcnt(0)
    v_lshrrev_b32 v8, 2, v0
    v_lshlrev_b32 v8, 7, v8
    v_bfe_u32 v60, v0, 3, 2
    v_lshl_add_u32 v8, v60, 5, v8
    v_and_b32 v60, 3, v0
    v_lshl_add_u32 v8, v60, 3, v8
    v_add_u32 v8, s61, v8
    v_xor_b32 v9, 32, v8
    v_xor_b32 v10, 64, v8
    v_xor_b32 v11, 96, v8
    s_waitcnt vmcnt(34)
    s_barrier
    ds_read_b64_tr_b16 v[160:161], v8 offset:0
    ds_read_b64_tr_b16 v[168:169], v9 offset:0
    ds_read_b64_tr_b16 v[176:177], v10 offset:0
    ds_read_b64_tr_b16 v[184:185], v11 offset:0
    s_cmp_eq_u32 s30, 6
    s_cbranch_scc0 L_skip_57
    s_mul_i32 s57, s14, 5
    s_add_u32 s57, s57, s15
    s_mov_b32 m0, 40960
    s_waitcnt vmcnt(27)
    buffer_load_dwordx4 v3, s[48:51], s57 offen offset:1024 nt lds
    s_mov_b32 s57, 196608
    s_mov_b32 s58, 588800
    s_mov_b32 m0, 141312
L_dma_58:
    s_waitcnt vmcnt(27)
    buffer_load_dwordx4 v7, s[36:39], s57 offen offset:0 nt lds
    s_waitcnt vmcnt(27)
    buffer_load_dwordx4 v7, s[36:39], s58 offen offset:1024 nt lds
    s_add_u32 s57, s57, 24576
    s_add_u32 s58, s58, 24576
    s_add_u32 m0, m0, 2048
    s_cmp_lg_u32 m0, 157696
    s_cbranch_scc1 L_dma_58
L_skip_57:
    s_waitcnt lgkmcnt(0)
    s_cmp_eq_u32 s30, 5
    s_cbranch_scc0 L_skip_59
    s_waitcnt vmcnt(0)
L_pw_60:
    v_max3_u32 v28, v24, v25, v26
    v_max_u32 v28, v28, v27
    v_cmp_eq_u32 vcc, -1, v28
    s_cbranch_vccnz L_pr_61
    v_xor_b32 v24, s63, v24
    v_xor_b32 v25, s63, v25
    v_xor_b32 v26, s63, v26
    v_xor_b32 v27, s63, v27
    v_or3_b32 v24, v24, v25, v26
    v_or_b32 v24, v24, v27
    v_cmp_ne_u32 vcc, 0, v24
    s_lshl_b32 s57, s31, 3
    s_lshr_b64 vcc, vcc, s57
    s_and_b32 s57, vcc_lo, 0xff
    s_cselect_b32 s57, 0, 1
    v_mov_b32 v37, 162880
    v_mov_b32 v38, s57
    ds_write_b32 v37, v38
    s_waitcnt lgkmcnt(0)
L_skip_59:
    s_waitcnt vmcnt(34)
    s_barrier
    ds_read_b64_tr_b16 v[192:193], v8 offset:16384
    ds_read_b64_tr_b16 v[200:201], v9 offset:16384
    ds_read_b64_tr_b16 v[208:209], v10 offset:16384
    ds_read_b64_tr_b16 v[216:217], v11 offset:16384
    s_cmp_eq_u32 s30, 6
    s_cbranch_scc0 L_skip_62
    s_mul_i32 s57, s14, 6
    s_mov_b32 m0, 43008
    s_waitcnt vmcnt(27)
    buffer_load_dwordx4 v3, s[48:51], s57 offen offset:0 nt lds
    s_mov_b32 s57, 196736
    s_mov_b32 s58, 588928
    s_mov_b32 m0, 92160
L_dma_63:
    s_waitcnt vmcnt(27)
    buffer_load_dwordx4 v7, s[36:39], s57 offen offset:0 nt lds
    s_waitcnt vmcnt(27)
    buffer_load_dwordx4 v7, s[36:39], s58 offen offset:1024 nt lds
    s_add_u32 s57, s57, 24576
    s_add_u32 s58, s58, 24576
    s_add_u32 m0, m0, 2048
    s_cmp_lg_u32 m0, 108544
    s_cbranch_scc1 L_dma_63
L_skip_62:
    s_waitcnt lgkmcnt(0)
    v_mov_b32 v41, 162880
    ds_read_b32 v42, v41
    s_waitcnt lgkmcnt(0)
    v_readfirstlane_b32 s55, v42
    s_cmp_eq_u32 s55, 0
    s_cbranch_scc1 L_spread
L_spread_back:
    s_cmp_eq_u32 s30, 4
    s_cbranch_scc0 L_skip_75
    s_mul_i32 s59, s53, 6400
    s_add_u32 s59, s59, s62
    s_add_u32 s59, s59, 40960
    s_add_u32 s60, s59, 6144
    v_lshlrev_b32 v16, 4, v0
    s_add_u32 s60, s59, 3072
    s_mov_b32 m0, 79872
    s_nop 0
    buffer_load_dwordx4 v16, s[40:43], s59 offen offset:0 sc1 nt lds
    buffer_load_dwordx4 v16, s[40:43], s59 offen offset:1024 sc1 nt lds
    buffer_load_dwordx4 v16, s[40:43], s59 offen offset:2048 sc1 nt lds
    s_mov_b32 m0, 82944
    s_nop 0
    buffer_load_dwordx4 v16, s[40:43], s60 offen offset:0 sc1 nt lds
    buffer_load_dwordx4 v16, s[40:43], s60 offen offset:1024 sc1 nt lds
    buffer_load_dwordx4 v16, s[40:43], s60 offen offset:2048 sc1 nt lds
    s_mov_b64 exec, 0xf
    buffer_load_dwordx4 v16, s[40:43], s60 offen offset:3072 sc1 nt lds
    s_mov_b64 exec, -1
L_skip_75:
    s_waitcnt vmcnt(34)
    s_barrier
    ds_read_b64_tr_b16 v[224:225], v8 offset:32768
    ds_read_b64_tr_b16 v[232:233], v9 offset:32768
    ds_read_b64_tr_b16 v[240:241], v10 offset:32768
    ds_read_b64_tr_b16 v[248:249], v11 offset:32768
    s_cmp_eq_u32 s30, 6
    s_cbranch_scc0 L_skip_76
    s_mul_i32 s57, s14, 6
    s_add_u32 s57, s57, s15
    s_mov_b32 m0, 43008
    s_waitcnt vmcnt(27)
    buffer_load_dwordx4 v3, s[48:51], s57 offen offset:1024 nt lds
    s_mov_b32 s57, 196864
    s_mov_b32 s58, 589056
    s_mov_b32 m0, 108544
L_dma_77:
    s_waitcnt vmcnt(27)
    buffer_load_dwordx4 v7, s[36:39], s57 offen offset:0 nt lds
    s_waitcnt vmcnt(27)
    buffer_load_dwordx4 v7, s[36:39], s58 offen offset:1024 nt lds
    s_add_u32 s57, s57, 24576
    s_add_u32 s58, s58, 24576
    s_add_u32 m0, m0, 2048
    s_cmp_lg_u32 m0, 124928
    s_cbranch_scc1 L_dma_77
L_skip_76:
    s_waitcnt lgkmcnt(0)
    s_waitcnt vmcnt(34)
    s_barrier
    ds_read_b64_tr_b16 v[162:163], v8 offset:49152
    ds_read_b64_tr_b16 v[170:171], v9 offset:49152
    ds_read_b64_tr_b16 v[178:179], v10 offset:49152
    ds_read_b64_tr_b16 v[186:187], v11 offset:49152
    s_cmp_eq_u32 s30, 6
    s_cbranch_scc0 L_skip_78
    s_mul_i32 s57, s14, 7
    s_mov_b32 m0, 45056
    s_waitcnt vmcnt(27)
    buffer_load_dwordx4 v3, s[48:51], s57 offen offset:0 nt lds
    s_mov_b32 s57, 786432
    s_mov_b32 s58, 1178624
    s_mov_b32 m0, 124928
L_dma_79:
    s_waitcnt vmcnt(27)
    buffer_load_dwordx4 v7, s[36:39], s57 offen offset:0 nt lds
    s_waitcnt vmcnt(27)
    buffer_load_dwordx4 v7, s[36:39], s58 offen offset:1024 nt lds
    s_add_u32 s57, s57, 24576
    s_add_u32 s58, s58, 24576
    s_add_u32 m0, m0, 2048
    s_cmp_lg_u32 m0, 141312
    s_cbranch_scc1 L_dma_79
L_skip_78:
    s_waitcnt lgkmcnt(0)
    s_cmp_eq_u32 s30, 4
    s_cbranch_scc0 L_skip_80
    s_waitcnt vmcnt(0)
L_skip_80:
    s_waitcnt vmcnt(34)
    s_barrier
    ds_read_b64_tr_b16 v[194:195], v8 offset:0
    ds_read_b64_tr_b16 v[202:203], v9 offset:0
    ds_read_b64_tr_b16 v[210:211], v10 offset:0
    ds_read_b64_tr_b16 v[218:219], v11 offset:0
    s_cmp_eq_u32 s30, 6
    s_cbranch_scc0 L_skip_81
    s_mul_i32 s57, s14, 7
    s_add_u32 s57, s57, s15
    s_mov_b32 m0, 45056
    s_nop 0
    buffer_load_dwordx4 v3, s[48:51], s57 offen offset:1024 nt lds
    s_mov_b32 s57, 786560
    s_mov_b32 s58, 1178752
    s_mov_b32 m0, 141312
L_dma_82:
    s_nop 0
    buffer_load_dwordx4 v7, s[36:39], s57 offen offset:0 nt lds
    buffer_load_dwordx4 v7, s[36:39], s58 offen offset:1024 nt lds
    s_add_u32 s57, s57, 24576
    s_add_u32 s58, s58, 24576
    s_add_u32 m0, m0, 2048
    s_cmp_lg_u32 m0, 157696
    s_cbranch_scc1 L_dma_82
L_skip_81:
    s_waitcnt lgkmcnt(0)
    v_lshlrev_b32 v40, 4, v0
    v_add_u32 v40, 79872, v40
    ds_read_b128 v[12:15], v40 offset:3072
    ds_read_b128 v[16:19], v40 offset:4096
    ds_read_b128 v[20:23], v40 offset:5120
    v_mov_b64 v[24:25], 0
    v_mov_b64 v[26:27], 0
    v_mov_b64 v[28:29], 0
    v_mov_b64 v[30:31], 0
    v_mov_b64 v[32:33], 0
    v_mov_b64 v[34:35], 0
    v_mov_b64 v[36:37], 0
    v_mov_b64 v[38:39], 0
    s_waitcnt lgkmcnt(0)
    v_smfmac_f32_16x16x64_bf16 v[24:27], v[12:15], v[64:71], v1
    v_smfmac_f32_16x16x64_bf16 v[24:27], v[16:19], v[72:79], v1
    v_smfmac_f32_16x16x64_bf16 v[24:27], v[20:23], v[80:87], v1
    v_smfmac_f32_16x16x64_bf16 v[32:35], v[12:15], v[112:119], v1
    v_smfmac_f32_16x16x64_bf16 v[32:35], v[16:19], v[120:127], v1
    v_smfmac_f32_16x16x64_bf16 v[32:35], v[20:23], v[128:135], v1
    v_smfmac_f32_16x16x64_bf16 v[28:31], v[12:15], v[88:95], v1
    v_smfmac_f32_16x16x64_bf16 v[28:31], v[16:19], v[96:103], v1
    v_smfmac_f32_16x16x64_bf16 v[28:31], v[20:23], v[104:111], v1
    v_smfmac_f32_16x16x64_bf16 v[36:39], v[12:15], v[136:143], v1
    s_nop 0
    v_pk_add_f32 v[24:25], v[24:25], v[26:27]
    v_add_f32 v24, v24, v25
    v_smfmac_f32_16x16x64_bf16 v[36:39], v[16:19], v[144:151], v1
    v_pk_add_f32 v[32:33], v[32:33], v[34:35]
    v_add_f32 v32, v32, v33
    v_smfmac_f32_16x16x64_bf16 v[36:39], v[20:23], v[152:159], v1
    s_nop 0
    v_permlane32_swap_b32 v24, v32
    v_add_f32 v24, v24, v32
    v_pk_add_f32 v[28:29], v[28:29], v[30:31]
    v_add_f32 v28, v28, v29
    s_nop 2
    v_pk_add_f32 v[36:37], v[36:37], v[38:39]
    v_add_f32 v36, v36, v37
    s_nop 1
    v_permlane32_swap_b32 v28, v36
    v_add_f32 v28, v28, v36
    s_nop 1
    v_permlane16_swap_b32 v24, v28
    v_add_f32 v6, v24, v28
    s_waitcnt vmcnt(34)
    s_barrier
    ds_read_b64_tr_b16 v[226:227], v8 offset:16384
    ds_read_b64_tr_b16 v[234:235], v9 offset:16384
    ds_read_b64_tr_b16 v[242:243], v10 offset:16384
    ds_read_b64_tr_b16 v[250:251], v11 offset:16384
    s_cmp_eq_u32 s30, 6
    s_cbranch_scc0 L_skip_83
    s_mul_i32 s57, s14, 8
    s_mov_b32 m0, 47104
    s_nop 0
    buffer_load_dwordx4 v3, s[48:51], s57 offen offset:0 nt lds
    s_mov_b32 s57, 786688
    s_mov_b32 s58, 1178880
    s_mov_b32 m0, 92160
L_dma_84:
    s_nop 0
    buffer_load_dwordx4 v7, s[36:39], s57 offen offset:0 nt lds
    buffer_load_dwordx4 v7, s[36:39], s58 offen offset:1024 nt lds
    s_add_u32 s57, s57, 24576
    s_add_u32 s58, s58, 24576
    s_add_u32 m0, m0, 2048
    s_cmp_lg_u32 m0, 108544
    s_cbranch_scc1 L_dma_84
L_skip_83:
    s_waitcnt lgkmcnt(0)
    v_and_b32 v41, 7, v0
    v_lshlrev_b32 v41, 3, v41
    v_add_u32 v41, 86016, v41
    ds_read_b128 v[12:15], v40 offset:0
    ds_read_b128 v[16:19], v40 offset:1024
    ds_read_b128 v[20:23], v40 offset:2048
    ds_read_b64 v[52:53], v41
    v_mov_b64 v[24:25], 0
    v_mov_b64 v[26:27], 0
    v_mov_b64 v[28:29], 0
    v_mov_b64 v[30:31], 0
    v_mov_b64 v[32:33], 0
    v_mov_b64 v[34:35], 0
    v_mov_b64 v[36:37], 0
    v_mov_b64 v[38:39], 0
    s_waitcnt lgkmcnt(0)
    v_smfmac_f32_16x16x64_bf16 v[24:27], v[12:15], v[64:71], v1
    v_add_f32_dpp v52, v52, v52 row_ror:4 row_mask:0xf bank_mask:0xf
    v_add_f32_dpp v53, v53, v53 row_ror:4 row_mask:0xf bank_mask:0xf
    v_smfmac_f32_16x16x64_bf16 v[24:27], v[16:19], v[72:79], v1
    v_add_f32_dpp v52, v52, v52 row_ror:2 row_mask:0xf bank_mask:0xf
    v_add_f32_dpp v53, v53, v53 row_ror:2 row_mask:0xf bank_mask:0xf
    v_smfmac_f32_16x16x64_bf16 v[24:27], v[20:23], v[80:87], v1
    v_add_f32_dpp v52, v52, v52 row_ror:1 row_mask:0xf bank_mask:0xf
    v_add_f32_dpp v53, v53, v53 row_ror:1 row_mask:0xf bank_mask:0xf
    v_smfmac_f32_16x16x64_bf16 v[32:35], v[12:15], v[112:119], v1
    v_mul_f32 v52, 0x3acccccd, v52
    v_mul_f32 v53, 0x3acccccd, v53
    v_smfmac_f32_16x16x64_bf16 v[32:35], v[16:19], v[120:127], v1
    v_fma_f32 v53, -v52, v52, v53
    v_max_f32 v53, 0, v53
    v_smfmac_f32_16x16x64_bf16 v[32:35], v[20:23], v[128:135], v1
    v_add_f32 v53, 0x3727c5ac, v53
    v_rsq_f32 v53, v53
    v_smfmac_f32_16x16x64_bf16 v[28:31], v[12:15], v[88:95], v1
    s_mov_b32 vcc_lo, 0x55555555
    v_mul_f32 v53, 0x3dd53b95, v53
    v_smfmac_f32_16x16x64_bf16 v[28:31], v[16:19], v[96:103], v1
    s_mov_b32 vcc_hi, 0x55555555
    v_smfmac_f32_16x16x64_bf16 v[28:31], v[20:23], v[104:111], v1
    v_smfmac_f32_16x16x64_bf16 v[36:39], v[12:15], v[136:143], v1
    v_pk_add_f32 v[24:25], v[24:25], v[26:27]
    v_add_f32 v24, v24, v25
    v_smfmac_f32_16x16x64_bf16 v[36:39], v[16:19], v[144:151], v1
    v_pk_add_f32 v[32:33], v[32:33], v[34:35]
    v_add_f32 v32, v32, v33
    v_smfmac_f32_16x16x64_bf16 v[36:39], v[20:23], v[152:159], v1
    s_nop 0
    v_permlane32_swap_b32 v24, v32
    v_add_f32 v24, v24, v32
    v_pk_add_f32 v[28:29], v[28:29], v[30:31]
    v_add_f32 v28, v28, v29
    s_nop 2
    v_pk_add_f32 v[36:37], v[36:37], v[38:39]
    v_add_f32 v36, v36, v37
    s_nop 1
    v_permlane32_swap_b32 v28, v36
    v_add_f32 v28, v28, v36
    s_nop 1
    v_permlane16_swap_b32 v24, v28
    v_add_f32 v24, v24, v28
    v_fma_f32 v24, -v52, v6, v24
    s_nop 1
    v_max_f32_dpp v21, v24, v24 row_ror:8 row_mask:0xf bank_mask:0xf
    s_nop 1
    v_max_f32_dpp v21, v21, v21 row_ror:4 row_mask:0xf bank_mask:0xf
    s_nop 1
    v_max_f32_dpp v21, v21, v21 row_ror:2 row_mask:0xf bank_mask:0xf
    s_nop 1
    v_max_f32_dpp v21, v21, v21 row_ror:1 row_mask:0xf bank_mask:0xf
    s_nop 1
    v_max_f32_dpp v21, v21, v21 row_bcast:15 row_mask:0xa bank_mask:0xf
    s_nop 1
    v_max_f32_dpp v21, v21, v21 row_bcast:31 row_mask:0xc bank_mask:0xf
    s_nop 0
    v_readlane_b32 s57, v21, 63
    s_nop 1
    v_subrev_f32 v24, s57, v24
    v_mul_f32 v24, v24, v53
    v_exp_f32 v22, v24
    v_mul_f32 v20, s57, v53
    s_nop 0
    v_mov_b32_dpp v23, v22 row_shl:1 row_mask:0xf bank_mask:0xf bound_ctrl:0
    v_cvt_pk_bf16_f32 v23, v22, v23
    v_cndmask_b32 v12, 0, v23, vcc
    v_mov_b32 v21, v22
    s_nop 0
    v_mov_b32_dpp v13, v12 row_shl:4 row_mask:0xf bank_mask:0xf bound_ctrl:0
    v_mov_b32_dpp v14, v12 row_shl:8 row_mask:0xf bank_mask:0xf bound_ctrl:0
    v_mov_b32_dpp v15, v12 row_shl:12 row_mask:0xf bank_mask:0xf bound_ctrl:0
    v_mov_b64 v[40:41], 0
    v_mov_b64 v[42:43], 0
    v_mov_b64 v[44:45], 0
    v_mov_b64 v[46:47], 0
    v_mov_b64 v[48:49], 0
    v_mov_b64 v[50:51], 0
    v_mov_b64 v[52:53], 0
    v_mov_b64 v[54:55], 0
    v_mov_b64 v[56:57], 0
    v_mov_b64 v[58:59], 0
    v_mov_b64 v[60:61], 0
    v_mov_b64 v[62:63], 0
    s_lshl_b32 s58, s30, 3
    s_add_u32 s58, s58, 162816
    v_mov_b32 v37, s58
    v_mov_b32_dpp v16, v12 row_shr:1 row_mask:0xf bank_mask:0xf bound_ctrl:0
    v_mov_b32_dpp v17, v12 row_shl:3 row_mask:0xf bank_mask:0xf bound_ctrl:0
    v_mov_b32_dpp v18, v12 row_shl:7 row_mask:0xf bank_mask:0xf bound_ctrl:0
    v_mov_b32_dpp v19, v12 row_shl:11 row_mask:0xf bank_mask:0xf bound_ctrl:0
    v_permlane32_swap_b32 v21, v22
    v_add_f32 v21, v21, v22
    v_mov_b32 v22, v21
    s_nop 1
    v_permlane16_swap_b32 v21, v22
    v_add_f32 v21, v21, v22
    s_nop 1
    v_add_f32_dpp v21, v21, v21 row_ror:8 row_mask:0xf bank_mask:0xf
    s_nop 1
    v_add_f32_dpp v21, v21, v21 row_ror:4 row_mask:0xf bank_mask:0xf
    s_nop 1
    v_add_f32_dpp v21, v21, v21 row_ror:2 row_mask:0xf bank_mask:0xf
    s_nop 1
    v_add_f32_dpp v21, v21, v21 row_ror:1 row_mask:0xf bank_mask:0xf
    ds_write_b64 v37, v[20:21]
    v_and_b32 v36, 15, v0
    v_lshlrev_b32 v36, 4, v36
    v_add_u32 v36, s61, v36
    v_add_u32 v36, 32768, v36
    s_waitcnt lgkmcnt(0)
    s_waitcnt vmcnt(34)
    s_barrier
    ds_read_b64_tr_b16 v[164:165], v8 offset:32768
    ds_read_b64_tr_b16 v[172:173], v9 offset:32768
    ds_read_b64_tr_b16 v[180:181], v10 offset:32768
    ds_read_b64_tr_b16 v[188:189], v11 offset:32768
    s_cmp_eq_u32 s30, 6
    s_cbranch_scc0 L_skip_85
    s_mul_i32 s57, s14, 8
    s_add_u32 s57, s57, s15
    s_mov_b32 m0, 47104
    s_waitcnt vmcnt(27)
    buffer_load_dwordx4 v3, s[48:51], s57 offen offset:1024 nt lds
    s_mov_b32 s57, 983040
    s_mov_b32 s58, 1375232
    s_mov_b32 m0, 108544
L_dma_86:
    s_waitcnt vmcnt(27)
    buffer_load_dwordx4 v7, s[36:39], s57 offen offset:0 nt lds
    s_waitcnt vmcnt(27)
    buffer_load_dwordx4 v7, s[36:39], s58 offen offset:1024 nt lds
    s_add_u32 s57, s57, 24576
    s_add_u32 s58, s58, 24576
    s_add_u32 m0, m0, 2048
    s_cmp_lg_u32 m0, 124928
    s_cbranch_scc1 L_dma_86
L_skip_85:
    s_waitcnt lgkmcnt(0)
    s_cmp_lt_u32 s30, 2
    s_cbranch_scc0 L_skip_87
    v_and_b32 v37, 7, v0
    v_lshlrev_b32 v37, 3, v37
    v_add_u32 v37, 162816, v37
    ds_read_b64 v[38:39], v37
    s_lshl_b32 s57, s53, 3
    s_add_u32 s57, s57, s54
    s_lshl_b32 s57, s57, 2
    v_mov_b32 v23, s57
    s_add_u32 s57, s62, 37888
    s_waitcnt lgkmcnt(0)
    v_max_f32_dpp v37, v38, v38 row_ror:4 row_mask:0xf bank_mask:0xf
    s_nop 1
    v_max_f32_dpp v37, v37, v37 row_ror:2 row_mask:0xf bank_mask:0xf
    s_nop 1
    v_max_f32_dpp v37, v37, v37 row_ror:1 row_mask:0xf bank_mask:0xf
    v_sub_f32 v38, v38, v37
    v_exp_f32 v38, v38
    s_nop 0
    v_mul_f32 v39, v38, v39
    s_nop 1
    v_add_f32_dpp v39, v39, v39 row_ror:4 row_mask:0xf bank_mask:0xf
    s_nop 1
    v_add_f32_dpp v39, v39, v39 row_ror:2 row_mask:0xf bank_mask:0xf
    s_nop 1
    v_add_f32_dpp v39, v39, v39 row_ror:1 row_mask:0xf bank_mask:0xf
    v_log_f32 v22, v39
    v_rcp_f32 v39, v39
    v_add_f32 v22, v22, v37
    v_min_u32 v22, -2, v22
    v_mul_f32 v38, v38, v39
    s_cmp_eq_u32 s30, 0
    s_cbranch_scc0 L_skip_88
    s_mov_b64 exec, 0x1
    s_cmp_eq_u32 s55, 0
    s_cbranch_scc1 L_gs_89
    buffer_store_dword v22, v23, s[40:43], s57 offen
L_gb_90:
    s_mov_b64 exec, -1
L_skip_88:
    v_readlane_b32 s64, v38, 0
    v_readlane_b32 s65, v38, 1
    v_readlane_b32 s66, v38, 2
    v_readlane_b32 s67, v38, 3
    v_readlane_b32 s68, v38, 4
    v_readlane_b32 s69, v38, 5
    v_readlane_b32 s70, v38, 6
    v_readlane_b32 s71, v38, 7
    s_mul_i32 s57, s30, 48
    v_add_u32 v38, s57, v0
    v_bfe_u32 v20, v38, 5, 2
    v_lshlrev_b32 v20, 8, v20
    v_and_b32 v39, 15, v38
    v_lshl_add_u32 v20, v39, 4, v20
    v_bfe_u32 v39, v38, 4, 1
    v_lshl_add_u32 v20, v39, 3, v20
    v_add_u32 v20, 124928, v20
    s_lshr_b32 s57, s54, 1
    s_lshl_b32 s57, s57, 2
    s_and_b32 s58, s54, 1
    s_add_u32 s57, s57, s58
    s_lshl_b32 s58, s57, 4
    s_lshl_b32 s57, s57, 3
    v_bfe_u32 v21, v0, 3, 2
    v_lshlrev_b32 v21, 8, v21
    v_bfe_u32 v39, v0, 2, 1
    v_lshl_add_u32 v21, v39, 5, v21
    v_and_b32 v39, 3, v0
    v_lshl_add_u32 v21, v39, 2, v21
    v_add_u32 v21, s58, v21
    v_bfe_u32 v38, v0, 3, 1
    v_lshlrev_b32 v38, 8, v38
    v_bfe_u32 v39, v0, 1, 1
    v_lshl_add_u32 v38, v39, 7, v38
    v_bfe_u32 v39, v0, 2, 1
    v_lshl_add_u32 v38, v39, 4, v38
    v_and_b32 v39, 1, v0
    v_lshl_add_u32 v38, v39, 2, v38
    v_add_u32 v38, s57, v38
    v_add_u32 v38, 1024, v38
    v_cmp_gt_u32 vcc, 32, v0
    s_nop 1
    v_cndmask_b32 v21, v38, v21, vcc
    s_lshl_b32 s57, s53, 1
    s_add_u32 s57, s57, s30
    s_mul_i32 s57, s57, 1536
    s_add_u32 s57, s57, s62
    s_add_u32 s57, s57, 0
    v_add_u32 v21, s57, v21
L_skip_87:
    s_waitcnt vmcnt(34)
    s_barrier
    ds_read_b64_tr_b16 v[196:197], v8 offset:49152
    ds_read_b64_tr_b16 v[204:205], v9 offset:49152
    ds_read_b64_tr_b16 v[212:213], v10 offset:49152
    ds_read_b64_tr_b16 v[220:221], v11 offset:49152
    s_cmp_eq_u32 s30, 6
    s_cbranch_scc0 L_skip_91
    s_mul_i32 s57, s14, 9
    s_mov_b32 m0, 49152
    s_waitcnt vmcnt(27)
    buffer_load_dwordx4 v3, s[48:51], s57 offen offset:0 nt lds
    s_mov_b32 s57, 983168
    s_mov_b32 s58, 1375360
    s_mov_b32 m0, 124928
L_dma_92:
    s_waitcnt vmcnt(27)
    buffer_load_dwordx4 v7, s[36:39], s57 offen offset:0 nt lds
    s_waitcnt vmcnt(27)
    buffer_load_dwordx4 v7, s[36:39], s58 offen offset:1024 nt lds
    s_add_u32 s57, s57, 24576
    s_add_u32 s58, s58, 24576
    s_add_u32 m0, m0, 2048
    s_cmp_lg_u32 m0, 141312
    s_cbranch_scc1 L_dma_92
L_skip_91:
    s_waitcnt lgkmcnt(0)
    s_cmp_eq_u32 s30, 2
    s_cbranch_scc0 L_skip_93
    s_mul_i32 s57, s52, 1280
    s_add_u32 s57, s57, s62
    v_min_u32 v37, 9, v0
    v_lshlrev_b32 v37, 7, v37
    buffer_load_dword v37, v37, s[40:43], s57 offen sc1 nt
L_skip_93:
    s_waitcnt vmcnt(34)
    s_barrier
    ds_read_b64_tr_b16 v[228:229], v8 offset:0
    ds_read_b64_tr_b16 v[236:237], v9 offset:0
    ds_read_b64_tr_b16 v[244:245], v10 offset:0
    ds_read_b64_tr_b16 v[252:253], v11 offset:0
    s_cmp_eq_u32 s30, 6
    s_cbranch_scc0 L_skip_94
    s_mul_i32 s57, s14, 9
    s_add_u32 s57, s57, s15
    s_mov_b32 m0, 49152
    s_waitcnt vmcnt(27)
    buffer_load_dwordx4 v3, s[48:51], s57 offen offset:1024 nt lds
    s_mov_b32 s57, 983296
    s_mov_b32 s58, 1375488
    s_mov_b32 m0, 141312
L_dma_95:
    s_waitcnt vmcnt(27)
    buffer_load_dwordx4 v7, s[36:39], s57 offen offset:0 nt lds
    s_waitcnt vmcnt(27)
    buffer_load_dwordx4 v7, s[36:39], s58 offen offset:1024 nt lds
    s_add_u32 s57, s57, 24576
    s_add_u32 s58, s58, 24576
    s_add_u32 m0, m0, 2048
    s_cmp_lg_u32 m0, 157696
    s_cbranch_scc1 L_dma_95
L_skip_94:
    s_waitcnt lgkmcnt(0)
    s_branch L_tail
.p2align 10
L_tail:
L_pad0:
    s_cbranch_execz L_pad1
    s_waitcnt vmcnt(34)
    s_barrier
    ds_read_b64_tr_b16 v[166:167], v8 offset:16384
    ds_read_b64_tr_b16 v[174:175], v9 offset:16384
    ds_read_b64_tr_b16 v[182:183], v10 offset:16384
    ds_read_b64_tr_b16 v[190:191], v11 offset:16384
    s_waitcnt lgkmcnt(0)
    v_smfmac_f32_16x16x64_bf16 v[40:43], v[12:15], v[160:167], v1
    v_smfmac_f32_16x16x64_bf16 v[40:43], v[16:19], v[168:175], v1
    v_smfmac_f32_16x16x64_bf16 v[44:47], v[12:15], v[176:183], v1
    v_smfmac_f32_16x16x64_bf16 v[44:47], v[16:19], v[184:191], v1
    s_cmp_eq_u32 s30, 6
    s_cbranch_scc0 L_skip_96
    s_mul_i32 s57, s14, 10
    s_add_u32 s58, s57, s15
    s_mov_b32 m0, 51200
L_dma_97:
    s_waitcnt vmcnt(33)
    buffer_load_dwordx4 v3, s[48:51], s57 offen offset:0 nt lds
    s_waitcnt vmcnt(33)
    buffer_load_dwordx4 v3, s[48:51], s58 offen offset:1024 nt lds
    s_add_u32 s57, s57, s14
    s_add_u32 s58, s58, s14
    s_add_u32 m0, m0, 2048
    s_cmp_lg_u32 m0, 65536
    s_cbranch_scc1 L_dma_97
L_skip_96:
    s_nop 3
    v_pk_add_f32 v[24:25], v[40:41], v[42:43]
    s_nop 0
    v_pk_add_f32 v[26:27], v[44:45], v[46:47]
    s_waitcnt vmcnt(31)
    s_barrier
    ds_read_b64_tr_b16 v[198:199], v8 offset:32768
    ds_read_b64_tr_b16 v[206:207], v9 offset:32768
    ds_read_b64_tr_b16 v[214:215], v10 offset:32768
    ds_read_b64_tr_b16 v[222:223], v11 offset:32768
    s_waitcnt lgkmcnt(0)
    v_smfmac_f32_16x16x64_bf16 v[48:51], v[12:15], v[192:199], v1
    v_smfmac_f32_16x16x64_bf16 v[48:51], v[16:19], v[200:207], v1
    v_smfmac_f32_16x16x64_bf16 v[52:55], v[12:15], v[208:215], v1
    v_smfmac_f32_16x16x64_bf16 v[52:55], v[16:19], v[216:223], v1
    s_cmp_eq_u32 s30, 6
    s_cbranch_scc0 L_skip_98
    s_mul_i32 s57, s14, 17
    s_add_u32 s58, s57, s15
    s_mov_b32 m0, 65536
L_dma_99:
    s_waitcnt vmcnt(33)
    buffer_load_dwordx4 v3, s[48:51], s57 offen offset:0 nt lds
    s_waitcnt vmcnt(33)
    buffer_load_dwordx4 v3, s[48:51], s58 offen offset:1024 nt lds
    s_add_u32 s57, s57, s14
    s_add_u32 s58, s58, s14
    s_add_u32 m0, m0, 2048
    s_cmp_lg_u32 m0, 79872
    s_cbranch_scc1 L_dma_99
L_skip_98:
    s_nop 3
    v_pk_add_f32 v[28:29], v[48:49], v[50:51]
    s_nop 0
    v_pk_add_f32 v[30:31], v[52:53], v[54:55]
    s_waitcnt vmcnt(28)
    s_barrier
    ds_read_b64_tr_b16 v[230:231], v8 offset:49152
    ds_read_b64_tr_b16 v[238:239], v9 offset:49152
    ds_read_b64_tr_b16 v[246:247], v10 offset:49152
    ds_read_b64_tr_b16 v[254:255], v11 offset:49152
    s_waitcnt lgkmcnt(0)
    v_smfmac_f32_16x16x64_bf16 v[56:59], v[12:15], v[224:231], v1
    v_smfmac_f32_16x16x64_bf16 v[56:59], v[16:19], v[232:239], v1
    v_smfmac_f32_16x16x64_bf16 v[60:63], v[12:15], v[240:247], v1
    v_smfmac_f32_16x16x64_bf16 v[60:63], v[16:19], v[248:255], v1
    s_nop 5
    v_pk_add_f32 v[32:33], v[56:57], v[58:59]
    s_nop 0
    v_pk_add_f32 v[34:35], v[60:61], v[62:63]
    s_setprio 0
    s_mov_b64 exec, 0xffff
    ds_write_b128 v36, v[24:27] offset:0
    ds_write_b128 v36, v[28:31] offset:256
    ds_write_b128 v36, v[32:35] offset:512
    s_mov_b64 exec, -1
    s_waitcnt lgkmcnt(0)
L_b2_0:
    s_barrier
    s_cmp_lt_u32 s30, 2
    s_cbranch_scc0 L_skip_100
L_pad1:
    s_cbranch_execz L_pad2
    s_mov_b32 exec_lo, 0xffffffff
    s_mov_b32 exec_hi, 0xffff
    ds_read_b64 v[40:41], v20 offset:0
    ds_read_b64 v[42:43], v20 offset:2048
    ds_read_b64 v[44:45], v20 offset:4096
    ds_read_b64 v[46:47], v20 offset:6144
    ds_read_b64 v[48:49], v20 offset:8192
    ds_read_b64 v[50:51], v20 offset:10240
    ds_read_b64 v[52:53], v20 offset:12288
    ds_read_b64 v[54:55], v20 offset:14336
    s_waitcnt lgkmcnt(7)
    v_mul_f32 v56, s64, v40
    v_mul_f32 v57, s64, v41
    s_waitcnt lgkmcnt(6)
    v_fmac_f32 v56, s65, v42
    v_fmac_f32 v57, s65, v43
    s_waitcnt lgkmcnt(5)
    v_fmac_f32 v56, s66, v44
    v_fmac_f32 v57, s66, v45
    s_waitcnt lgkmcnt(4)
    v_fmac_f32 v56, s67, v46
    v_fmac_f32 v57, s67, v47
    s_waitcnt lgkmcnt(3)
    v_fmac_f32 v56, s68, v48
    v_fmac_f32 v57, s68, v49
    s_waitcnt lgkmcnt(2)
    v_fmac_f32 v56, s69, v50
    v_fmac_f32 v57, s69, v51
    s_waitcnt lgkmcnt(1)
    v_fmac_f32 v56, s70, v52
    v_fmac_f32 v57, s70, v53
    s_waitcnt lgkmcnt(0)
    v_fmac_f32 v56, s71, v54
    v_fmac_f32 v57, s71, v55
    v_cvt_pk_bf16_f32 v56, v56, v57
    v_min_u32 v56, -2, v56
    s_cmp_eq_u32 s55, 0
    s_cbranch_scc1 L_gs_101
    buffer_store_dword v56, v21, s[40:43], 0 offen
L_gb_102:
    s_mov_b64 exec, -1
L_skip_100:
    s_cmp_eq_u32 s30, 6
    s_cbranch_scc0 L_skip_103
    s_waitcnt vmcnt(0)
L_skip_103:
    s_barrier
    s_cmp_lt_u32 s52, 20
    s_cbranch_scc0 L_typeB_0
    s_lshr_b32 s57, s30, 1
    s_lshl_b32 s57, s57, 5
    s_add_u32 s57, s57, s62
    s_add_u32 s59, s57, 37888
    v_and_b32 v5, 7, v0
    v_lshlrev_b32 v5, 2, v5
    v_lshrrev_b32 v22, 4, v0
    v_lshlrev_b32 v22, 3, v22
    buffer_load_dword v18, v5, s[40:43], s59 offen sc1
    buffer_load_dwordx2 v[20:21], v22, s[40:43], s59 offen sc1
    s_mul_i32 s57, s30, 6144
    v_lshrrev_b32 v7, 2, v0
    v_lshlrev_b32 v7, 6, v7
    v_bfe_u32 v60, v0, 4, 1
    v_lshl_add_u32 v7, v60, 5, v7
    v_and_b32 v60, 3, v0
    v_lshl_add_u32 v7, v60, 3, v7
    v_add_u32 v7, s57, v7
    v_add_u32 v7, 30720, v7
    v_xor_b32 v8, 32, v7
    s_mul_i32 s60, s30, 1536
    s_add_u32 s60, s60, s62
    s_add_u32 s60, s60, 0
    v_lshlrev_b32 v9, 4, v0
    v_lshlrev_b32 v10, 3, v0
    ds_read_b64_tr_b16 v[36:37], v7 offset:0
    ds_read_b64_tr_b16 v[38:39], v7 offset:1024
    ds_read_b64_tr_b16 v[40:41], v7 offset:2048
    ds_read_b64_tr_b16 v[42:43], v7 offset:3072
    ds_read_b64_tr_b16 v[44:45], v7 offset:4096
    ds_read_b64_tr_b16 v[46:47], v7 offset:5120
    ds_read_b64_tr_b16 v[48:49], v8 offset:0
    ds_read_b64_tr_b16 v[50:51], v8 offset:1024
    ds_read_b64_tr_b16 v[52:53], v8 offset:2048
    ds_read_b64_tr_b16 v[54:55], v8 offset:3072
    ds_read_b64_tr_b16 v[56:57], v8 offset:4096
    ds_read_b64_tr_b16 v[58:59], v8 offset:5120
    v_mov_b64 v[24:25], 0
    v_mov_b64 v[26:27], 0
    v_mov_b64 v[28:29], 0
    v_mov_b64 v[30:31], 0
    s_lshl_b32 s57, s30, 8
    v_lshlrev_b32 v11, 2, v0
    v_add_u32 v11, s57, v11
    v_add_u32 v11, 157696, v11
    s_waitcnt vmcnt(0)
L_pw_104:
    v_max3_u32 v19, v18, v20, v21
L_pad2:
    s_cbranch_execz L_pad3
    v_cmp_eq_u32 vcc, -1, v19
    s_cbranch_vccnz L_pr_105
    buffer_load_dwordx4 v[12:15], v9, s[40:43], s60 offen sc1
    buffer_load_dwordx2 v[16:17], v10, s[40:43], s60 offen offset:1024 sc1
    v_max_f32_dpp v19, v18, v18 row_ror:4 row_mask:0xf bank_mask:0xf
    s_nop 1
    v_max_f32_dpp v19, v19, v19 row_ror:2 row_mask:0xf bank_mask:0xf
    s_nop 1
    v_max_f32_dpp v19, v19, v19 row_ror:1 row_mask:0xf bank_mask:0xf
    v_sub_f32 v18, v18, v19
    v_sub_f32 v20, v20, v19
    v_sub_f32 v21, v21, v19
    v_exp_f32 v18, v18
    v_exp_f32 v20, v20
    v_exp_f32 v21, v21
    v_add_f32_dpp v18, v18, v18 row_ror:4 row_mask:0xf bank_mask:0xf
    s_nop 1
    v_add_f32_dpp v18, v18, v18 row_ror:2 row_mask:0xf bank_mask:0xf
    s_nop 1
    v_add_f32_dpp v18, v18, v18 row_ror:1 row_mask:0xf bank_mask:0xf
    v_rcp_f32 v18, v18
    s_nop 0
    v_mul_f32 v20, v20, v18
    v_mul_f32 v21, v21, v18
    s_waitcnt lgkmcnt(0)
    s_waitcnt vmcnt(0)
L_pw_106:
    v_max3_u32 v19, v12, v13, v14
    v_max3_u32 v19, v19, v15, v16
    v_max_u32 v19, v19, v17
    v_cmp_eq_u32 vcc, -1, v19
    s_cbranch_vccnz L_pr_107
    v_smfmac_f32_16x16x64_bf16 v[24:27], v[12:15], v[36:43], v1
    v_smfmac_f32_16x16x64_bf16 v[28:31], v[12:15], v[48:55], v1
    v_smfmac_f32_16x16x32_bf16 v[24:27], v[16:17], v[44:47], v1
    v_smfmac_f32_16x16x32_bf16 v[28:31], v[16:17], v[56:59], v1
    s_nop 6
    v_pk_add_f32 v[24:25], v[24:25], v[26:27]
    v_pk_add_f32 v[28:29], v[28:29], v[30:31]
    v_mul_f32 v24, v24, v20
    v_mul_f32 v28, v28, v20
    v_fmac_f32 v24, v25, v21
    v_fmac_f32 v28, v29, v21
    s_nop 1
    v_permlane32_swap_b32 v24, v28
    v_add_f32 v24, v24, v28
    ds_write_b32 v11, v24
    v_lshlrev_b32 v5, 2, v0
    v_add_u32 v5, 157696, v5
    s_mul_i32 s59, s31, 2560
    s_lshl_b32 s58, s52, 7
    s_add_u32 s59, s59, s58
    s_add_u32 s59, s59, 1114048
    v_lshlrev_b32 v9, 2, v0
    s_waitcnt lgkmcnt(0)
    s_barrier
    s_cmp_eq_u32 s30, 2
    s_cbranch_scc0 L_skip_108
    ds_read2st64_b32 v[12:13], v5 offset0:0 offset1:1
    ds_read2st64_b32 v[14:15], v5 offset0:2 offset1:3
    ds_read2st64_b32 v[16:17], v5 offset0:4 offset1:5
    ds_read2st64_b32 v[18:19], v5 offset0:6 offset1:7
    s_waitcnt lgkmcnt(2)
    v_pk_add_f32 v[12:13], v[12:13], v[14:15]
    s_waitcnt lgkmcnt(0)
    v_pk_add_f32 v[16:17], v[16:17], v[18:19]
    v_pk_add_f32 v[12:13], v[12:13], v[16:17]
    v_add_f32 v12, v12, v13
    v_mov_b32 v13, v12
    s_nop 1
    v_permlane16_swap_b32 v12, v13
    v_add_f32 v12, v12, v13
    v_min_u32 v12, -2, v12
    s_mov_b32 exec_lo, 0xffff0000
    s_mov_b32 exec_hi, 0xffff
    buffer_store_dword v12, v9, s[40:43], s59 offen sc1
    s_lshl_b32 s57, s52, 2
    s_add_u32 s57, s57, s62
    s_add_u32 s57, s57, 38144
    s_mov_b64 exec, 0x1
    s_cmp_eq_u32 s55, 0
    s_cbranch_scc1 L_gs_109
    buffer_store_dword v0, v0, s[40:43], s57 offen
L_gb_110:
    s_mov_b64 exec, -1
L_skip_108:
    s_sub_u32 s57, s30, 5
    s_cmp_lt_u32 s57, 2
    s_cbranch_scc0 L_skip_111
    s_sub_u32 s60, s30, 5
    s_mul_i32 s59, s60, 6144
    s_add_u32 s59, s59, 79872
    s_mov_b32 s44, s20
    s_mov_b32 s45, s21
    s_mov_b32 s46, 1966080
L_pad3:
    s_cbranch_execz L_pad4
    s_mov_b32 s47, 0x20000
    s_mul_i32 s57, s31, 245760
    s_lshl_b32 s58, s52, 6
    s_add_u32 s57, s57, s58
    s_lshl_b32 s58, s60, 5
    s_add_u32 s57, s57, s58
    v_lshrrev_b32 v5, 1, v0
    v_mul_u32_u24 v5, 1280, v5
    v_and_b32 v60, 1, v0
    v_lshl_add_u32 v5, v60, 4, v5
    v_add_u32 v5, s57, v5
    s_add_u32 m0, s59, 0
    s_mov_b32 s57, 0
    buffer_load_dwordx4 v5, s[44:47], s57 offen nt lds
    s_add_u32 m0, s59, 1024
    s_mov_b32 s57, 40960
    buffer_load_dwordx4 v5, s[44:47], s57 offen nt lds
    s_add_u32 m0, s59, 2048
    s_mov_b32 s57, 81920
    buffer_load_dwordx4 v5, s[44:47], s57 offen nt lds
    s_add_u32 m0, s59, 3072
    s_mov_b32 s57, 122880
    buffer_load_dwordx4 v5, s[44:47], s57 offen nt lds
    s_add_u32 m0, s59, 4096
    s_mov_b32 s57, 163840
    buffer_load_dwordx4 v5, s[44:47], s57 offen nt lds
    s_add_u32 m0, s59, 5120
    s_mov_b32 s57, 204800
    buffer_load_dwordx4 v5, s[44:47], s57 offen nt lds
    v_lshrrev_b32 v7, 5, v0
    v_lshlrev_b32 v7, 9, v7
    v_bfe_u32 v60, v0, 4, 1
    v_lshl_add_u32 v7, v60, 7, v7
    v_bfe_u32 v60, v0, 3, 1
    v_lshl_add_u32 v7, v60, 8, v7
    v_bfe_u32 v60, v0, 2, 1
    v_lshl_add_u32 v7, v60, 5, v7
    v_and_b32 v60, 3, v0
    v_lshl_add_u32 v7, v60, 3, v7
    v_add_u32 v7, s59, v7
    s_add_u32 s59, s62, 37120
    v_lshrrev_b32 v5, 4, v0
    v_lshlrev_b32 v5, 5, v5
    v_bfe_u32 v60, v0, 1, 1
    v_lshl_add_u32 v5, v60, 4, v5
    v_mov_b64 v[24:25], 0
    v_mov_b64 v[26:27], 0
    s_mul_i32 s57, s31, 2560
    s_lshl_b32 s58, s52, 7
    s_add_u32 s57, s57, s58
    s_lshl_b32 s60, s60, 6
    s_add_u32 s60, s60, s57
    s_add_u32 s60, s60, 1134592
    v_lshlrev_b32 v9, 2, v0
    s_waitcnt vmcnt(0)
    ds_read_b64_tr_b16 v[36:37], v7 offset:0
    ds_read_b64_tr_b16 v[38:39], v7 offset:64
    ds_read_b64_tr_b16 v[40:41], v7 offset:1024
    ds_read_b64_tr_b16 v[42:43], v7 offset:1088
    ds_read_b64_tr_b16 v[44:45], v7 offset:2048
    ds_read_b64_tr_b16 v[46:47], v7 offset:2112
    ds_read_b64_tr_b16 v[48:49], v7 offset:3072
    ds_read_b64_tr_b16 v[50:51], v7 offset:3136
    ds_read_b64_tr_b16 v[52:53], v7 offset:4096
    ds_read_b64_tr_b16 v[54:55], v7 offset:4160
    ds_read_b64_tr_b16 v[56:57], v7 offset:5120
    ds_read_b64_tr_b16 v[58:59], v7 offset:5184
    buffer_load_dwordx4 v[12:15], v5, s[40:43], s59 offen offset:0 sc1
    buffer_load_dwordx4 v[16:19], v5, s[40:43], s59 offen offset:128 sc1
    buffer_load_dwordx4 v[20:23], v5, s[40:43], s59 offen offset:256 sc1
    s_waitcnt lgkmcnt(0)
    s_waitcnt vmcnt(0)
L_pw_112:
    v_max3_u32 v28, v12, v13, v14
    v_max3_u32 v28, v28, v15, v16
    v_max3_u32 v28, v28, v17, v18
    v_max3_u32 v28, v28, v19, v20
L_pad4:
    s_cbranch_execz L_pad5
    v_max3_u32 v28, v28, v21, v22
    v_max_u32 v28, v28, v23
    v_cmp_eq_u32 vcc, -1, v28
    s_cbranch_vccnz L_pr_113
    v_smfmac_f32_16x16x64_bf16 v[24:27], v[12:15], v[36:43], v1
    v_smfmac_f32_16x16x64_bf16 v[24:27], v[16:19], v[44:51], v1
    v_smfmac_f32_16x16x64_bf16 v[24:27], v[20:23], v[52:59], v1
    s_nop 7
    v_add_f32 v24, v24, v26
    v_min_u32 v24, -2, v24
    s_mov_b64 exec, 0xffff
    buffer_store_dword v24, v9, s[40:43], s60 offen sc1
    s_cmp_eq_u32 s30, 6
    s_cbranch_scc0 L_skip_114
    s_lshl_b32 s57, s52, 2
    s_add_u32 s57, s57, s62
    s_add_u32 s57, s57, 38272
    s_mov_b64 exec, 0x1
    s_cmp_eq_u32 s55, 0
    s_cbranch_scc1 L_gs_115
    buffer_store_dword v0, v0, s[40:43], s57 offen
L_gb_116:
    s_mov_b64 exec, -1
L_skip_114:
    s_mov_b64 exec, -1
L_skip_111:
    s_branch L_p1
L_typeB_0:
    s_cmp_lt_u32 s30, 5
    s_cbranch_scc0 L_skip_117
    s_mul_i32 s57, s30, 4096
    v_lshrrev_b32 v10, 4, v0
    v_lshlrev_b32 v10, 10, v10
    v_bfe_u32 v60, v0, 3, 1
    v_lshl_add_u32 v10, v60, 8, v10
    v_bfe_u32 v60, v0, 1, 1
    v_lshl_add_u32 v10, v60, 7, v10
    v_bfe_u32 v60, v0, 2, 1
    v_lshl_add_u32 v10, v60, 5, v10
    v_and_b32 v60, 1, v0
    v_lshl_add_u32 v10, v60, 3, v10
    v_add_u32 v10, s57, v10
    v_add_u32 v10, 30720, v10
    ds_read_b64_tr_b16 v[36:37], v10 offset:0
    ds_read_b64_tr_b16 v[38:39], v10 offset:512
    ds_read_b64_tr_b16 v[40:41], v10 offset:64
    ds_read_b64_tr_b16 v[42:43], v10 offset:576
    ds_read_b64_tr_b16 v[44:45], v10 offset:16
    ds_read_b64_tr_b16 v[46:47], v10 offset:528
    ds_read_b64_tr_b16 v[48:49], v10 offset:80
    ds_read_b64_tr_b16 v[50:51], v10 offset:592
    s_lshl_b32 s57, s30, 10
    v_lshlrev_b32 v11, 4, v0
    v_add_u32 v11, s57, v11
    v_add_u32 v11, 157696, v11
    v_mov_b32 v32, 0x3f803f80
    v_mov_b32 v33, 0x3f803f80
    v_mov_b32 v34, 0x3f803f80
    v_mov_b32 v35, 0x3f803f80
    v_mov_b32 v61, 0x3f803f80
    s_lshl_b32 s57, s30, 9
    v_lshrrev_b32 v5, 5, v0
    v_mul_u32_u24 v5, 2560, v5
    v_and_b32 v60, 31, v0
    v_lshl_add_u32 v5, v60, 4, v5
    v_add_u32 v5, s57, v5
    s_add_u32 s57, s62, 38144
    v_min_u32 v9, 19, v0
    v_lshlrev_b32 v9, 2, v9
    buffer_load_dword v12, v9, s[40:43], s57 offen sc1
    s_waitcnt vmcnt(0)
L_pw_118:
    v_cmp_eq_u32 vcc, -1, v12
    s_cbranch_vccnz L_pr_119
    s_mov_b32 s57, 1114112
    buffer_load_dwordx4 v[12:15], v5, s[40:43], s57 offen sc1
    s_mov_b32 s58, 1119232
    buffer_load_dwordx4 v[16:19], v5, s[40:43], s58 offen sc1
    s_mov_b32 s59, 1124352
    buffer_load_dwordx4 v[20:23], v5, s[40:43], s59 offen sc1
    s_mov_b32 s60, 1129472
    buffer_load_dwordx4 v[24:27], v5, s[40:43], s60 offen sc1
L_gw_120:
    s_waitcnt vmcnt(2)
    v_pk_add_f32 v[28:29], v[12:13], v[16:17]
    v_pk_add_f32 v[30:31], v[14:15], v[18:19]
    s_waitcnt vmcnt(1)
    v_pk_add_f32 v[28:29], v[28:29], v[20:21]
L_pad5:
    s_cbranch_execz L_pad6
    v_pk_add_f32 v[30:31], v[30:31], v[22:23]
    s_waitcnt vmcnt(0)
    v_pk_add_f32 v[28:29], v[28:29], v[24:25]
    v_pk_add_f32 v[30:31], v[30:31], v[26:27]
    s_nop 1
    v_permlane32_swap_b32 v28, v30
    v_permlane32_swap_b32 v29, v31
    v_pk_add_f32 v[28:29], v[28:29], v[30:31]
    v_pk_add_f32 v[28:29], v[28:29], v[2:3]
    v_cmp_u_f32 vcc, v28, v29
    s_cbranch_vccnz L_gr_121
L_gk_122:
    v_cvt_pk_bf16_f32 v28, v28, v29
    v_mov_b64 v[12:13], 0
    v_mov_b64 v[14:15], 0
    v_mov_b32_dpp v32, v28 quad_perm:[0,1,2,3] row_mask:0xf bank_mask:0x1
    v_mov_b32_dpp v33, v28 row_shl:4 row_mask:0xf bank_mask:0x1
    v_mov_b32_dpp v34, v28 row_shl:8 row_mask:0xf bank_mask:0x1
    v_mov_b32_dpp v35, v28 row_shl:12 row_mask:0xf bank_mask:0x1
    v_dot2_f32_bf16 v27, v28, v61, 0
    v_dot2_f32_bf16 v62, v28, v28, 0
    s_waitcnt lgkmcnt(0)
    v_smfmac_f32_16x16x64_bf16 v[12:15], v[32:35], v[36:43], v1
    v_mov_b64 v[16:17], 0
    v_mov_b64 v[18:19], 0
    v_permlane32_swap_b32 v27, v62
    s_nop 0
    v_smfmac_f32_16x16x64_bf16 v[16:19], v[32:35], v[44:51], v1
    v_add_f32 v27, v27, v62
    v_mov_b32 v62, v27
    s_nop 1
    v_permlane16_swap_b32 v27, v62
    v_add_f32 v27, v27, v62
    v_lshlrev_b32 v2, 16, v28
    v_and_b32 v3, 0xffff0000, v28
    v_add_f32_dpp v27, v27, v27 row_ror:8 row_mask:0xf bank_mask:0xf
    v_pk_add_f32 v[12:13], v[12:13], v[14:15]
    v_pk_add_f32 v[16:17], v[16:17], v[18:19]
    v_add_f32_dpp v27, v27, v27 row_ror:4 row_mask:0xf bank_mask:0xf
    v_add_f32_dpp v24, v13, v12 row_shl:8 row_mask:0xf bank_mask:0xf bound_ctrl:0
    v_add_f32_dpp v25, v17, v16 row_shl:8 row_mask:0xf bank_mask:0xf bound_ctrl:0
    v_add_f32_dpp v27, v27, v27 row_ror:2 row_mask:0xf bank_mask:0xf
    s_nop 1
    v_add_f32_dpp v27, v27, v27 row_ror:1 row_mask:0xf bank_mask:0xf
    ds_write_b128 v11, v[24:27]
    s_waitcnt lgkmcnt(0)
L_skip_117:
    s_cmp_eq_u32 s30, 5
    s_cbranch_scc0 L_skip_127
    v_and_b32 v10, 7, v0
    v_lshlrev_b32 v10, 4, v10
    v_bfe_u32 v60, v0, 3, 2
    v_lshl_add_u32 v10, v60, 2, v10
    v_lshrrev_b32 v60, 5, v0
    v_lshl_add_u32 v10, v60, 8, v10
    v_add_u32 v10, 157696, v10
    v_mov_b32 v60, 158220
    v_cmp_eq_u32 vcc, 25, v0
    s_nop 1
    v_cndmask_b32 v10, v10, v60, vcc
    s_sub_u32 s59, s52, 20
    s_lshl_b32 s59, s59, 5
    s_add_u32 s59, s59, s62
    s_add_u32 s59, s59, 37120
    v_lshlrev_b32 v11, 1, v0
    v_mov_b32 v18, 0xc0135761
    v_mov_b32 v19, 0xbdd2d3e8
L_skip_127:
    s_barrier
    s_cmp_eq_u32 s30, 5
    s_cbranch_scc0 L_skip_128
    ds_read2st64_b32 v[12:13], v10 offset0:0 offset1:4
    ds_read2st64_b32 v[14:15], v10 offset0:8 offset1:12
    ds_read_b32 v16, v10 offset:4096
    s_waitcnt lgkmcnt(1)
    v_pk_add_f32 v[12:13], v[12:13], v[14:15]
    s_waitcnt lgkmcnt(0)
    v_add_f32 v12, v12, v16
    v_add_f32 v12, v12, v13
    v_mov_b32 v14, 0x3acccccd
    v_readlane_b32 s57, v12, 24
    v_readlane_b32 s58, v12, 25
    v_permlane32_swap_b32 v12, v13
    v_mul_f32 v15, s57, v14
    v_mul_f32 v16, s58, v14
    v_fma_f32 v16, -v15, v15, v16
    v_max_f32 v16, 0, v16
    v_add_f32 v16, 0x3727c5ac, v16
L_pad6:
    s_cbranch_execz L_pad7
    v_rsq_f32 v16, v16
    v_fma_f32 v12, -v15, v13, v12
    v_mul_f32 v12, v12, v16
    v_add_f32 v12, v12, v4
    v_mul_f32 v13, v12, v12
    v_fma_f32 v13, v13, v19, v18
    v_mul_f32 v13, v13, v12
    v_exp_f32 v13, v13
    s_nop 0
    v_add_f32 v13, 1.0, v13
    v_rcp_f32 v13, v13
    s_nop 0
    v_mul_f32 v12, v12, v13
    s_nop 1
    v_mov_b32_dpp v13, v12 row_shl:1 row_mask:0xf bank_mask:0xf bound_ctrl:0
    v_cvt_pk_bf16_f32 v12, v12, v13
    v_min_u32 v12, -2, v12
    s_mov_b64 exec, 0x5555
    s_cmp_eq_u32 s55, 0
    s_cbranch_scc1 L_gs_129
    buffer_store_dword v12, v11, s[40:43], s59 offen
L_gb_130:
    s_mov_b64 exec, -1
L_skip_128:
L_p1:
    s_cmp_lt_u32 s30, 6
    s_cbranch_scc0 L_skip_131
    s_lshr_b32 s57, s30, 1
    s_lshl_b32 s57, s57, 10
    s_and_b32 s58, s30, 1
    s_lshl_b32 s58, s58, 6
    s_add_u32 s57, s57, s58
    v_lshrrev_b32 v18, 5, v0
    v_mul_u32_u24 v18, 6144, v18
    v_bfe_u32 v60, v0, 3, 1
    v_mul_u32_u24 v60, 3072, v60
    v_add_u32 v18, v60, v18
    v_bfe_u32 v60, v0, 4, 1
    v_lshl_add_u32 v18, v60, 9, v18
    v_bfe_u32 v60, v0, 2, 1
    v_lshl_add_u32 v18, v60, 7, v18
    v_and_b32 v60, 3, v0
    v_lshl_add_u32 v18, v60, 3, v18
    v_add_u32 v18, s57, v18
    v_bfe_u32 v19, v0, 4, 1
    v_mul_u32_u24 v19, 3072, v19
    v_bfe_u32 v60, v0, 3, 1
    v_lshl_add_u32 v19, v60, 9, v19
    v_bfe_u32 v60, v0, 2, 1
    v_lshl_add_u32 v19, v60, 7, v19
    v_and_b32 v60, 3, v0
    v_lshl_add_u32 v19, v60, 3, v19
    v_add_u32 v19, s57, v19
    v_add_u32 v19, 24576, v19
    ds_read_b64_tr_b16 v[36:37], v18 offset:0
    ds_read_b64_tr_b16 v[38:39], v18 offset:256
    ds_read_b64_tr_b16 v[40:41], v18 offset:12288
    ds_read_b64_tr_b16 v[42:43], v18 offset:12544
    ds_read_b64_tr_b16 v[44:45], v19 offset:0
    ds_read_b64_tr_b16 v[46:47], v19 offset:256
    ds_read_b64_tr_b16 v[48:49], v18 offset:32
    ds_read_b64_tr_b16 v[50:51], v18 offset:288
    ds_read_b64_tr_b16 v[52:53], v18 offset:12320
    ds_read_b64_tr_b16 v[54:55], v18 offset:12576
    ds_read_b64_tr_b16 v[56:57], v19 offset:32
    ds_read_b64_tr_b16 v[58:59], v19 offset:288
    v_lshrrev_b32 v32, 4, v0
    v_lshlrev_b32 v32, 5, v32
    v_bfe_u32 v60, v0, 1, 1
    v_lshl_add_u32 v32, v60, 4, v32
    v_and_b32 v60, 1, v0
    v_mul_u32_u24 v60, 192, v60
    v_add_u32 v32, v60, v32
    v_add_u32 v32, 162944, v32
    v_lshrrev_b32 v33, 4, v0
    v_lshlrev_b32 v33, 4, v33
    v_bfe_u32 v60, v0, 1, 1
    v_lshl_add_u32 v33, v60, 3, v33
    v_and_b32 v60, 1, v0
    v_mul_u32_u24 v60, 192, v60
    v_add_u32 v33, v60, v33
    v_add_u32 v33, 163072, v33
    v_mov_b64 v[24:25], 0
    v_mov_b64 v[26:27], 0
    v_mov_b64 v[28:29], 0
    v_mov_b64 v[30:31], 0
    s_lshr_b32 s57, s54, 1
    s_lshl_b32 s57, s57, 2
L_pad7:
    s_cbranch_execz L_pad8
    s_and_b32 s58, s54, 1
    s_add_u32 s57, s57, s58
    s_lshl_b32 s57, s57, 4
    s_lshl_b32 s58, s30, 9
    s_add_u32 s57, s57, s58
    v_bfe_u32 v34, v0, 4, 1
    v_lshlrev_b32 v34, 8, v34
    v_bfe_u32 v60, v0, 1, 1
    v_lshl_add_u32 v34, v60, 5, v34
    v_bfe_u32 v60, v0, 2, 2
    v_lshl_add_u32 v34, v60, 2, v34
    v_lshrrev_b32 v60, 5, v0
    v_mul_u32_u24 v60, 3072, v60
    v_add_u32 v34, v60, v34
    v_add_u32 v34, s57, v34
    s_mul_i32 s59, s53, 3072
    s_add_u32 s59, s59, s62
    s_add_u32 s59, s59, 24576
    s_lshl_b32 s60, s53, 6
    s_add_u32 s60, s60, s62
    s_add_u32 s60, s60, 36864
L_skip_131:
    s_cmp_eq_u32 s30, 7
    s_cbranch_scc0 L_skip_132
    v_and_b32 v60, 31, v0
    v_min_u32 v60, 19, v60
    s_mul_i32 s57, s54, 320
    v_lshrrev_b32 v5, 5, v0
    v_mul_u32_u24 v5, 2560, v5
    v_add_u32 v5, s57, v5
    v_lshl_add_u32 v5, v60, 4, v5
    v_and_b32 v60, 31, v0
    v_cmp_gt_u32 s[64:65], 20, v60
    v_min_u32 v60, 19, v60
    v_lshrrev_b32 v35, 5, v0
    v_lshlrev_b32 v35, 2, v35
    v_add_u32 v35, 162944, v35
    v_lshl_add_u32 v35, v60, 3, v35
    s_mul_i32 s66, s53, 3072
    s_add_u32 s66, s66, s62
    s_add_u32 s66, s66, 24576
    s_lshl_b32 s67, s53, 6
    s_add_u32 s67, s67, s62
    s_add_u32 s67, s67, 36864
    s_lshl_b32 s57, s54, 3
    v_lshrrev_b32 v34, 5, v0
    v_lshlrev_b32 v34, 2, v34
    v_add_u32 v34, s57, v34
    v_mov_b32 v61, 0x3f803f80
    s_add_u32 s57, s62, 37120
    v_mov_b32 v9, 0
    buffer_load_dword v12, v9, s[40:43], s57 offen sc1
    s_waitcnt vmcnt(0)
L_pw_133:
    v_cmp_eq_u32 vcc, -1, v12
    s_cbranch_vccnz L_pr_134
    s_mov_b32 s57, 1114112
    buffer_load_dwordx4 v[12:15], v5, s[40:43], s57 offen sc1
    s_mov_b32 s58, 1119232
    buffer_load_dwordx4 v[16:19], v5, s[40:43], s58 offen sc1
    s_mov_b32 s59, 1124352
    buffer_load_dwordx4 v[20:23], v5, s[40:43], s59 offen sc1
    s_mov_b32 s60, 1129472
    buffer_load_dwordx4 v[24:27], v5, s[40:43], s60 offen sc1
L_gw_135:
    s_waitcnt vmcnt(2)
    v_pk_add_f32 v[28:29], v[12:13], v[16:17]
    v_pk_add_f32 v[30:31], v[14:15], v[18:19]
    s_waitcnt vmcnt(1)
    v_pk_add_f32 v[28:29], v[28:29], v[20:21]
    v_pk_add_f32 v[30:31], v[30:31], v[22:23]
    s_waitcnt vmcnt(0)
    v_pk_add_f32 v[28:29], v[28:29], v[24:25]
    v_pk_add_f32 v[30:31], v[30:31], v[26:27]
    s_nop 1
    v_permlane32_swap_b32 v28, v30
    v_permlane32_swap_b32 v29, v31
    v_pk_add_f32 v[28:29], v[28:29], v[30:31]
    v_pk_add_f32 v[28:29], v[28:29], v[2:3]
    v_cmp_u_f32 vcc, v28, v29
    s_cbranch_vccnz L_gr_136
L_gk_137:
    v_cvt_pk_bf16_f32 v28, v28, v29
    v_lshlrev_b32 v2, 16, v28
    v_and_b32 v3, 0xffff0000, v28
    v_lshlrev_b32 v60, 16, v4
    v_add_f32 v2, v2, v60
    v_and_b32 v60, 0xffff0000, v4
    v_add_f32 v3, v3, v60
    s_add_u32 s57, s62, 38272
L_pad8:
    s_cbranch_execz L_pad9
    v_min_u32 v9, 19, v0
    v_lshlrev_b32 v9, 2, v9
    buffer_load_dword v12, v9, s[40:43], s57 offen sc1
    s_waitcnt vmcnt(0)
L_pw_142:
    v_cmp_eq_u32 vcc, -1, v12
    s_cbranch_vccnz L_pr_143
    s_mov_b32 s57, 1134592
    buffer_load_dwordx4 v[12:15], v5, s[40:43], s57 offen sc1
    s_mov_b32 s58, 1139712
    buffer_load_dwordx4 v[16:19], v5, s[40:43], s58 offen sc1
    s_mov_b32 s59, 1144832
    buffer_load_dwordx4 v[20:23], v5, s[40:43], s59 offen sc1
    s_mov_b32 s60, 1149952
    buffer_load_dwordx4 v[24:27], v5, s[40:43], s60 offen sc1
L_gw_144:
    s_waitcnt vmcnt(2)
    v_pk_add_f32 v[28:29], v[12:13], v[16:17]
    v_pk_add_f32 v[30:31], v[14:15], v[18:19]
    s_waitcnt vmcnt(1)
    v_pk_add_f32 v[28:29], v[28:29], v[20:21]
    v_pk_add_f32 v[30:31], v[30:31], v[22:23]
    s_waitcnt vmcnt(0)
    v_pk_add_f32 v[28:29], v[28:29], v[24:25]
    v_pk_add_f32 v[30:31], v[30:31], v[26:27]
    s_nop 1
    v_permlane32_swap_b32 v28, v30
    v_permlane32_swap_b32 v29, v31
    v_pk_add_f32 v[28:29], v[28:29], v[30:31]
    v_pk_add_f32 v[28:29], v[28:29], v[2:3]
    v_cmp_u_f32 vcc, v28, v29
    s_cbranch_vccnz L_gr_145
L_gk_146:
    v_cvt_pk_bf16_f32 v28, v28, v29
    ds_write_b32 v35, v28
    s_waitcnt lgkmcnt(0)
L_skip_132:
    s_barrier
    s_cmp_lt_u32 s30, 6
    s_cbranch_scc0 L_skip_151
    ds_read_b128 v[12:15], v32
    ds_read_b64 v[16:17], v33
    s_waitcnt lgkmcnt(1)
    v_smfmac_f32_16x16x64_bf16 v[24:27], v[12:15], v[36:43], v1
    v_smfmac_f32_16x16x64_bf16 v[28:31], v[12:15], v[48:55], v1
    s_waitcnt lgkmcnt(0)
    v_smfmac_f32_16x16x32_bf16 v[24:27], v[16:17], v[44:47], v1
    v_smfmac_f32_16x16x32_bf16 v[28:31], v[16:17], v[56:59], v1
    s_nop 6
    v_add_f32 v12, v24, v26
    s_nop 1
    v_add_f32_dpp v12, v28, v30 quad_perm:[0,1,2,3] row_mask:0x2 bank_mask:0xf
    s_nop 1
    v_mov_b32_dpp v13, v12 row_shl:1 row_mask:0xf bank_mask:0xf bound_ctrl:0
    v_cvt_pk_bf16_f32 v12, v12, v13
    v_min_u32 v12, -2, v12
    s_mov_b64 exec, 0x55555555
    s_cmp_eq_u32 s55, 0
    s_cbranch_scc1 L_gs_152
    buffer_store_dword v12, v34, s[40:43], s59 offen
L_gb_153:
    s_mov_b64 exec, -1
L_skip_151:
    s_cmp_eq_u32 s30, 7
    s_cbranch_scc0 L_skip_154
    v_lshlrev_b32 v2, 16, v28
    v_and_b32 v3, 0xffff0000, v28
    v_cndmask_b32 v28, 0, v28, s[64:65]
    v_dot2_f32_bf16 v27, v28, v61, 0
    v_dot2_f32_bf16 v62, v28, v28, 0
    s_nop 2
    v_permlane32_swap_b32 v27, v62
    v_add_f32 v27, v27, v62
    v_mov_b32 v62, v27
    s_nop 1
    v_permlane16_swap_b32 v27, v62
    v_add_f32 v27, v27, v62
    s_nop 1
    v_add_f32_dpp v27, v27, v27 row_ror:8 row_mask:0xf bank_mask:0xf
    s_nop 1
    v_add_f32_dpp v27, v27, v27 row_ror:4 row_mask:0xf bank_mask:0xf
    s_nop 1
    v_add_f32_dpp v27, v27, v27 row_ror:2 row_mask:0xf bank_mask:0xf
    s_nop 1
    v_add_f32_dpp v27, v27, v27 row_ror:1 row_mask:0xf bank_mask:0xf
    v_min_u32 v27, -2, v27
    s_mov_b32 exec_lo, 0x1
    s_mov_b32 exec_hi, 0x1
    s_cmp_eq_u32 s55, 0
    s_cbranch_scc1 L_gs_155
    buffer_store_dword v27, v34, s[40:43], s67 offen
L_gb_156:
    s_mov_b64 exec, -1
L_skip_154:
    s_mul_i32 s59, s53, 3072
L_pad9:
    s_cbranch_execz L_pad10
    s_add_u32 s59, s59, s62
    s_add_u32 s59, s59, 24576
    s_lshl_b32 s60, s53, 6
    s_add_u32 s60, s60, s62
    s_add_u32 s60, s60, 36864
    v_lshlrev_b32 v5, 4, v0
    v_add_u32 v5, s59, v5
    v_and_b32 v7, 7, v0
    v_lshlrev_b32 v7, 3, v7
    v_add_u32 v7, s60, v7
    buffer_load_dwordx2 v[8:9], v7, s[40:43], 0 offen sc1
    buffer_load_dwordx4 v[12:15], v5, s[40:43], 0 offen offset:0 sc1
    buffer_load_dwordx4 v[16:19], v5, s[40:43], 0 offen offset:1024 sc1
    buffer_load_dwordx4 v[20:23], v5, s[40:43], 0 offen offset:2048 sc1
    v_mov_b64 v[24:25], 0
    v_mov_b64 v[26:27], 0
    v_mov_b64 v[28:29], 0
    v_mov_b64 v[30:31], 0
    v_mov_b64 v[32:33], 0
    v_mov_b64 v[34:35], 0
    v_mov_b64 v[36:37], 0
    v_mov_b64 v[38:39], 0
    v_mov_b64 v[40:41], 0
    v_mov_b64 v[42:43], 0
    v_mov_b64 v[44:45], 0
    v_mov_b64 v[46:47], 0
    v_mov_b64 v[48:49], 0
    v_mov_b64 v[50:51], 0
    v_mov_b64 v[52:53], 0
    v_mov_b64 v[54:55], 0
    v_mov_b64 v[56:57], 0
    v_mov_b64 v[58:59], 0
    v_mov_b64 v[60:61], 0
    v_mov_b64 v[62:63], 0
    s_lshl_b32 s58, s30, 3
    s_add_u32 s58, s58, 162816
    v_mov_b32 v10, s58
    s_waitcnt vmcnt(0)
L_pw_157:
    v_max3_u32 v11, v8, v9, v12
    v_max3_u32 v11, v11, v13, v14
    v_max3_u32 v11, v11, v15, v16
    v_max3_u32 v11, v11, v17, v18
    v_max3_u32 v11, v11, v19, v20
    v_max3_u32 v11, v11, v21, v22
    v_max_u32 v11, v11, v23
    v_cmp_eq_u32 vcc, -1, v11
    s_cbranch_vccnz L_pr_158
    v_smfmac_f32_16x16x64_bf16 v[24:27], v[12:15], v[64:71], v1
    v_add_f32_dpp v8, v8, v8 row_ror:4 row_mask:0xf bank_mask:0xf
    v_add_f32_dpp v9, v9, v9 row_ror:4 row_mask:0xf bank_mask:0xf
    v_smfmac_f32_16x16x64_bf16 v[24:27], v[16:19], v[72:79], v1
    v_add_f32_dpp v8, v8, v8 row_ror:2 row_mask:0xf bank_mask:0xf
    v_add_f32_dpp v9, v9, v9 row_ror:2 row_mask:0xf bank_mask:0xf
    v_smfmac_f32_16x16x64_bf16 v[24:27], v[20:23], v[80:87], v1
    v_add_f32_dpp v8, v8, v8 row_ror:1 row_mask:0xf bank_mask:0xf
    v_add_f32_dpp v9, v9, v9 row_ror:1 row_mask:0xf bank_mask:0xf
    v_smfmac_f32_16x16x64_bf16 v[32:35], v[12:15], v[112:119], v1
    v_mul_f32 v8, 0x3acccccd, v8
    v_mul_f32 v9, 0x3acccccd, v9
    v_smfmac_f32_16x16x64_bf16 v[32:35], v[16:19], v[120:127], v1
    v_fma_f32 v9, -v8, v8, v9
    v_max_f32 v9, 0, v9
    v_smfmac_f32_16x16x64_bf16 v[32:35], v[20:23], v[128:135], v1
    v_add_f32 v9, 0x3727c5ac, v9
    v_rsq_f32 v9, v9
    v_smfmac_f32_16x16x64_bf16 v[28:31], v[12:15], v[88:95], v1
    s_mov_b32 vcc_lo, 0x55555555
    v_mul_f32 v9, 0x3dd53b95, v9
    v_smfmac_f32_16x16x64_bf16 v[28:31], v[16:19], v[96:103], v1
    s_mov_b32 vcc_hi, 0x55555555
    v_smfmac_f32_16x16x64_bf16 v[28:31], v[20:23], v[104:111], v1
    v_smfmac_f32_16x16x64_bf16 v[36:39], v[12:15], v[136:143], v1
    v_pk_add_f32 v[24:25], v[24:25], v[26:27]
    v_add_f32 v24, v24, v25
    v_smfmac_f32_16x16x64_bf16 v[36:39], v[16:19], v[144:151], v1
    v_pk_add_f32 v[32:33], v[32:33], v[34:35]
    v_add_f32 v32, v32, v33
    v_smfmac_f32_16x16x64_bf16 v[36:39], v[20:23], v[152:159], v1
    s_nop 0
    v_permlane32_swap_b32 v24, v32
    v_add_f32 v24, v24, v32
    v_pk_add_f32 v[28:29], v[28:29], v[30:31]
    v_add_f32 v28, v28, v29
    s_nop 2
    v_pk_add_f32 v[36:37], v[36:37], v[38:39]
L_pad10:
    s_cbranch_execz L_pad11
    v_add_f32 v36, v36, v37
    s_nop 1
    v_permlane32_swap_b32 v28, v36
    v_add_f32 v28, v28, v36
    s_nop 1
    v_permlane16_swap_b32 v24, v28
    v_add_f32 v24, v24, v28
    v_fma_f32 v24, -v8, v6, v24
    s_nop 1
    v_max_f32_dpp v21, v24, v24 row_ror:8 row_mask:0xf bank_mask:0xf
    s_nop 1
    v_max_f32_dpp v21, v21, v21 row_ror:4 row_mask:0xf bank_mask:0xf
    s_nop 1
    v_max_f32_dpp v21, v21, v21 row_ror:2 row_mask:0xf bank_mask:0xf
    s_nop 1
    v_max_f32_dpp v21, v21, v21 row_ror:1 row_mask:0xf bank_mask:0xf
    s_nop 1
    v_max_f32_dpp v21, v21, v21 row_bcast:15 row_mask:0xa bank_mask:0xf
    s_nop 1
    v_max_f32_dpp v21, v21, v21 row_bcast:31 row_mask:0xc bank_mask:0xf
    s_nop 0
    v_readlane_b32 s57, v21, 63
    s_nop 1
    v_subrev_f32 v24, s57, v24
    v_mul_f32 v24, v24, v9
    v_exp_f32 v22, v24
    v_mul_f32 v20, s57, v9
    s_nop 0
    v_mov_b32_dpp v23, v22 row_shl:1 row_mask:0xf bank_mask:0xf bound_ctrl:0
    v_cvt_pk_bf16_f32 v23, v22, v23
    v_cndmask_b32 v12, 0, v23, vcc
    v_mov_b32 v21, v22
    s_nop 0
    v_mov_b32_dpp v13, v12 row_shl:4 row_mask:0xf bank_mask:0xf bound_ctrl:0
    v_mov_b32_dpp v14, v12 row_shl:8 row_mask:0xf bank_mask:0xf bound_ctrl:0
    v_mov_b32_dpp v15, v12 row_shl:12 row_mask:0xf bank_mask:0xf bound_ctrl:0
    s_nop 1
    v_smfmac_f32_16x16x64_bf16 v[40:43], v[12:15], v[160:167], v1
    v_mov_b32_dpp v16, v12 row_shr:1 row_mask:0xf bank_mask:0xf bound_ctrl:0
    v_mov_b32_dpp v17, v12 row_shl:3 row_mask:0xf bank_mask:0xf bound_ctrl:0
    v_smfmac_f32_16x16x64_bf16 v[44:47], v[12:15], v[176:183], v1
    v_mov_b32_dpp v18, v12 row_shl:7 row_mask:0xf bank_mask:0xf bound_ctrl:0
    v_mov_b32_dpp v19, v12 row_shl:11 row_mask:0xf bank_mask:0xf bound_ctrl:0
    v_smfmac_f32_16x16x64_bf16 v[48:51], v[12:15], v[192:199], v1
    v_permlane32_swap_b32 v21, v22
    v_add_f32 v21, v21, v22
    v_smfmac_f32_16x16x64_bf16 v[52:55], v[12:15], v[208:215], v1
    v_mov_b32 v22, v21
    s_nop 1
    v_permlane16_swap_b32 v21, v22
    v_smfmac_f32_16x16x64_bf16 v[56:59], v[12:15], v[224:231], v1
    v_add_f32 v21, v21, v22
    s_nop 1
    v_add_f32_dpp v21, v21, v21 row_ror:8 row_mask:0xf bank_mask:0xf
    v_smfmac_f32_16x16x64_bf16 v[60:63], v[12:15], v[240:247], v1
    s_nop 0
    v_add_f32_dpp v21, v21, v21 row_ror:4 row_mask:0xf bank_mask:0xf
    s_nop 1
    v_add_f32_dpp v21, v21, v21 row_ror:2 row_mask:0xf bank_mask:0xf
    v_smfmac_f32_16x16x64_bf16 v[40:43], v[16:19], v[168:175], v1
    s_nop 0
    v_add_f32_dpp v21, v21, v21 row_ror:1 row_mask:0xf bank_mask:0xf
    ds_write_b64 v10, v[20:21]
    v_smfmac_f32_16x16x64_bf16 v[44:47], v[16:19], v[184:191], v1
    v_and_b32 v36, 15, v0
    v_lshlrev_b32 v36, 4, v36
    v_add_u32 v36, s61, v36
    v_add_u32 v36, 32768, v36
    v_smfmac_f32_16x16x64_bf16 v[48:51], v[16:19], v[200:207], v1
    v_smfmac_f32_16x16x64_bf16 v[52:55], v[16:19], v[216:223], v1
    s_cmp_ge_u32 s30, 4
    s_cbranch_scc0 L_skip_159
    s_waitcnt lgkmcnt(0)
    s_barrier
L_skip_159:
    v_smfmac_f32_16x16x64_bf16 v[56:59], v[16:19], v[232:239], v1
    v_smfmac_f32_16x16x64_bf16 v[60:63], v[16:19], v[248:255], v1
    v_pk_add_f32 v[24:25], v[40:41], v[42:43]
    v_pk_add_f32 v[26:27], v[44:45], v[46:47]
    s_nop 0
    v_pk_add_f32 v[28:29], v[48:49], v[50:51]
    v_pk_add_f32 v[30:31], v[52:53], v[54:55]
    s_nop 1
    v_pk_add_f32 v[32:33], v[56:57], v[58:59]
    v_pk_add_f32 v[34:35], v[60:61], v[62:63]
    s_mov_b64 exec, 0xffff
L_pad11:
    s_cbranch_execz L_pad12
    ds_write_b128 v36, v[24:27] offset:0
    ds_write_b128 v36, v[28:31] offset:256
    ds_write_b128 v36, v[32:35] offset:512
    s_mov_b64 exec, -1
    s_cmp_lt_u32 s30, 4
    s_cbranch_scc1 L_old
    s_waitcnt lgkmcnt(0)
L_b2_1:
    s_barrier
    s_cmp_lt_u32 s30, 2
    s_cbranch_scc0 L_skip_163
    s_mov_b32 exec_lo, 0xffffffff
    s_mov_b32 exec_hi, 0xffff
    ds_read_b64 v[40:41], v20 offset:0
    ds_read_b64 v[42:43], v20 offset:2048
    ds_read_b64 v[44:45], v20 offset:4096
    ds_read_b64 v[46:47], v20 offset:6144
    ds_read_b64 v[48:49], v20 offset:8192
    ds_read_b64 v[50:51], v20 offset:10240
    ds_read_b64 v[52:53], v20 offset:12288
    ds_read_b64 v[54:55], v20 offset:14336
    s_waitcnt lgkmcnt(7)
    v_mul_f32 v56, s64, v40
    v_mul_f32 v57, s64, v41
    s_waitcnt lgkmcnt(6)
    v_fmac_f32 v56, s65, v42
    v_fmac_f32 v57, s65, v43
    s_waitcnt lgkmcnt(5)
    v_fmac_f32 v56, s66, v44
    v_fmac_f32 v57, s66, v45
    s_waitcnt lgkmcnt(4)
    v_fmac_f32 v56, s67, v46
    v_fmac_f32 v57, s67, v47
    s_waitcnt lgkmcnt(3)
    v_fmac_f32 v56, s68, v48
    v_fmac_f32 v57, s68, v49
    s_waitcnt lgkmcnt(2)
    v_fmac_f32 v56, s69, v50
    v_fmac_f32 v57, s69, v51
    s_waitcnt lgkmcnt(1)
    v_fmac_f32 v56, s70, v52
    v_fmac_f32 v57, s70, v53
    s_waitcnt lgkmcnt(0)
    v_fmac_f32 v56, s71, v54
    v_fmac_f32 v57, s71, v55
    v_cvt_pk_bf16_f32 v56, v56, v57
    v_min_u32 v56, -2, v56
    s_cmp_eq_u32 s55, 0
    s_cbranch_scc1 L_gs_164
    buffer_store_dword v56, v21, s[40:43], 0 offen
L_gb_165:
    s_mov_b64 exec, -1
L_skip_163:
    s_cmp_lt_u32 s52, 20
    s_cbranch_scc0 L_typeB_1
    s_lshr_b32 s57, s30, 1
    s_lshl_b32 s57, s57, 5
    s_add_u32 s57, s57, s62
    s_add_u32 s59, s57, 38016
    v_and_b32 v5, 7, v0
    v_lshlrev_b32 v5, 2, v5
    v_lshrrev_b32 v22, 4, v0
    v_lshlrev_b32 v22, 3, v22
    buffer_load_dword v18, v5, s[40:43], s59 offen sc1
    buffer_load_dwordx2 v[20:21], v22, s[40:43], s59 offen sc1
    s_mul_i32 s57, s30, 6144
    v_lshrrev_b32 v7, 2, v0
    v_lshlrev_b32 v7, 6, v7
    v_bfe_u32 v60, v0, 4, 1
    v_lshl_add_u32 v7, v60, 5, v7
    v_and_b32 v60, 3, v0
    v_lshl_add_u32 v7, v60, 3, v7
    v_add_u32 v7, s57, v7
    v_add_u32 v7, 30720, v7
    v_xor_b32 v8, 32, v7
    s_mul_i32 s60, s30, 1536
    s_add_u32 s60, s60, s62
    s_add_u32 s60, s60, 12288
    v_lshlrev_b32 v9, 4, v0
    v_lshlrev_b32 v10, 3, v0
    ds_read_b64_tr_b16 v[36:37], v7 offset:0
    ds_read_b64_tr_b16 v[38:39], v7 offset:1024
    ds_read_b64_tr_b16 v[40:41], v7 offset:2048
    ds_read_b64_tr_b16 v[42:43], v7 offset:3072
    ds_read_b64_tr_b16 v[44:45], v7 offset:4096
    ds_read_b64_tr_b16 v[46:47], v7 offset:5120
    ds_read_b64_tr_b16 v[48:49], v8 offset:0
    ds_read_b64_tr_b16 v[50:51], v8 offset:1024
    ds_read_b64_tr_b16 v[52:53], v8 offset:2048
    ds_read_b64_tr_b16 v[54:55], v8 offset:3072
    ds_read_b64_tr_b16 v[56:57], v8 offset:4096
    ds_read_b64_tr_b16 v[58:59], v8 offset:5120
    v_mov_b64 v[24:25], 0
    v_mov_b64 v[26:27], 0
L_pad12:
    s_cbranch_execz L_pad13
    v_mov_b64 v[28:29], 0
    v_mov_b64 v[30:31], 0
    s_lshl_b32 s57, s30, 8
    v_lshlrev_b32 v11, 2, v0
    v_add_u32 v11, s57, v11
    v_add_u32 v11, 157696, v11
    s_waitcnt vmcnt(0)
L_pw_166:
    v_max3_u32 v19, v18, v20, v21
    v_cmp_eq_u32 vcc, -1, v19
    s_cbranch_vccnz L_pr_167
    buffer_load_dwordx4 v[12:15], v9, s[40:43], s60 offen sc1
    buffer_load_dwordx2 v[16:17], v10, s[40:43], s60 offen offset:1024 sc1
    v_max_f32_dpp v19, v18, v18 row_ror:4 row_mask:0xf bank_mask:0xf
    s_nop 1
    v_max_f32_dpp v19, v19, v19 row_ror:2 row_mask:0xf bank_mask:0xf
    s_nop 1
    v_max_f32_dpp v19, v19, v19 row_ror:1 row_mask:0xf bank_mask:0xf
    v_sub_f32 v18, v18, v19
    v_sub_f32 v20, v20, v19
    v_sub_f32 v21, v21, v19
    v_exp_f32 v18, v18
    v_exp_f32 v20, v20
    v_exp_f32 v21, v21
    v_add_f32_dpp v18, v18, v18 row_ror:4 row_mask:0xf bank_mask:0xf
    s_nop 1
    v_add_f32_dpp v18, v18, v18 row_ror:2 row_mask:0xf bank_mask:0xf
    s_nop 1
    v_add_f32_dpp v18, v18, v18 row_ror:1 row_mask:0xf bank_mask:0xf
    v_rcp_f32 v18, v18
    s_nop 0
    v_mul_f32 v20, v20, v18
    v_mul_f32 v21, v21, v18
    s_waitcnt lgkmcnt(0)
    s_waitcnt vmcnt(0)
L_pw_168:
    v_max3_u32 v19, v12, v13, v14
    v_max3_u32 v19, v19, v15, v16
    v_max_u32 v19, v19, v17
    v_cmp_eq_u32 vcc, -1, v19
    s_cbranch_vccnz L_pr_169
    v_smfmac_f32_16x16x64_bf16 v[24:27], v[12:15], v[36:43], v1
    v_smfmac_f32_16x16x64_bf16 v[28:31], v[12:15], v[48:55], v1
    v_smfmac_f32_16x16x32_bf16 v[24:27], v[16:17], v[44:47], v1
    v_smfmac_f32_16x16x32_bf16 v[28:31], v[16:17], v[56:59], v1
    s_nop 6
    v_pk_add_f32 v[24:25], v[24:25], v[26:27]
    v_pk_add_f32 v[28:29], v[28:29], v[30:31]
    v_mul_f32 v24, v24, v20
    v_mul_f32 v28, v28, v20
    v_fmac_f32 v24, v25, v21
    v_fmac_f32 v28, v29, v21
    s_nop 1
    v_permlane32_swap_b32 v24, v28
    v_add_f32 v24, v24, v28
    ds_write_b32 v11, v24
    v_lshlrev_b32 v5, 2, v0
    v_add_u32 v5, 157696, v5
    s_mul_i32 s59, s31, 2560
    s_lshl_b32 s58, s52, 7
    s_add_u32 s59, s59, s58
    s_add_u32 s59, s59, 1155008
    v_lshlrev_b32 v9, 2, v0
    s_waitcnt lgkmcnt(0)
    s_barrier
    s_cmp_eq_u32 s30, 2
    s_cbranch_scc0 L_skip_170
    ds_read2st64_b32 v[12:13], v5 offset0:0 offset1:1
    ds_read2st64_b32 v[14:15], v5 offset0:2 offset1:3
    ds_read2st64_b32 v[16:17], v5 offset0:4 offset1:5
    ds_read2st64_b32 v[18:19], v5 offset0:6 offset1:7
    s_waitcnt lgkmcnt(2)
    v_pk_add_f32 v[12:13], v[12:13], v[14:15]
    s_waitcnt lgkmcnt(0)
    v_pk_add_f32 v[16:17], v[16:17], v[18:19]
    v_pk_add_f32 v[12:13], v[12:13], v[16:17]
    v_add_f32 v12, v12, v13
    v_mov_b32 v13, v12
    s_nop 1
    v_permlane16_swap_b32 v12, v13
    v_add_f32 v12, v12, v13
    v_min_u32 v12, -2, v12
    s_mov_b32 exec_lo, 0xffff0000
    s_mov_b32 exec_hi, 0xffff
    buffer_store_dword v12, v9, s[40:43], s59 offen sc1
    s_lshl_b32 s57, s52, 2
    s_add_u32 s57, s57, s62
    s_add_u32 s57, s57, 38400
    s_mov_b64 exec, 0x1
    s_cmp_eq_u32 s55, 0
    s_cbranch_scc1 L_gs_171
    buffer_store_dword v0, v0, s[40:43], s57 offen
L_gb_172:
    s_mov_b64 exec, -1
L_skip_170:
    s_sub_u32 s57, s30, 5
    s_cmp_lt_u32 s57, 2
L_pad13:
    s_cbranch_execz L_pad14
    s_cbranch_scc0 L_skip_173
    s_sub_u32 s60, s30, 5
    s_mul_i32 s59, s60, 6144
    s_add_u32 s59, s59, 79872
    v_lshrrev_b32 v7, 5, v0
    v_lshlrev_b32 v7, 9, v7
    v_bfe_u32 v60, v0, 4, 1
    v_lshl_add_u32 v7, v60, 7, v7
    v_bfe_u32 v60, v0, 3, 1
    v_lshl_add_u32 v7, v60, 8, v7
    v_bfe_u32 v60, v0, 2, 1
    v_lshl_add_u32 v7, v60, 5, v7
    v_and_b32 v60, 3, v0
    v_lshl_add_u32 v7, v60, 3, v7
    v_add_u32 v7, s59, v7
    s_add_u32 s59, s62, 37504
    v_lshrrev_b32 v5, 4, v0
    v_lshlrev_b32 v5, 5, v5
    v_bfe_u32 v60, v0, 1, 1
    v_lshl_add_u32 v5, v60, 4, v5
    v_mov_b64 v[24:25], 0
    v_mov_b64 v[26:27], 0
    s_mul_i32 s57, s31, 2560
    s_lshl_b32 s58, s52, 7
    s_add_u32 s57, s57, s58
    s_lshl_b32 s60, s60, 6
    s_add_u32 s60, s60, s57
    s_add_u32 s60, s60, 1175552
    v_lshlrev_b32 v9, 2, v0
    ds_read_b64_tr_b16 v[36:37], v7 offset:0
    ds_read_b64_tr_b16 v[38:39], v7 offset:64
    ds_read_b64_tr_b16 v[40:41], v7 offset:1024
    ds_read_b64_tr_b16 v[42:43], v7 offset:1088
    ds_read_b64_tr_b16 v[44:45], v7 offset:2048
    ds_read_b64_tr_b16 v[46:47], v7 offset:2112
    ds_read_b64_tr_b16 v[48:49], v7 offset:3072
    ds_read_b64_tr_b16 v[50:51], v7 offset:3136
    ds_read_b64_tr_b16 v[52:53], v7 offset:4096
    ds_read_b64_tr_b16 v[54:55], v7 offset:4160
    ds_read_b64_tr_b16 v[56:57], v7 offset:5120
    ds_read_b64_tr_b16 v[58:59], v7 offset:5184
    buffer_load_dwordx4 v[12:15], v5, s[40:43], s59 offen offset:0 sc1
    buffer_load_dwordx4 v[16:19], v5, s[40:43], s59 offen offset:128 sc1
    buffer_load_dwordx4 v[20:23], v5, s[40:43], s59 offen offset:256 sc1
    s_waitcnt lgkmcnt(0)
    s_waitcnt vmcnt(0)
L_pw_174:
    v_max3_u32 v28, v12, v13, v14
    v_max3_u32 v28, v28, v15, v16
    v_max3_u32 v28, v28, v17, v18
    v_max3_u32 v28, v28, v19, v20
    v_max3_u32 v28, v28, v21, v22
    v_max_u32 v28, v28, v23
    v_cmp_eq_u32 vcc, -1, v28
    s_cbranch_vccnz L_pr_175
    v_smfmac_f32_16x16x64_bf16 v[24:27], v[12:15], v[36:43], v1
    v_smfmac_f32_16x16x64_bf16 v[24:27], v[16:19], v[44:51], v1
    v_smfmac_f32_16x16x64_bf16 v[24:27], v[20:23], v[52:59], v1
    s_nop 7
    v_add_f32 v24, v24, v26
    v_min_u32 v24, -2, v24
    s_mov_b64 exec, 0xffff
    buffer_store_dword v24, v9, s[40:43], s60 offen sc1
    s_cmp_eq_u32 s30, 6
    s_cbranch_scc0 L_skip_176
    s_lshl_b32 s57, s52, 2
    s_add_u32 s57, s57, s62
    s_add_u32 s57, s57, 38528
    s_mov_b64 exec, 0x1
    s_cmp_eq_u32 s55, 0
    s_cbranch_scc1 L_gs_177
    buffer_store_dword v0, v0, s[40:43], s57 offen
L_gb_178:
    s_mov_b64 exec, -1
L_skip_176:
    s_mov_b64 exec, -1
L_skip_173:
    s_branch L_done
L_typeB_1:
    s_cmp_lt_u32 s30, 5
    s_cbranch_scc0 L_skip_179
    s_mul_i32 s57, s30, 4096
    v_lshrrev_b32 v10, 4, v0
    v_lshlrev_b32 v10, 10, v10
    v_bfe_u32 v60, v0, 3, 1
    v_lshl_add_u32 v10, v60, 8, v10
    v_bfe_u32 v60, v0, 1, 1
L_pad14:
    s_cbranch_execz L_pad15
    v_lshl_add_u32 v10, v60, 7, v10
    v_bfe_u32 v60, v0, 2, 1
    v_lshl_add_u32 v10, v60, 5, v10
    v_and_b32 v60, 1, v0
    v_lshl_add_u32 v10, v60, 3, v10
    v_add_u32 v10, s57, v10
    v_add_u32 v10, 30720, v10
    ds_read_b64_tr_b16 v[36:37], v10 offset:0
    ds_read_b64_tr_b16 v[38:39], v10 offset:512
    ds_read_b64_tr_b16 v[40:41], v10 offset:64
    ds_read_b64_tr_b16 v[42:43], v10 offset:576
    ds_read_b64_tr_b16 v[44:45], v10 offset:16
    ds_read_b64_tr_b16 v[46:47], v10 offset:528
    ds_read_b64_tr_b16 v[48:49], v10 offset:80
    ds_read_b64_tr_b16 v[50:51], v10 offset:592
    s_lshl_b32 s57, s30, 10
    v_lshlrev_b32 v11, 4, v0
    v_add_u32 v11, s57, v11
    v_add_u32 v11, 157696, v11
    v_mov_b32 v32, 0x3f803f80
    v_mov_b32 v33, 0x3f803f80
    v_mov_b32 v34, 0x3f803f80
    v_mov_b32 v35, 0x3f803f80
    v_mov_b32 v61, 0x3f803f80
    s_lshl_b32 s57, s30, 9
    v_lshrrev_b32 v5, 5, v0
    v_mul_u32_u24 v5, 2560, v5
    v_and_b32 v60, 31, v0
    v_lshl_add_u32 v5, v60, 4, v5
    v_add_u32 v5, s57, v5
    v_lshlrev_b32 v60, 16, v4
    v_add_f32 v2, v2, v60
    v_and_b32 v60, 0xffff0000, v4
    v_add_f32 v3, v3, v60
    s_mov_b32 s57, 1134592
    buffer_load_dwordx4 v[12:15], v5, s[40:43], s57 offen sc1
    s_mov_b32 s58, 1139712
    buffer_load_dwordx4 v[16:19], v5, s[40:43], s58 offen sc1
    s_mov_b32 s59, 1144832
    buffer_load_dwordx4 v[20:23], v5, s[40:43], s59 offen sc1
    s_mov_b32 s60, 1149952
    buffer_load_dwordx4 v[24:27], v5, s[40:43], s60 offen sc1
L_gw_180:
    s_waitcnt vmcnt(2)
    v_pk_add_f32 v[28:29], v[12:13], v[16:17]
    v_pk_add_f32 v[30:31], v[14:15], v[18:19]
    s_waitcnt vmcnt(1)
    v_pk_add_f32 v[28:29], v[28:29], v[20:21]
    v_pk_add_f32 v[30:31], v[30:31], v[22:23]
    s_waitcnt vmcnt(0)
    v_pk_add_f32 v[28:29], v[28:29], v[24:25]
    v_pk_add_f32 v[30:31], v[30:31], v[26:27]
    s_nop 1
    v_permlane32_swap_b32 v28, v30
    v_permlane32_swap_b32 v29, v31
    v_pk_add_f32 v[28:29], v[28:29], v[30:31]
    v_pk_add_f32 v[28:29], v[28:29], v[2:3]
    v_cmp_u_f32 vcc, v28, v29
    s_cbranch_vccnz L_gr_181
L_gk_182:
    v_cvt_pk_bf16_f32 v28, v28, v29
    v_lshlrev_b32 v2, 16, v28
    v_and_b32 v3, 0xffff0000, v28
    s_add_u32 s57, s62, 38400
    v_min_u32 v9, 19, v0
    v_lshlrev_b32 v9, 2, v9
    buffer_load_dword v12, v9, s[40:43], s57 offen sc1
    s_waitcnt vmcnt(0)
L_pw_187:
    v_cmp_eq_u32 vcc, -1, v12
    s_cbranch_vccnz L_pr_188
    s_mov_b32 s57, 1155072
    buffer_load_dwordx4 v[12:15], v5, s[40:43], s57 offen sc1
    s_mov_b32 s58, 1160192
    buffer_load_dwordx4 v[16:19], v5, s[40:43], s58 offen sc1
    s_mov_b32 s59, 1165312
    buffer_load_dwordx4 v[20:23], v5, s[40:43], s59 offen sc1
    s_mov_b32 s60, 1170432
    buffer_load_dwordx4 v[24:27], v5, s[40:43], s60 offen sc1
L_gw_189:
    s_waitcnt vmcnt(2)
L_pad15:
    s_cbranch_execz L_pad16
    v_pk_add_f32 v[28:29], v[12:13], v[16:17]
    v_pk_add_f32 v[30:31], v[14:15], v[18:19]
    s_waitcnt vmcnt(1)
    v_pk_add_f32 v[28:29], v[28:29], v[20:21]
    v_pk_add_f32 v[30:31], v[30:31], v[22:23]
    s_waitcnt vmcnt(0)
    v_pk_add_f32 v[28:29], v[28:29], v[24:25]
    v_pk_add_f32 v[30:31], v[30:31], v[26:27]
    s_nop 1
    v_permlane32_swap_b32 v28, v30
    v_permlane32_swap_b32 v29, v31
    v_pk_add_f32 v[28:29], v[28:29], v[30:31]
    v_pk_add_f32 v[28:29], v[28:29], v[2:3]
    v_cmp_u_f32 vcc, v28, v29
    s_cbranch_vccnz L_gr_190
L_gk_191:
    v_cvt_pk_bf16_f32 v28, v28, v29
    v_mov_b64 v[12:13], 0
    v_mov_b64 v[14:15], 0
    v_mov_b32_dpp v32, v28 quad_perm:[0,1,2,3] row_mask:0xf bank_mask:0x1
    v_mov_b32_dpp v33, v28 row_shl:4 row_mask:0xf bank_mask:0x1
    v_mov_b32_dpp v34, v28 row_shl:8 row_mask:0xf bank_mask:0x1
    v_mov_b32_dpp v35, v28 row_shl:12 row_mask:0xf bank_mask:0x1
    v_dot2_f32_bf16 v27, v28, v61, 0
    v_dot2_f32_bf16 v62, v28, v28, 0
    s_waitcnt lgkmcnt(0)
    v_smfmac_f32_16x16x64_bf16 v[12:15], v[32:35], v[36:43], v1
    v_mov_b64 v[16:17], 0
    v_mov_b64 v[18:19], 0
    v_permlane32_swap_b32 v27, v62
    s_nop 0
    v_smfmac_f32_16x16x64_bf16 v[16:19], v[32:35], v[44:51], v1
    v_add_f32 v27, v27, v62
    v_mov_b32 v62, v27
    s_nop 1
    v_permlane16_swap_b32 v27, v62
    v_add_f32 v27, v27, v62
    v_lshlrev_b32 v2, 16, v28
    v_and_b32 v3, 0xffff0000, v28
    v_add_f32_dpp v27, v27, v27 row_ror:8 row_mask:0xf bank_mask:0xf
    v_pk_add_f32 v[12:13], v[12:13], v[14:15]
    v_pk_add_f32 v[16:17], v[16:17], v[18:19]
    v_add_f32_dpp v27, v27, v27 row_ror:4 row_mask:0xf bank_mask:0xf
    v_add_f32_dpp v24, v13, v12 row_shl:8 row_mask:0xf bank_mask:0xf bound_ctrl:0
    v_add_f32_dpp v25, v17, v16 row_shl:8 row_mask:0xf bank_mask:0xf bound_ctrl:0
    v_add_f32_dpp v27, v27, v27 row_ror:2 row_mask:0xf bank_mask:0xf
    s_nop 1
    v_add_f32_dpp v27, v27, v27 row_ror:1 row_mask:0xf bank_mask:0xf
    ds_write_b128 v11, v[24:27]
    s_waitcnt lgkmcnt(0)
L_skip_179:
    s_cmp_eq_u32 s30, 5
    s_cbranch_scc0 L_skip_196
    v_and_b32 v10, 7, v0
    v_lshlrev_b32 v10, 4, v10
    v_bfe_u32 v60, v0, 3, 2
    v_lshl_add_u32 v10, v60, 2, v10
    v_lshrrev_b32 v60, 5, v0
    v_lshl_add_u32 v10, v60, 8, v10
    v_add_u32 v10, 157696, v10
    v_mov_b32 v60, 158220
    v_cmp_eq_u32 vcc, 25, v0
    s_nop 1
    v_cndmask_b32 v10, v10, v60, vcc
    s_sub_u32 s59, s52, 20
    s_lshl_b32 s59, s59, 5
    s_add_u32 s59, s59, s62
    s_add_u32 s59, s59, 37504
    v_lshlrev_b32 v11, 1, v0
    v_mov_b32 v18, 0xc0135761
    v_mov_b32 v19, 0xbdd2d3e8
L_skip_196:
    s_barrier
    s_cmp_eq_u32 s30, 5
    s_cbranch_scc0 L_skip_197
    ds_read2st64_b32 v[12:13], v10 offset0:0 offset1:4
    ds_read2st64_b32 v[14:15], v10 offset0:8 offset1:12
    ds_read_b32 v16, v10 offset:4096
    s_waitcnt lgkmcnt(1)
    v_pk_add_f32 v[12:13], v[12:13], v[14:15]
    s_waitcnt lgkmcnt(0)
    v_add_f32 v12, v12, v16
    v_add_f32 v12, v12, v13
    v_mov_b32 v14, 0x3acccccd
    v_readlane_b32 s57, v12, 24
    v_readlane_b32 s58, v12, 25
    v_permlane32_swap_b32 v12, v13
    v_mul_f32 v15, s57, v14
L_pad16:
    s_cbranch_execz L_pad17
    v_mul_f32 v16, s58, v14
    v_fma_f32 v16, -v15, v15, v16
    v_max_f32 v16, 0, v16
    v_add_f32 v16, 0x3727c5ac, v16
    v_rsq_f32 v16, v16
    v_fma_f32 v12, -v15, v13, v12
    v_mul_f32 v12, v12, v16
    v_add_f32 v12, v12, v4
    v_mul_f32 v13, v12, v12
    v_fma_f32 v13, v13, v19, v18
    v_mul_f32 v13, v13, v12
    v_exp_f32 v13, v13
    s_nop 0
    v_add_f32 v13, 1.0, v13
    v_rcp_f32 v13, v13
    s_nop 0
    v_mul_f32 v12, v12, v13
    s_nop 1
    v_mov_b32_dpp v13, v12 row_shl:1 row_mask:0xf bank_mask:0xf bound_ctrl:0
    v_cvt_pk_bf16_f32 v12, v12, v13
    v_min_u32 v12, -2, v12
    s_mov_b64 exec, 0x5555
    s_cmp_eq_u32 s55, 0
    s_cbranch_scc1 L_gs_198
    buffer_store_dword v12, v11, s[40:43], s59 offen
L_gb_199:
    s_mov_b64 exec, -1
L_skip_197:
    s_sub_u32 s57, s52, 20
    s_cmp_eq_u32 s57, s30
    s_cbranch_scc0 L_done
    s_cmp_lt_u32 s30, 5
    s_cbranch_scc0 L_done
    s_cmp_eq_u32 s31, 0
    s_cbranch_scc0 L_done
    v_lshlrev_b32 v60, 16, v4
    v_add_f32 v2, v2, v60
    v_and_b32 v60, 0xffff0000, v4
    v_add_f32 v3, v3, v60
    s_lshl_b32 s57, s30, 8
    v_and_b32 v7, 31, v0
    v_lshlrev_b32 v7, 3, v7
    v_lshrrev_b32 v60, 5, v0
    v_lshl_add_u32 v7, v60, 2, v7
    v_add_u32 v7, s57, v7
    s_add_u32 s57, s62, 38528
    v_min_u32 v9, 19, v0
    v_lshlrev_b32 v9, 2, v9
    buffer_load_dword v12, v9, s[40:43], s57 offen sc1
    s_waitcnt vmcnt(0)
L_pw_200:
    v_cmp_eq_u32 vcc, -1, v12
    s_cbranch_vccnz L_pr_201
    s_mov_b32 s57, 1175552
    buffer_load_dwordx4 v[12:15], v5, s[40:43], s57 offen sc1
    s_mov_b32 s58, 1180672
    buffer_load_dwordx4 v[16:19], v5, s[40:43], s58 offen sc1
    s_mov_b32 s59, 1185792
    buffer_load_dwordx4 v[20:23], v5, s[40:43], s59 offen sc1
    s_mov_b32 s60, 1190912
    buffer_load_dwordx4 v[24:27], v5, s[40:43], s60 offen sc1
L_gw_202:
    s_waitcnt vmcnt(2)
    v_pk_add_f32 v[28:29], v[12:13], v[16:17]
    v_pk_add_f32 v[30:31], v[14:15], v[18:19]
    s_waitcnt vmcnt(1)
    v_pk_add_f32 v[28:29], v[28:29], v[20:21]
    v_pk_add_f32 v[30:31], v[30:31], v[22:23]
    s_waitcnt vmcnt(0)
    v_pk_add_f32 v[28:29], v[28:29], v[24:25]
    v_pk_add_f32 v[30:31], v[30:31], v[26:27]
    s_nop 1
    v_permlane32_swap_b32 v28, v30
    v_permlane32_swap_b32 v29, v31
    v_pk_add_f32 v[28:29], v[28:29], v[30:31]
    v_pk_add_f32 v[28:29], v[28:29], v[2:3]
    v_cmp_u_f32 vcc, v28, v29
    s_cbranch_vccnz L_gr_203
L_gk_204:
    v_cvt_pk_bf16_f32 v28, v28, v29
    global_store_dword v7, v28, s[24:25]
    s_branch L_done
L_gs_27:
    buffer_store_dword v27, v34, s[40:43], s67 offen sc1
    s_branch L_gb_28
L_gs_30:
    buffer_store_dword v12, v34, s[40:43], s59 offen sc1
    s_branch L_gb_31
L_cr_42:
    s_sub_u32 s56, s56, 1
    s_cbranch_scc1 L_done
    global_load_dword v2, v3, s[26:27] sc1
    s_waitcnt vmcnt(0)
    s_branch L_cw_41
L_cr_54:
    s_sub_u32 s56, s56, 1
    s_cbranch_scc1 L_done
    global_load_dword v2, v3, s[26:27] sc1
    s_branch L_cw_53
L_pr_61:
    s_sub_u32 s56, s56, 1
    s_cbranch_scc1 L_done
    buffer_load_dwordx4 v[24:27], v3, s[40:43], 0 offen sc1
L_pad17:
    s_cbranch_execz L_pad18
    s_waitcnt vmcnt(0)
    s_branch L_pw_60
L_gs_67:
    buffer_store_dword v27, v34, s[40:43], s67 offen sc1
    s_branch L_gb_68
L_gs_70:
    buffer_store_dword v12, v34, s[40:43], s59 offen sc1
    s_branch L_gb_71
L_pr_74:
    s_sub_u32 s56, s56, 1
    s_cbranch_scc1 L_done
    buffer_load_dword v17, v16, s[40:43], s72 offen offset:128 sc1
    s_waitcnt vmcnt(0)
    s_branch L_pw_73
L_gs_89:
    buffer_store_dword v22, v23, s[40:43], s57 offen sc1
    s_branch L_gb_90
L_gs_101:
    buffer_store_dword v56, v21, s[40:43], 0 offen sc1
    s_branch L_gb_102
L_pr_105:
    s_sub_u32 s56, s56, 1
    s_cbranch_scc1 L_done
    buffer_load_dword v18, v5, s[40:43], s59 offen sc1
    buffer_load_dwordx2 v[20:21], v22, s[40:43], s59 offen sc1
    s_waitcnt vmcnt(0)
    s_branch L_pw_104
L_pr_107:
    s_sub_u32 s56, s56, 1
    s_cbranch_scc1 L_done
    buffer_load_dwordx4 v[12:15], v9, s[40:43], s60 offen sc1
    buffer_load_dwordx2 v[16:17], v10, s[40:43], s60 offen offset:1024 sc1
    s_waitcnt vmcnt(0)
    s_branch L_pw_106
L_gs_109:
    buffer_store_dword v0, v0, s[40:43], s57 offen sc1
    s_branch L_gb_110
L_pr_113:
    s_sub_u32 s56, s56, 1
    s_cbranch_scc1 L_done
    buffer_load_dwordx4 v[12:15], v5, s[40:43], s59 offen offset:0 sc1
    buffer_load_dwordx4 v[16:19], v5, s[40:43], s59 offen offset:128 sc1
    buffer_load_dwordx4 v[20:23], v5, s[40:43], s59 offen offset:256 sc1
    s_waitcnt vmcnt(0)
    s_branch L_pw_112
L_gs_115:
    buffer_store_dword v0, v0, s[40:43], s57 offen sc1
    s_branch L_gb_116
L_pr_119:
    s_sub_u32 s56, s56, 1
    s_cbranch_scc1 L_done
    buffer_load_dword v12, v9, s[40:43], s57 offen sc1
    s_waitcnt vmcnt(0)
    s_branch L_pw_118
L_gr_121:
    s_sub_u32 s56, s56, 1
    s_cbranch_scc1 L_done
    s_mov_b64 s[74:75], 0
    v_max3_u32 v30, v12, v13, v14
    v_max_u32 v30, v30, v15
    v_cmp_eq_u32 vcc, -1, v30
    s_cbranch_vccz L_gn_123
    s_or_b64 s[74:75], s[74:75], vcc
    s_mov_b64 exec, vcc
    buffer_load_dwordx4 v[12:15], v5, s[40:43], s57 offen sc1
    s_mov_b64 exec, -1
L_gn_123:
    v_max3_u32 v30, v16, v17, v18
    v_max_u32 v30, v30, v19
    v_cmp_eq_u32 vcc, -1, v30
    s_cbranch_vccz L_gn_124
    s_or_b64 s[74:75], s[74:75], vcc
    s_mov_b64 exec, vcc
    buffer_load_dwordx4 v[16:19], v5, s[40:43], s58 offen sc1
    s_mov_b64 exec, -1
L_gn_124:
    v_max3_u32 v30, v20, v21, v22
    v_max_u32 v30, v30, v23
    v_cmp_eq_u32 vcc, -1, v30
    s_cbranch_vccz L_gn_125
    s_or_b64 s[74:75], s[74:75], vcc
    s_mov_b64 exec, vcc
    buffer_load_dwordx4 v[20:23], v5, s[40:43], s59 offen sc1
    s_mov_b64 exec, -1
L_gn_125:
    v_max3_u32 v30, v24, v25, v26
    v_max_u32 v30, v30, v27
    v_cmp_eq_u32 vcc, -1, v30
    s_cbranch_vccz L_gn_126
    s_or_b64 s[74:75], s[74:75], vcc
    s_mov_b64 exec, vcc
    buffer_load_dwordx4 v[24:27], v5, s[40:43], s60 offen sc1
    s_mov_b64 exec, -1
L_gn_126:
    s_cmp_eq_u64 s[74:75], 0
    s_cbranch_scc1 L_gk_122
    s_waitcnt vmcnt(0)
    s_branch L_gw_120
L_gs_129:
    buffer_store_dword v12, v11, s[40:43], s59 offen sc1
    s_branch L_gb_130
L_pr_134:
    s_sub_u32 s56, s56, 1
    s_cbranch_scc1 L_done
    buffer_load_dword v12, v9, s[40:43], s57 offen sc1
    s_waitcnt vmcnt(0)
    s_branch L_pw_133
L_gr_136:
    s_sub_u32 s56, s56, 1
    s_cbranch_scc1 L_done
    s_mov_b64 s[74:75], 0
    v_max3_u32 v30, v12, v13, v14
    v_max_u32 v30, v30, v15
    v_cmp_eq_u32 vcc, -1, v30
    s_cbranch_vccz L_gn_138
    s_or_b64 s[74:75], s[74:75], vcc
    s_mov_b64 exec, vcc
    buffer_load_dwordx4 v[12:15], v5, s[40:43], s57 offen sc1
L_pad18:
    s_cbranch_execz L_pad19
    s_mov_b64 exec, -1
L_gn_138:
    v_max3_u32 v30, v16, v17, v18
    v_max_u32 v30, v30, v19
    v_cmp_eq_u32 vcc, -1, v30
    s_cbranch_vccz L_gn_139
    s_or_b64 s[74:75], s[74:75], vcc
    s_mov_b64 exec, vcc
    buffer_load_dwordx4 v[16:19], v5, s[40:43], s58 offen sc1
    s_mov_b64 exec, -1
L_gn_139:
    v_max3_u32 v30, v20, v21, v22
    v_max_u32 v30, v30, v23
    v_cmp_eq_u32 vcc, -1, v30
    s_cbranch_vccz L_gn_140
    s_or_b64 s[74:75], s[74:75], vcc
    s_mov_b64 exec, vcc
    buffer_load_dwordx4 v[20:23], v5, s[40:43], s59 offen sc1
    s_mov_b64 exec, -1
L_gn_140:
    v_max3_u32 v30, v24, v25, v26
    v_max_u32 v30, v30, v27
    v_cmp_eq_u32 vcc, -1, v30
    s_cbranch_vccz L_gn_141
    s_or_b64 s[74:75], s[74:75], vcc
    s_mov_b64 exec, vcc
    buffer_load_dwordx4 v[24:27], v5, s[40:43], s60 offen sc1
    s_mov_b64 exec, -1
L_gn_141:
    s_cmp_eq_u64 s[74:75], 0
    s_cbranch_scc1 L_gk_137
    s_waitcnt vmcnt(0)
    s_branch L_gw_135
L_pr_143:
    s_sub_u32 s56, s56, 1
    s_cbranch_scc1 L_done
    buffer_load_dword v12, v9, s[40:43], s57 offen sc1
    s_waitcnt vmcnt(0)
    s_branch L_pw_142
L_gr_145:
    s_sub_u32 s56, s56, 1
    s_cbranch_scc1 L_done
    s_mov_b64 s[74:75], 0
    v_max3_u32 v30, v12, v13, v14
    v_max_u32 v30, v30, v15
    v_cmp_eq_u32 vcc, -1, v30
    s_cbranch_vccz L_gn_147
    s_or_b64 s[74:75], s[74:75], vcc
    s_mov_b64 exec, vcc
    buffer_load_dwordx4 v[12:15], v5, s[40:43], s57 offen sc1
    s_mov_b64 exec, -1
L_gn_147:
    v_max3_u32 v30, v16, v17, v18
    v_max_u32 v30, v30, v19
    v_cmp_eq_u32 vcc, -1, v30
    s_cbranch_vccz L_gn_148
    s_or_b64 s[74:75], s[74:75], vcc
    s_mov_b64 exec, vcc
    buffer_load_dwordx4 v[16:19], v5, s[40:43], s58 offen sc1
    s_mov_b64 exec, -1
L_gn_148:
    v_max3_u32 v30, v20, v21, v22
    v_max_u32 v30, v30, v23
    v_cmp_eq_u32 vcc, -1, v30
    s_cbranch_vccz L_gn_149
    s_or_b64 s[74:75], s[74:75], vcc
    s_mov_b64 exec, vcc
    buffer_load_dwordx4 v[20:23], v5, s[40:43], s59 offen sc1
    s_mov_b64 exec, -1
L_gn_149:
    v_max3_u32 v30, v24, v25, v26
    v_max_u32 v30, v30, v27
    v_cmp_eq_u32 vcc, -1, v30
    s_cbranch_vccz L_gn_150
    s_or_b64 s[74:75], s[74:75], vcc
    s_mov_b64 exec, vcc
    buffer_load_dwordx4 v[24:27], v5, s[40:43], s60 offen sc1
    s_mov_b64 exec, -1
L_gn_150:
    s_cmp_eq_u64 s[74:75], 0
    s_cbranch_scc1 L_gk_146
    s_waitcnt vmcnt(0)
    s_branch L_gw_144
L_gs_152:
    buffer_store_dword v12, v34, s[40:43], s59 offen sc1
    s_branch L_gb_153
L_gs_155:
    buffer_store_dword v27, v34, s[40:43], s67 offen sc1
    s_branch L_gb_156
L_pr_158:
    s_sub_u32 s56, s56, 1
    s_cbranch_scc1 L_done
    buffer_load_dwordx2 v[8:9], v7, s[40:43], 0 offen sc1
    buffer_load_dwordx4 v[12:15], v5, s[40:43], 0 offen offset:0 sc1
    buffer_load_dwordx4 v[16:19], v5, s[40:43], 0 offen offset:1024 sc1
    buffer_load_dwordx4 v[20:23], v5, s[40:43], 0 offen offset:2048 sc1
    s_waitcnt vmcnt(0)
    s_branch L_pw_157
L_gs_161:
    buffer_store_dword v22, v23, s[40:43], s57 offen sc1
    s_branch L_gb_162
L_old:
    s_waitcnt lgkmcnt(0)
    s_barrier
    s_cmp_lt_u32 s30, 2
    s_cbranch_scc0 L_b2_1
    v_and_b32 v37, 7, v0
    v_lshlrev_b32 v37, 3, v37
    v_add_u32 v37, 162816, v37
    ds_read_b64 v[38:39], v37
    s_lshl_b32 s57, s53, 3
    s_add_u32 s57, s57, s54
    s_lshl_b32 s57, s57, 2
    v_mov_b32 v23, s57
    s_add_u32 s57, s62, 38016
    s_waitcnt lgkmcnt(0)
    v_max_f32_dpp v37, v38, v38 row_ror:4 row_mask:0xf bank_mask:0xf
L_pad19:
    s_cbranch_execz L_pad20
    s_nop 1
    v_max_f32_dpp v37, v37, v37 row_ror:2 row_mask:0xf bank_mask:0xf
    s_nop 1
    v_max_f32_dpp v37, v37, v37 row_ror:1 row_mask:0xf bank_mask:0xf
    v_sub_f32 v38, v38, v37
    v_exp_f32 v38, v38
    s_nop 0
    v_mul_f32 v39, v38, v39
    s_nop 1
    v_add_f32_dpp v39, v39, v39 row_ror:4 row_mask:0xf bank_mask:0xf
    s_nop 1
    v_add_f32_dpp v39, v39, v39 row_ror:2 row_mask:0xf bank_mask:0xf
    s_nop 1
    v_add_f32_dpp v39, v39, v39 row_ror:1 row_mask:0xf bank_mask:0xf
    v_log_f32 v22, v39
    v_rcp_f32 v39, v39
    v_add_f32 v22, v22, v37
    v_min_u32 v22, -2, v22
    v_mul_f32 v38, v38, v39
    s_cmp_eq_u32 s30, 0
    s_cbranch_scc0 L_skip_160
    s_mov_b64 exec, 0x1
    s_cmp_eq_u32 s55, 0
    s_cbranch_scc1 L_gs_161
    buffer_store_dword v22, v23, s[40:43], s57 offen
L_gb_162:
    s_mov_b64 exec, -1
L_skip_160:
    v_readlane_b32 s64, v38, 0
    v_readlane_b32 s65, v38, 1
    v_readlane_b32 s66, v38, 2
    v_readlane_b32 s67, v38, 3
    v_readlane_b32 s68, v38, 4
    v_readlane_b32 s69, v38, 5
    v_readlane_b32 s70, v38, 6
    v_readlane_b32 s71, v38, 7
    s_mul_i32 s57, s30, 48
    v_add_u32 v38, s57, v0
    v_bfe_u32 v20, v38, 5, 2
    v_lshlrev_b32 v20, 8, v20
    v_and_b32 v39, 15, v38
    v_lshl_add_u32 v20, v39, 4, v20
    v_bfe_u32 v39, v38, 4, 1
    v_lshl_add_u32 v20, v39, 3, v20
    v_add_u32 v20, 124928, v20
    s_lshr_b32 s57, s54, 1
    s_lshl_b32 s57, s57, 2
    s_and_b32 s58, s54, 1
    s_add_u32 s57, s57, s58
    s_lshl_b32 s58, s57, 4
    s_lshl_b32 s57, s57, 3
    v_bfe_u32 v21, v0, 3, 2
    v_lshlrev_b32 v21, 8, v21
    v_bfe_u32 v39, v0, 2, 1
    v_lshl_add_u32 v21, v39, 5, v21
    v_and_b32 v39, 3, v0
    v_lshl_add_u32 v21, v39, 2, v21
    v_add_u32 v21, s58, v21
    v_bfe_u32 v38, v0, 3, 1
    v_lshlrev_b32 v38, 8, v38
    v_bfe_u32 v39, v0, 1, 1
    v_lshl_add_u32 v38, v39, 7, v38
    v_bfe_u32 v39, v0, 2, 1
    v_lshl_add_u32 v38, v39, 4, v38
    v_and_b32 v39, 1, v0
    v_lshl_add_u32 v38, v39, 2, v38
    v_add_u32 v38, s57, v38
    v_add_u32 v38, 1024, v38
    v_cmp_gt_u32 vcc, 32, v0
    s_nop 1
    v_cndmask_b32 v21, v38, v21, vcc
    s_lshl_b32 s57, s53, 1
    s_add_u32 s57, s57, s30
    s_mul_i32 s57, s57, 1536
    s_add_u32 s57, s57, s62
    s_add_u32 s57, s57, 12288
    v_add_u32 v21, s57, v21
    s_branch L_b2_1
L_gs_164:
    buffer_store_dword v56, v21, s[40:43], 0 offen sc1
    s_branch L_gb_165
L_pr_167:
    s_sub_u32 s56, s56, 1
    s_cbranch_scc1 L_done
    buffer_load_dword v18, v5, s[40:43], s59 offen sc1
    buffer_load_dwordx2 v[20:21], v22, s[40:43], s59 offen sc1
    s_waitcnt vmcnt(0)
    s_branch L_pw_166
L_pr_169:
    s_sub_u32 s56, s56, 1
    s_cbranch_scc1 L_done
    buffer_load_dwordx4 v[12:15], v9, s[40:43], s60 offen sc1
    buffer_load_dwordx2 v[16:17], v10, s[40:43], s60 offen offset:1024 sc1
    s_waitcnt vmcnt(0)
L_pad20:
    s_cbranch_execz L_pad21
    s_branch L_pw_168
L_gs_171:
    buffer_store_dword v0, v0, s[40:43], s57 offen sc1
    s_branch L_gb_172
L_pr_175:
    s_sub_u32 s56, s56, 1
    s_cbranch_scc1 L_done
    buffer_load_dwordx4 v[12:15], v5, s[40:43], s59 offen offset:0 sc1
    buffer_load_dwordx4 v[16:19], v5, s[40:43], s59 offen offset:128 sc1
    buffer_load_dwordx4 v[20:23], v5, s[40:43], s59 offen offset:256 sc1
    s_waitcnt vmcnt(0)
    s_branch L_pw_174
L_gs_177:
    buffer_store_dword v0, v0, s[40:43], s57 offen sc1
    s_branch L_gb_178
L_gr_181:
    s_sub_u32 s56, s56, 1
    s_cbranch_scc1 L_done
    s_mov_b64 s[74:75], 0
    v_max3_u32 v30, v12, v13, v14
    v_max_u32 v30, v30, v15
    v_cmp_eq_u32 vcc, -1, v30
    s_cbranch_vccz L_gn_183
    s_or_b64 s[74:75], s[74:75], vcc
    s_mov_b64 exec, vcc
    buffer_load_dwordx4 v[12:15], v5, s[40:43], s57 offen sc1
    s_mov_b64 exec, -1
L_gn_183:
    v_max3_u32 v30, v16, v17, v18
    v_max_u32 v30, v30, v19
    v_cmp_eq_u32 vcc, -1, v30
    s_cbranch_vccz L_gn_184
    s_or_b64 s[74:75], s[74:75], vcc
    s_mov_b64 exec, vcc
    buffer_load_dwordx4 v[16:19], v5, s[40:43], s58 offen sc1
    s_mov_b64 exec, -1
L_gn_184:
    v_max3_u32 v30, v20, v21, v22
    v_max_u32 v30, v30, v23
    v_cmp_eq_u32 vcc, -1, v30
    s_cbranch_vccz L_gn_185
    s_or_b64 s[74:75], s[74:75], vcc
    s_mov_b64 exec, vcc
    buffer_load_dwordx4 v[20:23], v5, s[40:43], s59 offen sc1
    s_mov_b64 exec, -1
L_gn_185:
    v_max3_u32 v30, v24, v25, v26
    v_max_u32 v30, v30, v27
    v_cmp_eq_u32 vcc, -1, v30
    s_cbranch_vccz L_gn_186
    s_or_b64 s[74:75], s[74:75], vcc
    s_mov_b64 exec, vcc
    buffer_load_dwordx4 v[24:27], v5, s[40:43], s60 offen sc1
    s_mov_b64 exec, -1
L_gn_186:
    s_cmp_eq_u64 s[74:75], 0
    s_cbranch_scc1 L_gk_182
    s_waitcnt vmcnt(0)
    s_branch L_gw_180
L_pr_188:
    s_sub_u32 s56, s56, 1
    s_cbranch_scc1 L_done
    buffer_load_dword v12, v9, s[40:43], s57 offen sc1
    s_waitcnt vmcnt(0)
    s_branch L_pw_187
L_gr_190:
    s_sub_u32 s56, s56, 1
    s_cbranch_scc1 L_done
    s_mov_b64 s[74:75], 0
    v_max3_u32 v30, v12, v13, v14
    v_max_u32 v30, v30, v15
    v_cmp_eq_u32 vcc, -1, v30
    s_cbranch_vccz L_gn_192
    s_or_b64 s[74:75], s[74:75], vcc
    s_mov_b64 exec, vcc
    buffer_load_dwordx4 v[12:15], v5, s[40:43], s57 offen sc1
    s_mov_b64 exec, -1
L_gn_192:
    v_max3_u32 v30, v16, v17, v18
    v_max_u32 v30, v30, v19
    v_cmp_eq_u32 vcc, -1, v30
    s_cbranch_vccz L_gn_193
    s_or_b64 s[74:75], s[74:75], vcc
    s_mov_b64 exec, vcc
    buffer_load_dwordx4 v[16:19], v5, s[40:43], s58 offen sc1
    s_mov_b64 exec, -1
L_gn_193:
    v_max3_u32 v30, v20, v21, v22
    v_max_u32 v30, v30, v23
    v_cmp_eq_u32 vcc, -1, v30
    s_cbranch_vccz L_gn_194
    s_or_b64 s[74:75], s[74:75], vcc
    s_mov_b64 exec, vcc
    buffer_load_dwordx4 v[20:23], v5, s[40:43], s59 offen sc1
    s_mov_b64 exec, -1
L_gn_194:
    v_max3_u32 v30, v24, v25, v26
    v_max_u32 v30, v30, v27
    v_cmp_eq_u32 vcc, -1, v30
    s_cbranch_vccz L_gn_195
    s_or_b64 s[74:75], s[74:75], vcc
    s_mov_b64 exec, vcc
    buffer_load_dwordx4 v[24:27], v5, s[40:43], s60 offen sc1
    s_mov_b64 exec, -1
L_gn_195:
    s_cmp_eq_u64 s[74:75], 0
    s_cbranch_scc1 L_gk_191
    s_waitcnt vmcnt(0)
    s_branch L_gw_189
L_gs_198:
    buffer_store_dword v12, v11, s[40:43], s59 offen sc1
    s_branch L_gb_199
L_pr_201:
    s_sub_u32 s56, s56, 1
    s_cbranch_scc1 L_done
    buffer_load_dword v12, v9, s[40:43], s57 offen sc1
    s_waitcnt vmcnt(0)
    s_branch L_pw_200
L_gr_203:
    s_sub_u32 s56, s56, 1
L_pad21:
    s_cbranch_execz L_padback
    s_cbranch_scc1 L_done
    s_mov_b64 s[74:75], 0
    v_max3_u32 v30, v12, v13, v14
    v_max_u32 v30, v30, v15
    v_cmp_eq_u32 vcc, -1, v30
    s_cbranch_vccz L_gn_205
    s_or_b64 s[74:75], s[74:75], vcc
    s_mov_b64 exec, vcc
    buffer_load_dwordx4 v[12:15], v5, s[40:43], s57 offen sc1
    s_mov_b64 exec, -1
L_gn_205:
    v_max3_u32 v30, v16, v17, v18
    v_max_u32 v30, v30, v19
    v_cmp_eq_u32 vcc, -1, v30
    s_cbranch_vccz L_gn_206
    s_or_b64 s[74:75], s[74:75], vcc
    s_mov_b64 exec, vcc
    buffer_load_dwordx4 v[16:19], v5, s[40:43], s58 offen sc1
    s_mov_b64 exec, -1
L_gn_206:
    v_max3_u32 v30, v20, v21, v22
    v_max_u32 v30, v30, v23
    v_cmp_eq_u32 vcc, -1, v30
    s_cbranch_vccz L_gn_207
    s_or_b64 s[74:75], s[74:75], vcc
    s_mov_b64 exec, vcc
    buffer_load_dwordx4 v[20:23], v5, s[40:43], s59 offen sc1
    s_mov_b64 exec, -1
L_gn_207:
    v_max3_u32 v30, v24, v25, v26
    v_max_u32 v30, v30, v27
    v_cmp_eq_u32 vcc, -1, v30
    s_cbranch_vccz L_gn_208
    s_or_b64 s[74:75], s[74:75], vcc
    s_mov_b64 exec, vcc
    buffer_load_dwordx4 v[24:27], v5, s[40:43], s60 offen sc1
    s_mov_b64 exec, -1
L_gn_208:
    s_cmp_eq_u64 s[74:75], 0
    s_cbranch_scc1 L_gk_204
    s_waitcnt vmcnt(0)
    s_branch L_gw_202
L_tail_end:
L_spread:
    s_add_u32 s62, s62, 557056
    s_cmp_eq_u32 s30, 5
    s_cbranch_scc0 L_skip_64
    v_mov_b64 v[12:13], -1
    v_mov_b64 v[14:15], -1
    v_lshlrev_b32 v16, 4, v0
    s_mul_i32 s57, s52, 1280
    s_add_u32 s57, s57, s62
    s_mov_b64 exec, 0xffff
    buffer_store_dwordx4 v[12:15], v16, s[40:43], s57 offen offset:1024 sc1
    s_mov_b64 exec, -1
    buffer_store_dwordx4 v[12:15], v16, s[40:43], s57 offen sc1
L_skip_64:
    s_cmp_eq_u32 s30, 7
    s_cbranch_scc0 L_skip_65
    v_and_b32 v60, 31, v0
    v_cmp_gt_u32 s[64:65], 20, v60
    v_min_u32 v60, 19, v60
    v_lshrrev_b32 v35, 5, v0
    v_lshlrev_b32 v35, 2, v35
    v_add_u32 v35, 162944, v35
    v_lshl_add_u32 v35, v60, 3, v35
    s_mul_i32 s66, s53, 6400
    s_add_u32 s66, s66, s62
    s_add_u32 s66, s66, 40960
    s_add_u32 s67, s66, 6144
    s_lshl_b32 s57, s54, 3
    v_lshrrev_b32 v34, 5, v0
    v_lshlrev_b32 v34, 2, v34
    v_add_u32 v34, s57, v34
    v_mov_b32 v61, 0x3f803f80
    v_cvt_pk_bf16_f32 v28, v2, v3
L_skip_65:
    s_cmp_eq_u32 s30, 7
    s_cbranch_scc0 L_skip_66
    v_lshlrev_b32 v2, 16, v28
    v_and_b32 v3, 0xffff0000, v28
    v_cndmask_b32 v28, 0, v28, s[64:65]
    v_dot2_f32_bf16 v27, v28, v61, 0
    v_dot2_f32_bf16 v62, v28, v28, 0
    s_nop 2
    v_permlane32_swap_b32 v27, v62
    v_add_f32 v27, v27, v62
    v_mov_b32 v62, v27
    s_nop 1
    v_permlane16_swap_b32 v27, v62
    v_add_f32 v27, v27, v62
    s_nop 1
    v_add_f32_dpp v27, v27, v27 row_ror:8 row_mask:0xf bank_mask:0xf
    s_nop 1
    v_add_f32_dpp v27, v27, v27 row_ror:4 row_mask:0xf bank_mask:0xf
    s_nop 1
    v_add_f32_dpp v27, v27, v27 row_ror:2 row_mask:0xf bank_mask:0xf
    s_nop 1
    v_add_f32_dpp v27, v27, v27 row_ror:1 row_mask:0xf bank_mask:0xf
    v_min_u32 v27, -2, v27
    s_mov_b32 exec_lo, 0x1
    s_mov_b32 exec_hi, 0x1
    s_cmp_eq_u32 s55, 0
    s_cbranch_scc1 L_gs_67
    buffer_store_dword v27, v34, s[40:43], s67 offen
L_gb_68:
    s_mov_b64 exec, -1
L_skip_66:
    s_cmp_lt_u32 s30, 6
    s_cbranch_scc0 L_skip_69
    s_lshr_b32 s57, s30, 1
    s_lshl_b32 s57, s57, 10
    s_and_b32 s58, s30, 1
    s_lshl_b32 s58, s58, 6
    s_add_u32 s57, s57, s58
    v_lshrrev_b32 v18, 5, v0
    v_mul_u32_u24 v18, 6144, v18
    v_bfe_u32 v60, v0, 3, 1
    v_mul_u32_u24 v60, 3072, v60
    v_add_u32 v18, v60, v18
    v_bfe_u32 v60, v0, 4, 1
    v_lshl_add_u32 v18, v60, 9, v18
    v_bfe_u32 v60, v0, 2, 1
    v_lshl_add_u32 v18, v60, 7, v18
    v_and_b32 v60, 3, v0
    v_lshl_add_u32 v18, v60, 3, v18
    v_add_u32 v18, s57, v18
    v_bfe_u32 v19, v0, 4, 1
    v_mul_u32_u24 v19, 3072, v19
    v_bfe_u32 v60, v0, 3, 1
    v_lshl_add_u32 v19, v60, 9, v19
    v_bfe_u32 v60, v0, 2, 1
    v_lshl_add_u32 v19, v60, 7, v19
    v_and_b32 v60, 3, v0
    v_lshl_add_u32 v19, v60, 3, v19
    v_add_u32 v19, s57, v19
    v_add_u32 v19, 24576, v19
    ds_read_b64_tr_b16 v[36:37], v18 offset:0
    ds_read_b64_tr_b16 v[38:39], v18 offset:256
    ds_read_b64_tr_b16 v[40:41], v18 offset:12288
    ds_read_b64_tr_b16 v[42:43], v18 offset:12544
    ds_read_b64_tr_b16 v[44:45], v19 offset:0
    ds_read_b64_tr_b16 v[46:47], v19 offset:256
    ds_read_b64_tr_b16 v[48:49], v18 offset:32
    ds_read_b64_tr_b16 v[50:51], v18 offset:288
    ds_read_b64_tr_b16 v[52:53], v18 offset:12320
    ds_read_b64_tr_b16 v[54:55], v18 offset:12576
    ds_read_b64_tr_b16 v[56:57], v19 offset:32
    ds_read_b64_tr_b16 v[58:59], v19 offset:288
    v_lshrrev_b32 v32, 4, v0
    v_lshlrev_b32 v32, 5, v32
    v_bfe_u32 v60, v0, 1, 1
    v_lshl_add_u32 v32, v60, 4, v32
    v_and_b32 v60, 1, v0
    v_mul_u32_u24 v60, 192, v60
    v_add_u32 v32, v60, v32
    v_add_u32 v32, 162944, v32
    v_lshrrev_b32 v33, 4, v0
    v_lshlrev_b32 v33, 4, v33
    v_bfe_u32 v60, v0, 1, 1
    v_lshl_add_u32 v33, v60, 3, v33
    v_and_b32 v60, 1, v0
    v_mul_u32_u24 v60, 192, v60
    v_add_u32 v33, v60, v33
    v_add_u32 v33, 163072, v33
    v_mov_b64 v[24:25], 0
    v_mov_b64 v[26:27], 0
    v_mov_b64 v[28:29], 0
    v_mov_b64 v[30:31], 0
    s_lshr_b32 s57, s54, 1
    s_lshl_b32 s57, s57, 2
    s_and_b32 s58, s54, 1
    s_add_u32 s57, s57, s58
    s_lshl_b32 s57, s57, 4
    s_lshl_b32 s58, s30, 9
    s_add_u32 s57, s57, s58
    v_bfe_u32 v34, v0, 4, 1
    v_lshlrev_b32 v34, 8, v34
    v_bfe_u32 v60, v0, 1, 1
    v_lshl_add_u32 v34, v60, 5, v34
    v_bfe_u32 v60, v0, 2, 2
    v_lshl_add_u32 v34, v60, 2, v34
    v_lshrrev_b32 v60, 5, v0
    v_mul_u32_u24 v60, 3072, v60
    v_add_u32 v34, v60, v34
    v_add_u32 v34, s57, v34
    s_mul_i32 s59, s53, 6400
    s_add_u32 s59, s59, s62
    s_add_u32 s59, s59, 40960
    s_add_u32 s60, s59, 6144
    ds_read_b128 v[12:15], v32
    ds_read_b64 v[16:17], v33
    s_waitcnt lgkmcnt(1)
    v_smfmac_f32_16x16x64_bf16 v[24:27], v[12:15], v[36:43], v1
    v_smfmac_f32_16x16x64_bf16 v[28:31], v[12:15], v[48:55], v1
    s_waitcnt lgkmcnt(0)
    v_smfmac_f32_16x16x32_bf16 v[24:27], v[16:17], v[44:47], v1
    v_smfmac_f32_16x16x32_bf16 v[28:31], v[16:17], v[56:59], v1
    s_nop 6
    v_add_f32 v12, v24, v26
    s_nop 1
    v_add_f32_dpp v12, v28, v30 quad_perm:[0,1,2,3] row_mask:0x2 bank_mask:0xf
    s_nop 1
    v_add_f32_dpp v12, v25, v27 quad_perm:[0,1,2,3] row_mask:0x4 bank_mask:0xf
    s_nop 1
    v_add_f32_dpp v12, v29, v31 quad_perm:[0,1,2,3] row_mask:0x8 bank_mask:0xf
    s_nop 1
    v_mov_b32_dpp v13, v12 row_shl:1 row_mask:0xf bank_mask:0xf bound_ctrl:0
    v_cvt_pk_bf16_f32 v12, v12, v13
    v_min_u32 v12, -2, v12
    s_mov_b32 exec_lo, 0x55555555
    s_mov_b32 exec_hi, 0x55555555
    s_cmp_eq_u32 s55, 0
    s_cbranch_scc1 L_gs_70
    buffer_store_dword v12, v34, s[40:43], s59 offen
L_gb_71:
    s_mov_b64 exec, -1
L_skip_69:
    s_waitcnt vmcnt(0)
    s_barrier
    s_cmp_eq_u32 s30, 5
    s_cbranch_scc0 L_skip_72
    s_lshl_b32 s57, s52, 2
    s_add_u32 s57, s57, s72
    v_mov_b32 v13, s63
    s_mov_b64 exec, 0x1
    buffer_store_dword v13, v0, s[40:43], s57 offen offset:128 sc1
    s_mov_b64 exec, -1
    v_and_b32 v16, 31, v0
    v_lshlrev_b32 v16, 2, v16
    buffer_load_dword v17, v16, s[40:43], s72 offen offset:128 sc1
    s_waitcnt vmcnt(0)
L_pw_73:
    v_cmp_eq_u32 vcc, -1, v17
    s_cbranch_vccnz L_pr_74
L_skip_72:
    s_barrier
    s_branch L_spread_back
L_done:
L_exit:
    s_endpgm
.section .rodata,"a"
.p2align 6
.amdhsa_kernel interleave_layers__sliding_block_cached__dense_activation_gelu__decode_kernel
  .amdhsa_next_free_vgpr 256
  .amdhsa_next_free_sgpr 102
  .amdhsa_accum_offset 256
  .amdhsa_group_segment_fixed_size 0
  .amdhsa_kernarg_size 104
  .amdhsa_user_sgpr_count 2
  .amdhsa_user_sgpr_kernarg_segment_ptr 1
  .amdhsa_system_sgpr_workgroup_id_x 1
  .amdhsa_float_denorm_mode_32 3
.end_amdhsa_kernel
```

```asm
; @launch grid=(256,1,1) block=(512,1,1) lds=160256
.amdgcn_target "amdgcn-amd-amdhsa--gfx950"
.text
.fill 64, 4, 0xbf800000
.globl interleave_layers__sliding_block_cached__dense_activation_gelu__decode_kernel
.p2align 8
.type interleave_layers__sliding_block_cached__dense_activation_gelu__decode_kernel,@function
interleave_layers__sliding_block_cached__dense_activation_gelu__decode_kernel:
    s_load_dwordx16 s[4:19], s[0:1], 0
    s_load_dwordx8 s[20:27], s[0:1], 64
    s_load_dwordx2 s[28:29], s[0:1], 96
    s_cmp_ge_u32 s2, 256
    s_cbranch_scc1 L_exit
    s_getpc_b64 s[74:75]
L_pc:
    v_lshlrev_b32 v5, 6, v0
    v_min_u32 v5, L_exit-L_pc, v5
    global_load_dword v59, v5, s[74:75]
    v_lshrrev_b32 v5, 6, v0
    v_and_b32 v0, 63, v0
    v_readfirstlane_b32 s30, v5
    s_and_b32 s31, s2, 7
    s_lshr_b32 s52, s2, 3
    s_and_b32 s53, s52, 3
    s_lshr_b32 s54, s52, 2
    s_lshl_b32 s73, s31, 2
    s_add_u32 s73, s73, s53
    s_mul_i32 s3, s54, 3
    s_add_u32 s3, s3, s53
    s_cmp_eq_u32 s53, 3
    s_cselect_b32 s3, 31, s3
    v_lshrrev_b32 v8, 5, v0
    v_lshlrev_b32 v8, 2, v8
    v_bfe_u32 v60, v0, 4, 1
    v_lshl_add_u32 v8, v60, 0, v8
    v_and_b32 v9, 7, v0
    v_xor_b32 v8, v8, v9
    v_lshrrev_b32 v10, 3, v0
    v_mul_u32_u24 v10, 384, v10
    v_lshl_add_u32 v5, v8, 4, v10
    v_xor_b32 v6, 32, v5
    v_lshrrev_b32 v8, 4, v0
    v_lshlrev_b32 v8, 1, v8
    v_xor_b32 v8, v8, v9
    v_lshl_add_u32 v7, v8, 4, v10
    v_lshrrev_b32 v2, 3, v0
    v_mul_u32_u24 v2, 12288, v2
    v_and_b32 v60, 7, v0
    v_lshl_add_u32 v2, v60, 4, v2
    s_mul_i32 s57, s73, 12582912
    s_mul_i32 s58, s54, 3072
    s_add_u32 s57, s57, s58
    s_add_u32 s57, s57, 11010048
    s_sub_u32 s58, 1572864, s58
    s_mul_i32 s59, s73, 384
    s_mul_i32 s60, s54, 983040
    s_add_u32 s59, s59, s60
    s_sub_u32 s60, 7866368, s59
    s_lshl_b32 s61, s30, 11
    s_add_u32 s61, s61, 92160
    s_mul_i32 s62, s31, 83968
    s_lshl_b32 s72, s31, 8
    s_add_u32 s72, s72, 1425408
    s_mov_b32 s56, 65536
    s_mov_b32 s55, 1
    s_getreg_b32 s63, hwreg(20, 0, 3)
    v_mov_b32 v11, 0
    v_mov_b32 v3, 0
    v_mov_b32 v21, 0
    v_mov_b32 v34, 0
    v_mov_b32 v62, 0
    v_mov_b32 v63, 0
    v_mov_b64 v[12:13], -1
    v_mov_b64 v[14:15], -1
    v_lshlrev_b32 v10, 4, v0
    s_waitcnt lgkmcnt(0)
    s_add_u32 s32, s6, s57
    s_addc_u32 s33, s7, 0
    s_mov_b32 s34, s58
    s_mov_b32 s35, 0x20000
    s_add_u32 s36, s8, s57
    s_addc_u32 s37, s9, 0
    s_mov_b32 s38, s58
    s_mov_b32 s39, 0x20000
    s_mov_b32 s40, s28
    s_mov_b32 s41, s29
    s_mov_b32 s42, 1427456
    s_mov_b32 s43, 0x20000
    s_add_u32 s44, s10, s59
    s_addc_u32 s45, s11, 0
    s_mov_b32 s46, s60
    s_mov_b32 s47, 0x20000
    s_sub_u32 s44, s44, 2048
    s_subb_u32 s45, s45, 0
    s_cmp_eq_u32 s30, 6
    s_cbranch_scc0 L_skip_1
    s_setprio 3
    s_mov_b32 s57, 0
    s_mov_b32 s58, 195584
    s_mov_b32 m0, 92160
L_dma_2:
    s_waitcnt vmcnt(27)
    buffer_load_dwordx4 v5, s[32:35], s57 offen offset:0 nt lds
    s_waitcnt vmcnt(27)
    buffer_load_dwordx4 v6, s[32:35], s58 offen offset:1024 nt lds
    s_add_u32 s57, s57, 24576
    s_add_u32 s58, s58, 24576
    s_add_u32 m0, m0, 2048
    s_cmp_lg_u32 m0, 108544
    s_cbranch_scc1 L_dma_2
    s_mov_b32 s57, 128
    s_mov_b32 s58, 195712
    s_mov_b32 m0, 108544
L_dma_3:
    s_waitcnt vmcnt(27)
    buffer_load_dwordx4 v5, s[32:35], s57 offen offset:0 nt lds
    s_waitcnt vmcnt(27)
    buffer_load_dwordx4 v6, s[32:35], s58 offen offset:1024 nt lds
    s_add_u32 s57, s57, 24576
    s_add_u32 s58, s58, 24576
    s_add_u32 m0, m0, 2048
    s_cmp_lg_u32 m0, 124928
    s_cbranch_scc1 L_dma_3
    s_mov_b32 s57, 2048
    s_mov_b32 s58, 1152
    s_mov_b32 s59, 256
    s_mov_b32 m0, 0
L_dma_4:
    s_waitcnt vmcnt(27)
    buffer_load_dwordx4 v2, s[44:47], s57 offen offset:0 nt lds
    s_waitcnt vmcnt(27)
    buffer_load_dwordx4 v2, s[44:47], s58 offen offset:1024 nt lds
    s_waitcnt vmcnt(27)
    buffer_load_dwordx4 v2, s[44:47], s59 offen offset:2048 nt lds
    s_add_u32 s57, s57, 98304
    s_add_u32 s58, s58, 98304
    s_add_u32 s59, s59, 98304
    s_add_u32 m0, m0, 3072
    s_cmp_lg_u32 m0, 15360
    s_cbranch_scc1 L_dma_4
L_skip_1:
    s_cmp_lt_u32 s3, 20
    s_cselect_b32 s57, 7864320, 0
    s_add_u32 s58, s54, 1
    s_mul_i32 s58, s58, 245760
    s_cmp_lg_u32 s53, 3
    s_cselect_b64 s[48:49], s[12:13], s[16:17]
    s_cselect_b32 s50, s57, s58
    s_mov_b32 s51, 0x20000
    s_cmp_eq_u32 s30, 5
    s_cbranch_scc0 L_skip_5
    s_cmp_eq_u32 s52, 31
    s_cbranch_scc0 L_skip_6
    s_mov_b64 exec, 0xffff
    buffer_store_dwordx4 v[12:15], v10, s[40:43], s72 offen sc1
L_skip_6:
    s_mul_i32 s58, s2, 320
    s_add_u32 s58, s58, 1343488
    s_mov_b64 exec, 0xfffff
    buffer_store_dwordx4 v[12:15], v10, s[40:43], s58 offen sc1
    s_mul_i32 s57, s52, 1792
    s_add_u32 s57, s57, s62
    s_mov_b32 exec_lo, 0xffffffff
    s_mov_b32 exec_hi, 0xffff
    buffer_store_dwordx4 v[12:15], v10, s[40:43], s57 offen offset:1024
    s_mov_b64 exec, -1
    buffer_store_dwordx4 v[12:15], v10, s[40:43], s57 offen
    v_subrev_u32 v16, 8, v0
    v_cmp_gt_u32 vcc, 40, v16
    v_mov_b32 v16, 0x3f803f80
    s_nop 0
    v_cndmask_b32 v18, 0, v16, vcc
    v_min_u32 v16, 55, v0
    v_lshlrev_b32 v16, 2, v16
    v_add_u32 v16, 160032, v16
    ds_write_b32 v16, v18
    v_and_b32 v3, 7, v0
    v_lshlrev_b32 v3, 5, v3
L_skip_5:
    s_cmp_eq_u32 s30, 7
    s_cbranch_scc0 L_skip_7
    v_and_b32 v60, 31, v0
    v_min_u32 v60, 19, v60
    s_mul_i32 s57, s54, 160
    v_lshrrev_b32 v16, 5, v0
    v_lshlrev_b32 v16, 2, v16
    v_add_u32 v16, s57, v16
    v_lshl_add_u32 v16, v60, 3, v16
    global_load_dword v28, v16, s[4:5]
    global_load_dword v4, v16, s[22:23]
L_skip_7:
    v_bfe_u32 v8, v0, 1, 3
    v_lshrrev_b32 v9, 4, v0
    v_xor_b32 v9, v8, v9
    v_bfe_u32 v8, v0, 2, 1
    v_lshlrev_b32 v8, 10, v8
    v_bfe_u32 v60, v0, 3, 1
    v_lshl_add_u32 v8, v60, 9, v8
    v_and_b32 v60, 3, v0
    v_lshl_add_u32 v8, v60, 7, v8
    v_add_u32 v8, s61, v8
    v_lshl_add_u32 v8, v9, 4, v8
    v_xor_b32 v9, 64, v8
    v_bfe_u32 v1, v0, 1, 1
    v_mul_u32_u24 v1, 43690, v1
    v_add_u32 v1, 17476, v1
    s_waitcnt vmcnt(31)
    s_barrier
    ds_read_b128 v[64:67], v8 offset:0
    ds_read_b128 v[68:71], v9 offset:0
    s_cmp_eq_u32 s30, 6
    s_cbranch_scc0 L_skip_8
    s_mov_b32 s57, 256
    s_mov_b32 s58, 195840
    s_mov_b32 m0, 124928
L_dma_9:
    s_waitcnt vmcnt(27)
    buffer_load_dwordx4 v5, s[32:35], s57 offen offset:0 nt lds
    s_waitcnt vmcnt(27)
    buffer_load_dwordx4 v6, s[32:35], s58 offen offset:1024 nt lds
    s_add_u32 s57, s57, 24576
    s_add_u32 s58, s58, 24576
    s_add_u32 m0, m0, 2048
    s_cmp_lg_u32 m0, 141312
    s_cbranch_scc1 L_dma_9
L_skip_8:
    s_waitcnt lgkmcnt(0)
    s_cmp_eq_u32 s30, 5
    s_cbranch_scc0 L_skip_10
    s_cmp_eq_u32 s52, 31
    s_cbranch_scc0 L_skip_11
    s_lshl_b32 s57, s31, 5
    v_mov_b32 v16, s57
    s_waitcnt vmcnt(3)
    s_mov_b64 exec, 0x1
    global_store_dword v16, v12, s[26:27] sc1
    s_mov_b64 exec, -1
L_skip_11:
L_skip_10:
    s_waitcnt vmcnt(31)
    s_barrier
    ds_read_b128 v[72:75], v8 offset:16384
    ds_read_b128 v[76:79], v9 offset:16384
    s_cmp_eq_u32 s30, 6
    s_cbranch_scc0 L_skip_12
    s_mov_b32 s57, 493568
    s_mov_b32 s58, 492672
    s_mov_b32 s59, 491776
    s_mov_b32 m0, 15360
L_dma_13:
    s_waitcnt vmcnt(27)
    buffer_load_dwordx4 v2, s[44:47], s57 offen offset:0 nt lds
    s_waitcnt vmcnt(27)
    buffer_load_dwordx4 v2, s[44:47], s58 offen offset:1024 nt lds
    s_waitcnt vmcnt(27)
    buffer_load_dwordx4 v2, s[44:47], s59 offen offset:2048 nt lds
    s_add_u32 s57, s57, 98304
    s_add_u32 s58, s58, 98304
    s_add_u32 s59, s59, 98304
    s_add_u32 m0, m0, 3072
    s_cmp_lg_u32 m0, 30720
    s_cbranch_scc1 L_dma_13
    s_mov_b32 s57, 393216
    s_mov_b32 s58, 588800
    s_mov_b32 m0, 141312
L_dma_14:
    s_waitcnt vmcnt(27)
    buffer_load_dwordx4 v5, s[32:35], s57 offen offset:0 nt lds
    s_waitcnt vmcnt(27)
    buffer_load_dwordx4 v6, s[32:35], s58 offen offset:1024 nt lds
    s_add_u32 s57, s57, 24576
    s_add_u32 s58, s58, 24576
    s_add_u32 m0, m0, 2048
    s_cmp_lg_u32 m0, 157696
    s_cbranch_scc1 L_dma_14
L_skip_12:
    s_waitcnt lgkmcnt(0)
    s_waitcnt vmcnt(31)
    s_barrier
    ds_read_b128 v[80:83], v8 offset:32768
    ds_read_b128 v[84:87], v9 offset:32768
    s_cmp_eq_u32 s30, 6
    s_cbranch_scc0 L_skip_15
    s_cmp_lg_u32 s53, 3
    s_cbranch_scc0 L_wb_16
    s_mul_i32 s57, s31, 983040
    s_lshl_b32 s58, s3, 6
    s_add_u32 s57, s57, s58
    v_bfe_u32 v38, v0, 4, 1
    v_lshlrev_b32 v38, 1, v38
    v_xor_b32 v38, v38, v0
    v_and_b32 v38, 3, v38
    v_lshrrev_b32 v3, 5, v0
    v_mul_u32_u24 v3, 10240, v3
    v_bfe_u32 v39, v0, 4, 1
    v_mul_u32_u24 v39, 2560, v39
    v_add_u32 v3, v39, v3
    v_bfe_u32 v39, v0, 3, 1
    v_mul_u32_u24 v39, 5120, v39
    v_add_u32 v3, v39, v3
    v_bfe_u32 v39, v0, 2, 1
    v_mul_u32_u24 v39, 20480, v39
    v_add_u32 v3, v39, v3
    v_add_u32 v3, s57, v3
    v_lshl_add_u32 v3, v38, 4, v3
    s_mov_b32 s14, 40960
    s_mov_b32 s15, 256
    s_branch L_we_17
L_wb_16:
    s_mul_i32 s57, s31, 384
    s_mul_i32 s58, s54, 245760
    s_add_u32 s57, s57, s58
    v_lshlrev_b32 v3, 4, v0
    v_add_u32 v3, s57, v3
    v_mov_b32 v38, 2688
    v_cmp_lt_u32 vcc, 23, v0
    s_nop 1
    v_cndmask_b32 v38, 0, v38, vcc
    v_add_u32 v3, v38, v3
    v_mov_b32 v38, 0x7f000000
    v_cmp_lt_u32 vcc, 47, v0
    s_nop 1
    v_cndmask_b32 v3, v3, v38, vcc
    s_mov_b32 s14, 12288
    s_mov_b32 s15, 5120
L_we_17:
    s_mul_i32 s57, s14, 0
    s_mov_b32 m0, 30720
    s_waitcnt vmcnt(27)
    buffer_load_dwordx4 v3, s[48:51], s57 offen offset:0 nt lds
    s_mov_b32 s57, 393344
    s_mov_b32 s58, 588928
    s_mov_b32 m0, 92160
L_dma_18:
    s_waitcnt vmcnt(27)
    buffer_load_dwordx4 v5, s[32:35], s57 offen offset:0 nt lds
    s_waitcnt vmcnt(27)
    buffer_load_dwordx4 v6, s[32:35], s58 offen offset:1024 nt lds
    s_add_u32 s57, s57, 24576
    s_add_u32 s58, s58, 24576
    s_add_u32 m0, m0, 2048
    s_cmp_lg_u32 m0, 108544
    s_cbranch_scc1 L_dma_18
    s_mul_i32 s57, s14, 0
    s_add_u32 s57, s57, s15
    s_mov_b32 m0, 30720
    s_waitcnt vmcnt(27)
    buffer_load_dwordx4 v3, s[48:51], s57 offen offset:1024 nt lds
    s_mov_b32 s57, 393472
    s_mov_b32 s58, 589056
    s_mov_b32 m0, 108544
L_dma_19:
    s_waitcnt vmcnt(27)
    buffer_load_dwordx4 v5, s[32:35], s57 offen offset:0 nt lds
    s_waitcnt vmcnt(27)
    buffer_load_dwordx4 v6, s[32:35], s58 offen offset:1024 nt lds
    s_add_u32 s57, s57, 24576
    s_add_u32 s58, s58, 24576
    s_add_u32 m0, m0, 2048
    s_cmp_lg_u32 m0, 124928
    s_cbranch_scc1 L_dma_19
L_skip_15:
    s_waitcnt lgkmcnt(0)
    s_cmp_eq_u32 s30, 7
    s_cbranch_scc0 L_skip_20
    v_and_b32 v60, 31, v0
    v_cmp_gt_u32 s[64:65], 20, v60
    v_min_u32 v60, 19, v60
    v_lshrrev_b32 v35, 5, v0
    v_lshlrev_b32 v35, 2, v35
    v_add_u32 v35, 159872, v35
    v_lshl_add_u32 v35, v60, 3, v35
    s_mul_i32 s66, s53, 6400
    s_add_u32 s66, s66, s62
    s_add_u32 s66, s66, 57344
    s_add_u32 s67, s66, 6144
    s_lshl_b32 s57, s54, 3
    v_lshrrev_b32 v34, 5, v0
    v_lshlrev_b32 v34, 2, v34
    v_add_u32 v34, s57, v34
    v_mov_b32 v61, 0x3f803f80
    s_waitcnt vmcnt(0)
    ds_write_b32 v35, v28
    s_waitcnt lgkmcnt(0)
L_skip_20:
    s_waitcnt vmcnt(34)
    s_barrier
    ds_read_b128 v[88:91], v8 offset:49152
    ds_read_b128 v[92:95], v9 offset:49152
    s_cmp_eq_u32 s30, 6
    s_cbranch_scc0 L_skip_21
    s_mul_i32 s57, s14, 1
    s_mov_b32 m0, 32768
    s_waitcnt vmcnt(27)
    buffer_load_dwordx4 v3, s[48:51], s57 offen offset:0 nt lds
    s_mov_b32 s57, 786432
    s_mov_b32 s58, 982016
    s_mov_b32 m0, 124928
L_dma_22:
    s_waitcnt vmcnt(27)
    buffer_load_dwordx4 v5, s[32:35], s57 offen offset:0 nt lds
    s_waitcnt vmcnt(27)
    buffer_load_dwordx4 v6, s[32:35], s58 offen offset:1024 nt lds
    s_add_u32 s57, s57, 24576
    s_add_u32 s58, s58, 24576
    s_add_u32 m0, m0, 2048
    s_cmp_lg_u32 m0, 141312
    s_cbranch_scc1 L_dma_22
L_skip_21:
    s_waitcnt lgkmcnt(0)
    s_cmp_eq_u32 s30, 3
    s_cbranch_scc0 L_skip_23
    s_mov_b64 exec, 0
    s_cbranch_execz L_pad0
L_padback:
    s_mov_b64 exec, -1
L_skip_23:
    s_cmp_eq_u32 s30, 7
    s_cbranch_scc0 L_skip_24
    v_lshlrev_b32 v2, 16, v28
    v_and_b32 v3, 0xffff0000, v28
    v_cndmask_b32 v28, 0, v28, s[64:65]
    v_dot2_f32_bf16 v27, v28, v61, 0
    v_dot2_f32_bf16 v62, v28, v28, 0
    s_nop 2
    v_permlane32_swap_b32 v27, v62
    v_add_f32 v27, v27, v62
    v_mov_b32 v62, v27
    s_nop 1
    v_permlane16_swap_b32 v27, v62
    v_add_f32 v27, v27, v62
    s_nop 1
    v_add_f32_dpp v27, v27, v27 row_ror:8 row_mask:0xf bank_mask:0xf
    s_nop 1
    v_add_f32_dpp v27, v27, v27 row_ror:4 row_mask:0xf bank_mask:0xf
    s_nop 1
    v_add_f32_dpp v27, v27, v27 row_ror:2 row_mask:0xf bank_mask:0xf
    s_nop 1
    v_add_f32_dpp v27, v27, v27 row_ror:1 row_mask:0xf bank_mask:0xf
    v_min_u32 v27, -2, v27
    s_mov_b32 exec_lo, 0x1
    s_mov_b32 exec_hi, 0x1
    s_cmp_eq_u32 s55, 0
    s_cbranch_scc1 L_gs_25
    buffer_store_dword v27, v34, s[40:43], s67 offen
L_gb_26:
    s_mov_b64 exec, -1
L_skip_24:
    s_cmp_lt_u32 s30, 6
    s_cbranch_scc0 L_skip_27
    s_lshr_b32 s57, s30, 1
    s_mul_i32 s57, s57, 1024
    s_and_b32 s58, s30, 1
    s_lshl_b32 s58, s58, 6
    s_add_u32 s57, s57, s58
    v_lshrrev_b32 v18, 5, v0
    v_mul_u32_u24 v18, 6144, v18
    v_bfe_u32 v60, v0, 3, 1
    v_mul_u32_u24 v60, 3072, v60
    v_add_u32 v18, v60, v18
    v_bfe_u32 v60, v0, 4, 1
    v_lshl_add_u32 v18, v60, 9, v18
    v_bfe_u32 v60, v0, 2, 1
    v_lshl_add_u32 v18, v60, 7, v18
    v_and_b32 v60, 3, v0
    v_lshl_add_u32 v18, v60, 3, v18
    v_add_u32 v18, s57, v18
    v_bfe_u32 v19, v0, 4, 1
    v_mul_u32_u24 v19, 3072, v19
    v_bfe_u32 v60, v0, 3, 1
    v_lshl_add_u32 v19, v60, 9, v19
    v_bfe_u32 v60, v0, 2, 1
    v_lshl_add_u32 v19, v60, 7, v19
    v_and_b32 v60, 3, v0
    v_lshl_add_u32 v19, v60, 3, v19
    v_add_u32 v19, s57, v19
    v_add_u32 v19, 24576, v19
    ds_read_b64_tr_b16 v[36:37], v18 offset:0
    ds_read_b64_tr_b16 v[38:39], v18 offset:256
    ds_read_b64_tr_b16 v[40:41], v18 offset:12288
    ds_read_b64_tr_b16 v[42:43], v18 offset:12544
    ds_read_b64_tr_b16 v[44:45], v19 offset:0
    ds_read_b64_tr_b16 v[46:47], v19 offset:256
    ds_read_b64_tr_b16 v[48:49], v18 offset:32
    ds_read_b64_tr_b16 v[50:51], v18 offset:288
    ds_read_b64_tr_b16 v[52:53], v18 offset:12320
    ds_read_b64_tr_b16 v[54:55], v18 offset:12576
    ds_read_b64_tr_b16 v[56:57], v19 offset:32
    ds_read_b64_tr_b16 v[58:59], v19 offset:288
    v_lshrrev_b32 v32, 4, v0
    v_lshlrev_b32 v32, 5, v32
    v_bfe_u32 v60, v0, 1, 1
    v_lshl_add_u32 v32, v60, 4, v32
    v_and_b32 v60, 1, v0
    v_mul_u32_u24 v60, 192, v60
    v_add_u32 v32, v60, v32
    v_add_u32 v32, 159872, v32
    v_lshrrev_b32 v33, 4, v0
    v_lshlrev_b32 v33, 4, v33
    v_bfe_u32 v60, v0, 1, 1
    v_lshl_add_u32 v33, v60, 3, v33
    v_and_b32 v60, 1, v0
    v_mul_u32_u24 v60, 192, v60
    v_add_u32 v33, v60, v33
    v_add_u32 v33, 160000, v33
    v_mov_b64 v[24:25], 0
    v_mov_b64 v[26:27], 0
    v_mov_b64 v[28:29], 0
    v_mov_b64 v[30:31], 0
    s_lshr_b32 s57, s54, 1
    s_lshl_b32 s57, s57, 2
    s_and_b32 s58, s54, 1
    s_add_u32 s57, s57, s58
    s_lshl_b32 s57, s57, 4
    s_lshl_b32 s58, s30, 9
    s_add_u32 s57, s57, s58
    v_bfe_u32 v34, v0, 4, 1
    v_lshlrev_b32 v34, 8, v34
    v_bfe_u32 v60, v0, 1, 1
    v_lshl_add_u32 v34, v60, 5, v34
    v_bfe_u32 v60, v0, 2, 2
    v_lshl_add_u32 v34, v60, 2, v34
    v_lshrrev_b32 v60, 5, v0
    v_mul_u32_u24 v60, 3072, v60
    v_add_u32 v34, v60, v34
    v_add_u32 v34, s57, v34
    s_mul_i32 s59, s53, 6400
    s_add_u32 s59, s59, s62
    s_add_u32 s59, s59, 57344
    s_add_u32 s60, s59, 6144
    ds_read_b128 v[12:15], v32
    ds_read_b64 v[16:17], v33
    s_waitcnt lgkmcnt(1)
    v_smfmac_f32_16x16x64_bf16 v[24:27], v[12:15], v[36:43], v1
    v_smfmac_f32_16x16x64_bf16 v[28:31], v[12:15], v[48:55], v1
    s_waitcnt lgkmcnt(0)
    v_smfmac_f32_16x16x32_bf16 v[24:27], v[16:17], v[44:47], v1
    v_smfmac_f32_16x16x32_bf16 v[28:31], v[16:17], v[56:59], v1
    s_nop 6
    v_add_f32 v12, v24, v26
    s_nop 1
    v_add_f32_dpp v12, v28, v30 quad_perm:[0,1,2,3] row_mask:0x2 bank_mask:0xf
    s_nop 1
    v_add_f32_dpp v12, v25, v27 quad_perm:[0,1,2,3] row_mask:0x4 bank_mask:0xf
    s_nop 1
    v_add_f32_dpp v12, v29, v31 quad_perm:[0,1,2,3] row_mask:0x8 bank_mask:0xf
    s_nop 1
    v_mov_b32_dpp v13, v12 row_shl:1 row_mask:0xf bank_mask:0xf bound_ctrl:0
    v_cvt_pk_bf16_f32 v12, v12, v13
    v_min_u32 v12, -2, v12
    s_mov_b32 exec_lo, 0x55555555
    s_mov_b32 exec_hi, 0x55555555
    s_cmp_eq_u32 s55, 0
    s_cbranch_scc1 L_gs_28
    buffer_store_dword v12, v34, s[40:43], s59 offen
L_gb_29:
    s_mov_b64 exec, -1
L_skip_27:
    s_cmp_eq_u32 s30, 5
    s_cbranch_scc0 L_skip_30
    global_load_dword v2, v3, s[26:27] sc1
L_skip_30:
    s_waitcnt vmcnt(34)
    s_barrier
    ds_read_b128 v[96:99], v8 offset:0
    ds_read_b128 v[100:103], v9 offset:0
    s_cmp_eq_u32 s30, 6
    s_cbranch_scc0 L_skip_31
    s_mul_i32 s57, s14, 1
    s_add_u32 s57, s57, s15
    s_mov_b32 m0, 32768
    s_waitcnt vmcnt(27)
    buffer_load_dwordx4 v3, s[48:51], s57 offen offset:1024 nt lds
    s_mov_b32 s57, 786560
    s_mov_b32 s58, 982144
    s_mov_b32 m0, 141312
L_dma_32:
    s_waitcnt vmcnt(27)
    buffer_load_dwordx4 v5, s[32:35], s57 offen offset:0 nt lds
    s_waitcnt vmcnt(27)
    buffer_load_dwordx4 v6, s[32:35], s58 offen offset:1024 nt lds
    s_add_u32 s57, s57, 24576
    s_add_u32 s58, s58, 24576
    s_add_u32 m0, m0, 2048
    s_cmp_lg_u32 m0, 157696
    s_cbranch_scc1 L_dma_32
L_skip_31:
    s_waitcnt lgkmcnt(0)
    s_waitcnt vmcnt(34)
    s_barrier
    ds_read_b128 v[104:107], v8 offset:16384
    ds_read_b128 v[108:111], v9 offset:16384
    s_cmp_eq_u32 s30, 6
    s_cbranch_scc0 L_skip_33
    s_mul_i32 s57, s14, 2
    s_mov_b32 m0, 34816
    s_waitcnt vmcnt(27)
    buffer_load_dwordx4 v3, s[48:51], s57 offen offset:0 nt lds
    s_mov_b32 s57, 786688
    s_mov_b32 s58, 982272
    s_mov_b32 m0, 92160
L_dma_34:
    s_waitcnt vmcnt(27)
    buffer_load_dwordx4 v5, s[32:35], s57 offen offset:0 nt lds
    s_waitcnt vmcnt(27)
    buffer_load_dwordx4 v6, s[32:35], s58 offen offset:1024 nt lds
    s_add_u32 s57, s57, 24576
    s_add_u32 s58, s58, 24576
    s_add_u32 m0, m0, 2048
    s_cmp_lg_u32 m0, 108544
    s_cbranch_scc1 L_dma_34
L_skip_33:
    s_waitcnt lgkmcnt(0)
    s_cmp_lg_u32 s30, 6
    s_cbranch_scc0 L_skip_35
    s_waitcnt vmcnt(0)
L_skip_35:
    s_waitcnt vmcnt(34)
    s_barrier
    ds_read_b128 v[112:115], v8 offset:32768
    ds_read_b128 v[116:119], v9 offset:32768
    s_cmp_eq_u32 s30, 6
    s_cbranch_scc0 L_skip_36
    s_mul_i32 s57, s14, 2
    s_add_u32 s57, s57, s15
    s_mov_b32 m0, 34816
    s_waitcnt vmcnt(27)
    buffer_load_dwordx4 v3, s[48:51], s57 offen offset:1024 nt lds
    s_mov_b32 s57, 1179648
    s_mov_b32 s58, 1375232
    s_mov_b32 m0, 108544
L_dma_37:
    s_waitcnt vmcnt(27)
    buffer_load_dwordx4 v5, s[32:35], s57 offen offset:0 nt lds
    s_waitcnt vmcnt(27)
    buffer_load_dwordx4 v6, s[32:35], s58 offen offset:1024 nt lds
    s_add_u32 s57, s57, 24576
    s_add_u32 s58, s58, 24576
    s_add_u32 m0, m0, 2048
    s_cmp_lg_u32 m0, 124928
    s_cbranch_scc1 L_dma_37
L_skip_36:
    s_waitcnt lgkmcnt(0)
    s_cmp_eq_u32 s30, 5
    s_cbranch_scc0 L_skip_38
L_cw_39:
    v_readlane_b32 s57, v2, s31
    s_cmp_eq_u32 s57, 0
    s_cbranch_scc1 L_cr_40
    s_lshl_b32 s57, s52, 2
    s_add_u32 s57, s57, s72
    v_mov_b32 v13, s63
    s_mov_b64 exec, 0x1
    buffer_store_dword v13, v0, s[40:43], s57 offen offset:0 sc1
    s_mov_b64 exec, -1
L_skip_38:
    s_waitcnt vmcnt(34)
    s_barrier
    ds_read_b128 v[120:123], v8 offset:49152
    ds_read_b128 v[124:127], v9 offset:49152
    s_cmp_eq_u32 s30, 6
    s_cbranch_scc0 L_skip_41
    s_mul_i32 s57, s14, 3
    s_mov_b32 m0, 36864
    s_waitcnt vmcnt(27)
    buffer_load_dwordx4 v3, s[48:51], s57 offen offset:0 nt lds
    s_mov_b32 s57, 1179776
    s_mov_b32 s58, 1375360
    s_mov_b32 m0, 124928
L_dma_42:
    s_waitcnt vmcnt(27)
    buffer_load_dwordx4 v5, s[32:35], s57 offen offset:0 nt lds
    s_waitcnt vmcnt(27)
    buffer_load_dwordx4 v6, s[32:35], s58 offen offset:1024 nt lds
    s_add_u32 s57, s57, 24576
    s_add_u32 s58, s58, 24576
    s_add_u32 m0, m0, 2048
    s_cmp_lg_u32 m0, 141312
    s_cbranch_scc1 L_dma_42
L_skip_41:
    s_waitcnt lgkmcnt(0)
    s_waitcnt vmcnt(34)
    s_barrier
    ds_read_b128 v[128:131], v8 offset:0
    ds_read_b128 v[132:135], v9 offset:0
    s_cmp_eq_u32 s30, 6
    s_cbranch_scc0 L_skip_43
    s_mul_i32 s57, s14, 3
    s_add_u32 s57, s57, s15
    s_mov_b32 m0, 36864
    s_waitcnt vmcnt(27)
    buffer_load_dwordx4 v3, s[48:51], s57 offen offset:1024 nt lds
    s_mov_b32 s57, 1179904
    s_mov_b32 s58, 1375488
    s_mov_b32 m0, 141312
L_dma_44:
    s_waitcnt vmcnt(27)
    buffer_load_dwordx4 v5, s[32:35], s57 offen offset:0 nt lds
    s_waitcnt vmcnt(27)
    buffer_load_dwordx4 v6, s[32:35], s58 offen offset:1024 nt lds
    s_add_u32 s57, s57, 24576
    s_add_u32 s58, s58, 24576
    s_add_u32 m0, m0, 2048
    s_cmp_lg_u32 m0, 157696
    s_cbranch_scc1 L_dma_44
L_skip_43:
    s_waitcnt lgkmcnt(0)
    s_cmp_eq_u32 s30, 5
    s_cbranch_scc0 L_skip_45
    global_load_dword v2, v3, s[26:27] sc1
L_skip_45:
    s_waitcnt vmcnt(34)
    s_barrier
    ds_read_b128 v[136:139], v8 offset:16384
    ds_read_b128 v[140:143], v9 offset:16384
    s_cmp_eq_u32 s30, 6
    s_cbranch_scc0 L_skip_46
    s_mul_i32 s57, s14, 4
    s_mov_b32 m0, 38912
    s_waitcnt vmcnt(27)
    buffer_load_dwordx4 v3, s[48:51], s57 offen offset:0 nt lds
    s_mov_b32 s57, 0
    s_mov_b32 s58, 392192
    s_mov_b32 m0, 92160
L_dma_47:
    s_waitcnt vmcnt(27)
    buffer_load_dwordx4 v7, s[36:39], s57 offen offset:0 nt lds
    s_waitcnt vmcnt(27)
    buffer_load_dwordx4 v7, s[36:39], s58 offen offset:1024 nt lds
    s_add_u32 s57, s57, 24576
    s_add_u32 s58, s58, 24576
    s_add_u32 m0, m0, 2048
    s_cmp_lg_u32 m0, 108544
    s_cbranch_scc1 L_dma_47
L_skip_46:
    s_waitcnt lgkmcnt(0)
    s_waitcnt vmcnt(34)
    s_barrier
    ds_read_b128 v[144:147], v8 offset:32768
    ds_read_b128 v[148:151], v9 offset:32768
    s_cmp_eq_u32 s30, 6
    s_cbranch_scc0 L_skip_48
    s_mul_i32 s57, s14, 4
    s_add_u32 s57, s57, s15
    s_mov_b32 m0, 38912
    s_waitcnt vmcnt(27)
    buffer_load_dwordx4 v3, s[48:51], s57 offen offset:1024 nt lds
    s_mov_b32 s57, 128
    s_mov_b32 s58, 392320
    s_mov_b32 m0, 108544
L_dma_49:
    s_waitcnt vmcnt(27)
    buffer_load_dwordx4 v7, s[36:39], s57 offen offset:0 nt lds
    s_waitcnt vmcnt(27)
    buffer_load_dwordx4 v7, s[36:39], s58 offen offset:1024 nt lds
    s_add_u32 s57, s57, 24576
    s_add_u32 s58, s58, 24576
    s_add_u32 m0, m0, 2048
    s_cmp_lg_u32 m0, 124928
    s_cbranch_scc1 L_dma_49
L_skip_48:
    s_waitcnt lgkmcnt(0)
    s_cmp_eq_u32 s30, 5
    s_cbranch_scc0 L_skip_50
L_cw_51:
    s_waitcnt vmcnt(0)
    v_cmp_eq_u32 vcc, 0, v2
    s_cbranch_vccnz L_cr_52
    v_lshrrev_b32 v3, 3, v0
    v_lshlrev_b32 v3, 8, v3
    v_and_b32 v2, 7, v0
    v_lshl_add_u32 v3, v2, 4, v3
    v_add_u32 v3, 1425408, v3
    buffer_load_dwordx4 v[24:27], v3, s[40:43], 0 offen sc1
L_skip_50:
    s_waitcnt vmcnt(34)
    s_barrier
    ds_read_b128 v[152:155], v8 offset:49152
    ds_read_b128 v[156:159], v9 offset:49152
    s_cmp_eq_u32 s30, 6
    s_cbranch_scc0 L_skip_53
    s_mul_i32 s57, s14, 5
    s_mov_b32 m0, 40960
    s_waitcnt vmcnt(27)
    buffer_load_dwordx4 v3, s[48:51], s57 offen offset:0 nt lds
    s_mov_b32 s57, 256
    s_mov_b32 s58, 392448
    s_mov_b32 m0, 124928
L_dma_54:
    s_waitcnt vmcnt(27)
    buffer_load_dwordx4 v7, s[36:39], s57 offen offset:0 nt lds
    s_waitcnt vmcnt(27)
    buffer_load_dwordx4 v7, s[36:39], s58 offen offset:1024 nt lds
    s_add_u32 s57, s57, 24576
    s_add_u32 s58, s58, 24576
    s_add_u32 m0, m0, 2048
    s_cmp_lg_u32 m0, 141312
    s_cbranch_scc1 L_dma_54
L_skip_53:
    s_waitcnt lgkmcnt(0)
    v_lshrrev_b32 v8, 2, v0
    v_lshlrev_b32 v8, 7, v8
    v_bfe_u32 v60, v0, 3, 2
    v_lshl_add_u32 v8, v60, 5, v8
    v_and_b32 v60, 3, v0
    v_lshl_add_u32 v8, v60, 3, v8
    v_add_u32 v8, s61, v8
    v_xor_b32 v9, 32, v8
    v_xor_b32 v10, 64, v8
    v_xor_b32 v11, 96, v8
    s_waitcnt vmcnt(34)
    s_barrier
    ds_read_b64_tr_b16 v[160:161], v8 offset:0
    ds_read_b64_tr_b16 v[168:169], v9 offset:0
    ds_read_b64_tr_b16 v[176:177], v10 offset:0
    ds_read_b64_tr_b16 v[184:185], v11 offset:0
    s_cmp_eq_u32 s30, 6
    s_cbranch_scc0 L_skip_55
    s_mul_i32 s57, s14, 5
    s_add_u32 s57, s57, s15
    s_mov_b32 m0, 40960
    s_waitcnt vmcnt(27)
    buffer_load_dwordx4 v3, s[48:51], s57 offen offset:1024 nt lds
    s_mov_b32 s57, 196608
    s_mov_b32 s58, 588800
    s_mov_b32 m0, 141312
L_dma_56:
    s_waitcnt vmcnt(27)
    buffer_load_dwordx4 v7, s[36:39], s57 offen offset:0 nt lds
    s_waitcnt vmcnt(27)
    buffer_load_dwordx4 v7, s[36:39], s58 offen offset:1024 nt lds
    s_add_u32 s57, s57, 24576
    s_add_u32 s58, s58, 24576
    s_add_u32 m0, m0, 2048
    s_cmp_lg_u32 m0, 157696
    s_cbranch_scc1 L_dma_56
L_skip_55:
    s_waitcnt lgkmcnt(0)
    s_cmp_eq_u32 s30, 5
    s_cbranch_scc0 L_skip_57
    s_waitcnt vmcnt(0)
L_pw_58:
    v_max3_u32 v28, v24, v25, v26
    v_max_u32 v28, v28, v27
    v_cmp_eq_u32 vcc, -1, v28
    s_cbranch_vccnz L_pr_59
    v_xor_b32 v24, s63, v24
    v_xor_b32 v25, s63, v25
    v_xor_b32 v26, s63, v26
    v_xor_b32 v27, s63, v27
    v_or3_b32 v24, v24, v25, v26
    v_or_b32 v24, v24, v27
    v_cmp_ne_u32 vcc, 0, v24
    s_lshl_b32 s57, s31, 3
    s_lshr_b64 vcc, vcc, s57
    s_and_b32 s57, vcc_lo, 0xff
    s_cselect_b32 s57, 0, 1
    v_mov_b32 v37, 159808
    v_mov_b32 v38, s57
    ds_write_b32 v37, v38
    s_waitcnt lgkmcnt(0)
L_skip_57:
    s_waitcnt vmcnt(34)
    s_barrier
    ds_read_b64_tr_b16 v[192:193], v8 offset:16384
    ds_read_b64_tr_b16 v[200:201], v9 offset:16384
    ds_read_b64_tr_b16 v[208:209], v10 offset:16384
    ds_read_b64_tr_b16 v[216:217], v11 offset:16384
    s_cmp_eq_u32 s30, 6
    s_cbranch_scc0 L_skip_60
    s_mul_i32 s57, s14, 6
    s_mov_b32 m0, 43008
    s_waitcnt vmcnt(27)
    buffer_load_dwordx4 v3, s[48:51], s57 offen offset:0 nt lds
    s_mov_b32 s57, 196736
    s_mov_b32 s58, 588928
    s_mov_b32 m0, 92160
L_dma_61:
    s_waitcnt vmcnt(27)
    buffer_load_dwordx4 v7, s[36:39], s57 offen offset:0 nt lds
    s_waitcnt vmcnt(27)
    buffer_load_dwordx4 v7, s[36:39], s58 offen offset:1024 nt lds
    s_add_u32 s57, s57, 24576
    s_add_u32 s58, s58, 24576
    s_add_u32 m0, m0, 2048
    s_cmp_lg_u32 m0, 108544
    s_cbranch_scc1 L_dma_61
L_skip_60:
    s_waitcnt lgkmcnt(0)
    v_mov_b32 v41, 159808
    ds_read_b32 v42, v41
    s_waitcnt lgkmcnt(0)
    v_readfirstlane_b32 s55, v42
    s_cmp_eq_u32 s55, 0
    s_cbranch_scc1 L_spread
L_spread_back:
    s_cmp_eq_u32 s30, 4
    s_cbranch_scc0 L_skip_73
    s_mul_i32 s59, s53, 6400
    s_add_u32 s59, s59, s62
    s_add_u32 s59, s59, 57344
    s_add_u32 s60, s59, 6144
    v_lshlrev_b32 v16, 4, v0
    s_add_u32 s60, s59, 3072
    s_mov_b32 m0, 79872
    s_nop 0
    buffer_load_dwordx4 v16, s[40:43], s59 offen offset:0 sc1 nt lds
    buffer_load_dwordx4 v16, s[40:43], s59 offen offset:1024 sc1 nt lds
    buffer_load_dwordx4 v16, s[40:43], s59 offen offset:2048 sc1 nt lds
    s_mov_b32 m0, 82944
    s_nop 0
    buffer_load_dwordx4 v16, s[40:43], s60 offen offset:0 sc1 nt lds
    buffer_load_dwordx4 v16, s[40:43], s60 offen offset:1024 sc1 nt lds
    buffer_load_dwordx4 v16, s[40:43], s60 offen offset:2048 sc1 nt lds
    s_mov_b64 exec, 0xf
    buffer_load_dwordx4 v16, s[40:43], s60 offen offset:3072 sc1 nt lds
    s_mov_b64 exec, -1
L_skip_73:
    s_waitcnt vmcnt(34)
    s_barrier
    ds_read_b64_tr_b16 v[224:225], v8 offset:32768
    ds_read_b64_tr_b16 v[232:233], v9 offset:32768
    ds_read_b64_tr_b16 v[240:241], v10 offset:32768
    ds_read_b64_tr_b16 v[248:249], v11 offset:32768
    s_cmp_eq_u32 s30, 6
    s_cbranch_scc0 L_skip_74
    s_mul_i32 s57, s14, 6
    s_add_u32 s57, s57, s15
    s_mov_b32 m0, 43008
    s_waitcnt vmcnt(27)
    buffer_load_dwordx4 v3, s[48:51], s57 offen offset:1024 nt lds
    s_mov_b32 s57, 196864
    s_mov_b32 s58, 589056
    s_mov_b32 m0, 108544
L_dma_75:
    s_waitcnt vmcnt(27)
    buffer_load_dwordx4 v7, s[36:39], s57 offen offset:0 nt lds
    s_waitcnt vmcnt(27)
    buffer_load_dwordx4 v7, s[36:39], s58 offen offset:1024 nt lds
    s_add_u32 s57, s57, 24576
    s_add_u32 s58, s58, 24576
    s_add_u32 m0, m0, 2048
    s_cmp_lg_u32 m0, 124928
    s_cbranch_scc1 L_dma_75
L_skip_74:
    s_waitcnt lgkmcnt(0)
    s_waitcnt vmcnt(34)
    s_barrier
    ds_read_b64_tr_b16 v[162:163], v8 offset:49152
    ds_read_b64_tr_b16 v[170:171], v9 offset:49152
    ds_read_b64_tr_b16 v[178:179], v10 offset:49152
    ds_read_b64_tr_b16 v[186:187], v11 offset:49152
    s_cmp_eq_u32 s30, 6
    s_cbranch_scc0 L_skip_76
    s_mul_i32 s57, s14, 7
    s_mov_b32 m0, 45056
    s_waitcnt vmcnt(27)
    buffer_load_dwordx4 v3, s[48:51], s57 offen offset:0 nt lds
    s_mov_b32 s57, 786432
    s_mov_b32 s58, 1178624
    s_mov_b32 m0, 124928
L_dma_77:
    s_waitcnt vmcnt(27)
    buffer_load_dwordx4 v7, s[36:39], s57 offen offset:0 nt lds
    s_waitcnt vmcnt(27)
    buffer_load_dwordx4 v7, s[36:39], s58 offen offset:1024 nt lds
    s_add_u32 s57, s57, 24576
    s_add_u32 s58, s58, 24576
    s_add_u32 m0, m0, 2048
    s_cmp_lg_u32 m0, 141312
    s_cbranch_scc1 L_dma_77
L_skip_76:
    s_waitcnt lgkmcnt(0)
    s_cmp_eq_u32 s30, 4
    s_cbranch_scc0 L_skip_78
    s_waitcnt vmcnt(0)
L_skip_78:
    s_waitcnt vmcnt(34)
    s_barrier
    ds_read_b64_tr_b16 v[194:195], v8 offset:0
    ds_read_b64_tr_b16 v[202:203], v9 offset:0
    ds_read_b64_tr_b16 v[210:211], v10 offset:0
    ds_read_b64_tr_b16 v[218:219], v11 offset:0
    s_cmp_eq_u32 s30, 6
    s_cbranch_scc0 L_skip_79
    s_mul_i32 s57, s14, 7
    s_add_u32 s57, s57, s15
    s_mov_b32 m0, 45056
    s_nop 0
    buffer_load_dwordx4 v3, s[48:51], s57 offen offset:1024 nt lds
    s_mov_b32 s57, 786560
    s_mov_b32 s58, 1178752
    s_mov_b32 m0, 141312
L_dma_80:
    s_nop 0
    buffer_load_dwordx4 v7, s[36:39], s57 offen offset:0 nt lds
    buffer_load_dwordx4 v7, s[36:39], s58 offen offset:1024 nt lds
    s_add_u32 s57, s57, 24576
    s_add_u32 s58, s58, 24576
    s_add_u32 m0, m0, 2048
    s_cmp_lg_u32 m0, 157696
    s_cbranch_scc1 L_dma_80
L_skip_79:
    s_waitcnt lgkmcnt(0)
    v_lshlrev_b32 v40, 4, v0
    v_add_u32 v40, 79872, v40
    ds_read_b128 v[12:15], v40 offset:3072
    ds_read_b128 v[16:19], v40 offset:4096
    ds_read_b128 v[20:23], v40 offset:5120
    v_mov_b64 v[24:25], 0
    v_mov_b64 v[26:27], 0
    v_mov_b64 v[28:29], 0
    v_mov_b64 v[30:31], 0
    v_mov_b64 v[32:33], 0
    v_mov_b64 v[34:35], 0
    v_mov_b64 v[36:37], 0
    v_mov_b64 v[38:39], 0
    s_waitcnt lgkmcnt(0)
    v_smfmac_f32_16x16x64_bf16 v[24:27], v[12:15], v[64:71], v1
    v_smfmac_f32_16x16x64_bf16 v[24:27], v[16:19], v[72:79], v1
    v_smfmac_f32_16x16x64_bf16 v[24:27], v[20:23], v[80:87], v1
    v_smfmac_f32_16x16x64_bf16 v[32:35], v[12:15], v[112:119], v1
    v_smfmac_f32_16x16x64_bf16 v[32:35], v[16:19], v[120:127], v1
    v_smfmac_f32_16x16x64_bf16 v[32:35], v[20:23], v[128:135], v1
    v_smfmac_f32_16x16x64_bf16 v[28:31], v[12:15], v[88:95], v1
    v_smfmac_f32_16x16x64_bf16 v[28:31], v[16:19], v[96:103], v1
    v_smfmac_f32_16x16x64_bf16 v[28:31], v[20:23], v[104:111], v1
    v_smfmac_f32_16x16x64_bf16 v[36:39], v[12:15], v[136:143], v1
    s_nop 0
    v_pk_add_f32 v[24:25], v[24:25], v[26:27]
    v_add_f32 v24, v24, v25
    v_smfmac_f32_16x16x64_bf16 v[36:39], v[16:19], v[144:151], v1
    v_pk_add_f32 v[32:33], v[32:33], v[34:35]
    v_add_f32 v32, v32, v33
    v_smfmac_f32_16x16x64_bf16 v[36:39], v[20:23], v[152:159], v1
    s_nop 0
    v_permlane32_swap_b32 v24, v32
    v_add_f32 v24, v24, v32
    v_pk_add_f32 v[28:29], v[28:29], v[30:31]
    v_add_f32 v28, v28, v29
    s_nop 2
    v_pk_add_f32 v[36:37], v[36:37], v[38:39]
    v_add_f32 v36, v36, v37
    s_nop 1
    v_permlane32_swap_b32 v28, v36
    v_add_f32 v28, v28, v36
    s_nop 1
    v_permlane16_swap_b32 v24, v28
    v_add_f32 v6, v24, v28
    s_waitcnt vmcnt(34)
    s_barrier
    ds_read_b64_tr_b16 v[226:227], v8 offset:16384
    ds_read_b64_tr_b16 v[234:235], v9 offset:16384
    ds_read_b64_tr_b16 v[242:243], v10 offset:16384
    ds_read_b64_tr_b16 v[250:251], v11 offset:16384
    s_cmp_eq_u32 s30, 6
    s_cbranch_scc0 L_skip_81
    s_mul_i32 s57, s14, 8
    s_mov_b32 m0, 47104
    s_nop 0
    buffer_load_dwordx4 v3, s[48:51], s57 offen offset:0 nt lds
    s_mov_b32 s57, 786688
    s_mov_b32 s58, 1178880
    s_mov_b32 m0, 92160
L_dma_82:
    s_nop 0
    buffer_load_dwordx4 v7, s[36:39], s57 offen offset:0 nt lds
    buffer_load_dwordx4 v7, s[36:39], s58 offen offset:1024 nt lds
    s_add_u32 s57, s57, 24576
    s_add_u32 s58, s58, 24576
    s_add_u32 m0, m0, 2048
    s_cmp_lg_u32 m0, 108544
    s_cbranch_scc1 L_dma_82
L_skip_81:
    s_waitcnt lgkmcnt(0)
    v_and_b32 v41, 7, v0
    v_lshlrev_b32 v41, 3, v41
    v_add_u32 v41, 86016, v41
    ds_read_b128 v[12:15], v40 offset:0
    ds_read_b128 v[16:19], v40 offset:1024
    ds_read_b128 v[20:23], v40 offset:2048
    ds_read_b64 v[52:53], v41
    v_mov_b64 v[24:25], 0
    v_mov_b64 v[26:27], 0
    v_mov_b64 v[28:29], 0
    v_mov_b64 v[30:31], 0
    v_mov_b64 v[32:33], 0
    v_mov_b64 v[34:35], 0
    v_mov_b64 v[36:37], 0
    v_mov_b64 v[38:39], 0
    s_waitcnt lgkmcnt(0)
    v_smfmac_f32_16x16x64_bf16 v[24:27], v[12:15], v[64:71], v1
    v_add_f32_dpp v52, v52, v52 row_ror:4 row_mask:0xf bank_mask:0xf
    v_add_f32_dpp v53, v53, v53 row_ror:4 row_mask:0xf bank_mask:0xf
    v_smfmac_f32_16x16x64_bf16 v[24:27], v[16:19], v[72:79], v1
    v_add_f32_dpp v52, v52, v52 row_ror:2 row_mask:0xf bank_mask:0xf
    v_add_f32_dpp v53, v53, v53 row_ror:2 row_mask:0xf bank_mask:0xf
    v_smfmac_f32_16x16x64_bf16 v[24:27], v[20:23], v[80:87], v1
    v_add_f32_dpp v52, v52, v52 row_ror:1 row_mask:0xf bank_mask:0xf
    v_add_f32_dpp v53, v53, v53 row_ror:1 row_mask:0xf bank_mask:0xf
    v_smfmac_f32_16x16x64_bf16 v[32:35], v[12:15], v[112:119], v1
    v_mul_f32 v52, 0x3acccccd, v52
    v_mul_f32 v53, 0x3acccccd, v53
    v_smfmac_f32_16x16x64_bf16 v[32:35], v[16:19], v[120:127], v1
    v_fma_f32 v53, -v52, v52, v53
    v_max_f32 v53, 0, v53
    v_smfmac_f32_16x16x64_bf16 v[32:35], v[20:23], v[128:135], v1
    v_add_f32 v53, 0x3727c5ac, v53
    v_rsq_f32 v53, v53
    v_smfmac_f32_16x16x64_bf16 v[28:31], v[12:15], v[88:95], v1
    s_mov_b32 vcc_lo, 0x55555555
    v_mul_f32 v53, 0x3dd53b95, v53
    v_smfmac_f32_16x16x64_bf16 v[28:31], v[16:19], v[96:103], v1
    s_mov_b32 vcc_hi, 0x55555555
    v_smfmac_f32_16x16x64_bf16 v[28:31], v[20:23], v[104:111], v1
    v_smfmac_f32_16x16x64_bf16 v[36:39], v[12:15], v[136:143], v1
    v_pk_add_f32 v[24:25], v[24:25], v[26:27]
    v_add_f32 v24, v24, v25
    v_smfmac_f32_16x16x64_bf16 v[36:39], v[16:19], v[144:151], v1
    v_pk_add_f32 v[32:33], v[32:33], v[34:35]
    v_add_f32 v32, v32, v33
    v_smfmac_f32_16x16x64_bf16 v[36:39], v[20:23], v[152:159], v1
    s_nop 0
    v_permlane32_swap_b32 v24, v32
    v_add_f32 v24, v24, v32
    v_pk_add_f32 v[28:29], v[28:29], v[30:31]
    v_add_f32 v28, v28, v29
    s_nop 2
    v_pk_add_f32 v[36:37], v[36:37], v[38:39]
    v_add_f32 v36, v36, v37
    s_nop 1
    v_permlane32_swap_b32 v28, v36
    v_add_f32 v28, v28, v36
    s_nop 1
    v_permlane16_swap_b32 v24, v28
    v_add_f32 v24, v24, v28
    v_fma_f32 v24, -v52, v6, v24
    s_nop 1
    v_max_f32_dpp v21, v24, v24 row_ror:8 row_mask:0xf bank_mask:0xf
    s_nop 1
    v_max_f32_dpp v21, v21, v21 row_ror:4 row_mask:0xf bank_mask:0xf
    s_nop 1
    v_max_f32_dpp v21, v21, v21 row_ror:2 row_mask:0xf bank_mask:0xf
    s_nop 1
    v_max_f32_dpp v21, v21, v21 row_ror:1 row_mask:0xf bank_mask:0xf
    s_nop 1
    v_max_f32_dpp v21, v21, v21 row_bcast:15 row_mask:0xa bank_mask:0xf
    s_nop 1
    v_max_f32_dpp v21, v21, v21 row_bcast:31 row_mask:0xc bank_mask:0xf
    s_nop 0
    v_readlane_b32 s57, v21, 63
    s_nop 1
    v_subrev_f32 v24, s57, v24
    v_mul_f32 v24, v24, v53
    v_exp_f32 v22, v24
    v_mul_f32 v20, s57, v53
    s_nop 0
    v_mov_b32_dpp v23, v22 row_shl:1 row_mask:0xf bank_mask:0xf bound_ctrl:0
    v_cvt_pk_bf16_f32 v23, v22, v23
    v_cndmask_b32 v12, 0, v23, vcc
    v_mov_b32 v21, v22
    s_nop 0
    v_mov_b32_dpp v13, v12 row_shl:4 row_mask:0xf bank_mask:0xf bound_ctrl:0
    v_mov_b32_dpp v14, v12 row_shl:8 row_mask:0xf bank_mask:0xf bound_ctrl:0
    v_mov_b32_dpp v15, v12 row_shl:12 row_mask:0xf bank_mask:0xf bound_ctrl:0
    v_mov_b64 v[40:41], 0
    v_mov_b64 v[42:43], 0
    v_mov_b64 v[44:45], 0
    v_mov_b64 v[46:47], 0
    v_mov_b64 v[48:49], 0
    v_mov_b64 v[50:51], 0
    v_mov_b64 v[52:53], 0
    v_mov_b64 v[54:55], 0
    v_mov_b64 v[56:57], 0
    v_mov_b64 v[58:59], 0
    v_mov_b64 v[60:61], 0
    v_mov_b64 v[62:63], 0
    s_lshl_b32 s58, s30, 3
    s_add_u32 s58, s58, 159744
    v_mov_b32 v37, s58
    v_mov_b32_dpp v16, v12 row_shr:1 row_mask:0xf bank_mask:0xf bound_ctrl:0
    v_mov_b32_dpp v17, v12 row_shl:3 row_mask:0xf bank_mask:0xf bound_ctrl:0
    v_mov_b32_dpp v18, v12 row_shl:7 row_mask:0xf bank_mask:0xf bound_ctrl:0
    v_mov_b32_dpp v19, v12 row_shl:11 row_mask:0xf bank_mask:0xf bound_ctrl:0
    v_permlane32_swap_b32 v21, v22
    v_add_f32 v21, v21, v22
    v_mov_b32 v22, v21
    s_nop 1
    v_permlane16_swap_b32 v21, v22
    v_add_f32 v21, v21, v22
    s_nop 1
    v_add_f32_dpp v21, v21, v21 row_ror:8 row_mask:0xf bank_mask:0xf
    s_nop 1
    v_add_f32_dpp v21, v21, v21 row_ror:4 row_mask:0xf bank_mask:0xf
    s_nop 1
    v_add_f32_dpp v21, v21, v21 row_ror:2 row_mask:0xf bank_mask:0xf
    s_nop 1
    v_add_f32_dpp v21, v21, v21 row_ror:1 row_mask:0xf bank_mask:0xf
    ds_write_b64 v37, v[20:21]
    v_and_b32 v36, 15, v0
    v_lshlrev_b32 v36, 4, v36
    v_add_u32 v36, s61, v36
    v_add_u32 v36, 32768, v36
    s_waitcnt lgkmcnt(0)
    s_waitcnt vmcnt(34)
    s_barrier
    ds_read_b64_tr_b16 v[164:165], v8 offset:32768
    ds_read_b64_tr_b16 v[172:173], v9 offset:32768
    ds_read_b64_tr_b16 v[180:181], v10 offset:32768
    ds_read_b64_tr_b16 v[188:189], v11 offset:32768
    s_cmp_eq_u32 s30, 6
    s_cbranch_scc0 L_skip_83
    s_mul_i32 s57, s14, 8
    s_add_u32 s57, s57, s15
    s_mov_b32 m0, 47104
    s_waitcnt vmcnt(27)
    buffer_load_dwordx4 v3, s[48:51], s57 offen offset:1024 nt lds
    s_mov_b32 s57, 983040
    s_mov_b32 s58, 1375232
    s_mov_b32 m0, 108544
L_dma_84:
    s_waitcnt vmcnt(27)
    buffer_load_dwordx4 v7, s[36:39], s57 offen offset:0 nt lds
    s_waitcnt vmcnt(27)
    buffer_load_dwordx4 v7, s[36:39], s58 offen offset:1024 nt lds
    s_add_u32 s57, s57, 24576
    s_add_u32 s58, s58, 24576
    s_add_u32 m0, m0, 2048
    s_cmp_lg_u32 m0, 124928
    s_cbranch_scc1 L_dma_84
L_skip_83:
    s_waitcnt lgkmcnt(0)
    s_cmp_lt_u32 s30, 2
    s_cbranch_scc0 L_skip_85
    v_and_b32 v37, 7, v0
    v_lshlrev_b32 v37, 3, v37
    v_add_u32 v37, 159744, v37
    ds_read_b64 v[38:39], v37
    s_lshl_b32 s57, s53, 3
    s_add_u32 s57, s57, s54
    s_lshl_b32 s57, s57, 2
    v_mov_b32 v23, s57
    s_add_u32 s57, s62, 55808
    s_waitcnt lgkmcnt(0)
    v_max_f32_dpp v37, v38, v38 row_ror:4 row_mask:0xf bank_mask:0xf
    s_nop 1
    v_max_f32_dpp v37, v37, v37 row_ror:2 row_mask:0xf bank_mask:0xf
    s_nop 1
    v_max_f32_dpp v37, v37, v37 row_ror:1 row_mask:0xf bank_mask:0xf
    v_sub_f32 v38, v38, v37
    v_exp_f32 v38, v38
    s_nop 0
    v_mul_f32 v39, v38, v39
    s_nop 1
    v_add_f32_dpp v39, v39, v39 row_ror:4 row_mask:0xf bank_mask:0xf
    s_nop 1
    v_add_f32_dpp v39, v39, v39 row_ror:2 row_mask:0xf bank_mask:0xf
    s_nop 1
    v_add_f32_dpp v39, v39, v39 row_ror:1 row_mask:0xf bank_mask:0xf
    v_log_f32 v22, v39
    v_rcp_f32 v39, v39
    v_add_f32 v22, v22, v37
    v_min_u32 v22, -2, v22
    v_mul_f32 v38, v38, v39
    s_cmp_eq_u32 s30, 0
    s_cbranch_scc0 L_skip_86
    s_mov_b64 exec, 0x1
    s_cmp_eq_u32 s55, 0
    s_cbranch_scc1 L_gs_87
    buffer_store_dword v22, v23, s[40:43], s57 offen
L_gb_88:
    s_mov_b64 exec, -1
L_skip_86:
    v_readlane_b32 s64, v38, 0
    v_readlane_b32 s65, v38, 1
    v_readlane_b32 s66, v38, 2
    v_readlane_b32 s67, v38, 3
    v_readlane_b32 s68, v38, 4
    v_readlane_b32 s69, v38, 5
    v_readlane_b32 s70, v38, 6
    v_readlane_b32 s71, v38, 7
    s_mul_i32 s57, s30, 48
    v_add_u32 v38, s57, v0
    v_bfe_u32 v20, v38, 5, 2
    v_lshlrev_b32 v20, 8, v20
    v_and_b32 v39, 15, v38
    v_lshl_add_u32 v20, v39, 4, v20
    v_bfe_u32 v39, v38, 4, 1
    v_lshl_add_u32 v20, v39, 3, v20
    v_add_u32 v20, 124928, v20
    s_lshr_b32 s57, s54, 1
    s_lshl_b32 s57, s57, 2
    s_and_b32 s58, s54, 1
    s_add_u32 s57, s57, s58
    s_lshl_b32 s58, s57, 4
    s_lshl_b32 s57, s57, 3
    v_bfe_u32 v21, v0, 3, 2
    v_lshlrev_b32 v21, 8, v21
    v_bfe_u32 v39, v0, 2, 1
    v_lshl_add_u32 v21, v39, 5, v21
    v_and_b32 v39, 3, v0
    v_lshl_add_u32 v21, v39, 2, v21
    v_add_u32 v21, s58, v21
    v_bfe_u32 v38, v0, 3, 1
    v_lshlrev_b32 v38, 8, v38
    v_bfe_u32 v39, v0, 1, 1
    v_lshl_add_u32 v38, v39, 7, v38
    v_bfe_u32 v39, v0, 2, 1
    v_lshl_add_u32 v38, v39, 4, v38
    v_and_b32 v39, 1, v0
    v_lshl_add_u32 v38, v39, 2, v38
    v_add_u32 v38, s57, v38
    v_add_u32 v38, 1024, v38
    v_cmp_gt_u32 vcc, 32, v0
    s_nop 1
    v_cndmask_b32 v21, v38, v21, vcc
    s_lshl_b32 s57, s53, 1
    s_add_u32 s57, s57, s30
    s_mul_i32 s57, s57, 1536
    s_add_u32 s57, s57, s62
    s_add_u32 s57, s57, 0
    v_add_u32 v21, s57, v21
L_skip_85:
    s_waitcnt vmcnt(34)
    s_barrier
    ds_read_b64_tr_b16 v[196:197], v8 offset:49152
    ds_read_b64_tr_b16 v[204:205], v9 offset:49152
    ds_read_b64_tr_b16 v[212:213], v10 offset:49152
    ds_read_b64_tr_b16 v[220:221], v11 offset:49152
    s_cmp_eq_u32 s30, 6
    s_cbranch_scc0 L_skip_89
    s_mul_i32 s57, s14, 9
    s_mov_b32 m0, 49152
    s_waitcnt vmcnt(27)
    buffer_load_dwordx4 v3, s[48:51], s57 offen offset:0 nt lds
    s_mov_b32 s57, 983168
    s_mov_b32 s58, 1375360
    s_mov_b32 m0, 124928
L_dma_90:
    s_waitcnt vmcnt(27)
    buffer_load_dwordx4 v7, s[36:39], s57 offen offset:0 nt lds
    s_waitcnt vmcnt(27)
    buffer_load_dwordx4 v7, s[36:39], s58 offen offset:1024 nt lds
    s_add_u32 s57, s57, 24576
    s_add_u32 s58, s58, 24576
    s_add_u32 m0, m0, 2048
    s_cmp_lg_u32 m0, 141312
    s_cbranch_scc1 L_dma_90
L_skip_89:
    s_waitcnt lgkmcnt(0)
    s_cmp_eq_u32 s30, 2
    s_cbranch_scc0 L_skip_91
    s_mul_i32 s57, s52, 1792
    s_add_u32 s57, s57, s62
    v_min_u32 v37, 13, v0
    v_lshlrev_b32 v37, 7, v37
    buffer_load_dword v37, v37, s[40:43], s57 offen sc1 nt
L_skip_91:
    s_waitcnt vmcnt(34)
    s_barrier
    ds_read_b64_tr_b16 v[228:229], v8 offset:0
    ds_read_b64_tr_b16 v[236:237], v9 offset:0
    ds_read_b64_tr_b16 v[244:245], v10 offset:0
    ds_read_b64_tr_b16 v[252:253], v11 offset:0
    s_cmp_eq_u32 s30, 6
    s_cbranch_scc0 L_skip_92
    s_mul_i32 s57, s14, 9
    s_add_u32 s57, s57, s15
    s_mov_b32 m0, 49152
    s_waitcnt vmcnt(27)
    buffer_load_dwordx4 v3, s[48:51], s57 offen offset:1024 nt lds
    s_mov_b32 s57, 983296
    s_mov_b32 s58, 1375488
    s_mov_b32 m0, 141312
L_dma_93:
    s_waitcnt vmcnt(27)
    buffer_load_dwordx4 v7, s[36:39], s57 offen offset:0 nt lds
    s_waitcnt vmcnt(27)
    buffer_load_dwordx4 v7, s[36:39], s58 offen offset:1024 nt lds
    s_add_u32 s57, s57, 24576
    s_add_u32 s58, s58, 24576
    s_add_u32 m0, m0, 2048
    s_cmp_lg_u32 m0, 157696
    s_cbranch_scc1 L_dma_93
L_skip_92:
    s_waitcnt lgkmcnt(0)
    s_branch L_tail
.p2align 10
L_tail:
L_pad0:
    s_cbranch_execz L_pad1
    s_waitcnt vmcnt(34)
    s_barrier
    ds_read_b64_tr_b16 v[166:167], v8 offset:16384
    ds_read_b64_tr_b16 v[174:175], v9 offset:16384
    ds_read_b64_tr_b16 v[182:183], v10 offset:16384
    ds_read_b64_tr_b16 v[190:191], v11 offset:16384
    s_waitcnt lgkmcnt(0)
    v_smfmac_f32_16x16x64_bf16 v[40:43], v[12:15], v[160:167], v1
    v_smfmac_f32_16x16x64_bf16 v[40:43], v[16:19], v[168:175], v1
    v_smfmac_f32_16x16x64_bf16 v[44:47], v[12:15], v[176:183], v1
    v_smfmac_f32_16x16x64_bf16 v[44:47], v[16:19], v[184:191], v1
    s_cmp_eq_u32 s30, 6
    s_cbranch_scc0 L_skip_94
    s_mul_i32 s57, s14, 10
    s_add_u32 s58, s57, s15
    s_mov_b32 m0, 51200
L_dma_95:
    s_waitcnt vmcnt(33)
    buffer_load_dwordx4 v3, s[48:51], s57 offen offset:0 nt lds
    s_waitcnt vmcnt(33)
    buffer_load_dwordx4 v3, s[48:51], s58 offen offset:1024 nt lds
    s_add_u32 s57, s57, s14
    s_add_u32 s58, s58, s14
    s_add_u32 m0, m0, 2048
    s_cmp_lg_u32 m0, 65536
    s_cbranch_scc1 L_dma_95
L_skip_94:
    s_nop 3
    v_pk_add_f32 v[24:25], v[40:41], v[42:43]
    s_nop 0
    v_pk_add_f32 v[26:27], v[44:45], v[46:47]
    s_waitcnt vmcnt(31)
    s_barrier
    ds_read_b64_tr_b16 v[198:199], v8 offset:32768
    ds_read_b64_tr_b16 v[206:207], v9 offset:32768
    ds_read_b64_tr_b16 v[214:215], v10 offset:32768
    ds_read_b64_tr_b16 v[222:223], v11 offset:32768
    s_waitcnt lgkmcnt(0)
    v_smfmac_f32_16x16x64_bf16 v[48:51], v[12:15], v[192:199], v1
    v_smfmac_f32_16x16x64_bf16 v[48:51], v[16:19], v[200:207], v1
    v_smfmac_f32_16x16x64_bf16 v[52:55], v[12:15], v[208:215], v1
    v_smfmac_f32_16x16x64_bf16 v[52:55], v[16:19], v[216:223], v1
    s_cmp_eq_u32 s30, 6
    s_cbranch_scc0 L_skip_96
    s_mul_i32 s57, s14, 17
    s_add_u32 s58, s57, s15
    s_mov_b32 m0, 65536
L_dma_97:
    s_waitcnt vmcnt(33)
    buffer_load_dwordx4 v3, s[48:51], s57 offen offset:0 nt lds
    s_waitcnt vmcnt(33)
    buffer_load_dwordx4 v3, s[48:51], s58 offen offset:1024 nt lds
    s_add_u32 s57, s57, s14
    s_add_u32 s58, s58, s14
    s_add_u32 m0, m0, 2048
    s_cmp_lg_u32 m0, 79872
    s_cbranch_scc1 L_dma_97
L_skip_96:
    s_nop 3
    v_pk_add_f32 v[28:29], v[48:49], v[50:51]
    s_nop 0
    v_pk_add_f32 v[30:31], v[52:53], v[54:55]
    s_waitcnt vmcnt(28)
    s_barrier
    ds_read_b64_tr_b16 v[230:231], v8 offset:49152
    ds_read_b64_tr_b16 v[238:239], v9 offset:49152
    ds_read_b64_tr_b16 v[246:247], v10 offset:49152
    ds_read_b64_tr_b16 v[254:255], v11 offset:49152
    s_waitcnt lgkmcnt(0)
    v_smfmac_f32_16x16x64_bf16 v[56:59], v[12:15], v[224:231], v1
    v_smfmac_f32_16x16x64_bf16 v[56:59], v[16:19], v[232:239], v1
    v_smfmac_f32_16x16x64_bf16 v[60:63], v[12:15], v[240:247], v1
    v_smfmac_f32_16x16x64_bf16 v[60:63], v[16:19], v[248:255], v1
    s_nop 5
    v_pk_add_f32 v[32:33], v[56:57], v[58:59]
    s_nop 0
    v_pk_add_f32 v[34:35], v[60:61], v[62:63]
    s_setprio 0
    s_mov_b64 exec, 0xffff
    ds_write_b128 v36, v[24:27] offset:0
    ds_write_b128 v36, v[28:31] offset:256
    ds_write_b128 v36, v[32:35] offset:512
    s_mov_b64 exec, -1
    s_waitcnt lgkmcnt(0)
L_b2_0:
    s_barrier
    s_cmp_lt_u32 s30, 2
    s_cbranch_scc0 L_skip_98
L_pad1:
    s_cbranch_execz L_pad2
    s_mov_b32 exec_lo, 0xffffffff
    s_mov_b32 exec_hi, 0xffff
    ds_read_b64 v[40:41], v20 offset:0
    ds_read_b64 v[42:43], v20 offset:2048
    ds_read_b64 v[44:45], v20 offset:4096
    ds_read_b64 v[46:47], v20 offset:6144
    ds_read_b64 v[48:49], v20 offset:8192
    ds_read_b64 v[50:51], v20 offset:10240
    ds_read_b64 v[52:53], v20 offset:12288
    ds_read_b64 v[54:55], v20 offset:14336
    s_waitcnt lgkmcnt(7)
    v_mul_f32 v56, s64, v40
    v_mul_f32 v57, s64, v41
    s_waitcnt lgkmcnt(6)
    v_fmac_f32 v56, s65, v42
    v_fmac_f32 v57, s65, v43
    s_waitcnt lgkmcnt(5)
    v_fmac_f32 v56, s66, v44
    v_fmac_f32 v57, s66, v45
    s_waitcnt lgkmcnt(4)
    v_fmac_f32 v56, s67, v46
    v_fmac_f32 v57, s67, v47
    s_waitcnt lgkmcnt(3)
    v_fmac_f32 v56, s68, v48
    v_fmac_f32 v57, s68, v49
    s_waitcnt lgkmcnt(2)
    v_fmac_f32 v56, s69, v50
    v_fmac_f32 v57, s69, v51
    s_waitcnt lgkmcnt(1)
    v_fmac_f32 v56, s70, v52
    v_fmac_f32 v57, s70, v53
    s_waitcnt lgkmcnt(0)
    v_fmac_f32 v56, s71, v54
    v_fmac_f32 v57, s71, v55
    v_cvt_pk_bf16_f32 v56, v56, v57
    v_min_u32 v56, -2, v56
    s_cmp_eq_u32 s55, 0
    s_cbranch_scc1 L_gs_99
    buffer_store_dword v56, v21, s[40:43], 0 offen
L_gb_100:
    s_mov_b64 exec, -1
L_skip_98:
    s_cmp_eq_u32 s30, 6
    s_cbranch_scc0 L_skip_101
    s_waitcnt vmcnt(0)
L_skip_101:
    s_barrier
    s_cmp_lt_u32 s3, 20
    s_cbranch_scc0 L_typeB_0
    s_lshr_b32 s57, s30, 1
    s_lshl_b32 s57, s57, 5
    s_add_u32 s57, s57, s62
    s_add_u32 s59, s57, 55808
    v_and_b32 v5, 7, v0
    v_lshlrev_b32 v5, 2, v5
    v_lshrrev_b32 v22, 4, v0
    v_lshlrev_b32 v22, 3, v22
    buffer_load_dword v18, v5, s[40:43], s59 offen sc1
    buffer_load_dwordx2 v[20:21], v22, s[40:43], s59 offen sc1
    s_mul_i32 s57, s30, 6144
    v_lshrrev_b32 v7, 2, v0
    v_lshlrev_b32 v7, 6, v7
    v_bfe_u32 v60, v0, 4, 1
    v_lshl_add_u32 v7, v60, 5, v7
    v_and_b32 v60, 3, v0
    v_lshl_add_u32 v7, v60, 3, v7
    v_add_u32 v7, s57, v7
    v_add_u32 v7, 30720, v7
    v_xor_b32 v8, 32, v7
    s_mul_i32 s60, s30, 1536
    s_add_u32 s60, s60, s62
    s_add_u32 s60, s60, 0
    v_lshlrev_b32 v9, 4, v0
    v_lshlrev_b32 v10, 3, v0
    ds_read_b64_tr_b16 v[36:37], v7 offset:0
    ds_read_b64_tr_b16 v[38:39], v7 offset:1024
    ds_read_b64_tr_b16 v[40:41], v7 offset:2048
    ds_read_b64_tr_b16 v[42:43], v7 offset:3072
    ds_read_b64_tr_b16 v[44:45], v7 offset:4096
    ds_read_b64_tr_b16 v[46:47], v7 offset:5120
    ds_read_b64_tr_b16 v[48:49], v8 offset:0
    ds_read_b64_tr_b16 v[50:51], v8 offset:1024
    ds_read_b64_tr_b16 v[52:53], v8 offset:2048
    ds_read_b64_tr_b16 v[54:55], v8 offset:3072
    ds_read_b64_tr_b16 v[56:57], v8 offset:4096
    ds_read_b64_tr_b16 v[58:59], v8 offset:5120
    v_mov_b64 v[24:25], 0
    v_mov_b64 v[26:27], 0
    v_mov_b64 v[28:29], 0
    v_mov_b64 v[30:31], 0
    s_lshl_b32 s57, s30, 8
    v_lshlrev_b32 v11, 2, v0
    v_add_u32 v11, s57, v11
    v_add_u32 v11, 157696, v11
    s_waitcnt vmcnt(0)
L_pw_102:
    v_max3_u32 v19, v18, v20, v21
L_pad2:
    s_cbranch_execz L_pad3
    v_cmp_eq_u32 vcc, -1, v19
    s_cbranch_vccnz L_pr_103
    buffer_load_dwordx4 v[12:15], v9, s[40:43], s60 offen sc1
    buffer_load_dwordx2 v[16:17], v10, s[40:43], s60 offen offset:1024 sc1
    v_max_f32_dpp v19, v18, v18 row_ror:4 row_mask:0xf bank_mask:0xf
    s_nop 1
    v_max_f32_dpp v19, v19, v19 row_ror:2 row_mask:0xf bank_mask:0xf
    s_nop 1
    v_max_f32_dpp v19, v19, v19 row_ror:1 row_mask:0xf bank_mask:0xf
    v_sub_f32 v18, v18, v19
    v_sub_f32 v20, v20, v19
    v_sub_f32 v21, v21, v19
    v_exp_f32 v18, v18
    v_exp_f32 v20, v20
    v_exp_f32 v21, v21
    v_add_f32_dpp v18, v18, v18 row_ror:4 row_mask:0xf bank_mask:0xf
    s_nop 1
    v_add_f32_dpp v18, v18, v18 row_ror:2 row_mask:0xf bank_mask:0xf
    s_nop 1
    v_add_f32_dpp v18, v18, v18 row_ror:1 row_mask:0xf bank_mask:0xf
    v_rcp_f32 v18, v18
    s_nop 0
    v_mul_f32 v20, v20, v18
    v_mul_f32 v21, v21, v18
    s_waitcnt lgkmcnt(0)
    s_waitcnt vmcnt(0)
L_pw_104:
    v_max3_u32 v19, v12, v13, v14
    v_max3_u32 v19, v19, v15, v16
    v_max_u32 v19, v19, v17
    v_cmp_eq_u32 vcc, -1, v19
    s_cbranch_vccnz L_pr_105
    v_smfmac_f32_16x16x64_bf16 v[24:27], v[12:15], v[36:43], v1
    v_smfmac_f32_16x16x64_bf16 v[28:31], v[12:15], v[48:55], v1
    v_smfmac_f32_16x16x32_bf16 v[24:27], v[16:17], v[44:47], v1
    v_smfmac_f32_16x16x32_bf16 v[28:31], v[16:17], v[56:59], v1
    s_nop 6
    v_pk_add_f32 v[24:25], v[24:25], v[26:27]
    v_pk_add_f32 v[28:29], v[28:29], v[30:31]
    v_mul_f32 v24, v24, v20
    v_mul_f32 v28, v28, v20
    v_fmac_f32 v24, v25, v21
    v_fmac_f32 v28, v29, v21
    s_nop 1
    v_permlane32_swap_b32 v24, v28
    v_add_f32 v24, v24, v28
    ds_write_b32 v11, v24
    v_lshlrev_b32 v5, 2, v0
    v_add_u32 v5, 157696, v5
    s_mul_i32 s59, s31, 2560
    s_lshl_b32 s58, s3, 7
    s_add_u32 s59, s59, s58
    s_add_u32 s59, s59, 1343424
    v_lshlrev_b32 v9, 2, v0
    s_waitcnt lgkmcnt(0)
    s_barrier
    s_cmp_eq_u32 s30, 2
    s_cbranch_scc0 L_skip_106
    ds_read2st64_b32 v[12:13], v5 offset0:0 offset1:1
    ds_read2st64_b32 v[14:15], v5 offset0:2 offset1:3
    ds_read2st64_b32 v[16:17], v5 offset0:4 offset1:5
    ds_read2st64_b32 v[18:19], v5 offset0:6 offset1:7
    s_waitcnt lgkmcnt(2)
    v_pk_add_f32 v[12:13], v[12:13], v[14:15]
    s_waitcnt lgkmcnt(0)
    v_pk_add_f32 v[16:17], v[16:17], v[18:19]
    v_pk_add_f32 v[12:13], v[12:13], v[16:17]
    v_add_f32 v12, v12, v13
    v_mov_b32 v13, v12
    s_nop 1
    v_permlane16_swap_b32 v12, v13
    v_add_f32 v12, v12, v13
    v_min_u32 v12, -2, v12
    s_mov_b32 exec_lo, 0xffff0000
    s_mov_b32 exec_hi, 0xffff
    buffer_store_dword v12, v9, s[40:43], s59 offen sc1
    s_lshl_b32 s57, s3, 2
    s_add_u32 s57, s57, s62
    s_add_u32 s57, s57, 56064
    s_mov_b64 exec, 0x1
    s_cmp_eq_u32 s55, 0
    s_cbranch_scc1 L_gs_107
    buffer_store_dword v0, v0, s[40:43], s57 offen
L_gb_108:
    s_mov_b64 exec, -1
L_skip_106:
    s_sub_u32 s57, s30, 5
    s_cmp_lt_u32 s57, 2
    s_cbranch_scc0 L_skip_109
    s_sub_u32 s60, s30, 5
    s_mul_i32 s59, s60, 6144
    s_add_u32 s59, s59, 79872
    s_mov_b32 s44, s20
    s_mov_b32 s45, s21
    s_mov_b32 s46, 1966080
L_pad3:
    s_cbranch_execz L_pad4
    s_mov_b32 s47, 0x20000
    s_mul_i32 s57, s31, 245760
    s_lshl_b32 s58, s3, 6
    s_add_u32 s57, s57, s58
    s_lshl_b32 s58, s60, 5
    s_add_u32 s57, s57, s58
    v_lshrrev_b32 v5, 1, v0
    v_mul_u32_u24 v5, 1280, v5
    v_and_b32 v60, 1, v0
    v_lshl_add_u32 v5, v60, 4, v5
    v_add_u32 v5, s57, v5
    s_add_u32 m0, s59, 0
    s_mov_b32 s57, 0
    buffer_load_dwordx4 v5, s[44:47], s57 offen nt lds
    s_add_u32 m0, s59, 1024
    s_mov_b32 s57, 40960
    buffer_load_dwordx4 v5, s[44:47], s57 offen nt lds
    s_add_u32 m0, s59, 2048
    s_mov_b32 s57, 81920
    buffer_load_dwordx4 v5, s[44:47], s57 offen nt lds
    s_add_u32 m0, s59, 3072
    s_mov_b32 s57, 122880
    buffer_load_dwordx4 v5, s[44:47], s57 offen nt lds
    s_add_u32 m0, s59, 4096
    s_mov_b32 s57, 163840
    buffer_load_dwordx4 v5, s[44:47], s57 offen nt lds
    s_add_u32 m0, s59, 5120
    s_mov_b32 s57, 204800
    buffer_load_dwordx4 v5, s[44:47], s57 offen nt lds
    s_mul_i32 s57, s31, 384
    v_lshlrev_b32 v5, 1, v0
    v_add_u32 v5, s57, v5
    global_load_ushort v8, v5, s[18:19] offset:0
    global_load_ushort v9, v5, s[18:19] offset:128
    global_load_ushort v10, v5, s[18:19] offset:256
    v_lshlrev_b32 v11, 4, v0
    v_lshrrev_b32 v7, 4, v0
    v_lshlrev_b32 v7, 8, v7
    v_bfe_u32 v60, v0, 2, 2
    v_lshl_add_u32 v7, v60, 5, v7
    v_and_b32 v60, 3, v0
    v_lshl_add_u32 v7, v60, 3, v7
    v_add_u32 v7, s59, v7
    s_mul_i32 s57, s31, 2560
    s_lshl_b32 s58, s3, 7
    s_add_u32 s57, s57, s58
    s_lshl_b32 s60, s60, 6
    s_add_u32 s60, s60, s57
    s_add_u32 s60, s60, 1363968
    s_add_u32 s58, s62, 49152
    s_add_u32 s59, s58, 3072
    buffer_load_dwordx4 v[12:15], v11, s[40:43], s58 offen offset:0 sc1
    buffer_load_dwordx4 v[16:19], v11, s[40:43], s58 offen offset:1024 sc1
    buffer_load_dwordx4 v[20:23], v11, s[40:43], s58 offen offset:2048 sc1
    buffer_load_dwordx4 v[24:27], v11, s[40:43], s59 offen offset:0 sc1
    buffer_load_dwordx4 v[28:31], v11, s[40:43], s59 offen offset:1024 sc1
    buffer_load_dwordx4 v[32:35], v11, s[40:43], s59 offen offset:2048 sc1
    s_waitcnt vmcnt(0)
L_pw_110:
    v_max3_u32 v60, v12, v13, v14
    v_max3_u32 v60, v60, v15, v16
    v_max3_u32 v60, v60, v17, v18
    v_max3_u32 v60, v60, v19, v20
    v_max3_u32 v60, v60, v21, v22
    v_max3_u32 v60, v60, v23, v24
    v_max3_u32 v60, v60, v25, v26
    v_max3_u32 v60, v60, v27, v28
    v_max3_u32 v60, v60, v29, v30
    v_max3_u32 v60, v60, v31, v32
    v_max3_u32 v60, v60, v33, v34
    v_max_u32 v60, v60, v35
    v_cmp_eq_u32 vcc, -1, v60
    s_cbranch_vccnz L_pr_111
    ds_read_b64_tr_b16 v[36:37], v7 offset:0
    ds_read_b64_tr_b16 v[38:39], v7 offset:128
    ds_read_b64_tr_b16 v[40:41], v7 offset:1024
    ds_read_b64_tr_b16 v[42:43], v7 offset:1152
L_pad4:
    s_cbranch_execz L_pad5
    ds_read_b64_tr_b16 v[44:45], v7 offset:2048
    ds_read_b64_tr_b16 v[46:47], v7 offset:2176
    ds_read_b64_tr_b16 v[48:49], v7 offset:3072
    ds_read_b64_tr_b16 v[50:51], v7 offset:3200
    ds_read_b64_tr_b16 v[52:53], v7 offset:4096
    ds_read_b64_tr_b16 v[54:55], v7 offset:4224
    ds_read_b64_tr_b16 v[56:57], v7 offset:5120
    ds_read_b64_tr_b16 v[58:59], v7 offset:5248
    v_pk_add_f32 v[12:13], v[12:13], v[14:15]
    v_pk_add_f32 v[16:17], v[16:17], v[18:19]
    v_pk_add_f32 v[12:13], v[12:13], v[16:17]
    v_add_f32 v4, v12, v13
    v_pk_add_f32 v[20:21], v[20:21], v[22:23]
    v_pk_add_f32 v[24:25], v[24:25], v[26:27]
    v_pk_add_f32 v[20:21], v[20:21], v[24:25]
    v_add_f32 v5, v20, v21
    v_pk_add_f32 v[28:29], v[28:29], v[30:31]
    v_pk_add_f32 v[32:33], v[32:33], v[34:35]
    v_pk_add_f32 v[28:29], v[28:29], v[32:33]
    v_add_f32 v7, v28, v29
    v_lshlrev_b32 v8, 16, v8
    v_lshlrev_b32 v9, 16, v9
    v_lshlrev_b32 v10, 16, v10
    v_mov_b64 v[60:61], 0
    v_mov_b64 v[62:63], 0
    s_add_u32 s58, s62, 36864
    s_add_u32 s57, s62, 55552
    s_add_u32 s59, s58, 3072
    s_mov_b32 s64, 0xbdd2d3e8
    v_and_b32 v12, 7, v0
    v_lshlrev_b32 v12, 3, v12
    buffer_load_dwordx2 v[2:3], v12, s[40:43], s57 offen sc1
    s_waitcnt lgkmcnt(0)
    s_waitcnt vmcnt(0)
L_pw_112:
    v_max_u32 v13, v2, v3
    v_cmp_eq_u32 vcc, -1, v13
    s_cbranch_vccnz L_pr_113
    buffer_load_dwordx4 v[12:15], v11, s[40:43], s58 offen offset:0 sc1
    buffer_load_dwordx4 v[16:19], v11, s[40:43], s58 offen offset:1024 sc1
    buffer_load_dwordx4 v[20:23], v11, s[40:43], s58 offen offset:2048 sc1
    buffer_load_dwordx4 v[24:27], v11, s[40:43], s59 offen offset:0 sc1
    buffer_load_dwordx4 v[28:31], v11, s[40:43], s59 offen offset:1024 sc1
    buffer_load_dwordx4 v[32:35], v11, s[40:43], s59 offen offset:2048 sc1
    v_add_f32_dpp v2, v2, v2 row_ror:4 row_mask:0xf bank_mask:0xf
    v_add_f32_dpp v3, v3, v3 row_ror:4 row_mask:0xf bank_mask:0xf
    s_nop 0
    v_add_f32_dpp v2, v2, v2 row_ror:2 row_mask:0xf bank_mask:0xf
    v_add_f32_dpp v3, v3, v3 row_ror:2 row_mask:0xf bank_mask:0xf
    s_nop 0
    v_add_f32_dpp v2, v2, v2 row_ror:1 row_mask:0xf bank_mask:0xf
    v_add_f32_dpp v3, v3, v3 row_ror:1 row_mask:0xf bank_mask:0xf
    v_mul_f32 v2, 0x3acccccd, v2
    v_mul_f32 v3, 0x3acccccd, v3
    v_fma_f32 v3, -v2, v2, v3
    v_max_f32 v3, 0, v3
    v_add_f32 v3, 0x3727c5ac, v3
    v_rsq_f32 v3, v3
    s_nop 0
    v_mul_f32 v2, v2, v3
    v_fma_f32 v8, -v2, v4, v8
    v_fma_f32 v9, -v2, v5, v9
    v_fma_f32 v10, -v2, v7, v10
    v_lshlrev_b32 v7, 2, v0
    v_mov_b32 v2, 0xc0135761
    s_waitcnt vmcnt(4)
    v_pk_add_f32 v[12:13], v[12:13], v[14:15]
    v_pk_add_f32 v[16:17], v[16:17], v[18:19]
    v_pk_add_f32 v[12:13], v[12:13], v[16:17]
    v_add_f32 v12, v12, v13
    s_waitcnt vmcnt(2)
    v_pk_add_f32 v[20:21], v[20:21], v[22:23]
    v_pk_add_f32 v[24:25], v[24:25], v[26:27]
    v_pk_add_f32 v[20:21], v[20:21], v[24:25]
    v_add_f32 v13, v20, v21
    s_waitcnt vmcnt(0)
    v_pk_add_f32 v[28:29], v[28:29], v[30:31]
    v_pk_add_f32 v[32:33], v[32:33], v[34:35]
L_pad5:
    s_cbranch_execz L_pad6
    v_pk_add_f32 v[28:29], v[28:29], v[32:33]
    v_add_f32 v14, v28, v29
    v_add_f32 v15, v12, v13
    v_cmp_u_f32 vcc, v15, v14
    s_cbranch_vccnz L_hr_114
L_hk_115:
    v_fma_f32 v12, v12, v3, v8
    v_fma_f32 v13, v13, v3, v9
    v_fma_f32 v14, v14, v3, v10
    v_mul_f32 v16, v12, v12
    v_mul_f32 v17, v13, v13
    v_mul_f32 v18, v14, v14
    v_fma_f32 v16, v16, s64, v2
    v_fma_f32 v17, v17, s64, v2
    v_fma_f32 v18, v18, s64, v2
    v_mul_f32 v16, v16, v12
    v_mul_f32 v17, v17, v13
    v_mul_f32 v18, v18, v14
    v_exp_f32 v16, v16
    v_exp_f32 v17, v17
    v_exp_f32 v18, v18
    v_add_f32 v16, 1.0, v16
    v_add_f32 v17, 1.0, v17
    v_add_f32 v18, 1.0, v18
    v_rcp_f32 v16, v16
    v_rcp_f32 v17, v17
    v_rcp_f32 v18, v18
    v_mul_f32 v12, v12, v16
    v_mul_f32 v13, v13, v17
    v_mul_f32 v14, v14, v18
    v_mov_b32_dpp v16, v12 row_shl:1 row_mask:0xf bank_mask:0xf bound_ctrl:0
    v_mov_b32_dpp v17, v13 row_shl:1 row_mask:0xf bank_mask:0xf bound_ctrl:0
    v_mov_b32_dpp v18, v14 row_shl:1 row_mask:0xf bank_mask:0xf bound_ctrl:0
    v_cvt_pk_bf16_f32 v20, v12, v16
    v_cvt_pk_bf16_f32 v24, v13, v17
    v_cvt_pk_bf16_f32 v28, v14, v18
    v_mov_b32_dpp v21, v20 row_shl:4 row_mask:0xf bank_mask:0xf bound_ctrl:0
    v_mov_b32_dpp v22, v20 row_shl:8 row_mask:0xf bank_mask:0xf bound_ctrl:0
    v_mov_b32_dpp v23, v20 row_shl:12 row_mask:0xf bank_mask:0xf bound_ctrl:0
    v_mov_b32_dpp v25, v24 row_shl:4 row_mask:0xf bank_mask:0xf bound_ctrl:0
    v_mov_b32_dpp v26, v24 row_shl:8 row_mask:0xf bank_mask:0xf bound_ctrl:0
    v_mov_b32_dpp v27, v24 row_shl:12 row_mask:0xf bank_mask:0xf bound_ctrl:0
    v_smfmac_f32_16x16x64_bf16 v[60:63], v[20:23], v[36:43], v1
    v_mov_b32_dpp v29, v28 row_shl:4 row_mask:0xf bank_mask:0xf bound_ctrl:0
    v_mov_b32_dpp v30, v28 row_shl:8 row_mask:0xf bank_mask:0xf bound_ctrl:0
    v_mov_b32_dpp v31, v28 row_shl:12 row_mask:0xf bank_mask:0xf bound_ctrl:0
    v_smfmac_f32_16x16x64_bf16 v[60:63], v[24:27], v[44:51], v1
    s_nop 0
    v_smfmac_f32_16x16x64_bf16 v[60:63], v[28:31], v[52:59], v1
    s_nop 7
    v_add_f32 v60, v60, v62
    v_min_u32 v60, -2, v60
    s_mov_b64 exec, 0xffff
    buffer_store_dword v60, v7, s[40:43], s60 offen sc1
    s_cmp_eq_u32 s30, 6
    s_cbranch_scc0 L_skip_118
    s_lshl_b32 s57, s3, 2
    s_add_u32 s57, s57, s62
    s_add_u32 s57, s57, 56192
    s_mov_b64 exec, 0x1
    s_cmp_eq_u32 s55, 0
    s_cbranch_scc1 L_gs_119
    buffer_store_dword v0, v0, s[40:43], s57 offen
L_gb_120:
    s_mov_b64 exec, -1
L_skip_118:
    s_mov_b64 exec, -1
L_skip_109:
    s_branch L_p1
L_typeB_0:
    s_cmp_eq_u32 s53, 3
    s_cbranch_scc0 L_p1
    s_cmp_lt_u32 s30, 6
    s_cbranch_scc0 L_skip_121
    s_lshr_b32 s57, s30, 1
    s_mul_i32 s57, s57, 128
    s_and_b32 s58, s30, 1
    s_lshl_b32 s58, s58, 6
    s_add_u32 s57, s57, s58
    v_lshrrev_b32 v18, 5, v0
    v_lshlrev_b32 v18, 13, v18
    v_bfe_u32 v60, v0, 3, 1
    v_lshl_add_u32 v18, v60, 12, v18
    v_bfe_u32 v60, v0, 4, 1
    v_lshl_add_u32 v18, v60, 11, v18
    v_bfe_u32 v60, v0, 2, 1
    v_mul_u32_u24 v60, 384, v60
    v_add_u32 v18, v60, v18
    v_and_b32 v60, 3, v0
    v_lshl_add_u32 v18, v60, 3, v18
    v_add_u32 v18, s57, v18
    v_add_u32 v18, 30720, v18
    v_bfe_u32 v19, v0, 4, 1
L_pad6:
    s_cbranch_execz L_pad7
    v_lshlrev_b32 v19, 12, v19
    v_bfe_u32 v60, v0, 3, 1
    v_lshl_add_u32 v19, v60, 11, v19
    v_bfe_u32 v60, v0, 2, 1
    v_mul_u32_u24 v60, 384, v60
    v_add_u32 v19, v60, v19
    v_and_b32 v60, 3, v0
    v_lshl_add_u32 v19, v60, 3, v19
    v_add_u32 v19, s57, v19
    v_add_u32 v19, 63488, v19
    ds_read_b64_tr_b16 v[36:37], v18 offset:0
    ds_read_b64_tr_b16 v[38:39], v18 offset:1024
    ds_read_b64_tr_b16 v[40:41], v18 offset:16384
    ds_read_b64_tr_b16 v[42:43], v18 offset:17408
    ds_read_b64_tr_b16 v[44:45], v19 offset:0
    ds_read_b64_tr_b16 v[46:47], v19 offset:1024
    ds_read_b64_tr_b16 v[48:49], v18 offset:32
    ds_read_b64_tr_b16 v[50:51], v18 offset:1056
    ds_read_b64_tr_b16 v[52:53], v18 offset:16416
    ds_read_b64_tr_b16 v[54:55], v18 offset:17440
    ds_read_b64_tr_b16 v[56:57], v19 offset:32
    ds_read_b64_tr_b16 v[58:59], v19 offset:1056
    v_lshrrev_b32 v32, 4, v0
    v_lshlrev_b32 v32, 5, v32
    v_bfe_u32 v60, v0, 1, 1
    v_lshl_add_u32 v32, v60, 4, v32
    v_and_b32 v60, 1, v0
    v_mul_u32_u24 v60, 192, v60
    v_add_u32 v32, v60, v32
    v_add_u32 v32, 159872, v32
    v_lshrrev_b32 v33, 4, v0
    v_lshlrev_b32 v33, 4, v33
    v_bfe_u32 v60, v0, 1, 1
    v_lshl_add_u32 v33, v60, 3, v33
    v_and_b32 v60, 1, v0
    v_mul_u32_u24 v60, 192, v60
    v_add_u32 v33, v60, v33
    v_add_u32 v33, 160000, v33
    v_mov_b64 v[24:25], 0
    v_mov_b64 v[26:27], 0
    v_mov_b64 v[28:29], 0
    v_mov_b64 v[30:31], 0
    s_lshr_b32 s57, s30, 1
    s_lshl_b32 s57, s57, 11
    s_and_b32 s58, s30, 1
    s_lshl_b32 s58, s58, 9
    s_add_u32 s57, s57, s58
    s_lshr_b32 s58, s54, 2
    s_lshl_b32 s58, s58, 10
    s_add_u32 s57, s57, s58
    s_and_b32 s58, s54, 3
    s_lshl_b32 s58, s58, 2
    s_add_u32 s57, s57, s58
    v_and_b32 v34, 31, v0
    v_lshlrev_b32 v34, 4, v34
    v_add_u32 v34, s57, v34
    s_add_u32 s59, s62, 36864
    s_add_u32 s60, s62, 55552
    ds_read_b128 v[12:15], v32
    ds_read_b64 v[16:17], v33
    s_waitcnt lgkmcnt(1)
    v_smfmac_f32_16x16x64_bf16 v[24:27], v[12:15], v[36:43], v1
    v_smfmac_f32_16x16x64_bf16 v[28:31], v[12:15], v[48:55], v1
    s_waitcnt lgkmcnt(0)
    v_smfmac_f32_16x16x32_bf16 v[24:27], v[16:17], v[44:47], v1
    v_smfmac_f32_16x16x32_bf16 v[28:31], v[16:17], v[56:59], v1
    s_add_u32 s60, s62, 49152
    s_nop 5
    v_add_f32 v12, v25, v27
    s_nop 1
    v_add_f32_dpp v12, v29, v31 quad_perm:[0,1,2,3] row_mask:0x2 bank_mask:0xf
    v_min_u32 v12, -2, v12
    s_mov_b32 exec_lo, 0xffffffff
    s_mov_b32 exec_hi, 0x0
    s_cmp_eq_u32 s55, 0
    s_cbranch_scc1 L_gs_122
    buffer_store_dword v12, v34, s[40:43], s60 offen
L_gb_123:
    s_mov_b64 exec, -1
    v_mov_b64 v[24:25], 0
    v_mov_b64 v[26:27], 0
    v_mov_b64 v[28:29], 0
    v_mov_b64 v[30:31], 0
L_skip_121:
    s_cmp_eq_u32 s30, 7
    s_cbranch_scc0 L_skip_124
    v_and_b32 v60, 31, v0
    v_min_u32 v60, 19, v60
    s_mul_i32 s57, s54, 320
    v_lshrrev_b32 v5, 5, v0
L_pad7:
    s_cbranch_execz L_pad8
    v_mul_u32_u24 v5, 2560, v5
    v_add_u32 v5, s57, v5
    v_lshl_add_u32 v5, v60, 4, v5
    v_and_b32 v60, 31, v0
    v_cmp_gt_u32 s[64:65], 20, v60
    v_min_u32 v60, 19, v60
    v_lshrrev_b32 v35, 5, v0
    v_lshlrev_b32 v35, 2, v35
    v_add_u32 v35, 159872, v35
    v_lshl_add_u32 v35, v60, 3, v35
    s_add_u32 s66, s62, 36864
    s_add_u32 s67, s62, 55552
    s_lshl_b32 s57, s54, 3
    v_lshrrev_b32 v34, 5, v0
    v_lshlrev_b32 v34, 2, v34
    v_add_u32 v34, s57, v34
    v_mov_b32 v61, 0x3f803f80
    s_add_u32 s57, s62, 56064
    v_min_u32 v9, 19, v0
    v_lshlrev_b32 v9, 2, v9
    buffer_load_dword v12, v9, s[40:43], s57 offen sc1
    s_waitcnt vmcnt(0)
L_pw_125:
    v_cmp_eq_u32 vcc, -1, v12
    s_cbranch_vccnz L_pr_126
    s_mov_b32 s57, 1343488
    buffer_load_dwordx4 v[12:15], v5, s[40:43], s57 offen sc1
    s_mov_b32 s58, 1348608
    buffer_load_dwordx4 v[16:19], v5, s[40:43], s58 offen sc1
    s_mov_b32 s59, 1353728
    buffer_load_dwordx4 v[20:23], v5, s[40:43], s59 offen sc1
    s_mov_b32 s60, 1358848
    buffer_load_dwordx4 v[24:27], v5, s[40:43], s60 offen sc1
L_gw_127:
    s_waitcnt vmcnt(2)
    v_pk_add_f32 v[28:29], v[12:13], v[16:17]
    v_pk_add_f32 v[30:31], v[14:15], v[18:19]
    s_waitcnt vmcnt(1)
    v_pk_add_f32 v[28:29], v[28:29], v[20:21]
    v_pk_add_f32 v[30:31], v[30:31], v[22:23]
    s_waitcnt vmcnt(0)
    v_pk_add_f32 v[28:29], v[28:29], v[24:25]
    v_pk_add_f32 v[30:31], v[30:31], v[26:27]
    s_nop 1
    v_permlane32_swap_b32 v28, v30
    v_permlane32_swap_b32 v29, v31
    v_pk_add_f32 v[28:29], v[28:29], v[30:31]
    v_pk_add_f32 v[28:29], v[28:29], v[2:3]
    v_cmp_u_f32 vcc, v28, v29
    s_cbranch_vccnz L_gr_128
L_gk_129:
    v_cvt_pk_bf16_f32 v28, v28, v29
    ds_write_b32 v35, v28
    s_waitcnt lgkmcnt(0)
L_skip_124:
    s_barrier
    s_cmp_lt_u32 s30, 6
    s_cbranch_scc0 L_skip_134
    ds_read_b128 v[12:15], v32
    ds_read_b64 v[16:17], v33
    s_waitcnt lgkmcnt(1)
    v_smfmac_f32_16x16x64_bf16 v[24:27], v[12:15], v[36:43], v1
    v_smfmac_f32_16x16x64_bf16 v[28:31], v[12:15], v[48:55], v1
    s_waitcnt lgkmcnt(0)
    v_smfmac_f32_16x16x32_bf16 v[24:27], v[16:17], v[44:47], v1
    v_smfmac_f32_16x16x32_bf16 v[28:31], v[16:17], v[56:59], v1
    s_nop 6
    v_add_f32 v12, v24, v26
    s_nop 1
    v_add_f32_dpp v12, v28, v30 quad_perm:[0,1,2,3] row_mask:0x2 bank_mask:0xf
    v_min_u32 v12, -2, v12
    s_mov_b32 exec_lo, 0xffffffff
    s_mov_b32 exec_hi, 0x0
    s_cmp_eq_u32 s55, 0
    s_cbranch_scc1 L_gs_135
    buffer_store_dword v12, v34, s[40:43], s59 offen
L_gb_136:
    s_mov_b64 exec, -1
L_skip_134:
    s_cmp_eq_u32 s30, 7
    s_cbranch_scc0 L_skip_137
    v_lshlrev_b32 v2, 16, v28
    v_and_b32 v3, 0xffff0000, v28
    v_cndmask_b32 v28, 0, v28, s[64:65]
    v_dot2_f32_bf16 v27, v28, v61, 0
    v_dot2_f32_bf16 v62, v28, v28, 0
    s_nop 2
    v_permlane32_swap_b32 v27, v62
    v_add_f32 v27, v27, v62
    v_mov_b32 v62, v27
    s_nop 1
    v_permlane16_swap_b32 v27, v62
    v_add_f32 v27, v27, v62
L_pad8:
    s_cbranch_execz L_pad9
    s_nop 1
    v_add_f32_dpp v27, v27, v27 row_ror:8 row_mask:0xf bank_mask:0xf
    s_nop 1
    v_add_f32_dpp v27, v27, v27 row_ror:4 row_mask:0xf bank_mask:0xf
    s_nop 1
    v_add_f32_dpp v27, v27, v27 row_ror:2 row_mask:0xf bank_mask:0xf
    s_nop 1
    v_add_f32_dpp v27, v27, v27 row_ror:1 row_mask:0xf bank_mask:0xf
    v_min_u32 v27, -2, v27
    s_mov_b32 exec_lo, 0x1
    s_mov_b32 exec_hi, 0x1
    s_cmp_eq_u32 s55, 0
    s_cbranch_scc1 L_gs_138
    buffer_store_dword v27, v34, s[40:43], s67 offen
L_gb_139:
    s_mov_b64 exec, -1
L_skip_137:
L_p1:
    s_cmp_lt_u32 s30, 6
    s_cbranch_scc0 L_skip_140
    s_lshr_b32 s57, s30, 1
    s_mul_i32 s57, s57, 1024
    s_and_b32 s58, s30, 1
    s_lshl_b32 s58, s58, 6
    s_add_u32 s57, s57, s58
    v_lshrrev_b32 v18, 5, v0
    v_mul_u32_u24 v18, 6144, v18
    v_bfe_u32 v60, v0, 3, 1
    v_mul_u32_u24 v60, 3072, v60
    v_add_u32 v18, v60, v18
    v_bfe_u32 v60, v0, 4, 1
    v_lshl_add_u32 v18, v60, 9, v18
    v_bfe_u32 v60, v0, 2, 1
    v_lshl_add_u32 v18, v60, 7, v18
    v_and_b32 v60, 3, v0
    v_lshl_add_u32 v18, v60, 3, v18
    v_add_u32 v18, s57, v18
    v_bfe_u32 v19, v0, 4, 1
    v_mul_u32_u24 v19, 3072, v19
    v_bfe_u32 v60, v0, 3, 1
    v_lshl_add_u32 v19, v60, 9, v19
    v_bfe_u32 v60, v0, 2, 1
    v_lshl_add_u32 v19, v60, 7, v19
    v_and_b32 v60, 3, v0
    v_lshl_add_u32 v19, v60, 3, v19
    v_add_u32 v19, s57, v19
    v_add_u32 v19, 24576, v19
    ds_read_b64_tr_b16 v[36:37], v18 offset:0
    ds_read_b64_tr_b16 v[38:39], v18 offset:256
    ds_read_b64_tr_b16 v[40:41], v18 offset:12288
    ds_read_b64_tr_b16 v[42:43], v18 offset:12544
    ds_read_b64_tr_b16 v[44:45], v19 offset:0
    ds_read_b64_tr_b16 v[46:47], v19 offset:256
    ds_read_b64_tr_b16 v[48:49], v18 offset:32
    ds_read_b64_tr_b16 v[50:51], v18 offset:288
    ds_read_b64_tr_b16 v[52:53], v18 offset:12320
    ds_read_b64_tr_b16 v[54:55], v18 offset:12576
    ds_read_b64_tr_b16 v[56:57], v19 offset:32
    ds_read_b64_tr_b16 v[58:59], v19 offset:288
    v_lshrrev_b32 v32, 4, v0
    v_lshlrev_b32 v32, 5, v32
    v_bfe_u32 v60, v0, 1, 1
    v_lshl_add_u32 v32, v60, 4, v32
    v_and_b32 v60, 1, v0
    v_mul_u32_u24 v60, 192, v60
    v_add_u32 v32, v60, v32
    v_add_u32 v32, 159872, v32
    v_lshrrev_b32 v33, 4, v0
    v_lshlrev_b32 v33, 4, v33
    v_bfe_u32 v60, v0, 1, 1
    v_lshl_add_u32 v33, v60, 3, v33
    v_and_b32 v60, 1, v0
    v_mul_u32_u24 v60, 192, v60
    v_add_u32 v33, v60, v33
    v_add_u32 v33, 160000, v33
    v_mov_b64 v[24:25], 0
    v_mov_b64 v[26:27], 0
    v_mov_b64 v[28:29], 0
    v_mov_b64 v[30:31], 0
    s_lshr_b32 s57, s54, 1
    s_lshl_b32 s57, s57, 2
    s_and_b32 s58, s54, 1
    s_add_u32 s57, s57, s58
    s_lshl_b32 s57, s57, 4
    s_lshl_b32 s58, s30, 9
    s_add_u32 s57, s57, s58
    v_bfe_u32 v34, v0, 4, 1
L_pad9:
    s_cbranch_execz L_pad10
    v_lshlrev_b32 v34, 8, v34
    v_bfe_u32 v60, v0, 1, 1
    v_lshl_add_u32 v34, v60, 5, v34
    v_bfe_u32 v60, v0, 2, 2
    v_lshl_add_u32 v34, v60, 2, v34
    v_lshrrev_b32 v60, 5, v0
    v_mul_u32_u24 v60, 3072, v60
    v_add_u32 v34, v60, v34
    v_add_u32 v34, s57, v34
    s_mul_i32 s59, s53, 3072
    s_add_u32 s59, s59, s62
    s_add_u32 s59, s59, 24576
    s_lshl_b32 s60, s53, 6
    s_add_u32 s60, s60, s62
    s_add_u32 s60, s60, 55296
L_skip_140:
    s_cmp_eq_u32 s30, 7
    s_cbranch_scc0 L_skip_141
    v_and_b32 v60, 31, v0
    v_min_u32 v60, 19, v60
    s_mul_i32 s57, s54, 320
    v_lshrrev_b32 v5, 5, v0
    v_mul_u32_u24 v5, 2560, v5
    v_add_u32 v5, s57, v5
    v_lshl_add_u32 v5, v60, 4, v5
    v_and_b32 v60, 31, v0
    v_cmp_gt_u32 s[64:65], 20, v60
    v_min_u32 v60, 19, v60
    v_lshrrev_b32 v35, 5, v0
    v_lshlrev_b32 v35, 2, v35
    v_add_u32 v35, 159872, v35
    v_lshl_add_u32 v35, v60, 3, v35
    s_mul_i32 s66, s53, 3072
    s_add_u32 s66, s66, s62
    s_add_u32 s66, s66, 24576
    s_lshl_b32 s67, s53, 6
    s_add_u32 s67, s67, s62
    s_add_u32 s67, s67, 55296
    s_lshl_b32 s57, s54, 3
    v_lshrrev_b32 v34, 5, v0
    v_lshlrev_b32 v34, 2, v34
    v_add_u32 v34, s57, v34
    v_mov_b32 v61, 0x3f803f80
    s_cmp_lg_u32 s53, 3
    s_cbranch_scc0 L_skip_142
    s_add_u32 s57, s62, 55552
    v_mov_b32 v9, 0
    buffer_load_dword v12, v9, s[40:43], s57 offen sc1
    s_waitcnt vmcnt(0)
L_pw_143:
    v_cmp_eq_u32 vcc, -1, v12
    s_cbranch_vccnz L_pr_144
    s_mov_b32 s57, 1343488
    buffer_load_dwordx4 v[12:15], v5, s[40:43], s57 offen sc1
    s_mov_b32 s58, 1348608
    buffer_load_dwordx4 v[16:19], v5, s[40:43], s58 offen sc1
    s_mov_b32 s59, 1353728
    buffer_load_dwordx4 v[20:23], v5, s[40:43], s59 offen sc1
    s_mov_b32 s60, 1358848
    buffer_load_dwordx4 v[24:27], v5, s[40:43], s60 offen sc1
L_gw_145:
    s_waitcnt vmcnt(2)
    v_pk_add_f32 v[28:29], v[12:13], v[16:17]
    v_pk_add_f32 v[30:31], v[14:15], v[18:19]
    s_waitcnt vmcnt(1)
    v_pk_add_f32 v[28:29], v[28:29], v[20:21]
    v_pk_add_f32 v[30:31], v[30:31], v[22:23]
    s_waitcnt vmcnt(0)
    v_pk_add_f32 v[28:29], v[28:29], v[24:25]
    v_pk_add_f32 v[30:31], v[30:31], v[26:27]
    s_nop 1
    v_permlane32_swap_b32 v28, v30
    v_permlane32_swap_b32 v29, v31
    v_pk_add_f32 v[28:29], v[28:29], v[30:31]
    v_pk_add_f32 v[28:29], v[28:29], v[2:3]
    v_cmp_u_f32 vcc, v28, v29
    s_cbranch_vccnz L_gr_146
L_gk_147:
    v_cvt_pk_bf16_f32 v28, v28, v29
    v_lshlrev_b32 v2, 16, v28
    v_and_b32 v3, 0xffff0000, v28
L_skip_142:
    v_lshlrev_b32 v60, 16, v4
    v_add_f32 v2, v2, v60
    v_and_b32 v60, 0xffff0000, v4
    v_add_f32 v3, v3, v60
    s_add_u32 s57, s62, 56192
    v_min_u32 v9, 19, v0
    v_lshlrev_b32 v9, 2, v9
    buffer_load_dword v12, v9, s[40:43], s57 offen sc1
    s_waitcnt vmcnt(0)
L_pw_152:
L_pad10:
    s_cbranch_execz L_pad11
    v_cmp_eq_u32 vcc, -1, v12
    s_cbranch_vccnz L_pr_153
    s_mov_b32 s57, 1363968
    buffer_load_dwordx4 v[12:15], v5, s[40:43], s57 offen sc1
    s_mov_b32 s58, 1369088
    buffer_load_dwordx4 v[16:19], v5, s[40:43], s58 offen sc1
    s_mov_b32 s59, 1374208
    buffer_load_dwordx4 v[20:23], v5, s[40:43], s59 offen sc1
    s_mov_b32 s60, 1379328
    buffer_load_dwordx4 v[24:27], v5, s[40:43], s60 offen sc1
L_gw_154:
    s_waitcnt vmcnt(2)
    v_pk_add_f32 v[28:29], v[12:13], v[16:17]
    v_pk_add_f32 v[30:31], v[14:15], v[18:19]
    s_waitcnt vmcnt(1)
    v_pk_add_f32 v[28:29], v[28:29], v[20:21]
    v_pk_add_f32 v[30:31], v[30:31], v[22:23]
    s_waitcnt vmcnt(0)
    v_pk_add_f32 v[28:29], v[28:29], v[24:25]
    v_pk_add_f32 v[30:31], v[30:31], v[26:27]
    s_nop 1
    v_permlane32_swap_b32 v28, v30
    v_permlane32_swap_b32 v29, v31
    v_pk_add_f32 v[28:29], v[28:29], v[30:31]
    v_pk_add_f32 v[28:29], v[28:29], v[2:3]
    v_cmp_u_f32 vcc, v28, v29
    s_cbranch_vccnz L_gr_155
L_gk_156:
    v_cvt_pk_bf16_f32 v28, v28, v29
    ds_write_b32 v35, v28
    s_waitcnt lgkmcnt(0)
L_skip_141:
    s_barrier
    s_cmp_lt_u32 s30, 6
    s_cbranch_scc0 L_skip_161
    ds_read_b128 v[12:15], v32
    ds_read_b64 v[16:17], v33
    s_waitcnt lgkmcnt(1)
    v_smfmac_f32_16x16x64_bf16 v[24:27], v[12:15], v[36:43], v1
    v_smfmac_f32_16x16x64_bf16 v[28:31], v[12:15], v[48:55], v1
    s_waitcnt lgkmcnt(0)
    v_smfmac_f32_16x16x32_bf16 v[24:27], v[16:17], v[44:47], v1
    v_smfmac_f32_16x16x32_bf16 v[28:31], v[16:17], v[56:59], v1
    s_nop 6
    v_add_f32 v12, v24, v26
    s_nop 1
    v_add_f32_dpp v12, v28, v30 quad_perm:[0,1,2,3] row_mask:0x2 bank_mask:0xf
    s_nop 1
    v_mov_b32_dpp v13, v12 row_shl:1 row_mask:0xf bank_mask:0xf bound_ctrl:0
    v_cvt_pk_bf16_f32 v12, v12, v13
    v_min_u32 v12, -2, v12
    s_mov_b64 exec, 0x55555555
    s_cmp_eq_u32 s55, 0
    s_cbranch_scc1 L_gs_162
    buffer_store_dword v12, v34, s[40:43], s59 offen
L_gb_163:
    s_mov_b64 exec, -1
L_skip_161:
    s_cmp_eq_u32 s30, 7
    s_cbranch_scc0 L_skip_164
    v_lshlrev_b32 v2, 16, v28
    v_and_b32 v3, 0xffff0000, v28
    v_cndmask_b32 v28, 0, v28, s[64:65]
    v_dot2_f32_bf16 v27, v28, v61, 0
    v_dot2_f32_bf16 v62, v28, v28, 0
    s_nop 2
    v_permlane32_swap_b32 v27, v62
    v_add_f32 v27, v27, v62
    v_mov_b32 v62, v27
    s_nop 1
    v_permlane16_swap_b32 v27, v62
    v_add_f32 v27, v27, v62
    s_nop 1
    v_add_f32_dpp v27, v27, v27 row_ror:8 row_mask:0xf bank_mask:0xf
    s_nop 1
    v_add_f32_dpp v27, v27, v27 row_ror:4 row_mask:0xf bank_mask:0xf
    s_nop 1
    v_add_f32_dpp v27, v27, v27 row_ror:2 row_mask:0xf bank_mask:0xf
    s_nop 1
    v_add_f32_dpp v27, v27, v27 row_ror:1 row_mask:0xf bank_mask:0xf
    v_min_u32 v27, -2, v27
    s_mov_b32 exec_lo, 0x1
    s_mov_b32 exec_hi, 0x1
    s_cmp_eq_u32 s55, 0
    s_cbranch_scc1 L_gs_165
    buffer_store_dword v27, v34, s[40:43], s67 offen
L_gb_166:
    s_mov_b64 exec, -1
L_skip_164:
    s_mul_i32 s59, s53, 3072
    s_add_u32 s59, s59, s62
    s_add_u32 s59, s59, 24576
    s_lshl_b32 s60, s53, 6
    s_add_u32 s60, s60, s62
L_pad11:
    s_cbranch_execz L_pad12
    s_add_u32 s60, s60, 55296
    v_lshlrev_b32 v5, 4, v0
    v_add_u32 v5, s59, v5
    v_and_b32 v7, 7, v0
    v_lshlrev_b32 v7, 3, v7
    v_add_u32 v7, s60, v7
    buffer_load_dwordx2 v[8:9], v7, s[40:43], 0 offen sc1
    buffer_load_dwordx4 v[12:15], v5, s[40:43], 0 offen offset:0 sc1
    buffer_load_dwordx4 v[16:19], v5, s[40:43], 0 offen offset:1024 sc1
    buffer_load_dwordx4 v[20:23], v5, s[40:43], 0 offen offset:2048 sc1
    v_mov_b64 v[24:25], 0
    v_mov_b64 v[26:27], 0
    v_mov_b64 v[28:29], 0
    v_mov_b64 v[30:31], 0
    v_mov_b64 v[32:33], 0
    v_mov_b64 v[34:35], 0
    v_mov_b64 v[36:37], 0
    v_mov_b64 v[38:39], 0
    v_mov_b64 v[40:41], 0
    v_mov_b64 v[42:43], 0
    v_mov_b64 v[44:45], 0
    v_mov_b64 v[46:47], 0
    v_mov_b64 v[48:49], 0
    v_mov_b64 v[50:51], 0
    v_mov_b64 v[52:53], 0
    v_mov_b64 v[54:55], 0
    v_mov_b64 v[56:57], 0
    v_mov_b64 v[58:59], 0
    v_mov_b64 v[60:61], 0
    v_mov_b64 v[62:63], 0
    s_lshl_b32 s58, s30, 3
    s_add_u32 s58, s58, 159744
    v_mov_b32 v10, s58
    s_waitcnt vmcnt(0)
L_pw_167:
    v_max3_u32 v11, v8, v9, v12
    v_max3_u32 v11, v11, v13, v14
    v_max3_u32 v11, v11, v15, v16
    v_max3_u32 v11, v11, v17, v18
    v_max3_u32 v11, v11, v19, v20
    v_max3_u32 v11, v11, v21, v22
    v_max_u32 v11, v11, v23
    v_cmp_eq_u32 vcc, -1, v11
    s_cbranch_vccnz L_pr_168
    v_smfmac_f32_16x16x64_bf16 v[24:27], v[12:15], v[64:71], v1
    v_add_f32_dpp v8, v8, v8 row_ror:4 row_mask:0xf bank_mask:0xf
    v_add_f32_dpp v9, v9, v9 row_ror:4 row_mask:0xf bank_mask:0xf
    v_smfmac_f32_16x16x64_bf16 v[24:27], v[16:19], v[72:79], v1
    v_add_f32_dpp v8, v8, v8 row_ror:2 row_mask:0xf bank_mask:0xf
    v_add_f32_dpp v9, v9, v9 row_ror:2 row_mask:0xf bank_mask:0xf
    v_smfmac_f32_16x16x64_bf16 v[24:27], v[20:23], v[80:87], v1
    v_add_f32_dpp v8, v8, v8 row_ror:1 row_mask:0xf bank_mask:0xf
    v_add_f32_dpp v9, v9, v9 row_ror:1 row_mask:0xf bank_mask:0xf
    v_smfmac_f32_16x16x64_bf16 v[32:35], v[12:15], v[112:119], v1
    v_mul_f32 v8, 0x3acccccd, v8
    v_mul_f32 v9, 0x3acccccd, v9
    v_smfmac_f32_16x16x64_bf16 v[32:35], v[16:19], v[120:127], v1
    v_fma_f32 v9, -v8, v8, v9
    v_max_f32 v9, 0, v9
    v_smfmac_f32_16x16x64_bf16 v[32:35], v[20:23], v[128:135], v1
    v_add_f32 v9, 0x3727c5ac, v9
    v_rsq_f32 v9, v9
    v_smfmac_f32_16x16x64_bf16 v[28:31], v[12:15], v[88:95], v1
    s_mov_b32 vcc_lo, 0x55555555
    v_mul_f32 v9, 0x3dd53b95, v9
    v_smfmac_f32_16x16x64_bf16 v[28:31], v[16:19], v[96:103], v1
    s_mov_b32 vcc_hi, 0x55555555
    v_smfmac_f32_16x16x64_bf16 v[28:31], v[20:23], v[104:111], v1
    v_smfmac_f32_16x16x64_bf16 v[36:39], v[12:15], v[136:143], v1
    v_pk_add_f32 v[24:25], v[24:25], v[26:27]
    v_add_f32 v24, v24, v25
    v_smfmac_f32_16x16x64_bf16 v[36:39], v[16:19], v[144:151], v1
    v_pk_add_f32 v[32:33], v[32:33], v[34:35]
    v_add_f32 v32, v32, v33
    v_smfmac_f32_16x16x64_bf16 v[36:39], v[20:23], v[152:159], v1
    s_nop 0
    v_permlane32_swap_b32 v24, v32
    v_add_f32 v24, v24, v32
    v_pk_add_f32 v[28:29], v[28:29], v[30:31]
    v_add_f32 v28, v28, v29
    s_nop 2
    v_pk_add_f32 v[36:37], v[36:37], v[38:39]
    v_add_f32 v36, v36, v37
    s_nop 1
    v_permlane32_swap_b32 v28, v36
    v_add_f32 v28, v28, v36
    s_nop 1
L_pad12:
    s_cbranch_execz L_pad13
    v_permlane16_swap_b32 v24, v28
    v_add_f32 v24, v24, v28
    v_fma_f32 v24, -v8, v6, v24
    s_nop 1
    v_max_f32_dpp v21, v24, v24 row_ror:8 row_mask:0xf bank_mask:0xf
    s_nop 1
    v_max_f32_dpp v21, v21, v21 row_ror:4 row_mask:0xf bank_mask:0xf
    s_nop 1
    v_max_f32_dpp v21, v21, v21 row_ror:2 row_mask:0xf bank_mask:0xf
    s_nop 1
    v_max_f32_dpp v21, v21, v21 row_ror:1 row_mask:0xf bank_mask:0xf
    s_nop 1
    v_max_f32_dpp v21, v21, v21 row_bcast:15 row_mask:0xa bank_mask:0xf
    s_nop 1
    v_max_f32_dpp v21, v21, v21 row_bcast:31 row_mask:0xc bank_mask:0xf
    s_nop 0
    v_readlane_b32 s57, v21, 63
    s_nop 1
    v_subrev_f32 v24, s57, v24
    v_mul_f32 v24, v24, v9
    v_exp_f32 v22, v24
    v_mul_f32 v20, s57, v9
    s_nop 0
    v_mov_b32_dpp v23, v22 row_shl:1 row_mask:0xf bank_mask:0xf bound_ctrl:0
    v_cvt_pk_bf16_f32 v23, v22, v23
    v_cndmask_b32 v12, 0, v23, vcc
    v_mov_b32 v21, v22
    s_nop 0
    v_mov_b32_dpp v13, v12 row_shl:4 row_mask:0xf bank_mask:0xf bound_ctrl:0
    v_mov_b32_dpp v14, v12 row_shl:8 row_mask:0xf bank_mask:0xf bound_ctrl:0
    v_mov_b32_dpp v15, v12 row_shl:12 row_mask:0xf bank_mask:0xf bound_ctrl:0
    s_nop 1
    v_smfmac_f32_16x16x64_bf16 v[40:43], v[12:15], v[160:167], v1
    v_mov_b32_dpp v16, v12 row_shr:1 row_mask:0xf bank_mask:0xf bound_ctrl:0
    v_mov_b32_dpp v17, v12 row_shl:3 row_mask:0xf bank_mask:0xf bound_ctrl:0
    v_smfmac_f32_16x16x64_bf16 v[44:47], v[12:15], v[176:183], v1
    v_mov_b32_dpp v18, v12 row_shl:7 row_mask:0xf bank_mask:0xf bound_ctrl:0
    v_mov_b32_dpp v19, v12 row_shl:11 row_mask:0xf bank_mask:0xf bound_ctrl:0
    v_smfmac_f32_16x16x64_bf16 v[48:51], v[12:15], v[192:199], v1
    v_permlane32_swap_b32 v21, v22
    v_add_f32 v21, v21, v22
    v_smfmac_f32_16x16x64_bf16 v[52:55], v[12:15], v[208:215], v1
    v_mov_b32 v22, v21
    s_nop 1
    v_permlane16_swap_b32 v21, v22
    v_smfmac_f32_16x16x64_bf16 v[56:59], v[12:15], v[224:231], v1
    v_add_f32 v21, v21, v22
    s_nop 1
    v_add_f32_dpp v21, v21, v21 row_ror:8 row_mask:0xf bank_mask:0xf
    v_smfmac_f32_16x16x64_bf16 v[60:63], v[12:15], v[240:247], v1
    s_nop 0
    v_add_f32_dpp v21, v21, v21 row_ror:4 row_mask:0xf bank_mask:0xf
    s_nop 1
    v_add_f32_dpp v21, v21, v21 row_ror:2 row_mask:0xf bank_mask:0xf
    v_smfmac_f32_16x16x64_bf16 v[40:43], v[16:19], v[168:175], v1
    s_nop 0
    v_add_f32_dpp v21, v21, v21 row_ror:1 row_mask:0xf bank_mask:0xf
    ds_write_b64 v10, v[20:21]
    v_smfmac_f32_16x16x64_bf16 v[44:47], v[16:19], v[184:191], v1
    v_and_b32 v36, 15, v0
    v_lshlrev_b32 v36, 4, v36
    v_add_u32 v36, s61, v36
    v_add_u32 v36, 32768, v36
    v_smfmac_f32_16x16x64_bf16 v[48:51], v[16:19], v[200:207], v1
    v_smfmac_f32_16x16x64_bf16 v[52:55], v[16:19], v[216:223], v1
    s_cmp_ge_u32 s30, 4
    s_cbranch_scc0 L_skip_169
    s_waitcnt lgkmcnt(0)
    s_barrier
L_skip_169:
    v_smfmac_f32_16x16x64_bf16 v[56:59], v[16:19], v[232:239], v1
    v_smfmac_f32_16x16x64_bf16 v[60:63], v[16:19], v[248:255], v1
    v_pk_add_f32 v[24:25], v[40:41], v[42:43]
    v_pk_add_f32 v[26:27], v[44:45], v[46:47]
    s_nop 0
    v_pk_add_f32 v[28:29], v[48:49], v[50:51]
    v_pk_add_f32 v[30:31], v[52:53], v[54:55]
    s_nop 1
    v_pk_add_f32 v[32:33], v[56:57], v[58:59]
    v_pk_add_f32 v[34:35], v[60:61], v[62:63]
    s_mov_b64 exec, 0xffff
    ds_write_b128 v36, v[24:27] offset:0
    ds_write_b128 v36, v[28:31] offset:256
    ds_write_b128 v36, v[32:35] offset:512
L_pad13:
    s_cbranch_execz L_pad14
    s_mov_b64 exec, -1
    s_cmp_lt_u32 s30, 4
    s_cbranch_scc1 L_old
    s_waitcnt lgkmcnt(0)
L_b2_1:
    s_barrier
    s_cmp_lt_u32 s30, 2
    s_cbranch_scc0 L_skip_173
    s_mov_b32 exec_lo, 0xffffffff
    s_mov_b32 exec_hi, 0xffff
    ds_read_b64 v[40:41], v20 offset:0
    ds_read_b64 v[42:43], v20 offset:2048
    ds_read_b64 v[44:45], v20 offset:4096
    ds_read_b64 v[46:47], v20 offset:6144
    ds_read_b64 v[48:49], v20 offset:8192
    ds_read_b64 v[50:51], v20 offset:10240
    ds_read_b64 v[52:53], v20 offset:12288
    ds_read_b64 v[54:55], v20 offset:14336
    s_waitcnt lgkmcnt(7)
    v_mul_f32 v56, s64, v40
    v_mul_f32 v57, s64, v41
    s_waitcnt lgkmcnt(6)
    v_fmac_f32 v56, s65, v42
    v_fmac_f32 v57, s65, v43
    s_waitcnt lgkmcnt(5)
    v_fmac_f32 v56, s66, v44
    v_fmac_f32 v57, s66, v45
    s_waitcnt lgkmcnt(4)
    v_fmac_f32 v56, s67, v46
    v_fmac_f32 v57, s67, v47
    s_waitcnt lgkmcnt(3)
    v_fmac_f32 v56, s68, v48
    v_fmac_f32 v57, s68, v49
    s_waitcnt lgkmcnt(2)
    v_fmac_f32 v56, s69, v50
    v_fmac_f32 v57, s69, v51
    s_waitcnt lgkmcnt(1)
    v_fmac_f32 v56, s70, v52
    v_fmac_f32 v57, s70, v53
    s_waitcnt lgkmcnt(0)
    v_fmac_f32 v56, s71, v54
    v_fmac_f32 v57, s71, v55
    v_cvt_pk_bf16_f32 v56, v56, v57
    v_min_u32 v56, -2, v56
    s_cmp_eq_u32 s55, 0
    s_cbranch_scc1 L_gs_174
    buffer_store_dword v56, v21, s[40:43], 0 offen
L_gb_175:
    s_mov_b64 exec, -1
L_skip_173:
    s_cmp_lt_u32 s3, 20
    s_cbranch_scc0 L_typeB_1
    s_lshr_b32 s57, s30, 1
    s_lshl_b32 s57, s57, 5
    s_add_u32 s57, s57, s62
    s_add_u32 s59, s57, 55936
    v_and_b32 v5, 7, v0
    v_lshlrev_b32 v5, 2, v5
    v_lshrrev_b32 v22, 4, v0
    v_lshlrev_b32 v22, 3, v22
    buffer_load_dword v18, v5, s[40:43], s59 offen sc1
    buffer_load_dwordx2 v[20:21], v22, s[40:43], s59 offen sc1
    s_mul_i32 s57, s30, 6144
    v_lshrrev_b32 v7, 2, v0
    v_lshlrev_b32 v7, 6, v7
    v_bfe_u32 v60, v0, 4, 1
    v_lshl_add_u32 v7, v60, 5, v7
    v_and_b32 v60, 3, v0
    v_lshl_add_u32 v7, v60, 3, v7
    v_add_u32 v7, s57, v7
    v_add_u32 v7, 30720, v7
    v_xor_b32 v8, 32, v7
    s_mul_i32 s60, s30, 1536
    s_add_u32 s60, s60, s62
    s_add_u32 s60, s60, 12288
    v_lshlrev_b32 v9, 4, v0
    v_lshlrev_b32 v10, 3, v0
    ds_read_b64_tr_b16 v[36:37], v7 offset:0
    ds_read_b64_tr_b16 v[38:39], v7 offset:1024
    ds_read_b64_tr_b16 v[40:41], v7 offset:2048
    ds_read_b64_tr_b16 v[42:43], v7 offset:3072
    ds_read_b64_tr_b16 v[44:45], v7 offset:4096
    ds_read_b64_tr_b16 v[46:47], v7 offset:5120
    ds_read_b64_tr_b16 v[48:49], v8 offset:0
    ds_read_b64_tr_b16 v[50:51], v8 offset:1024
    ds_read_b64_tr_b16 v[52:53], v8 offset:2048
    ds_read_b64_tr_b16 v[54:55], v8 offset:3072
    ds_read_b64_tr_b16 v[56:57], v8 offset:4096
    ds_read_b64_tr_b16 v[58:59], v8 offset:5120
    v_mov_b64 v[24:25], 0
    v_mov_b64 v[26:27], 0
    v_mov_b64 v[28:29], 0
    v_mov_b64 v[30:31], 0
    s_lshl_b32 s57, s30, 8
    v_lshlrev_b32 v11, 2, v0
    v_add_u32 v11, s57, v11
L_pad14:
    s_cbranch_execz L_pad15
    v_add_u32 v11, 157696, v11
    s_waitcnt vmcnt(0)
L_pw_176:
    v_max3_u32 v19, v18, v20, v21
    v_cmp_eq_u32 vcc, -1, v19
    s_cbranch_vccnz L_pr_177
    buffer_load_dwordx4 v[12:15], v9, s[40:43], s60 offen sc1
    buffer_load_dwordx2 v[16:17], v10, s[40:43], s60 offen offset:1024 sc1
    v_max_f32_dpp v19, v18, v18 row_ror:4 row_mask:0xf bank_mask:0xf
    s_nop 1
    v_max_f32_dpp v19, v19, v19 row_ror:2 row_mask:0xf bank_mask:0xf
    s_nop 1
    v_max_f32_dpp v19, v19, v19 row_ror:1 row_mask:0xf bank_mask:0xf
    v_sub_f32 v18, v18, v19
    v_sub_f32 v20, v20, v19
    v_sub_f32 v21, v21, v19
    v_exp_f32 v18, v18
    v_exp_f32 v20, v20
    v_exp_f32 v21, v21
    v_add_f32_dpp v18, v18, v18 row_ror:4 row_mask:0xf bank_mask:0xf
    s_nop 1
    v_add_f32_dpp v18, v18, v18 row_ror:2 row_mask:0xf bank_mask:0xf
    s_nop 1
    v_add_f32_dpp v18, v18, v18 row_ror:1 row_mask:0xf bank_mask:0xf
    v_rcp_f32 v18, v18
    s_nop 0
    v_mul_f32 v20, v20, v18
    v_mul_f32 v21, v21, v18
    s_waitcnt lgkmcnt(0)
    s_waitcnt vmcnt(0)
L_pw_178:
    v_max3_u32 v19, v12, v13, v14
    v_max3_u32 v19, v19, v15, v16
    v_max_u32 v19, v19, v17
    v_cmp_eq_u32 vcc, -1, v19
    s_cbranch_vccnz L_pr_179
    v_smfmac_f32_16x16x64_bf16 v[24:27], v[12:15], v[36:43], v1
    v_smfmac_f32_16x16x64_bf16 v[28:31], v[12:15], v[48:55], v1
    v_smfmac_f32_16x16x32_bf16 v[24:27], v[16:17], v[44:47], v1
    v_smfmac_f32_16x16x32_bf16 v[28:31], v[16:17], v[56:59], v1
    s_nop 6
    v_pk_add_f32 v[24:25], v[24:25], v[26:27]
    v_pk_add_f32 v[28:29], v[28:29], v[30:31]
    v_mul_f32 v24, v24, v20
    v_mul_f32 v28, v28, v20
    v_fmac_f32 v24, v25, v21
    v_fmac_f32 v28, v29, v21
    s_nop 1
    v_permlane32_swap_b32 v24, v28
    v_add_f32 v24, v24, v28
    ds_write_b32 v11, v24
    v_lshlrev_b32 v5, 2, v0
    v_add_u32 v5, 157696, v5
    s_mul_i32 s59, s31, 2560
    s_lshl_b32 s58, s3, 7
    s_add_u32 s59, s59, s58
    s_add_u32 s59, s59, 1384384
    v_lshlrev_b32 v9, 2, v0
    s_waitcnt lgkmcnt(0)
    s_barrier
    s_cmp_eq_u32 s30, 2
    s_cbranch_scc0 L_skip_180
    ds_read2st64_b32 v[12:13], v5 offset0:0 offset1:1
    ds_read2st64_b32 v[14:15], v5 offset0:2 offset1:3
    ds_read2st64_b32 v[16:17], v5 offset0:4 offset1:5
    ds_read2st64_b32 v[18:19], v5 offset0:6 offset1:7
    s_waitcnt lgkmcnt(2)
    v_pk_add_f32 v[12:13], v[12:13], v[14:15]
    s_waitcnt lgkmcnt(0)
    v_pk_add_f32 v[16:17], v[16:17], v[18:19]
    v_pk_add_f32 v[12:13], v[12:13], v[16:17]
    v_add_f32 v12, v12, v13
    v_mov_b32 v13, v12
    s_nop 1
    v_permlane16_swap_b32 v12, v13
    v_add_f32 v12, v12, v13
    v_min_u32 v12, -2, v12
    s_mov_b32 exec_lo, 0xffff0000
    s_mov_b32 exec_hi, 0xffff
    buffer_store_dword v12, v9, s[40:43], s59 offen sc1
    s_lshl_b32 s57, s3, 2
    s_add_u32 s57, s57, s62
    s_add_u32 s57, s57, 56320
    s_mov_b64 exec, 0x1
    s_cmp_eq_u32 s55, 0
    s_cbranch_scc1 L_gs_181
    buffer_store_dword v0, v0, s[40:43], s57 offen
L_gb_182:
    s_mov_b64 exec, -1
L_skip_180:
    s_sub_u32 s57, s30, 5
    s_cmp_lt_u32 s57, 2
    s_cbranch_scc0 L_skip_183
    s_sub_u32 s60, s30, 5
    s_mul_i32 s59, s60, 6144
    s_add_u32 s59, s59, 79872
L_pad15:
    s_cbranch_execz L_pad16
    s_mul_i32 s57, s31, 384
    v_lshlrev_b32 v5, 1, v0
    v_add_u32 v5, s57, v5
    global_load_ushort v8, v5, s[18:19] offset:0
    global_load_ushort v9, v5, s[18:19] offset:128
    global_load_ushort v10, v5, s[18:19] offset:256
    v_lshlrev_b32 v11, 4, v0
    v_lshrrev_b32 v7, 4, v0
    v_lshlrev_b32 v7, 8, v7
    v_bfe_u32 v60, v0, 2, 2
    v_lshl_add_u32 v7, v60, 5, v7
    v_and_b32 v60, 3, v0
    v_lshl_add_u32 v7, v60, 3, v7
    v_add_u32 v7, s59, v7
    s_mul_i32 s57, s31, 2560
    s_lshl_b32 s58, s3, 7
    s_add_u32 s57, s57, s58
    s_lshl_b32 s60, s60, 6
    s_add_u32 s60, s60, s57
    s_add_u32 s60, s60, 1404928
    s_add_u32 s58, s62, 49152
    s_add_u32 s59, s58, 3072
    buffer_load_dwordx4 v[12:15], v11, s[40:43], s58 offen offset:0 sc1
    buffer_load_dwordx4 v[16:19], v11, s[40:43], s58 offen offset:1024 sc1
    buffer_load_dwordx4 v[20:23], v11, s[40:43], s58 offen offset:2048 sc1
    buffer_load_dwordx4 v[24:27], v11, s[40:43], s59 offen offset:0 sc1
    buffer_load_dwordx4 v[28:31], v11, s[40:43], s59 offen offset:1024 sc1
    buffer_load_dwordx4 v[32:35], v11, s[40:43], s59 offen offset:2048 sc1
    s_waitcnt vmcnt(0)
L_pw_184:
    v_max3_u32 v60, v12, v13, v14
    v_max3_u32 v60, v60, v15, v16
    v_max3_u32 v60, v60, v17, v18
    v_max3_u32 v60, v60, v19, v20
    v_max3_u32 v60, v60, v21, v22
    v_max3_u32 v60, v60, v23, v24
    v_max3_u32 v60, v60, v25, v26
    v_max3_u32 v60, v60, v27, v28
    v_max3_u32 v60, v60, v29, v30
    v_max3_u32 v60, v60, v31, v32
    v_max3_u32 v60, v60, v33, v34
    v_max_u32 v60, v60, v35
    v_cmp_eq_u32 vcc, -1, v60
    s_cbranch_vccnz L_pr_185
    ds_read_b64_tr_b16 v[36:37], v7 offset:0
    ds_read_b64_tr_b16 v[38:39], v7 offset:128
    ds_read_b64_tr_b16 v[40:41], v7 offset:1024
    ds_read_b64_tr_b16 v[42:43], v7 offset:1152
    ds_read_b64_tr_b16 v[44:45], v7 offset:2048
    ds_read_b64_tr_b16 v[46:47], v7 offset:2176
    ds_read_b64_tr_b16 v[48:49], v7 offset:3072
    ds_read_b64_tr_b16 v[50:51], v7 offset:3200
    ds_read_b64_tr_b16 v[52:53], v7 offset:4096
    ds_read_b64_tr_b16 v[54:55], v7 offset:4224
    ds_read_b64_tr_b16 v[56:57], v7 offset:5120
    ds_read_b64_tr_b16 v[58:59], v7 offset:5248
    v_pk_add_f32 v[12:13], v[12:13], v[14:15]
    v_pk_add_f32 v[16:17], v[16:17], v[18:19]
    v_pk_add_f32 v[12:13], v[12:13], v[16:17]
    v_add_f32 v4, v12, v13
    v_pk_add_f32 v[20:21], v[20:21], v[22:23]
    v_pk_add_f32 v[24:25], v[24:25], v[26:27]
    v_pk_add_f32 v[20:21], v[20:21], v[24:25]
    v_add_f32 v5, v20, v21
    v_pk_add_f32 v[28:29], v[28:29], v[30:31]
    v_pk_add_f32 v[32:33], v[32:33], v[34:35]
    v_pk_add_f32 v[28:29], v[28:29], v[32:33]
    v_add_f32 v7, v28, v29
    v_lshlrev_b32 v8, 16, v8
    v_lshlrev_b32 v9, 16, v9
    v_lshlrev_b32 v10, 16, v10
    v_mov_b64 v[60:61], 0
    v_mov_b64 v[62:63], 0
    s_add_u32 s58, s62, 43008
    s_add_u32 s57, s62, 55680
    s_add_u32 s59, s58, 3072
L_pad16:
    s_cbranch_execz L_pad17
    s_mov_b32 s64, 0xbdd2d3e8
    v_and_b32 v12, 7, v0
    v_lshlrev_b32 v12, 3, v12
    buffer_load_dwordx2 v[2:3], v12, s[40:43], s57 offen sc1
    s_waitcnt lgkmcnt(0)
    s_waitcnt vmcnt(0)
L_pw_186:
    v_max_u32 v13, v2, v3
    v_cmp_eq_u32 vcc, -1, v13
    s_cbranch_vccnz L_pr_187
    buffer_load_dwordx4 v[12:15], v11, s[40:43], s58 offen offset:0 sc1
    buffer_load_dwordx4 v[16:19], v11, s[40:43], s58 offen offset:1024 sc1
    buffer_load_dwordx4 v[20:23], v11, s[40:43], s58 offen offset:2048 sc1
    buffer_load_dwordx4 v[24:27], v11, s[40:43], s59 offen offset:0 sc1
    buffer_load_dwordx4 v[28:31], v11, s[40:43], s59 offen offset:1024 sc1
    buffer_load_dwordx4 v[32:35], v11, s[40:43], s59 offen offset:2048 sc1
    v_add_f32_dpp v2, v2, v2 row_ror:4 row_mask:0xf bank_mask:0xf
    v_add_f32_dpp v3, v3, v3 row_ror:4 row_mask:0xf bank_mask:0xf
    s_nop 0
    v_add_f32_dpp v2, v2, v2 row_ror:2 row_mask:0xf bank_mask:0xf
    v_add_f32_dpp v3, v3, v3 row_ror:2 row_mask:0xf bank_mask:0xf
    s_nop 0
    v_add_f32_dpp v2, v2, v2 row_ror:1 row_mask:0xf bank_mask:0xf
    v_add_f32_dpp v3, v3, v3 row_ror:1 row_mask:0xf bank_mask:0xf
    v_mul_f32 v2, 0x3acccccd, v2
    v_mul_f32 v3, 0x3acccccd, v3
    v_fma_f32 v3, -v2, v2, v3
    v_max_f32 v3, 0, v3
    v_add_f32 v3, 0x3727c5ac, v3
    v_rsq_f32 v3, v3
    s_nop 0
    v_mul_f32 v2, v2, v3
    v_fma_f32 v8, -v2, v4, v8
    v_fma_f32 v9, -v2, v5, v9
    v_fma_f32 v10, -v2, v7, v10
    v_lshlrev_b32 v7, 2, v0
    v_mov_b32 v2, 0xc0135761
    s_waitcnt vmcnt(4)
    v_pk_add_f32 v[12:13], v[12:13], v[14:15]
    v_pk_add_f32 v[16:17], v[16:17], v[18:19]
    v_pk_add_f32 v[12:13], v[12:13], v[16:17]
    v_add_f32 v12, v12, v13
    s_waitcnt vmcnt(2)
    v_pk_add_f32 v[20:21], v[20:21], v[22:23]
    v_pk_add_f32 v[24:25], v[24:25], v[26:27]
    v_pk_add_f32 v[20:21], v[20:21], v[24:25]
    v_add_f32 v13, v20, v21
    s_waitcnt vmcnt(0)
    v_pk_add_f32 v[28:29], v[28:29], v[30:31]
    v_pk_add_f32 v[32:33], v[32:33], v[34:35]
    v_pk_add_f32 v[28:29], v[28:29], v[32:33]
    v_add_f32 v14, v28, v29
    v_add_f32 v15, v12, v13
    v_cmp_u_f32 vcc, v15, v14
    s_cbranch_vccnz L_hr_188
L_hk_189:
    v_fma_f32 v12, v12, v3, v8
    v_fma_f32 v13, v13, v3, v9
    v_fma_f32 v14, v14, v3, v10
    v_mul_f32 v16, v12, v12
    v_mul_f32 v17, v13, v13
    v_mul_f32 v18, v14, v14
    v_fma_f32 v16, v16, s64, v2
    v_fma_f32 v17, v17, s64, v2
    v_fma_f32 v18, v18, s64, v2
    v_mul_f32 v16, v16, v12
    v_mul_f32 v17, v17, v13
    v_mul_f32 v18, v18, v14
    v_exp_f32 v16, v16
    v_exp_f32 v17, v17
    v_exp_f32 v18, v18
    v_add_f32 v16, 1.0, v16
    v_add_f32 v17, 1.0, v17
    v_add_f32 v18, 1.0, v18
    v_rcp_f32 v16, v16
    v_rcp_f32 v17, v17
    v_rcp_f32 v18, v18
    v_mul_f32 v12, v12, v16
    v_mul_f32 v13, v13, v17
    v_mul_f32 v14, v14, v18
    v_mov_b32_dpp v16, v12 row_shl:1 row_mask:0xf bank_mask:0xf bound_ctrl:0
    v_mov_b32_dpp v17, v13 row_shl:1 row_mask:0xf bank_mask:0xf bound_ctrl:0
    v_mov_b32_dpp v18, v14 row_shl:1 row_mask:0xf bank_mask:0xf bound_ctrl:0
    v_cvt_pk_bf16_f32 v20, v12, v16
    v_cvt_pk_bf16_f32 v24, v13, v17
    v_cvt_pk_bf16_f32 v28, v14, v18
L_pad17:
    s_cbranch_execz L_pad18
    v_mov_b32_dpp v21, v20 row_shl:4 row_mask:0xf bank_mask:0xf bound_ctrl:0
    v_mov_b32_dpp v22, v20 row_shl:8 row_mask:0xf bank_mask:0xf bound_ctrl:0
    v_mov_b32_dpp v23, v20 row_shl:12 row_mask:0xf bank_mask:0xf bound_ctrl:0
    v_mov_b32_dpp v25, v24 row_shl:4 row_mask:0xf bank_mask:0xf bound_ctrl:0
    v_mov_b32_dpp v26, v24 row_shl:8 row_mask:0xf bank_mask:0xf bound_ctrl:0
    v_mov_b32_dpp v27, v24 row_shl:12 row_mask:0xf bank_mask:0xf bound_ctrl:0
    v_smfmac_f32_16x16x64_bf16 v[60:63], v[20:23], v[36:43], v1
    v_mov_b32_dpp v29, v28 row_shl:4 row_mask:0xf bank_mask:0xf bound_ctrl:0
    v_mov_b32_dpp v30, v28 row_shl:8 row_mask:0xf bank_mask:0xf bound_ctrl:0
    v_mov_b32_dpp v31, v28 row_shl:12 row_mask:0xf bank_mask:0xf bound_ctrl:0
    v_smfmac_f32_16x16x64_bf16 v[60:63], v[24:27], v[44:51], v1
    s_nop 0
    v_smfmac_f32_16x16x64_bf16 v[60:63], v[28:31], v[52:59], v1
    s_nop 7
    v_add_f32 v60, v60, v62
    v_min_u32 v60, -2, v60
    s_mov_b64 exec, 0xffff
    buffer_store_dword v60, v7, s[40:43], s60 offen sc1
    s_cmp_eq_u32 s30, 6
    s_cbranch_scc0 L_skip_192
    s_lshl_b32 s57, s3, 2
    s_add_u32 s57, s57, s62
    s_add_u32 s57, s57, 56448
    s_mov_b64 exec, 0x1
    s_cmp_eq_u32 s55, 0
    s_cbranch_scc1 L_gs_193
    buffer_store_dword v0, v0, s[40:43], s57 offen
L_gb_194:
    s_mov_b64 exec, -1
L_skip_192:
    s_mov_b64 exec, -1
L_skip_183:
    s_branch L_done
L_typeB_1:
    s_cmp_eq_u32 s53, 3
    s_cbranch_scc0 L_done
    s_cmp_lt_u32 s30, 6
    s_cbranch_scc0 L_skip_195
    s_lshr_b32 s57, s30, 1
    s_mul_i32 s57, s57, 128
    s_and_b32 s58, s30, 1
    s_lshl_b32 s58, s58, 6
    s_add_u32 s57, s57, s58
    v_lshrrev_b32 v18, 5, v0
    v_lshlrev_b32 v18, 13, v18
    v_bfe_u32 v60, v0, 3, 1
    v_lshl_add_u32 v18, v60, 12, v18
    v_bfe_u32 v60, v0, 4, 1
    v_lshl_add_u32 v18, v60, 11, v18
    v_bfe_u32 v60, v0, 2, 1
    v_mul_u32_u24 v60, 384, v60
    v_add_u32 v18, v60, v18
    v_and_b32 v60, 3, v0
    v_lshl_add_u32 v18, v60, 3, v18
    v_add_u32 v18, s57, v18
    v_add_u32 v18, 30720, v18
    v_bfe_u32 v19, v0, 4, 1
    v_lshlrev_b32 v19, 12, v19
    v_bfe_u32 v60, v0, 3, 1
    v_lshl_add_u32 v19, v60, 11, v19
    v_bfe_u32 v60, v0, 2, 1
    v_mul_u32_u24 v60, 384, v60
    v_add_u32 v19, v60, v19
    v_and_b32 v60, 3, v0
    v_lshl_add_u32 v19, v60, 3, v19
    v_add_u32 v19, s57, v19
    v_add_u32 v19, 63488, v19
    ds_read_b64_tr_b16 v[36:37], v18 offset:0
    ds_read_b64_tr_b16 v[38:39], v18 offset:1024
    ds_read_b64_tr_b16 v[40:41], v18 offset:16384
    ds_read_b64_tr_b16 v[42:43], v18 offset:17408
    ds_read_b64_tr_b16 v[44:45], v19 offset:0
    ds_read_b64_tr_b16 v[46:47], v19 offset:1024
    ds_read_b64_tr_b16 v[48:49], v18 offset:32
    ds_read_b64_tr_b16 v[50:51], v18 offset:1056
    ds_read_b64_tr_b16 v[52:53], v18 offset:16416
    ds_read_b64_tr_b16 v[54:55], v18 offset:17440
    ds_read_b64_tr_b16 v[56:57], v19 offset:32
    ds_read_b64_tr_b16 v[58:59], v19 offset:1056
    v_lshrrev_b32 v32, 4, v0
    v_lshlrev_b32 v32, 5, v32
    v_bfe_u32 v60, v0, 1, 1
    v_lshl_add_u32 v32, v60, 4, v32
    v_and_b32 v60, 1, v0
L_pad18:
    s_cbranch_execz L_pad19
    v_mul_u32_u24 v60, 192, v60
    v_add_u32 v32, v60, v32
    v_add_u32 v32, 159872, v32
    v_lshrrev_b32 v33, 4, v0
    v_lshlrev_b32 v33, 4, v33
    v_bfe_u32 v60, v0, 1, 1
    v_lshl_add_u32 v33, v60, 3, v33
    v_and_b32 v60, 1, v0
    v_mul_u32_u24 v60, 192, v60
    v_add_u32 v33, v60, v33
    v_add_u32 v33, 160000, v33
    v_mov_b64 v[24:25], 0
    v_mov_b64 v[26:27], 0
    v_mov_b64 v[28:29], 0
    v_mov_b64 v[30:31], 0
    s_lshr_b32 s57, s30, 1
    s_lshl_b32 s57, s57, 11
    s_and_b32 s58, s30, 1
    s_lshl_b32 s58, s58, 9
    s_add_u32 s57, s57, s58
    s_lshr_b32 s58, s54, 2
    s_lshl_b32 s58, s58, 10
    s_add_u32 s57, s57, s58
    s_and_b32 s58, s54, 3
    s_lshl_b32 s58, s58, 2
    s_add_u32 s57, s57, s58
    v_and_b32 v34, 31, v0
    v_lshlrev_b32 v34, 4, v34
    v_add_u32 v34, s57, v34
    s_add_u32 s59, s62, 43008
    s_add_u32 s60, s62, 55680
L_skip_195:
    s_cmp_eq_u32 s30, 7
    s_cbranch_scc0 L_skip_196
    v_and_b32 v60, 31, v0
    v_min_u32 v60, 19, v60
    s_mul_i32 s57, s54, 320
    v_lshrrev_b32 v5, 5, v0
    v_mul_u32_u24 v5, 2560, v5
    v_add_u32 v5, s57, v5
    v_lshl_add_u32 v5, v60, 4, v5
    v_and_b32 v60, 31, v0
    v_cmp_gt_u32 s[64:65], 20, v60
    v_min_u32 v60, 19, v60
    v_lshrrev_b32 v35, 5, v0
    v_lshlrev_b32 v35, 2, v35
    v_add_u32 v35, 159872, v35
    v_lshl_add_u32 v35, v60, 3, v35
    s_add_u32 s66, s62, 43008
    s_add_u32 s67, s62, 55680
    s_lshl_b32 s57, s54, 3
    v_lshrrev_b32 v34, 5, v0
    v_lshlrev_b32 v34, 2, v34
    v_add_u32 v34, s57, v34
    v_mov_b32 v61, 0x3f803f80
    s_add_u32 s57, s62, 56320
    v_min_u32 v9, 19, v0
    v_lshlrev_b32 v9, 2, v9
    buffer_load_dword v12, v9, s[40:43], s57 offen sc1
    s_waitcnt vmcnt(0)
L_pw_197:
    v_cmp_eq_u32 vcc, -1, v12
    s_cbranch_vccnz L_pr_198
    s_mov_b32 s57, 1384448
    buffer_load_dwordx4 v[12:15], v5, s[40:43], s57 offen sc1
    s_mov_b32 s58, 1389568
    buffer_load_dwordx4 v[16:19], v5, s[40:43], s58 offen sc1
    s_mov_b32 s59, 1394688
    buffer_load_dwordx4 v[20:23], v5, s[40:43], s59 offen sc1
    s_mov_b32 s60, 1399808
    buffer_load_dwordx4 v[24:27], v5, s[40:43], s60 offen sc1
L_gw_199:
    s_waitcnt vmcnt(2)
    v_pk_add_f32 v[28:29], v[12:13], v[16:17]
    v_pk_add_f32 v[30:31], v[14:15], v[18:19]
    s_waitcnt vmcnt(1)
    v_pk_add_f32 v[28:29], v[28:29], v[20:21]
    v_pk_add_f32 v[30:31], v[30:31], v[22:23]
    s_waitcnt vmcnt(0)
    v_pk_add_f32 v[28:29], v[28:29], v[24:25]
    v_pk_add_f32 v[30:31], v[30:31], v[26:27]
    s_nop 1
    v_permlane32_swap_b32 v28, v30
    v_permlane32_swap_b32 v29, v31
    v_pk_add_f32 v[28:29], v[28:29], v[30:31]
    v_pk_add_f32 v[28:29], v[28:29], v[2:3]
    v_cmp_u_f32 vcc, v28, v29
    s_cbranch_vccnz L_gr_200
L_gk_201:
    v_cvt_pk_bf16_f32 v28, v28, v29
    ds_write_b32 v35, v28
    s_waitcnt lgkmcnt(0)
L_skip_196:
    s_barrier
    s_cmp_lt_u32 s30, 6
L_pad19:
    s_cbranch_execz L_pad20
    s_cbranch_scc0 L_skip_206
    ds_read_b128 v[12:15], v32
    ds_read_b64 v[16:17], v33
    s_waitcnt lgkmcnt(1)
    v_smfmac_f32_16x16x64_bf16 v[24:27], v[12:15], v[36:43], v1
    v_smfmac_f32_16x16x64_bf16 v[28:31], v[12:15], v[48:55], v1
    s_waitcnt lgkmcnt(0)
    v_smfmac_f32_16x16x32_bf16 v[24:27], v[16:17], v[44:47], v1
    v_smfmac_f32_16x16x32_bf16 v[28:31], v[16:17], v[56:59], v1
    s_nop 6
    v_add_f32 v12, v24, v26
    s_nop 1
    v_add_f32_dpp v12, v28, v30 quad_perm:[0,1,2,3] row_mask:0x2 bank_mask:0xf
    v_min_u32 v12, -2, v12
    s_mov_b32 exec_lo, 0xffffffff
    s_mov_b32 exec_hi, 0x0
    s_cmp_eq_u32 s55, 0
    s_cbranch_scc1 L_gs_207
    buffer_store_dword v12, v34, s[40:43], s59 offen
L_gb_208:
    s_mov_b64 exec, -1
L_skip_206:
    s_cmp_eq_u32 s30, 7
    s_cbranch_scc0 L_skip_209
    v_lshlrev_b32 v2, 16, v28
    v_and_b32 v3, 0xffff0000, v28
    v_cndmask_b32 v28, 0, v28, s[64:65]
    v_dot2_f32_bf16 v27, v28, v61, 0
    v_dot2_f32_bf16 v62, v28, v28, 0
    s_nop 2
    v_permlane32_swap_b32 v27, v62
    v_add_f32 v27, v27, v62
    v_mov_b32 v62, v27
    s_nop 1
    v_permlane16_swap_b32 v27, v62
    v_add_f32 v27, v27, v62
    s_nop 1
    v_add_f32_dpp v27, v27, v27 row_ror:8 row_mask:0xf bank_mask:0xf
    s_nop 1
    v_add_f32_dpp v27, v27, v27 row_ror:4 row_mask:0xf bank_mask:0xf
    s_nop 1
    v_add_f32_dpp v27, v27, v27 row_ror:2 row_mask:0xf bank_mask:0xf
    s_nop 1
    v_add_f32_dpp v27, v27, v27 row_ror:1 row_mask:0xf bank_mask:0xf
    v_min_u32 v27, -2, v27
    s_mov_b32 exec_lo, 0x1
    s_mov_b32 exec_hi, 0x1
    s_cmp_eq_u32 s55, 0
    s_cbranch_scc1 L_gs_210
    buffer_store_dword v27, v34, s[40:43], s67 offen
L_gb_211:
    s_mov_b64 exec, -1
L_skip_209:
    s_cmp_eq_u32 s30, 7
    s_cbranch_scc0 L_done
    s_cmp_eq_u32 s31, 0
    s_cbranch_scc0 L_done
    v_lshlrev_b32 v60, 16, v4
    v_add_f32 v2, v2, v60
    v_and_b32 v60, 0xffff0000, v4
    v_add_f32 v3, v3, v60
    v_and_b32 v60, 31, v0
    v_min_u32 v60, 19, v60
    s_mul_i32 s57, s54, 160
    v_lshrrev_b32 v7, 5, v0
    v_lshlrev_b32 v7, 2, v7
    v_add_u32 v7, s57, v7
    v_lshl_add_u32 v7, v60, 3, v7
    s_add_u32 s57, s62, 56448
    v_min_u32 v9, 19, v0
    v_lshlrev_b32 v9, 2, v9
    buffer_load_dword v12, v9, s[40:43], s57 offen sc1
    s_waitcnt vmcnt(0)
L_pw_212:
    v_cmp_eq_u32 vcc, -1, v12
    s_cbranch_vccnz L_pr_213
    s_mov_b32 s57, 1404928
    buffer_load_dwordx4 v[12:15], v5, s[40:43], s57 offen sc1
    s_mov_b32 s58, 1410048
    buffer_load_dwordx4 v[16:19], v5, s[40:43], s58 offen sc1
    s_mov_b32 s59, 1415168
    buffer_load_dwordx4 v[20:23], v5, s[40:43], s59 offen sc1
    s_mov_b32 s60, 1420288
    buffer_load_dwordx4 v[24:27], v5, s[40:43], s60 offen sc1
L_gw_214:
    s_waitcnt vmcnt(2)
    v_pk_add_f32 v[28:29], v[12:13], v[16:17]
    v_pk_add_f32 v[30:31], v[14:15], v[18:19]
    s_waitcnt vmcnt(1)
    v_pk_add_f32 v[28:29], v[28:29], v[20:21]
    v_pk_add_f32 v[30:31], v[30:31], v[22:23]
    s_waitcnt vmcnt(0)
    v_pk_add_f32 v[28:29], v[28:29], v[24:25]
    v_pk_add_f32 v[30:31], v[30:31], v[26:27]
    s_nop 1
    v_permlane32_swap_b32 v28, v30
    v_permlane32_swap_b32 v29, v31
L_pad20:
    s_cbranch_execz L_pad21
    v_pk_add_f32 v[28:29], v[28:29], v[30:31]
    v_pk_add_f32 v[28:29], v[28:29], v[2:3]
    v_cmp_u_f32 vcc, v28, v29
    s_cbranch_vccnz L_gr_215
L_gk_216:
    v_cvt_pk_bf16_f32 v28, v28, v29
    global_store_dword v7, v28, s[24:25]
    s_branch L_done
L_gs_25:
    buffer_store_dword v27, v34, s[40:43], s67 offen sc1
    s_branch L_gb_26
L_gs_28:
    buffer_store_dword v12, v34, s[40:43], s59 offen sc1
    s_branch L_gb_29
L_cr_40:
    s_sub_u32 s56, s56, 1
    s_cbranch_scc1 L_done
    global_load_dword v2, v3, s[26:27] sc1
    s_waitcnt vmcnt(0)
    s_branch L_cw_39
L_cr_52:
    s_sub_u32 s56, s56, 1
    s_cbranch_scc1 L_done
    global_load_dword v2, v3, s[26:27] sc1
    s_branch L_cw_51
L_pr_59:
    s_sub_u32 s56, s56, 1
    s_cbranch_scc1 L_done
    buffer_load_dwordx4 v[24:27], v3, s[40:43], 0 offen sc1
    s_waitcnt vmcnt(0)
    s_branch L_pw_58
L_gs_65:
    buffer_store_dword v27, v34, s[40:43], s67 offen sc1
    s_branch L_gb_66
L_gs_68:
    buffer_store_dword v12, v34, s[40:43], s59 offen sc1
    s_branch L_gb_69
L_pr_72:
    s_sub_u32 s56, s56, 1
    s_cbranch_scc1 L_done
    buffer_load_dword v17, v16, s[40:43], s72 offen offset:128 sc1
    s_waitcnt vmcnt(0)
    s_branch L_pw_71
L_gs_87:
    buffer_store_dword v22, v23, s[40:43], s57 offen sc1
    s_branch L_gb_88
L_gs_99:
    buffer_store_dword v56, v21, s[40:43], 0 offen sc1
    s_branch L_gb_100
L_pr_103:
    s_sub_u32 s56, s56, 1
    s_cbranch_scc1 L_done
    buffer_load_dword v18, v5, s[40:43], s59 offen sc1
    buffer_load_dwordx2 v[20:21], v22, s[40:43], s59 offen sc1
    s_waitcnt vmcnt(0)
    s_branch L_pw_102
L_pr_105:
    s_sub_u32 s56, s56, 1
    s_cbranch_scc1 L_done
    buffer_load_dwordx4 v[12:15], v9, s[40:43], s60 offen sc1
    buffer_load_dwordx2 v[16:17], v10, s[40:43], s60 offen offset:1024 sc1
    s_waitcnt vmcnt(0)
    s_branch L_pw_104
L_gs_107:
    buffer_store_dword v0, v0, s[40:43], s57 offen sc1
    s_branch L_gb_108
L_pr_111:
    s_sub_u32 s56, s56, 1
    s_cbranch_scc1 L_done
    buffer_load_dwordx4 v[12:15], v11, s[40:43], s58 offen offset:0 sc1
    buffer_load_dwordx4 v[16:19], v11, s[40:43], s58 offen offset:1024 sc1
    buffer_load_dwordx4 v[20:23], v11, s[40:43], s58 offen offset:2048 sc1
    buffer_load_dwordx4 v[24:27], v11, s[40:43], s59 offen offset:0 sc1
    buffer_load_dwordx4 v[28:31], v11, s[40:43], s59 offen offset:1024 sc1
    buffer_load_dwordx4 v[32:35], v11, s[40:43], s59 offen offset:2048 sc1
    s_waitcnt vmcnt(0)
    s_branch L_pw_110
L_pr_113:
    s_sub_u32 s56, s56, 1
    s_cbranch_scc1 L_done
    buffer_load_dwordx2 v[2:3], v12, s[40:43], s57 offen sc1
    s_waitcnt vmcnt(0)
    s_branch L_pw_112
L_pr_117:
    s_sub_u32 s56, s56, 1
    s_cbranch_scc1 L_done
    buffer_load_dwordx4 v[12:15], v11, s[40:43], s58 offen offset:0 sc1
    buffer_load_dwordx4 v[16:19], v11, s[40:43], s58 offen offset:1024 sc1
    buffer_load_dwordx4 v[20:23], v11, s[40:43], s58 offen offset:2048 sc1
    buffer_load_dwordx4 v[24:27], v11, s[40:43], s59 offen offset:0 sc1
    buffer_load_dwordx4 v[28:31], v11, s[40:43], s59 offen offset:1024 sc1
    buffer_load_dwordx4 v[32:35], v11, s[40:43], s59 offen offset:2048 sc1
    s_waitcnt vmcnt(0)
    s_branch L_pw_116
L_hr_114:
    buffer_load_dwordx4 v[12:15], v11, s[40:43], s58 offen offset:0 sc1
    buffer_load_dwordx4 v[16:19], v11, s[40:43], s58 offen offset:1024 sc1
    buffer_load_dwordx4 v[20:23], v11, s[40:43], s58 offen offset:2048 sc1
    buffer_load_dwordx4 v[24:27], v11, s[40:43], s59 offen offset:0 sc1
    buffer_load_dwordx4 v[28:31], v11, s[40:43], s59 offen offset:1024 sc1
    buffer_load_dwordx4 v[32:35], v11, s[40:43], s59 offen offset:2048 sc1
    s_waitcnt vmcnt(0)
L_pw_116:
    v_max3_u32 v4, v12, v13, v14
    v_max3_u32 v4, v4, v15, v16
    v_max3_u32 v4, v4, v17, v18
L_pad21:
    s_cbranch_execz L_pad22
    v_max3_u32 v4, v4, v19, v20
    v_max3_u32 v4, v4, v21, v22
    v_max3_u32 v4, v4, v23, v24
    v_max3_u32 v4, v4, v25, v26
    v_max3_u32 v4, v4, v27, v28
    v_max3_u32 v4, v4, v29, v30
    v_max3_u32 v4, v4, v31, v32
    v_max3_u32 v4, v4, v33, v34
    v_max_u32 v4, v4, v35
    v_cmp_eq_u32 vcc, -1, v4
    s_cbranch_vccnz L_pr_117
    v_pk_add_f32 v[12:13], v[12:13], v[14:15]
    v_pk_add_f32 v[16:17], v[16:17], v[18:19]
    v_pk_add_f32 v[12:13], v[12:13], v[16:17]
    v_add_f32 v12, v12, v13
    v_pk_add_f32 v[20:21], v[20:21], v[22:23]
    v_pk_add_f32 v[24:25], v[24:25], v[26:27]
    v_pk_add_f32 v[20:21], v[20:21], v[24:25]
    v_add_f32 v13, v20, v21
    v_pk_add_f32 v[28:29], v[28:29], v[30:31]
    v_pk_add_f32 v[32:33], v[32:33], v[34:35]
    v_pk_add_f32 v[28:29], v[28:29], v[32:33]
    v_add_f32 v14, v28, v29
    s_branch L_hk_115
L_gs_119:
    buffer_store_dword v0, v0, s[40:43], s57 offen sc1
    s_branch L_gb_120
L_gs_122:
    buffer_store_dword v12, v34, s[40:43], s60 offen sc1
    s_branch L_gb_123
L_pr_126:
    s_sub_u32 s56, s56, 1
    s_cbranch_scc1 L_done
    buffer_load_dword v12, v9, s[40:43], s57 offen sc1
    s_waitcnt vmcnt(0)
    s_branch L_pw_125
L_gr_128:
    s_sub_u32 s56, s56, 1
    s_cbranch_scc1 L_done
    s_mov_b64 s[74:75], 0
    v_max3_u32 v30, v12, v13, v14
    v_max_u32 v30, v30, v15
    v_cmp_eq_u32 vcc, -1, v30
    s_cbranch_vccz L_gn_130
    s_or_b64 s[74:75], s[74:75], vcc
    s_mov_b64 exec, vcc
    buffer_load_dwordx4 v[12:15], v5, s[40:43], s57 offen sc1
    s_mov_b64 exec, -1
L_gn_130:
    v_max3_u32 v30, v16, v17, v18
    v_max_u32 v30, v30, v19
    v_cmp_eq_u32 vcc, -1, v30
    s_cbranch_vccz L_gn_131
    s_or_b64 s[74:75], s[74:75], vcc
    s_mov_b64 exec, vcc
    buffer_load_dwordx4 v[16:19], v5, s[40:43], s58 offen sc1
    s_mov_b64 exec, -1
L_gn_131:
    v_max3_u32 v30, v20, v21, v22
    v_max_u32 v30, v30, v23
    v_cmp_eq_u32 vcc, -1, v30
    s_cbranch_vccz L_gn_132
    s_or_b64 s[74:75], s[74:75], vcc
    s_mov_b64 exec, vcc
    buffer_load_dwordx4 v[20:23], v5, s[40:43], s59 offen sc1
    s_mov_b64 exec, -1
L_gn_132:
    v_max3_u32 v30, v24, v25, v26
    v_max_u32 v30, v30, v27
    v_cmp_eq_u32 vcc, -1, v30
    s_cbranch_vccz L_gn_133
    s_or_b64 s[74:75], s[74:75], vcc
    s_mov_b64 exec, vcc
    buffer_load_dwordx4 v[24:27], v5, s[40:43], s60 offen sc1
    s_mov_b64 exec, -1
L_gn_133:
    s_cmp_eq_u64 s[74:75], 0
    s_cbranch_scc1 L_gk_129
    s_waitcnt vmcnt(0)
    s_branch L_gw_127
L_gs_135:
    buffer_store_dword v12, v34, s[40:43], s59 offen sc1
    s_branch L_gb_136
L_gs_138:
    buffer_store_dword v27, v34, s[40:43], s67 offen sc1
    s_branch L_gb_139
L_pr_144:
    s_sub_u32 s56, s56, 1
    s_cbranch_scc1 L_done
    buffer_load_dword v12, v9, s[40:43], s57 offen sc1
    s_waitcnt vmcnt(0)
    s_branch L_pw_143
L_gr_146:
    s_sub_u32 s56, s56, 1
    s_cbranch_scc1 L_done
    s_mov_b64 s[74:75], 0
    v_max3_u32 v30, v12, v13, v14
    v_max_u32 v30, v30, v15
    v_cmp_eq_u32 vcc, -1, v30
    s_cbranch_vccz L_gn_148
    s_or_b64 s[74:75], s[74:75], vcc
    s_mov_b64 exec, vcc
    buffer_load_dwordx4 v[12:15], v5, s[40:43], s57 offen sc1
    s_mov_b64 exec, -1
L_gn_148:
    v_max3_u32 v30, v16, v17, v18
L_pad22:
    s_cbranch_execz L_pad23
    v_max_u32 v30, v30, v19
    v_cmp_eq_u32 vcc, -1, v30
    s_cbranch_vccz L_gn_149
    s_or_b64 s[74:75], s[74:75], vcc
    s_mov_b64 exec, vcc
    buffer_load_dwordx4 v[16:19], v5, s[40:43], s58 offen sc1
    s_mov_b64 exec, -1
L_gn_149:
    v_max3_u32 v30, v20, v21, v22
    v_max_u32 v30, v30, v23
    v_cmp_eq_u32 vcc, -1, v30
    s_cbranch_vccz L_gn_150
    s_or_b64 s[74:75], s[74:75], vcc
    s_mov_b64 exec, vcc
    buffer_load_dwordx4 v[20:23], v5, s[40:43], s59 offen sc1
    s_mov_b64 exec, -1
L_gn_150:
    v_max3_u32 v30, v24, v25, v26
    v_max_u32 v30, v30, v27
    v_cmp_eq_u32 vcc, -1, v30
    s_cbranch_vccz L_gn_151
    s_or_b64 s[74:75], s[74:75], vcc
    s_mov_b64 exec, vcc
    buffer_load_dwordx4 v[24:27], v5, s[40:43], s60 offen sc1
    s_mov_b64 exec, -1
L_gn_151:
    s_cmp_eq_u64 s[74:75], 0
    s_cbranch_scc1 L_gk_147
    s_waitcnt vmcnt(0)
    s_branch L_gw_145
L_pr_153:
    s_sub_u32 s56, s56, 1
    s_cbranch_scc1 L_done
    buffer_load_dword v12, v9, s[40:43], s57 offen sc1
    s_waitcnt vmcnt(0)
    s_branch L_pw_152
L_gr_155:
    s_sub_u32 s56, s56, 1
    s_cbranch_scc1 L_done
    s_mov_b64 s[74:75], 0
    v_max3_u32 v30, v12, v13, v14
    v_max_u32 v30, v30, v15
    v_cmp_eq_u32 vcc, -1, v30
    s_cbranch_vccz L_gn_157
    s_or_b64 s[74:75], s[74:75], vcc
    s_mov_b64 exec, vcc
    buffer_load_dwordx4 v[12:15], v5, s[40:43], s57 offen sc1
    s_mov_b64 exec, -1
L_gn_157:
    v_max3_u32 v30, v16, v17, v18
    v_max_u32 v30, v30, v19
    v_cmp_eq_u32 vcc, -1, v30
    s_cbranch_vccz L_gn_158
    s_or_b64 s[74:75], s[74:75], vcc
    s_mov_b64 exec, vcc
    buffer_load_dwordx4 v[16:19], v5, s[40:43], s58 offen sc1
    s_mov_b64 exec, -1
L_gn_158:
    v_max3_u32 v30, v20, v21, v22
    v_max_u32 v30, v30, v23
    v_cmp_eq_u32 vcc, -1, v30
    s_cbranch_vccz L_gn_159
    s_or_b64 s[74:75], s[74:75], vcc
    s_mov_b64 exec, vcc
    buffer_load_dwordx4 v[20:23], v5, s[40:43], s59 offen sc1
    s_mov_b64 exec, -1
L_gn_159:
    v_max3_u32 v30, v24, v25, v26
    v_max_u32 v30, v30, v27
    v_cmp_eq_u32 vcc, -1, v30
    s_cbranch_vccz L_gn_160
    s_or_b64 s[74:75], s[74:75], vcc
    s_mov_b64 exec, vcc
    buffer_load_dwordx4 v[24:27], v5, s[40:43], s60 offen sc1
    s_mov_b64 exec, -1
L_gn_160:
    s_cmp_eq_u64 s[74:75], 0
    s_cbranch_scc1 L_gk_156
    s_waitcnt vmcnt(0)
    s_branch L_gw_154
L_gs_162:
    buffer_store_dword v12, v34, s[40:43], s59 offen sc1
    s_branch L_gb_163
L_gs_165:
    buffer_store_dword v27, v34, s[40:43], s67 offen sc1
    s_branch L_gb_166
L_pr_168:
    s_sub_u32 s56, s56, 1
    s_cbranch_scc1 L_done
    buffer_load_dwordx2 v[8:9], v7, s[40:43], 0 offen sc1
    buffer_load_dwordx4 v[12:15], v5, s[40:43], 0 offen offset:0 sc1
    buffer_load_dwordx4 v[16:19], v5, s[40:43], 0 offen offset:1024 sc1
    buffer_load_dwordx4 v[20:23], v5, s[40:43], 0 offen offset:2048 sc1
    s_waitcnt vmcnt(0)
    s_branch L_pw_167
L_gs_171:
    buffer_store_dword v22, v23, s[40:43], s57 offen sc1
    s_branch L_gb_172
L_old:
    s_waitcnt lgkmcnt(0)
    s_barrier
    s_cmp_lt_u32 s30, 2
    s_cbranch_scc0 L_b2_1
    v_and_b32 v37, 7, v0
    v_lshlrev_b32 v37, 3, v37
    v_add_u32 v37, 159744, v37
    ds_read_b64 v[38:39], v37
    s_lshl_b32 s57, s53, 3
    s_add_u32 s57, s57, s54
    s_lshl_b32 s57, s57, 2
    v_mov_b32 v23, s57
    s_add_u32 s57, s62, 55936
    s_waitcnt lgkmcnt(0)
    v_max_f32_dpp v37, v38, v38 row_ror:4 row_mask:0xf bank_mask:0xf
    s_nop 1
L_pad23:
    s_cbranch_execz L_pad24
    v_max_f32_dpp v37, v37, v37 row_ror:2 row_mask:0xf bank_mask:0xf
    s_nop 1
    v_max_f32_dpp v37, v37, v37 row_ror:1 row_mask:0xf bank_mask:0xf
    v_sub_f32 v38, v38, v37
    v_exp_f32 v38, v38
    s_nop 0
    v_mul_f32 v39, v38, v39
    s_nop 1
    v_add_f32_dpp v39, v39, v39 row_ror:4 row_mask:0xf bank_mask:0xf
    s_nop 1
    v_add_f32_dpp v39, v39, v39 row_ror:2 row_mask:0xf bank_mask:0xf
    s_nop 1
    v_add_f32_dpp v39, v39, v39 row_ror:1 row_mask:0xf bank_mask:0xf
    v_log_f32 v22, v39
    v_rcp_f32 v39, v39
    v_add_f32 v22, v22, v37
    v_min_u32 v22, -2, v22
    v_mul_f32 v38, v38, v39
    s_cmp_eq_u32 s30, 0
    s_cbranch_scc0 L_skip_170
    s_mov_b64 exec, 0x1
    s_cmp_eq_u32 s55, 0
    s_cbranch_scc1 L_gs_171
    buffer_store_dword v22, v23, s[40:43], s57 offen
L_gb_172:
    s_mov_b64 exec, -1
L_skip_170:
    v_readlane_b32 s64, v38, 0
    v_readlane_b32 s65, v38, 1
    v_readlane_b32 s66, v38, 2
    v_readlane_b32 s67, v38, 3
    v_readlane_b32 s68, v38, 4
    v_readlane_b32 s69, v38, 5
    v_readlane_b32 s70, v38, 6
    v_readlane_b32 s71, v38, 7
    s_mul_i32 s57, s30, 48
    v_add_u32 v38, s57, v0
    v_bfe_u32 v20, v38, 5, 2
    v_lshlrev_b32 v20, 8, v20
    v_and_b32 v39, 15, v38
    v_lshl_add_u32 v20, v39, 4, v20
    v_bfe_u32 v39, v38, 4, 1
    v_lshl_add_u32 v20, v39, 3, v20
    v_add_u32 v20, 124928, v20
    s_lshr_b32 s57, s54, 1
    s_lshl_b32 s57, s57, 2
    s_and_b32 s58, s54, 1
    s_add_u32 s57, s57, s58
    s_lshl_b32 s58, s57, 4
    s_lshl_b32 s57, s57, 3
    v_bfe_u32 v21, v0, 3, 2
    v_lshlrev_b32 v21, 8, v21
    v_bfe_u32 v39, v0, 2, 1
    v_lshl_add_u32 v21, v39, 5, v21
    v_and_b32 v39, 3, v0
    v_lshl_add_u32 v21, v39, 2, v21
    v_add_u32 v21, s58, v21
    v_bfe_u32 v38, v0, 3, 1
    v_lshlrev_b32 v38, 8, v38
    v_bfe_u32 v39, v0, 1, 1
    v_lshl_add_u32 v38, v39, 7, v38
    v_bfe_u32 v39, v0, 2, 1
    v_lshl_add_u32 v38, v39, 4, v38
    v_and_b32 v39, 1, v0
    v_lshl_add_u32 v38, v39, 2, v38
    v_add_u32 v38, s57, v38
    v_add_u32 v38, 1024, v38
    v_cmp_gt_u32 vcc, 32, v0
    s_nop 1
    v_cndmask_b32 v21, v38, v21, vcc
    s_lshl_b32 s57, s53, 1
    s_add_u32 s57, s57, s30
    s_mul_i32 s57, s57, 1536
    s_add_u32 s57, s57, s62
    s_add_u32 s57, s57, 12288
    v_add_u32 v21, s57, v21
    s_branch L_b2_1
L_gs_174:
    buffer_store_dword v56, v21, s[40:43], 0 offen sc1
    s_branch L_gb_175
L_pr_177:
    s_sub_u32 s56, s56, 1
    s_cbranch_scc1 L_done
    buffer_load_dword v18, v5, s[40:43], s59 offen sc1
    buffer_load_dwordx2 v[20:21], v22, s[40:43], s59 offen sc1
    s_waitcnt vmcnt(0)
    s_branch L_pw_176
L_pr_179:
    s_sub_u32 s56, s56, 1
    s_cbranch_scc1 L_done
    buffer_load_dwordx4 v[12:15], v9, s[40:43], s60 offen sc1
    buffer_load_dwordx2 v[16:17], v10, s[40:43], s60 offen offset:1024 sc1
    s_waitcnt vmcnt(0)
    s_branch L_pw_178
L_gs_181:
    buffer_store_dword v0, v0, s[40:43], s57 offen sc1
L_pad24:
    s_cbranch_execz L_pad25
    s_branch L_gb_182
L_pr_185:
    s_sub_u32 s56, s56, 1
    s_cbranch_scc1 L_done
    buffer_load_dwordx4 v[12:15], v11, s[40:43], s58 offen offset:0 sc1
    buffer_load_dwordx4 v[16:19], v11, s[40:43], s58 offen offset:1024 sc1
    buffer_load_dwordx4 v[20:23], v11, s[40:43], s58 offen offset:2048 sc1
    buffer_load_dwordx4 v[24:27], v11, s[40:43], s59 offen offset:0 sc1
    buffer_load_dwordx4 v[28:31], v11, s[40:43], s59 offen offset:1024 sc1
    buffer_load_dwordx4 v[32:35], v11, s[40:43], s59 offen offset:2048 sc1
    s_waitcnt vmcnt(0)
    s_branch L_pw_184
L_pr_187:
    s_sub_u32 s56, s56, 1
    s_cbranch_scc1 L_done
    buffer_load_dwordx2 v[2:3], v12, s[40:43], s57 offen sc1
    s_waitcnt vmcnt(0)
    s_branch L_pw_186
L_pr_191:
    s_sub_u32 s56, s56, 1
    s_cbranch_scc1 L_done
    buffer_load_dwordx4 v[12:15], v11, s[40:43], s58 offen offset:0 sc1
    buffer_load_dwordx4 v[16:19], v11, s[40:43], s58 offen offset:1024 sc1
    buffer_load_dwordx4 v[20:23], v11, s[40:43], s58 offen offset:2048 sc1
    buffer_load_dwordx4 v[24:27], v11, s[40:43], s59 offen offset:0 sc1
    buffer_load_dwordx4 v[28:31], v11, s[40:43], s59 offen offset:1024 sc1
    buffer_load_dwordx4 v[32:35], v11, s[40:43], s59 offen offset:2048 sc1
    s_waitcnt vmcnt(0)
    s_branch L_pw_190
L_hr_188:
    buffer_load_dwordx4 v[12:15], v11, s[40:43], s58 offen offset:0 sc1
    buffer_load_dwordx4 v[16:19], v11, s[40:43], s58 offen offset:1024 sc1
    buffer_load_dwordx4 v[20:23], v11, s[40:43], s58 offen offset:2048 sc1
    buffer_load_dwordx4 v[24:27], v11, s[40:43], s59 offen offset:0 sc1
    buffer_load_dwordx4 v[28:31], v11, s[40:43], s59 offen offset:1024 sc1
    buffer_load_dwordx4 v[32:35], v11, s[40:43], s59 offen offset:2048 sc1
    s_waitcnt vmcnt(0)
L_pw_190:
    v_max3_u32 v4, v12, v13, v14
    v_max3_u32 v4, v4, v15, v16
    v_max3_u32 v4, v4, v17, v18
    v_max3_u32 v4, v4, v19, v20
    v_max3_u32 v4, v4, v21, v22
    v_max3_u32 v4, v4, v23, v24
    v_max3_u32 v4, v4, v25, v26
    v_max3_u32 v4, v4, v27, v28
    v_max3_u32 v4, v4, v29, v30
    v_max3_u32 v4, v4, v31, v32
    v_max3_u32 v4, v4, v33, v34
    v_max_u32 v4, v4, v35
    v_cmp_eq_u32 vcc, -1, v4
    s_cbranch_vccnz L_pr_191
    v_pk_add_f32 v[12:13], v[12:13], v[14:15]
    v_pk_add_f32 v[16:17], v[16:17], v[18:19]
    v_pk_add_f32 v[12:13], v[12:13], v[16:17]
    v_add_f32 v12, v12, v13
    v_pk_add_f32 v[20:21], v[20:21], v[22:23]
    v_pk_add_f32 v[24:25], v[24:25], v[26:27]
    v_pk_add_f32 v[20:21], v[20:21], v[24:25]
    v_add_f32 v13, v20, v21
    v_pk_add_f32 v[28:29], v[28:29], v[30:31]
    v_pk_add_f32 v[32:33], v[32:33], v[34:35]
    v_pk_add_f32 v[28:29], v[28:29], v[32:33]
    v_add_f32 v14, v28, v29
    s_branch L_hk_189
L_gs_193:
    buffer_store_dword v0, v0, s[40:43], s57 offen sc1
    s_branch L_gb_194
L_pr_198:
    s_sub_u32 s56, s56, 1
    s_cbranch_scc1 L_done
    buffer_load_dword v12, v9, s[40:43], s57 offen sc1
    s_waitcnt vmcnt(0)
    s_branch L_pw_197
L_gr_200:
    s_sub_u32 s56, s56, 1
    s_cbranch_scc1 L_done
    s_mov_b64 s[74:75], 0
    v_max3_u32 v30, v12, v13, v14
    v_max_u32 v30, v30, v15
    v_cmp_eq_u32 vcc, -1, v30
    s_cbranch_vccz L_gn_202
    s_or_b64 s[74:75], s[74:75], vcc
    s_mov_b64 exec, vcc
    buffer_load_dwordx4 v[12:15], v5, s[40:43], s57 offen sc1
    s_mov_b64 exec, -1
L_gn_202:
    v_max3_u32 v30, v16, v17, v18
    v_max_u32 v30, v30, v19
    v_cmp_eq_u32 vcc, -1, v30
    s_cbranch_vccz L_gn_203
L_pad25:
    s_cbranch_execz L_padback
    s_or_b64 s[74:75], s[74:75], vcc
    s_mov_b64 exec, vcc
    buffer_load_dwordx4 v[16:19], v5, s[40:43], s58 offen sc1
    s_mov_b64 exec, -1
L_gn_203:
    v_max3_u32 v30, v20, v21, v22
    v_max_u32 v30, v30, v23
    v_cmp_eq_u32 vcc, -1, v30
    s_cbranch_vccz L_gn_204
    s_or_b64 s[74:75], s[74:75], vcc
    s_mov_b64 exec, vcc
    buffer_load_dwordx4 v[20:23], v5, s[40:43], s59 offen sc1
    s_mov_b64 exec, -1
L_gn_204:
    v_max3_u32 v30, v24, v25, v26
    v_max_u32 v30, v30, v27
    v_cmp_eq_u32 vcc, -1, v30
    s_cbranch_vccz L_gn_205
    s_or_b64 s[74:75], s[74:75], vcc
    s_mov_b64 exec, vcc
    buffer_load_dwordx4 v[24:27], v5, s[40:43], s60 offen sc1
    s_mov_b64 exec, -1
L_gn_205:
    s_cmp_eq_u64 s[74:75], 0
    s_cbranch_scc1 L_gk_201
    s_waitcnt vmcnt(0)
    s_branch L_gw_199
L_gs_207:
    buffer_store_dword v12, v34, s[40:43], s59 offen sc1
    s_branch L_gb_208
L_gs_210:
    buffer_store_dword v27, v34, s[40:43], s67 offen sc1
    s_branch L_gb_211
L_pr_213:
    s_sub_u32 s56, s56, 1
    s_cbranch_scc1 L_done
    buffer_load_dword v12, v9, s[40:43], s57 offen sc1
    s_waitcnt vmcnt(0)
    s_branch L_pw_212
L_gr_215:
    s_sub_u32 s56, s56, 1
    s_cbranch_scc1 L_done
    s_mov_b64 s[74:75], 0
    v_max3_u32 v30, v12, v13, v14
    v_max_u32 v30, v30, v15
    v_cmp_eq_u32 vcc, -1, v30
    s_cbranch_vccz L_gn_217
    s_or_b64 s[74:75], s[74:75], vcc
    s_mov_b64 exec, vcc
    buffer_load_dwordx4 v[12:15], v5, s[40:43], s57 offen sc1
    s_mov_b64 exec, -1
L_gn_217:
    v_max3_u32 v30, v16, v17, v18
    v_max_u32 v30, v30, v19
    v_cmp_eq_u32 vcc, -1, v30
    s_cbranch_vccz L_gn_218
    s_or_b64 s[74:75], s[74:75], vcc
    s_mov_b64 exec, vcc
    buffer_load_dwordx4 v[16:19], v5, s[40:43], s58 offen sc1
    s_mov_b64 exec, -1
L_gn_218:
    v_max3_u32 v30, v20, v21, v22
    v_max_u32 v30, v30, v23
    v_cmp_eq_u32 vcc, -1, v30
    s_cbranch_vccz L_gn_219
    s_or_b64 s[74:75], s[74:75], vcc
    s_mov_b64 exec, vcc
    buffer_load_dwordx4 v[20:23], v5, s[40:43], s59 offen sc1
    s_mov_b64 exec, -1
L_gn_219:
    v_max3_u32 v30, v24, v25, v26
    v_max_u32 v30, v30, v27
    v_cmp_eq_u32 vcc, -1, v30
    s_cbranch_vccz L_gn_220
    s_or_b64 s[74:75], s[74:75], vcc
    s_mov_b64 exec, vcc
    buffer_load_dwordx4 v[24:27], v5, s[40:43], s60 offen sc1
    s_mov_b64 exec, -1
L_gn_220:
    s_cmp_eq_u64 s[74:75], 0
    s_cbranch_scc1 L_gk_216
    s_waitcnt vmcnt(0)
    s_branch L_gw_214
L_tail_end:
L_spread:
    s_add_u32 s62, s62, 671744
    s_cmp_eq_u32 s30, 5
    s_cbranch_scc0 L_skip_62
    v_mov_b64 v[12:13], -1
    v_mov_b64 v[14:15], -1
    v_lshlrev_b32 v16, 4, v0
    s_mul_i32 s57, s52, 1792
    s_add_u32 s57, s57, s62
    s_mov_b32 exec_lo, 0xffffffff
    s_mov_b32 exec_hi, 0xffff
    buffer_store_dwordx4 v[12:15], v16, s[40:43], s57 offen offset:1024 sc1
    s_mov_b64 exec, -1
    buffer_store_dwordx4 v[12:15], v16, s[40:43], s57 offen sc1
L_skip_62:
    s_cmp_eq_u32 s30, 7
    s_cbranch_scc0 L_skip_63
    v_and_b32 v60, 31, v0
    v_cmp_gt_u32 s[64:65], 20, v60
    v_min_u32 v60, 19, v60
    v_lshrrev_b32 v35, 5, v0
    v_lshlrev_b32 v35, 2, v35
    v_add_u32 v35, 159872, v35
    v_lshl_add_u32 v35, v60, 3, v35
    s_mul_i32 s66, s53, 6400
    s_add_u32 s66, s66, s62
    s_add_u32 s66, s66, 57344
    s_add_u32 s67, s66, 6144
    s_lshl_b32 s57, s54, 3
    v_lshrrev_b32 v34, 5, v0
    v_lshlrev_b32 v34, 2, v34
    v_add_u32 v34, s57, v34
    v_mov_b32 v61, 0x3f803f80
    v_cvt_pk_bf16_f32 v28, v2, v3
L_skip_63:
    s_cmp_eq_u32 s30, 7
    s_cbranch_scc0 L_skip_64
    v_lshlrev_b32 v2, 16, v28
    v_and_b32 v3, 0xffff0000, v28
    v_cndmask_b32 v28, 0, v28, s[64:65]
    v_dot2_f32_bf16 v27, v28, v61, 0
    v_dot2_f32_bf16 v62, v28, v28, 0
    s_nop 2
    v_permlane32_swap_b32 v27, v62
    v_add_f32 v27, v27, v62
    v_mov_b32 v62, v27
    s_nop 1
    v_permlane16_swap_b32 v27, v62
    v_add_f32 v27, v27, v62
    s_nop 1
    v_add_f32_dpp v27, v27, v27 row_ror:8 row_mask:0xf bank_mask:0xf
    s_nop 1
    v_add_f32_dpp v27, v27, v27 row_ror:4 row_mask:0xf bank_mask:0xf
    s_nop 1
    v_add_f32_dpp v27, v27, v27 row_ror:2 row_mask:0xf bank_mask:0xf
    s_nop 1
    v_add_f32_dpp v27, v27, v27 row_ror:1 row_mask:0xf bank_mask:0xf
    v_min_u32 v27, -2, v27
    s_mov_b32 exec_lo, 0x1
    s_mov_b32 exec_hi, 0x1
    s_cmp_eq_u32 s55, 0
    s_cbranch_scc1 L_gs_65
    buffer_store_dword v27, v34, s[40:43], s67 offen
L_gb_66:
    s_mov_b64 exec, -1
L_skip_64:
    s_cmp_lt_u32 s30, 6
    s_cbranch_scc0 L_skip_67
    s_lshr_b32 s57, s30, 1
    s_mul_i32 s57, s57, 1024
    s_and_b32 s58, s30, 1
    s_lshl_b32 s58, s58, 6
    s_add_u32 s57, s57, s58
    v_lshrrev_b32 v18, 5, v0
    v_mul_u32_u24 v18, 6144, v18
    v_bfe_u32 v60, v0, 3, 1
    v_mul_u32_u24 v60, 3072, v60
    v_add_u32 v18, v60, v18
    v_bfe_u32 v60, v0, 4, 1
    v_lshl_add_u32 v18, v60, 9, v18
    v_bfe_u32 v60, v0, 2, 1
    v_lshl_add_u32 v18, v60, 7, v18
    v_and_b32 v60, 3, v0
    v_lshl_add_u32 v18, v60, 3, v18
    v_add_u32 v18, s57, v18
    v_bfe_u32 v19, v0, 4, 1
    v_mul_u32_u24 v19, 3072, v19
    v_bfe_u32 v60, v0, 3, 1
    v_lshl_add_u32 v19, v60, 9, v19
    v_bfe_u32 v60, v0, 2, 1
    v_lshl_add_u32 v19, v60, 7, v19
    v_and_b32 v60, 3, v0
    v_lshl_add_u32 v19, v60, 3, v19
    v_add_u32 v19, s57, v19
    v_add_u32 v19, 24576, v19
    ds_read_b64_tr_b16 v[36:37], v18 offset:0
    ds_read_b64_tr_b16 v[38:39], v18 offset:256
    ds_read_b64_tr_b16 v[40:41], v18 offset:12288
    ds_read_b64_tr_b16 v[42:43], v18 offset:12544
    ds_read_b64_tr_b16 v[44:45], v19 offset:0
    ds_read_b64_tr_b16 v[46:47], v19 offset:256
    ds_read_b64_tr_b16 v[48:49], v18 offset:32
    ds_read_b64_tr_b16 v[50:51], v18 offset:288
    ds_read_b64_tr_b16 v[52:53], v18 offset:12320
    ds_read_b64_tr_b16 v[54:55], v18 offset:12576
    ds_read_b64_tr_b16 v[56:57], v19 offset:32
    ds_read_b64_tr_b16 v[58:59], v19 offset:288
    v_lshrrev_b32 v32, 4, v0
    v_lshlrev_b32 v32, 5, v32
    v_bfe_u32 v60, v0, 1, 1
    v_lshl_add_u32 v32, v60, 4, v32
    v_and_b32 v60, 1, v0
    v_mul_u32_u24 v60, 192, v60
    v_add_u32 v32, v60, v32
    v_add_u32 v32, 159872, v32
    v_lshrrev_b32 v33, 4, v0
    v_lshlrev_b32 v33, 4, v33
    v_bfe_u32 v60, v0, 1, 1
    v_lshl_add_u32 v33, v60, 3, v33
    v_and_b32 v60, 1, v0
    v_mul_u32_u24 v60, 192, v60
    v_add_u32 v33, v60, v33
    v_add_u32 v33, 160000, v33
    v_mov_b64 v[24:25], 0
    v_mov_b64 v[26:27], 0
    v_mov_b64 v[28:29], 0
    v_mov_b64 v[30:31], 0
    s_lshr_b32 s57, s54, 1
    s_lshl_b32 s57, s57, 2
    s_and_b32 s58, s54, 1
    s_add_u32 s57, s57, s58
    s_lshl_b32 s57, s57, 4
    s_lshl_b32 s58, s30, 9
    s_add_u32 s57, s57, s58
    v_bfe_u32 v34, v0, 4, 1
    v_lshlrev_b32 v34, 8, v34
    v_bfe_u32 v60, v0, 1, 1
    v_lshl_add_u32 v34, v60, 5, v34
    v_bfe_u32 v60, v0, 2, 2
    v_lshl_add_u32 v34, v60, 2, v34
    v_lshrrev_b32 v60, 5, v0
    v_mul_u32_u24 v60, 3072, v60
    v_add_u32 v34, v60, v34
    v_add_u32 v34, s57, v34
    s_mul_i32 s59, s53, 6400
    s_add_u32 s59, s59, s62
    s_add_u32 s59, s59, 57344
    s_add_u32 s60, s59, 6144
    ds_read_b128 v[12:15], v32
    ds_read_b64 v[16:17], v33
    s_waitcnt lgkmcnt(1)
    v_smfmac_f32_16x16x64_bf16 v[24:27], v[12:15], v[36:43], v1
    v_smfmac_f32_16x16x64_bf16 v[28:31], v[12:15], v[48:55], v1
    s_waitcnt lgkmcnt(0)
    v_smfmac_f32_16x16x32_bf16 v[24:27], v[16:17], v[44:47], v1
    v_smfmac_f32_16x16x32_bf16 v[28:31], v[16:17], v[56:59], v1
    s_nop 6
    v_add_f32 v12, v24, v26
    s_nop 1
    v_add_f32_dpp v12, v28, v30 quad_perm:[0,1,2,3] row_mask:0x2 bank_mask:0xf
    s_nop 1
    v_add_f32_dpp v12, v25, v27 quad_perm:[0,1,2,3] row_mask:0x4 bank_mask:0xf
    s_nop 1
    v_add_f32_dpp v12, v29, v31 quad_perm:[0,1,2,3] row_mask:0x8 bank_mask:0xf
    s_nop 1
    v_mov_b32_dpp v13, v12 row_shl:1 row_mask:0xf bank_mask:0xf bound_ctrl:0
    v_cvt_pk_bf16_f32 v12, v12, v13
    v_min_u32 v12, -2, v12
    s_mov_b32 exec_lo, 0x55555555
    s_mov_b32 exec_hi, 0x55555555
    s_cmp_eq_u32 s55, 0
    s_cbranch_scc1 L_gs_68
    buffer_store_dword v12, v34, s[40:43], s59 offen
L_gb_69:
    s_mov_b64 exec, -1
L_skip_67:
    s_waitcnt vmcnt(0)
    s_barrier
    s_cmp_eq_u32 s30, 5
    s_cbranch_scc0 L_skip_70
    s_lshl_b32 s57, s52, 2
    s_add_u32 s57, s57, s72
    v_mov_b32 v13, s63
    s_mov_b64 exec, 0x1
    buffer_store_dword v13, v0, s[40:43], s57 offen offset:128 sc1
    s_mov_b64 exec, -1
    v_and_b32 v16, 31, v0
    v_lshlrev_b32 v16, 2, v16
    buffer_load_dword v17, v16, s[40:43], s72 offen offset:128 sc1
    s_waitcnt vmcnt(0)
L_pw_71:
    v_cmp_eq_u32 vcc, -1, v17
    s_cbranch_vccnz L_pr_72
L_skip_70:
    s_barrier
    s_branch L_spread_back
L_done:
L_exit:
    s_endpgm
.section .rodata,"a"
.p2align 6
.amdhsa_kernel interleave_layers__sliding_block_cached__dense_activation_gelu__decode_kernel
  .amdhsa_next_free_vgpr 256
  .amdhsa_next_free_sgpr 102
  .amdhsa_accum_offset 256
  .amdhsa_group_segment_fixed_size 0
  .amdhsa_kernarg_size 104
  .amdhsa_user_sgpr_count 2
  .amdhsa_user_sgpr_kernarg_segment_ptr 1
  .amdhsa_system_sgpr_workgroup_id_x 1
  .amdhsa_float_denorm_mode_32 3
.end_amdhsa_kernel
```

```asm
; @launch grid=(256,1,1) block=(512,1,1) lds=160256
.amdgcn_target "amdgcn-amd-amdhsa--gfx950"
.text
.fill 64, 4, 0xbf800000
.globl interleave_layers__sliding_block_cached__dense_activation_gelu__decode_kernel
.p2align 8
.type interleave_layers__sliding_block_cached__dense_activation_gelu__decode_kernel,@function
interleave_layers__sliding_block_cached__dense_activation_gelu__decode_kernel:
    s_load_dwordx16 s[4:19], s[0:1], 0
    s_load_dwordx8 s[20:27], s[0:1], 64
    s_load_dwordx2 s[28:29], s[0:1], 96
    s_cmp_ge_u32 s2, 256
    s_cbranch_scc1 L_exit
    s_getpc_b64 s[74:75]
L_pc:
    v_lshlrev_b32 v5, 6, v0
    v_min_u32 v5, L_exit-L_pc, v5
    global_load_dword v59, v5, s[74:75]
    v_lshrrev_b32 v5, 6, v0
    v_and_b32 v0, 63, v0
    v_readfirstlane_b32 s30, v5
    s_and_b32 s31, s2, 7
    s_lshr_b32 s52, s2, 3
    s_and_b32 s53, s52, 3
    s_lshr_b32 s54, s52, 2
    s_lshl_b32 s73, s31, 2
    s_add_u32 s73, s73, s53
    s_mul_i32 s3, s54, 3
    s_add_u32 s3, s3, s53
    s_cmp_eq_u32 s53, 3
    s_cselect_b32 s3, 31, s3
    v_lshrrev_b32 v8, 5, v0
    v_lshlrev_b32 v8, 2, v8
    v_bfe_u32 v60, v0, 4, 1
    v_lshl_add_u32 v8, v60, 0, v8
    v_and_b32 v9, 7, v0
    v_xor_b32 v8, v8, v9
    v_lshrrev_b32 v10, 3, v0
    v_mul_u32_u24 v10, 384, v10
    v_lshl_add_u32 v5, v8, 4, v10
    v_xor_b32 v6, 32, v5
    v_lshrrev_b32 v8, 4, v0
    v_lshlrev_b32 v8, 1, v8
    v_xor_b32 v8, v8, v9
    v_lshl_add_u32 v7, v8, 4, v10
    v_lshrrev_b32 v2, 3, v0
    v_mul_u32_u24 v2, 12288, v2
    v_and_b32 v60, 7, v0
    v_lshl_add_u32 v2, v60, 4, v2
    s_mul_i32 s57, s73, 12582912
    s_mul_i32 s58, s54, 3072
    s_add_u32 s57, s57, s58
    s_add_u32 s57, s57, 11010048
    s_sub_u32 s58, 1572864, s58
    s_mul_i32 s59, s73, 384
    s_mul_i32 s60, s54, 983040
    s_add_u32 s59, s59, s60
    s_sub_u32 s60, 7866368, s59
    s_lshl_b32 s61, s30, 11
    s_add_u32 s61, s61, 92160
    s_mul_i32 s62, s31, 83968
    s_lshl_b32 s72, s31, 8
    s_add_u32 s72, s72, 1425408
    s_mov_b32 s56, 65536
    s_mov_b32 s55, 1
    s_getreg_b32 s63, hwreg(20, 0, 3)
    v_mov_b32 v11, 0
    v_mov_b32 v3, 0
    v_mov_b32 v21, 0
    v_mov_b32 v34, 0
    v_mov_b32 v62, 0
    v_mov_b32 v63, 0
    v_mov_b64 v[12:13], -1
    v_mov_b64 v[14:15], -1
    v_lshlrev_b32 v10, 4, v0
    s_waitcnt lgkmcnt(0)
    s_add_u32 s32, s6, s57
    s_addc_u32 s33, s7, 0
    s_mov_b32 s34, s58
    s_mov_b32 s35, 0x20000
    s_add_u32 s36, s8, s57
    s_addc_u32 s37, s9, 0
    s_mov_b32 s38, s58
    s_mov_b32 s39, 0x20000
    s_mov_b32 s40, s28
    s_mov_b32 s41, s29
    s_mov_b32 s42, 1427456
    s_mov_b32 s43, 0x20000
    s_add_u32 s44, s10, s59
    s_addc_u32 s45, s11, 0
    s_mov_b32 s46, s60
    s_mov_b32 s47, 0x20000
    s_sub_u32 s44, s44, 2048
    s_subb_u32 s45, s45, 0
    s_cmp_eq_u32 s30, 6
    s_cbranch_scc0 L_skip_1
    s_setprio 3
    s_mov_b32 s57, 0
    s_mov_b32 s58, 195584
    s_mov_b32 m0, 92160
L_dma_2:
    s_waitcnt vmcnt(23)
    buffer_load_dwordx4 v5, s[32:35], s57 offen offset:0 nt lds
    s_waitcnt vmcnt(23)
    buffer_load_dwordx4 v6, s[32:35], s58 offen offset:1024 nt lds
    s_add_u32 s57, s57, 24576
    s_add_u32 s58, s58, 24576
    s_add_u32 m0, m0, 2048
    s_cmp_lg_u32 m0, 108544
    s_cbranch_scc1 L_dma_2
    s_mov_b32 s57, 128
    s_mov_b32 s58, 195712
    s_mov_b32 m0, 108544
L_dma_3:
    s_waitcnt vmcnt(23)
    buffer_load_dwordx4 v5, s[32:35], s57 offen offset:0 nt lds
    s_waitcnt vmcnt(23)
    buffer_load_dwordx4 v6, s[32:35], s58 offen offset:1024 nt lds
    s_add_u32 s57, s57, 24576
    s_add_u32 s58, s58, 24576
    s_add_u32 m0, m0, 2048
    s_cmp_lg_u32 m0, 124928
    s_cbranch_scc1 L_dma_3
    s_mov_b32 s57, 2048
    s_mov_b32 s58, 1152
    s_mov_b32 s59, 256
    s_mov_b32 m0, 0
L_dma_4:
    s_waitcnt vmcnt(23)
    buffer_load_dwordx4 v2, s[44:47], s57 offen offset:0 nt lds
    s_waitcnt vmcnt(23)
    buffer_load_dwordx4 v2, s[44:47], s58 offen offset:1024 nt lds
    s_waitcnt vmcnt(23)
    buffer_load_dwordx4 v2, s[44:47], s59 offen offset:2048 nt lds
    s_add_u32 s57, s57, 98304
    s_add_u32 s58, s58, 98304
    s_add_u32 s59, s59, 98304
    s_add_u32 m0, m0, 3072
    s_cmp_lg_u32 m0, 15360
    s_cbranch_scc1 L_dma_4
L_skip_1:
    s_cmp_lt_u32 s3, 20
    s_cselect_b32 s57, 7864320, 0
    s_add_u32 s58, s54, 1
    s_mul_i32 s58, s58, 245760
    s_cmp_lg_u32 s53, 3
    s_cselect_b64 s[48:49], s[12:13], s[16:17]
    s_cselect_b32 s50, s57, s58
    s_mov_b32 s51, 0x20000
    s_cmp_eq_u32 s30, 5
    s_cbranch_scc0 L_skip_5
    s_cmp_eq_u32 s52, 31
    s_cbranch_scc0 L_skip_6
    s_mov_b64 exec, 0xffff
    buffer_store_dwordx4 v[12:15], v10, s[40:43], s72 offen sc1
L_skip_6:
    s_mul_i32 s58, s2, 320
    s_add_u32 s58, s58, 1343488
    s_mov_b64 exec, 0xfffff
    buffer_store_dwordx4 v[12:15], v10, s[40:43], s58 offen sc1
    s_mul_i32 s57, s52, 1792
    s_add_u32 s57, s57, s62
    s_mov_b32 exec_lo, 0xffffffff
    s_mov_b32 exec_hi, 0xffff
    buffer_store_dwordx4 v[12:15], v10, s[40:43], s57 offen offset:1024
    s_mov_b64 exec, -1
    buffer_store_dwordx4 v[12:15], v10, s[40:43], s57 offen
    v_subrev_u32 v16, 8, v0
    v_cmp_gt_u32 vcc, 40, v16
    v_mov_b32 v16, 0x3f803f80
    s_nop 0
    v_cndmask_b32 v18, 0, v16, vcc
    v_min_u32 v16, 55, v0
    v_lshlrev_b32 v16, 2, v16
    v_add_u32 v16, 160032, v16
    ds_write_b32 v16, v18
    v_and_b32 v3, 7, v0
    v_lshlrev_b32 v3, 5, v3
L_skip_5:
    s_cmp_eq_u32 s30, 7
    s_cbranch_scc0 L_skip_7
    v_and_b32 v60, 31, v0
    v_min_u32 v60, 19, v60
    s_mul_i32 s57, s54, 160
    v_lshrrev_b32 v16, 5, v0
    v_lshlrev_b32 v16, 2, v16
    v_add_u32 v16, s57, v16
    v_lshl_add_u32 v16, v60, 3, v16
    global_load_dword v28, v16, s[4:5]
    global_load_dword v4, v16, s[22:23]
L_skip_7:
    v_bfe_u32 v8, v0, 1, 3
    v_lshrrev_b32 v9, 4, v0
    v_xor_b32 v9, v8, v9
    v_bfe_u32 v8, v0, 2, 1
    v_lshlrev_b32 v8, 10, v8
    v_bfe_u32 v60, v0, 3, 1
    v_lshl_add_u32 v8, v60, 9, v8
    v_and_b32 v60, 3, v0
    v_lshl_add_u32 v8, v60, 7, v8
    v_add_u32 v8, s61, v8
    v_lshl_add_u32 v8, v9, 4, v8
    v_xor_b32 v9, 64, v8
    v_bfe_u32 v1, v0, 1, 1
    v_mul_u32_u24 v1, 43690, v1
    v_add_u32 v1, 17476, v1
    s_waitcnt vmcnt(31)
    s_barrier
    ds_read_b128 v[64:67], v8 offset:0
    ds_read_b128 v[68:71], v9 offset:0
    s_cmp_eq_u32 s30, 6
    s_cbranch_scc0 L_skip_8
    s_mov_b32 s57, 256
    s_mov_b32 s58, 195840
    s_mov_b32 m0, 124928
L_dma_9:
    s_waitcnt vmcnt(23)
    buffer_load_dwordx4 v5, s[32:35], s57 offen offset:0 nt lds
    s_waitcnt vmcnt(23)
    buffer_load_dwordx4 v6, s[32:35], s58 offen offset:1024 nt lds
    s_add_u32 s57, s57, 24576
    s_add_u32 s58, s58, 24576
    s_add_u32 m0, m0, 2048
    s_cmp_lg_u32 m0, 141312
    s_cbranch_scc1 L_dma_9
L_skip_8:
    s_waitcnt lgkmcnt(0)
    s_cmp_eq_u32 s30, 5
    s_cbranch_scc0 L_skip_10
    s_cmp_eq_u32 s52, 31
    s_cbranch_scc0 L_skip_11
    s_lshl_b32 s57, s31, 5
    v_mov_b32 v16, s57
    s_waitcnt vmcnt(3)
    s_mov_b64 exec, 0x1
    global_store_dword v16, v12, s[26:27] sc1
    s_mov_b64 exec, -1
L_skip_11:
L_skip_10:
    s_waitcnt vmcnt(31)
    s_barrier
    ds_read_b128 v[72:75], v8 offset:16384
    ds_read_b128 v[76:79], v9 offset:16384
    s_cmp_eq_u32 s30, 6
    s_cbranch_scc0 L_skip_12
    s_mov_b32 s57, 493568
    s_mov_b32 s58, 492672
    s_mov_b32 s59, 491776
    s_mov_b32 m0, 15360
L_dma_13:
    s_waitcnt vmcnt(23)
    buffer_load_dwordx4 v2, s[44:47], s57 offen offset:0 nt lds
    s_waitcnt vmcnt(23)
    buffer_load_dwordx4 v2, s[44:47], s58 offen offset:1024 nt lds
    s_waitcnt vmcnt(23)
    buffer_load_dwordx4 v2, s[44:47], s59 offen offset:2048 nt lds
    s_add_u32 s57, s57, 98304
    s_add_u32 s58, s58, 98304
    s_add_u32 s59, s59, 98304
    s_add_u32 m0, m0, 3072
    s_cmp_lg_u32 m0, 30720
    s_cbranch_scc1 L_dma_13
    s_mov_b32 s57, 393216
    s_mov_b32 s58, 588800
    s_mov_b32 m0, 141312
L_dma_14:
    s_waitcnt vmcnt(23)
    buffer_load_dwordx4 v5, s[32:35], s57 offen offset:0 nt lds
    s_waitcnt vmcnt(23)
    buffer_load_dwordx4 v6, s[32:35], s58 offen offset:1024 nt lds
    s_add_u32 s57, s57, 24576
    s_add_u32 s58, s58, 24576
    s_add_u32 m0, m0, 2048
    s_cmp_lg_u32 m0, 157696
    s_cbranch_scc1 L_dma_14
L_skip_12:
    s_waitcnt lgkmcnt(0)
    s_waitcnt vmcnt(31)
    s_barrier
    ds_read_b128 v[80:83], v8 offset:32768
    ds_read_b128 v[84:87], v9 offset:32768
    s_cmp_eq_u32 s30, 6
    s_cbranch_scc0 L_skip_15
    s_cmp_lg_u32 s53, 3
    s_cbranch_scc0 L_wb_16
    s_mul_i32 s57, s31, 983040
    s_lshl_b32 s58, s3, 6
    s_add_u32 s57, s57, s58
    v_bfe_u32 v38, v0, 4, 1
    v_lshlrev_b32 v38, 1, v38
    v_xor_b32 v38, v38, v0
    v_and_b32 v38, 3, v38
    v_lshrrev_b32 v3, 5, v0
    v_mul_u32_u24 v3, 10240, v3
    v_bfe_u32 v39, v0, 4, 1
    v_mul_u32_u24 v39, 2560, v39
    v_add_u32 v3, v39, v3
    v_bfe_u32 v39, v0, 3, 1
    v_mul_u32_u24 v39, 5120, v39
    v_add_u32 v3, v39, v3
    v_bfe_u32 v39, v0, 2, 1
    v_mul_u32_u24 v39, 20480, v39
    v_add_u32 v3, v39, v3
    v_add_u32 v3, s57, v3
    v_lshl_add_u32 v3, v38, 4, v3
    s_mov_b32 s14, 40960
    s_mov_b32 s15, 256
    s_branch L_we_17
L_wb_16:
    s_mul_i32 s57, s31, 384
    s_mul_i32 s58, s54, 245760
    s_add_u32 s57, s57, s58
    v_lshlrev_b32 v3, 4, v0
    v_add_u32 v3, s57, v3
    v_mov_b32 v38, 2688
    v_cmp_lt_u32 vcc, 23, v0
    s_nop 1
    v_cndmask_b32 v38, 0, v38, vcc
    v_add_u32 v3, v38, v3
    v_mov_b32 v38, 0x7f000000
    v_cmp_lt_u32 vcc, 47, v0
    s_nop 1
    v_cndmask_b32 v3, v3, v38, vcc
    s_mov_b32 s14, 12288
    s_mov_b32 s15, 5120
L_we_17:
    s_mul_i32 s57, s14, 0
    s_mov_b32 m0, 30720
    s_waitcnt vmcnt(23)
    buffer_load_dwordx4 v3, s[48:51], s57 offen offset:0 nt lds
    s_mul_i32 s57, s14, 0
    s_add_u32 s57, s57, s15
    s_mov_b32 m0, 30720
    s_waitcnt vmcnt(23)
    buffer_load_dwordx4 v3, s[48:51], s57 offen offset:1024 nt lds
    s_mov_b32 s57, 393344
    s_mov_b32 s58, 588928
    s_mov_b32 m0, 92160
L_dma_18:
    s_waitcnt vmcnt(23)
    buffer_load_dwordx4 v5, s[32:35], s57 offen offset:0 nt lds
    s_waitcnt vmcnt(23)
    buffer_load_dwordx4 v6, s[32:35], s58 offen offset:1024 nt lds
    s_add_u32 s57, s57, 24576
    s_add_u32 s58, s58, 24576
    s_add_u32 m0, m0, 2048
    s_cmp_lg_u32 m0, 108544
    s_cbranch_scc1 L_dma_18
    s_mul_i32 s57, s14, 1
    s_mov_b32 m0, 32768
    s_waitcnt vmcnt(23)
    buffer_load_dwordx4 v3, s[48:51], s57 offen offset:0 nt lds
    s_mul_i32 s57, s14, 1
    s_add_u32 s57, s57, s15
    s_mov_b32 m0, 32768
    s_waitcnt vmcnt(23)
    buffer_load_dwordx4 v3, s[48:51], s57 offen offset:1024 nt lds
    s_mov_b32 s57, 393472
    s_mov_b32 s58, 589056
    s_mov_b32 m0, 108544
L_dma_19:
    s_waitcnt vmcnt(23)
    buffer_load_dwordx4 v5, s[32:35], s57 offen offset:0 nt lds
    s_waitcnt vmcnt(23)
    buffer_load_dwordx4 v6, s[32:35], s58 offen offset:1024 nt lds
    s_add_u32 s57, s57, 24576
    s_add_u32 s58, s58, 24576
    s_add_u32 m0, m0, 2048
    s_cmp_lg_u32 m0, 124928
    s_cbranch_scc1 L_dma_19
L_skip_15:
    s_waitcnt lgkmcnt(0)
    s_cmp_eq_u32 s30, 7
    s_cbranch_scc0 L_skip_20
    v_and_b32 v60, 31, v0
    v_cmp_gt_u32 s[64:65], 20, v60
    v_min_u32 v60, 19, v60
    v_lshrrev_b32 v35, 5, v0
    v_lshlrev_b32 v35, 2, v35
    v_add_u32 v35, 159872, v35
    v_lshl_add_u32 v35, v60, 3, v35
    s_mul_i32 s66, s53, 6400
    s_add_u32 s66, s66, s62
    s_add_u32 s66, s66, 57344
    s_add_u32 s67, s66, 6144
    s_lshl_b32 s57, s54, 3
    v_lshrrev_b32 v34, 5, v0
    v_lshlrev_b32 v34, 2, v34
    v_add_u32 v34, s57, v34
    v_mov_b32 v61, 0x3f803f80
    s_waitcnt vmcnt(0)
    ds_write_b32 v35, v28
    s_waitcnt lgkmcnt(0)
L_skip_20:
    s_waitcnt vmcnt(36)
    s_barrier
    ds_read_b128 v[88:91], v8 offset:49152
    ds_read_b128 v[92:95], v9 offset:49152
    s_cmp_eq_u32 s30, 6
    s_cbranch_scc0 L_skip_21
    s_mul_i32 s57, s14, 2
    s_mov_b32 m0, 34816
    s_waitcnt vmcnt(23)
    buffer_load_dwordx4 v3, s[48:51], s57 offen offset:0 nt lds
    s_mul_i32 s57, s14, 2
    s_add_u32 s57, s57, s15
    s_mov_b32 m0, 34816
    s_waitcnt vmcnt(23)
    buffer_load_dwordx4 v3, s[48:51], s57 offen offset:1024 nt lds
    s_mov_b32 s57, 786432
    s_mov_b32 s58, 982016
    s_mov_b32 m0, 124928
L_dma_22:
    s_waitcnt vmcnt(23)
    buffer_load_dwordx4 v5, s[32:35], s57 offen offset:0 nt lds
    s_waitcnt vmcnt(23)
    buffer_load_dwordx4 v6, s[32:35], s58 offen offset:1024 nt lds
    s_add_u32 s57, s57, 24576
    s_add_u32 s58, s58, 24576
    s_add_u32 m0, m0, 2048
    s_cmp_lg_u32 m0, 141312
    s_cbranch_scc1 L_dma_22
L_skip_21:
    s_waitcnt lgkmcnt(0)
    s_cmp_eq_u32 s30, 3
    s_cbranch_scc0 L_skip_23
    s_mov_b64 exec, 0
    s_cbranch_execz L_pad0
L_padback:
    s_mov_b64 exec, -1
L_skip_23:
    s_cmp_eq_u32 s30, 7
    s_cbranch_scc0 L_skip_24
    v_lshlrev_b32 v2, 16, v28
    v_and_b32 v3, 0xffff0000, v28
    v_cndmask_b32 v28, 0, v28, s[64:65]
    v_dot2_f32_bf16 v27, v28, v61, 0
    v_dot2_f32_bf16 v62, v28, v28, 0
    s_nop 2
    v_permlane32_swap_b32 v27, v62
    v_add_f32 v27, v27, v62
    v_mov_b32 v62, v27
    s_nop 1
    v_permlane16_swap_b32 v27, v62
    v_add_f32 v27, v27, v62
    s_nop 1
    v_add_f32_dpp v27, v27, v27 row_ror:8 row_mask:0xf bank_mask:0xf
    s_nop 1
    v_add_f32_dpp v27, v27, v27 row_ror:4 row_mask:0xf bank_mask:0xf
    s_nop 1
    v_add_f32_dpp v27, v27, v27 row_ror:2 row_mask:0xf bank_mask:0xf
    s_nop 1
    v_add_f32_dpp v27, v27, v27 row_ror:1 row_mask:0xf bank_mask:0xf
    v_min_u32 v27, -2, v27
    s_mov_b32 exec_lo, 0x1
    s_mov_b32 exec_hi, 0x1
    s_cmp_eq_u32 s55, 0
    s_cbranch_scc1 L_gs_25
    buffer_store_dword v27, v34, s[40:43], s67 offen
L_gb_26:
    s_mov_b64 exec, -1
L_skip_24:
    s_cmp_lt_u32 s30, 6
    s_cbranch_scc0 L_skip_27
    s_lshr_b32 s57, s30, 1
    s_mul_i32 s57, s57, 1024
    s_and_b32 s58, s30, 1
    s_lshl_b32 s58, s58, 6
    s_add_u32 s57, s57, s58
    v_lshrrev_b32 v18, 5, v0
    v_mul_u32_u24 v18, 6144, v18
    v_bfe_u32 v60, v0, 3, 1
    v_mul_u32_u24 v60, 3072, v60
    v_add_u32 v18, v60, v18
    v_bfe_u32 v60, v0, 4, 1
    v_lshl_add_u32 v18, v60, 9, v18
    v_bfe_u32 v60, v0, 2, 1
    v_lshl_add_u32 v18, v60, 7, v18
    v_and_b32 v60, 3, v0
    v_lshl_add_u32 v18, v60, 3, v18
    v_add_u32 v18, s57, v18
    v_bfe_u32 v19, v0, 4, 1
    v_mul_u32_u24 v19, 3072, v19
    v_bfe_u32 v60, v0, 3, 1
    v_lshl_add_u32 v19, v60, 9, v19
    v_bfe_u32 v60, v0, 2, 1
    v_lshl_add_u32 v19, v60, 7, v19
    v_and_b32 v60, 3, v0
    v_lshl_add_u32 v19, v60, 3, v19
    v_add_u32 v19, s57, v19
    v_add_u32 v19, 24576, v19
    ds_read_b64_tr_b16 v[36:37], v18 offset:0
    ds_read_b64_tr_b16 v[38:39], v18 offset:256
    ds_read_b64_tr_b16 v[40:41], v18 offset:12288
    ds_read_b64_tr_b16 v[42:43], v18 offset:12544
    ds_read_b64_tr_b16 v[44:45], v19 offset:0
    ds_read_b64_tr_b16 v[46:47], v19 offset:256
    ds_read_b64_tr_b16 v[48:49], v18 offset:32
    ds_read_b64_tr_b16 v[50:51], v18 offset:288
    ds_read_b64_tr_b16 v[52:53], v18 offset:12320
    ds_read_b64_tr_b16 v[54:55], v18 offset:12576
    ds_read_b64_tr_b16 v[56:57], v19 offset:32
    ds_read_b64_tr_b16 v[58:59], v19 offset:288
    v_lshrrev_b32 v32, 4, v0
    v_lshlrev_b32 v32, 5, v32
    v_bfe_u32 v60, v0, 1, 1
    v_lshl_add_u32 v32, v60, 4, v32
    v_and_b32 v60, 1, v0
    v_mul_u32_u24 v60, 192, v60
    v_add_u32 v32, v60, v32
    v_add_u32 v32, 159872, v32
    v_lshrrev_b32 v33, 4, v0
    v_lshlrev_b32 v33, 4, v33
    v_bfe_u32 v60, v0, 1, 1
    v_lshl_add_u32 v33, v60, 3, v33
    v_and_b32 v60, 1, v0
    v_mul_u32_u24 v60, 192, v60
    v_add_u32 v33, v60, v33
    v_add_u32 v33, 160000, v33
    v_mov_b64 v[24:25], 0
    v_mov_b64 v[26:27], 0
    v_mov_b64 v[28:29], 0
    v_mov_b64 v[30:31], 0
    s_lshr_b32 s57, s54, 1
    s_lshl_b32 s57, s57, 2
    s_and_b32 s58, s54, 1
    s_add_u32 s57, s57, s58
    s_lshl_b32 s57, s57, 4
    s_lshl_b32 s58, s30, 9
    s_add_u32 s57, s57, s58
    v_bfe_u32 v34, v0, 4, 1
    v_lshlrev_b32 v34, 8, v34
    v_bfe_u32 v60, v0, 1, 1
    v_lshl_add_u32 v34, v60, 5, v34
    v_bfe_u32 v60, v0, 2, 2
    v_lshl_add_u32 v34, v60, 2, v34
    v_lshrrev_b32 v60, 5, v0
    v_mul_u32_u24 v60, 3072, v60
    v_add_u32 v34, v60, v34
    v_add_u32 v34, s57, v34
    s_mul_i32 s59, s53, 6400
    s_add_u32 s59, s59, s62
    s_add_u32 s59, s59, 57344
    s_add_u32 s60, s59, 6144
    ds_read_b128 v[12:15], v32
    ds_read_b64 v[16:17], v33
    s_waitcnt lgkmcnt(1)
    v_smfmac_f32_16x16x64_bf16 v[24:27], v[12:15], v[36:43], v1
    v_smfmac_f32_16x16x64_bf16 v[28:31], v[12:15], v[48:55], v1
    s_waitcnt lgkmcnt(0)
    v_smfmac_f32_16x16x32_bf16 v[24:27], v[16:17], v[44:47], v1
    v_smfmac_f32_16x16x32_bf16 v[28:31], v[16:17], v[56:59], v1
    s_nop 6
    v_add_f32 v12, v24, v26
    s_nop 1
    v_add_f32_dpp v12, v28, v30 quad_perm:[0,1,2,3] row_mask:0x2 bank_mask:0xf
    s_nop 1
    v_add_f32_dpp v12, v25, v27 quad_perm:[0,1,2,3] row_mask:0x4 bank_mask:0xf
    s_nop 1
    v_add_f32_dpp v12, v29, v31 quad_perm:[0,1,2,3] row_mask:0x8 bank_mask:0xf
    s_nop 1
    v_mov_b32_dpp v13, v12 row_shl:1 row_mask:0xf bank_mask:0xf bound_ctrl:0
    v_cvt_pk_bf16_f32 v12, v12, v13
    v_min_u32 v12, -2, v12
    s_mov_b32 exec_lo, 0x55555555
    s_mov_b32 exec_hi, 0x55555555
    s_cmp_eq_u32 s55, 0
    s_cbranch_scc1 L_gs_28
    buffer_store_dword v12, v34, s[40:43], s59 offen
L_gb_29:
    s_mov_b64 exec, -1
L_skip_27:
    s_cmp_eq_u32 s30, 5
    s_cbranch_scc0 L_skip_30
    global_load_dword v2, v3, s[26:27] sc1
L_skip_30:
    s_waitcnt vmcnt(36)
    s_barrier
    ds_read_b128 v[96:99], v8 offset:0
    ds_read_b128 v[100:103], v9 offset:0
    s_cmp_eq_u32 s30, 6
    s_cbranch_scc0 L_skip_31
    s_mul_i32 s57, s14, 3
    s_mov_b32 m0, 36864
    s_waitcnt vmcnt(23)
    buffer_load_dwordx4 v3, s[48:51], s57 offen offset:0 nt lds
    s_mul_i32 s57, s14, 3
    s_add_u32 s57, s57, s15
    s_mov_b32 m0, 36864
    s_waitcnt vmcnt(23)
    buffer_load_dwordx4 v3, s[48:51], s57 offen offset:1024 nt lds
    s_mov_b32 s57, 786560
    s_mov_b32 s58, 982144
    s_mov_b32 m0, 141312
L_dma_32:
    s_waitcnt vmcnt(23)
    buffer_load_dwordx4 v5, s[32:35], s57 offen offset:0 nt lds
    s_waitcnt vmcnt(23)
    buffer_load_dwordx4 v6, s[32:35], s58 offen offset:1024 nt lds
    s_add_u32 s57, s57, 24576
    s_add_u32 s58, s58, 24576
    s_add_u32 m0, m0, 2048
    s_cmp_lg_u32 m0, 157696
    s_cbranch_scc1 L_dma_32
L_skip_31:
    s_waitcnt lgkmcnt(0)
    s_waitcnt vmcnt(36)
    s_barrier
    ds_read_b128 v[104:107], v8 offset:16384
    ds_read_b128 v[108:111], v9 offset:16384
    s_cmp_eq_u32 s30, 6
    s_cbranch_scc0 L_skip_33
    s_mul_i32 s57, s14, 4
    s_mov_b32 m0, 38912
    s_waitcnt vmcnt(23)
    buffer_load_dwordx4 v3, s[48:51], s57 offen offset:0 nt lds
    s_mul_i32 s57, s14, 4
    s_add_u32 s57, s57, s15
    s_mov_b32 m0, 38912
    s_waitcnt vmcnt(23)
    buffer_load_dwordx4 v3, s[48:51], s57 offen offset:1024 nt lds
    s_mov_b32 s57, 786688
    s_mov_b32 s58, 982272
    s_mov_b32 m0, 92160
L_dma_34:
    s_waitcnt vmcnt(23)
    buffer_load_dwordx4 v5, s[32:35], s57 offen offset:0 nt lds
    s_waitcnt vmcnt(23)
    buffer_load_dwordx4 v6, s[32:35], s58 offen offset:1024 nt lds
    s_add_u32 s57, s57, 24576
    s_add_u32 s58, s58, 24576
    s_add_u32 m0, m0, 2048
    s_cmp_lg_u32 m0, 108544
    s_cbranch_scc1 L_dma_34
L_skip_33:
    s_waitcnt lgkmcnt(0)
    s_cmp_lg_u32 s30, 6
    s_cbranch_scc0 L_skip_35
    s_waitcnt vmcnt(0)
L_skip_35:
    s_waitcnt vmcnt(36)
    s_barrier
    ds_read_b128 v[112:115], v8 offset:32768
    ds_read_b128 v[116:119], v9 offset:32768
    s_cmp_eq_u32 s30, 6
    s_cbranch_scc0 L_skip_36
    s_mul_i32 s57, s14, 5
    s_mov_b32 m0, 40960
    s_waitcnt vmcnt(23)
    buffer_load_dwordx4 v3, s[48:51], s57 offen offset:0 nt lds
    s_mul_i32 s57, s14, 5
    s_add_u32 s57, s57, s15
    s_mov_b32 m0, 40960
    s_waitcnt vmcnt(23)
    buffer_load_dwordx4 v3, s[48:51], s57 offen offset:1024 nt lds
    s_mov_b32 s57, 1179648
    s_mov_b32 s58, 1375232
    s_mov_b32 m0, 108544
L_dma_37:
    s_waitcnt vmcnt(23)
    buffer_load_dwordx4 v5, s[32:35], s57 offen offset:0 nt lds
    s_waitcnt vmcnt(23)
    buffer_load_dwordx4 v6, s[32:35], s58 offen offset:1024 nt lds
    s_add_u32 s57, s57, 24576
    s_add_u32 s58, s58, 24576
    s_add_u32 m0, m0, 2048
    s_cmp_lg_u32 m0, 124928
    s_cbranch_scc1 L_dma_37
L_skip_36:
    s_waitcnt lgkmcnt(0)
    s_cmp_eq_u32 s30, 5
    s_cbranch_scc0 L_skip_38
L_cw_39:
    v_readlane_b32 s57, v2, s31
    s_cmp_eq_u32 s57, 0
    s_cbranch_scc1 L_cr_40
    s_lshl_b32 s57, s52, 2
    s_add_u32 s57, s57, s72
    v_mov_b32 v13, s63
    s_mov_b64 exec, 0x1
    buffer_store_dword v13, v0, s[40:43], s57 offen offset:0 sc1
    s_mov_b64 exec, -1
L_skip_38:
    s_waitcnt vmcnt(36)
    s_barrier
    ds_read_b128 v[120:123], v8 offset:49152
    ds_read_b128 v[124:127], v9 offset:49152
    s_cmp_eq_u32 s30, 6
    s_cbranch_scc0 L_skip_41
    s_mul_i32 s57, s14, 6
    s_mov_b32 m0, 43008
    s_waitcnt vmcnt(23)
    buffer_load_dwordx4 v3, s[48:51], s57 offen offset:0 nt lds
    s_mul_i32 s57, s14, 6
    s_add_u32 s57, s57, s15
    s_mov_b32 m0, 43008
    s_waitcnt vmcnt(23)
    buffer_load_dwordx4 v3, s[48:51], s57 offen offset:1024 nt lds
    s_mov_b32 s57, 1179776
    s_mov_b32 s58, 1375360
    s_mov_b32 m0, 124928
L_dma_42:
    s_waitcnt vmcnt(23)
    buffer_load_dwordx4 v5, s[32:35], s57 offen offset:0 nt lds
    s_waitcnt vmcnt(23)
    buffer_load_dwordx4 v6, s[32:35], s58 offen offset:1024 nt lds
    s_add_u32 s57, s57, 24576
    s_add_u32 s58, s58, 24576
    s_add_u32 m0, m0, 2048
    s_cmp_lg_u32 m0, 141312
    s_cbranch_scc1 L_dma_42
L_skip_41:
    s_waitcnt lgkmcnt(0)
    s_waitcnt vmcnt(36)
    s_barrier
    ds_read_b128 v[128:131], v8 offset:0
    ds_read_b128 v[132:135], v9 offset:0
    s_cmp_eq_u32 s30, 6
    s_cbranch_scc0 L_skip_43
    s_mul_i32 s57, s14, 7
    s_mov_b32 m0, 45056
    s_waitcnt vmcnt(23)
    buffer_load_dwordx4 v3, s[48:51], s57 offen offset:0 nt lds
    s_mul_i32 s57, s14, 7
    s_add_u32 s57, s57, s15
    s_mov_b32 m0, 45056
    s_waitcnt vmcnt(23)
    buffer_load_dwordx4 v3, s[48:51], s57 offen offset:1024 nt lds
    s_mov_b32 s57, 1179904
    s_mov_b32 s58, 1375488
    s_mov_b32 m0, 141312
L_dma_44:
    s_waitcnt vmcnt(23)
    buffer_load_dwordx4 v5, s[32:35], s57 offen offset:0 nt lds
    s_waitcnt vmcnt(23)
    buffer_load_dwordx4 v6, s[32:35], s58 offen offset:1024 nt lds
    s_add_u32 s57, s57, 24576
    s_add_u32 s58, s58, 24576
    s_add_u32 m0, m0, 2048
    s_cmp_lg_u32 m0, 157696
    s_cbranch_scc1 L_dma_44
L_skip_43:
    s_waitcnt lgkmcnt(0)
    s_cmp_eq_u32 s30, 5
    s_cbranch_scc0 L_skip_45
    global_load_dword v2, v3, s[26:27] sc1
L_skip_45:
    s_waitcnt vmcnt(36)
    s_barrier
    ds_read_b128 v[136:139], v8 offset:16384
    ds_read_b128 v[140:143], v9 offset:16384
    s_cmp_eq_u32 s30, 6
    s_cbranch_scc0 L_skip_46
    s_mul_i32 s57, s14, 8
    s_mov_b32 m0, 47104
    s_waitcnt vmcnt(23)
    buffer_load_dwordx4 v3, s[48:51], s57 offen offset:0 nt lds
    s_mul_i32 s57, s14, 8
    s_add_u32 s57, s57, s15
    s_mov_b32 m0, 47104
    s_waitcnt vmcnt(23)
    buffer_load_dwordx4 v3, s[48:51], s57 offen offset:1024 nt lds
    s_mov_b32 s57, 0
    s_mov_b32 s58, 392192
    s_mov_b32 m0, 92160
L_dma_47:
    s_waitcnt vmcnt(23)
    buffer_load_dwordx4 v7, s[36:39], s57 offen offset:0 nt lds
    s_waitcnt vmcnt(23)
    buffer_load_dwordx4 v7, s[36:39], s58 offen offset:1024 nt lds
    s_add_u32 s57, s57, 24576
    s_add_u32 s58, s58, 24576
    s_add_u32 m0, m0, 2048
    s_cmp_lg_u32 m0, 108544
    s_cbranch_scc1 L_dma_47
L_skip_46:
    s_waitcnt lgkmcnt(0)
    s_waitcnt vmcnt(36)
    s_barrier
    ds_read_b128 v[144:147], v8 offset:32768
    ds_read_b128 v[148:151], v9 offset:32768
    s_cmp_eq_u32 s30, 6
    s_cbranch_scc0 L_skip_48
    s_mul_i32 s57, s14, 9
    s_mov_b32 m0, 49152
    s_waitcnt vmcnt(23)
    buffer_load_dwordx4 v3, s[48:51], s57 offen offset:0 nt lds
    s_mul_i32 s57, s14, 9
    s_add_u32 s57, s57, s15
    s_mov_b32 m0, 49152
    s_waitcnt vmcnt(23)
    buffer_load_dwordx4 v3, s[48:51], s57 offen offset:1024 nt lds
    s_mov_b32 s57, 128
    s_mov_b32 s58, 392320
    s_mov_b32 m0, 108544
L_dma_49:
    s_waitcnt vmcnt(23)
    buffer_load_dwordx4 v7, s[36:39], s57 offen offset:0 nt lds
    s_waitcnt vmcnt(23)
    buffer_load_dwordx4 v7, s[36:39], s58 offen offset:1024 nt lds
    s_add_u32 s57, s57, 24576
    s_add_u32 s58, s58, 24576
    s_add_u32 m0, m0, 2048
    s_cmp_lg_u32 m0, 124928
    s_cbranch_scc1 L_dma_49
L_skip_48:
    s_waitcnt lgkmcnt(0)
    s_cmp_eq_u32 s30, 5
    s_cbranch_scc0 L_skip_50
L_cw_51:
    s_waitcnt vmcnt(0)
    v_cmp_eq_u32 vcc, 0, v2
    s_cbranch_vccnz L_cr_52
    v_lshrrev_b32 v3, 3, v0
    v_lshlrev_b32 v3, 8, v3
    v_and_b32 v2, 7, v0
    v_lshl_add_u32 v3, v2, 4, v3
    v_add_u32 v3, 1425408, v3
    buffer_load_dwordx4 v[24:27], v3, s[40:43], 0 offen sc1
L_skip_50:
    s_waitcnt vmcnt(36)
    s_barrier
    ds_read_b128 v[152:155], v8 offset:49152
    ds_read_b128 v[156:159], v9 offset:49152
    s_cmp_eq_u32 s30, 6
    s_cbranch_scc0 L_skip_53
    s_mul_i32 s57, s14, 10
    s_mov_b32 m0, 51200
    s_waitcnt vmcnt(23)
    buffer_load_dwordx4 v3, s[48:51], s57 offen offset:0 nt lds
    s_mul_i32 s57, s14, 10
    s_add_u32 s57, s57, s15
    s_mov_b32 m0, 51200
    s_waitcnt vmcnt(23)
    buffer_load_dwordx4 v3, s[48:51], s57 offen offset:1024 nt lds
    s_mov_b32 s57, 256
    s_mov_b32 s58, 392448
    s_mov_b32 m0, 124928
L_dma_54:
    s_nop 0
    buffer_load_dwordx4 v7, s[36:39], s57 offen offset:0 nt lds
    buffer_load_dwordx4 v7, s[36:39], s58 offen offset:1024 nt lds
    s_add_u32 s57, s57, 24576
    s_add_u32 s58, s58, 24576
    s_add_u32 m0, m0, 2048
    s_cmp_lg_u32 m0, 141312
    s_cbranch_scc1 L_dma_54
L_skip_53:
    s_waitcnt lgkmcnt(0)
    v_lshrrev_b32 v8, 2, v0
    v_lshlrev_b32 v8, 7, v8
    v_bfe_u32 v60, v0, 3, 2
    v_lshl_add_u32 v8, v60, 5, v8
    v_and_b32 v60, 3, v0
    v_lshl_add_u32 v8, v60, 3, v8
    v_add_u32 v8, s61, v8
    v_xor_b32 v9, 32, v8
    v_xor_b32 v10, 64, v8
    v_xor_b32 v11, 96, v8
    s_waitcnt vmcnt(36)
    s_barrier
    ds_read_b64_tr_b16 v[160:161], v8 offset:0
    ds_read_b64_tr_b16 v[168:169], v9 offset:0
    ds_read_b64_tr_b16 v[176:177], v10 offset:0
    ds_read_b64_tr_b16 v[184:185], v11 offset:0
    s_cmp_eq_u32 s30, 6
    s_cbranch_scc0 L_skip_55
    s_mul_i32 s57, s14, 11
    s_mov_b32 m0, 53248
    s_nop 0
    buffer_load_dwordx4 v3, s[48:51], s57 offen offset:0 nt lds
    s_mul_i32 s57, s14, 11
    s_add_u32 s57, s57, s15
    s_mov_b32 m0, 53248
    s_nop 0
    buffer_load_dwordx4 v3, s[48:51], s57 offen offset:1024 nt lds
    s_mov_b32 s57, 196608
    s_mov_b32 s58, 588800
    s_mov_b32 m0, 141312
L_dma_56:
    s_nop 0
    buffer_load_dwordx4 v7, s[36:39], s57 offen offset:0 nt lds
    buffer_load_dwordx4 v7, s[36:39], s58 offen offset:1024 nt lds
    s_add_u32 s57, s57, 24576
    s_add_u32 s58, s58, 24576
    s_add_u32 m0, m0, 2048
    s_cmp_lg_u32 m0, 157696
    s_cbranch_scc1 L_dma_56
L_skip_55:
    s_waitcnt lgkmcnt(0)
    s_cmp_eq_u32 s30, 5
    s_cbranch_scc0 L_skip_57
    s_waitcnt vmcnt(0)
L_pw_58:
    v_max3_u32 v28, v24, v25, v26
    v_max_u32 v28, v28, v27
    v_cmp_eq_u32 vcc, -1, v28
    s_cbranch_vccnz L_pr_59
    v_xor_b32 v24, s63, v24
    v_xor_b32 v25, s63, v25
    v_xor_b32 v26, s63, v26
    v_xor_b32 v27, s63, v27
    v_or3_b32 v24, v24, v25, v26
    v_or_b32 v24, v24, v27
    v_cmp_ne_u32 vcc, 0, v24
    s_lshl_b32 s57, s31, 3
    s_lshr_b64 vcc, vcc, s57
    s_and_b32 s57, vcc_lo, 0xff
    s_cselect_b32 s57, 0, 1
    v_mov_b32 v37, 159808
    v_mov_b32 v38, s57
    ds_write_b32 v37, v38
    s_waitcnt lgkmcnt(0)
L_skip_57:
    s_waitcnt vmcnt(36)
    s_barrier
    ds_read_b64_tr_b16 v[192:193], v8 offset:16384
    ds_read_b64_tr_b16 v[200:201], v9 offset:16384
    ds_read_b64_tr_b16 v[208:209], v10 offset:16384
    ds_read_b64_tr_b16 v[216:217], v11 offset:16384
    s_cmp_eq_u32 s30, 6
    s_cbranch_scc0 L_skip_60
    s_mov_b32 s57, 196736
    s_mov_b32 s58, 588928
    s_mov_b32 m0, 92160
L_dma_61:
    s_nop 0
    buffer_load_dwordx4 v7, s[36:39], s57 offen offset:0 nt lds
    buffer_load_dwordx4 v7, s[36:39], s58 offen offset:1024 nt lds
    s_add_u32 s57, s57, 24576
    s_add_u32 s58, s58, 24576
    s_add_u32 m0, m0, 2048
    s_cmp_lg_u32 m0, 108544
    s_cbranch_scc1 L_dma_61
L_skip_60:
    s_waitcnt lgkmcnt(0)
    v_mov_b32 v41, 159808
    ds_read_b32 v42, v41
    s_waitcnt lgkmcnt(0)
    v_readfirstlane_b32 s55, v42
    s_cmp_eq_u32 s55, 0
    s_cbranch_scc1 L_spread
L_spread_back:
    s_cmp_eq_u32 s30, 4
    s_cbranch_scc0 L_skip_73
    s_mul_i32 s59, s53, 6400
    s_add_u32 s59, s59, s62
    s_add_u32 s59, s59, 57344
    s_add_u32 s60, s59, 6144
    v_lshlrev_b32 v16, 4, v0
    s_add_u32 s60, s59, 3072
    s_mov_b32 m0, 79872
    s_nop 0
    buffer_load_dwordx4 v16, s[40:43], s59 offen offset:0 sc1 nt lds
    buffer_load_dwordx4 v16, s[40:43], s59 offen offset:1024 sc1 nt lds
    buffer_load_dwordx4 v16, s[40:43], s59 offen offset:2048 sc1 nt lds
    s_mov_b32 m0, 82944
    s_nop 0
    buffer_load_dwordx4 v16, s[40:43], s60 offen offset:0 sc1 nt lds
    buffer_load_dwordx4 v16, s[40:43], s60 offen offset:1024 sc1 nt lds
    buffer_load_dwordx4 v16, s[40:43], s60 offen offset:2048 sc1 nt lds
    s_mov_b64 exec, 0xf
    buffer_load_dwordx4 v16, s[40:43], s60 offen offset:3072 sc1 nt lds
    s_mov_b64 exec, -1
L_skip_73:
    s_waitcnt vmcnt(34)
    s_barrier
    ds_read_b64_tr_b16 v[224:225], v8 offset:32768
    ds_read_b64_tr_b16 v[232:233], v9 offset:32768
    ds_read_b64_tr_b16 v[240:241], v10 offset:32768
    ds_read_b64_tr_b16 v[248:249], v11 offset:32768
    s_cmp_eq_u32 s30, 6
    s_cbranch_scc0 L_skip_74
    s_mov_b32 s57, 196864
    s_mov_b32 s58, 589056
    s_mov_b32 m0, 108544
L_dma_75:
    s_nop 0
    buffer_load_dwordx4 v7, s[36:39], s57 offen offset:0 nt lds
    buffer_load_dwordx4 v7, s[36:39], s58 offen offset:1024 nt lds
    s_add_u32 s57, s57, 24576
    s_add_u32 s58, s58, 24576
    s_add_u32 m0, m0, 2048
    s_cmp_lg_u32 m0, 124928
    s_cbranch_scc1 L_dma_75
L_skip_74:
    s_waitcnt lgkmcnt(0)
    s_waitcnt vmcnt(32)
    s_barrier
    ds_read_b64_tr_b16 v[162:163], v8 offset:49152
    ds_read_b64_tr_b16 v[170:171], v9 offset:49152
    ds_read_b64_tr_b16 v[178:179], v10 offset:49152
    ds_read_b64_tr_b16 v[186:187], v11 offset:49152
    s_cmp_eq_u32 s30, 6
    s_cbranch_scc0 L_skip_76
    s_mov_b32 s57, 786432
    s_mov_b32 s58, 1178624
    s_mov_b32 m0, 124928
L_dma_77:
    s_nop 0
    buffer_load_dwordx4 v7, s[36:39], s57 offen offset:0 nt lds
    buffer_load_dwordx4 v7, s[36:39], s58 offen offset:1024 nt lds
    s_add_u32 s57, s57, 24576
    s_add_u32 s58, s58, 24576
    s_add_u32 m0, m0, 2048
    s_cmp_lg_u32 m0, 141312
    s_cbranch_scc1 L_dma_77
L_skip_76:
    s_waitcnt lgkmcnt(0)
    s_cmp_eq_u32 s30, 4
    s_cbranch_scc0 L_skip_78
    s_waitcnt vmcnt(0)
L_skip_78:
    s_waitcnt vmcnt(32)
    s_barrier
    ds_read_b64_tr_b16 v[194:195], v8 offset:0
    ds_read_b64_tr_b16 v[202:203], v9 offset:0
    ds_read_b64_tr_b16 v[210:211], v10 offset:0
    ds_read_b64_tr_b16 v[218:219], v11 offset:0
    s_cmp_eq_u32 s30, 6
    s_cbranch_scc0 L_skip_79
    s_mov_b32 s57, 786560
    s_mov_b32 s58, 1178752
    s_mov_b32 m0, 141312
L_dma_80:
    s_nop 0
    buffer_load_dwordx4 v7, s[36:39], s57 offen offset:0 nt lds
    buffer_load_dwordx4 v7, s[36:39], s58 offen offset:1024 nt lds
    s_add_u32 s57, s57, 24576
    s_add_u32 s58, s58, 24576
    s_add_u32 m0, m0, 2048
    s_cmp_lg_u32 m0, 157696
    s_cbranch_scc1 L_dma_80
L_skip_79:
    s_waitcnt lgkmcnt(0)
    v_lshlrev_b32 v40, 4, v0
    v_add_u32 v40, 79872, v40
    ds_read_b128 v[12:15], v40 offset:3072
    ds_read_b128 v[16:19], v40 offset:4096
    ds_read_b128 v[20:23], v40 offset:5120
    v_mov_b64 v[24:25], 0
    v_mov_b64 v[26:27], 0
    v_mov_b64 v[28:29], 0
    v_mov_b64 v[30:31], 0
    v_mov_b64 v[32:33], 0
    v_mov_b64 v[34:35], 0
    v_mov_b64 v[36:37], 0
    v_mov_b64 v[38:39], 0
    s_waitcnt lgkmcnt(0)
    v_smfmac_f32_16x16x64_bf16 v[24:27], v[12:15], v[64:71], v1
    v_smfmac_f32_16x16x64_bf16 v[24:27], v[16:19], v[72:79], v1
    v_smfmac_f32_16x16x64_bf16 v[24:27], v[20:23], v[80:87], v1
    v_smfmac_f32_16x16x64_bf16 v[32:35], v[12:15], v[112:119], v1
    v_smfmac_f32_16x16x64_bf16 v[32:35], v[16:19], v[120:127], v1
    v_smfmac_f32_16x16x64_bf16 v[32:35], v[20:23], v[128:135], v1
    v_smfmac_f32_16x16x64_bf16 v[28:31], v[12:15], v[88:95], v1
    v_smfmac_f32_16x16x64_bf16 v[28:31], v[16:19], v[96:103], v1
    v_smfmac_f32_16x16x64_bf16 v[28:31], v[20:23], v[104:111], v1
    v_smfmac_f32_16x16x64_bf16 v[36:39], v[12:15], v[136:143], v1
    s_nop 0
    v_pk_add_f32 v[24:25], v[24:25], v[26:27]
    v_add_f32 v24, v24, v25
    v_smfmac_f32_16x16x64_bf16 v[36:39], v[16:19], v[144:151], v1
    v_pk_add_f32 v[32:33], v[32:33], v[34:35]
    v_add_f32 v32, v32, v33
    v_smfmac_f32_16x16x64_bf16 v[36:39], v[20:23], v[152:159], v1
    s_nop 0
    v_permlane32_swap_b32 v24, v32
    v_add_f32 v24, v24, v32
    v_pk_add_f32 v[28:29], v[28:29], v[30:31]
    v_add_f32 v28, v28, v29
    s_nop 2
    v_pk_add_f32 v[36:37], v[36:37], v[38:39]
    v_add_f32 v36, v36, v37
    s_nop 1
    v_permlane32_swap_b32 v28, v36
    v_add_f32 v28, v28, v36
    s_nop 1
    v_permlane16_swap_b32 v24, v28
    v_add_f32 v6, v24, v28
    s_waitcnt vmcnt(32)
    s_barrier
    ds_read_b64_tr_b16 v[226:227], v8 offset:16384
    ds_read_b64_tr_b16 v[234:235], v9 offset:16384
    ds_read_b64_tr_b16 v[242:243], v10 offset:16384
    ds_read_b64_tr_b16 v[250:251], v11 offset:16384
    s_cmp_eq_u32 s30, 6
    s_cbranch_scc0 L_skip_81
    s_mov_b32 s57, 786688
    s_mov_b32 s58, 1178880
    s_mov_b32 m0, 92160
L_dma_82:
    s_nop 0
    buffer_load_dwordx4 v7, s[36:39], s57 offen offset:0 nt lds
    buffer_load_dwordx4 v7, s[36:39], s58 offen offset:1024 nt lds
    s_add_u32 s57, s57, 24576
    s_add_u32 s58, s58, 24576
    s_add_u32 m0, m0, 2048
    s_cmp_lg_u32 m0, 108544
    s_cbranch_scc1 L_dma_82
L_skip_81:
    s_waitcnt lgkmcnt(0)
    v_and_b32 v41, 7, v0
    v_lshlrev_b32 v41, 3, v41
    v_add_u32 v41, 86016, v41
    ds_read_b128 v[12:15], v40 offset:0
    ds_read_b128 v[16:19], v40 offset:1024
    ds_read_b128 v[20:23], v40 offset:2048
    ds_read_b64 v[52:53], v41
    v_mov_b64 v[24:25], 0
    v_mov_b64 v[26:27], 0
    v_mov_b64 v[28:29], 0
    v_mov_b64 v[30:31], 0
    v_mov_b64 v[32:33], 0
    v_mov_b64 v[34:35], 0
    v_mov_b64 v[36:37], 0
    v_mov_b64 v[38:39], 0
    s_waitcnt lgkmcnt(0)
    v_smfmac_f32_16x16x64_bf16 v[24:27], v[12:15], v[64:71], v1
    v_add_f32_dpp v52, v52, v52 row_ror:4 row_mask:0xf bank_mask:0xf
    v_add_f32_dpp v53, v53, v53 row_ror:4 row_mask:0xf bank_mask:0xf
    v_smfmac_f32_16x16x64_bf16 v[24:27], v[16:19], v[72:79], v1
    v_add_f32_dpp v52, v52, v52 row_ror:2 row_mask:0xf bank_mask:0xf
    v_add_f32_dpp v53, v53, v53 row_ror:2 row_mask:0xf bank_mask:0xf
    v_smfmac_f32_16x16x64_bf16 v[24:27], v[20:23], v[80:87], v1
    v_add_f32_dpp v52, v52, v52 row_ror:1 row_mask:0xf bank_mask:0xf
    v_add_f32_dpp v53, v53, v53 row_ror:1 row_mask:0xf bank_mask:0xf
    v_smfmac_f32_16x16x64_bf16 v[32:35], v[12:15], v[112:119], v1
    v_mul_f32 v52, 0x3acccccd, v52
    v_mul_f32 v53, 0x3acccccd, v53
    v_smfmac_f32_16x16x64_bf16 v[32:35], v[16:19], v[120:127], v1
    v_fma_f32 v53, -v52, v52, v53
    v_max_f32 v53, 0, v53
    v_smfmac_f32_16x16x64_bf16 v[32:35], v[20:23], v[128:135], v1
    v_add_f32 v53, 0x3727c5ac, v53
    v_rsq_f32 v53, v53
    v_smfmac_f32_16x16x64_bf16 v[28:31], v[12:15], v[88:95], v1
    s_mov_b32 vcc_lo, 0x55555555
    v_mul_f32 v53, 0x3dd53b95, v53
    v_smfmac_f32_16x16x64_bf16 v[28:31], v[16:19], v[96:103], v1
    s_mov_b32 vcc_hi, 0x55555555
    v_smfmac_f32_16x16x64_bf16 v[28:31], v[20:23], v[104:111], v1
    v_smfmac_f32_16x16x64_bf16 v[36:39], v[12:15], v[136:143], v1
    v_pk_add_f32 v[24:25], v[24:25], v[26:27]
    v_add_f32 v24, v24, v25
    v_smfmac_f32_16x16x64_bf16 v[36:39], v[16:19], v[144:151], v1
    v_pk_add_f32 v[32:33], v[32:33], v[34:35]
    v_add_f32 v32, v32, v33
    v_smfmac_f32_16x16x64_bf16 v[36:39], v[20:23], v[152:159], v1
    s_nop 0
    v_permlane32_swap_b32 v24, v32
    v_add_f32 v24, v24, v32
    v_pk_add_f32 v[28:29], v[28:29], v[30:31]
    v_add_f32 v28, v28, v29
    s_nop 2
    v_pk_add_f32 v[36:37], v[36:37], v[38:39]
    v_add_f32 v36, v36, v37
    s_nop 1
    v_permlane32_swap_b32 v28, v36
    v_add_f32 v28, v28, v36
    s_nop 1
    v_permlane16_swap_b32 v24, v28
    v_add_f32 v24, v24, v28
    v_fma_f32 v24, -v52, v6, v24
    s_nop 1
    v_max_f32_dpp v21, v24, v24 row_ror:8 row_mask:0xf bank_mask:0xf
    s_nop 1
    v_max_f32_dpp v21, v21, v21 row_ror:4 row_mask:0xf bank_mask:0xf
    s_nop 1
    v_max_f32_dpp v21, v21, v21 row_ror:2 row_mask:0xf bank_mask:0xf
    s_nop 1
    v_max_f32_dpp v21, v21, v21 row_ror:1 row_mask:0xf bank_mask:0xf
    s_nop 1
    v_max_f32_dpp v21, v21, v21 row_bcast:15 row_mask:0xa bank_mask:0xf
    s_nop 1
    v_max_f32_dpp v21, v21, v21 row_bcast:31 row_mask:0xc bank_mask:0xf
    s_nop 0
    v_readlane_b32 s57, v21, 63
    s_nop 1
    v_subrev_f32 v24, s57, v24
    v_mul_f32 v24, v24, v53
    v_exp_f32 v22, v24
    v_mul_f32 v20, s57, v53
    s_nop 0
    v_mov_b32_dpp v23, v22 row_shl:1 row_mask:0xf bank_mask:0xf bound_ctrl:0
    v_cvt_pk_bf16_f32 v23, v22, v23
    v_cndmask_b32 v12, 0, v23, vcc
    v_mov_b32 v21, v22
    s_nop 0
    v_mov_b32_dpp v13, v12 row_shl:4 row_mask:0xf bank_mask:0xf bound_ctrl:0
    v_mov_b32_dpp v14, v12 row_shl:8 row_mask:0xf bank_mask:0xf bound_ctrl:0
    v_mov_b32_dpp v15, v12 row_shl:12 row_mask:0xf bank_mask:0xf bound_ctrl:0
    v_mov_b64 v[40:41], 0
    v_mov_b64 v[42:43], 0
    v_mov_b64 v[44:45], 0
    v_mov_b64 v[46:47], 0
    v_mov_b64 v[48:49], 0
    v_mov_b64 v[50:51], 0
    v_mov_b64 v[52:53], 0
    v_mov_b64 v[54:55], 0
    v_mov_b64 v[56:57], 0
    v_mov_b64 v[58:59], 0
    v_mov_b64 v[60:61], 0
    v_mov_b64 v[62:63], 0
    s_lshl_b32 s58, s30, 3
    s_add_u32 s58, s58, 159744
    v_mov_b32 v37, s58
    v_mov_b32_dpp v16, v12 row_shr:1 row_mask:0xf bank_mask:0xf bound_ctrl:0
    v_mov_b32_dpp v17, v12 row_shl:3 row_mask:0xf bank_mask:0xf bound_ctrl:0
    v_mov_b32_dpp v18, v12 row_shl:7 row_mask:0xf bank_mask:0xf bound_ctrl:0
    v_mov_b32_dpp v19, v12 row_shl:11 row_mask:0xf bank_mask:0xf bound_ctrl:0
    v_permlane32_swap_b32 v21, v22
    v_add_f32 v21, v21, v22
    v_mov_b32 v22, v21
    s_nop 1
    v_permlane16_swap_b32 v21, v22
    v_add_f32 v21, v21, v22
    s_nop 1
    v_add_f32_dpp v21, v21, v21 row_ror:8 row_mask:0xf bank_mask:0xf
    s_nop 1
    v_add_f32_dpp v21, v21, v21 row_ror:4 row_mask:0xf bank_mask:0xf
    s_nop 1
    v_add_f32_dpp v21, v21, v21 row_ror:2 row_mask:0xf bank_mask:0xf
    s_nop 1
    v_add_f32_dpp v21, v21, v21 row_ror:1 row_mask:0xf bank_mask:0xf
    ds_write_b64 v37, v[20:21]
    v_and_b32 v36, 15, v0
    v_lshlrev_b32 v36, 4, v36
    v_add_u32 v36, s61, v36
    v_add_u32 v36, 32768, v36
    s_waitcnt lgkmcnt(0)
    s_waitcnt vmcnt(32)
    s_barrier
    ds_read_b64_tr_b16 v[164:165], v8 offset:32768
    ds_read_b64_tr_b16 v[172:173], v9 offset:32768
    ds_read_b64_tr_b16 v[180:181], v10 offset:32768
    ds_read_b64_tr_b16 v[188:189], v11 offset:32768
    s_cmp_eq_u32 s30, 6
    s_cbranch_scc0 L_skip_83
    s_mov_b32 s57, 983040
    s_mov_b32 s58, 1375232
    s_mov_b32 m0, 108544
L_dma_84:
    s_nop 0
    buffer_load_dwordx4 v7, s[36:39], s57 offen offset:0 nt lds
    buffer_load_dwordx4 v7, s[36:39], s58 offen offset:1024 nt lds
    s_add_u32 s57, s57, 24576
    s_add_u32 s58, s58, 24576
    s_add_u32 m0, m0, 2048
    s_cmp_lg_u32 m0, 124928
    s_cbranch_scc1 L_dma_84
L_skip_83:
    s_waitcnt lgkmcnt(0)
    s_cmp_lt_u32 s30, 2
    s_cbranch_scc0 L_skip_85
    v_and_b32 v37, 7, v0
    v_lshlrev_b32 v37, 3, v37
    v_add_u32 v37, 159744, v37
    ds_read_b64 v[38:39], v37
    s_lshl_b32 s57, s53, 3
    s_add_u32 s57, s57, s54
    s_lshl_b32 s57, s57, 2
    v_mov_b32 v23, s57
    s_add_u32 s57, s62, 55808
    s_waitcnt lgkmcnt(0)
    v_max_f32_dpp v37, v38, v38 row_ror:4 row_mask:0xf bank_mask:0xf
    s_nop 1
    v_max_f32_dpp v37, v37, v37 row_ror:2 row_mask:0xf bank_mask:0xf
    s_nop 1
    v_max_f32_dpp v37, v37, v37 row_ror:1 row_mask:0xf bank_mask:0xf
    v_sub_f32 v38, v38, v37
    v_exp_f32 v38, v38
    s_nop 0
    v_mul_f32 v39, v38, v39
    s_nop 1
    v_add_f32_dpp v39, v39, v39 row_ror:4 row_mask:0xf bank_mask:0xf
    s_nop 1
    v_add_f32_dpp v39, v39, v39 row_ror:2 row_mask:0xf bank_mask:0xf
    s_nop 1
    v_add_f32_dpp v39, v39, v39 row_ror:1 row_mask:0xf bank_mask:0xf
    v_log_f32 v22, v39
    v_rcp_f32 v39, v39
    v_add_f32 v22, v22, v37
    v_min_u32 v22, -2, v22
    v_mul_f32 v38, v38, v39
    s_cmp_eq_u32 s30, 0
    s_cbranch_scc0 L_skip_86
    s_mov_b64 exec, 0x1
    s_cmp_eq_u32 s55, 0
    s_cbranch_scc1 L_gs_87
    buffer_store_dword v22, v23, s[40:43], s57 offen
L_gb_88:
    s_mov_b64 exec, -1
L_skip_86:
    v_readlane_b32 s64, v38, 0
    v_readlane_b32 s65, v38, 1
    v_readlane_b32 s66, v38, 2
    v_readlane_b32 s67, v38, 3
    v_readlane_b32 s68, v38, 4
    v_readlane_b32 s69, v38, 5
    v_readlane_b32 s70, v38, 6
    v_readlane_b32 s71, v38, 7
    s_mul_i32 s57, s30, 48
    v_add_u32 v38, s57, v0
    v_bfe_u32 v20, v38, 5, 2
    v_lshlrev_b32 v20, 8, v20
    v_and_b32 v39, 15, v38
    v_lshl_add_u32 v20, v39, 4, v20
    v_bfe_u32 v39, v38, 4, 1
    v_lshl_add_u32 v20, v39, 3, v20
    v_add_u32 v20, 124928, v20
    s_lshr_b32 s57, s54, 1
    s_lshl_b32 s57, s57, 2
    s_and_b32 s58, s54, 1
    s_add_u32 s57, s57, s58
    s_lshl_b32 s58, s57, 4
    s_lshl_b32 s57, s57, 3
    v_bfe_u32 v21, v0, 3, 2
    v_lshlrev_b32 v21, 8, v21
    v_bfe_u32 v39, v0, 2, 1
    v_lshl_add_u32 v21, v39, 5, v21
    v_and_b32 v39, 3, v0
    v_lshl_add_u32 v21, v39, 2, v21
    v_add_u32 v21, s58, v21
    v_bfe_u32 v38, v0, 3, 1
    v_lshlrev_b32 v38, 8, v38
    v_bfe_u32 v39, v0, 1, 1
    v_lshl_add_u32 v38, v39, 7, v38
    v_bfe_u32 v39, v0, 2, 1
    v_lshl_add_u32 v38, v39, 4, v38
    v_and_b32 v39, 1, v0
    v_lshl_add_u32 v38, v39, 2, v38
    v_add_u32 v38, s57, v38
    v_add_u32 v38, 1024, v38
    v_cmp_gt_u32 vcc, 32, v0
    s_nop 1
    v_cndmask_b32 v21, v38, v21, vcc
    s_lshl_b32 s57, s53, 1
    s_add_u32 s57, s57, s30
    s_mul_i32 s57, s57, 1536
    s_add_u32 s57, s57, s62
    s_add_u32 s57, s57, 0
    v_add_u32 v21, s57, v21
L_skip_85:
    s_waitcnt vmcnt(32)
    s_barrier
    ds_read_b64_tr_b16 v[196:197], v8 offset:49152
    ds_read_b64_tr_b16 v[204:205], v9 offset:49152
    ds_read_b64_tr_b16 v[212:213], v10 offset:49152
    ds_read_b64_tr_b16 v[220:221], v11 offset:49152
    s_cmp_eq_u32 s30, 6
    s_cbranch_scc0 L_skip_89
    s_mov_b32 s57, 983168
    s_mov_b32 s58, 1375360
    s_mov_b32 m0, 124928
L_dma_90:
    s_nop 0
    buffer_load_dwordx4 v7, s[36:39], s57 offen offset:0 nt lds
    buffer_load_dwordx4 v7, s[36:39], s58 offen offset:1024 nt lds
    s_add_u32 s57, s57, 24576
    s_add_u32 s58, s58, 24576
    s_add_u32 m0, m0, 2048
    s_cmp_lg_u32 m0, 141312
    s_cbranch_scc1 L_dma_90
L_skip_89:
    s_waitcnt lgkmcnt(0)
    s_cmp_eq_u32 s30, 2
    s_cbranch_scc0 L_skip_91
    s_mul_i32 s57, s52, 1792
    s_add_u32 s57, s57, s62
    v_min_u32 v37, 13, v0
    v_lshlrev_b32 v37, 7, v37
    buffer_load_dword v37, v37, s[40:43], s57 offen sc1 nt
L_skip_91:
    s_waitcnt vmcnt(32)
    s_barrier
    ds_read_b64_tr_b16 v[228:229], v8 offset:0
    ds_read_b64_tr_b16 v[236:237], v9 offset:0
    ds_read_b64_tr_b16 v[244:245], v10 offset:0
    ds_read_b64_tr_b16 v[252:253], v11 offset:0
    s_cmp_eq_u32 s30, 6
    s_cbranch_scc0 L_skip_92
    s_mov_b32 s57, 983296
    s_mov_b32 s58, 1375488
    s_mov_b32 m0, 141312
L_dma_93:
    s_nop 0
    buffer_load_dwordx4 v7, s[36:39], s57 offen offset:0 nt lds
    buffer_load_dwordx4 v7, s[36:39], s58 offen offset:1024 nt lds
    s_add_u32 s57, s57, 24576
    s_add_u32 s58, s58, 24576
    s_add_u32 m0, m0, 2048
    s_cmp_lg_u32 m0, 157696
    s_cbranch_scc1 L_dma_93
L_skip_92:
    s_waitcnt lgkmcnt(0)
    s_branch L_tail
.p2align 10
L_tail:
L_pad0:
    s_cbranch_execz L_pad1
    s_waitcnt vmcnt(32)
    s_barrier
    ds_read_b64_tr_b16 v[166:167], v8 offset:16384
    ds_read_b64_tr_b16 v[174:175], v9 offset:16384
    ds_read_b64_tr_b16 v[182:183], v10 offset:16384
    ds_read_b64_tr_b16 v[190:191], v11 offset:16384
    s_waitcnt lgkmcnt(0)
    v_smfmac_f32_16x16x64_bf16 v[40:43], v[12:15], v[160:167], v1
    v_smfmac_f32_16x16x64_bf16 v[40:43], v[16:19], v[168:175], v1
    v_smfmac_f32_16x16x64_bf16 v[44:47], v[12:15], v[176:183], v1
    v_smfmac_f32_16x16x64_bf16 v[44:47], v[16:19], v[184:191], v1
    s_cmp_eq_u32 s30, 6
    s_cbranch_scc0 L_skip_94
    s_mul_i32 s57, s14, 12
    s_add_u32 s58, s57, s15
    s_mov_b32 m0, 55296
L_dma_95:
    s_nop 0
    buffer_load_dwordx4 v3, s[48:51], s57 offen offset:0 nt lds
    buffer_load_dwordx4 v3, s[48:51], s58 offen offset:1024 nt lds
    s_add_u32 s57, s57, s14
    s_add_u32 s58, s58, s14
    s_add_u32 m0, m0, 2048
    s_cmp_lg_u32 m0, 67584
    s_cbranch_scc1 L_dma_95
    s_mul_i32 s57, s14, 18
    s_add_u32 s58, s57, s15
    s_mov_b32 m0, 67584
L_dma_96:
    s_nop 0
    buffer_load_dwordx4 v3, s[48:51], s57 offen offset:0 nt lds
    buffer_load_dwordx4 v3, s[48:51], s58 offen offset:1024 nt lds
    s_add_u32 s57, s57, s14
    s_add_u32 s58, s58, s14
    s_add_u32 m0, m0, 2048
    s_cmp_lg_u32 m0, 79872
    s_cbranch_scc1 L_dma_96
L_skip_94:
    s_nop 3
    v_pk_add_f32 v[24:25], v[40:41], v[42:43]
    s_nop 0
    v_pk_add_f32 v[26:27], v[44:45], v[46:47]
    s_waitcnt vmcnt(40)
    s_barrier
    ds_read_b64_tr_b16 v[198:199], v8 offset:32768
    ds_read_b64_tr_b16 v[206:207], v9 offset:32768
    ds_read_b64_tr_b16 v[214:215], v10 offset:32768
    ds_read_b64_tr_b16 v[222:223], v11 offset:32768
    s_waitcnt lgkmcnt(0)
    v_smfmac_f32_16x16x64_bf16 v[48:51], v[12:15], v[192:199], v1
    v_smfmac_f32_16x16x64_bf16 v[48:51], v[16:19], v[200:207], v1
    v_smfmac_f32_16x16x64_bf16 v[52:55], v[12:15], v[208:215], v1
    v_smfmac_f32_16x16x64_bf16 v[52:55], v[16:19], v[216:223], v1
    s_nop 5
    v_pk_add_f32 v[28:29], v[48:49], v[50:51]
    s_nop 0
    v_pk_add_f32 v[30:31], v[52:53], v[54:55]
    s_waitcnt vmcnt(24)
    s_barrier
    ds_read_b64_tr_b16 v[230:231], v8 offset:49152
    ds_read_b64_tr_b16 v[238:239], v9 offset:49152
    ds_read_b64_tr_b16 v[246:247], v10 offset:49152
    ds_read_b64_tr_b16 v[254:255], v11 offset:49152
    s_waitcnt lgkmcnt(0)
    v_smfmac_f32_16x16x64_bf16 v[56:59], v[12:15], v[224:231], v1
    v_smfmac_f32_16x16x64_bf16 v[56:59], v[16:19], v[232:239], v1
    v_smfmac_f32_16x16x64_bf16 v[60:63], v[12:15], v[240:247], v1
    v_smfmac_f32_16x16x64_bf16 v[60:63], v[16:19], v[248:255], v1
    s_nop 5
    v_pk_add_f32 v[32:33], v[56:57], v[58:59]
    s_nop 0
    v_pk_add_f32 v[34:35], v[60:61], v[62:63]
    s_setprio 0
    s_mov_b64 exec, 0xffff
    ds_write_b128 v36, v[24:27] offset:0
    ds_write_b128 v36, v[28:31] offset:256
    ds_write_b128 v36, v[32:35] offset:512
    s_mov_b64 exec, -1
    s_waitcnt lgkmcnt(0)
L_b2_0:
    s_barrier
    s_cmp_lt_u32 s30, 2
    s_cbranch_scc0 L_skip_97
    s_mov_b32 exec_lo, 0xffffffff
    s_mov_b32 exec_hi, 0xffff
    ds_read_b64 v[40:41], v20 offset:0
L_pad1:
    s_cbranch_execz L_pad2
    ds_read_b64 v[42:43], v20 offset:2048
    ds_read_b64 v[44:45], v20 offset:4096
    ds_read_b64 v[46:47], v20 offset:6144
    ds_read_b64 v[48:49], v20 offset:8192
    ds_read_b64 v[50:51], v20 offset:10240
    ds_read_b64 v[52:53], v20 offset:12288
    ds_read_b64 v[54:55], v20 offset:14336
    s_waitcnt lgkmcnt(7)
    v_mul_f32 v56, s64, v40
    v_mul_f32 v57, s64, v41
    s_waitcnt lgkmcnt(6)
    v_fmac_f32 v56, s65, v42
    v_fmac_f32 v57, s65, v43
    s_waitcnt lgkmcnt(5)
    v_fmac_f32 v56, s66, v44
    v_fmac_f32 v57, s66, v45
    s_waitcnt lgkmcnt(4)
    v_fmac_f32 v56, s67, v46
    v_fmac_f32 v57, s67, v47
    s_waitcnt lgkmcnt(3)
    v_fmac_f32 v56, s68, v48
    v_fmac_f32 v57, s68, v49
    s_waitcnt lgkmcnt(2)
    v_fmac_f32 v56, s69, v50
    v_fmac_f32 v57, s69, v51
    s_waitcnt lgkmcnt(1)
    v_fmac_f32 v56, s70, v52
    v_fmac_f32 v57, s70, v53
    s_waitcnt lgkmcnt(0)
    v_fmac_f32 v56, s71, v54
    v_fmac_f32 v57, s71, v55
    v_cvt_pk_bf16_f32 v56, v56, v57
    v_min_u32 v56, -2, v56
    s_cmp_eq_u32 s55, 0
    s_cbranch_scc1 L_gs_98
    buffer_store_dword v56, v21, s[40:43], 0 offen
L_gb_99:
    s_mov_b64 exec, -1
L_skip_97:
    s_cmp_eq_u32 s30, 6
    s_cbranch_scc0 L_skip_100
    s_waitcnt vmcnt(0)
L_skip_100:
    s_barrier
    s_cmp_lt_u32 s3, 20
    s_cbranch_scc0 L_typeB_0
    s_lshr_b32 s57, s30, 1
    s_lshl_b32 s57, s57, 5
    s_add_u32 s57, s57, s62
    s_add_u32 s59, s57, 55808
    v_and_b32 v5, 7, v0
    v_lshlrev_b32 v5, 2, v5
    v_lshrrev_b32 v22, 4, v0
    v_lshlrev_b32 v22, 3, v22
    buffer_load_dword v18, v5, s[40:43], s59 offen sc1
    buffer_load_dwordx2 v[20:21], v22, s[40:43], s59 offen sc1
    s_mul_i32 s57, s30, 6144
    v_lshrrev_b32 v7, 2, v0
    v_lshlrev_b32 v7, 6, v7
    v_bfe_u32 v60, v0, 4, 1
    v_lshl_add_u32 v7, v60, 5, v7
    v_and_b32 v60, 3, v0
    v_lshl_add_u32 v7, v60, 3, v7
    v_add_u32 v7, s57, v7
    v_add_u32 v7, 30720, v7
    v_xor_b32 v8, 32, v7
    s_mul_i32 s60, s30, 1536
    s_add_u32 s60, s60, s62
    s_add_u32 s60, s60, 0
    v_lshlrev_b32 v9, 4, v0
    v_lshlrev_b32 v10, 3, v0
    ds_read_b64_tr_b16 v[36:37], v7 offset:0
    ds_read_b64_tr_b16 v[38:39], v7 offset:1024
    ds_read_b64_tr_b16 v[40:41], v7 offset:2048
    ds_read_b64_tr_b16 v[42:43], v7 offset:3072
    ds_read_b64_tr_b16 v[44:45], v7 offset:4096
    ds_read_b64_tr_b16 v[46:47], v7 offset:5120
    ds_read_b64_tr_b16 v[48:49], v8 offset:0
    ds_read_b64_tr_b16 v[50:51], v8 offset:1024
    ds_read_b64_tr_b16 v[52:53], v8 offset:2048
    ds_read_b64_tr_b16 v[54:55], v8 offset:3072
    ds_read_b64_tr_b16 v[56:57], v8 offset:4096
    ds_read_b64_tr_b16 v[58:59], v8 offset:5120
    v_mov_b64 v[24:25], 0
    v_mov_b64 v[26:27], 0
    v_mov_b64 v[28:29], 0
    v_mov_b64 v[30:31], 0
    s_lshl_b32 s57, s30, 8
    v_lshlrev_b32 v11, 2, v0
    v_add_u32 v11, s57, v11
    v_add_u32 v11, 157696, v11
    s_waitcnt vmcnt(0)
L_pw_101:
    v_max3_u32 v19, v18, v20, v21
    v_cmp_eq_u32 vcc, -1, v19
    s_cbranch_vccnz L_pr_102
    buffer_load_dwordx4 v[12:15], v9, s[40:43], s60 offen sc1
L_pad2:
    s_cbranch_execz L_pad3
    buffer_load_dwordx2 v[16:17], v10, s[40:43], s60 offen offset:1024 sc1
    v_max_f32_dpp v19, v18, v18 row_ror:4 row_mask:0xf bank_mask:0xf
    s_nop 1
    v_max_f32_dpp v19, v19, v19 row_ror:2 row_mask:0xf bank_mask:0xf
    s_nop 1
    v_max_f32_dpp v19, v19, v19 row_ror:1 row_mask:0xf bank_mask:0xf
    v_sub_f32 v18, v18, v19
    v_sub_f32 v20, v20, v19
    v_sub_f32 v21, v21, v19
    v_exp_f32 v18, v18
    v_exp_f32 v20, v20
    v_exp_f32 v21, v21
    v_add_f32_dpp v18, v18, v18 row_ror:4 row_mask:0xf bank_mask:0xf
    s_nop 1
    v_add_f32_dpp v18, v18, v18 row_ror:2 row_mask:0xf bank_mask:0xf
    s_nop 1
    v_add_f32_dpp v18, v18, v18 row_ror:1 row_mask:0xf bank_mask:0xf
    v_rcp_f32 v18, v18
    s_nop 0
    v_mul_f32 v20, v20, v18
    v_mul_f32 v21, v21, v18
    s_waitcnt lgkmcnt(0)
    s_waitcnt vmcnt(0)
L_pw_103:
    v_max3_u32 v19, v12, v13, v14
    v_max3_u32 v19, v19, v15, v16
    v_max_u32 v19, v19, v17
    v_cmp_eq_u32 vcc, -1, v19
    s_cbranch_vccnz L_pr_104
    v_smfmac_f32_16x16x64_bf16 v[24:27], v[12:15], v[36:43], v1
    v_smfmac_f32_16x16x64_bf16 v[28:31], v[12:15], v[48:55], v1
    v_smfmac_f32_16x16x32_bf16 v[24:27], v[16:17], v[44:47], v1
    v_smfmac_f32_16x16x32_bf16 v[28:31], v[16:17], v[56:59], v1
    s_nop 6
    v_pk_add_f32 v[24:25], v[24:25], v[26:27]
    v_pk_add_f32 v[28:29], v[28:29], v[30:31]
    v_mul_f32 v24, v24, v20
    v_mul_f32 v28, v28, v20
    v_fmac_f32 v24, v25, v21
    v_fmac_f32 v28, v29, v21
    s_nop 1
    v_permlane32_swap_b32 v24, v28
    v_add_f32 v24, v24, v28
    ds_write_b32 v11, v24
    v_lshlrev_b32 v5, 2, v0
    v_add_u32 v5, 157696, v5
    s_mul_i32 s59, s31, 2560
    s_lshl_b32 s58, s3, 7
    s_add_u32 s59, s59, s58
    s_add_u32 s59, s59, 1343424
    v_lshlrev_b32 v9, 2, v0
    s_waitcnt lgkmcnt(0)
    s_barrier
    s_cmp_eq_u32 s30, 2
    s_cbranch_scc0 L_skip_105
    ds_read2st64_b32 v[12:13], v5 offset0:0 offset1:1
    ds_read2st64_b32 v[14:15], v5 offset0:2 offset1:3
    ds_read2st64_b32 v[16:17], v5 offset0:4 offset1:5
    ds_read2st64_b32 v[18:19], v5 offset0:6 offset1:7
    s_waitcnt lgkmcnt(2)
    v_pk_add_f32 v[12:13], v[12:13], v[14:15]
    s_waitcnt lgkmcnt(0)
    v_pk_add_f32 v[16:17], v[16:17], v[18:19]
    v_pk_add_f32 v[12:13], v[12:13], v[16:17]
    v_add_f32 v12, v12, v13
    v_mov_b32 v13, v12
    s_nop 1
    v_permlane16_swap_b32 v12, v13
    v_add_f32 v12, v12, v13
    v_min_u32 v12, -2, v12
    s_mov_b32 exec_lo, 0xffff0000
    s_mov_b32 exec_hi, 0xffff
    buffer_store_dword v12, v9, s[40:43], s59 offen sc1
    s_lshl_b32 s57, s3, 2
    s_add_u32 s57, s57, s62
    s_add_u32 s57, s57, 56064
    s_mov_b64 exec, 0x1
    s_cmp_eq_u32 s55, 0
    s_cbranch_scc1 L_gs_106
    buffer_store_dword v0, v0, s[40:43], s57 offen
L_gb_107:
    s_mov_b64 exec, -1
L_skip_105:
    s_sub_u32 s57, s30, 5
    s_cmp_lt_u32 s57, 2
    s_cbranch_scc0 L_skip_108
    s_sub_u32 s60, s30, 5
    s_mul_i32 s59, s60, 6144
    s_add_u32 s59, s59, 79872
    s_mov_b32 s44, s20
    s_mov_b32 s45, s21
    s_mov_b32 s46, 1966080
    s_mov_b32 s47, 0x20000
    s_mul_i32 s57, s31, 245760
L_pad3:
    s_cbranch_execz L_pad4
    s_lshl_b32 s58, s3, 6
    s_add_u32 s57, s57, s58
    s_lshl_b32 s58, s60, 5
    s_add_u32 s57, s57, s58
    v_lshrrev_b32 v5, 1, v0
    v_mul_u32_u24 v5, 1280, v5
    v_and_b32 v60, 1, v0
    v_lshl_add_u32 v5, v60, 4, v5
    v_add_u32 v5, s57, v5
    s_add_u32 m0, s59, 0
    s_mov_b32 s57, 0
    buffer_load_dwordx4 v5, s[44:47], s57 offen nt lds
    s_add_u32 m0, s59, 1024
    s_mov_b32 s57, 40960
    buffer_load_dwordx4 v5, s[44:47], s57 offen nt lds
    s_add_u32 m0, s59, 2048
    s_mov_b32 s57, 81920
    buffer_load_dwordx4 v5, s[44:47], s57 offen nt lds
    s_add_u32 m0, s59, 3072
    s_mov_b32 s57, 122880
    buffer_load_dwordx4 v5, s[44:47], s57 offen nt lds
    s_add_u32 m0, s59, 4096
    s_mov_b32 s57, 163840
    buffer_load_dwordx4 v5, s[44:47], s57 offen nt lds
    s_add_u32 m0, s59, 5120
    s_mov_b32 s57, 204800
    buffer_load_dwordx4 v5, s[44:47], s57 offen nt lds
    s_mul_i32 s57, s31, 384
    v_lshlrev_b32 v5, 1, v0
    v_add_u32 v5, s57, v5
    global_load_ushort v8, v5, s[18:19] offset:0
    global_load_ushort v9, v5, s[18:19] offset:128
    global_load_ushort v10, v5, s[18:19] offset:256
    v_lshlrev_b32 v11, 4, v0
    v_lshrrev_b32 v7, 4, v0
    v_lshlrev_b32 v7, 8, v7
    v_bfe_u32 v60, v0, 2, 2
    v_lshl_add_u32 v7, v60, 5, v7
    v_and_b32 v60, 3, v0
    v_lshl_add_u32 v7, v60, 3, v7
    v_add_u32 v7, s59, v7
    s_mul_i32 s57, s31, 2560
    s_lshl_b32 s58, s3, 7
    s_add_u32 s57, s57, s58
    s_lshl_b32 s60, s60, 6
    s_add_u32 s60, s60, s57
    s_add_u32 s60, s60, 1363968
    s_add_u32 s58, s62, 49152
    s_add_u32 s59, s58, 3072
    buffer_load_dwordx4 v[12:15], v11, s[40:43], s58 offen offset:0 sc1
    buffer_load_dwordx4 v[16:19], v11, s[40:43], s58 offen offset:1024 sc1
    buffer_load_dwordx4 v[20:23], v11, s[40:43], s58 offen offset:2048 sc1
    buffer_load_dwordx4 v[24:27], v11, s[40:43], s59 offen offset:0 sc1
    buffer_load_dwordx4 v[28:31], v11, s[40:43], s59 offen offset:1024 sc1
    buffer_load_dwordx4 v[32:35], v11, s[40:43], s59 offen offset:2048 sc1
    s_waitcnt vmcnt(0)
L_pw_109:
    v_max3_u32 v60, v12, v13, v14
    v_max3_u32 v60, v60, v15, v16
    v_max3_u32 v60, v60, v17, v18
    v_max3_u32 v60, v60, v19, v20
    v_max3_u32 v60, v60, v21, v22
    v_max3_u32 v60, v60, v23, v24
    v_max3_u32 v60, v60, v25, v26
    v_max3_u32 v60, v60, v27, v28
    v_max3_u32 v60, v60, v29, v30
    v_max3_u32 v60, v60, v31, v32
    v_max3_u32 v60, v60, v33, v34
    v_max_u32 v60, v60, v35
    v_cmp_eq_u32 vcc, -1, v60
    s_cbranch_vccnz L_pr_110
    ds_read_b64_tr_b16 v[36:37], v7 offset:0
    ds_read_b64_tr_b16 v[38:39], v7 offset:128
    ds_read_b64_tr_b16 v[40:41], v7 offset:1024
    ds_read_b64_tr_b16 v[42:43], v7 offset:1152
    ds_read_b64_tr_b16 v[44:45], v7 offset:2048
    ds_read_b64_tr_b16 v[46:47], v7 offset:2176
L_pad4:
    s_cbranch_execz L_pad5
    ds_read_b64_tr_b16 v[48:49], v7 offset:3072
    ds_read_b64_tr_b16 v[50:51], v7 offset:3200
    ds_read_b64_tr_b16 v[52:53], v7 offset:4096
    ds_read_b64_tr_b16 v[54:55], v7 offset:4224
    ds_read_b64_tr_b16 v[56:57], v7 offset:5120
    ds_read_b64_tr_b16 v[58:59], v7 offset:5248
    v_pk_add_f32 v[12:13], v[12:13], v[14:15]
    v_pk_add_f32 v[16:17], v[16:17], v[18:19]
    v_pk_add_f32 v[12:13], v[12:13], v[16:17]
    v_add_f32 v4, v12, v13
    v_pk_add_f32 v[20:21], v[20:21], v[22:23]
    v_pk_add_f32 v[24:25], v[24:25], v[26:27]
    v_pk_add_f32 v[20:21], v[20:21], v[24:25]
    v_add_f32 v5, v20, v21
    v_pk_add_f32 v[28:29], v[28:29], v[30:31]
    v_pk_add_f32 v[32:33], v[32:33], v[34:35]
    v_pk_add_f32 v[28:29], v[28:29], v[32:33]
    v_add_f32 v7, v28, v29
    v_lshlrev_b32 v8, 16, v8
    v_lshlrev_b32 v9, 16, v9
    v_lshlrev_b32 v10, 16, v10
    v_mov_b64 v[60:61], 0
    v_mov_b64 v[62:63], 0
    s_add_u32 s58, s62, 36864
    s_add_u32 s57, s62, 55552
    s_add_u32 s59, s58, 3072
    s_mov_b32 s64, 0xbdd2d3e8
    v_and_b32 v12, 7, v0
    v_lshlrev_b32 v12, 3, v12
    buffer_load_dwordx2 v[2:3], v12, s[40:43], s57 offen sc1
    s_waitcnt lgkmcnt(0)
    s_waitcnt vmcnt(0)
L_pw_111:
    v_max_u32 v13, v2, v3
    v_cmp_eq_u32 vcc, -1, v13
    s_cbranch_vccnz L_pr_112
    buffer_load_dwordx4 v[12:15], v11, s[40:43], s58 offen offset:0 sc1
    buffer_load_dwordx4 v[16:19], v11, s[40:43], s58 offen offset:1024 sc1
    buffer_load_dwordx4 v[20:23], v11, s[40:43], s58 offen offset:2048 sc1
    buffer_load_dwordx4 v[24:27], v11, s[40:43], s59 offen offset:0 sc1
    buffer_load_dwordx4 v[28:31], v11, s[40:43], s59 offen offset:1024 sc1
    buffer_load_dwordx4 v[32:35], v11, s[40:43], s59 offen offset:2048 sc1
    v_add_f32_dpp v2, v2, v2 row_ror:4 row_mask:0xf bank_mask:0xf
    v_add_f32_dpp v3, v3, v3 row_ror:4 row_mask:0xf bank_mask:0xf
    s_nop 0
    v_add_f32_dpp v2, v2, v2 row_ror:2 row_mask:0xf bank_mask:0xf
    v_add_f32_dpp v3, v3, v3 row_ror:2 row_mask:0xf bank_mask:0xf
    s_nop 0
    v_add_f32_dpp v2, v2, v2 row_ror:1 row_mask:0xf bank_mask:0xf
    v_add_f32_dpp v3, v3, v3 row_ror:1 row_mask:0xf bank_mask:0xf
    v_mul_f32 v2, 0x3acccccd, v2
    v_mul_f32 v3, 0x3acccccd, v3
    v_fma_f32 v3, -v2, v2, v3
    v_max_f32 v3, 0, v3
    v_add_f32 v3, 0x3727c5ac, v3
    v_rsq_f32 v3, v3
    s_nop 0
    v_mul_f32 v2, v2, v3
    v_fma_f32 v8, -v2, v4, v8
    v_fma_f32 v9, -v2, v5, v9
    v_fma_f32 v10, -v2, v7, v10
    v_lshlrev_b32 v7, 2, v0
    v_mov_b32 v2, 0xc0135761
    s_waitcnt vmcnt(4)
    v_pk_add_f32 v[12:13], v[12:13], v[14:15]
    v_pk_add_f32 v[16:17], v[16:17], v[18:19]
    v_pk_add_f32 v[12:13], v[12:13], v[16:17]
    v_add_f32 v12, v12, v13
    s_waitcnt vmcnt(2)
    v_pk_add_f32 v[20:21], v[20:21], v[22:23]
    v_pk_add_f32 v[24:25], v[24:25], v[26:27]
    v_pk_add_f32 v[20:21], v[20:21], v[24:25]
    v_add_f32 v13, v20, v21
    s_waitcnt vmcnt(0)
    v_pk_add_f32 v[28:29], v[28:29], v[30:31]
    v_pk_add_f32 v[32:33], v[32:33], v[34:35]
    v_pk_add_f32 v[28:29], v[28:29], v[32:33]
    v_add_f32 v14, v28, v29
L_pad5:
    s_cbranch_execz L_pad6
    v_add_f32 v15, v12, v13
    v_cmp_u_f32 vcc, v15, v14
    s_cbranch_vccnz L_hr_113
L_hk_114:
    v_fma_f32 v12, v12, v3, v8
    v_fma_f32 v13, v13, v3, v9
    v_fma_f32 v14, v14, v3, v10
    v_mul_f32 v16, v12, v12
    v_mul_f32 v17, v13, v13
    v_mul_f32 v18, v14, v14
    v_fma_f32 v16, v16, s64, v2
    v_fma_f32 v17, v17, s64, v2
    v_fma_f32 v18, v18, s64, v2
    v_mul_f32 v16, v16, v12
    v_mul_f32 v17, v17, v13
    v_mul_f32 v18, v18, v14
    v_exp_f32 v16, v16
    v_exp_f32 v17, v17
    v_exp_f32 v18, v18
    v_add_f32 v16, 1.0, v16
    v_add_f32 v17, 1.0, v17
    v_add_f32 v18, 1.0, v18
    v_rcp_f32 v16, v16
    v_rcp_f32 v17, v17
    v_rcp_f32 v18, v18
    v_mul_f32 v12, v12, v16
    v_mul_f32 v13, v13, v17
    v_mul_f32 v14, v14, v18
    v_mov_b32_dpp v16, v12 row_shl:1 row_mask:0xf bank_mask:0xf bound_ctrl:0
    v_mov_b32_dpp v17, v13 row_shl:1 row_mask:0xf bank_mask:0xf bound_ctrl:0
    v_mov_b32_dpp v18, v14 row_shl:1 row_mask:0xf bank_mask:0xf bound_ctrl:0
    v_cvt_pk_bf16_f32 v20, v12, v16
    v_cvt_pk_bf16_f32 v24, v13, v17
    v_cvt_pk_bf16_f32 v28, v14, v18
    v_mov_b32_dpp v21, v20 row_shl:4 row_mask:0xf bank_mask:0xf bound_ctrl:0
    v_mov_b32_dpp v22, v20 row_shl:8 row_mask:0xf bank_mask:0xf bound_ctrl:0
    v_mov_b32_dpp v23, v20 row_shl:12 row_mask:0xf bank_mask:0xf bound_ctrl:0
    v_mov_b32_dpp v25, v24 row_shl:4 row_mask:0xf bank_mask:0xf bound_ctrl:0
    v_mov_b32_dpp v26, v24 row_shl:8 row_mask:0xf bank_mask:0xf bound_ctrl:0
    v_mov_b32_dpp v27, v24 row_shl:12 row_mask:0xf bank_mask:0xf bound_ctrl:0
    v_smfmac_f32_16x16x64_bf16 v[60:63], v[20:23], v[36:43], v1
    v_mov_b32_dpp v29, v28 row_shl:4 row_mask:0xf bank_mask:0xf bound_ctrl:0
    v_mov_b32_dpp v30, v28 row_shl:8 row_mask:0xf bank_mask:0xf bound_ctrl:0
    v_mov_b32_dpp v31, v28 row_shl:12 row_mask:0xf bank_mask:0xf bound_ctrl:0
    v_smfmac_f32_16x16x64_bf16 v[60:63], v[24:27], v[44:51], v1
    s_nop 0
    v_smfmac_f32_16x16x64_bf16 v[60:63], v[28:31], v[52:59], v1
    s_nop 7
    v_add_f32 v60, v60, v62
    v_min_u32 v60, -2, v60
    s_mov_b64 exec, 0xffff
    buffer_store_dword v60, v7, s[40:43], s60 offen sc1
    s_cmp_eq_u32 s30, 6
    s_cbranch_scc0 L_skip_117
    s_lshl_b32 s57, s3, 2
    s_add_u32 s57, s57, s62
    s_add_u32 s57, s57, 56192
    s_mov_b64 exec, 0x1
    s_cmp_eq_u32 s55, 0
    s_cbranch_scc1 L_gs_118
    buffer_store_dword v0, v0, s[40:43], s57 offen
L_gb_119:
    s_mov_b64 exec, -1
L_skip_117:
    s_mov_b64 exec, -1
L_skip_108:
    s_branch L_p1
L_typeB_0:
    s_cmp_eq_u32 s53, 3
    s_cbranch_scc0 L_p1
    s_cmp_lt_u32 s30, 6
    s_cbranch_scc0 L_skip_120
    s_lshr_b32 s57, s30, 1
    s_mul_i32 s57, s57, 128
    s_and_b32 s58, s30, 1
    s_lshl_b32 s58, s58, 6
    s_add_u32 s57, s57, s58
    v_lshrrev_b32 v18, 5, v0
    v_lshlrev_b32 v18, 13, v18
    v_bfe_u32 v60, v0, 3, 1
    v_lshl_add_u32 v18, v60, 12, v18
    v_bfe_u32 v60, v0, 4, 1
    v_lshl_add_u32 v18, v60, 11, v18
    v_bfe_u32 v60, v0, 2, 1
    v_mul_u32_u24 v60, 384, v60
    v_add_u32 v18, v60, v18
    v_and_b32 v60, 3, v0
    v_lshl_add_u32 v18, v60, 3, v18
    v_add_u32 v18, s57, v18
    v_add_u32 v18, 30720, v18
    v_bfe_u32 v19, v0, 4, 1
    v_lshlrev_b32 v19, 12, v19
    v_bfe_u32 v60, v0, 3, 1
L_pad6:
    s_cbranch_execz L_pad7
    v_lshl_add_u32 v19, v60, 11, v19
    v_bfe_u32 v60, v0, 2, 1
    v_mul_u32_u24 v60, 384, v60
    v_add_u32 v19, v60, v19
    v_and_b32 v60, 3, v0
    v_lshl_add_u32 v19, v60, 3, v19
    v_add_u32 v19, s57, v19
    v_add_u32 v19, 63488, v19
    ds_read_b64_tr_b16 v[36:37], v18 offset:0
    ds_read_b64_tr_b16 v[38:39], v18 offset:1024
    ds_read_b64_tr_b16 v[40:41], v18 offset:16384
    ds_read_b64_tr_b16 v[42:43], v18 offset:17408
    ds_read_b64_tr_b16 v[44:45], v19 offset:0
    ds_read_b64_tr_b16 v[46:47], v19 offset:1024
    ds_read_b64_tr_b16 v[48:49], v18 offset:32
    ds_read_b64_tr_b16 v[50:51], v18 offset:1056
    ds_read_b64_tr_b16 v[52:53], v18 offset:16416
    ds_read_b64_tr_b16 v[54:55], v18 offset:17440
    ds_read_b64_tr_b16 v[56:57], v19 offset:32
    ds_read_b64_tr_b16 v[58:59], v19 offset:1056
    v_lshrrev_b32 v32, 4, v0
    v_lshlrev_b32 v32, 5, v32
    v_bfe_u32 v60, v0, 1, 1
    v_lshl_add_u32 v32, v60, 4, v32
    v_and_b32 v60, 1, v0
    v_mul_u32_u24 v60, 192, v60
    v_add_u32 v32, v60, v32
    v_add_u32 v32, 159872, v32
    v_lshrrev_b32 v33, 4, v0
    v_lshlrev_b32 v33, 4, v33
    v_bfe_u32 v60, v0, 1, 1
    v_lshl_add_u32 v33, v60, 3, v33
    v_and_b32 v60, 1, v0
    v_mul_u32_u24 v60, 192, v60
    v_add_u32 v33, v60, v33
    v_add_u32 v33, 160000, v33
    v_mov_b64 v[24:25], 0
    v_mov_b64 v[26:27], 0
    v_mov_b64 v[28:29], 0
    v_mov_b64 v[30:31], 0
    s_lshr_b32 s57, s30, 1
    s_lshl_b32 s57, s57, 11
    s_and_b32 s58, s30, 1
    s_lshl_b32 s58, s58, 9
    s_add_u32 s57, s57, s58
    s_lshr_b32 s58, s54, 2
    s_lshl_b32 s58, s58, 10
    s_add_u32 s57, s57, s58
    s_and_b32 s58, s54, 3
    s_lshl_b32 s58, s58, 2
    s_add_u32 s57, s57, s58
    v_and_b32 v34, 31, v0
    v_lshlrev_b32 v34, 4, v34
    v_add_u32 v34, s57, v34
    s_add_u32 s59, s62, 36864
    s_add_u32 s60, s62, 55552
    ds_read_b128 v[12:15], v32
    ds_read_b64 v[16:17], v33
    s_waitcnt lgkmcnt(1)
    v_smfmac_f32_16x16x64_bf16 v[24:27], v[12:15], v[36:43], v1
    v_smfmac_f32_16x16x64_bf16 v[28:31], v[12:15], v[48:55], v1
    s_waitcnt lgkmcnt(0)
    v_smfmac_f32_16x16x32_bf16 v[24:27], v[16:17], v[44:47], v1
    v_smfmac_f32_16x16x32_bf16 v[28:31], v[16:17], v[56:59], v1
    s_add_u32 s60, s62, 49152
    s_nop 5
    v_add_f32 v12, v25, v27
    s_nop 1
    v_add_f32_dpp v12, v29, v31 quad_perm:[0,1,2,3] row_mask:0x2 bank_mask:0xf
    v_min_u32 v12, -2, v12
    s_mov_b32 exec_lo, 0xffffffff
    s_mov_b32 exec_hi, 0x0
    s_cmp_eq_u32 s55, 0
    s_cbranch_scc1 L_gs_121
    buffer_store_dword v12, v34, s[40:43], s60 offen
L_gb_122:
    s_mov_b64 exec, -1
    v_mov_b64 v[24:25], 0
    v_mov_b64 v[26:27], 0
    v_mov_b64 v[28:29], 0
    v_mov_b64 v[30:31], 0
L_skip_120:
    s_cmp_eq_u32 s30, 7
    s_cbranch_scc0 L_skip_123
    v_and_b32 v60, 31, v0
    v_min_u32 v60, 19, v60
    s_mul_i32 s57, s54, 320
    v_lshrrev_b32 v5, 5, v0
    v_mul_u32_u24 v5, 2560, v5
    v_add_u32 v5, s57, v5
    v_lshl_add_u32 v5, v60, 4, v5
L_pad7:
    s_cbranch_execz L_pad8
    v_and_b32 v60, 31, v0
    v_cmp_gt_u32 s[64:65], 20, v60
    v_min_u32 v60, 19, v60
    v_lshrrev_b32 v35, 5, v0
    v_lshlrev_b32 v35, 2, v35
    v_add_u32 v35, 159872, v35
    v_lshl_add_u32 v35, v60, 3, v35
    s_add_u32 s66, s62, 36864
    s_add_u32 s67, s62, 55552
    s_lshl_b32 s57, s54, 3
    v_lshrrev_b32 v34, 5, v0
    v_lshlrev_b32 v34, 2, v34
    v_add_u32 v34, s57, v34
    v_mov_b32 v61, 0x3f803f80
    s_add_u32 s57, s62, 56064
    v_min_u32 v9, 19, v0
    v_lshlrev_b32 v9, 2, v9
    buffer_load_dword v12, v9, s[40:43], s57 offen sc1
    s_waitcnt vmcnt(0)
L_pw_124:
    v_cmp_eq_u32 vcc, -1, v12
    s_cbranch_vccnz L_pr_125
    s_mov_b32 s57, 1343488
    buffer_load_dwordx4 v[12:15], v5, s[40:43], s57 offen sc1
    s_mov_b32 s58, 1348608
    buffer_load_dwordx4 v[16:19], v5, s[40:43], s58 offen sc1
    s_mov_b32 s59, 1353728
    buffer_load_dwordx4 v[20:23], v5, s[40:43], s59 offen sc1
    s_mov_b32 s60, 1358848
    buffer_load_dwordx4 v[24:27], v5, s[40:43], s60 offen sc1
L_gw_126:
    s_waitcnt vmcnt(2)
    v_pk_add_f32 v[28:29], v[12:13], v[16:17]
    v_pk_add_f32 v[30:31], v[14:15], v[18:19]
    s_waitcnt vmcnt(1)
    v_pk_add_f32 v[28:29], v[28:29], v[20:21]
    v_pk_add_f32 v[30:31], v[30:31], v[22:23]
    s_waitcnt vmcnt(0)
    v_pk_add_f32 v[28:29], v[28:29], v[24:25]
    v_pk_add_f32 v[30:31], v[30:31], v[26:27]
    s_nop 1
    v_permlane32_swap_b32 v28, v30
    v_permlane32_swap_b32 v29, v31
    v_pk_add_f32 v[28:29], v[28:29], v[30:31]
    v_pk_add_f32 v[28:29], v[28:29], v[2:3]
    v_cmp_u_f32 vcc, v28, v29
    s_cbranch_vccnz L_gr_127
L_gk_128:
    v_cvt_pk_bf16_f32 v28, v28, v29
    ds_write_b32 v35, v28
    s_waitcnt lgkmcnt(0)
L_skip_123:
    s_barrier
    s_cmp_lt_u32 s30, 6
    s_cbranch_scc0 L_skip_133
    ds_read_b128 v[12:15], v32
    ds_read_b64 v[16:17], v33
    s_waitcnt lgkmcnt(1)
    v_smfmac_f32_16x16x64_bf16 v[24:27], v[12:15], v[36:43], v1
    v_smfmac_f32_16x16x64_bf16 v[28:31], v[12:15], v[48:55], v1
    s_waitcnt lgkmcnt(0)
    v_smfmac_f32_16x16x32_bf16 v[24:27], v[16:17], v[44:47], v1
    v_smfmac_f32_16x16x32_bf16 v[28:31], v[16:17], v[56:59], v1
    s_nop 6
    v_add_f32 v12, v24, v26
    s_nop 1
    v_add_f32_dpp v12, v28, v30 quad_perm:[0,1,2,3] row_mask:0x2 bank_mask:0xf
    v_min_u32 v12, -2, v12
    s_mov_b32 exec_lo, 0xffffffff
    s_mov_b32 exec_hi, 0x0
    s_cmp_eq_u32 s55, 0
    s_cbranch_scc1 L_gs_134
    buffer_store_dword v12, v34, s[40:43], s59 offen
L_gb_135:
    s_mov_b64 exec, -1
L_skip_133:
    s_cmp_eq_u32 s30, 7
    s_cbranch_scc0 L_skip_136
    v_lshlrev_b32 v2, 16, v28
    v_and_b32 v3, 0xffff0000, v28
    v_cndmask_b32 v28, 0, v28, s[64:65]
    v_dot2_f32_bf16 v27, v28, v61, 0
    v_dot2_f32_bf16 v62, v28, v28, 0
    s_nop 2
    v_permlane32_swap_b32 v27, v62
    v_add_f32 v27, v27, v62
    v_mov_b32 v62, v27
    s_nop 1
    v_permlane16_swap_b32 v27, v62
    v_add_f32 v27, v27, v62
    s_nop 1
    v_add_f32_dpp v27, v27, v27 row_ror:8 row_mask:0xf bank_mask:0xf
    s_nop 1
L_pad8:
    s_cbranch_execz L_pad9
    v_add_f32_dpp v27, v27, v27 row_ror:4 row_mask:0xf bank_mask:0xf
    s_nop 1
    v_add_f32_dpp v27, v27, v27 row_ror:2 row_mask:0xf bank_mask:0xf
    s_nop 1
    v_add_f32_dpp v27, v27, v27 row_ror:1 row_mask:0xf bank_mask:0xf
    v_min_u32 v27, -2, v27
    s_mov_b32 exec_lo, 0x1
    s_mov_b32 exec_hi, 0x1
    s_cmp_eq_u32 s55, 0
    s_cbranch_scc1 L_gs_137
    buffer_store_dword v27, v34, s[40:43], s67 offen
L_gb_138:
    s_mov_b64 exec, -1
L_skip_136:
L_p1:
    s_cmp_lt_u32 s30, 6
    s_cbranch_scc0 L_skip_139
    s_lshr_b32 s57, s30, 1
    s_mul_i32 s57, s57, 1024
    s_and_b32 s58, s30, 1
    s_lshl_b32 s58, s58, 6
    s_add_u32 s57, s57, s58
    v_lshrrev_b32 v18, 5, v0
    v_mul_u32_u24 v18, 6144, v18
    v_bfe_u32 v60, v0, 3, 1
    v_mul_u32_u24 v60, 3072, v60
    v_add_u32 v18, v60, v18
    v_bfe_u32 v60, v0, 4, 1
    v_lshl_add_u32 v18, v60, 9, v18
    v_bfe_u32 v60, v0, 2, 1
    v_lshl_add_u32 v18, v60, 7, v18
    v_and_b32 v60, 3, v0
    v_lshl_add_u32 v18, v60, 3, v18
    v_add_u32 v18, s57, v18
    v_bfe_u32 v19, v0, 4, 1
    v_mul_u32_u24 v19, 3072, v19
    v_bfe_u32 v60, v0, 3, 1
    v_lshl_add_u32 v19, v60, 9, v19
    v_bfe_u32 v60, v0, 2, 1
    v_lshl_add_u32 v19, v60, 7, v19
    v_and_b32 v60, 3, v0
    v_lshl_add_u32 v19, v60, 3, v19
    v_add_u32 v19, s57, v19
    v_add_u32 v19, 24576, v19
    ds_read_b64_tr_b16 v[36:37], v18 offset:0
    ds_read_b64_tr_b16 v[38:39], v18 offset:256
    ds_read_b64_tr_b16 v[40:41], v18 offset:12288
    ds_read_b64_tr_b16 v[42:43], v18 offset:12544
    ds_read_b64_tr_b16 v[44:45], v19 offset:0
    ds_read_b64_tr_b16 v[46:47], v19 offset:256
    ds_read_b64_tr_b16 v[48:49], v18 offset:32
    ds_read_b64_tr_b16 v[50:51], v18 offset:288
    ds_read_b64_tr_b16 v[52:53], v18 offset:12320
    ds_read_b64_tr_b16 v[54:55], v18 offset:12576
    ds_read_b64_tr_b16 v[56:57], v19 offset:32
    ds_read_b64_tr_b16 v[58:59], v19 offset:288
    v_lshrrev_b32 v32, 4, v0
    v_lshlrev_b32 v32, 5, v32
    v_bfe_u32 v60, v0, 1, 1
    v_lshl_add_u32 v32, v60, 4, v32
    v_and_b32 v60, 1, v0
    v_mul_u32_u24 v60, 192, v60
    v_add_u32 v32, v60, v32
    v_add_u32 v32, 159872, v32
    v_lshrrev_b32 v33, 4, v0
    v_lshlrev_b32 v33, 4, v33
    v_bfe_u32 v60, v0, 1, 1
    v_lshl_add_u32 v33, v60, 3, v33
    v_and_b32 v60, 1, v0
    v_mul_u32_u24 v60, 192, v60
    v_add_u32 v33, v60, v33
    v_add_u32 v33, 160000, v33
    v_mov_b64 v[24:25], 0
    v_mov_b64 v[26:27], 0
    v_mov_b64 v[28:29], 0
    v_mov_b64 v[30:31], 0
    s_lshr_b32 s57, s54, 1
    s_lshl_b32 s57, s57, 2
    s_and_b32 s58, s54, 1
    s_add_u32 s57, s57, s58
    s_lshl_b32 s57, s57, 4
    s_lshl_b32 s58, s30, 9
    s_add_u32 s57, s57, s58
    v_bfe_u32 v34, v0, 4, 1
    v_lshlrev_b32 v34, 8, v34
    v_bfe_u32 v60, v0, 1, 1
    v_lshl_add_u32 v34, v60, 5, v34
L_pad9:
    s_cbranch_execz L_pad10
    v_bfe_u32 v60, v0, 2, 2
    v_lshl_add_u32 v34, v60, 2, v34
    v_lshrrev_b32 v60, 5, v0
    v_mul_u32_u24 v60, 3072, v60
    v_add_u32 v34, v60, v34
    v_add_u32 v34, s57, v34
    s_mul_i32 s59, s53, 3072
    s_add_u32 s59, s59, s62
    s_add_u32 s59, s59, 24576
    s_lshl_b32 s60, s53, 6
    s_add_u32 s60, s60, s62
    s_add_u32 s60, s60, 55296
L_skip_139:
    s_cmp_eq_u32 s30, 7
    s_cbranch_scc0 L_skip_140
    v_and_b32 v60, 31, v0
    v_min_u32 v60, 19, v60
    s_mul_i32 s57, s54, 320
    v_lshrrev_b32 v5, 5, v0
    v_mul_u32_u24 v5, 2560, v5
    v_add_u32 v5, s57, v5
    v_lshl_add_u32 v5, v60, 4, v5
    v_and_b32 v60, 31, v0
    v_cmp_gt_u32 s[64:65], 20, v60
    v_min_u32 v60, 19, v60
    v_lshrrev_b32 v35, 5, v0
    v_lshlrev_b32 v35, 2, v35
    v_add_u32 v35, 159872, v35
    v_lshl_add_u32 v35, v60, 3, v35
    s_mul_i32 s66, s53, 3072
    s_add_u32 s66, s66, s62
    s_add_u32 s66, s66, 24576
    s_lshl_b32 s67, s53, 6
    s_add_u32 s67, s67, s62
    s_add_u32 s67, s67, 55296
    s_lshl_b32 s57, s54, 3
    v_lshrrev_b32 v34, 5, v0
    v_lshlrev_b32 v34, 2, v34
    v_add_u32 v34, s57, v34
    v_mov_b32 v61, 0x3f803f80
    s_cmp_lg_u32 s53, 3
    s_cbranch_scc0 L_skip_141
    s_add_u32 s57, s62, 55552
    v_mov_b32 v9, 0
    buffer_load_dword v12, v9, s[40:43], s57 offen sc1
    s_waitcnt vmcnt(0)
L_pw_142:
    v_cmp_eq_u32 vcc, -1, v12
    s_cbranch_vccnz L_pr_143
    s_mov_b32 s57, 1343488
    buffer_load_dwordx4 v[12:15], v5, s[40:43], s57 offen sc1
    s_mov_b32 s58, 1348608
    buffer_load_dwordx4 v[16:19], v5, s[40:43], s58 offen sc1
    s_mov_b32 s59, 1353728
    buffer_load_dwordx4 v[20:23], v5, s[40:43], s59 offen sc1
    s_mov_b32 s60, 1358848
    buffer_load_dwordx4 v[24:27], v5, s[40:43], s60 offen sc1
L_gw_144:
    s_waitcnt vmcnt(2)
    v_pk_add_f32 v[28:29], v[12:13], v[16:17]
    v_pk_add_f32 v[30:31], v[14:15], v[18:19]
    s_waitcnt vmcnt(1)
    v_pk_add_f32 v[28:29], v[28:29], v[20:21]
    v_pk_add_f32 v[30:31], v[30:31], v[22:23]
    s_waitcnt vmcnt(0)
    v_pk_add_f32 v[28:29], v[28:29], v[24:25]
    v_pk_add_f32 v[30:31], v[30:31], v[26:27]
    s_nop 1
    v_permlane32_swap_b32 v28, v30
    v_permlane32_swap_b32 v29, v31
    v_pk_add_f32 v[28:29], v[28:29], v[30:31]
    v_pk_add_f32 v[28:29], v[28:29], v[2:3]
    v_cmp_u_f32 vcc, v28, v29
    s_cbranch_vccnz L_gr_145
L_gk_146:
    v_cvt_pk_bf16_f32 v28, v28, v29
    v_lshlrev_b32 v2, 16, v28
    v_and_b32 v3, 0xffff0000, v28
L_skip_141:
    v_lshlrev_b32 v60, 16, v4
    v_add_f32 v2, v2, v60
    v_and_b32 v60, 0xffff0000, v4
    v_add_f32 v3, v3, v60
    s_add_u32 s57, s62, 56192
    v_min_u32 v9, 19, v0
    v_lshlrev_b32 v9, 2, v9
    buffer_load_dword v12, v9, s[40:43], s57 offen sc1
    s_waitcnt vmcnt(0)
L_pw_151:
    v_cmp_eq_u32 vcc, -1, v12
    s_cbranch_vccnz L_pr_152
    s_mov_b32 s57, 1363968
L_pad10:
    s_cbranch_execz L_pad11
    buffer_load_dwordx4 v[12:15], v5, s[40:43], s57 offen sc1
    s_mov_b32 s58, 1369088
    buffer_load_dwordx4 v[16:19], v5, s[40:43], s58 offen sc1
    s_mov_b32 s59, 1374208
    buffer_load_dwordx4 v[20:23], v5, s[40:43], s59 offen sc1
    s_mov_b32 s60, 1379328
    buffer_load_dwordx4 v[24:27], v5, s[40:43], s60 offen sc1
L_gw_153:
    s_waitcnt vmcnt(2)
    v_pk_add_f32 v[28:29], v[12:13], v[16:17]
    v_pk_add_f32 v[30:31], v[14:15], v[18:19]
    s_waitcnt vmcnt(1)
    v_pk_add_f32 v[28:29], v[28:29], v[20:21]
    v_pk_add_f32 v[30:31], v[30:31], v[22:23]
    s_waitcnt vmcnt(0)
    v_pk_add_f32 v[28:29], v[28:29], v[24:25]
    v_pk_add_f32 v[30:31], v[30:31], v[26:27]
    s_nop 1
    v_permlane32_swap_b32 v28, v30
    v_permlane32_swap_b32 v29, v31
    v_pk_add_f32 v[28:29], v[28:29], v[30:31]
    v_pk_add_f32 v[28:29], v[28:29], v[2:3]
    v_cmp_u_f32 vcc, v28, v29
    s_cbranch_vccnz L_gr_154
L_gk_155:
    v_cvt_pk_bf16_f32 v28, v28, v29
    ds_write_b32 v35, v28
    s_waitcnt lgkmcnt(0)
L_skip_140:
    s_barrier
    s_cmp_lt_u32 s30, 6
    s_cbranch_scc0 L_skip_160
    ds_read_b128 v[12:15], v32
    ds_read_b64 v[16:17], v33
    s_waitcnt lgkmcnt(1)
    v_smfmac_f32_16x16x64_bf16 v[24:27], v[12:15], v[36:43], v1
    v_smfmac_f32_16x16x64_bf16 v[28:31], v[12:15], v[48:55], v1
    s_waitcnt lgkmcnt(0)
    v_smfmac_f32_16x16x32_bf16 v[24:27], v[16:17], v[44:47], v1
    v_smfmac_f32_16x16x32_bf16 v[28:31], v[16:17], v[56:59], v1
    s_nop 6
    v_add_f32 v12, v24, v26
    s_nop 1
    v_add_f32_dpp v12, v28, v30 quad_perm:[0,1,2,3] row_mask:0x2 bank_mask:0xf
    s_nop 1
    v_mov_b32_dpp v13, v12 row_shl:1 row_mask:0xf bank_mask:0xf bound_ctrl:0
    v_cvt_pk_bf16_f32 v12, v12, v13
    v_min_u32 v12, -2, v12
    s_mov_b64 exec, 0x55555555
    s_cmp_eq_u32 s55, 0
    s_cbranch_scc1 L_gs_161
    buffer_store_dword v12, v34, s[40:43], s59 offen
L_gb_162:
    s_mov_b64 exec, -1
L_skip_160:
    s_cmp_eq_u32 s30, 7
    s_cbranch_scc0 L_skip_163
    v_lshlrev_b32 v2, 16, v28
    v_and_b32 v3, 0xffff0000, v28
    v_cndmask_b32 v28, 0, v28, s[64:65]
    v_dot2_f32_bf16 v27, v28, v61, 0
    v_dot2_f32_bf16 v62, v28, v28, 0
    s_nop 2
    v_permlane32_swap_b32 v27, v62
    v_add_f32 v27, v27, v62
    v_mov_b32 v62, v27
    s_nop 1
    v_permlane16_swap_b32 v27, v62
    v_add_f32 v27, v27, v62
    s_nop 1
    v_add_f32_dpp v27, v27, v27 row_ror:8 row_mask:0xf bank_mask:0xf
    s_nop 1
    v_add_f32_dpp v27, v27, v27 row_ror:4 row_mask:0xf bank_mask:0xf
    s_nop 1
    v_add_f32_dpp v27, v27, v27 row_ror:2 row_mask:0xf bank_mask:0xf
    s_nop 1
    v_add_f32_dpp v27, v27, v27 row_ror:1 row_mask:0xf bank_mask:0xf
    v_min_u32 v27, -2, v27
    s_mov_b32 exec_lo, 0x1
    s_mov_b32 exec_hi, 0x1
    s_cmp_eq_u32 s55, 0
    s_cbranch_scc1 L_gs_164
    buffer_store_dword v27, v34, s[40:43], s67 offen
L_gb_165:
    s_mov_b64 exec, -1
L_skip_163:
    s_mul_i32 s59, s53, 3072
    s_add_u32 s59, s59, s62
    s_add_u32 s59, s59, 24576
    s_lshl_b32 s60, s53, 6
    s_add_u32 s60, s60, s62
    s_add_u32 s60, s60, 55296
    v_lshlrev_b32 v5, 4, v0
    v_add_u32 v5, s59, v5
L_pad11:
    s_cbranch_execz L_pad12
    v_and_b32 v7, 7, v0
    v_lshlrev_b32 v7, 3, v7
    v_add_u32 v7, s60, v7
    buffer_load_dwordx2 v[8:9], v7, s[40:43], 0 offen sc1
    buffer_load_dwordx4 v[12:15], v5, s[40:43], 0 offen offset:0 sc1
    buffer_load_dwordx4 v[16:19], v5, s[40:43], 0 offen offset:1024 sc1
    buffer_load_dwordx4 v[20:23], v5, s[40:43], 0 offen offset:2048 sc1
    v_mov_b64 v[24:25], 0
    v_mov_b64 v[26:27], 0
    v_mov_b64 v[28:29], 0
    v_mov_b64 v[30:31], 0
    v_mov_b64 v[32:33], 0
    v_mov_b64 v[34:35], 0
    v_mov_b64 v[36:37], 0
    v_mov_b64 v[38:39], 0
    v_mov_b64 v[40:41], 0
    v_mov_b64 v[42:43], 0
    v_mov_b64 v[44:45], 0
    v_mov_b64 v[46:47], 0
    v_mov_b64 v[48:49], 0
    v_mov_b64 v[50:51], 0
    v_mov_b64 v[52:53], 0
    v_mov_b64 v[54:55], 0
    v_mov_b64 v[56:57], 0
    v_mov_b64 v[58:59], 0
    v_mov_b64 v[60:61], 0
    v_mov_b64 v[62:63], 0
    s_lshl_b32 s58, s30, 3
    s_add_u32 s58, s58, 159744
    v_mov_b32 v10, s58
    s_waitcnt vmcnt(0)
L_pw_166:
    v_max3_u32 v11, v8, v9, v12
    v_max3_u32 v11, v11, v13, v14
    v_max3_u32 v11, v11, v15, v16
    v_max3_u32 v11, v11, v17, v18
    v_max3_u32 v11, v11, v19, v20
    v_max3_u32 v11, v11, v21, v22
    v_max_u32 v11, v11, v23
    v_cmp_eq_u32 vcc, -1, v11
    s_cbranch_vccnz L_pr_167
    v_smfmac_f32_16x16x64_bf16 v[24:27], v[12:15], v[64:71], v1
    v_add_f32_dpp v8, v8, v8 row_ror:4 row_mask:0xf bank_mask:0xf
    v_add_f32_dpp v9, v9, v9 row_ror:4 row_mask:0xf bank_mask:0xf
    v_smfmac_f32_16x16x64_bf16 v[24:27], v[16:19], v[72:79], v1
    v_add_f32_dpp v8, v8, v8 row_ror:2 row_mask:0xf bank_mask:0xf
    v_add_f32_dpp v9, v9, v9 row_ror:2 row_mask:0xf bank_mask:0xf
    v_smfmac_f32_16x16x64_bf16 v[24:27], v[20:23], v[80:87], v1
    v_add_f32_dpp v8, v8, v8 row_ror:1 row_mask:0xf bank_mask:0xf
    v_add_f32_dpp v9, v9, v9 row_ror:1 row_mask:0xf bank_mask:0xf
    v_smfmac_f32_16x16x64_bf16 v[32:35], v[12:15], v[112:119], v1
    v_mul_f32 v8, 0x3acccccd, v8
    v_mul_f32 v9, 0x3acccccd, v9
    v_smfmac_f32_16x16x64_bf16 v[32:35], v[16:19], v[120:127], v1
    v_fma_f32 v9, -v8, v8, v9
    v_max_f32 v9, 0, v9
    v_smfmac_f32_16x16x64_bf16 v[32:35], v[20:23], v[128:135], v1
    v_add_f32 v9, 0x3727c5ac, v9
    v_rsq_f32 v9, v9
    v_smfmac_f32_16x16x64_bf16 v[28:31], v[12:15], v[88:95], v1
    s_mov_b32 vcc_lo, 0x55555555
    v_mul_f32 v9, 0x3dd53b95, v9
    v_smfmac_f32_16x16x64_bf16 v[28:31], v[16:19], v[96:103], v1
    s_mov_b32 vcc_hi, 0x55555555
    v_smfmac_f32_16x16x64_bf16 v[28:31], v[20:23], v[104:111], v1
    v_smfmac_f32_16x16x64_bf16 v[36:39], v[12:15], v[136:143], v1
    v_pk_add_f32 v[24:25], v[24:25], v[26:27]
    v_add_f32 v24, v24, v25
    v_smfmac_f32_16x16x64_bf16 v[36:39], v[16:19], v[144:151], v1
    v_pk_add_f32 v[32:33], v[32:33], v[34:35]
    v_add_f32 v32, v32, v33
    v_smfmac_f32_16x16x64_bf16 v[36:39], v[20:23], v[152:159], v1
    s_nop 0
    v_permlane32_swap_b32 v24, v32
    v_add_f32 v24, v24, v32
    v_pk_add_f32 v[28:29], v[28:29], v[30:31]
    v_add_f32 v28, v28, v29
    s_nop 2
    v_pk_add_f32 v[36:37], v[36:37], v[38:39]
    v_add_f32 v36, v36, v37
    s_nop 1
    v_permlane32_swap_b32 v28, v36
    v_add_f32 v28, v28, v36
    s_nop 1
    v_permlane16_swap_b32 v24, v28
    v_add_f32 v24, v24, v28
    v_fma_f32 v24, -v8, v6, v24
L_pad12:
    s_cbranch_execz L_pad13
    s_nop 1
    v_max_f32_dpp v21, v24, v24 row_ror:8 row_mask:0xf bank_mask:0xf
    s_nop 1
    v_max_f32_dpp v21, v21, v21 row_ror:4 row_mask:0xf bank_mask:0xf
    s_nop 1
    v_max_f32_dpp v21, v21, v21 row_ror:2 row_mask:0xf bank_mask:0xf
    s_nop 1
    v_max_f32_dpp v21, v21, v21 row_ror:1 row_mask:0xf bank_mask:0xf
    s_nop 1
    v_max_f32_dpp v21, v21, v21 row_bcast:15 row_mask:0xa bank_mask:0xf
    s_nop 1
    v_max_f32_dpp v21, v21, v21 row_bcast:31 row_mask:0xc bank_mask:0xf
    s_nop 0
    v_readlane_b32 s57, v21, 63
    s_nop 1
    v_subrev_f32 v24, s57, v24
    v_mul_f32 v24, v24, v9
    v_exp_f32 v22, v24
    v_mul_f32 v20, s57, v9
    s_nop 0
    v_mov_b32_dpp v23, v22 row_shl:1 row_mask:0xf bank_mask:0xf bound_ctrl:0
    v_cvt_pk_bf16_f32 v23, v22, v23
    v_cndmask_b32 v12, 0, v23, vcc
    v_mov_b32 v21, v22
    s_nop 0
    v_mov_b32_dpp v13, v12 row_shl:4 row_mask:0xf bank_mask:0xf bound_ctrl:0
    v_mov_b32_dpp v14, v12 row_shl:8 row_mask:0xf bank_mask:0xf bound_ctrl:0
    v_mov_b32_dpp v15, v12 row_shl:12 row_mask:0xf bank_mask:0xf bound_ctrl:0
    s_nop 1
    v_smfmac_f32_16x16x64_bf16 v[40:43], v[12:15], v[160:167], v1
    v_mov_b32_dpp v16, v12 row_shr:1 row_mask:0xf bank_mask:0xf bound_ctrl:0
    v_mov_b32_dpp v17, v12 row_shl:3 row_mask:0xf bank_mask:0xf bound_ctrl:0
    v_smfmac_f32_16x16x64_bf16 v[44:47], v[12:15], v[176:183], v1
    v_mov_b32_dpp v18, v12 row_shl:7 row_mask:0xf bank_mask:0xf bound_ctrl:0
    v_mov_b32_dpp v19, v12 row_shl:11 row_mask:0xf bank_mask:0xf bound_ctrl:0
    v_smfmac_f32_16x16x64_bf16 v[48:51], v[12:15], v[192:199], v1
    v_permlane32_swap_b32 v21, v22
    v_add_f32 v21, v21, v22
    v_smfmac_f32_16x16x64_bf16 v[52:55], v[12:15], v[208:215], v1
    v_mov_b32 v22, v21
    s_nop 1
    v_permlane16_swap_b32 v21, v22
    v_smfmac_f32_16x16x64_bf16 v[56:59], v[12:15], v[224:231], v1
    v_add_f32 v21, v21, v22
    s_nop 1
    v_add_f32_dpp v21, v21, v21 row_ror:8 row_mask:0xf bank_mask:0xf
    v_smfmac_f32_16x16x64_bf16 v[60:63], v[12:15], v[240:247], v1
    s_nop 0
    v_add_f32_dpp v21, v21, v21 row_ror:4 row_mask:0xf bank_mask:0xf
    s_nop 1
    v_add_f32_dpp v21, v21, v21 row_ror:2 row_mask:0xf bank_mask:0xf
    v_smfmac_f32_16x16x64_bf16 v[40:43], v[16:19], v[168:175], v1
    s_nop 0
    v_add_f32_dpp v21, v21, v21 row_ror:1 row_mask:0xf bank_mask:0xf
    ds_write_b64 v10, v[20:21]
    v_smfmac_f32_16x16x64_bf16 v[44:47], v[16:19], v[184:191], v1
    v_and_b32 v36, 15, v0
    v_lshlrev_b32 v36, 4, v36
    v_add_u32 v36, s61, v36
    v_add_u32 v36, 32768, v36
    v_smfmac_f32_16x16x64_bf16 v[48:51], v[16:19], v[200:207], v1
    v_smfmac_f32_16x16x64_bf16 v[52:55], v[16:19], v[216:223], v1
    s_cmp_ge_u32 s30, 4
    s_cbranch_scc0 L_skip_168
    s_waitcnt lgkmcnt(0)
    s_barrier
L_skip_168:
    v_smfmac_f32_16x16x64_bf16 v[56:59], v[16:19], v[232:239], v1
    v_smfmac_f32_16x16x64_bf16 v[60:63], v[16:19], v[248:255], v1
    v_pk_add_f32 v[24:25], v[40:41], v[42:43]
    v_pk_add_f32 v[26:27], v[44:45], v[46:47]
    s_nop 0
    v_pk_add_f32 v[28:29], v[48:49], v[50:51]
    v_pk_add_f32 v[30:31], v[52:53], v[54:55]
    s_nop 1
    v_pk_add_f32 v[32:33], v[56:57], v[58:59]
    v_pk_add_f32 v[34:35], v[60:61], v[62:63]
    s_mov_b64 exec, 0xffff
    ds_write_b128 v36, v[24:27] offset:0
    ds_write_b128 v36, v[28:31] offset:256
    ds_write_b128 v36, v[32:35] offset:512
    s_mov_b64 exec, -1
    s_cmp_lt_u32 s30, 4
    s_cbranch_scc1 L_old
L_pad13:
    s_cbranch_execz L_pad14
    s_waitcnt lgkmcnt(0)
L_b2_1:
    s_barrier
    s_cmp_lt_u32 s30, 2
    s_cbranch_scc0 L_skip_172
    s_mov_b32 exec_lo, 0xffffffff
    s_mov_b32 exec_hi, 0xffff
    ds_read_b64 v[40:41], v20 offset:0
    ds_read_b64 v[42:43], v20 offset:2048
    ds_read_b64 v[44:45], v20 offset:4096
    ds_read_b64 v[46:47], v20 offset:6144
    ds_read_b64 v[48:49], v20 offset:8192
    ds_read_b64 v[50:51], v20 offset:10240
    ds_read_b64 v[52:53], v20 offset:12288
    ds_read_b64 v[54:55], v20 offset:14336
    s_waitcnt lgkmcnt(7)
    v_mul_f32 v56, s64, v40
    v_mul_f32 v57, s64, v41
    s_waitcnt lgkmcnt(6)
    v_fmac_f32 v56, s65, v42
    v_fmac_f32 v57, s65, v43
    s_waitcnt lgkmcnt(5)
    v_fmac_f32 v56, s66, v44
    v_fmac_f32 v57, s66, v45
    s_waitcnt lgkmcnt(4)
    v_fmac_f32 v56, s67, v46
    v_fmac_f32 v57, s67, v47
    s_waitcnt lgkmcnt(3)
    v_fmac_f32 v56, s68, v48
    v_fmac_f32 v57, s68, v49
    s_waitcnt lgkmcnt(2)
    v_fmac_f32 v56, s69, v50
    v_fmac_f32 v57, s69, v51
    s_waitcnt lgkmcnt(1)
    v_fmac_f32 v56, s70, v52
    v_fmac_f32 v57, s70, v53
    s_waitcnt lgkmcnt(0)
    v_fmac_f32 v56, s71, v54
    v_fmac_f32 v57, s71, v55
    v_cvt_pk_bf16_f32 v56, v56, v57
    v_min_u32 v56, -2, v56
    s_cmp_eq_u32 s55, 0
    s_cbranch_scc1 L_gs_173
    buffer_store_dword v56, v21, s[40:43], 0 offen
L_gb_174:
    s_mov_b64 exec, -1
L_skip_172:
    s_cmp_lt_u32 s3, 20
    s_cbranch_scc0 L_typeB_1
    s_lshr_b32 s57, s30, 1
    s_lshl_b32 s57, s57, 5
    s_add_u32 s57, s57, s62
    s_add_u32 s59, s57, 55936
    v_and_b32 v5, 7, v0
    v_lshlrev_b32 v5, 2, v5
    v_lshrrev_b32 v22, 4, v0
    v_lshlrev_b32 v22, 3, v22
    buffer_load_dword v18, v5, s[40:43], s59 offen sc1
    buffer_load_dwordx2 v[20:21], v22, s[40:43], s59 offen sc1
    s_mul_i32 s57, s30, 6144
    v_lshrrev_b32 v7, 2, v0
    v_lshlrev_b32 v7, 6, v7
    v_bfe_u32 v60, v0, 4, 1
    v_lshl_add_u32 v7, v60, 5, v7
    v_and_b32 v60, 3, v0
    v_lshl_add_u32 v7, v60, 3, v7
    v_add_u32 v7, s57, v7
    v_add_u32 v7, 30720, v7
    v_xor_b32 v8, 32, v7
    s_mul_i32 s60, s30, 1536
    s_add_u32 s60, s60, s62
    s_add_u32 s60, s60, 12288
    v_lshlrev_b32 v9, 4, v0
    v_lshlrev_b32 v10, 3, v0
    ds_read_b64_tr_b16 v[36:37], v7 offset:0
    ds_read_b64_tr_b16 v[38:39], v7 offset:1024
    ds_read_b64_tr_b16 v[40:41], v7 offset:2048
    ds_read_b64_tr_b16 v[42:43], v7 offset:3072
    ds_read_b64_tr_b16 v[44:45], v7 offset:4096
    ds_read_b64_tr_b16 v[46:47], v7 offset:5120
    ds_read_b64_tr_b16 v[48:49], v8 offset:0
    ds_read_b64_tr_b16 v[50:51], v8 offset:1024
    ds_read_b64_tr_b16 v[52:53], v8 offset:2048
    ds_read_b64_tr_b16 v[54:55], v8 offset:3072
    ds_read_b64_tr_b16 v[56:57], v8 offset:4096
    ds_read_b64_tr_b16 v[58:59], v8 offset:5120
    v_mov_b64 v[24:25], 0
    v_mov_b64 v[26:27], 0
    v_mov_b64 v[28:29], 0
    v_mov_b64 v[30:31], 0
    s_lshl_b32 s57, s30, 8
    v_lshlrev_b32 v11, 2, v0
    v_add_u32 v11, s57, v11
    v_add_u32 v11, 157696, v11
    s_waitcnt vmcnt(0)
L_pw_175:
    v_max3_u32 v19, v18, v20, v21
L_pad14:
    s_cbranch_execz L_pad15
    v_cmp_eq_u32 vcc, -1, v19
    s_cbranch_vccnz L_pr_176
    buffer_load_dwordx4 v[12:15], v9, s[40:43], s60 offen sc1
    buffer_load_dwordx2 v[16:17], v10, s[40:43], s60 offen offset:1024 sc1
    v_max_f32_dpp v19, v18, v18 row_ror:4 row_mask:0xf bank_mask:0xf
    s_nop 1
    v_max_f32_dpp v19, v19, v19 row_ror:2 row_mask:0xf bank_mask:0xf
    s_nop 1
    v_max_f32_dpp v19, v19, v19 row_ror:1 row_mask:0xf bank_mask:0xf
    v_sub_f32 v18, v18, v19
    v_sub_f32 v20, v20, v19
    v_sub_f32 v21, v21, v19
    v_exp_f32 v18, v18
    v_exp_f32 v20, v20
    v_exp_f32 v21, v21
    v_add_f32_dpp v18, v18, v18 row_ror:4 row_mask:0xf bank_mask:0xf
    s_nop 1
    v_add_f32_dpp v18, v18, v18 row_ror:2 row_mask:0xf bank_mask:0xf
    s_nop 1
    v_add_f32_dpp v18, v18, v18 row_ror:1 row_mask:0xf bank_mask:0xf
    v_rcp_f32 v18, v18
    s_nop 0
    v_mul_f32 v20, v20, v18
    v_mul_f32 v21, v21, v18
    s_waitcnt lgkmcnt(0)
    s_waitcnt vmcnt(0)
L_pw_177:
    v_max3_u32 v19, v12, v13, v14
    v_max3_u32 v19, v19, v15, v16
    v_max_u32 v19, v19, v17
    v_cmp_eq_u32 vcc, -1, v19
    s_cbranch_vccnz L_pr_178
    v_smfmac_f32_16x16x64_bf16 v[24:27], v[12:15], v[36:43], v1
    v_smfmac_f32_16x16x64_bf16 v[28:31], v[12:15], v[48:55], v1
    v_smfmac_f32_16x16x32_bf16 v[24:27], v[16:17], v[44:47], v1
    v_smfmac_f32_16x16x32_bf16 v[28:31], v[16:17], v[56:59], v1
    s_nop 6
    v_pk_add_f32 v[24:25], v[24:25], v[26:27]
    v_pk_add_f32 v[28:29], v[28:29], v[30:31]
    v_mul_f32 v24, v24, v20
    v_mul_f32 v28, v28, v20
    v_fmac_f32 v24, v25, v21
    v_fmac_f32 v28, v29, v21
    s_nop 1
    v_permlane32_swap_b32 v24, v28
    v_add_f32 v24, v24, v28
    ds_write_b32 v11, v24
    v_lshlrev_b32 v5, 2, v0
    v_add_u32 v5, 157696, v5
    s_mul_i32 s59, s31, 2560
    s_lshl_b32 s58, s3, 7
    s_add_u32 s59, s59, s58
    s_add_u32 s59, s59, 1384384
    v_lshlrev_b32 v9, 2, v0
    s_waitcnt lgkmcnt(0)
    s_barrier
    s_cmp_eq_u32 s30, 2
    s_cbranch_scc0 L_skip_179
    ds_read2st64_b32 v[12:13], v5 offset0:0 offset1:1
    ds_read2st64_b32 v[14:15], v5 offset0:2 offset1:3
    ds_read2st64_b32 v[16:17], v5 offset0:4 offset1:5
    ds_read2st64_b32 v[18:19], v5 offset0:6 offset1:7
    s_waitcnt lgkmcnt(2)
    v_pk_add_f32 v[12:13], v[12:13], v[14:15]
    s_waitcnt lgkmcnt(0)
    v_pk_add_f32 v[16:17], v[16:17], v[18:19]
    v_pk_add_f32 v[12:13], v[12:13], v[16:17]
    v_add_f32 v12, v12, v13
    v_mov_b32 v13, v12
    s_nop 1
    v_permlane16_swap_b32 v12, v13
    v_add_f32 v12, v12, v13
    v_min_u32 v12, -2, v12
    s_mov_b32 exec_lo, 0xffff0000
    s_mov_b32 exec_hi, 0xffff
    buffer_store_dword v12, v9, s[40:43], s59 offen sc1
    s_lshl_b32 s57, s3, 2
    s_add_u32 s57, s57, s62
    s_add_u32 s57, s57, 56320
    s_mov_b64 exec, 0x1
    s_cmp_eq_u32 s55, 0
    s_cbranch_scc1 L_gs_180
    buffer_store_dword v0, v0, s[40:43], s57 offen
L_gb_181:
    s_mov_b64 exec, -1
L_skip_179:
    s_sub_u32 s57, s30, 5
    s_cmp_lt_u32 s57, 2
    s_cbranch_scc0 L_skip_182
    s_sub_u32 s60, s30, 5
    s_mul_i32 s59, s60, 6144
    s_add_u32 s59, s59, 79872
    s_mul_i32 s57, s31, 384
    v_lshlrev_b32 v5, 1, v0
L_pad15:
    s_cbranch_execz L_pad16
    v_add_u32 v5, s57, v5
    global_load_ushort v8, v5, s[18:19] offset:0
    global_load_ushort v9, v5, s[18:19] offset:128
    global_load_ushort v10, v5, s[18:19] offset:256
    v_lshlrev_b32 v11, 4, v0
    v_lshrrev_b32 v7, 4, v0
    v_lshlrev_b32 v7, 8, v7
    v_bfe_u32 v60, v0, 2, 2
    v_lshl_add_u32 v7, v60, 5, v7
    v_and_b32 v60, 3, v0
    v_lshl_add_u32 v7, v60, 3, v7
    v_add_u32 v7, s59, v7
    s_mul_i32 s57, s31, 2560
    s_lshl_b32 s58, s3, 7
    s_add_u32 s57, s57, s58
    s_lshl_b32 s60, s60, 6
    s_add_u32 s60, s60, s57
    s_add_u32 s60, s60, 1404928
    s_add_u32 s58, s62, 49152
    s_add_u32 s59, s58, 3072
    buffer_load_dwordx4 v[12:15], v11, s[40:43], s58 offen offset:0 sc1
    buffer_load_dwordx4 v[16:19], v11, s[40:43], s58 offen offset:1024 sc1
    buffer_load_dwordx4 v[20:23], v11, s[40:43], s58 offen offset:2048 sc1
    buffer_load_dwordx4 v[24:27], v11, s[40:43], s59 offen offset:0 sc1
    buffer_load_dwordx4 v[28:31], v11, s[40:43], s59 offen offset:1024 sc1
    buffer_load_dwordx4 v[32:35], v11, s[40:43], s59 offen offset:2048 sc1
    s_waitcnt vmcnt(0)
L_pw_183:
    v_max3_u32 v60, v12, v13, v14
    v_max3_u32 v60, v60, v15, v16
    v_max3_u32 v60, v60, v17, v18
    v_max3_u32 v60, v60, v19, v20
    v_max3_u32 v60, v60, v21, v22
    v_max3_u32 v60, v60, v23, v24
    v_max3_u32 v60, v60, v25, v26
    v_max3_u32 v60, v60, v27, v28
    v_max3_u32 v60, v60, v29, v30
    v_max3_u32 v60, v60, v31, v32
    v_max3_u32 v60, v60, v33, v34
    v_max_u32 v60, v60, v35
    v_cmp_eq_u32 vcc, -1, v60
    s_cbranch_vccnz L_pr_184
    ds_read_b64_tr_b16 v[36:37], v7 offset:0
    ds_read_b64_tr_b16 v[38:39], v7 offset:128
    ds_read_b64_tr_b16 v[40:41], v7 offset:1024
    ds_read_b64_tr_b16 v[42:43], v7 offset:1152
    ds_read_b64_tr_b16 v[44:45], v7 offset:2048
    ds_read_b64_tr_b16 v[46:47], v7 offset:2176
    ds_read_b64_tr_b16 v[48:49], v7 offset:3072
    ds_read_b64_tr_b16 v[50:51], v7 offset:3200
    ds_read_b64_tr_b16 v[52:53], v7 offset:4096
    ds_read_b64_tr_b16 v[54:55], v7 offset:4224
    ds_read_b64_tr_b16 v[56:57], v7 offset:5120
    ds_read_b64_tr_b16 v[58:59], v7 offset:5248
    v_pk_add_f32 v[12:13], v[12:13], v[14:15]
    v_pk_add_f32 v[16:17], v[16:17], v[18:19]
    v_pk_add_f32 v[12:13], v[12:13], v[16:17]
    v_add_f32 v4, v12, v13
    v_pk_add_f32 v[20:21], v[20:21], v[22:23]
    v_pk_add_f32 v[24:25], v[24:25], v[26:27]
    v_pk_add_f32 v[20:21], v[20:21], v[24:25]
    v_add_f32 v5, v20, v21
    v_pk_add_f32 v[28:29], v[28:29], v[30:31]
    v_pk_add_f32 v[32:33], v[32:33], v[34:35]
    v_pk_add_f32 v[28:29], v[28:29], v[32:33]
    v_add_f32 v7, v28, v29
    v_lshlrev_b32 v8, 16, v8
    v_lshlrev_b32 v9, 16, v9
    v_lshlrev_b32 v10, 16, v10
    v_mov_b64 v[60:61], 0
    v_mov_b64 v[62:63], 0
    s_add_u32 s58, s62, 43008
    s_add_u32 s57, s62, 55680
    s_add_u32 s59, s58, 3072
    s_mov_b32 s64, 0xbdd2d3e8
    v_and_b32 v12, 7, v0
L_pad16:
    s_cbranch_execz L_pad17
    v_lshlrev_b32 v12, 3, v12
    buffer_load_dwordx2 v[2:3], v12, s[40:43], s57 offen sc1
    s_waitcnt lgkmcnt(0)
    s_waitcnt vmcnt(0)
L_pw_185:
    v_max_u32 v13, v2, v3
    v_cmp_eq_u32 vcc, -1, v13
    s_cbranch_vccnz L_pr_186
    buffer_load_dwordx4 v[12:15], v11, s[40:43], s58 offen offset:0 sc1
    buffer_load_dwordx4 v[16:19], v11, s[40:43], s58 offen offset:1024 sc1
    buffer_load_dwordx4 v[20:23], v11, s[40:43], s58 offen offset:2048 sc1
    buffer_load_dwordx4 v[24:27], v11, s[40:43], s59 offen offset:0 sc1
    buffer_load_dwordx4 v[28:31], v11, s[40:43], s59 offen offset:1024 sc1
    buffer_load_dwordx4 v[32:35], v11, s[40:43], s59 offen offset:2048 sc1
    v_add_f32_dpp v2, v2, v2 row_ror:4 row_mask:0xf bank_mask:0xf
    v_add_f32_dpp v3, v3, v3 row_ror:4 row_mask:0xf bank_mask:0xf
    s_nop 0
    v_add_f32_dpp v2, v2, v2 row_ror:2 row_mask:0xf bank_mask:0xf
    v_add_f32_dpp v3, v3, v3 row_ror:2 row_mask:0xf bank_mask:0xf
    s_nop 0
    v_add_f32_dpp v2, v2, v2 row_ror:1 row_mask:0xf bank_mask:0xf
    v_add_f32_dpp v3, v3, v3 row_ror:1 row_mask:0xf bank_mask:0xf
    v_mul_f32 v2, 0x3acccccd, v2
    v_mul_f32 v3, 0x3acccccd, v3
    v_fma_f32 v3, -v2, v2, v3
    v_max_f32 v3, 0, v3
    v_add_f32 v3, 0x3727c5ac, v3
    v_rsq_f32 v3, v3
    s_nop 0
    v_mul_f32 v2, v2, v3
    v_fma_f32 v8, -v2, v4, v8
    v_fma_f32 v9, -v2, v5, v9
    v_fma_f32 v10, -v2, v7, v10
    v_lshlrev_b32 v7, 2, v0
    v_mov_b32 v2, 0xc0135761
    s_waitcnt vmcnt(4)
    v_pk_add_f32 v[12:13], v[12:13], v[14:15]
    v_pk_add_f32 v[16:17], v[16:17], v[18:19]
    v_pk_add_f32 v[12:13], v[12:13], v[16:17]
    v_add_f32 v12, v12, v13
    s_waitcnt vmcnt(2)
    v_pk_add_f32 v[20:21], v[20:21], v[22:23]
    v_pk_add_f32 v[24:25], v[24:25], v[26:27]
    v_pk_add_f32 v[20:21], v[20:21], v[24:25]
    v_add_f32 v13, v20, v21
    s_waitcnt vmcnt(0)
    v_pk_add_f32 v[28:29], v[28:29], v[30:31]
    v_pk_add_f32 v[32:33], v[32:33], v[34:35]
    v_pk_add_f32 v[28:29], v[28:29], v[32:33]
    v_add_f32 v14, v28, v29
    v_add_f32 v15, v12, v13
    v_cmp_u_f32 vcc, v15, v14
    s_cbranch_vccnz L_hr_187
L_hk_188:
    v_fma_f32 v12, v12, v3, v8
    v_fma_f32 v13, v13, v3, v9
    v_fma_f32 v14, v14, v3, v10
    v_mul_f32 v16, v12, v12
    v_mul_f32 v17, v13, v13
    v_mul_f32 v18, v14, v14
    v_fma_f32 v16, v16, s64, v2
    v_fma_f32 v17, v17, s64, v2
    v_fma_f32 v18, v18, s64, v2
    v_mul_f32 v16, v16, v12
    v_mul_f32 v17, v17, v13
    v_mul_f32 v18, v18, v14
    v_exp_f32 v16, v16
    v_exp_f32 v17, v17
    v_exp_f32 v18, v18
    v_add_f32 v16, 1.0, v16
    v_add_f32 v17, 1.0, v17
    v_add_f32 v18, 1.0, v18
    v_rcp_f32 v16, v16
    v_rcp_f32 v17, v17
    v_rcp_f32 v18, v18
    v_mul_f32 v12, v12, v16
    v_mul_f32 v13, v13, v17
    v_mul_f32 v14, v14, v18
    v_mov_b32_dpp v16, v12 row_shl:1 row_mask:0xf bank_mask:0xf bound_ctrl:0
    v_mov_b32_dpp v17, v13 row_shl:1 row_mask:0xf bank_mask:0xf bound_ctrl:0
    v_mov_b32_dpp v18, v14 row_shl:1 row_mask:0xf bank_mask:0xf bound_ctrl:0
    v_cvt_pk_bf16_f32 v20, v12, v16
    v_cvt_pk_bf16_f32 v24, v13, v17
    v_cvt_pk_bf16_f32 v28, v14, v18
    v_mov_b32_dpp v21, v20 row_shl:4 row_mask:0xf bank_mask:0xf bound_ctrl:0
    v_mov_b32_dpp v22, v20 row_shl:8 row_mask:0xf bank_mask:0xf bound_ctrl:0
L_pad17:
    s_cbranch_execz L_pad18
    v_mov_b32_dpp v23, v20 row_shl:12 row_mask:0xf bank_mask:0xf bound_ctrl:0
    v_mov_b32_dpp v25, v24 row_shl:4 row_mask:0xf bank_mask:0xf bound_ctrl:0
    v_mov_b32_dpp v26, v24 row_shl:8 row_mask:0xf bank_mask:0xf bound_ctrl:0
    v_mov_b32_dpp v27, v24 row_shl:12 row_mask:0xf bank_mask:0xf bound_ctrl:0
    v_smfmac_f32_16x16x64_bf16 v[60:63], v[20:23], v[36:43], v1
    v_mov_b32_dpp v29, v28 row_shl:4 row_mask:0xf bank_mask:0xf bound_ctrl:0
    v_mov_b32_dpp v30, v28 row_shl:8 row_mask:0xf bank_mask:0xf bound_ctrl:0
    v_mov_b32_dpp v31, v28 row_shl:12 row_mask:0xf bank_mask:0xf bound_ctrl:0
    v_smfmac_f32_16x16x64_bf16 v[60:63], v[24:27], v[44:51], v1
    s_nop 0
    v_smfmac_f32_16x16x64_bf16 v[60:63], v[28:31], v[52:59], v1
    s_nop 7
    v_add_f32 v60, v60, v62
    v_min_u32 v60, -2, v60
    s_mov_b64 exec, 0xffff
    buffer_store_dword v60, v7, s[40:43], s60 offen sc1
    s_cmp_eq_u32 s30, 6
    s_cbranch_scc0 L_skip_191
    s_lshl_b32 s57, s3, 2
    s_add_u32 s57, s57, s62
    s_add_u32 s57, s57, 56448
    s_mov_b64 exec, 0x1
    s_cmp_eq_u32 s55, 0
    s_cbranch_scc1 L_gs_192
    buffer_store_dword v0, v0, s[40:43], s57 offen
L_gb_193:
    s_mov_b64 exec, -1
L_skip_191:
    s_mov_b64 exec, -1
L_skip_182:
    s_branch L_done
L_typeB_1:
    s_cmp_eq_u32 s53, 3
    s_cbranch_scc0 L_done
    s_cmp_lt_u32 s30, 6
    s_cbranch_scc0 L_skip_194
    s_lshr_b32 s57, s30, 1
    s_mul_i32 s57, s57, 128
    s_and_b32 s58, s30, 1
    s_lshl_b32 s58, s58, 6
    s_add_u32 s57, s57, s58
    v_lshrrev_b32 v18, 5, v0
    v_lshlrev_b32 v18, 13, v18
    v_bfe_u32 v60, v0, 3, 1
    v_lshl_add_u32 v18, v60, 12, v18
    v_bfe_u32 v60, v0, 4, 1
    v_lshl_add_u32 v18, v60, 11, v18
    v_bfe_u32 v60, v0, 2, 1
    v_mul_u32_u24 v60, 384, v60
    v_add_u32 v18, v60, v18
    v_and_b32 v60, 3, v0
    v_lshl_add_u32 v18, v60, 3, v18
    v_add_u32 v18, s57, v18
    v_add_u32 v18, 30720, v18
    v_bfe_u32 v19, v0, 4, 1
    v_lshlrev_b32 v19, 12, v19
    v_bfe_u32 v60, v0, 3, 1
    v_lshl_add_u32 v19, v60, 11, v19
    v_bfe_u32 v60, v0, 2, 1
    v_mul_u32_u24 v60, 384, v60
    v_add_u32 v19, v60, v19
    v_and_b32 v60, 3, v0
    v_lshl_add_u32 v19, v60, 3, v19
    v_add_u32 v19, s57, v19
    v_add_u32 v19, 63488, v19
    ds_read_b64_tr_b16 v[36:37], v18 offset:0
    ds_read_b64_tr_b16 v[38:39], v18 offset:1024
    ds_read_b64_tr_b16 v[40:41], v18 offset:16384
    ds_read_b64_tr_b16 v[42:43], v18 offset:17408
    ds_read_b64_tr_b16 v[44:45], v19 offset:0
    ds_read_b64_tr_b16 v[46:47], v19 offset:1024
    ds_read_b64_tr_b16 v[48:49], v18 offset:32
    ds_read_b64_tr_b16 v[50:51], v18 offset:1056
    ds_read_b64_tr_b16 v[52:53], v18 offset:16416
    ds_read_b64_tr_b16 v[54:55], v18 offset:17440
    ds_read_b64_tr_b16 v[56:57], v19 offset:32
    ds_read_b64_tr_b16 v[58:59], v19 offset:1056
    v_lshrrev_b32 v32, 4, v0
    v_lshlrev_b32 v32, 5, v32
    v_bfe_u32 v60, v0, 1, 1
    v_lshl_add_u32 v32, v60, 4, v32
    v_and_b32 v60, 1, v0
    v_mul_u32_u24 v60, 192, v60
    v_add_u32 v32, v60, v32
    v_add_u32 v32, 159872, v32
L_pad18:
    s_cbranch_execz L_pad19
    v_lshrrev_b32 v33, 4, v0
    v_lshlrev_b32 v33, 4, v33
    v_bfe_u32 v60, v0, 1, 1
    v_lshl_add_u32 v33, v60, 3, v33
    v_and_b32 v60, 1, v0
    v_mul_u32_u24 v60, 192, v60
    v_add_u32 v33, v60, v33
    v_add_u32 v33, 160000, v33
    v_mov_b64 v[24:25], 0
    v_mov_b64 v[26:27], 0
    v_mov_b64 v[28:29], 0
    v_mov_b64 v[30:31], 0
    s_lshr_b32 s57, s30, 1
    s_lshl_b32 s57, s57, 11
    s_and_b32 s58, s30, 1
    s_lshl_b32 s58, s58, 9
    s_add_u32 s57, s57, s58
    s_lshr_b32 s58, s54, 2
    s_lshl_b32 s58, s58, 10
    s_add_u32 s57, s57, s58
    s_and_b32 s58, s54, 3
    s_lshl_b32 s58, s58, 2
    s_add_u32 s57, s57, s58
    v_and_b32 v34, 31, v0
    v_lshlrev_b32 v34, 4, v34
    v_add_u32 v34, s57, v34
    s_add_u32 s59, s62, 43008
    s_add_u32 s60, s62, 55680
L_skip_194:
    s_cmp_eq_u32 s30, 7
    s_cbranch_scc0 L_skip_195
    v_and_b32 v60, 31, v0
    v_min_u32 v60, 19, v60
    s_mul_i32 s57, s54, 320
    v_lshrrev_b32 v5, 5, v0
    v_mul_u32_u24 v5, 2560, v5
    v_add_u32 v5, s57, v5
    v_lshl_add_u32 v5, v60, 4, v5
    v_and_b32 v60, 31, v0
    v_cmp_gt_u32 s[64:65], 20, v60
    v_min_u32 v60, 19, v60
    v_lshrrev_b32 v35, 5, v0
    v_lshlrev_b32 v35, 2, v35
    v_add_u32 v35, 159872, v35
    v_lshl_add_u32 v35, v60, 3, v35
    s_add_u32 s66, s62, 43008
    s_add_u32 s67, s62, 55680
    s_lshl_b32 s57, s54, 3
    v_lshrrev_b32 v34, 5, v0
    v_lshlrev_b32 v34, 2, v34
    v_add_u32 v34, s57, v34
    v_mov_b32 v61, 0x3f803f80
    s_add_u32 s57, s62, 56320
    v_min_u32 v9, 19, v0
    v_lshlrev_b32 v9, 2, v9
    buffer_load_dword v12, v9, s[40:43], s57 offen sc1
    s_waitcnt vmcnt(0)
L_pw_196:
    v_cmp_eq_u32 vcc, -1, v12
    s_cbranch_vccnz L_pr_197
    s_mov_b32 s57, 1384448
    buffer_load_dwordx4 v[12:15], v5, s[40:43], s57 offen sc1
    s_mov_b32 s58, 1389568
    buffer_load_dwordx4 v[16:19], v5, s[40:43], s58 offen sc1
    s_mov_b32 s59, 1394688
    buffer_load_dwordx4 v[20:23], v5, s[40:43], s59 offen sc1
    s_mov_b32 s60, 1399808
    buffer_load_dwordx4 v[24:27], v5, s[40:43], s60 offen sc1
L_gw_198:
    s_waitcnt vmcnt(2)
    v_pk_add_f32 v[28:29], v[12:13], v[16:17]
    v_pk_add_f32 v[30:31], v[14:15], v[18:19]
    s_waitcnt vmcnt(1)
    v_pk_add_f32 v[28:29], v[28:29], v[20:21]
    v_pk_add_f32 v[30:31], v[30:31], v[22:23]
    s_waitcnt vmcnt(0)
    v_pk_add_f32 v[28:29], v[28:29], v[24:25]
    v_pk_add_f32 v[30:31], v[30:31], v[26:27]
    s_nop 1
    v_permlane32_swap_b32 v28, v30
    v_permlane32_swap_b32 v29, v31
    v_pk_add_f32 v[28:29], v[28:29], v[30:31]
    v_pk_add_f32 v[28:29], v[28:29], v[2:3]
    v_cmp_u_f32 vcc, v28, v29
    s_cbranch_vccnz L_gr_199
L_gk_200:
    v_cvt_pk_bf16_f32 v28, v28, v29
    ds_write_b32 v35, v28
    s_waitcnt lgkmcnt(0)
L_skip_195:
    s_barrier
    s_cmp_lt_u32 s30, 6
    s_cbranch_scc0 L_skip_205
    ds_read_b128 v[12:15], v32
    ds_read_b64 v[16:17], v33
L_pad19:
    s_cbranch_execz L_pad20
    s_waitcnt lgkmcnt(1)
    v_smfmac_f32_16x16x64_bf16 v[24:27], v[12:15], v[36:43], v1
    v_smfmac_f32_16x16x64_bf16 v[28:31], v[12:15], v[48:55], v1
    s_waitcnt lgkmcnt(0)
    v_smfmac_f32_16x16x32_bf16 v[24:27], v[16:17], v[44:47], v1
    v_smfmac_f32_16x16x32_bf16 v[28:31], v[16:17], v[56:59], v1
    s_nop 6
    v_add_f32 v12, v24, v26
    s_nop 1
    v_add_f32_dpp v12, v28, v30 quad_perm:[0,1,2,3] row_mask:0x2 bank_mask:0xf
    v_min_u32 v12, -2, v12
    s_mov_b32 exec_lo, 0xffffffff
    s_mov_b32 exec_hi, 0x0
    s_cmp_eq_u32 s55, 0
    s_cbranch_scc1 L_gs_206
    buffer_store_dword v12, v34, s[40:43], s59 offen
L_gb_207:
    s_mov_b64 exec, -1
L_skip_205:
    s_cmp_eq_u32 s30, 7
    s_cbranch_scc0 L_skip_208
    v_lshlrev_b32 v2, 16, v28
    v_and_b32 v3, 0xffff0000, v28
    v_cndmask_b32 v28, 0, v28, s[64:65]
    v_dot2_f32_bf16 v27, v28, v61, 0
    v_dot2_f32_bf16 v62, v28, v28, 0
    s_nop 2
    v_permlane32_swap_b32 v27, v62
    v_add_f32 v27, v27, v62
    v_mov_b32 v62, v27
    s_nop 1
    v_permlane16_swap_b32 v27, v62
    v_add_f32 v27, v27, v62
    s_nop 1
    v_add_f32_dpp v27, v27, v27 row_ror:8 row_mask:0xf bank_mask:0xf
    s_nop 1
    v_add_f32_dpp v27, v27, v27 row_ror:4 row_mask:0xf bank_mask:0xf
    s_nop 1
    v_add_f32_dpp v27, v27, v27 row_ror:2 row_mask:0xf bank_mask:0xf
    s_nop 1
    v_add_f32_dpp v27, v27, v27 row_ror:1 row_mask:0xf bank_mask:0xf
    v_min_u32 v27, -2, v27
    s_mov_b32 exec_lo, 0x1
    s_mov_b32 exec_hi, 0x1
    s_cmp_eq_u32 s55, 0
    s_cbranch_scc1 L_gs_209
    buffer_store_dword v27, v34, s[40:43], s67 offen
L_gb_210:
    s_mov_b64 exec, -1
L_skip_208:
    s_cmp_eq_u32 s30, 7
    s_cbranch_scc0 L_done
    s_cmp_eq_u32 s31, 0
    s_cbranch_scc0 L_done
    v_lshlrev_b32 v60, 16, v4
    v_add_f32 v2, v2, v60
    v_and_b32 v60, 0xffff0000, v4
    v_add_f32 v3, v3, v60
    v_and_b32 v60, 31, v0
    v_min_u32 v60, 19, v60
    s_mul_i32 s57, s54, 160
    v_lshrrev_b32 v7, 5, v0
    v_lshlrev_b32 v7, 2, v7
    v_add_u32 v7, s57, v7
    v_lshl_add_u32 v7, v60, 3, v7
    s_add_u32 s57, s62, 56448
    v_min_u32 v9, 19, v0
    v_lshlrev_b32 v9, 2, v9
    buffer_load_dword v12, v9, s[40:43], s57 offen sc1
    s_waitcnt vmcnt(0)
L_pw_211:
    v_cmp_eq_u32 vcc, -1, v12
    s_cbranch_vccnz L_pr_212
    s_mov_b32 s57, 1404928
    buffer_load_dwordx4 v[12:15], v5, s[40:43], s57 offen sc1
    s_mov_b32 s58, 1410048
    buffer_load_dwordx4 v[16:19], v5, s[40:43], s58 offen sc1
    s_mov_b32 s59, 1415168
    buffer_load_dwordx4 v[20:23], v5, s[40:43], s59 offen sc1
    s_mov_b32 s60, 1420288
    buffer_load_dwordx4 v[24:27], v5, s[40:43], s60 offen sc1
L_gw_213:
    s_waitcnt vmcnt(2)
    v_pk_add_f32 v[28:29], v[12:13], v[16:17]
    v_pk_add_f32 v[30:31], v[14:15], v[18:19]
    s_waitcnt vmcnt(1)
    v_pk_add_f32 v[28:29], v[28:29], v[20:21]
    v_pk_add_f32 v[30:31], v[30:31], v[22:23]
    s_waitcnt vmcnt(0)
    v_pk_add_f32 v[28:29], v[28:29], v[24:25]
    v_pk_add_f32 v[30:31], v[30:31], v[26:27]
    s_nop 1
    v_permlane32_swap_b32 v28, v30
    v_permlane32_swap_b32 v29, v31
    v_pk_add_f32 v[28:29], v[28:29], v[30:31]
    v_pk_add_f32 v[28:29], v[28:29], v[2:3]
L_pad20:
    s_cbranch_execz L_pad21
    v_cmp_u_f32 vcc, v28, v29
    s_cbranch_vccnz L_gr_214
L_gk_215:
    v_cvt_pk_bf16_f32 v28, v28, v29
    global_store_dword v7, v28, s[24:25]
    s_branch L_done
L_gs_25:
    buffer_store_dword v27, v34, s[40:43], s67 offen sc1
    s_branch L_gb_26
L_gs_28:
    buffer_store_dword v12, v34, s[40:43], s59 offen sc1
    s_branch L_gb_29
L_cr_40:
    s_sub_u32 s56, s56, 1
    s_cbranch_scc1 L_done
    global_load_dword v2, v3, s[26:27] sc1
    s_waitcnt vmcnt(0)
    s_branch L_cw_39
L_cr_52:
    s_sub_u32 s56, s56, 1
    s_cbranch_scc1 L_done
    global_load_dword v2, v3, s[26:27] sc1
    s_branch L_cw_51
L_pr_59:
    s_sub_u32 s56, s56, 1
    s_cbranch_scc1 L_done
    buffer_load_dwordx4 v[24:27], v3, s[40:43], 0 offen sc1
    s_waitcnt vmcnt(0)
    s_branch L_pw_58
L_gs_65:
    buffer_store_dword v27, v34, s[40:43], s67 offen sc1
    s_branch L_gb_66
L_gs_68:
    buffer_store_dword v12, v34, s[40:43], s59 offen sc1
    s_branch L_gb_69
L_pr_72:
    s_sub_u32 s56, s56, 1
    s_cbranch_scc1 L_done
    buffer_load_dword v17, v16, s[40:43], s72 offen offset:128 sc1
    s_waitcnt vmcnt(0)
    s_branch L_pw_71
L_gs_87:
    buffer_store_dword v22, v23, s[40:43], s57 offen sc1
    s_branch L_gb_88
L_gs_98:
    buffer_store_dword v56, v21, s[40:43], 0 offen sc1
    s_branch L_gb_99
L_pr_102:
    s_sub_u32 s56, s56, 1
    s_cbranch_scc1 L_done
    buffer_load_dword v18, v5, s[40:43], s59 offen sc1
    buffer_load_dwordx2 v[20:21], v22, s[40:43], s59 offen sc1
    s_waitcnt vmcnt(0)
    s_branch L_pw_101
L_pr_104:
    s_sub_u32 s56, s56, 1
    s_cbranch_scc1 L_done
    buffer_load_dwordx4 v[12:15], v9, s[40:43], s60 offen sc1
    buffer_load_dwordx2 v[16:17], v10, s[40:43], s60 offen offset:1024 sc1
    s_waitcnt vmcnt(0)
    s_branch L_pw_103
L_gs_106:
    buffer_store_dword v0, v0, s[40:43], s57 offen sc1
    s_branch L_gb_107
L_pr_110:
    s_sub_u32 s56, s56, 1
    s_cbranch_scc1 L_done
    buffer_load_dwordx4 v[12:15], v11, s[40:43], s58 offen offset:0 sc1
    buffer_load_dwordx4 v[16:19], v11, s[40:43], s58 offen offset:1024 sc1
    buffer_load_dwordx4 v[20:23], v11, s[40:43], s58 offen offset:2048 sc1
    buffer_load_dwordx4 v[24:27], v11, s[40:43], s59 offen offset:0 sc1
    buffer_load_dwordx4 v[28:31], v11, s[40:43], s59 offen offset:1024 sc1
    buffer_load_dwordx4 v[32:35], v11, s[40:43], s59 offen offset:2048 sc1
    s_waitcnt vmcnt(0)
    s_branch L_pw_109
L_pr_112:
    s_sub_u32 s56, s56, 1
    s_cbranch_scc1 L_done
    buffer_load_dwordx2 v[2:3], v12, s[40:43], s57 offen sc1
    s_waitcnt vmcnt(0)
    s_branch L_pw_111
L_pr_116:
    s_sub_u32 s56, s56, 1
    s_cbranch_scc1 L_done
    buffer_load_dwordx4 v[12:15], v11, s[40:43], s58 offen offset:0 sc1
    buffer_load_dwordx4 v[16:19], v11, s[40:43], s58 offen offset:1024 sc1
    buffer_load_dwordx4 v[20:23], v11, s[40:43], s58 offen offset:2048 sc1
    buffer_load_dwordx4 v[24:27], v11, s[40:43], s59 offen offset:0 sc1
    buffer_load_dwordx4 v[28:31], v11, s[40:43], s59 offen offset:1024 sc1
    buffer_load_dwordx4 v[32:35], v11, s[40:43], s59 offen offset:2048 sc1
    s_waitcnt vmcnt(0)
    s_branch L_pw_115
L_hr_113:
    buffer_load_dwordx4 v[12:15], v11, s[40:43], s58 offen offset:0 sc1
    buffer_load_dwordx4 v[16:19], v11, s[40:43], s58 offen offset:1024 sc1
    buffer_load_dwordx4 v[20:23], v11, s[40:43], s58 offen offset:2048 sc1
    buffer_load_dwordx4 v[24:27], v11, s[40:43], s59 offen offset:0 sc1
    buffer_load_dwordx4 v[28:31], v11, s[40:43], s59 offen offset:1024 sc1
    buffer_load_dwordx4 v[32:35], v11, s[40:43], s59 offen offset:2048 sc1
    s_waitcnt vmcnt(0)
L_pw_115:
    v_max3_u32 v4, v12, v13, v14
    v_max3_u32 v4, v4, v15, v16
    v_max3_u32 v4, v4, v17, v18
    v_max3_u32 v4, v4, v19, v20
    v_max3_u32 v4, v4, v21, v22
L_pad21:
    s_cbranch_execz L_pad22
    v_max3_u32 v4, v4, v23, v24
    v_max3_u32 v4, v4, v25, v26
    v_max3_u32 v4, v4, v27, v28
    v_max3_u32 v4, v4, v29, v30
    v_max3_u32 v4, v4, v31, v32
    v_max3_u32 v4, v4, v33, v34
    v_max_u32 v4, v4, v35
    v_cmp_eq_u32 vcc, -1, v4
    s_cbranch_vccnz L_pr_116
    v_pk_add_f32 v[12:13], v[12:13], v[14:15]
    v_pk_add_f32 v[16:17], v[16:17], v[18:19]
    v_pk_add_f32 v[12:13], v[12:13], v[16:17]
    v_add_f32 v12, v12, v13
    v_pk_add_f32 v[20:21], v[20:21], v[22:23]
    v_pk_add_f32 v[24:25], v[24:25], v[26:27]
    v_pk_add_f32 v[20:21], v[20:21], v[24:25]
    v_add_f32 v13, v20, v21
    v_pk_add_f32 v[28:29], v[28:29], v[30:31]
    v_pk_add_f32 v[32:33], v[32:33], v[34:35]
    v_pk_add_f32 v[28:29], v[28:29], v[32:33]
    v_add_f32 v14, v28, v29
    s_branch L_hk_114
L_gs_118:
    buffer_store_dword v0, v0, s[40:43], s57 offen sc1
    s_branch L_gb_119
L_gs_121:
    buffer_store_dword v12, v34, s[40:43], s60 offen sc1
    s_branch L_gb_122
L_pr_125:
    s_sub_u32 s56, s56, 1
    s_cbranch_scc1 L_done
    buffer_load_dword v12, v9, s[40:43], s57 offen sc1
    s_waitcnt vmcnt(0)
    s_branch L_pw_124
L_gr_127:
    s_sub_u32 s56, s56, 1
    s_cbranch_scc1 L_done
    s_mov_b64 s[74:75], 0
    v_max3_u32 v30, v12, v13, v14
    v_max_u32 v30, v30, v15
    v_cmp_eq_u32 vcc, -1, v30
    s_cbranch_vccz L_gn_129
    s_or_b64 s[74:75], s[74:75], vcc
    s_mov_b64 exec, vcc
    buffer_load_dwordx4 v[12:15], v5, s[40:43], s57 offen sc1
    s_mov_b64 exec, -1
L_gn_129:
    v_max3_u32 v30, v16, v17, v18
    v_max_u32 v30, v30, v19
    v_cmp_eq_u32 vcc, -1, v30
    s_cbranch_vccz L_gn_130
    s_or_b64 s[74:75], s[74:75], vcc
    s_mov_b64 exec, vcc
    buffer_load_dwordx4 v[16:19], v5, s[40:43], s58 offen sc1
    s_mov_b64 exec, -1
L_gn_130:
    v_max3_u32 v30, v20, v21, v22
    v_max_u32 v30, v30, v23
    v_cmp_eq_u32 vcc, -1, v30
    s_cbranch_vccz L_gn_131
    s_or_b64 s[74:75], s[74:75], vcc
    s_mov_b64 exec, vcc
    buffer_load_dwordx4 v[20:23], v5, s[40:43], s59 offen sc1
    s_mov_b64 exec, -1
L_gn_131:
    v_max3_u32 v30, v24, v25, v26
    v_max_u32 v30, v30, v27
    v_cmp_eq_u32 vcc, -1, v30
    s_cbranch_vccz L_gn_132
    s_or_b64 s[74:75], s[74:75], vcc
    s_mov_b64 exec, vcc
    buffer_load_dwordx4 v[24:27], v5, s[40:43], s60 offen sc1
    s_mov_b64 exec, -1
L_gn_132:
    s_cmp_eq_u64 s[74:75], 0
    s_cbranch_scc1 L_gk_128
    s_waitcnt vmcnt(0)
    s_branch L_gw_126
L_gs_134:
    buffer_store_dword v12, v34, s[40:43], s59 offen sc1
    s_branch L_gb_135
L_gs_137:
    buffer_store_dword v27, v34, s[40:43], s67 offen sc1
    s_branch L_gb_138
L_pr_143:
    s_sub_u32 s56, s56, 1
    s_cbranch_scc1 L_done
    buffer_load_dword v12, v9, s[40:43], s57 offen sc1
    s_waitcnt vmcnt(0)
    s_branch L_pw_142
L_gr_145:
    s_sub_u32 s56, s56, 1
    s_cbranch_scc1 L_done
    s_mov_b64 s[74:75], 0
    v_max3_u32 v30, v12, v13, v14
    v_max_u32 v30, v30, v15
    v_cmp_eq_u32 vcc, -1, v30
    s_cbranch_vccz L_gn_147
    s_or_b64 s[74:75], s[74:75], vcc
    s_mov_b64 exec, vcc
    buffer_load_dwordx4 v[12:15], v5, s[40:43], s57 offen sc1
    s_mov_b64 exec, -1
L_gn_147:
    v_max3_u32 v30, v16, v17, v18
    v_max_u32 v30, v30, v19
    v_cmp_eq_u32 vcc, -1, v30
    s_cbranch_vccz L_gn_148
L_pad22:
    s_cbranch_execz L_pad23
    s_or_b64 s[74:75], s[74:75], vcc
    s_mov_b64 exec, vcc
    buffer_load_dwordx4 v[16:19], v5, s[40:43], s58 offen sc1
    s_mov_b64 exec, -1
L_gn_148:
    v_max3_u32 v30, v20, v21, v22
    v_max_u32 v30, v30, v23
    v_cmp_eq_u32 vcc, -1, v30
    s_cbranch_vccz L_gn_149
    s_or_b64 s[74:75], s[74:75], vcc
    s_mov_b64 exec, vcc
    buffer_load_dwordx4 v[20:23], v5, s[40:43], s59 offen sc1
    s_mov_b64 exec, -1
L_gn_149:
    v_max3_u32 v30, v24, v25, v26
    v_max_u32 v30, v30, v27
    v_cmp_eq_u32 vcc, -1, v30
    s_cbranch_vccz L_gn_150
    s_or_b64 s[74:75], s[74:75], vcc
    s_mov_b64 exec, vcc
    buffer_load_dwordx4 v[24:27], v5, s[40:43], s60 offen sc1
    s_mov_b64 exec, -1
L_gn_150:
    s_cmp_eq_u64 s[74:75], 0
    s_cbranch_scc1 L_gk_146
    s_waitcnt vmcnt(0)
    s_branch L_gw_144
L_pr_152:
    s_sub_u32 s56, s56, 1
    s_cbranch_scc1 L_done
    buffer_load_dword v12, v9, s[40:43], s57 offen sc1
    s_waitcnt vmcnt(0)
    s_branch L_pw_151
L_gr_154:
    s_sub_u32 s56, s56, 1
    s_cbranch_scc1 L_done
    s_mov_b64 s[74:75], 0
    v_max3_u32 v30, v12, v13, v14
    v_max_u32 v30, v30, v15
    v_cmp_eq_u32 vcc, -1, v30
    s_cbranch_vccz L_gn_156
    s_or_b64 s[74:75], s[74:75], vcc
    s_mov_b64 exec, vcc
    buffer_load_dwordx4 v[12:15], v5, s[40:43], s57 offen sc1
    s_mov_b64 exec, -1
L_gn_156:
    v_max3_u32 v30, v16, v17, v18
    v_max_u32 v30, v30, v19
    v_cmp_eq_u32 vcc, -1, v30
    s_cbranch_vccz L_gn_157
    s_or_b64 s[74:75], s[74:75], vcc
    s_mov_b64 exec, vcc
    buffer_load_dwordx4 v[16:19], v5, s[40:43], s58 offen sc1
    s_mov_b64 exec, -1
L_gn_157:
    v_max3_u32 v30, v20, v21, v22
    v_max_u32 v30, v30, v23
    v_cmp_eq_u32 vcc, -1, v30
    s_cbranch_vccz L_gn_158
    s_or_b64 s[74:75], s[74:75], vcc
    s_mov_b64 exec, vcc
    buffer_load_dwordx4 v[20:23], v5, s[40:43], s59 offen sc1
    s_mov_b64 exec, -1
L_gn_158:
    v_max3_u32 v30, v24, v25, v26
    v_max_u32 v30, v30, v27
    v_cmp_eq_u32 vcc, -1, v30
    s_cbranch_vccz L_gn_159
    s_or_b64 s[74:75], s[74:75], vcc
    s_mov_b64 exec, vcc
    buffer_load_dwordx4 v[24:27], v5, s[40:43], s60 offen sc1
    s_mov_b64 exec, -1
L_gn_159:
    s_cmp_eq_u64 s[74:75], 0
    s_cbranch_scc1 L_gk_155
    s_waitcnt vmcnt(0)
    s_branch L_gw_153
L_gs_161:
    buffer_store_dword v12, v34, s[40:43], s59 offen sc1
    s_branch L_gb_162
L_gs_164:
    buffer_store_dword v27, v34, s[40:43], s67 offen sc1
    s_branch L_gb_165
L_pr_167:
    s_sub_u32 s56, s56, 1
    s_cbranch_scc1 L_done
    buffer_load_dwordx2 v[8:9], v7, s[40:43], 0 offen sc1
    buffer_load_dwordx4 v[12:15], v5, s[40:43], 0 offen offset:0 sc1
    buffer_load_dwordx4 v[16:19], v5, s[40:43], 0 offen offset:1024 sc1
    buffer_load_dwordx4 v[20:23], v5, s[40:43], 0 offen offset:2048 sc1
    s_waitcnt vmcnt(0)
    s_branch L_pw_166
L_gs_170:
    buffer_store_dword v22, v23, s[40:43], s57 offen sc1
    s_branch L_gb_171
L_old:
    s_waitcnt lgkmcnt(0)
    s_barrier
    s_cmp_lt_u32 s30, 2
    s_cbranch_scc0 L_b2_1
    v_and_b32 v37, 7, v0
    v_lshlrev_b32 v37, 3, v37
    v_add_u32 v37, 159744, v37
    ds_read_b64 v[38:39], v37
    s_lshl_b32 s57, s53, 3
    s_add_u32 s57, s57, s54
    s_lshl_b32 s57, s57, 2
    v_mov_b32 v23, s57
    s_add_u32 s57, s62, 55936
    s_waitcnt lgkmcnt(0)
    v_max_f32_dpp v37, v38, v38 row_ror:4 row_mask:0xf bank_mask:0xf
    s_nop 1
    v_max_f32_dpp v37, v37, v37 row_ror:2 row_mask:0xf bank_mask:0xf
    s_nop 1
    v_max_f32_dpp v37, v37, v37 row_ror:1 row_mask:0xf bank_mask:0xf
L_pad23:
    s_cbranch_execz L_pad24
    v_sub_f32 v38, v38, v37
    v_exp_f32 v38, v38
    s_nop 0
    v_mul_f32 v39, v38, v39
    s_nop 1
    v_add_f32_dpp v39, v39, v39 row_ror:4 row_mask:0xf bank_mask:0xf
    s_nop 1
    v_add_f32_dpp v39, v39, v39 row_ror:2 row_mask:0xf bank_mask:0xf
    s_nop 1
    v_add_f32_dpp v39, v39, v39 row_ror:1 row_mask:0xf bank_mask:0xf
    v_log_f32 v22, v39
    v_rcp_f32 v39, v39
    v_add_f32 v22, v22, v37
    v_min_u32 v22, -2, v22
    v_mul_f32 v38, v38, v39
    s_cmp_eq_u32 s30, 0
    s_cbranch_scc0 L_skip_169
    s_mov_b64 exec, 0x1
    s_cmp_eq_u32 s55, 0
    s_cbranch_scc1 L_gs_170
    buffer_store_dword v22, v23, s[40:43], s57 offen
L_gb_171:
    s_mov_b64 exec, -1
L_skip_169:
    v_readlane_b32 s64, v38, 0
    v_readlane_b32 s65, v38, 1
    v_readlane_b32 s66, v38, 2
    v_readlane_b32 s67, v38, 3
    v_readlane_b32 s68, v38, 4
    v_readlane_b32 s69, v38, 5
    v_readlane_b32 s70, v38, 6
    v_readlane_b32 s71, v38, 7
    s_mul_i32 s57, s30, 48
    v_add_u32 v38, s57, v0
    v_bfe_u32 v20, v38, 5, 2
    v_lshlrev_b32 v20, 8, v20
    v_and_b32 v39, 15, v38
    v_lshl_add_u32 v20, v39, 4, v20
    v_bfe_u32 v39, v38, 4, 1
    v_lshl_add_u32 v20, v39, 3, v20
    v_add_u32 v20, 124928, v20
    s_lshr_b32 s57, s54, 1
    s_lshl_b32 s57, s57, 2
    s_and_b32 s58, s54, 1
    s_add_u32 s57, s57, s58
    s_lshl_b32 s58, s57, 4
    s_lshl_b32 s57, s57, 3
    v_bfe_u32 v21, v0, 3, 2
    v_lshlrev_b32 v21, 8, v21
    v_bfe_u32 v39, v0, 2, 1
    v_lshl_add_u32 v21, v39, 5, v21
    v_and_b32 v39, 3, v0
    v_lshl_add_u32 v21, v39, 2, v21
    v_add_u32 v21, s58, v21
    v_bfe_u32 v38, v0, 3, 1
    v_lshlrev_b32 v38, 8, v38
    v_bfe_u32 v39, v0, 1, 1
    v_lshl_add_u32 v38, v39, 7, v38
    v_bfe_u32 v39, v0, 2, 1
    v_lshl_add_u32 v38, v39, 4, v38
    v_and_b32 v39, 1, v0
    v_lshl_add_u32 v38, v39, 2, v38
    v_add_u32 v38, s57, v38
    v_add_u32 v38, 1024, v38
    v_cmp_gt_u32 vcc, 32, v0
    s_nop 1
    v_cndmask_b32 v21, v38, v21, vcc
    s_lshl_b32 s57, s53, 1
    s_add_u32 s57, s57, s30
    s_mul_i32 s57, s57, 1536
    s_add_u32 s57, s57, s62
    s_add_u32 s57, s57, 12288
    v_add_u32 v21, s57, v21
    s_branch L_b2_1
L_gs_173:
    buffer_store_dword v56, v21, s[40:43], 0 offen sc1
    s_branch L_gb_174
L_pr_176:
    s_sub_u32 s56, s56, 1
    s_cbranch_scc1 L_done
    buffer_load_dword v18, v5, s[40:43], s59 offen sc1
    buffer_load_dwordx2 v[20:21], v22, s[40:43], s59 offen sc1
    s_waitcnt vmcnt(0)
    s_branch L_pw_175
L_pr_178:
    s_sub_u32 s56, s56, 1
    s_cbranch_scc1 L_done
    buffer_load_dwordx4 v[12:15], v9, s[40:43], s60 offen sc1
    buffer_load_dwordx2 v[16:17], v10, s[40:43], s60 offen offset:1024 sc1
    s_waitcnt vmcnt(0)
    s_branch L_pw_177
L_gs_180:
    buffer_store_dword v0, v0, s[40:43], s57 offen sc1
    s_branch L_gb_181
L_pr_184:
    s_sub_u32 s56, s56, 1
    s_cbranch_scc1 L_done
L_pad24:
    s_cbranch_execz L_pad25
    buffer_load_dwordx4 v[12:15], v11, s[40:43], s58 offen offset:0 sc1
    buffer_load_dwordx4 v[16:19], v11, s[40:43], s58 offen offset:1024 sc1
    buffer_load_dwordx4 v[20:23], v11, s[40:43], s58 offen offset:2048 sc1
    buffer_load_dwordx4 v[24:27], v11, s[40:43], s59 offen offset:0 sc1
    buffer_load_dwordx4 v[28:31], v11, s[40:43], s59 offen offset:1024 sc1
    buffer_load_dwordx4 v[32:35], v11, s[40:43], s59 offen offset:2048 sc1
    s_waitcnt vmcnt(0)
    s_branch L_pw_183
L_pr_186:
    s_sub_u32 s56, s56, 1
    s_cbranch_scc1 L_done
    buffer_load_dwordx2 v[2:3], v12, s[40:43], s57 offen sc1
    s_waitcnt vmcnt(0)
    s_branch L_pw_185
L_pr_190:
    s_sub_u32 s56, s56, 1
    s_cbranch_scc1 L_done
    buffer_load_dwordx4 v[12:15], v11, s[40:43], s58 offen offset:0 sc1
    buffer_load_dwordx4 v[16:19], v11, s[40:43], s58 offen offset:1024 sc1
    buffer_load_dwordx4 v[20:23], v11, s[40:43], s58 offen offset:2048 sc1
    buffer_load_dwordx4 v[24:27], v11, s[40:43], s59 offen offset:0 sc1
    buffer_load_dwordx4 v[28:31], v11, s[40:43], s59 offen offset:1024 sc1
    buffer_load_dwordx4 v[32:35], v11, s[40:43], s59 offen offset:2048 sc1
    s_waitcnt vmcnt(0)
    s_branch L_pw_189
L_hr_187:
    buffer_load_dwordx4 v[12:15], v11, s[40:43], s58 offen offset:0 sc1
    buffer_load_dwordx4 v[16:19], v11, s[40:43], s58 offen offset:1024 sc1
    buffer_load_dwordx4 v[20:23], v11, s[40:43], s58 offen offset:2048 sc1
    buffer_load_dwordx4 v[24:27], v11, s[40:43], s59 offen offset:0 sc1
    buffer_load_dwordx4 v[28:31], v11, s[40:43], s59 offen offset:1024 sc1
    buffer_load_dwordx4 v[32:35], v11, s[40:43], s59 offen offset:2048 sc1
    s_waitcnt vmcnt(0)
L_pw_189:
    v_max3_u32 v4, v12, v13, v14
    v_max3_u32 v4, v4, v15, v16
    v_max3_u32 v4, v4, v17, v18
    v_max3_u32 v4, v4, v19, v20
    v_max3_u32 v4, v4, v21, v22
    v_max3_u32 v4, v4, v23, v24
    v_max3_u32 v4, v4, v25, v26
    v_max3_u32 v4, v4, v27, v28
    v_max3_u32 v4, v4, v29, v30
    v_max3_u32 v4, v4, v31, v32
    v_max3_u32 v4, v4, v33, v34
    v_max_u32 v4, v4, v35
    v_cmp_eq_u32 vcc, -1, v4
    s_cbranch_vccnz L_pr_190
    v_pk_add_f32 v[12:13], v[12:13], v[14:15]
    v_pk_add_f32 v[16:17], v[16:17], v[18:19]
    v_pk_add_f32 v[12:13], v[12:13], v[16:17]
    v_add_f32 v12, v12, v13
    v_pk_add_f32 v[20:21], v[20:21], v[22:23]
    v_pk_add_f32 v[24:25], v[24:25], v[26:27]
    v_pk_add_f32 v[20:21], v[20:21], v[24:25]
    v_add_f32 v13, v20, v21
    v_pk_add_f32 v[28:29], v[28:29], v[30:31]
    v_pk_add_f32 v[32:33], v[32:33], v[34:35]
    v_pk_add_f32 v[28:29], v[28:29], v[32:33]
    v_add_f32 v14, v28, v29
    s_branch L_hk_188
L_gs_192:
    buffer_store_dword v0, v0, s[40:43], s57 offen sc1
    s_branch L_gb_193
L_pr_197:
    s_sub_u32 s56, s56, 1
    s_cbranch_scc1 L_done
    buffer_load_dword v12, v9, s[40:43], s57 offen sc1
    s_waitcnt vmcnt(0)
    s_branch L_pw_196
L_gr_199:
    s_sub_u32 s56, s56, 1
    s_cbranch_scc1 L_done
    s_mov_b64 s[74:75], 0
    v_max3_u32 v30, v12, v13, v14
    v_max_u32 v30, v30, v15
    v_cmp_eq_u32 vcc, -1, v30
    s_cbranch_vccz L_gn_201
    s_or_b64 s[74:75], s[74:75], vcc
    s_mov_b64 exec, vcc
    buffer_load_dwordx4 v[12:15], v5, s[40:43], s57 offen sc1
    s_mov_b64 exec, -1
L_gn_201:
    v_max3_u32 v30, v16, v17, v18
    v_max_u32 v30, v30, v19
    v_cmp_eq_u32 vcc, -1, v30
    s_cbranch_vccz L_gn_202
    s_or_b64 s[74:75], s[74:75], vcc
    s_mov_b64 exec, vcc
    buffer_load_dwordx4 v[16:19], v5, s[40:43], s58 offen sc1
L_pad25:
    s_cbranch_execz L_padback
    s_mov_b64 exec, -1
L_gn_202:
    v_max3_u32 v30, v20, v21, v22
    v_max_u32 v30, v30, v23
    v_cmp_eq_u32 vcc, -1, v30
    s_cbranch_vccz L_gn_203
    s_or_b64 s[74:75], s[74:75], vcc
    s_mov_b64 exec, vcc
    buffer_load_dwordx4 v[20:23], v5, s[40:43], s59 offen sc1
    s_mov_b64 exec, -1
L_gn_203:
    v_max3_u32 v30, v24, v25, v26
    v_max_u32 v30, v30, v27
    v_cmp_eq_u32 vcc, -1, v30
    s_cbranch_vccz L_gn_204
    s_or_b64 s[74:75], s[74:75], vcc
    s_mov_b64 exec, vcc
    buffer_load_dwordx4 v[24:27], v5, s[40:43], s60 offen sc1
    s_mov_b64 exec, -1
L_gn_204:
    s_cmp_eq_u64 s[74:75], 0
    s_cbranch_scc1 L_gk_200
    s_waitcnt vmcnt(0)
    s_branch L_gw_198
L_gs_206:
    buffer_store_dword v12, v34, s[40:43], s59 offen sc1
    s_branch L_gb_207
L_gs_209:
    buffer_store_dword v27, v34, s[40:43], s67 offen sc1
    s_branch L_gb_210
L_pr_212:
    s_sub_u32 s56, s56, 1
    s_cbranch_scc1 L_done
    buffer_load_dword v12, v9, s[40:43], s57 offen sc1
    s_waitcnt vmcnt(0)
    s_branch L_pw_211
L_gr_214:
    s_sub_u32 s56, s56, 1
    s_cbranch_scc1 L_done
    s_mov_b64 s[74:75], 0
    v_max3_u32 v30, v12, v13, v14
    v_max_u32 v30, v30, v15
    v_cmp_eq_u32 vcc, -1, v30
    s_cbranch_vccz L_gn_216
    s_or_b64 s[74:75], s[74:75], vcc
    s_mov_b64 exec, vcc
    buffer_load_dwordx4 v[12:15], v5, s[40:43], s57 offen sc1
    s_mov_b64 exec, -1
L_gn_216:
    v_max3_u32 v30, v16, v17, v18
    v_max_u32 v30, v30, v19
    v_cmp_eq_u32 vcc, -1, v30
    s_cbranch_vccz L_gn_217
    s_or_b64 s[74:75], s[74:75], vcc
    s_mov_b64 exec, vcc
    buffer_load_dwordx4 v[16:19], v5, s[40:43], s58 offen sc1
    s_mov_b64 exec, -1
L_gn_217:
    v_max3_u32 v30, v20, v21, v22
    v_max_u32 v30, v30, v23
    v_cmp_eq_u32 vcc, -1, v30
    s_cbranch_vccz L_gn_218
    s_or_b64 s[74:75], s[74:75], vcc
    s_mov_b64 exec, vcc
    buffer_load_dwordx4 v[20:23], v5, s[40:43], s59 offen sc1
    s_mov_b64 exec, -1
L_gn_218:
    v_max3_u32 v30, v24, v25, v26
    v_max_u32 v30, v30, v27
    v_cmp_eq_u32 vcc, -1, v30
    s_cbranch_vccz L_gn_219
    s_or_b64 s[74:75], s[74:75], vcc
    s_mov_b64 exec, vcc
    buffer_load_dwordx4 v[24:27], v5, s[40:43], s60 offen sc1
    s_mov_b64 exec, -1
L_gn_219:
    s_cmp_eq_u64 s[74:75], 0
    s_cbranch_scc1 L_gk_215
    s_waitcnt vmcnt(0)
    s_branch L_gw_213
L_tail_end:
L_spread:
    s_add_u32 s62, s62, 671744
    s_cmp_eq_u32 s30, 5
    s_cbranch_scc0 L_skip_62
    v_mov_b64 v[12:13], -1
    v_mov_b64 v[14:15], -1
    v_lshlrev_b32 v16, 4, v0
    s_mul_i32 s57, s52, 1792
    s_add_u32 s57, s57, s62
    s_mov_b32 exec_lo, 0xffffffff
    s_mov_b32 exec_hi, 0xffff
    buffer_store_dwordx4 v[12:15], v16, s[40:43], s57 offen offset:1024 sc1
    s_mov_b64 exec, -1
    buffer_store_dwordx4 v[12:15], v16, s[40:43], s57 offen sc1
L_skip_62:
    s_cmp_eq_u32 s30, 7
    s_cbranch_scc0 L_skip_63
    v_and_b32 v60, 31, v0
    v_cmp_gt_u32 s[64:65], 20, v60
    v_min_u32 v60, 19, v60
    v_lshrrev_b32 v35, 5, v0
    v_lshlrev_b32 v35, 2, v35
    v_add_u32 v35, 159872, v35
    v_lshl_add_u32 v35, v60, 3, v35
    s_mul_i32 s66, s53, 6400
    s_add_u32 s66, s66, s62
    s_add_u32 s66, s66, 57344
    s_add_u32 s67, s66, 6144
    s_lshl_b32 s57, s54, 3
    v_lshrrev_b32 v34, 5, v0
    v_lshlrev_b32 v34, 2, v34
    v_add_u32 v34, s57, v34
    v_mov_b32 v61, 0x3f803f80
    v_cvt_pk_bf16_f32 v28, v2, v3
L_skip_63:
    s_cmp_eq_u32 s30, 7
    s_cbranch_scc0 L_skip_64
    v_lshlrev_b32 v2, 16, v28
    v_and_b32 v3, 0xffff0000, v28
    v_cndmask_b32 v28, 0, v28, s[64:65]
    v_dot2_f32_bf16 v27, v28, v61, 0
    v_dot2_f32_bf16 v62, v28, v28, 0
    s_nop 2
    v_permlane32_swap_b32 v27, v62
    v_add_f32 v27, v27, v62
    v_mov_b32 v62, v27
    s_nop 1
    v_permlane16_swap_b32 v27, v62
    v_add_f32 v27, v27, v62
    s_nop 1
    v_add_f32_dpp v27, v27, v27 row_ror:8 row_mask:0xf bank_mask:0xf
    s_nop 1
    v_add_f32_dpp v27, v27, v27 row_ror:4 row_mask:0xf bank_mask:0xf
    s_nop 1
    v_add_f32_dpp v27, v27, v27 row_ror:2 row_mask:0xf bank_mask:0xf
    s_nop 1
    v_add_f32_dpp v27, v27, v27 row_ror:1 row_mask:0xf bank_mask:0xf
    v_min_u32 v27, -2, v27
    s_mov_b32 exec_lo, 0x1
    s_mov_b32 exec_hi, 0x1
    s_cmp_eq_u32 s55, 0
    s_cbranch_scc1 L_gs_65
    buffer_store_dword v27, v34, s[40:43], s67 offen
L_gb_66:
    s_mov_b64 exec, -1
L_skip_64:
    s_cmp_lt_u32 s30, 6
    s_cbranch_scc0 L_skip_67
    s_lshr_b32 s57, s30, 1
    s_mul_i32 s57, s57, 1024
    s_and_b32 s58, s30, 1
    s_lshl_b32 s58, s58, 6
    s_add_u32 s57, s57, s58
    v_lshrrev_b32 v18, 5, v0
    v_mul_u32_u24 v18, 6144, v18
    v_bfe_u32 v60, v0, 3, 1
    v_mul_u32_u24 v60, 3072, v60
    v_add_u32 v18, v60, v18
    v_bfe_u32 v60, v0, 4, 1
    v_lshl_add_u32 v18, v60, 9, v18
    v_bfe_u32 v60, v0, 2, 1
    v_lshl_add_u32 v18, v60, 7, v18
    v_and_b32 v60, 3, v0
    v_lshl_add_u32 v18, v60, 3, v18
    v_add_u32 v18, s57, v18
    v_bfe_u32 v19, v0, 4, 1
    v_mul_u32_u24 v19, 3072, v19
    v_bfe_u32 v60, v0, 3, 1
    v_lshl_add_u32 v19, v60, 9, v19
    v_bfe_u32 v60, v0, 2, 1
    v_lshl_add_u32 v19, v60, 7, v19
    v_and_b32 v60, 3, v0
    v_lshl_add_u32 v19, v60, 3, v19
    v_add_u32 v19, s57, v19
    v_add_u32 v19, 24576, v19
    ds_read_b64_tr_b16 v[36:37], v18 offset:0
    ds_read_b64_tr_b16 v[38:39], v18 offset:256
    ds_read_b64_tr_b16 v[40:41], v18 offset:12288
    ds_read_b64_tr_b16 v[42:43], v18 offset:12544
    ds_read_b64_tr_b16 v[44:45], v19 offset:0
    ds_read_b64_tr_b16 v[46:47], v19 offset:256
    ds_read_b64_tr_b16 v[48:49], v18 offset:32
    ds_read_b64_tr_b16 v[50:51], v18 offset:288
    ds_read_b64_tr_b16 v[52:53], v18 offset:12320
    ds_read_b64_tr_b16 v[54:55], v18 offset:12576
    ds_read_b64_tr_b16 v[56:57], v19 offset:32
    ds_read_b64_tr_b16 v[58:59], v19 offset:288
    v_lshrrev_b32 v32, 4, v0
    v_lshlrev_b32 v32, 5, v32
    v_bfe_u32 v60, v0, 1, 1
    v_lshl_add_u32 v32, v60, 4, v32
    v_and_b32 v60, 1, v0
    v_mul_u32_u24 v60, 192, v60
    v_add_u32 v32, v60, v32
    v_add_u32 v32, 159872, v32
    v_lshrrev_b32 v33, 4, v0
    v_lshlrev_b32 v33, 4, v33
    v_bfe_u32 v60, v0, 1, 1
    v_lshl_add_u32 v33, v60, 3, v33
    v_and_b32 v60, 1, v0
    v_mul_u32_u24 v60, 192, v60
    v_add_u32 v33, v60, v33
    v_add_u32 v33, 160000, v33
    v_mov_b64 v[24:25], 0
    v_mov_b64 v[26:27], 0
    v_mov_b64 v[28:29], 0
    v_mov_b64 v[30:31], 0
    s_lshr_b32 s57, s54, 1
    s_lshl_b32 s57, s57, 2
    s_and_b32 s58, s54, 1
    s_add_u32 s57, s57, s58
    s_lshl_b32 s57, s57, 4
    s_lshl_b32 s58, s30, 9
    s_add_u32 s57, s57, s58
    v_bfe_u32 v34, v0, 4, 1
    v_lshlrev_b32 v34, 8, v34
    v_bfe_u32 v60, v0, 1, 1
    v_lshl_add_u32 v34, v60, 5, v34
    v_bfe_u32 v60, v0, 2, 2
    v_lshl_add_u32 v34, v60, 2, v34
    v_lshrrev_b32 v60, 5, v0
    v_mul_u32_u24 v60, 3072, v60
    v_add_u32 v34, v60, v34
    v_add_u32 v34, s57, v34
    s_mul_i32 s59, s53, 6400
    s_add_u32 s59, s59, s62
    s_add_u32 s59, s59, 57344
    s_add_u32 s60, s59, 6144
    ds_read_b128 v[12:15], v32
    ds_read_b64 v[16:17], v33
    s_waitcnt lgkmcnt(1)
    v_smfmac_f32_16x16x64_bf16 v[24:27], v[12:15], v[36:43], v1
    v_smfmac_f32_16x16x64_bf16 v[28:31], v[12:15], v[48:55], v1
    s_waitcnt lgkmcnt(0)
    v_smfmac_f32_16x16x32_bf16 v[24:27], v[16:17], v[44:47], v1
    v_smfmac_f32_16x16x32_bf16 v[28:31], v[16:17], v[56:59], v1
    s_nop 6
    v_add_f32 v12, v24, v26
    s_nop 1
    v_add_f32_dpp v12, v28, v30 quad_perm:[0,1,2,3] row_mask:0x2 bank_mask:0xf
    s_nop 1
    v_add_f32_dpp v12, v25, v27 quad_perm:[0,1,2,3] row_mask:0x4 bank_mask:0xf
    s_nop 1
    v_add_f32_dpp v12, v29, v31 quad_perm:[0,1,2,3] row_mask:0x8 bank_mask:0xf
    s_nop 1
    v_mov_b32_dpp v13, v12 row_shl:1 row_mask:0xf bank_mask:0xf bound_ctrl:0
    v_cvt_pk_bf16_f32 v12, v12, v13
    v_min_u32 v12, -2, v12
    s_mov_b32 exec_lo, 0x55555555
    s_mov_b32 exec_hi, 0x55555555
    s_cmp_eq_u32 s55, 0
    s_cbranch_scc1 L_gs_68
    buffer_store_dword v12, v34, s[40:43], s59 offen
L_gb_69:
    s_mov_b64 exec, -1
L_skip_67:
    s_waitcnt vmcnt(0)
    s_barrier
    s_cmp_eq_u32 s30, 5
    s_cbranch_scc0 L_skip_70
    s_lshl_b32 s57, s52, 2
    s_add_u32 s57, s57, s72
    v_mov_b32 v13, s63
    s_mov_b64 exec, 0x1
    buffer_store_dword v13, v0, s[40:43], s57 offen offset:128 sc1
    s_mov_b64 exec, -1
    v_and_b32 v16, 31, v0
    v_lshlrev_b32 v16, 2, v16
    buffer_load_dword v17, v16, s[40:43], s72 offen offset:128 sc1
    s_waitcnt vmcnt(0)
L_pw_71:
    v_cmp_eq_u32 vcc, -1, v17
    s_cbranch_vccnz L_pr_72
L_skip_70:
    s_barrier
    s_branch L_spread_back
L_done:
L_exit:
    s_endpgm
.section .rodata,"a"
.p2align 6
.amdhsa_kernel interleave_layers__sliding_block_cached__dense_activation_gelu__decode_kernel
  .amdhsa_next_free_vgpr 256
  .amdhsa_next_free_sgpr 102
  .amdhsa_accum_offset 256
  .amdhsa_group_segment_fixed_size 0
  .amdhsa_kernarg_size 104
  .amdhsa_user_sgpr_count 2
  .amdhsa_user_sgpr_kernarg_segment_ptr 1
  .amdhsa_system_sgpr_workgroup_id_x 1
  .amdhsa_float_denorm_mode_32 3
.end_amdhsa_kernel
```

```asm
; @launch grid=(256,1,1) block=(512,1,1) lds=160256
.amdgcn_target "amdgcn-amd-amdhsa--gfx950"
.text
.fill 64, 4, 0xbf800000
.globl interleave_layers__sliding_block_cached__dense_activation_gelu__decode_kernel
.p2align 8
.type interleave_layers__sliding_block_cached__dense_activation_gelu__decode_kernel,@function
interleave_layers__sliding_block_cached__dense_activation_gelu__decode_kernel:
    s_load_dwordx16 s[4:19], s[0:1], 0
    s_load_dwordx8 s[20:27], s[0:1], 64
    s_load_dwordx2 s[28:29], s[0:1], 96
    s_cmp_ge_u32 s2, 256
    s_cbranch_scc1 L_exit
    s_getpc_b64 s[74:75]
L_pc:
    v_lshlrev_b32 v5, 6, v0
    v_min_u32 v5, L_exit-L_pc, v5
    global_load_dword v59, v5, s[74:75]
    v_lshrrev_b32 v5, 6, v0
    v_and_b32 v0, 63, v0
    v_readfirstlane_b32 s30, v5
    s_and_b32 s31, s2, 7
    s_lshr_b32 s52, s2, 3
    s_and_b32 s53, s52, 3
    s_lshr_b32 s54, s52, 2
    s_lshl_b32 s73, s31, 2
    s_add_u32 s73, s73, s53
    s_mul_i32 s3, s54, 3
    s_add_u32 s3, s3, s53
    s_cmp_eq_u32 s53, 3
    s_cselect_b32 s3, 31, s3
    v_lshrrev_b32 v8, 5, v0
    v_lshlrev_b32 v8, 2, v8
    v_bfe_u32 v60, v0, 4, 1
    v_lshl_add_u32 v8, v60, 0, v8
    v_and_b32 v9, 7, v0
    v_xor_b32 v8, v8, v9
    v_lshrrev_b32 v10, 3, v0
    v_mul_u32_u24 v10, 384, v10
    v_lshl_add_u32 v5, v8, 4, v10
    v_xor_b32 v6, 32, v5
    v_lshrrev_b32 v8, 4, v0
    v_lshlrev_b32 v8, 1, v8
    v_xor_b32 v8, v8, v9
    v_lshl_add_u32 v7, v8, 4, v10
    v_lshrrev_b32 v2, 3, v0
    v_mul_u32_u24 v2, 12288, v2
    v_and_b32 v60, 7, v0
    v_lshl_add_u32 v2, v60, 4, v2
    s_mul_i32 s57, s73, 12582912
    s_mul_i32 s58, s54, 3072
    s_add_u32 s57, s57, s58
    s_add_u32 s57, s57, 11010048
    s_sub_u32 s58, 1572864, s58
    s_mul_i32 s59, s73, 384
    s_mul_i32 s60, s54, 983040
    s_add_u32 s59, s59, s60
    s_sub_u32 s60, 7866368, s59
    s_lshl_b32 s61, s30, 11
    s_add_u32 s61, s61, 92160
    s_mul_i32 s62, s31, 83968
    s_lshl_b32 s72, s31, 9
    s_add_u32 s72, s72, 1425408
    s_mov_b32 s56, 65536
    s_mov_b32 s55, 1
    s_getreg_b32 s63, hwreg(20, 0, 3)
    v_mov_b32 v11, 0
    v_mov_b32 v3, 0
    v_mov_b32 v21, 0
    v_mov_b32 v24, 0
    v_mov_b32 v34, 0
    v_mov_b64 v[12:13], -1
    v_mov_b64 v[14:15], -1
    v_lshlrev_b32 v10, 4, v0
    s_waitcnt lgkmcnt(0)
    s_add_u32 s32, s6, s57
    s_addc_u32 s33, s7, 0
    s_mov_b32 s34, s58
    s_mov_b32 s35, 0x20000
    s_add_u32 s36, s8, s57
    s_addc_u32 s37, s9, 0
    s_mov_b32 s38, s58
    s_mov_b32 s39, 0x20000
    s_mov_b32 s40, s28
    s_mov_b32 s41, s29
    s_mov_b32 s42, 1429504
    s_mov_b32 s43, 0x20000
    s_add_u32 s44, s10, s59
    s_addc_u32 s45, s11, 0
    s_mov_b32 s46, s60
    s_mov_b32 s47, 0x20000
    s_sub_u32 s44, s44, 2048
    s_subb_u32 s45, s45, 0
    s_cmp_eq_u32 s30, 6
    s_cbranch_scc0 L_skip_1
    s_setprio 3
    s_mov_b32 s57, 0
    s_mov_b32 s58, 195584
    s_mov_b32 m0, 92160
L_dma_2:
    s_waitcnt vmcnt(25)
    buffer_load_dwordx4 v5, s[32:35], s57 offen offset:0 nt lds
    s_waitcnt vmcnt(25)
    buffer_load_dwordx4 v6, s[32:35], s58 offen offset:1024 nt lds
    s_add_u32 s57, s57, 24576
    s_add_u32 s58, s58, 24576
    s_add_u32 m0, m0, 2048
    s_cmp_lg_u32 m0, 108544
    s_cbranch_scc1 L_dma_2
    s_mov_b32 s57, 128
    s_mov_b32 s58, 195712
    s_mov_b32 m0, 108544
L_dma_3:
    s_waitcnt vmcnt(25)
    buffer_load_dwordx4 v5, s[32:35], s57 offen offset:0 nt lds
    s_waitcnt vmcnt(25)
    buffer_load_dwordx4 v6, s[32:35], s58 offen offset:1024 nt lds
    s_add_u32 s57, s57, 24576
    s_add_u32 s58, s58, 24576
    s_add_u32 m0, m0, 2048
    s_cmp_lg_u32 m0, 124928
    s_cbranch_scc1 L_dma_3
    s_mov_b32 s57, 2048
    s_mov_b32 s58, 1152
    s_mov_b32 s59, 256
    s_mov_b32 m0, 0
L_dma_4:
    s_waitcnt vmcnt(25)
    buffer_load_dwordx4 v2, s[44:47], s57 offen offset:0 nt lds
    s_waitcnt vmcnt(25)
    buffer_load_dwordx4 v2, s[44:47], s58 offen offset:1024 nt lds
    s_waitcnt vmcnt(25)
    buffer_load_dwordx4 v2, s[44:47], s59 offen offset:2048 nt lds
    s_add_u32 s57, s57, 98304
    s_add_u32 s58, s58, 98304
    s_add_u32 s59, s59, 98304
    s_add_u32 m0, m0, 3072
    s_cmp_lg_u32 m0, 15360
    s_cbranch_scc1 L_dma_4
L_skip_1:
    s_cmp_lt_u32 s3, 20
    s_cselect_b32 s57, 7864320, 0
    s_add_u32 s58, s54, 1
    s_mul_i32 s58, s58, 245760
    s_cmp_lg_u32 s53, 3
    s_cselect_b64 s[48:49], s[12:13], s[16:17]
    s_cselect_b32 s50, s57, s58
    s_mov_b32 s51, 0x20000
    s_cmp_eq_u32 s30, 5
    s_cbranch_scc0 L_skip_5
    s_cmp_eq_u32 s52, 31
    s_cbranch_scc0 L_skip_6
    s_mov_b64 exec, 0xffffff
    buffer_store_dwordx4 v[12:15], v10, s[40:43], s72 offen sc1
    s_mov_b64 exec, -1
L_skip_6:
    s_cmp_lt_u32 s3, 20
    s_cbranch_scc0 L_skip_7
    s_mul_i32 s57, s31, 2560
    s_lshl_b32 s58, s3, 7
    s_add_u32 s58, s58, s57
    s_add_u32 s58, s58, 1343488
    v_bfe_u32 v16, v0, 3, 2
    v_mul_u32_u24 v16, 20480, v16
    v_and_b32 v60, 7, v0
    v_lshl_add_u32 v16, v60, 4, v16
    s_mov_b32 exec_lo, 0xffffffff
    s_mov_b32 exec_hi, 0x0
    buffer_store_dwordx4 v[12:15], v16, s[40:43], s58 offen sc1
L_skip_7:
    s_mul_i32 s57, s52, 1792
    s_add_u32 s57, s57, s62
    s_mov_b32 exec_lo, 0xffffffff
    s_mov_b32 exec_hi, 0xffff
    buffer_store_dwordx4 v[12:15], v10, s[40:43], s57 offen offset:1024
    s_mov_b64 exec, -1
    buffer_store_dwordx4 v[12:15], v10, s[40:43], s57 offen
    s_mov_b64 exec, -1
    v_subrev_u32 v16, 8, v0
    v_cmp_gt_u32 vcc, 40, v16
    v_mov_b32 v16, 0x3f803f80
    s_nop 0
    v_cndmask_b32 v18, 0, v16, vcc
    v_min_u32 v16, 55, v0
    v_lshlrev_b32 v16, 2, v16
    v_add_u32 v16, 160032, v16
    ds_write_b32 v16, v18
    v_and_b32 v3, 7, v0
    v_lshlrev_b32 v3, 5, v3
L_skip_5:
    s_cmp_eq_u32 s30, 7
    s_cbranch_scc0 L_skip_8
    v_and_b32 v60, 31, v0
    v_min_u32 v60, 19, v60
    s_mul_i32 s57, s54, 160
    v_lshrrev_b32 v16, 5, v0
    v_lshlrev_b32 v16, 2, v16
    v_add_u32 v16, s57, v16
    v_lshl_add_u32 v16, v60, 3, v16
    global_load_dword v28, v16, s[4:5]
    global_load_dword v4, v16, s[22:23]
L_skip_8:
    v_bfe_u32 v8, v0, 1, 3
    v_lshrrev_b32 v9, 4, v0
    v_xor_b32 v9, v8, v9
    v_bfe_u32 v8, v0, 2, 1
    v_lshlrev_b32 v8, 10, v8
    v_bfe_u32 v60, v0, 3, 1
    v_lshl_add_u32 v8, v60, 9, v8
    v_and_b32 v60, 3, v0
    v_lshl_add_u32 v8, v60, 7, v8
    v_add_u32 v8, s61, v8
    v_lshl_add_u32 v8, v9, 4, v8
    v_xor_b32 v9, 64, v8
    v_bfe_u32 v1, v0, 1, 1
    v_mul_u32_u24 v1, 43690, v1
    v_add_u32 v1, 17476, v1
    s_waitcnt vmcnt(31)
    s_barrier
    ds_read_b128 v[64:67], v8 offset:0
    ds_read_b128 v[68:71], v9 offset:0
    s_cmp_eq_u32 s30, 6
    s_cbranch_scc0 L_skip_9
    s_mov_b32 s57, 256
    s_mov_b32 s58, 195840
    s_mov_b32 m0, 124928
L_dma_10:
    s_waitcnt vmcnt(25)
    buffer_load_dwordx4 v5, s[32:35], s57 offen offset:0 nt lds
    s_waitcnt vmcnt(25)
    buffer_load_dwordx4 v6, s[32:35], s58 offen offset:1024 nt lds
    s_add_u32 s57, s57, 24576
    s_add_u32 s58, s58, 24576
    s_add_u32 m0, m0, 2048
    s_cmp_lg_u32 m0, 141312
    s_cbranch_scc1 L_dma_10
L_skip_9:
    s_waitcnt lgkmcnt(0)
    s_cmp_eq_u32 s30, 5
    s_cbranch_scc0 L_skip_11
    s_cmp_eq_u32 s52, 31
    s_cbranch_scc0 L_skip_12
    s_lshl_b32 s57, s31, 5
    v_mov_b32 v16, s57
    s_add_u32 s57, s63, 1
    v_mov_b32 v12, s57
    s_waitcnt vmcnt(2)
    s_mov_b64 exec, 0x1
    global_store_dword v16, v12, s[26:27] sc1
    s_mov_b64 exec, -1
L_skip_12:
L_skip_11:
    s_waitcnt vmcnt(31)
    s_barrier
    ds_read_b128 v[72:75], v8 offset:16384
    ds_read_b128 v[76:79], v9 offset:16384
    s_cmp_eq_u32 s30, 6
    s_cbranch_scc0 L_skip_13
    s_mov_b32 s57, 493568
    s_mov_b32 s58, 492672
    s_mov_b32 s59, 491776
    s_mov_b32 m0, 15360
L_dma_14:
    s_waitcnt vmcnt(25)
    buffer_load_dwordx4 v2, s[44:47], s57 offen offset:0 nt lds
    s_waitcnt vmcnt(25)
    buffer_load_dwordx4 v2, s[44:47], s58 offen offset:1024 nt lds
    s_waitcnt vmcnt(25)
    buffer_load_dwordx4 v2, s[44:47], s59 offen offset:2048 nt lds
    s_add_u32 s57, s57, 98304
    s_add_u32 s58, s58, 98304
    s_add_u32 s59, s59, 98304
    s_add_u32 m0, m0, 3072
    s_cmp_lg_u32 m0, 30720
    s_cbranch_scc1 L_dma_14
    s_mov_b32 s57, 393216
    s_mov_b32 s58, 588800
    s_mov_b32 m0, 141312
L_dma_15:
    s_waitcnt vmcnt(25)
    buffer_load_dwordx4 v5, s[32:35], s57 offen offset:0 nt lds
    s_waitcnt vmcnt(25)
    buffer_load_dwordx4 v6, s[32:35], s58 offen offset:1024 nt lds
    s_add_u32 s57, s57, 24576
    s_add_u32 s58, s58, 24576
    s_add_u32 m0, m0, 2048
    s_cmp_lg_u32 m0, 157696
    s_cbranch_scc1 L_dma_15
L_skip_13:
    s_waitcnt lgkmcnt(0)
    s_waitcnt vmcnt(31)
    s_barrier
    ds_read_b128 v[80:83], v8 offset:32768
    ds_read_b128 v[84:87], v9 offset:32768
    s_cmp_eq_u32 s30, 6
    s_cbranch_scc0 L_skip_16
    s_cmp_lg_u32 s53, 3
    s_cbranch_scc0 L_wb_17
    s_mul_i32 s57, s31, 983040
    s_lshl_b32 s58, s3, 6
    s_add_u32 s57, s57, s58
    v_bfe_u32 v38, v0, 4, 1
    v_lshlrev_b32 v38, 1, v38
    v_xor_b32 v38, v38, v0
    v_and_b32 v38, 3, v38
    v_lshrrev_b32 v3, 5, v0
    v_mul_u32_u24 v3, 10240, v3
    v_bfe_u32 v39, v0, 4, 1
    v_mul_u32_u24 v39, 2560, v39
    v_add_u32 v3, v39, v3
    v_bfe_u32 v39, v0, 3, 1
    v_mul_u32_u24 v39, 5120, v39
    v_add_u32 v3, v39, v3
    v_bfe_u32 v39, v0, 2, 1
    v_mul_u32_u24 v39, 20480, v39
    v_add_u32 v3, v39, v3
    v_add_u32 v3, s57, v3
    v_lshl_add_u32 v3, v38, 4, v3
    s_mov_b32 s14, 40960
    s_mov_b32 s15, 256
    s_branch L_we_18
L_wb_17:
    s_mul_i32 s57, s31, 384
    s_mul_i32 s58, s54, 245760
    s_add_u32 s57, s57, s58
    v_lshlrev_b32 v3, 4, v0
    v_add_u32 v3, s57, v3
    v_mov_b32 v38, 2688
    v_cmp_lt_u32 vcc, 23, v0
    s_nop 1
    v_cndmask_b32 v38, 0, v38, vcc
    v_add_u32 v3, v38, v3
    v_mov_b32 v38, 0x7f000000
    v_cmp_lt_u32 vcc, 47, v0
    s_nop 1
    v_cndmask_b32 v3, v3, v38, vcc
    s_mov_b32 s14, 12288
    s_mov_b32 s15, 5120
L_we_18:
    s_mul_i32 s57, s14, 0
    s_mov_b32 m0, 30720
    s_waitcnt vmcnt(25)
    buffer_load_dwordx4 v3, s[48:51], s57 offen offset:0 nt lds
    s_mul_i32 s57, s14, 0
    s_add_u32 s57, s57, s15
    s_mov_b32 m0, 30720
    s_waitcnt vmcnt(25)
    buffer_load_dwordx4 v3, s[48:51], s57 offen offset:1024 nt lds
    s_mov_b32 s57, 393344
    s_mov_b32 s58, 588928
    s_mov_b32 m0, 92160
L_dma_19:
    s_waitcnt vmcnt(25)
    buffer_load_dwordx4 v5, s[32:35], s57 offen offset:0 nt lds
    s_waitcnt vmcnt(25)
    buffer_load_dwordx4 v6, s[32:35], s58 offen offset:1024 nt lds
    s_add_u32 s57, s57, 24576
    s_add_u32 s58, s58, 24576
    s_add_u32 m0, m0, 2048
    s_cmp_lg_u32 m0, 108544
    s_cbranch_scc1 L_dma_19
    s_mul_i32 s57, s14, 1
    s_mov_b32 m0, 32768
    s_waitcnt vmcnt(25)
    buffer_load_dwordx4 v3, s[48:51], s57 offen offset:0 nt lds
    s_mul_i32 s57, s14, 1
    s_add_u32 s57, s57, s15
    s_mov_b32 m0, 32768
    s_waitcnt vmcnt(25)
    buffer_load_dwordx4 v3, s[48:51], s57 offen offset:1024 nt lds
    s_mov_b32 s57, 393472
    s_mov_b32 s58, 589056
    s_mov_b32 m0, 108544
L_dma_20:
    s_waitcnt vmcnt(25)
    buffer_load_dwordx4 v5, s[32:35], s57 offen offset:0 nt lds
    s_waitcnt vmcnt(25)
    buffer_load_dwordx4 v6, s[32:35], s58 offen offset:1024 nt lds
    s_add_u32 s57, s57, 24576
    s_add_u32 s58, s58, 24576
    s_add_u32 m0, m0, 2048
    s_cmp_lg_u32 m0, 124928
    s_cbranch_scc1 L_dma_20
L_skip_16:
    s_waitcnt lgkmcnt(0)
    s_cmp_eq_u32 s30, 7
    s_cbranch_scc0 L_skip_21
    v_and_b32 v60, 31, v0
    v_cmp_gt_u32 s[64:65], 20, v60
    v_min_u32 v60, 19, v60
    v_lshrrev_b32 v35, 5, v0
    v_lshlrev_b32 v35, 2, v35
    v_add_u32 v35, 159872, v35
    v_lshl_add_u32 v35, v60, 3, v35
    s_mul_i32 s66, s53, 6400
    s_add_u32 s66, s66, s62
    s_add_u32 s66, s66, 57344
    s_add_u32 s67, s66, 6144
    s_lshl_b32 s57, s54, 3
    v_lshrrev_b32 v34, 5, v0
    v_lshlrev_b32 v34, 2, v34
    v_add_u32 v34, s57, v34
    v_mov_b32 v61, 0x3f803f80
    s_waitcnt vmcnt(0)
    ds_write_b32 v35, v28
    s_waitcnt lgkmcnt(0)
L_skip_21:
    s_waitcnt vmcnt(36)
    s_barrier
    ds_read_b128 v[88:91], v8 offset:49152
    ds_read_b128 v[92:95], v9 offset:49152
    s_cmp_eq_u32 s30, 6
    s_cbranch_scc0 L_skip_22
    s_mul_i32 s57, s14, 2
    s_mov_b32 m0, 34816
    s_waitcnt vmcnt(25)
    buffer_load_dwordx4 v3, s[48:51], s57 offen offset:0 nt lds
    s_mul_i32 s57, s14, 2
    s_add_u32 s57, s57, s15
    s_mov_b32 m0, 34816
    s_waitcnt vmcnt(25)
    buffer_load_dwordx4 v3, s[48:51], s57 offen offset:1024 nt lds
    s_mov_b32 s57, 786432
    s_mov_b32 s58, 982016
    s_mov_b32 m0, 124928
L_dma_23:
    s_waitcnt vmcnt(25)
    buffer_load_dwordx4 v5, s[32:35], s57 offen offset:0 nt lds
    s_waitcnt vmcnt(25)
    buffer_load_dwordx4 v6, s[32:35], s58 offen offset:1024 nt lds
    s_add_u32 s57, s57, 24576
    s_add_u32 s58, s58, 24576
    s_add_u32 m0, m0, 2048
    s_cmp_lg_u32 m0, 141312
    s_cbranch_scc1 L_dma_23
L_skip_22:
    s_waitcnt lgkmcnt(0)
    s_cmp_eq_u32 s30, 3
    s_cbranch_scc0 L_skip_24
    s_mov_b64 exec, 0
    s_cbranch_execz L_pad0
L_padback:
    s_mov_b64 exec, -1
L_skip_24:
    s_cmp_eq_u32 s30, 7
    s_cbranch_scc0 L_skip_25
    v_lshlrev_b32 v2, 16, v28
    v_and_b32 v3, 0xffff0000, v28
    v_cndmask_b32 v28, 0, v28, s[64:65]
    v_dot2_f32_bf16 v27, v28, v61, 0
    v_dot2_f32_bf16 v62, v28, v28, 0
    s_nop 2
    v_permlane32_swap_b32 v27, v62
    v_add_f32 v27, v27, v62
    v_mov_b32 v62, v27
    s_nop 1
    v_permlane16_swap_b32 v27, v62
    v_add_f32 v27, v27, v62
    s_nop 1
    v_add_f32_dpp v27, v27, v27 row_ror:8 row_mask:0xf bank_mask:0xf
    s_nop 1
    v_add_f32_dpp v27, v27, v27 row_ror:4 row_mask:0xf bank_mask:0xf
    s_nop 1
    v_add_f32_dpp v27, v27, v27 row_ror:2 row_mask:0xf bank_mask:0xf
    s_nop 1
    v_add_f32_dpp v27, v27, v27 row_ror:1 row_mask:0xf bank_mask:0xf
    v_min_u32 v27, -2, v27
    s_mov_b32 exec_lo, 0x1
    s_mov_b32 exec_hi, 0x1
    s_cmp_eq_u32 s55, 0
    s_cbranch_scc1 L_gs_26
    buffer_store_dword v27, v34, s[40:43], s67 offen
L_gb_27:
    s_mov_b64 exec, -1
L_skip_25:
    s_cmp_lt_u32 s30, 6
    s_cbranch_scc0 L_skip_28
    s_lshr_b32 s57, s30, 1
    s_mul_i32 s57, s57, 1024
    s_and_b32 s58, s30, 1
    s_lshl_b32 s58, s58, 6
    s_add_u32 s57, s57, s58
    v_lshrrev_b32 v18, 5, v0
    v_mul_u32_u24 v18, 6144, v18
    v_bfe_u32 v60, v0, 3, 1
    v_mul_u32_u24 v60, 3072, v60
    v_add_u32 v18, v60, v18
    v_bfe_u32 v60, v0, 4, 1
    v_lshl_add_u32 v18, v60, 9, v18
    v_bfe_u32 v60, v0, 2, 1
    v_lshl_add_u32 v18, v60, 7, v18
    v_and_b32 v60, 3, v0
    v_lshl_add_u32 v18, v60, 3, v18
    v_add_u32 v18, s57, v18
    v_bfe_u32 v19, v0, 4, 1
    v_mul_u32_u24 v19, 3072, v19
    v_bfe_u32 v60, v0, 3, 1
    v_lshl_add_u32 v19, v60, 9, v19
    v_bfe_u32 v60, v0, 2, 1
    v_lshl_add_u32 v19, v60, 7, v19
    v_and_b32 v60, 3, v0
    v_lshl_add_u32 v19, v60, 3, v19
    v_add_u32 v19, s57, v19
    v_add_u32 v19, 24576, v19
    ds_read_b64_tr_b16 v[36:37], v18 offset:0
    ds_read_b64_tr_b16 v[38:39], v18 offset:256
    ds_read_b64_tr_b16 v[40:41], v18 offset:12288
    ds_read_b64_tr_b16 v[42:43], v18 offset:12544
    ds_read_b64_tr_b16 v[44:45], v19 offset:0
    ds_read_b64_tr_b16 v[46:47], v19 offset:256
    ds_read_b64_tr_b16 v[48:49], v18 offset:32
    ds_read_b64_tr_b16 v[50:51], v18 offset:288
    ds_read_b64_tr_b16 v[52:53], v18 offset:12320
    ds_read_b64_tr_b16 v[54:55], v18 offset:12576
    ds_read_b64_tr_b16 v[56:57], v19 offset:32
    ds_read_b64_tr_b16 v[58:59], v19 offset:288
    v_lshrrev_b32 v32, 4, v0
    v_lshlrev_b32 v32, 5, v32
    v_bfe_u32 v60, v0, 1, 1
    v_lshl_add_u32 v32, v60, 4, v32
    v_and_b32 v60, 1, v0
    v_mul_u32_u24 v60, 192, v60
    v_add_u32 v32, v60, v32
    v_add_u32 v32, 159872, v32
    v_lshrrev_b32 v33, 4, v0
    v_lshlrev_b32 v33, 4, v33
    v_bfe_u32 v60, v0, 1, 1
    v_lshl_add_u32 v33, v60, 3, v33
    v_and_b32 v60, 1, v0
    v_mul_u32_u24 v60, 192, v60
    v_add_u32 v33, v60, v33
    v_add_u32 v33, 160000, v33
    v_mov_b64 v[24:25], 0
    v_mov_b64 v[26:27], 0
    v_mov_b64 v[28:29], 0
    v_mov_b64 v[30:31], 0
    s_lshr_b32 s57, s54, 1
    s_lshl_b32 s57, s57, 2
    s_and_b32 s58, s54, 1
    s_add_u32 s57, s57, s58
    s_lshl_b32 s57, s57, 4
    s_lshl_b32 s58, s30, 9
    s_add_u32 s57, s57, s58
    v_bfe_u32 v34, v0, 4, 1
    v_lshlrev_b32 v34, 8, v34
    v_bfe_u32 v60, v0, 1, 1
    v_lshl_add_u32 v34, v60, 5, v34
    v_bfe_u32 v60, v0, 2, 2
    v_lshl_add_u32 v34, v60, 2, v34
    v_lshrrev_b32 v60, 5, v0
    v_mul_u32_u24 v60, 3072, v60
    v_add_u32 v34, v60, v34
    v_add_u32 v34, s57, v34
    s_mul_i32 s59, s53, 6400
    s_add_u32 s59, s59, s62
    s_add_u32 s59, s59, 57344
    s_add_u32 s60, s59, 6144
    ds_read_b128 v[12:15], v32
    ds_read_b64 v[16:17], v33
    s_waitcnt lgkmcnt(1)
    v_smfmac_f32_16x16x64_bf16 v[24:27], v[12:15], v[36:43], v1
    v_smfmac_f32_16x16x64_bf16 v[28:31], v[12:15], v[48:55], v1
    s_waitcnt lgkmcnt(0)
    v_smfmac_f32_16x16x32_bf16 v[24:27], v[16:17], v[44:47], v1
    v_smfmac_f32_16x16x32_bf16 v[28:31], v[16:17], v[56:59], v1
    s_nop 6
    v_add_f32 v12, v24, v26
    s_nop 1
    v_add_f32_dpp v12, v28, v30 quad_perm:[0,1,2,3] row_mask:0x2 bank_mask:0xf
    s_nop 1
    v_add_f32_dpp v12, v25, v27 quad_perm:[0,1,2,3] row_mask:0x4 bank_mask:0xf
    s_nop 1
    v_add_f32_dpp v12, v29, v31 quad_perm:[0,1,2,3] row_mask:0x8 bank_mask:0xf
    s_nop 1
    v_mov_b32_dpp v13, v12 row_shl:1 row_mask:0xf bank_mask:0xf bound_ctrl:0
    v_cvt_pk_bf16_f32 v12, v12, v13
    v_min_u32 v12, -2, v12
    s_mov_b32 exec_lo, 0x55555555
    s_mov_b32 exec_hi, 0x55555555
    s_cmp_eq_u32 s55, 0
    s_cbranch_scc1 L_gs_29
    buffer_store_dword v12, v34, s[40:43], s59 offen
L_gb_30:
    s_mov_b64 exec, -1
L_skip_28:
    s_cmp_eq_u32 s30, 5
    s_cbranch_scc0 L_skip_31
    global_load_dword v2, v3, s[26:27] sc1
L_skip_31:
    s_waitcnt vmcnt(36)
    s_barrier
    ds_read_b128 v[96:99], v8 offset:0
    ds_read_b128 v[100:103], v9 offset:0
    s_cmp_eq_u32 s30, 6
    s_cbranch_scc0 L_skip_32
    s_mul_i32 s57, s14, 3
    s_mov_b32 m0, 36864
    s_waitcnt vmcnt(25)
    buffer_load_dwordx4 v3, s[48:51], s57 offen offset:0 nt lds
    s_mul_i32 s57, s14, 3
    s_add_u32 s57, s57, s15
    s_mov_b32 m0, 36864
    s_waitcnt vmcnt(25)
    buffer_load_dwordx4 v3, s[48:51], s57 offen offset:1024 nt lds
    s_mov_b32 s57, 786560
    s_mov_b32 s58, 982144
    s_mov_b32 m0, 141312
L_dma_33:
    s_waitcnt vmcnt(25)
    buffer_load_dwordx4 v5, s[32:35], s57 offen offset:0 nt lds
    s_waitcnt vmcnt(25)
    buffer_load_dwordx4 v6, s[32:35], s58 offen offset:1024 nt lds
    s_add_u32 s57, s57, 24576
    s_add_u32 s58, s58, 24576
    s_add_u32 m0, m0, 2048
    s_cmp_lg_u32 m0, 157696
    s_cbranch_scc1 L_dma_33
L_skip_32:
    s_waitcnt lgkmcnt(0)
    s_waitcnt vmcnt(36)
    s_barrier
    ds_read_b128 v[104:107], v8 offset:16384
    ds_read_b128 v[108:111], v9 offset:16384
    s_cmp_eq_u32 s30, 6
    s_cbranch_scc0 L_skip_34
    s_mul_i32 s57, s14, 4
    s_mov_b32 m0, 38912
    s_waitcnt vmcnt(25)
    buffer_load_dwordx4 v3, s[48:51], s57 offen offset:0 nt lds
    s_mul_i32 s57, s14, 4
    s_add_u32 s57, s57, s15
    s_mov_b32 m0, 38912
    s_waitcnt vmcnt(25)
    buffer_load_dwordx4 v3, s[48:51], s57 offen offset:1024 nt lds
    s_mov_b32 s57, 786688
    s_mov_b32 s58, 982272
    s_mov_b32 m0, 92160
L_dma_35:
    s_waitcnt vmcnt(25)
    buffer_load_dwordx4 v5, s[32:35], s57 offen offset:0 nt lds
    s_waitcnt vmcnt(25)
    buffer_load_dwordx4 v6, s[32:35], s58 offen offset:1024 nt lds
    s_add_u32 s57, s57, 24576
    s_add_u32 s58, s58, 24576
    s_add_u32 m0, m0, 2048
    s_cmp_lg_u32 m0, 108544
    s_cbranch_scc1 L_dma_35
L_skip_34:
    s_waitcnt lgkmcnt(0)
    s_cmp_lg_u32 s30, 6
    s_cbranch_scc0 L_skip_36
    s_waitcnt vmcnt(0)
L_skip_36:
    s_waitcnt vmcnt(36)
    s_barrier
    ds_read_b128 v[112:115], v8 offset:32768
    ds_read_b128 v[116:119], v9 offset:32768
    s_cmp_eq_u32 s30, 6
    s_cbranch_scc0 L_skip_37
    s_mul_i32 s57, s14, 5
    s_mov_b32 m0, 40960
    s_waitcnt vmcnt(25)
    buffer_load_dwordx4 v3, s[48:51], s57 offen offset:0 nt lds
    s_mul_i32 s57, s14, 5
    s_add_u32 s57, s57, s15
    s_mov_b32 m0, 40960
    s_waitcnt vmcnt(25)
    buffer_load_dwordx4 v3, s[48:51], s57 offen offset:1024 nt lds
    s_mov_b32 s57, 1179648
    s_mov_b32 s58, 1375232
    s_mov_b32 m0, 108544
L_dma_38:
    s_waitcnt vmcnt(25)
    buffer_load_dwordx4 v5, s[32:35], s57 offen offset:0 nt lds
    s_waitcnt vmcnt(25)
    buffer_load_dwordx4 v6, s[32:35], s58 offen offset:1024 nt lds
    s_add_u32 s57, s57, 24576
    s_add_u32 s58, s58, 24576
    s_add_u32 m0, m0, 2048
    s_cmp_lg_u32 m0, 124928
    s_cbranch_scc1 L_dma_38
L_skip_37:
    s_waitcnt lgkmcnt(0)
    s_cmp_eq_u32 s30, 5
    s_cbranch_scc0 L_skip_39
L_cw_40:
    v_readlane_b32 s57, v2, s31
    s_cmp_eq_u32 s57, 0
    s_cbranch_scc1 L_cr_41
    s_sub_u32 s57, s57, 1
    s_cmp_eq_u32 s57, s63
    s_cselect_b32 s64, 1, 0
    s_cbranch_scc0 L_far_42
    s_lshl_b32 s57, s52, 2
    s_add_u32 s57, s57, s72
    s_mov_b64 exec, 1
    buffer_store_dword v0, v0, s[40:43], s57 offen offset:0
    s_mov_b64 exec, -1
L_fb_43:
L_skip_39:
    s_waitcnt vmcnt(36)
    s_barrier
    ds_read_b128 v[120:123], v8 offset:49152
    ds_read_b128 v[124:127], v9 offset:49152
    s_cmp_eq_u32 s30, 6
    s_cbranch_scc0 L_skip_44
    s_mul_i32 s57, s14, 6
    s_mov_b32 m0, 43008
    s_waitcnt vmcnt(25)
    buffer_load_dwordx4 v3, s[48:51], s57 offen offset:0 nt lds
    s_mul_i32 s57, s14, 6
    s_add_u32 s57, s57, s15
    s_mov_b32 m0, 43008
    s_waitcnt vmcnt(25)
    buffer_load_dwordx4 v3, s[48:51], s57 offen offset:1024 nt lds
    s_mov_b32 s57, 1179776
    s_mov_b32 s58, 1375360
    s_mov_b32 m0, 124928
L_dma_45:
    s_waitcnt vmcnt(25)
    buffer_load_dwordx4 v5, s[32:35], s57 offen offset:0 nt lds
    s_waitcnt vmcnt(25)
    buffer_load_dwordx4 v6, s[32:35], s58 offen offset:1024 nt lds
    s_add_u32 s57, s57, 24576
    s_add_u32 s58, s58, 24576
    s_add_u32 m0, m0, 2048
    s_cmp_lg_u32 m0, 141312
    s_cbranch_scc1 L_dma_45
L_skip_44:
    s_waitcnt lgkmcnt(0)
    s_waitcnt vmcnt(36)
    s_barrier
    ds_read_b128 v[128:131], v8 offset:0
    ds_read_b128 v[132:135], v9 offset:0
    s_cmp_eq_u32 s30, 6
    s_cbranch_scc0 L_skip_46
    s_mul_i32 s57, s14, 7
    s_mov_b32 m0, 45056
    s_waitcnt vmcnt(25)
    buffer_load_dwordx4 v3, s[48:51], s57 offen offset:0 nt lds
    s_mul_i32 s57, s14, 7
    s_add_u32 s57, s57, s15
    s_mov_b32 m0, 45056
    s_waitcnt vmcnt(25)
    buffer_load_dwordx4 v3, s[48:51], s57 offen offset:1024 nt lds
    s_mov_b32 s57, 1179904
    s_mov_b32 s58, 1375488
    s_mov_b32 m0, 141312
L_dma_47:
    s_waitcnt vmcnt(25)
    buffer_load_dwordx4 v5, s[32:35], s57 offen offset:0 nt lds
    s_waitcnt vmcnt(25)
    buffer_load_dwordx4 v6, s[32:35], s58 offen offset:1024 nt lds
    s_add_u32 s57, s57, 24576
    s_add_u32 s58, s58, 24576
    s_add_u32 m0, m0, 2048
    s_cmp_lg_u32 m0, 157696
    s_cbranch_scc1 L_dma_47
L_skip_46:
    s_waitcnt lgkmcnt(0)
    s_cmp_eq_u32 s30, 5
    s_cbranch_scc0 L_skip_48
    v_lshlrev_b32 v24, 2, v0
    buffer_load_dword v2, v24, s[40:43], s72 offen sc1
L_skip_48:
    s_waitcnt vmcnt(36)
    s_barrier
    ds_read_b128 v[136:139], v8 offset:16384
    ds_read_b128 v[140:143], v9 offset:16384
    s_cmp_eq_u32 s30, 6
    s_cbranch_scc0 L_skip_49
    s_mul_i32 s57, s14, 8
    s_mov_b32 m0, 47104
    s_waitcnt vmcnt(25)
    buffer_load_dwordx4 v3, s[48:51], s57 offen offset:0 nt lds
    s_mul_i32 s57, s14, 8
    s_add_u32 s57, s57, s15
    s_mov_b32 m0, 47104
    s_waitcnt vmcnt(25)
    buffer_load_dwordx4 v3, s[48:51], s57 offen offset:1024 nt lds
    s_mov_b32 s57, 0
    s_mov_b32 s58, 392192
    s_mov_b32 m0, 92160
L_dma_50:
    s_waitcnt vmcnt(25)
    buffer_load_dwordx4 v7, s[36:39], s57 offen offset:0 nt lds
    s_waitcnt vmcnt(25)
    buffer_load_dwordx4 v7, s[36:39], s58 offen offset:1024 nt lds
    s_add_u32 s57, s57, 24576
    s_add_u32 s58, s58, 24576
    s_add_u32 m0, m0, 2048
    s_cmp_lg_u32 m0, 108544
    s_cbranch_scc1 L_dma_50
L_skip_49:
    s_waitcnt lgkmcnt(0)
    s_waitcnt vmcnt(36)
    s_barrier
    ds_read_b128 v[144:147], v8 offset:32768
    ds_read_b128 v[148:151], v9 offset:32768
    s_cmp_eq_u32 s30, 6
    s_cbranch_scc0 L_skip_51
    s_mul_i32 s57, s14, 9
    s_mov_b32 m0, 49152
    s_waitcnt vmcnt(25)
    buffer_load_dwordx4 v3, s[48:51], s57 offen offset:0 nt lds
    s_mul_i32 s57, s14, 9
    s_add_u32 s57, s57, s15
    s_mov_b32 m0, 49152
    s_waitcnt vmcnt(25)
    buffer_load_dwordx4 v3, s[48:51], s57 offen offset:1024 nt lds
    s_mov_b32 s57, 128
    s_mov_b32 s58, 392320
    s_mov_b32 m0, 108544
L_dma_52:
    s_waitcnt vmcnt(25)
    buffer_load_dwordx4 v7, s[36:39], s57 offen offset:0 nt lds
    s_waitcnt vmcnt(25)
    buffer_load_dwordx4 v7, s[36:39], s58 offen offset:1024 nt lds
    s_add_u32 s57, s57, 24576
    s_add_u32 s58, s58, 24576
    s_add_u32 m0, m0, 2048
    s_cmp_lg_u32 m0, 124928
    s_cbranch_scc1 L_dma_52
L_skip_51:
    s_waitcnt lgkmcnt(0)
    s_cmp_eq_u32 s30, 5
    s_cbranch_scc0 L_skip_53
L_cw_54:
    s_waitcnt vmcnt(0)
    v_cmp_ne_u32 vcc, -1, v2
    s_mov_b32 s57, 0
    s_cmp_eq_u32 s64, 0
    s_cbranch_scc1 L_cd_56
    s_cmp_lg_u32 vcc_hi, 0
    s_cbranch_scc1 L_cd_56
    s_cmp_lg_u32 vcc_lo, -1
    s_cbranch_scc1 L_cr_55
    s_mov_b32 s57, 1
L_cd_56:
    v_mov_b32 v37, 159808
    v_mov_b32 v38, s57
    ds_write_b32 v37, v38
    s_waitcnt lgkmcnt(0)
L_skip_53:
    s_waitcnt vmcnt(36)
    s_barrier
    ds_read_b128 v[152:155], v8 offset:49152
    ds_read_b128 v[156:159], v9 offset:49152
    s_cmp_eq_u32 s30, 6
    s_cbranch_scc0 L_skip_57
    s_mul_i32 s57, s14, 10
    s_mov_b32 m0, 51200
    s_waitcnt vmcnt(25)
    buffer_load_dwordx4 v3, s[48:51], s57 offen offset:0 nt lds
    s_mul_i32 s57, s14, 10
    s_add_u32 s57, s57, s15
    s_mov_b32 m0, 51200
    s_waitcnt vmcnt(25)
    buffer_load_dwordx4 v3, s[48:51], s57 offen offset:1024 nt lds
    s_mov_b32 s57, 256
    s_mov_b32 s58, 392448
    s_mov_b32 m0, 124928
L_dma_58:
    s_waitcnt vmcnt(25)
    buffer_load_dwordx4 v7, s[36:39], s57 offen offset:0 nt lds
    s_waitcnt vmcnt(25)
    buffer_load_dwordx4 v7, s[36:39], s58 offen offset:1024 nt lds
    s_add_u32 s57, s57, 24576
    s_add_u32 s58, s58, 24576
    s_add_u32 m0, m0, 2048
    s_cmp_lg_u32 m0, 141312
    s_cbranch_scc1 L_dma_58
L_skip_57:
    s_waitcnt lgkmcnt(0)
    v_lshrrev_b32 v8, 2, v0
    v_lshlrev_b32 v8, 7, v8
    v_bfe_u32 v60, v0, 3, 2
    v_lshl_add_u32 v8, v60, 5, v8
    v_and_b32 v60, 3, v0
    v_lshl_add_u32 v8, v60, 3, v8
    v_add_u32 v8, s61, v8
    v_xor_b32 v9, 32, v8
    v_xor_b32 v10, 64, v8
    v_xor_b32 v11, 96, v8
    v_mov_b32 v41, 159808
    ds_read_b32 v42, v41
    s_waitcnt lgkmcnt(0)
    v_readfirstlane_b32 s55, v42
    s_cmp_eq_u32 s55, 0
    s_cbranch_scc1 L_spread
L_spread_back:
    s_cmp_eq_u32 s30, 5
    s_cbranch_scc0 L_skip_70
    s_cmp_eq_u32 s52, 31
    s_cbranch_scc0 L_skip_71
    s_lshl_b32 s57, s31, 5
    v_mov_b32 v16, s57
    v_mov_b32 v12, 1
    s_mov_b64 exec, 0x1
    global_store_dword v16, v12, s[26:27] offset:4 sc1
    s_mov_b64 exec, -1
L_skip_71:
L_skip_70:
    s_cmp_eq_u32 s30, 4
    s_cbranch_scc0 L_skip_72
    s_mul_i32 s59, s53, 6400
    s_add_u32 s59, s59, s62
    s_add_u32 s59, s59, 57344
    s_add_u32 s60, s59, 6144
    v_lshlrev_b32 v16, 4, v0
    s_add_u32 s60, s59, 3072
    s_mov_b32 m0, 79872
    s_nop 0
    buffer_load_dwordx4 v16, s[40:43], s59 offen offset:0 sc1 nt lds
    buffer_load_dwordx4 v16, s[40:43], s59 offen offset:1024 sc1 nt lds
    buffer_load_dwordx4 v16, s[40:43], s59 offen offset:2048 sc1 nt lds
    s_mov_b32 m0, 82944
    s_nop 0
    buffer_load_dwordx4 v16, s[40:43], s60 offen offset:0 sc1 nt lds
    buffer_load_dwordx4 v16, s[40:43], s60 offen offset:1024 sc1 nt lds
    buffer_load_dwordx4 v16, s[40:43], s60 offen offset:2048 sc1 nt lds
    s_mov_b64 exec, 0xf
    buffer_load_dwordx4 v16, s[40:43], s60 offen offset:3072 sc1 nt lds
    s_mov_b64 exec, -1
L_skip_72:
    s_waitcnt vmcnt(36)
    s_barrier
    ds_read_b64_tr_b16 v[160:161], v8 offset:0
    ds_read_b64_tr_b16 v[168:169], v9 offset:0
    ds_read_b64_tr_b16 v[176:177], v10 offset:0
    ds_read_b64_tr_b16 v[184:185], v11 offset:0
    s_cmp_eq_u32 s30, 6
    s_cbranch_scc0 L_skip_73
    s_mul_i32 s57, s14, 11
    s_mov_b32 m0, 53248
    s_waitcnt vmcnt(25)
    buffer_load_dwordx4 v3, s[48:51], s57 offen offset:0 nt lds
    s_mul_i32 s57, s14, 11
    s_add_u32 s57, s57, s15
    s_mov_b32 m0, 53248
    s_waitcnt vmcnt(25)
    buffer_load_dwordx4 v3, s[48:51], s57 offen offset:1024 nt lds
    s_mov_b32 s57, 196608
    s_mov_b32 s58, 588800
    s_mov_b32 m0, 141312
L_dma_74:
    s_waitcnt vmcnt(25)
    buffer_load_dwordx4 v7, s[36:39], s57 offen offset:0 nt lds
    s_waitcnt vmcnt(25)
    buffer_load_dwordx4 v7, s[36:39], s58 offen offset:1024 nt lds
    s_add_u32 s57, s57, 24576
    s_add_u32 s58, s58, 24576
    s_add_u32 m0, m0, 2048
    s_cmp_lg_u32 m0, 157696
    s_cbranch_scc1 L_dma_74
L_skip_73:
    s_waitcnt lgkmcnt(0)
    s_waitcnt vmcnt(36)
    s_barrier
    ds_read_b64_tr_b16 v[192:193], v8 offset:16384
    ds_read_b64_tr_b16 v[200:201], v9 offset:16384
    ds_read_b64_tr_b16 v[208:209], v10 offset:16384
    ds_read_b64_tr_b16 v[216:217], v11 offset:16384
    s_cmp_eq_u32 s30, 6
    s_cbranch_scc0 L_skip_75
    s_mul_i32 s57, s14, 12
    s_mov_b32 m0, 55296
    s_waitcnt vmcnt(25)
    buffer_load_dwordx4 v3, s[48:51], s57 offen offset:0 nt lds
    s_mul_i32 s57, s14, 12
    s_add_u32 s57, s57, s15
    s_mov_b32 m0, 55296
    s_waitcnt vmcnt(25)
    buffer_load_dwordx4 v3, s[48:51], s57 offen offset:1024 nt lds
    s_mov_b32 s57, 196736
    s_mov_b32 s58, 588928
    s_mov_b32 m0, 92160
L_dma_76:
    s_waitcnt vmcnt(25)
    buffer_load_dwordx4 v7, s[36:39], s57 offen offset:0 nt lds
    s_waitcnt vmcnt(25)
    buffer_load_dwordx4 v7, s[36:39], s58 offen offset:1024 nt lds
    s_add_u32 s57, s57, 24576
    s_add_u32 s58, s58, 24576
    s_add_u32 m0, m0, 2048
    s_cmp_lg_u32 m0, 108544
    s_cbranch_scc1 L_dma_76
L_skip_75:
    s_waitcnt lgkmcnt(0)
    s_cmp_eq_u32 s30, 4
    s_cbranch_scc0 L_skip_77
    s_waitcnt vmcnt(0)
L_skip_77:
    s_waitcnt vmcnt(36)
    s_barrier
    ds_read_b64_tr_b16 v[224:225], v8 offset:32768
    ds_read_b64_tr_b16 v[232:233], v9 offset:32768
    ds_read_b64_tr_b16 v[240:241], v10 offset:32768
    ds_read_b64_tr_b16 v[248:249], v11 offset:32768
    s_cmp_eq_u32 s30, 6
    s_cbranch_scc0 L_skip_78
    s_mul_i32 s57, s14, 13
    s_mov_b32 m0, 57344
    s_nop 0
    buffer_load_dwordx4 v3, s[48:51], s57 offen offset:0 nt lds
    s_mul_i32 s57, s14, 13
    s_add_u32 s57, s57, s15
    s_mov_b32 m0, 57344
    s_nop 0
    buffer_load_dwordx4 v3, s[48:51], s57 offen offset:1024 nt lds
    s_mov_b32 s57, 196864
    s_mov_b32 s58, 589056
    s_mov_b32 m0, 108544
L_dma_79:
    s_nop 0
    buffer_load_dwordx4 v7, s[36:39], s57 offen offset:0 nt lds
    buffer_load_dwordx4 v7, s[36:39], s58 offen offset:1024 nt lds
    s_add_u32 s57, s57, 24576
    s_add_u32 s58, s58, 24576
    s_add_u32 m0, m0, 2048
    s_cmp_lg_u32 m0, 124928
    s_cbranch_scc1 L_dma_79
L_skip_78:
    s_waitcnt lgkmcnt(0)
    v_lshlrev_b32 v40, 4, v0
    v_add_u32 v40, 79872, v40
    ds_read_b128 v[12:15], v40 offset:3072
    ds_read_b128 v[16:19], v40 offset:4096
    ds_read_b128 v[20:23], v40 offset:5120
    v_mov_b64 v[24:25], 0
    v_mov_b64 v[26:27], 0
    v_mov_b64 v[28:29], 0
    v_mov_b64 v[30:31], 0
    v_mov_b64 v[32:33], 0
    v_mov_b64 v[34:35], 0
    v_mov_b64 v[36:37], 0
    v_mov_b64 v[38:39], 0
    s_waitcnt lgkmcnt(0)
    v_smfmac_f32_16x16x64_bf16 v[24:27], v[12:15], v[64:71], v1
    v_smfmac_f32_16x16x64_bf16 v[24:27], v[16:19], v[72:79], v1
    v_smfmac_f32_16x16x64_bf16 v[24:27], v[20:23], v[80:87], v1
    v_smfmac_f32_16x16x64_bf16 v[32:35], v[12:15], v[112:119], v1
    v_smfmac_f32_16x16x64_bf16 v[32:35], v[16:19], v[120:127], v1
    v_smfmac_f32_16x16x64_bf16 v[32:35], v[20:23], v[128:135], v1
    v_smfmac_f32_16x16x64_bf16 v[28:31], v[12:15], v[88:95], v1
    v_smfmac_f32_16x16x64_bf16 v[28:31], v[16:19], v[96:103], v1
    v_smfmac_f32_16x16x64_bf16 v[28:31], v[20:23], v[104:111], v1
    v_smfmac_f32_16x16x64_bf16 v[36:39], v[12:15], v[136:143], v1
    s_nop 0
    v_pk_add_f32 v[24:25], v[24:25], v[26:27]
    v_add_f32 v24, v24, v25
    v_smfmac_f32_16x16x64_bf16 v[36:39], v[16:19], v[144:151], v1
    v_pk_add_f32 v[32:33], v[32:33], v[34:35]
    v_add_f32 v32, v32, v33
    v_smfmac_f32_16x16x64_bf16 v[36:39], v[20:23], v[152:159], v1
    s_nop 0
    v_permlane32_swap_b32 v24, v32
    v_add_f32 v24, v24, v32
    v_pk_add_f32 v[28:29], v[28:29], v[30:31]
    v_add_f32 v28, v28, v29
    s_nop 2
    v_pk_add_f32 v[36:37], v[36:37], v[38:39]
    v_add_f32 v36, v36, v37
    s_nop 1
    v_permlane32_swap_b32 v28, v36
    v_add_f32 v28, v28, v36
    s_nop 1
    v_permlane16_swap_b32 v24, v28
    v_add_f32 v6, v24, v28
    s_waitcnt vmcnt(36)
    s_barrier
    ds_read_b64_tr_b16 v[162:163], v8 offset:49152
    ds_read_b64_tr_b16 v[170:171], v9 offset:49152
    ds_read_b64_tr_b16 v[178:179], v10 offset:49152
    ds_read_b64_tr_b16 v[186:187], v11 offset:49152
    s_cmp_eq_u32 s30, 6
    s_cbranch_scc0 L_skip_80
    s_mul_i32 s57, s14, 14
    s_mov_b32 m0, 59392
    s_nop 0
    buffer_load_dwordx4 v3, s[48:51], s57 offen offset:0 nt lds
    s_mul_i32 s57, s14, 14
    s_add_u32 s57, s57, s15
    s_mov_b32 m0, 59392
    s_nop 0
    buffer_load_dwordx4 v3, s[48:51], s57 offen offset:1024 nt lds
    s_mov_b32 s57, 786432
    s_mov_b32 s58, 1178624
    s_mov_b32 m0, 124928
L_dma_81:
    s_nop 0
    buffer_load_dwordx4 v7, s[36:39], s57 offen offset:0 nt lds
    buffer_load_dwordx4 v7, s[36:39], s58 offen offset:1024 nt lds
    s_add_u32 s57, s57, 24576
    s_add_u32 s58, s58, 24576
    s_add_u32 m0, m0, 2048
    s_cmp_lg_u32 m0, 141312
    s_cbranch_scc1 L_dma_81
L_skip_80:
    s_waitcnt lgkmcnt(0)
    v_and_b32 v41, 7, v0
    v_lshlrev_b32 v41, 3, v41
    v_add_u32 v41, 86016, v41
    ds_read_b128 v[12:15], v40 offset:0
    ds_read_b128 v[16:19], v40 offset:1024
    ds_read_b128 v[20:23], v40 offset:2048
    ds_read_b64 v[52:53], v41
    v_mov_b64 v[24:25], 0
    v_mov_b64 v[26:27], 0
    v_mov_b64 v[28:29], 0
    v_mov_b64 v[30:31], 0
    v_mov_b64 v[32:33], 0
    v_mov_b64 v[34:35], 0
    v_mov_b64 v[36:37], 0
    v_mov_b64 v[38:39], 0
    s_waitcnt lgkmcnt(0)
    v_smfmac_f32_16x16x64_bf16 v[24:27], v[12:15], v[64:71], v1
    v_add_f32_dpp v52, v52, v52 row_ror:4 row_mask:0xf bank_mask:0xf
    v_add_f32_dpp v53, v53, v53 row_ror:4 row_mask:0xf bank_mask:0xf
    v_smfmac_f32_16x16x64_bf16 v[24:27], v[16:19], v[72:79], v1
    v_add_f32_dpp v52, v52, v52 row_ror:2 row_mask:0xf bank_mask:0xf
    v_add_f32_dpp v53, v53, v53 row_ror:2 row_mask:0xf bank_mask:0xf
    v_smfmac_f32_16x16x64_bf16 v[24:27], v[20:23], v[80:87], v1
    v_add_f32_dpp v52, v52, v52 row_ror:1 row_mask:0xf bank_mask:0xf
    v_add_f32_dpp v53, v53, v53 row_ror:1 row_mask:0xf bank_mask:0xf
    v_smfmac_f32_16x16x64_bf16 v[32:35], v[12:15], v[112:119], v1
    v_mul_f32 v52, 0x3acccccd, v52
    v_mul_f32 v53, 0x3acccccd, v53
    v_smfmac_f32_16x16x64_bf16 v[32:35], v[16:19], v[120:127], v1
    v_fma_f32 v53, -v52, v52, v53
    v_max_f32 v53, 0, v53
    v_smfmac_f32_16x16x64_bf16 v[32:35], v[20:23], v[128:135], v1
    v_add_f32 v53, 0x3727c5ac, v53
    v_rsq_f32 v53, v53
    v_smfmac_f32_16x16x64_bf16 v[28:31], v[12:15], v[88:95], v1
    s_mov_b32 vcc_lo, 0x55555555
    v_mul_f32 v53, 0x3dd53b95, v53
    v_smfmac_f32_16x16x64_bf16 v[28:31], v[16:19], v[96:103], v1
    s_mov_b32 vcc_hi, 0x55555555
    v_smfmac_f32_16x16x64_bf16 v[28:31], v[20:23], v[104:111], v1
    v_smfmac_f32_16x16x64_bf16 v[36:39], v[12:15], v[136:143], v1
    v_pk_add_f32 v[24:25], v[24:25], v[26:27]
    v_add_f32 v24, v24, v25
    v_smfmac_f32_16x16x64_bf16 v[36:39], v[16:19], v[144:151], v1
    v_pk_add_f32 v[32:33], v[32:33], v[34:35]
    v_add_f32 v32, v32, v33
    v_smfmac_f32_16x16x64_bf16 v[36:39], v[20:23], v[152:159], v1
    s_nop 0
    v_permlane32_swap_b32 v24, v32
    v_add_f32 v24, v24, v32
    v_pk_add_f32 v[28:29], v[28:29], v[30:31]
    v_add_f32 v28, v28, v29
    s_nop 2
    v_pk_add_f32 v[36:37], v[36:37], v[38:39]
    v_add_f32 v36, v36, v37
    s_nop 1
    v_permlane32_swap_b32 v28, v36
    v_add_f32 v28, v28, v36
    s_nop 1
    v_permlane16_swap_b32 v24, v28
    v_add_f32 v24, v24, v28
    v_fma_f32 v24, -v52, v6, v24
    s_nop 1
    v_max_f32_dpp v21, v24, v24 row_ror:8 row_mask:0xf bank_mask:0xf
    s_nop 1
    v_max_f32_dpp v21, v21, v21 row_ror:4 row_mask:0xf bank_mask:0xf
    s_nop 1
    v_max_f32_dpp v21, v21, v21 row_ror:2 row_mask:0xf bank_mask:0xf
    s_nop 1
    v_max_f32_dpp v21, v21, v21 row_ror:1 row_mask:0xf bank_mask:0xf
    s_nop 1
    v_max_f32_dpp v21, v21, v21 row_bcast:15 row_mask:0xa bank_mask:0xf
    s_nop 1
    v_max_f32_dpp v21, v21, v21 row_bcast:31 row_mask:0xc bank_mask:0xf
    s_nop 0
    v_readlane_b32 s57, v21, 63
    s_nop 1
    v_subrev_f32 v24, s57, v24
    v_mul_f32 v24, v24, v53
    v_exp_f32 v22, v24
    v_mul_f32 v20, s57, v53
    s_nop 0
    v_mov_b32_dpp v23, v22 row_shl:1 row_mask:0xf bank_mask:0xf bound_ctrl:0
    v_cvt_pk_bf16_f32 v23, v22, v23
    v_cndmask_b32 v12, 0, v23, vcc
    v_mov_b32 v21, v22
    s_nop 0
    v_mov_b32_dpp v13, v12 row_shl:4 row_mask:0xf bank_mask:0xf bound_ctrl:0
    v_mov_b32_dpp v14, v12 row_shl:8 row_mask:0xf bank_mask:0xf bound_ctrl:0
    v_mov_b32_dpp v15, v12 row_shl:12 row_mask:0xf bank_mask:0xf bound_ctrl:0
    v_mov_b64 v[40:41], 0
    v_mov_b64 v[42:43], 0
    v_mov_b64 v[44:45], 0
    v_mov_b64 v[46:47], 0
    v_mov_b64 v[48:49], 0
    v_mov_b64 v[50:51], 0
    v_mov_b64 v[52:53], 0
    v_mov_b64 v[54:55], 0
    v_mov_b64 v[56:57], 0
    v_mov_b64 v[58:59], 0
    v_mov_b64 v[60:61], 0
    v_mov_b64 v[62:63], 0
    s_lshl_b32 s58, s30, 3
    s_add_u32 s58, s58, 159744
    v_mov_b32 v37, s58
    v_mov_b32_dpp v16, v12 row_shr:1 row_mask:0xf bank_mask:0xf bound_ctrl:0
    v_mov_b32_dpp v17, v12 row_shl:3 row_mask:0xf bank_mask:0xf bound_ctrl:0
    v_mov_b32_dpp v18, v12 row_shl:7 row_mask:0xf bank_mask:0xf bound_ctrl:0
    v_mov_b32_dpp v19, v12 row_shl:11 row_mask:0xf bank_mask:0xf bound_ctrl:0
    v_permlane32_swap_b32 v21, v22
    v_add_f32 v21, v21, v22
    v_mov_b32 v22, v21
    s_nop 1
    v_permlane16_swap_b32 v21, v22
    v_add_f32 v21, v21, v22
    s_nop 1
    v_add_f32_dpp v21, v21, v21 row_ror:8 row_mask:0xf bank_mask:0xf
    s_nop 1
    v_add_f32_dpp v21, v21, v21 row_ror:4 row_mask:0xf bank_mask:0xf
    s_nop 1
    v_add_f32_dpp v21, v21, v21 row_ror:2 row_mask:0xf bank_mask:0xf
    s_nop 1
    v_add_f32_dpp v21, v21, v21 row_ror:1 row_mask:0xf bank_mask:0xf
    ds_write_b64 v37, v[20:21]
    v_and_b32 v36, 15, v0
    v_lshlrev_b32 v36, 4, v36
    v_add_u32 v36, s61, v36
    v_add_u32 v36, 32768, v36
    s_waitcnt lgkmcnt(0)
    s_waitcnt vmcnt(36)
    s_barrier
    ds_read_b64_tr_b16 v[194:195], v8 offset:0
    ds_read_b64_tr_b16 v[202:203], v9 offset:0
    ds_read_b64_tr_b16 v[210:211], v10 offset:0
    ds_read_b64_tr_b16 v[218:219], v11 offset:0
    s_cmp_eq_u32 s30, 6
    s_cbranch_scc0 L_skip_82
    s_mul_i32 s57, s14, 15
    s_mov_b32 m0, 61440
    s_waitcnt vmcnt(25)
    buffer_load_dwordx4 v3, s[48:51], s57 offen offset:0 nt lds
    s_mul_i32 s57, s14, 15
    s_add_u32 s57, s57, s15
    s_mov_b32 m0, 61440
    s_waitcnt vmcnt(25)
    buffer_load_dwordx4 v3, s[48:51], s57 offen offset:1024 nt lds
    s_mov_b32 s57, 786560
    s_mov_b32 s58, 1178752
    s_mov_b32 m0, 141312
L_dma_83:
    s_waitcnt vmcnt(25)
    buffer_load_dwordx4 v7, s[36:39], s57 offen offset:0 nt lds
    s_waitcnt vmcnt(25)
    buffer_load_dwordx4 v7, s[36:39], s58 offen offset:1024 nt lds
    s_add_u32 s57, s57, 24576
    s_add_u32 s58, s58, 24576
    s_add_u32 m0, m0, 2048
    s_cmp_lg_u32 m0, 157696
    s_cbranch_scc1 L_dma_83
L_skip_82:
    s_waitcnt lgkmcnt(0)
    s_cmp_lt_u32 s30, 2
    s_cbranch_scc0 L_skip_84
    v_and_b32 v37, 7, v0
    v_lshlrev_b32 v37, 3, v37
    v_add_u32 v37, 159744, v37
    ds_read_b64 v[38:39], v37
    s_lshl_b32 s57, s53, 3
    s_add_u32 s57, s57, s54
    s_lshl_b32 s57, s57, 2
    v_mov_b32 v23, s57
    s_add_u32 s57, s62, 55808
    s_waitcnt lgkmcnt(0)
    v_max_f32_dpp v37, v38, v38 row_ror:4 row_mask:0xf bank_mask:0xf
    s_nop 1
    v_max_f32_dpp v37, v37, v37 row_ror:2 row_mask:0xf bank_mask:0xf
    s_nop 1
    v_max_f32_dpp v37, v37, v37 row_ror:1 row_mask:0xf bank_mask:0xf
    v_sub_f32 v38, v38, v37
    v_exp_f32 v38, v38
    s_nop 0
    v_mul_f32 v39, v38, v39
    s_nop 1
    v_add_f32_dpp v39, v39, v39 row_ror:4 row_mask:0xf bank_mask:0xf
    s_nop 1
    v_add_f32_dpp v39, v39, v39 row_ror:2 row_mask:0xf bank_mask:0xf
    s_nop 1
    v_add_f32_dpp v39, v39, v39 row_ror:1 row_mask:0xf bank_mask:0xf
    v_log_f32 v22, v39
    v_rcp_f32 v39, v39
    v_add_f32 v22, v22, v37
    v_min_u32 v22, -2, v22
    v_mul_f32 v38, v38, v39
    s_cmp_eq_u32 s30, 0
    s_cbranch_scc0 L_skip_85
    s_mov_b64 exec, 0x1
    s_cmp_eq_u32 s55, 0
    s_cbranch_scc1 L_gs_86
    buffer_store_dword v22, v23, s[40:43], s57 offen
L_gb_87:
    s_mov_b64 exec, -1
L_skip_85:
    v_readlane_b32 s64, v38, 0
    v_readlane_b32 s65, v38, 1
    v_readlane_b32 s66, v38, 2
    v_readlane_b32 s67, v38, 3
    v_readlane_b32 s68, v38, 4
    v_readlane_b32 s69, v38, 5
    v_readlane_b32 s70, v38, 6
    v_readlane_b32 s71, v38, 7
    s_mul_i32 s57, s30, 48
    v_add_u32 v38, s57, v0
    v_bfe_u32 v20, v38, 5, 2
    v_lshlrev_b32 v20, 8, v20
    v_and_b32 v39, 15, v38
    v_lshl_add_u32 v20, v39, 4, v20
    v_bfe_u32 v39, v38, 4, 1
    v_lshl_add_u32 v20, v39, 3, v20
    v_add_u32 v20, 124928, v20
    s_lshr_b32 s57, s54, 1
    s_lshl_b32 s57, s57, 2
    s_and_b32 s58, s54, 1
    s_add_u32 s57, s57, s58
    s_lshl_b32 s58, s57, 4
    s_lshl_b32 s57, s57, 3
    v_bfe_u32 v21, v0, 3, 2
    v_lshlrev_b32 v21, 8, v21
    v_bfe_u32 v39, v0, 2, 1
    v_lshl_add_u32 v21, v39, 5, v21
    v_and_b32 v39, 3, v0
    v_lshl_add_u32 v21, v39, 2, v21
    v_add_u32 v21, s58, v21
    v_bfe_u32 v38, v0, 3, 1
    v_lshlrev_b32 v38, 8, v38
    v_bfe_u32 v39, v0, 1, 1
    v_lshl_add_u32 v38, v39, 7, v38
    v_bfe_u32 v39, v0, 2, 1
    v_lshl_add_u32 v38, v39, 4, v38
    v_and_b32 v39, 1, v0
    v_lshl_add_u32 v38, v39, 2, v38
    v_add_u32 v38, s57, v38
    v_add_u32 v38, 1024, v38
    v_cmp_gt_u32 vcc, 32, v0
    s_nop 1
    v_cndmask_b32 v21, v38, v21, vcc
    s_lshl_b32 s57, s53, 1
    s_add_u32 s57, s57, s30
    s_mul_i32 s57, s57, 1536
    s_add_u32 s57, s57, s62
    s_add_u32 s57, s57, 0
    v_add_u32 v21, s57, v21
L_skip_84:
    s_waitcnt vmcnt(36)
    s_barrier
    ds_read_b64_tr_b16 v[226:227], v8 offset:16384
    ds_read_b64_tr_b16 v[234:235], v9 offset:16384
    ds_read_b64_tr_b16 v[242:243], v10 offset:16384
    ds_read_b64_tr_b16 v[250:251], v11 offset:16384
    s_cmp_eq_u32 s30, 6
    s_cbranch_scc0 L_skip_88
    s_mov_b32 s57, 786688
    s_mov_b32 s58, 1178880
    s_mov_b32 m0, 92160
L_dma_89:
    s_waitcnt vmcnt(25)
    buffer_load_dwordx4 v7, s[36:39], s57 offen offset:0 nt lds
    s_waitcnt vmcnt(25)
    buffer_load_dwordx4 v7, s[36:39], s58 offen offset:1024 nt lds
    s_add_u32 s57, s57, 24576
    s_add_u32 s58, s58, 24576
    s_add_u32 m0, m0, 2048
    s_cmp_lg_u32 m0, 108544
    s_cbranch_scc1 L_dma_89
L_skip_88:
    s_waitcnt lgkmcnt(0)
    s_cmp_eq_u32 s30, 5
    s_cbranch_scc0 L_skip_90
    global_load_dword v2, v3, s[26:27] offset:4 sc1
L_skip_90:
    s_waitcnt vmcnt(34)
    s_barrier
    ds_read_b64_tr_b16 v[164:165], v8 offset:32768
    ds_read_b64_tr_b16 v[172:173], v9 offset:32768
    ds_read_b64_tr_b16 v[180:181], v10 offset:32768
    ds_read_b64_tr_b16 v[188:189], v11 offset:32768
    s_cmp_eq_u32 s30, 6
    s_cbranch_scc0 L_skip_91
    s_mov_b32 s57, 983040
    s_mov_b32 s58, 1375232
    s_mov_b32 m0, 108544
L_dma_92:
    s_waitcnt vmcnt(25)
    buffer_load_dwordx4 v7, s[36:39], s57 offen offset:0 nt lds
    s_waitcnt vmcnt(25)
    buffer_load_dwordx4 v7, s[36:39], s58 offen offset:1024 nt lds
    s_add_u32 s57, s57, 24576
    s_add_u32 s58, s58, 24576
    s_add_u32 m0, m0, 2048
    s_cmp_lg_u32 m0, 124928
    s_cbranch_scc1 L_dma_92
L_skip_91:
    s_waitcnt lgkmcnt(0)
    s_waitcnt vmcnt(32)
    s_barrier
    ds_read_b64_tr_b16 v[196:197], v8 offset:49152
    ds_read_b64_tr_b16 v[204:205], v9 offset:49152
    ds_read_b64_tr_b16 v[212:213], v10 offset:49152
    ds_read_b64_tr_b16 v[220:221], v11 offset:49152
    s_cmp_eq_u32 s30, 6
    s_cbranch_scc0 L_skip_93
    s_mov_b32 s57, 983168
    s_mov_b32 s58, 1375360
    s_mov_b32 m0, 124928
L_dma_94:
    s_waitcnt vmcnt(25)
    buffer_load_dwordx4 v7, s[36:39], s57 offen offset:0 nt lds
    s_waitcnt vmcnt(25)
    buffer_load_dwordx4 v7, s[36:39], s58 offen offset:1024 nt lds
    s_add_u32 s57, s57, 24576
    s_add_u32 s58, s58, 24576
    s_add_u32 m0, m0, 2048
    s_cmp_lg_u32 m0, 141312
    s_cbranch_scc1 L_dma_94
L_skip_93:
    s_waitcnt lgkmcnt(0)
    s_cmp_eq_u32 s30, 5
    s_cbranch_scc0 L_skip_95
L_cw_96:
    s_waitcnt vmcnt(0)
    v_cmp_eq_u32 vcc, 0, v2
    s_cbranch_vccnz L_cr_97
L_skip_95:
    s_cmp_eq_u32 s30, 2
    s_cbranch_scc0 L_skip_98
    s_mul_i32 s57, s52, 1792
    s_add_u32 s57, s57, s62
    v_min_u32 v37, 13, v0
    v_lshlrev_b32 v37, 7, v37
    buffer_load_dword v37, v37, s[40:43], s57 offen sc1 nt
L_skip_98:
    s_waitcnt vmcnt(32)
    s_barrier
    ds_read_b64_tr_b16 v[228:229], v8 offset:0
    ds_read_b64_tr_b16 v[236:237], v9 offset:0
    ds_read_b64_tr_b16 v[244:245], v10 offset:0
    ds_read_b64_tr_b16 v[252:253], v11 offset:0
    s_cmp_eq_u32 s30, 6
    s_cbranch_scc0 L_skip_99
    s_mov_b32 s57, 983296
    s_mov_b32 s58, 1375488
    s_mov_b32 m0, 141312
L_dma_100:
    s_waitcnt vmcnt(25)
    buffer_load_dwordx4 v7, s[36:39], s57 offen offset:0 nt lds
    s_waitcnt vmcnt(25)
    buffer_load_dwordx4 v7, s[36:39], s58 offen offset:1024 nt lds
    s_add_u32 s57, s57, 24576
    s_add_u32 s58, s58, 24576
    s_add_u32 m0, m0, 2048
    s_cmp_lg_u32 m0, 157696
    s_cbranch_scc1 L_dma_100
L_skip_99:
    s_waitcnt lgkmcnt(0)
    s_branch L_tail
.p2align 10
L_tail:
L_pad0:
    s_cbranch_execz L_pad1
    s_waitcnt vmcnt(32)
    s_barrier
    ds_read_b64_tr_b16 v[166:167], v8 offset:16384
    ds_read_b64_tr_b16 v[174:175], v9 offset:16384
    ds_read_b64_tr_b16 v[182:183], v10 offset:16384
    ds_read_b64_tr_b16 v[190:191], v11 offset:16384
    s_waitcnt lgkmcnt(0)
    v_smfmac_f32_16x16x64_bf16 v[40:43], v[12:15], v[160:167], v1
    v_smfmac_f32_16x16x64_bf16 v[40:43], v[16:19], v[168:175], v1
    v_smfmac_f32_16x16x64_bf16 v[44:47], v[12:15], v[176:183], v1
    v_smfmac_f32_16x16x64_bf16 v[44:47], v[16:19], v[184:191], v1
    s_cmp_eq_u32 s30, 6
    s_cbranch_scc0 L_skip_101
    s_mul_i32 s57, s14, 16
    s_add_u32 s58, s57, s15
    s_mov_b32 m0, 63488
L_dma_102:
    s_waitcnt vmcnt(33)
    buffer_load_dwordx4 v3, s[48:51], s57 offen offset:0 nt lds
    s_waitcnt vmcnt(33)
    buffer_load_dwordx4 v3, s[48:51], s58 offen offset:1024 nt lds
    s_add_u32 s57, s57, s14
    s_add_u32 s58, s58, s14
    s_add_u32 m0, m0, 2048
    s_cmp_lg_u32 m0, 71680
    s_cbranch_scc1 L_dma_102
    s_mul_i32 s57, s14, 20
    s_add_u32 s58, s57, s15
    s_mov_b32 m0, 71680
L_dma_103:
    s_waitcnt vmcnt(33)
    buffer_load_dwordx4 v3, s[48:51], s57 offen offset:0 nt lds
    s_waitcnt vmcnt(33)
    buffer_load_dwordx4 v3, s[48:51], s58 offen offset:1024 nt lds
    s_add_u32 s57, s57, s14
    s_add_u32 s58, s58, s14
    s_add_u32 m0, m0, 2048
    s_cmp_lg_u32 m0, 79872
    s_cbranch_scc1 L_dma_103
L_skip_101:
    s_nop 3
    v_pk_add_f32 v[24:25], v[40:41], v[42:43]
    s_nop 0
    v_pk_add_f32 v[26:27], v[44:45], v[46:47]
    s_waitcnt vmcnt(32)
    s_barrier
    ds_read_b64_tr_b16 v[198:199], v8 offset:32768
    ds_read_b64_tr_b16 v[206:207], v9 offset:32768
    ds_read_b64_tr_b16 v[214:215], v10 offset:32768
    ds_read_b64_tr_b16 v[222:223], v11 offset:32768
    s_waitcnt lgkmcnt(0)
    v_smfmac_f32_16x16x64_bf16 v[48:51], v[12:15], v[192:199], v1
    v_smfmac_f32_16x16x64_bf16 v[48:51], v[16:19], v[200:207], v1
    v_smfmac_f32_16x16x64_bf16 v[52:55], v[12:15], v[208:215], v1
    v_smfmac_f32_16x16x64_bf16 v[52:55], v[16:19], v[216:223], v1
    s_nop 5
    v_pk_add_f32 v[28:29], v[48:49], v[50:51]
    s_nop 0
    v_pk_add_f32 v[30:31], v[52:53], v[54:55]
    s_waitcnt vmcnt(16)
    s_barrier
    ds_read_b64_tr_b16 v[230:231], v8 offset:49152
    ds_read_b64_tr_b16 v[238:239], v9 offset:49152
    ds_read_b64_tr_b16 v[246:247], v10 offset:49152
    ds_read_b64_tr_b16 v[254:255], v11 offset:49152
    s_waitcnt lgkmcnt(0)
    v_smfmac_f32_16x16x64_bf16 v[56:59], v[12:15], v[224:231], v1
    v_smfmac_f32_16x16x64_bf16 v[56:59], v[16:19], v[232:239], v1
    v_smfmac_f32_16x16x64_bf16 v[60:63], v[12:15], v[240:247], v1
    v_smfmac_f32_16x16x64_bf16 v[60:63], v[16:19], v[248:255], v1
    s_nop 5
    v_pk_add_f32 v[32:33], v[56:57], v[58:59]
    s_nop 0
    v_pk_add_f32 v[34:35], v[60:61], v[62:63]
    s_setprio 0
    s_mov_b64 exec, 0xffff
    ds_write_b128 v36, v[24:27] offset:0
    ds_write_b128 v36, v[28:31] offset:256
    ds_write_b128 v36, v[32:35] offset:512
    s_mov_b64 exec, -1
    s_waitcnt lgkmcnt(0)
L_b2_0:
    s_barrier
    s_cmp_lt_u32 s30, 2
    s_cbranch_scc0 L_skip_104
    s_mov_b32 exec_lo, 0xffffffff
    s_mov_b32 exec_hi, 0xffff
L_pad1:
    s_cbranch_execz L_pad2
    ds_read_b64 v[40:41], v20 offset:0
    ds_read_b64 v[42:43], v20 offset:2048
    ds_read_b64 v[44:45], v20 offset:4096
    ds_read_b64 v[46:47], v20 offset:6144
    ds_read_b64 v[48:49], v20 offset:8192
    ds_read_b64 v[50:51], v20 offset:10240
    ds_read_b64 v[52:53], v20 offset:12288
    ds_read_b64 v[54:55], v20 offset:14336
    s_waitcnt lgkmcnt(7)
    v_mul_f32 v56, s64, v40
    v_mul_f32 v57, s64, v41
    s_waitcnt lgkmcnt(6)
    v_fmac_f32 v56, s65, v42
    v_fmac_f32 v57, s65, v43
    s_waitcnt lgkmcnt(5)
    v_fmac_f32 v56, s66, v44
    v_fmac_f32 v57, s66, v45
    s_waitcnt lgkmcnt(4)
    v_fmac_f32 v56, s67, v46
    v_fmac_f32 v57, s67, v47
    s_waitcnt lgkmcnt(3)
    v_fmac_f32 v56, s68, v48
    v_fmac_f32 v57, s68, v49
    s_waitcnt lgkmcnt(2)
    v_fmac_f32 v56, s69, v50
    v_fmac_f32 v57, s69, v51
    s_waitcnt lgkmcnt(1)
    v_fmac_f32 v56, s70, v52
    v_fmac_f32 v57, s70, v53
    s_waitcnt lgkmcnt(0)
    v_fmac_f32 v56, s71, v54
    v_fmac_f32 v57, s71, v55
    v_cvt_pk_bf16_f32 v56, v56, v57
    v_min_u32 v56, -2, v56
    s_cmp_eq_u32 s55, 0
    s_cbranch_scc1 L_gs_105
    buffer_store_dword v56, v21, s[40:43], 0 offen
L_gb_106:
    s_mov_b64 exec, -1
L_skip_104:
    s_cmp_eq_u32 s30, 6
    s_cbranch_scc0 L_skip_107
    s_waitcnt vmcnt(0)
L_skip_107:
    s_barrier
    s_cmp_lt_u32 s3, 20
    s_cbranch_scc0 L_typeB_0
    s_lshr_b32 s57, s30, 1
    s_lshl_b32 s57, s57, 5
    s_add_u32 s57, s57, s62
    s_add_u32 s59, s57, 55808
    v_and_b32 v5, 7, v0
    v_lshlrev_b32 v5, 2, v5
    v_lshrrev_b32 v22, 4, v0
    v_lshlrev_b32 v22, 3, v22
    buffer_load_dword v18, v5, s[40:43], s59 offen sc1
    buffer_load_dwordx2 v[20:21], v22, s[40:43], s59 offen sc1
    s_mul_i32 s57, s30, 6144
    v_lshrrev_b32 v7, 2, v0
    v_lshlrev_b32 v7, 6, v7
    v_bfe_u32 v60, v0, 4, 1
    v_lshl_add_u32 v7, v60, 5, v7
    v_and_b32 v60, 3, v0
    v_lshl_add_u32 v7, v60, 3, v7
    v_add_u32 v7, s57, v7
    v_add_u32 v7, 30720, v7
    v_xor_b32 v8, 32, v7
    s_mul_i32 s60, s30, 1536
    s_add_u32 s60, s60, s62
    s_add_u32 s60, s60, 0
    v_lshlrev_b32 v9, 4, v0
    v_lshlrev_b32 v10, 3, v0
    ds_read_b64_tr_b16 v[36:37], v7 offset:0
    ds_read_b64_tr_b16 v[38:39], v7 offset:1024
    ds_read_b64_tr_b16 v[40:41], v7 offset:2048
    ds_read_b64_tr_b16 v[42:43], v7 offset:3072
    ds_read_b64_tr_b16 v[44:45], v7 offset:4096
    ds_read_b64_tr_b16 v[46:47], v7 offset:5120
    ds_read_b64_tr_b16 v[48:49], v8 offset:0
    ds_read_b64_tr_b16 v[50:51], v8 offset:1024
    ds_read_b64_tr_b16 v[52:53], v8 offset:2048
    ds_read_b64_tr_b16 v[54:55], v8 offset:3072
    ds_read_b64_tr_b16 v[56:57], v8 offset:4096
    ds_read_b64_tr_b16 v[58:59], v8 offset:5120
    v_mov_b64 v[24:25], 0
    v_mov_b64 v[26:27], 0
    v_mov_b64 v[28:29], 0
    v_mov_b64 v[30:31], 0
    s_lshl_b32 s57, s30, 8
    v_lshlrev_b32 v11, 2, v0
    v_add_u32 v11, s57, v11
    v_add_u32 v11, 157696, v11
    s_waitcnt vmcnt(0)
L_pw_108:
    v_max3_u32 v19, v18, v20, v21
    v_cmp_eq_u32 vcc, -1, v19
    s_cbranch_vccnz L_pr_109
L_pad2:
    s_cbranch_execz L_pad3
    buffer_load_dwordx4 v[12:15], v9, s[40:43], s60 offen sc1
    buffer_load_dwordx2 v[16:17], v10, s[40:43], s60 offen offset:1024 sc1
    v_max_f32_dpp v19, v18, v18 row_ror:4 row_mask:0xf bank_mask:0xf
    s_nop 1
    v_max_f32_dpp v19, v19, v19 row_ror:2 row_mask:0xf bank_mask:0xf
    s_nop 1
    v_max_f32_dpp v19, v19, v19 row_ror:1 row_mask:0xf bank_mask:0xf
    v_sub_f32 v18, v18, v19
    v_sub_f32 v20, v20, v19
    v_sub_f32 v21, v21, v19
    v_exp_f32 v18, v18
    v_exp_f32 v20, v20
    v_exp_f32 v21, v21
    v_add_f32_dpp v18, v18, v18 row_ror:4 row_mask:0xf bank_mask:0xf
    s_nop 1
    v_add_f32_dpp v18, v18, v18 row_ror:2 row_mask:0xf bank_mask:0xf
    s_nop 1
    v_add_f32_dpp v18, v18, v18 row_ror:1 row_mask:0xf bank_mask:0xf
    v_rcp_f32 v18, v18
    s_nop 0
    v_mul_f32 v20, v20, v18
    v_mul_f32 v21, v21, v18
    s_waitcnt lgkmcnt(0)
    s_waitcnt vmcnt(0)
L_pw_110:
    v_max3_u32 v19, v12, v13, v14
    v_max3_u32 v19, v19, v15, v16
    v_max_u32 v19, v19, v17
    v_cmp_eq_u32 vcc, -1, v19
    s_cbranch_vccnz L_pr_111
    v_smfmac_f32_16x16x64_bf16 v[24:27], v[12:15], v[36:43], v1
    v_smfmac_f32_16x16x64_bf16 v[28:31], v[12:15], v[48:55], v1
    v_smfmac_f32_16x16x32_bf16 v[24:27], v[16:17], v[44:47], v1
    v_smfmac_f32_16x16x32_bf16 v[28:31], v[16:17], v[56:59], v1
    s_nop 6
    v_pk_add_f32 v[24:25], v[24:25], v[26:27]
    v_pk_add_f32 v[28:29], v[28:29], v[30:31]
    v_mul_f32 v24, v24, v20
    v_mul_f32 v28, v28, v20
    v_fmac_f32 v24, v25, v21
    v_fmac_f32 v28, v29, v21
    s_nop 1
    v_permlane32_swap_b32 v24, v28
    v_add_f32 v24, v24, v28
    ds_write_b32 v11, v24
    v_lshlrev_b32 v5, 2, v0
    v_add_u32 v5, 157696, v5
    s_mul_i32 s59, s31, 2560
    s_lshl_b32 s58, s3, 7
    s_add_u32 s59, s59, s58
    s_add_u32 s59, s59, 1343424
    v_lshlrev_b32 v9, 2, v0
    s_waitcnt lgkmcnt(0)
    s_barrier
    s_cmp_eq_u32 s30, 2
    s_cbranch_scc0 L_skip_112
    ds_read2st64_b32 v[12:13], v5 offset0:0 offset1:1
    ds_read2st64_b32 v[14:15], v5 offset0:2 offset1:3
    ds_read2st64_b32 v[16:17], v5 offset0:4 offset1:5
    ds_read2st64_b32 v[18:19], v5 offset0:6 offset1:7
    s_waitcnt lgkmcnt(2)
    v_pk_add_f32 v[12:13], v[12:13], v[14:15]
    s_waitcnt lgkmcnt(0)
    v_pk_add_f32 v[16:17], v[16:17], v[18:19]
    v_pk_add_f32 v[12:13], v[12:13], v[16:17]
    v_add_f32 v12, v12, v13
    v_mov_b32 v13, v12
    s_nop 1
    v_permlane16_swap_b32 v12, v13
    v_add_f32 v12, v12, v13
    v_min_u32 v12, -2, v12
    s_mov_b32 exec_lo, 0xffff0000
    s_mov_b32 exec_hi, 0xffff
    buffer_store_dword v12, v9, s[40:43], s59 offen sc1
    s_lshl_b32 s57, s3, 2
    s_add_u32 s57, s57, s62
    s_add_u32 s57, s57, 56064
    s_mov_b64 exec, 0x1
    s_cmp_eq_u32 s55, 0
    s_cbranch_scc1 L_gs_113
    buffer_store_dword v0, v0, s[40:43], s57 offen
L_gb_114:
    s_mov_b64 exec, -1
L_skip_112:
    s_sub_u32 s57, s30, 5
    s_cmp_lt_u32 s57, 2
    s_cbranch_scc0 L_skip_115
    s_sub_u32 s60, s30, 5
    s_mul_i32 s59, s60, 6144
    s_add_u32 s59, s59, 79872
    s_mov_b32 s44, s20
    s_mov_b32 s45, s21
    s_mov_b32 s46, 1966080
    s_mov_b32 s47, 0x20000
L_pad3:
    s_cbranch_execz L_pad4
    s_mul_i32 s57, s31, 245760
    s_lshl_b32 s58, s3, 6
    s_add_u32 s57, s57, s58
    s_lshl_b32 s58, s60, 5
    s_add_u32 s57, s57, s58
    v_lshrrev_b32 v5, 1, v0
    v_mul_u32_u24 v5, 1280, v5
    v_and_b32 v60, 1, v0
    v_lshl_add_u32 v5, v60, 4, v5
    v_add_u32 v5, s57, v5
    s_add_u32 m0, s59, 0
    s_mov_b32 s57, 0
    buffer_load_dwordx4 v5, s[44:47], s57 offen nt lds
    s_add_u32 m0, s59, 1024
    s_mov_b32 s57, 40960
    buffer_load_dwordx4 v5, s[44:47], s57 offen nt lds
    s_add_u32 m0, s59, 2048
    s_mov_b32 s57, 81920
    buffer_load_dwordx4 v5, s[44:47], s57 offen nt lds
    s_add_u32 m0, s59, 3072
    s_mov_b32 s57, 122880
    buffer_load_dwordx4 v5, s[44:47], s57 offen nt lds
    s_add_u32 m0, s59, 4096
    s_mov_b32 s57, 163840
    buffer_load_dwordx4 v5, s[44:47], s57 offen nt lds
    s_add_u32 m0, s59, 5120
    s_mov_b32 s57, 204800
    buffer_load_dwordx4 v5, s[44:47], s57 offen nt lds
    s_mul_i32 s57, s31, 384
    v_lshlrev_b32 v5, 1, v0
    v_add_u32 v5, s57, v5
    global_load_ushort v8, v5, s[18:19] offset:0
    global_load_ushort v9, v5, s[18:19] offset:128
    global_load_ushort v10, v5, s[18:19] offset:256
    v_lshlrev_b32 v11, 4, v0
    v_lshrrev_b32 v7, 4, v0
    v_lshlrev_b32 v7, 8, v7
    v_bfe_u32 v60, v0, 2, 2
    v_lshl_add_u32 v7, v60, 5, v7
    v_and_b32 v60, 3, v0
    v_lshl_add_u32 v7, v60, 3, v7
    v_add_u32 v7, s59, v7
    s_mul_i32 s57, s31, 2560
    s_lshl_b32 s58, s3, 7
    s_add_u32 s57, s57, s58
    s_lshl_b32 s60, s60, 6
    s_add_u32 s60, s60, s57
    s_add_u32 s60, s60, 1363968
    s_add_u32 s58, s62, 49152
    s_add_u32 s59, s58, 3072
    buffer_load_dwordx4 v[12:15], v11, s[40:43], s58 offen offset:0 sc1
    buffer_load_dwordx4 v[16:19], v11, s[40:43], s58 offen offset:1024 sc1
    buffer_load_dwordx4 v[20:23], v11, s[40:43], s58 offen offset:2048 sc1
    buffer_load_dwordx4 v[24:27], v11, s[40:43], s59 offen offset:0 sc1
    buffer_load_dwordx4 v[28:31], v11, s[40:43], s59 offen offset:1024 sc1
    buffer_load_dwordx4 v[32:35], v11, s[40:43], s59 offen offset:2048 sc1
    s_waitcnt vmcnt(0)
L_pw_116:
    v_max3_u32 v60, v12, v13, v14
    v_max3_u32 v60, v60, v15, v16
    v_max3_u32 v60, v60, v17, v18
    v_max3_u32 v60, v60, v19, v20
    v_max3_u32 v60, v60, v21, v22
    v_max3_u32 v60, v60, v23, v24
    v_max3_u32 v60, v60, v25, v26
    v_max3_u32 v60, v60, v27, v28
    v_max3_u32 v60, v60, v29, v30
    v_max3_u32 v60, v60, v31, v32
    v_max3_u32 v60, v60, v33, v34
    v_max_u32 v60, v60, v35
    v_cmp_eq_u32 vcc, -1, v60
    s_cbranch_vccnz L_pr_117
    ds_read_b64_tr_b16 v[36:37], v7 offset:0
    ds_read_b64_tr_b16 v[38:39], v7 offset:128
    ds_read_b64_tr_b16 v[40:41], v7 offset:1024
    ds_read_b64_tr_b16 v[42:43], v7 offset:1152
    ds_read_b64_tr_b16 v[44:45], v7 offset:2048
L_pad4:
    s_cbranch_execz L_pad5
    ds_read_b64_tr_b16 v[46:47], v7 offset:2176
    ds_read_b64_tr_b16 v[48:49], v7 offset:3072
    ds_read_b64_tr_b16 v[50:51], v7 offset:3200
    ds_read_b64_tr_b16 v[52:53], v7 offset:4096
    ds_read_b64_tr_b16 v[54:55], v7 offset:4224
    ds_read_b64_tr_b16 v[56:57], v7 offset:5120
    ds_read_b64_tr_b16 v[58:59], v7 offset:5248
    v_pk_add_f32 v[12:13], v[12:13], v[14:15]
    v_pk_add_f32 v[16:17], v[16:17], v[18:19]
    v_pk_add_f32 v[12:13], v[12:13], v[16:17]
    v_add_f32 v4, v12, v13
    v_pk_add_f32 v[20:21], v[20:21], v[22:23]
    v_pk_add_f32 v[24:25], v[24:25], v[26:27]
    v_pk_add_f32 v[20:21], v[20:21], v[24:25]
    v_add_f32 v5, v20, v21
    v_pk_add_f32 v[28:29], v[28:29], v[30:31]
    v_pk_add_f32 v[32:33], v[32:33], v[34:35]
    v_pk_add_f32 v[28:29], v[28:29], v[32:33]
    v_add_f32 v7, v28, v29
    v_lshlrev_b32 v8, 16, v8
    v_lshlrev_b32 v9, 16, v9
    v_lshlrev_b32 v10, 16, v10
    v_mov_b64 v[60:61], 0
    v_mov_b64 v[62:63], 0
    s_add_u32 s58, s62, 36864
    s_add_u32 s57, s62, 55552
    s_add_u32 s59, s58, 3072
    s_mov_b32 s64, 0xbdd2d3e8
    v_and_b32 v12, 7, v0
    v_lshlrev_b32 v12, 3, v12
    buffer_load_dwordx2 v[2:3], v12, s[40:43], s57 offen sc1
    s_waitcnt lgkmcnt(0)
    s_waitcnt vmcnt(0)
L_pw_118:
    v_max_u32 v13, v2, v3
    v_cmp_eq_u32 vcc, -1, v13
    s_cbranch_vccnz L_pr_119
    buffer_load_dwordx4 v[12:15], v11, s[40:43], s58 offen offset:0 sc1
    buffer_load_dwordx4 v[16:19], v11, s[40:43], s58 offen offset:1024 sc1
    buffer_load_dwordx4 v[20:23], v11, s[40:43], s58 offen offset:2048 sc1
    buffer_load_dwordx4 v[24:27], v11, s[40:43], s59 offen offset:0 sc1
    buffer_load_dwordx4 v[28:31], v11, s[40:43], s59 offen offset:1024 sc1
    buffer_load_dwordx4 v[32:35], v11, s[40:43], s59 offen offset:2048 sc1
    v_add_f32_dpp v2, v2, v2 row_ror:4 row_mask:0xf bank_mask:0xf
    v_add_f32_dpp v3, v3, v3 row_ror:4 row_mask:0xf bank_mask:0xf
    s_nop 0
    v_add_f32_dpp v2, v2, v2 row_ror:2 row_mask:0xf bank_mask:0xf
    v_add_f32_dpp v3, v3, v3 row_ror:2 row_mask:0xf bank_mask:0xf
    s_nop 0
    v_add_f32_dpp v2, v2, v2 row_ror:1 row_mask:0xf bank_mask:0xf
    v_add_f32_dpp v3, v3, v3 row_ror:1 row_mask:0xf bank_mask:0xf
    v_mul_f32 v2, 0x3acccccd, v2
    v_mul_f32 v3, 0x3acccccd, v3
    v_fma_f32 v3, -v2, v2, v3
    v_max_f32 v3, 0, v3
    v_add_f32 v3, 0x3727c5ac, v3
    v_rsq_f32 v3, v3
    s_nop 0
    v_mul_f32 v2, v2, v3
    v_fma_f32 v8, -v2, v4, v8
    v_fma_f32 v9, -v2, v5, v9
    v_fma_f32 v10, -v2, v7, v10
    v_lshlrev_b32 v7, 2, v0
    v_mov_b32 v2, 0xc0135761
    s_waitcnt vmcnt(4)
    v_pk_add_f32 v[12:13], v[12:13], v[14:15]
    v_pk_add_f32 v[16:17], v[16:17], v[18:19]
    v_pk_add_f32 v[12:13], v[12:13], v[16:17]
    v_add_f32 v12, v12, v13
    s_waitcnt vmcnt(2)
    v_pk_add_f32 v[20:21], v[20:21], v[22:23]
    v_pk_add_f32 v[24:25], v[24:25], v[26:27]
    v_pk_add_f32 v[20:21], v[20:21], v[24:25]
    v_add_f32 v13, v20, v21
    s_waitcnt vmcnt(0)
    v_pk_add_f32 v[28:29], v[28:29], v[30:31]
    v_pk_add_f32 v[32:33], v[32:33], v[34:35]
    v_pk_add_f32 v[28:29], v[28:29], v[32:33]
L_pad5:
    s_cbranch_execz L_pad6
    v_add_f32 v14, v28, v29
    v_add_f32 v15, v12, v13
    v_cmp_u_f32 vcc, v15, v14
    s_cbranch_vccnz L_hr_120
L_hk_121:
    v_fma_f32 v12, v12, v3, v8
    v_fma_f32 v13, v13, v3, v9
    v_fma_f32 v14, v14, v3, v10
    v_mul_f32 v16, v12, v12
    v_mul_f32 v17, v13, v13
    v_mul_f32 v18, v14, v14
    v_fma_f32 v16, v16, s64, v2
    v_fma_f32 v17, v17, s64, v2
    v_fma_f32 v18, v18, s64, v2
    v_mul_f32 v16, v16, v12
    v_mul_f32 v17, v17, v13
    v_mul_f32 v18, v18, v14
    v_exp_f32 v16, v16
    v_exp_f32 v17, v17
    v_exp_f32 v18, v18
    v_add_f32 v16, 1.0, v16
    v_add_f32 v17, 1.0, v17
    v_add_f32 v18, 1.0, v18
    v_rcp_f32 v16, v16
    v_rcp_f32 v17, v17
    v_rcp_f32 v18, v18
    v_mul_f32 v12, v12, v16
    v_mul_f32 v13, v13, v17
    v_mul_f32 v14, v14, v18
    v_mov_b32_dpp v16, v12 row_shl:1 row_mask:0xf bank_mask:0xf bound_ctrl:0
    v_mov_b32_dpp v17, v13 row_shl:1 row_mask:0xf bank_mask:0xf bound_ctrl:0
    v_mov_b32_dpp v18, v14 row_shl:1 row_mask:0xf bank_mask:0xf bound_ctrl:0
    v_cvt_pk_bf16_f32 v20, v12, v16
    v_cvt_pk_bf16_f32 v24, v13, v17
    v_cvt_pk_bf16_f32 v28, v14, v18
    v_mov_b32_dpp v21, v20 row_shl:4 row_mask:0xf bank_mask:0xf bound_ctrl:0
    v_mov_b32_dpp v22, v20 row_shl:8 row_mask:0xf bank_mask:0xf bound_ctrl:0
    v_mov_b32_dpp v23, v20 row_shl:12 row_mask:0xf bank_mask:0xf bound_ctrl:0
    v_mov_b32_dpp v25, v24 row_shl:4 row_mask:0xf bank_mask:0xf bound_ctrl:0
    v_mov_b32_dpp v26, v24 row_shl:8 row_mask:0xf bank_mask:0xf bound_ctrl:0
    v_mov_b32_dpp v27, v24 row_shl:12 row_mask:0xf bank_mask:0xf bound_ctrl:0
    v_smfmac_f32_16x16x64_bf16 v[60:63], v[20:23], v[36:43], v1
    v_mov_b32_dpp v29, v28 row_shl:4 row_mask:0xf bank_mask:0xf bound_ctrl:0
    v_mov_b32_dpp v30, v28 row_shl:8 row_mask:0xf bank_mask:0xf bound_ctrl:0
    v_mov_b32_dpp v31, v28 row_shl:12 row_mask:0xf bank_mask:0xf bound_ctrl:0
    v_smfmac_f32_16x16x64_bf16 v[60:63], v[24:27], v[44:51], v1
    s_nop 0
    v_smfmac_f32_16x16x64_bf16 v[60:63], v[28:31], v[52:59], v1
    s_nop 7
    v_add_f32 v60, v60, v62
    v_min_u32 v60, -2, v60
    s_mov_b64 exec, 0xffff
    buffer_store_dword v60, v7, s[40:43], s60 offen sc1
    s_cmp_eq_u32 s30, 6
    s_cbranch_scc0 L_skip_124
    s_lshl_b32 s57, s3, 2
    s_add_u32 s57, s57, s62
    s_add_u32 s57, s57, 56192
    s_mov_b64 exec, 0x1
    s_cmp_eq_u32 s55, 0
    s_cbranch_scc1 L_gs_125
    buffer_store_dword v0, v0, s[40:43], s57 offen
L_gb_126:
    s_mov_b64 exec, -1
L_skip_124:
    s_mov_b64 exec, -1
L_skip_115:
    s_branch L_p1
L_typeB_0:
    s_cmp_eq_u32 s53, 3
    s_cbranch_scc0 L_p1
    s_cmp_lt_u32 s30, 6
    s_cbranch_scc0 L_skip_127
    s_lshr_b32 s57, s30, 1
    s_mul_i32 s57, s57, 128
    s_and_b32 s58, s30, 1
    s_lshl_b32 s58, s58, 6
    s_add_u32 s57, s57, s58
    v_lshrrev_b32 v18, 5, v0
    v_lshlrev_b32 v18, 13, v18
    v_bfe_u32 v60, v0, 3, 1
    v_lshl_add_u32 v18, v60, 12, v18
    v_bfe_u32 v60, v0, 4, 1
    v_lshl_add_u32 v18, v60, 11, v18
    v_bfe_u32 v60, v0, 2, 1
    v_mul_u32_u24 v60, 384, v60
    v_add_u32 v18, v60, v18
    v_and_b32 v60, 3, v0
    v_lshl_add_u32 v18, v60, 3, v18
    v_add_u32 v18, s57, v18
    v_add_u32 v18, 30720, v18
    v_bfe_u32 v19, v0, 4, 1
    v_lshlrev_b32 v19, 12, v19
L_pad6:
    s_cbranch_execz L_pad7
    v_bfe_u32 v60, v0, 3, 1
    v_lshl_add_u32 v19, v60, 11, v19
    v_bfe_u32 v60, v0, 2, 1
    v_mul_u32_u24 v60, 384, v60
    v_add_u32 v19, v60, v19
    v_and_b32 v60, 3, v0
    v_lshl_add_u32 v19, v60, 3, v19
    v_add_u32 v19, s57, v19
    v_add_u32 v19, 63488, v19
    ds_read_b64_tr_b16 v[36:37], v18 offset:0
    ds_read_b64_tr_b16 v[38:39], v18 offset:1024
    ds_read_b64_tr_b16 v[40:41], v18 offset:16384
    ds_read_b64_tr_b16 v[42:43], v18 offset:17408
    ds_read_b64_tr_b16 v[44:45], v19 offset:0
    ds_read_b64_tr_b16 v[46:47], v19 offset:1024
    ds_read_b64_tr_b16 v[48:49], v18 offset:32
    ds_read_b64_tr_b16 v[50:51], v18 offset:1056
    ds_read_b64_tr_b16 v[52:53], v18 offset:16416
    ds_read_b64_tr_b16 v[54:55], v18 offset:17440
    ds_read_b64_tr_b16 v[56:57], v19 offset:32
    ds_read_b64_tr_b16 v[58:59], v19 offset:1056
    v_lshrrev_b32 v32, 4, v0
    v_lshlrev_b32 v32, 5, v32
    v_bfe_u32 v60, v0, 1, 1
    v_lshl_add_u32 v32, v60, 4, v32
    v_and_b32 v60, 1, v0
    v_mul_u32_u24 v60, 192, v60
    v_add_u32 v32, v60, v32
    v_add_u32 v32, 159872, v32
    v_lshrrev_b32 v33, 4, v0
    v_lshlrev_b32 v33, 4, v33
    v_bfe_u32 v60, v0, 1, 1
    v_lshl_add_u32 v33, v60, 3, v33
    v_and_b32 v60, 1, v0
    v_mul_u32_u24 v60, 192, v60
    v_add_u32 v33, v60, v33
    v_add_u32 v33, 160000, v33
    v_mov_b64 v[24:25], 0
    v_mov_b64 v[26:27], 0
    v_mov_b64 v[28:29], 0
    v_mov_b64 v[30:31], 0
    s_lshr_b32 s57, s30, 1
    s_lshl_b32 s57, s57, 11
    s_and_b32 s58, s30, 1
    s_lshl_b32 s58, s58, 9
    s_add_u32 s57, s57, s58
    s_lshr_b32 s58, s54, 2
    s_lshl_b32 s58, s58, 10
    s_add_u32 s57, s57, s58
    s_and_b32 s58, s54, 3
    s_lshl_b32 s58, s58, 2
    s_add_u32 s57, s57, s58
    v_and_b32 v34, 31, v0
    v_lshlrev_b32 v34, 4, v34
    v_add_u32 v34, s57, v34
    s_add_u32 s59, s62, 36864
    s_add_u32 s60, s62, 55552
    ds_read_b128 v[12:15], v32
    ds_read_b64 v[16:17], v33
    s_waitcnt lgkmcnt(1)
    v_smfmac_f32_16x16x64_bf16 v[24:27], v[12:15], v[36:43], v1
    v_smfmac_f32_16x16x64_bf16 v[28:31], v[12:15], v[48:55], v1
    s_waitcnt lgkmcnt(0)
    v_smfmac_f32_16x16x32_bf16 v[24:27], v[16:17], v[44:47], v1
    v_smfmac_f32_16x16x32_bf16 v[28:31], v[16:17], v[56:59], v1
    s_add_u32 s60, s62, 49152
    s_nop 5
    v_add_f32 v12, v25, v27
    s_nop 1
    v_add_f32_dpp v12, v29, v31 quad_perm:[0,1,2,3] row_mask:0x2 bank_mask:0xf
    v_min_u32 v12, -2, v12
    s_mov_b32 exec_lo, 0xffffffff
    s_mov_b32 exec_hi, 0x0
    s_cmp_eq_u32 s55, 0
    s_cbranch_scc1 L_gs_128
    buffer_store_dword v12, v34, s[40:43], s60 offen
L_gb_129:
    s_mov_b64 exec, -1
    v_mov_b64 v[24:25], 0
    v_mov_b64 v[26:27], 0
    v_mov_b64 v[28:29], 0
    v_mov_b64 v[30:31], 0
L_skip_127:
    s_cmp_eq_u32 s30, 7
    s_cbranch_scc0 L_skip_130
    v_and_b32 v60, 31, v0
    v_min_u32 v60, 19, v60
    s_mul_i32 s57, s54, 320
    v_lshrrev_b32 v5, 5, v0
    v_mul_u32_u24 v5, 2560, v5
L_pad7:
    s_cbranch_execz L_pad8
    v_add_u32 v5, s57, v5
    v_lshl_add_u32 v5, v60, 4, v5
    v_and_b32 v60, 31, v0
    v_cmp_gt_u32 s[64:65], 20, v60
    v_min_u32 v60, 19, v60
    v_lshrrev_b32 v35, 5, v0
    v_lshlrev_b32 v35, 2, v35
    v_add_u32 v35, 159872, v35
    v_lshl_add_u32 v35, v60, 3, v35
    s_add_u32 s66, s62, 36864
    s_add_u32 s67, s62, 55552
    s_lshl_b32 s57, s54, 3
    v_lshrrev_b32 v34, 5, v0
    v_lshlrev_b32 v34, 2, v34
    v_add_u32 v34, s57, v34
    v_mov_b32 v61, 0x3f803f80
    s_add_u32 s57, s62, 56064
    v_min_u32 v9, 19, v0
    v_lshlrev_b32 v9, 2, v9
    buffer_load_dword v12, v9, s[40:43], s57 offen sc1
    s_waitcnt vmcnt(0)
L_pw_131:
    v_cmp_eq_u32 vcc, -1, v12
    s_cbranch_vccnz L_pr_132
    s_mov_b32 s57, 1343488
    buffer_load_dwordx4 v[12:15], v5, s[40:43], s57 offen sc1
    s_mov_b32 s58, 1348608
    buffer_load_dwordx4 v[16:19], v5, s[40:43], s58 offen sc1
    s_mov_b32 s59, 1353728
    buffer_load_dwordx4 v[20:23], v5, s[40:43], s59 offen sc1
    s_mov_b32 s60, 1358848
    buffer_load_dwordx4 v[24:27], v5, s[40:43], s60 offen sc1
L_gw_133:
    s_waitcnt vmcnt(2)
    v_pk_add_f32 v[28:29], v[12:13], v[16:17]
    v_pk_add_f32 v[30:31], v[14:15], v[18:19]
    s_waitcnt vmcnt(1)
    v_pk_add_f32 v[28:29], v[28:29], v[20:21]
    v_pk_add_f32 v[30:31], v[30:31], v[22:23]
    s_waitcnt vmcnt(0)
    v_pk_add_f32 v[28:29], v[28:29], v[24:25]
    v_pk_add_f32 v[30:31], v[30:31], v[26:27]
    s_nop 1
    v_permlane32_swap_b32 v28, v30
    v_permlane32_swap_b32 v29, v31
    v_pk_add_f32 v[28:29], v[28:29], v[30:31]
    v_pk_add_f32 v[28:29], v[28:29], v[2:3]
    v_cmp_u_f32 vcc, v28, v29
    s_cbranch_vccnz L_gr_134
L_gk_135:
    v_cvt_pk_bf16_f32 v28, v28, v29
    ds_write_b32 v35, v28
    s_waitcnt lgkmcnt(0)
L_skip_130:
    s_barrier
    s_cmp_lt_u32 s30, 6
    s_cbranch_scc0 L_skip_140
    ds_read_b128 v[12:15], v32
    ds_read_b64 v[16:17], v33
    s_waitcnt lgkmcnt(1)
    v_smfmac_f32_16x16x64_bf16 v[24:27], v[12:15], v[36:43], v1
    v_smfmac_f32_16x16x64_bf16 v[28:31], v[12:15], v[48:55], v1
    s_waitcnt lgkmcnt(0)
    v_smfmac_f32_16x16x32_bf16 v[24:27], v[16:17], v[44:47], v1
    v_smfmac_f32_16x16x32_bf16 v[28:31], v[16:17], v[56:59], v1
    s_nop 6
    v_add_f32 v12, v24, v26
    s_nop 1
    v_add_f32_dpp v12, v28, v30 quad_perm:[0,1,2,3] row_mask:0x2 bank_mask:0xf
    v_min_u32 v12, -2, v12
    s_mov_b32 exec_lo, 0xffffffff
    s_mov_b32 exec_hi, 0x0
    s_cmp_eq_u32 s55, 0
    s_cbranch_scc1 L_gs_141
    buffer_store_dword v12, v34, s[40:43], s59 offen
L_gb_142:
    s_mov_b64 exec, -1
L_skip_140:
    s_cmp_eq_u32 s30, 7
    s_cbranch_scc0 L_skip_143
    v_lshlrev_b32 v2, 16, v28
    v_and_b32 v3, 0xffff0000, v28
    v_cndmask_b32 v28, 0, v28, s[64:65]
    v_dot2_f32_bf16 v27, v28, v61, 0
    v_dot2_f32_bf16 v62, v28, v28, 0
    s_nop 2
    v_permlane32_swap_b32 v27, v62
    v_add_f32 v27, v27, v62
    v_mov_b32 v62, v27
    s_nop 1
    v_permlane16_swap_b32 v27, v62
    v_add_f32 v27, v27, v62
    s_nop 1
    v_add_f32_dpp v27, v27, v27 row_ror:8 row_mask:0xf bank_mask:0xf
L_pad8:
    s_cbranch_execz L_pad9
    s_nop 1
    v_add_f32_dpp v27, v27, v27 row_ror:4 row_mask:0xf bank_mask:0xf
    s_nop 1
    v_add_f32_dpp v27, v27, v27 row_ror:2 row_mask:0xf bank_mask:0xf
    s_nop 1
    v_add_f32_dpp v27, v27, v27 row_ror:1 row_mask:0xf bank_mask:0xf
    v_min_u32 v27, -2, v27
    s_mov_b32 exec_lo, 0x1
    s_mov_b32 exec_hi, 0x1
    s_cmp_eq_u32 s55, 0
    s_cbranch_scc1 L_gs_144
    buffer_store_dword v27, v34, s[40:43], s67 offen
L_gb_145:
    s_mov_b64 exec, -1
L_skip_143:
L_p1:
    s_cmp_lt_u32 s30, 6
    s_cbranch_scc0 L_skip_146
    s_lshr_b32 s57, s30, 1
    s_mul_i32 s57, s57, 1024
    s_and_b32 s58, s30, 1
    s_lshl_b32 s58, s58, 6
    s_add_u32 s57, s57, s58
    v_lshrrev_b32 v18, 5, v0
    v_mul_u32_u24 v18, 6144, v18
    v_bfe_u32 v60, v0, 3, 1
    v_mul_u32_u24 v60, 3072, v60
    v_add_u32 v18, v60, v18
    v_bfe_u32 v60, v0, 4, 1
    v_lshl_add_u32 v18, v60, 9, v18
    v_bfe_u32 v60, v0, 2, 1
    v_lshl_add_u32 v18, v60, 7, v18
    v_and_b32 v60, 3, v0
    v_lshl_add_u32 v18, v60, 3, v18
    v_add_u32 v18, s57, v18
    v_bfe_u32 v19, v0, 4, 1
    v_mul_u32_u24 v19, 3072, v19
    v_bfe_u32 v60, v0, 3, 1
    v_lshl_add_u32 v19, v60, 9, v19
    v_bfe_u32 v60, v0, 2, 1
    v_lshl_add_u32 v19, v60, 7, v19
    v_and_b32 v60, 3, v0
    v_lshl_add_u32 v19, v60, 3, v19
    v_add_u32 v19, s57, v19
    v_add_u32 v19, 24576, v19
    ds_read_b64_tr_b16 v[36:37], v18 offset:0
    ds_read_b64_tr_b16 v[38:39], v18 offset:256
    ds_read_b64_tr_b16 v[40:41], v18 offset:12288
    ds_read_b64_tr_b16 v[42:43], v18 offset:12544
    ds_read_b64_tr_b16 v[44:45], v19 offset:0
    ds_read_b64_tr_b16 v[46:47], v19 offset:256
    ds_read_b64_tr_b16 v[48:49], v18 offset:32
    ds_read_b64_tr_b16 v[50:51], v18 offset:288
    ds_read_b64_tr_b16 v[52:53], v18 offset:12320
    ds_read_b64_tr_b16 v[54:55], v18 offset:12576
    ds_read_b64_tr_b16 v[56:57], v19 offset:32
    ds_read_b64_tr_b16 v[58:59], v19 offset:288
    v_lshrrev_b32 v32, 4, v0
    v_lshlrev_b32 v32, 5, v32
    v_bfe_u32 v60, v0, 1, 1
    v_lshl_add_u32 v32, v60, 4, v32
    v_and_b32 v60, 1, v0
    v_mul_u32_u24 v60, 192, v60
    v_add_u32 v32, v60, v32
    v_add_u32 v32, 159872, v32
    v_lshrrev_b32 v33, 4, v0
    v_lshlrev_b32 v33, 4, v33
    v_bfe_u32 v60, v0, 1, 1
    v_lshl_add_u32 v33, v60, 3, v33
    v_and_b32 v60, 1, v0
    v_mul_u32_u24 v60, 192, v60
    v_add_u32 v33, v60, v33
    v_add_u32 v33, 160000, v33
    v_mov_b64 v[24:25], 0
    v_mov_b64 v[26:27], 0
    v_mov_b64 v[28:29], 0
    v_mov_b64 v[30:31], 0
    s_lshr_b32 s57, s54, 1
    s_lshl_b32 s57, s57, 2
    s_and_b32 s58, s54, 1
    s_add_u32 s57, s57, s58
    s_lshl_b32 s57, s57, 4
    s_lshl_b32 s58, s30, 9
    s_add_u32 s57, s57, s58
    v_bfe_u32 v34, v0, 4, 1
    v_lshlrev_b32 v34, 8, v34
    v_bfe_u32 v60, v0, 1, 1
L_pad9:
    s_cbranch_execz L_pad10
    v_lshl_add_u32 v34, v60, 5, v34
    v_bfe_u32 v60, v0, 2, 2
    v_lshl_add_u32 v34, v60, 2, v34
    v_lshrrev_b32 v60, 5, v0
    v_mul_u32_u24 v60, 3072, v60
    v_add_u32 v34, v60, v34
    v_add_u32 v34, s57, v34
    s_mul_i32 s59, s53, 3072
    s_add_u32 s59, s59, s62
    s_add_u32 s59, s59, 24576
    s_lshl_b32 s60, s53, 6
    s_add_u32 s60, s60, s62
    s_add_u32 s60, s60, 55296
L_skip_146:
    s_cmp_eq_u32 s30, 7
    s_cbranch_scc0 L_skip_147
    v_and_b32 v60, 31, v0
    v_min_u32 v60, 19, v60
    s_mul_i32 s57, s54, 320
    v_lshrrev_b32 v5, 5, v0
    v_mul_u32_u24 v5, 2560, v5
    v_add_u32 v5, s57, v5
    v_lshl_add_u32 v5, v60, 4, v5
    v_and_b32 v60, 31, v0
    v_cmp_gt_u32 s[64:65], 20, v60
    v_min_u32 v60, 19, v60
    v_lshrrev_b32 v35, 5, v0
    v_lshlrev_b32 v35, 2, v35
    v_add_u32 v35, 159872, v35
    v_lshl_add_u32 v35, v60, 3, v35
    s_mul_i32 s66, s53, 3072
    s_add_u32 s66, s66, s62
    s_add_u32 s66, s66, 24576
    s_lshl_b32 s67, s53, 6
    s_add_u32 s67, s67, s62
    s_add_u32 s67, s67, 55296
    s_lshl_b32 s57, s54, 3
    v_lshrrev_b32 v34, 5, v0
    v_lshlrev_b32 v34, 2, v34
    v_add_u32 v34, s57, v34
    v_mov_b32 v61, 0x3f803f80
    s_cmp_lg_u32 s53, 3
    s_cbranch_scc0 L_skip_148
    s_add_u32 s57, s62, 55552
    v_mov_b32 v9, 0
    buffer_load_dword v12, v9, s[40:43], s57 offen sc1
    s_waitcnt vmcnt(0)
L_pw_149:
    v_cmp_eq_u32 vcc, -1, v12
    s_cbranch_vccnz L_pr_150
    s_mov_b32 s57, 1343488
    buffer_load_dwordx4 v[12:15], v5, s[40:43], s57 offen sc1
    s_mov_b32 s58, 1348608
    buffer_load_dwordx4 v[16:19], v5, s[40:43], s58 offen sc1
    s_mov_b32 s59, 1353728
    buffer_load_dwordx4 v[20:23], v5, s[40:43], s59 offen sc1
    s_mov_b32 s60, 1358848
    buffer_load_dwordx4 v[24:27], v5, s[40:43], s60 offen sc1
L_gw_151:
    s_waitcnt vmcnt(2)
    v_pk_add_f32 v[28:29], v[12:13], v[16:17]
    v_pk_add_f32 v[30:31], v[14:15], v[18:19]
    s_waitcnt vmcnt(1)
    v_pk_add_f32 v[28:29], v[28:29], v[20:21]
    v_pk_add_f32 v[30:31], v[30:31], v[22:23]
    s_waitcnt vmcnt(0)
    v_pk_add_f32 v[28:29], v[28:29], v[24:25]
    v_pk_add_f32 v[30:31], v[30:31], v[26:27]
    s_nop 1
    v_permlane32_swap_b32 v28, v30
    v_permlane32_swap_b32 v29, v31
    v_pk_add_f32 v[28:29], v[28:29], v[30:31]
    v_pk_add_f32 v[28:29], v[28:29], v[2:3]
    v_cmp_u_f32 vcc, v28, v29
    s_cbranch_vccnz L_gr_152
L_gk_153:
    v_cvt_pk_bf16_f32 v28, v28, v29
    v_lshlrev_b32 v2, 16, v28
    v_and_b32 v3, 0xffff0000, v28
L_skip_148:
    v_lshlrev_b32 v60, 16, v4
    v_add_f32 v2, v2, v60
    v_and_b32 v60, 0xffff0000, v4
    v_add_f32 v3, v3, v60
    s_add_u32 s57, s62, 56192
    v_min_u32 v9, 19, v0
    v_lshlrev_b32 v9, 2, v9
    buffer_load_dword v12, v9, s[40:43], s57 offen sc1
    s_waitcnt vmcnt(0)
L_pw_158:
    v_cmp_eq_u32 vcc, -1, v12
    s_cbranch_vccnz L_pr_159
L_pad10:
    s_cbranch_execz L_pad11
    s_mov_b32 s57, 1363968
    buffer_load_dwordx4 v[12:15], v5, s[40:43], s57 offen sc1
    s_mov_b32 s58, 1369088
    buffer_load_dwordx4 v[16:19], v5, s[40:43], s58 offen sc1
    s_mov_b32 s59, 1374208
    buffer_load_dwordx4 v[20:23], v5, s[40:43], s59 offen sc1
    s_mov_b32 s60, 1379328
    buffer_load_dwordx4 v[24:27], v5, s[40:43], s60 offen sc1
L_gw_160:
    s_waitcnt vmcnt(2)
    v_pk_add_f32 v[28:29], v[12:13], v[16:17]
    v_pk_add_f32 v[30:31], v[14:15], v[18:19]
    s_waitcnt vmcnt(1)
    v_pk_add_f32 v[28:29], v[28:29], v[20:21]
    v_pk_add_f32 v[30:31], v[30:31], v[22:23]
    s_waitcnt vmcnt(0)
    v_pk_add_f32 v[28:29], v[28:29], v[24:25]
    v_pk_add_f32 v[30:31], v[30:31], v[26:27]
    s_nop 1
    v_permlane32_swap_b32 v28, v30
    v_permlane32_swap_b32 v29, v31
    v_pk_add_f32 v[28:29], v[28:29], v[30:31]
    v_pk_add_f32 v[28:29], v[28:29], v[2:3]
    v_cmp_u_f32 vcc, v28, v29
    s_cbranch_vccnz L_gr_161
L_gk_162:
    v_cvt_pk_bf16_f32 v28, v28, v29
    ds_write_b32 v35, v28
    s_waitcnt lgkmcnt(0)
L_skip_147:
    s_barrier
    s_cmp_lt_u32 s30, 6
    s_cbranch_scc0 L_skip_167
    ds_read_b128 v[12:15], v32
    ds_read_b64 v[16:17], v33
    s_waitcnt lgkmcnt(1)
    v_smfmac_f32_16x16x64_bf16 v[24:27], v[12:15], v[36:43], v1
    v_smfmac_f32_16x16x64_bf16 v[28:31], v[12:15], v[48:55], v1
    s_waitcnt lgkmcnt(0)
    v_smfmac_f32_16x16x32_bf16 v[24:27], v[16:17], v[44:47], v1
    v_smfmac_f32_16x16x32_bf16 v[28:31], v[16:17], v[56:59], v1
    s_nop 6
    v_add_f32 v12, v24, v26
    s_nop 1
    v_add_f32_dpp v12, v28, v30 quad_perm:[0,1,2,3] row_mask:0x2 bank_mask:0xf
    s_nop 1
    v_mov_b32_dpp v13, v12 row_shl:1 row_mask:0xf bank_mask:0xf bound_ctrl:0
    v_cvt_pk_bf16_f32 v12, v12, v13
    v_min_u32 v12, -2, v12
    s_mov_b64 exec, 0x55555555
    s_cmp_eq_u32 s55, 0
    s_cbranch_scc1 L_gs_168
    buffer_store_dword v12, v34, s[40:43], s59 offen
L_gb_169:
    s_mov_b64 exec, -1
L_skip_167:
    s_cmp_eq_u32 s30, 7
    s_cbranch_scc0 L_skip_170
    v_lshlrev_b32 v2, 16, v28
    v_and_b32 v3, 0xffff0000, v28
    v_cndmask_b32 v28, 0, v28, s[64:65]
    v_dot2_f32_bf16 v27, v28, v61, 0
    v_dot2_f32_bf16 v62, v28, v28, 0
    s_nop 2
    v_permlane32_swap_b32 v27, v62
    v_add_f32 v27, v27, v62
    v_mov_b32 v62, v27
    s_nop 1
    v_permlane16_swap_b32 v27, v62
    v_add_f32 v27, v27, v62
    s_nop 1
    v_add_f32_dpp v27, v27, v27 row_ror:8 row_mask:0xf bank_mask:0xf
    s_nop 1
    v_add_f32_dpp v27, v27, v27 row_ror:4 row_mask:0xf bank_mask:0xf
    s_nop 1
    v_add_f32_dpp v27, v27, v27 row_ror:2 row_mask:0xf bank_mask:0xf
    s_nop 1
    v_add_f32_dpp v27, v27, v27 row_ror:1 row_mask:0xf bank_mask:0xf
    v_min_u32 v27, -2, v27
    s_mov_b32 exec_lo, 0x1
    s_mov_b32 exec_hi, 0x1
    s_cmp_eq_u32 s55, 0
    s_cbranch_scc1 L_gs_171
    buffer_store_dword v27, v34, s[40:43], s67 offen
L_gb_172:
    s_mov_b64 exec, -1
L_skip_170:
    s_mul_i32 s59, s53, 3072
    s_add_u32 s59, s59, s62
    s_add_u32 s59, s59, 24576
    s_lshl_b32 s60, s53, 6
    s_add_u32 s60, s60, s62
    s_add_u32 s60, s60, 55296
L_pad11:
    s_cbranch_execz L_pad12
    v_lshlrev_b32 v5, 4, v0
    v_add_u32 v5, s59, v5
    v_and_b32 v7, 7, v0
    v_lshlrev_b32 v7, 3, v7
    v_add_u32 v7, s60, v7
    buffer_load_dwordx2 v[8:9], v7, s[40:43], 0 offen sc1
    buffer_load_dwordx4 v[12:15], v5, s[40:43], 0 offen offset:0 sc1
    buffer_load_dwordx4 v[16:19], v5, s[40:43], 0 offen offset:1024 sc1
    buffer_load_dwordx4 v[20:23], v5, s[40:43], 0 offen offset:2048 sc1
    v_mov_b64 v[24:25], 0
    v_mov_b64 v[26:27], 0
    v_mov_b64 v[28:29], 0
    v_mov_b64 v[30:31], 0
    v_mov_b64 v[32:33], 0
    v_mov_b64 v[34:35], 0
    v_mov_b64 v[36:37], 0
    v_mov_b64 v[38:39], 0
    v_mov_b64 v[40:41], 0
    v_mov_b64 v[42:43], 0
    v_mov_b64 v[44:45], 0
    v_mov_b64 v[46:47], 0
    v_mov_b64 v[48:49], 0
    v_mov_b64 v[50:51], 0
    v_mov_b64 v[52:53], 0
    v_mov_b64 v[54:55], 0
    v_mov_b64 v[56:57], 0
    v_mov_b64 v[58:59], 0
    v_mov_b64 v[60:61], 0
    v_mov_b64 v[62:63], 0
    s_lshl_b32 s58, s30, 3
    s_add_u32 s58, s58, 159744
    v_mov_b32 v10, s58
    s_waitcnt vmcnt(0)
L_pw_173:
    v_max3_u32 v11, v8, v9, v12
    v_max3_u32 v11, v11, v13, v14
    v_max3_u32 v11, v11, v15, v16
    v_max3_u32 v11, v11, v17, v18
    v_max3_u32 v11, v11, v19, v20
    v_max3_u32 v11, v11, v21, v22
    v_max_u32 v11, v11, v23
    v_cmp_eq_u32 vcc, -1, v11
    s_cbranch_vccnz L_pr_174
    v_smfmac_f32_16x16x64_bf16 v[24:27], v[12:15], v[64:71], v1
    v_add_f32_dpp v8, v8, v8 row_ror:4 row_mask:0xf bank_mask:0xf
    v_add_f32_dpp v9, v9, v9 row_ror:4 row_mask:0xf bank_mask:0xf
    v_smfmac_f32_16x16x64_bf16 v[24:27], v[16:19], v[72:79], v1
    v_add_f32_dpp v8, v8, v8 row_ror:2 row_mask:0xf bank_mask:0xf
    v_add_f32_dpp v9, v9, v9 row_ror:2 row_mask:0xf bank_mask:0xf
    v_smfmac_f32_16x16x64_bf16 v[24:27], v[20:23], v[80:87], v1
    v_add_f32_dpp v8, v8, v8 row_ror:1 row_mask:0xf bank_mask:0xf
    v_add_f32_dpp v9, v9, v9 row_ror:1 row_mask:0xf bank_mask:0xf
    v_smfmac_f32_16x16x64_bf16 v[32:35], v[12:15], v[112:119], v1
    v_mul_f32 v8, 0x3acccccd, v8
    v_mul_f32 v9, 0x3acccccd, v9
    v_smfmac_f32_16x16x64_bf16 v[32:35], v[16:19], v[120:127], v1
    v_fma_f32 v9, -v8, v8, v9
    v_max_f32 v9, 0, v9
    v_smfmac_f32_16x16x64_bf16 v[32:35], v[20:23], v[128:135], v1
    v_add_f32 v9, 0x3727c5ac, v9
    v_rsq_f32 v9, v9
    v_smfmac_f32_16x16x64_bf16 v[28:31], v[12:15], v[88:95], v1
    s_mov_b32 vcc_lo, 0x55555555
    v_mul_f32 v9, 0x3dd53b95, v9
    v_smfmac_f32_16x16x64_bf16 v[28:31], v[16:19], v[96:103], v1
    s_mov_b32 vcc_hi, 0x55555555
    v_smfmac_f32_16x16x64_bf16 v[28:31], v[20:23], v[104:111], v1
    v_smfmac_f32_16x16x64_bf16 v[36:39], v[12:15], v[136:143], v1
    v_pk_add_f32 v[24:25], v[24:25], v[26:27]
    v_add_f32 v24, v24, v25
    v_smfmac_f32_16x16x64_bf16 v[36:39], v[16:19], v[144:151], v1
    v_pk_add_f32 v[32:33], v[32:33], v[34:35]
    v_add_f32 v32, v32, v33
    v_smfmac_f32_16x16x64_bf16 v[36:39], v[20:23], v[152:159], v1
    s_nop 0
    v_permlane32_swap_b32 v24, v32
    v_add_f32 v24, v24, v32
    v_pk_add_f32 v[28:29], v[28:29], v[30:31]
    v_add_f32 v28, v28, v29
    s_nop 2
    v_pk_add_f32 v[36:37], v[36:37], v[38:39]
    v_add_f32 v36, v36, v37
    s_nop 1
    v_permlane32_swap_b32 v28, v36
    v_add_f32 v28, v28, v36
    s_nop 1
    v_permlane16_swap_b32 v24, v28
    v_add_f32 v24, v24, v28
L_pad12:
    s_cbranch_execz L_pad13
    v_fma_f32 v24, -v8, v6, v24
    s_nop 1
    v_max_f32_dpp v21, v24, v24 row_ror:8 row_mask:0xf bank_mask:0xf
    s_nop 1
    v_max_f32_dpp v21, v21, v21 row_ror:4 row_mask:0xf bank_mask:0xf
    s_nop 1
    v_max_f32_dpp v21, v21, v21 row_ror:2 row_mask:0xf bank_mask:0xf
    s_nop 1
    v_max_f32_dpp v21, v21, v21 row_ror:1 row_mask:0xf bank_mask:0xf
    s_nop 1
    v_max_f32_dpp v21, v21, v21 row_bcast:15 row_mask:0xa bank_mask:0xf
    s_nop 1
    v_max_f32_dpp v21, v21, v21 row_bcast:31 row_mask:0xc bank_mask:0xf
    s_nop 0
    v_readlane_b32 s57, v21, 63
    s_nop 1
    v_subrev_f32 v24, s57, v24
    v_mul_f32 v24, v24, v9
    v_exp_f32 v22, v24
    v_mul_f32 v20, s57, v9
    s_nop 0
    v_mov_b32_dpp v23, v22 row_shl:1 row_mask:0xf bank_mask:0xf bound_ctrl:0
    v_cvt_pk_bf16_f32 v23, v22, v23
    v_cndmask_b32 v12, 0, v23, vcc
    v_mov_b32 v21, v22
    s_nop 0
    v_mov_b32_dpp v13, v12 row_shl:4 row_mask:0xf bank_mask:0xf bound_ctrl:0
    v_mov_b32_dpp v14, v12 row_shl:8 row_mask:0xf bank_mask:0xf bound_ctrl:0
    v_mov_b32_dpp v15, v12 row_shl:12 row_mask:0xf bank_mask:0xf bound_ctrl:0
    s_nop 1
    v_smfmac_f32_16x16x64_bf16 v[40:43], v[12:15], v[160:167], v1
    v_mov_b32_dpp v16, v12 row_shr:1 row_mask:0xf bank_mask:0xf bound_ctrl:0
    v_mov_b32_dpp v17, v12 row_shl:3 row_mask:0xf bank_mask:0xf bound_ctrl:0
    v_smfmac_f32_16x16x64_bf16 v[44:47], v[12:15], v[176:183], v1
    v_mov_b32_dpp v18, v12 row_shl:7 row_mask:0xf bank_mask:0xf bound_ctrl:0
    v_mov_b32_dpp v19, v12 row_shl:11 row_mask:0xf bank_mask:0xf bound_ctrl:0
    v_smfmac_f32_16x16x64_bf16 v[48:51], v[12:15], v[192:199], v1
    v_permlane32_swap_b32 v21, v22
    v_add_f32 v21, v21, v22
    v_smfmac_f32_16x16x64_bf16 v[52:55], v[12:15], v[208:215], v1
    v_mov_b32 v22, v21
    s_nop 1
    v_permlane16_swap_b32 v21, v22
    v_smfmac_f32_16x16x64_bf16 v[56:59], v[12:15], v[224:231], v1
    v_add_f32 v21, v21, v22
    s_nop 1
    v_add_f32_dpp v21, v21, v21 row_ror:8 row_mask:0xf bank_mask:0xf
    v_smfmac_f32_16x16x64_bf16 v[60:63], v[12:15], v[240:247], v1
    s_nop 0
    v_add_f32_dpp v21, v21, v21 row_ror:4 row_mask:0xf bank_mask:0xf
    s_nop 1
    v_add_f32_dpp v21, v21, v21 row_ror:2 row_mask:0xf bank_mask:0xf
    v_smfmac_f32_16x16x64_bf16 v[40:43], v[16:19], v[168:175], v1
    s_nop 0
    v_add_f32_dpp v21, v21, v21 row_ror:1 row_mask:0xf bank_mask:0xf
    ds_write_b64 v10, v[20:21]
    v_smfmac_f32_16x16x64_bf16 v[44:47], v[16:19], v[184:191], v1
    v_and_b32 v36, 15, v0
    v_lshlrev_b32 v36, 4, v36
    v_add_u32 v36, s61, v36
    v_add_u32 v36, 32768, v36
    v_smfmac_f32_16x16x64_bf16 v[48:51], v[16:19], v[200:207], v1
    v_smfmac_f32_16x16x64_bf16 v[52:55], v[16:19], v[216:223], v1
    s_cmp_ge_u32 s30, 4
    s_cbranch_scc0 L_skip_175
    s_waitcnt lgkmcnt(0)
    s_barrier
L_skip_175:
    v_smfmac_f32_16x16x64_bf16 v[56:59], v[16:19], v[232:239], v1
    v_smfmac_f32_16x16x64_bf16 v[60:63], v[16:19], v[248:255], v1
    v_pk_add_f32 v[24:25], v[40:41], v[42:43]
    v_pk_add_f32 v[26:27], v[44:45], v[46:47]
    s_nop 0
    v_pk_add_f32 v[28:29], v[48:49], v[50:51]
    v_pk_add_f32 v[30:31], v[52:53], v[54:55]
    s_nop 1
    v_pk_add_f32 v[32:33], v[56:57], v[58:59]
    v_pk_add_f32 v[34:35], v[60:61], v[62:63]
    s_mov_b64 exec, 0xffff
    ds_write_b128 v36, v[24:27] offset:0
    ds_write_b128 v36, v[28:31] offset:256
    ds_write_b128 v36, v[32:35] offset:512
    s_mov_b64 exec, -1
L_pad13:
    s_cbranch_execz L_pad14
    s_cmp_lt_u32 s30, 4
    s_cbranch_scc1 L_old
    s_waitcnt lgkmcnt(0)
L_b2_1:
    s_barrier
    s_cmp_lt_u32 s30, 2
    s_cbranch_scc0 L_skip_179
    s_mov_b32 exec_lo, 0xffffffff
    s_mov_b32 exec_hi, 0xffff
    ds_read_b64 v[40:41], v20 offset:0
    ds_read_b64 v[42:43], v20 offset:2048
    ds_read_b64 v[44:45], v20 offset:4096
    ds_read_b64 v[46:47], v20 offset:6144
    ds_read_b64 v[48:49], v20 offset:8192
    ds_read_b64 v[50:51], v20 offset:10240
    ds_read_b64 v[52:53], v20 offset:12288
    ds_read_b64 v[54:55], v20 offset:14336
    s_waitcnt lgkmcnt(7)
    v_mul_f32 v56, s64, v40
    v_mul_f32 v57, s64, v41
    s_waitcnt lgkmcnt(6)
    v_fmac_f32 v56, s65, v42
    v_fmac_f32 v57, s65, v43
    s_waitcnt lgkmcnt(5)
    v_fmac_f32 v56, s66, v44
    v_fmac_f32 v57, s66, v45
    s_waitcnt lgkmcnt(4)
    v_fmac_f32 v56, s67, v46
    v_fmac_f32 v57, s67, v47
    s_waitcnt lgkmcnt(3)
    v_fmac_f32 v56, s68, v48
    v_fmac_f32 v57, s68, v49
    s_waitcnt lgkmcnt(2)
    v_fmac_f32 v56, s69, v50
    v_fmac_f32 v57, s69, v51
    s_waitcnt lgkmcnt(1)
    v_fmac_f32 v56, s70, v52
    v_fmac_f32 v57, s70, v53
    s_waitcnt lgkmcnt(0)
    v_fmac_f32 v56, s71, v54
    v_fmac_f32 v57, s71, v55
    v_cvt_pk_bf16_f32 v56, v56, v57
    v_min_u32 v56, -2, v56
    s_cmp_eq_u32 s55, 0
    s_cbranch_scc1 L_gs_180
    buffer_store_dword v56, v21, s[40:43], 0 offen
L_gb_181:
    s_mov_b64 exec, -1
L_skip_179:
    s_cmp_lt_u32 s3, 20
    s_cbranch_scc0 L_typeB_1
    s_lshr_b32 s57, s30, 1
    s_lshl_b32 s57, s57, 5
    s_add_u32 s57, s57, s62
    s_add_u32 s59, s57, 55936
    v_and_b32 v5, 7, v0
    v_lshlrev_b32 v5, 2, v5
    v_lshrrev_b32 v22, 4, v0
    v_lshlrev_b32 v22, 3, v22
    buffer_load_dword v18, v5, s[40:43], s59 offen sc1
    buffer_load_dwordx2 v[20:21], v22, s[40:43], s59 offen sc1
    s_mul_i32 s57, s30, 6144
    v_lshrrev_b32 v7, 2, v0
    v_lshlrev_b32 v7, 6, v7
    v_bfe_u32 v60, v0, 4, 1
    v_lshl_add_u32 v7, v60, 5, v7
    v_and_b32 v60, 3, v0
    v_lshl_add_u32 v7, v60, 3, v7
    v_add_u32 v7, s57, v7
    v_add_u32 v7, 30720, v7
    v_xor_b32 v8, 32, v7
    s_mul_i32 s60, s30, 1536
    s_add_u32 s60, s60, s62
    s_add_u32 s60, s60, 12288
    v_lshlrev_b32 v9, 4, v0
    v_lshlrev_b32 v10, 3, v0
    ds_read_b64_tr_b16 v[36:37], v7 offset:0
    ds_read_b64_tr_b16 v[38:39], v7 offset:1024
    ds_read_b64_tr_b16 v[40:41], v7 offset:2048
    ds_read_b64_tr_b16 v[42:43], v7 offset:3072
    ds_read_b64_tr_b16 v[44:45], v7 offset:4096
    ds_read_b64_tr_b16 v[46:47], v7 offset:5120
    ds_read_b64_tr_b16 v[48:49], v8 offset:0
    ds_read_b64_tr_b16 v[50:51], v8 offset:1024
    ds_read_b64_tr_b16 v[52:53], v8 offset:2048
    ds_read_b64_tr_b16 v[54:55], v8 offset:3072
    ds_read_b64_tr_b16 v[56:57], v8 offset:4096
    ds_read_b64_tr_b16 v[58:59], v8 offset:5120
    v_mov_b64 v[24:25], 0
    v_mov_b64 v[26:27], 0
    v_mov_b64 v[28:29], 0
    v_mov_b64 v[30:31], 0
    s_lshl_b32 s57, s30, 8
    v_lshlrev_b32 v11, 2, v0
    v_add_u32 v11, s57, v11
    v_add_u32 v11, 157696, v11
L_pad14:
    s_cbranch_execz L_pad15
    s_waitcnt vmcnt(0)
L_pw_182:
    v_max3_u32 v19, v18, v20, v21
    v_cmp_eq_u32 vcc, -1, v19
    s_cbranch_vccnz L_pr_183
    buffer_load_dwordx4 v[12:15], v9, s[40:43], s60 offen sc1
    buffer_load_dwordx2 v[16:17], v10, s[40:43], s60 offen offset:1024 sc1
    v_max_f32_dpp v19, v18, v18 row_ror:4 row_mask:0xf bank_mask:0xf
    s_nop 1
    v_max_f32_dpp v19, v19, v19 row_ror:2 row_mask:0xf bank_mask:0xf
    s_nop 1
    v_max_f32_dpp v19, v19, v19 row_ror:1 row_mask:0xf bank_mask:0xf
    v_sub_f32 v18, v18, v19
    v_sub_f32 v20, v20, v19
    v_sub_f32 v21, v21, v19
    v_exp_f32 v18, v18
    v_exp_f32 v20, v20
    v_exp_f32 v21, v21
    v_add_f32_dpp v18, v18, v18 row_ror:4 row_mask:0xf bank_mask:0xf
    s_nop 1
    v_add_f32_dpp v18, v18, v18 row_ror:2 row_mask:0xf bank_mask:0xf
    s_nop 1
    v_add_f32_dpp v18, v18, v18 row_ror:1 row_mask:0xf bank_mask:0xf
    v_rcp_f32 v18, v18
    s_nop 0
    v_mul_f32 v20, v20, v18
    v_mul_f32 v21, v21, v18
    s_waitcnt lgkmcnt(0)
    s_waitcnt vmcnt(0)
L_pw_184:
    v_max3_u32 v19, v12, v13, v14
    v_max3_u32 v19, v19, v15, v16
    v_max_u32 v19, v19, v17
    v_cmp_eq_u32 vcc, -1, v19
    s_cbranch_vccnz L_pr_185
    v_smfmac_f32_16x16x64_bf16 v[24:27], v[12:15], v[36:43], v1
    v_smfmac_f32_16x16x64_bf16 v[28:31], v[12:15], v[48:55], v1
    v_smfmac_f32_16x16x32_bf16 v[24:27], v[16:17], v[44:47], v1
    v_smfmac_f32_16x16x32_bf16 v[28:31], v[16:17], v[56:59], v1
    s_nop 6
    v_pk_add_f32 v[24:25], v[24:25], v[26:27]
    v_pk_add_f32 v[28:29], v[28:29], v[30:31]
    v_mul_f32 v24, v24, v20
    v_mul_f32 v28, v28, v20
    v_fmac_f32 v24, v25, v21
    v_fmac_f32 v28, v29, v21
    s_nop 1
    v_permlane32_swap_b32 v24, v28
    v_add_f32 v24, v24, v28
    ds_write_b32 v11, v24
    v_lshlrev_b32 v5, 2, v0
    v_add_u32 v5, 157696, v5
    s_mul_i32 s59, s31, 2560
    s_lshl_b32 s58, s3, 7
    s_add_u32 s59, s59, s58
    s_add_u32 s59, s59, 1384384
    v_lshlrev_b32 v9, 2, v0
    s_waitcnt lgkmcnt(0)
    s_barrier
    s_cmp_eq_u32 s30, 2
    s_cbranch_scc0 L_skip_186
    ds_read2st64_b32 v[12:13], v5 offset0:0 offset1:1
    ds_read2st64_b32 v[14:15], v5 offset0:2 offset1:3
    ds_read2st64_b32 v[16:17], v5 offset0:4 offset1:5
    ds_read2st64_b32 v[18:19], v5 offset0:6 offset1:7
    s_waitcnt lgkmcnt(2)
    v_pk_add_f32 v[12:13], v[12:13], v[14:15]
    s_waitcnt lgkmcnt(0)
    v_pk_add_f32 v[16:17], v[16:17], v[18:19]
    v_pk_add_f32 v[12:13], v[12:13], v[16:17]
    v_add_f32 v12, v12, v13
    v_mov_b32 v13, v12
    s_nop 1
    v_permlane16_swap_b32 v12, v13
    v_add_f32 v12, v12, v13
    v_min_u32 v12, -2, v12
    s_mov_b32 exec_lo, 0xffff0000
    s_mov_b32 exec_hi, 0xffff
    buffer_store_dword v12, v9, s[40:43], s59 offen sc1
    s_lshl_b32 s57, s3, 2
    s_add_u32 s57, s57, s62
    s_add_u32 s57, s57, 56320
    s_mov_b64 exec, 0x1
    s_cmp_eq_u32 s55, 0
    s_cbranch_scc1 L_gs_187
    buffer_store_dword v0, v0, s[40:43], s57 offen
L_gb_188:
    s_mov_b64 exec, -1
L_skip_186:
    s_sub_u32 s57, s30, 5
    s_cmp_lt_u32 s57, 2
    s_cbranch_scc0 L_skip_189
    s_sub_u32 s60, s30, 5
    s_mul_i32 s59, s60, 6144
    s_add_u32 s59, s59, 79872
    s_mul_i32 s57, s31, 384
L_pad15:
    s_cbranch_execz L_pad16
    v_lshlrev_b32 v5, 1, v0
    v_add_u32 v5, s57, v5
    global_load_ushort v8, v5, s[18:19] offset:0
    global_load_ushort v9, v5, s[18:19] offset:128
    global_load_ushort v10, v5, s[18:19] offset:256
    v_lshlrev_b32 v11, 4, v0
    v_lshrrev_b32 v7, 4, v0
    v_lshlrev_b32 v7, 8, v7
    v_bfe_u32 v60, v0, 2, 2
    v_lshl_add_u32 v7, v60, 5, v7
    v_and_b32 v60, 3, v0
    v_lshl_add_u32 v7, v60, 3, v7
    v_add_u32 v7, s59, v7
    s_mul_i32 s57, s31, 2560
    s_lshl_b32 s58, s3, 7
    s_add_u32 s57, s57, s58
    s_lshl_b32 s60, s60, 6
    s_add_u32 s60, s60, s57
    s_add_u32 s60, s60, 1404928
    s_add_u32 s58, s62, 49152
    s_add_u32 s59, s58, 3072
    buffer_load_dwordx4 v[12:15], v11, s[40:43], s58 offen offset:0 sc1
    buffer_load_dwordx4 v[16:19], v11, s[40:43], s58 offen offset:1024 sc1
    buffer_load_dwordx4 v[20:23], v11, s[40:43], s58 offen offset:2048 sc1
    buffer_load_dwordx4 v[24:27], v11, s[40:43], s59 offen offset:0 sc1
    buffer_load_dwordx4 v[28:31], v11, s[40:43], s59 offen offset:1024 sc1
    buffer_load_dwordx4 v[32:35], v11, s[40:43], s59 offen offset:2048 sc1
    s_waitcnt vmcnt(0)
L_pw_190:
    v_max3_u32 v60, v12, v13, v14
    v_max3_u32 v60, v60, v15, v16
    v_max3_u32 v60, v60, v17, v18
    v_max3_u32 v60, v60, v19, v20
    v_max3_u32 v60, v60, v21, v22
    v_max3_u32 v60, v60, v23, v24
    v_max3_u32 v60, v60, v25, v26
    v_max3_u32 v60, v60, v27, v28
    v_max3_u32 v60, v60, v29, v30
    v_max3_u32 v60, v60, v31, v32
    v_max3_u32 v60, v60, v33, v34
    v_max_u32 v60, v60, v35
    v_cmp_eq_u32 vcc, -1, v60
    s_cbranch_vccnz L_pr_191
    ds_read_b64_tr_b16 v[36:37], v7 offset:0
    ds_read_b64_tr_b16 v[38:39], v7 offset:128
    ds_read_b64_tr_b16 v[40:41], v7 offset:1024
    ds_read_b64_tr_b16 v[42:43], v7 offset:1152
    ds_read_b64_tr_b16 v[44:45], v7 offset:2048
    ds_read_b64_tr_b16 v[46:47], v7 offset:2176
    ds_read_b64_tr_b16 v[48:49], v7 offset:3072
    ds_read_b64_tr_b16 v[50:51], v7 offset:3200
    ds_read_b64_tr_b16 v[52:53], v7 offset:4096
    ds_read_b64_tr_b16 v[54:55], v7 offset:4224
    ds_read_b64_tr_b16 v[56:57], v7 offset:5120
    ds_read_b64_tr_b16 v[58:59], v7 offset:5248
    v_pk_add_f32 v[12:13], v[12:13], v[14:15]
    v_pk_add_f32 v[16:17], v[16:17], v[18:19]
    v_pk_add_f32 v[12:13], v[12:13], v[16:17]
    v_add_f32 v4, v12, v13
    v_pk_add_f32 v[20:21], v[20:21], v[22:23]
    v_pk_add_f32 v[24:25], v[24:25], v[26:27]
    v_pk_add_f32 v[20:21], v[20:21], v[24:25]
    v_add_f32 v5, v20, v21
    v_pk_add_f32 v[28:29], v[28:29], v[30:31]
    v_pk_add_f32 v[32:33], v[32:33], v[34:35]
    v_pk_add_f32 v[28:29], v[28:29], v[32:33]
    v_add_f32 v7, v28, v29
    v_lshlrev_b32 v8, 16, v8
    v_lshlrev_b32 v9, 16, v9
    v_lshlrev_b32 v10, 16, v10
    v_mov_b64 v[60:61], 0
    v_mov_b64 v[62:63], 0
    s_add_u32 s58, s62, 43008
    s_add_u32 s57, s62, 55680
    s_add_u32 s59, s58, 3072
    s_mov_b32 s64, 0xbdd2d3e8
L_pad16:
    s_cbranch_execz L_pad17
    v_and_b32 v12, 7, v0
    v_lshlrev_b32 v12, 3, v12
    buffer_load_dwordx2 v[2:3], v12, s[40:43], s57 offen sc1
    s_waitcnt lgkmcnt(0)
    s_waitcnt vmcnt(0)
L_pw_192:
    v_max_u32 v13, v2, v3
    v_cmp_eq_u32 vcc, -1, v13
    s_cbranch_vccnz L_pr_193
    buffer_load_dwordx4 v[12:15], v11, s[40:43], s58 offen offset:0 sc1
    buffer_load_dwordx4 v[16:19], v11, s[40:43], s58 offen offset:1024 sc1
    buffer_load_dwordx4 v[20:23], v11, s[40:43], s58 offen offset:2048 sc1
    buffer_load_dwordx4 v[24:27], v11, s[40:43], s59 offen offset:0 sc1
    buffer_load_dwordx4 v[28:31], v11, s[40:43], s59 offen offset:1024 sc1
    buffer_load_dwordx4 v[32:35], v11, s[40:43], s59 offen offset:2048 sc1
    v_add_f32_dpp v2, v2, v2 row_ror:4 row_mask:0xf bank_mask:0xf
    v_add_f32_dpp v3, v3, v3 row_ror:4 row_mask:0xf bank_mask:0xf
    s_nop 0
    v_add_f32_dpp v2, v2, v2 row_ror:2 row_mask:0xf bank_mask:0xf
    v_add_f32_dpp v3, v3, v3 row_ror:2 row_mask:0xf bank_mask:0xf
    s_nop 0
    v_add_f32_dpp v2, v2, v2 row_ror:1 row_mask:0xf bank_mask:0xf
    v_add_f32_dpp v3, v3, v3 row_ror:1 row_mask:0xf bank_mask:0xf
    v_mul_f32 v2, 0x3acccccd, v2
    v_mul_f32 v3, 0x3acccccd, v3
    v_fma_f32 v3, -v2, v2, v3
    v_max_f32 v3, 0, v3
    v_add_f32 v3, 0x3727c5ac, v3
    v_rsq_f32 v3, v3
    s_nop 0
    v_mul_f32 v2, v2, v3
    v_fma_f32 v8, -v2, v4, v8
    v_fma_f32 v9, -v2, v5, v9
    v_fma_f32 v10, -v2, v7, v10
    v_lshlrev_b32 v7, 2, v0
    v_mov_b32 v2, 0xc0135761
    s_waitcnt vmcnt(4)
    v_pk_add_f32 v[12:13], v[12:13], v[14:15]
    v_pk_add_f32 v[16:17], v[16:17], v[18:19]
    v_pk_add_f32 v[12:13], v[12:13], v[16:17]
    v_add_f32 v12, v12, v13
    s_waitcnt vmcnt(2)
    v_pk_add_f32 v[20:21], v[20:21], v[22:23]
    v_pk_add_f32 v[24:25], v[24:25], v[26:27]
    v_pk_add_f32 v[20:21], v[20:21], v[24:25]
    v_add_f32 v13, v20, v21
    s_waitcnt vmcnt(0)
    v_pk_add_f32 v[28:29], v[28:29], v[30:31]
    v_pk_add_f32 v[32:33], v[32:33], v[34:35]
    v_pk_add_f32 v[28:29], v[28:29], v[32:33]
    v_add_f32 v14, v28, v29
    v_add_f32 v15, v12, v13
    v_cmp_u_f32 vcc, v15, v14
    s_cbranch_vccnz L_hr_194
L_hk_195:
    v_fma_f32 v12, v12, v3, v8
    v_fma_f32 v13, v13, v3, v9
    v_fma_f32 v14, v14, v3, v10
    v_mul_f32 v16, v12, v12
    v_mul_f32 v17, v13, v13
    v_mul_f32 v18, v14, v14
    v_fma_f32 v16, v16, s64, v2
    v_fma_f32 v17, v17, s64, v2
    v_fma_f32 v18, v18, s64, v2
    v_mul_f32 v16, v16, v12
    v_mul_f32 v17, v17, v13
    v_mul_f32 v18, v18, v14
    v_exp_f32 v16, v16
    v_exp_f32 v17, v17
    v_exp_f32 v18, v18
    v_add_f32 v16, 1.0, v16
    v_add_f32 v17, 1.0, v17
    v_add_f32 v18, 1.0, v18
    v_rcp_f32 v16, v16
    v_rcp_f32 v17, v17
    v_rcp_f32 v18, v18
    v_mul_f32 v12, v12, v16
    v_mul_f32 v13, v13, v17
    v_mul_f32 v14, v14, v18
    v_mov_b32_dpp v16, v12 row_shl:1 row_mask:0xf bank_mask:0xf bound_ctrl:0
    v_mov_b32_dpp v17, v13 row_shl:1 row_mask:0xf bank_mask:0xf bound_ctrl:0
    v_mov_b32_dpp v18, v14 row_shl:1 row_mask:0xf bank_mask:0xf bound_ctrl:0
    v_cvt_pk_bf16_f32 v20, v12, v16
    v_cvt_pk_bf16_f32 v24, v13, v17
    v_cvt_pk_bf16_f32 v28, v14, v18
    v_mov_b32_dpp v21, v20 row_shl:4 row_mask:0xf bank_mask:0xf bound_ctrl:0
L_pad17:
    s_cbranch_execz L_pad18
    v_mov_b32_dpp v22, v20 row_shl:8 row_mask:0xf bank_mask:0xf bound_ctrl:0
    v_mov_b32_dpp v23, v20 row_shl:12 row_mask:0xf bank_mask:0xf bound_ctrl:0
    v_mov_b32_dpp v25, v24 row_shl:4 row_mask:0xf bank_mask:0xf bound_ctrl:0
    v_mov_b32_dpp v26, v24 row_shl:8 row_mask:0xf bank_mask:0xf bound_ctrl:0
    v_mov_b32_dpp v27, v24 row_shl:12 row_mask:0xf bank_mask:0xf bound_ctrl:0
    v_smfmac_f32_16x16x64_bf16 v[60:63], v[20:23], v[36:43], v1
    v_mov_b32_dpp v29, v28 row_shl:4 row_mask:0xf bank_mask:0xf bound_ctrl:0
    v_mov_b32_dpp v30, v28 row_shl:8 row_mask:0xf bank_mask:0xf bound_ctrl:0
    v_mov_b32_dpp v31, v28 row_shl:12 row_mask:0xf bank_mask:0xf bound_ctrl:0
    v_smfmac_f32_16x16x64_bf16 v[60:63], v[24:27], v[44:51], v1
    s_nop 0
    v_smfmac_f32_16x16x64_bf16 v[60:63], v[28:31], v[52:59], v1
    s_nop 7
    v_add_f32 v60, v60, v62
    v_min_u32 v60, -2, v60
    s_mov_b64 exec, 0xffff
    buffer_store_dword v60, v7, s[40:43], s60 offen sc1
    s_cmp_eq_u32 s30, 6
    s_cbranch_scc0 L_skip_198
    s_lshl_b32 s57, s3, 2
    s_add_u32 s57, s57, s62
    s_add_u32 s57, s57, 56448
    s_mov_b64 exec, 0x1
    s_cmp_eq_u32 s55, 0
    s_cbranch_scc1 L_gs_199
    buffer_store_dword v0, v0, s[40:43], s57 offen
L_gb_200:
    s_mov_b64 exec, -1
L_skip_198:
    s_mov_b64 exec, -1
L_skip_189:
    s_branch L_done
L_typeB_1:
    s_cmp_eq_u32 s53, 3
    s_cbranch_scc0 L_done
    s_cmp_lt_u32 s30, 6
    s_cbranch_scc0 L_skip_201
    s_lshr_b32 s57, s30, 1
    s_mul_i32 s57, s57, 128
    s_and_b32 s58, s30, 1
    s_lshl_b32 s58, s58, 6
    s_add_u32 s57, s57, s58
    v_lshrrev_b32 v18, 5, v0
    v_lshlrev_b32 v18, 13, v18
    v_bfe_u32 v60, v0, 3, 1
    v_lshl_add_u32 v18, v60, 12, v18
    v_bfe_u32 v60, v0, 4, 1
    v_lshl_add_u32 v18, v60, 11, v18
    v_bfe_u32 v60, v0, 2, 1
    v_mul_u32_u24 v60, 384, v60
    v_add_u32 v18, v60, v18
    v_and_b32 v60, 3, v0
    v_lshl_add_u32 v18, v60, 3, v18
    v_add_u32 v18, s57, v18
    v_add_u32 v18, 30720, v18
    v_bfe_u32 v19, v0, 4, 1
    v_lshlrev_b32 v19, 12, v19
    v_bfe_u32 v60, v0, 3, 1
    v_lshl_add_u32 v19, v60, 11, v19
    v_bfe_u32 v60, v0, 2, 1
    v_mul_u32_u24 v60, 384, v60
    v_add_u32 v19, v60, v19
    v_and_b32 v60, 3, v0
    v_lshl_add_u32 v19, v60, 3, v19
    v_add_u32 v19, s57, v19
    v_add_u32 v19, 63488, v19
    ds_read_b64_tr_b16 v[36:37], v18 offset:0
    ds_read_b64_tr_b16 v[38:39], v18 offset:1024
    ds_read_b64_tr_b16 v[40:41], v18 offset:16384
    ds_read_b64_tr_b16 v[42:43], v18 offset:17408
    ds_read_b64_tr_b16 v[44:45], v19 offset:0
    ds_read_b64_tr_b16 v[46:47], v19 offset:1024
    ds_read_b64_tr_b16 v[48:49], v18 offset:32
    ds_read_b64_tr_b16 v[50:51], v18 offset:1056
    ds_read_b64_tr_b16 v[52:53], v18 offset:16416
    ds_read_b64_tr_b16 v[54:55], v18 offset:17440
    ds_read_b64_tr_b16 v[56:57], v19 offset:32
    ds_read_b64_tr_b16 v[58:59], v19 offset:1056
    v_lshrrev_b32 v32, 4, v0
    v_lshlrev_b32 v32, 5, v32
    v_bfe_u32 v60, v0, 1, 1
    v_lshl_add_u32 v32, v60, 4, v32
    v_and_b32 v60, 1, v0
    v_mul_u32_u24 v60, 192, v60
L_pad18:
    s_cbranch_execz L_pad19
    v_add_u32 v32, v60, v32
    v_add_u32 v32, 159872, v32
    v_lshrrev_b32 v33, 4, v0
    v_lshlrev_b32 v33, 4, v33
    v_bfe_u32 v60, v0, 1, 1
    v_lshl_add_u32 v33, v60, 3, v33
    v_and_b32 v60, 1, v0
    v_mul_u32_u24 v60, 192, v60
    v_add_u32 v33, v60, v33
    v_add_u32 v33, 160000, v33
    v_mov_b64 v[24:25], 0
    v_mov_b64 v[26:27], 0
    v_mov_b64 v[28:29], 0
    v_mov_b64 v[30:31], 0
    s_lshr_b32 s57, s30, 1
    s_lshl_b32 s57, s57, 11
    s_and_b32 s58, s30, 1
    s_lshl_b32 s58, s58, 9
    s_add_u32 s57, s57, s58
    s_lshr_b32 s58, s54, 2
    s_lshl_b32 s58, s58, 10
    s_add_u32 s57, s57, s58
    s_and_b32 s58, s54, 3
    s_lshl_b32 s58, s58, 2
    s_add_u32 s57, s57, s58
    v_and_b32 v34, 31, v0
    v_lshlrev_b32 v34, 4, v34
    v_add_u32 v34, s57, v34
    s_add_u32 s59, s62, 43008
    s_add_u32 s60, s62, 55680
L_skip_201:
    s_cmp_eq_u32 s30, 7
    s_cbranch_scc0 L_skip_202
    v_and_b32 v60, 31, v0
    v_min_u32 v60, 19, v60
    s_mul_i32 s57, s54, 320
    v_lshrrev_b32 v5, 5, v0
    v_mul_u32_u24 v5, 2560, v5
    v_add_u32 v5, s57, v5
    v_lshl_add_u32 v5, v60, 4, v5
    v_and_b32 v60, 31, v0
    v_cmp_gt_u32 s[64:65], 20, v60
    v_min_u32 v60, 19, v60
    v_lshrrev_b32 v35, 5, v0
    v_lshlrev_b32 v35, 2, v35
    v_add_u32 v35, 159872, v35
    v_lshl_add_u32 v35, v60, 3, v35
    s_add_u32 s66, s62, 43008
    s_add_u32 s67, s62, 55680
    s_lshl_b32 s57, s54, 3
    v_lshrrev_b32 v34, 5, v0
    v_lshlrev_b32 v34, 2, v34
    v_add_u32 v34, s57, v34
    v_mov_b32 v61, 0x3f803f80
    s_add_u32 s57, s62, 56320
    v_min_u32 v9, 19, v0
    v_lshlrev_b32 v9, 2, v9
    buffer_load_dword v12, v9, s[40:43], s57 offen sc1
    s_waitcnt vmcnt(0)
L_pw_203:
    v_cmp_eq_u32 vcc, -1, v12
    s_cbranch_vccnz L_pr_204
    s_mov_b32 s57, 1384448
    buffer_load_dwordx4 v[12:15], v5, s[40:43], s57 offen sc1
    s_mov_b32 s58, 1389568
    buffer_load_dwordx4 v[16:19], v5, s[40:43], s58 offen sc1
    s_mov_b32 s59, 1394688
    buffer_load_dwordx4 v[20:23], v5, s[40:43], s59 offen sc1
    s_mov_b32 s60, 1399808
    buffer_load_dwordx4 v[24:27], v5, s[40:43], s60 offen sc1
L_gw_205:
    s_waitcnt vmcnt(2)
    v_pk_add_f32 v[28:29], v[12:13], v[16:17]
    v_pk_add_f32 v[30:31], v[14:15], v[18:19]
    s_waitcnt vmcnt(1)
    v_pk_add_f32 v[28:29], v[28:29], v[20:21]
    v_pk_add_f32 v[30:31], v[30:31], v[22:23]
    s_waitcnt vmcnt(0)
    v_pk_add_f32 v[28:29], v[28:29], v[24:25]
    v_pk_add_f32 v[30:31], v[30:31], v[26:27]
    s_nop 1
    v_permlane32_swap_b32 v28, v30
    v_permlane32_swap_b32 v29, v31
    v_pk_add_f32 v[28:29], v[28:29], v[30:31]
    v_pk_add_f32 v[28:29], v[28:29], v[2:3]
    v_cmp_u_f32 vcc, v28, v29
    s_cbranch_vccnz L_gr_206
L_gk_207:
    v_cvt_pk_bf16_f32 v28, v28, v29
    ds_write_b32 v35, v28
    s_waitcnt lgkmcnt(0)
L_skip_202:
    s_barrier
    s_cmp_lt_u32 s30, 6
    s_cbranch_scc0 L_skip_212
    ds_read_b128 v[12:15], v32
L_pad19:
    s_cbranch_execz L_pad20
    ds_read_b64 v[16:17], v33
    s_waitcnt lgkmcnt(1)
    v_smfmac_f32_16x16x64_bf16 v[24:27], v[12:15], v[36:43], v1
    v_smfmac_f32_16x16x64_bf16 v[28:31], v[12:15], v[48:55], v1
    s_waitcnt lgkmcnt(0)
    v_smfmac_f32_16x16x32_bf16 v[24:27], v[16:17], v[44:47], v1
    v_smfmac_f32_16x16x32_bf16 v[28:31], v[16:17], v[56:59], v1
    s_nop 6
    v_add_f32 v12, v24, v26
    s_nop 1
    v_add_f32_dpp v12, v28, v30 quad_perm:[0,1,2,3] row_mask:0x2 bank_mask:0xf
    v_min_u32 v12, -2, v12
    s_mov_b32 exec_lo, 0xffffffff
    s_mov_b32 exec_hi, 0x0
    s_cmp_eq_u32 s55, 0
    s_cbranch_scc1 L_gs_213
    buffer_store_dword v12, v34, s[40:43], s59 offen
L_gb_214:
    s_mov_b64 exec, -1
L_skip_212:
    s_cmp_eq_u32 s30, 7
    s_cbranch_scc0 L_skip_215
    v_lshlrev_b32 v2, 16, v28
    v_and_b32 v3, 0xffff0000, v28
    v_cndmask_b32 v28, 0, v28, s[64:65]
    v_dot2_f32_bf16 v27, v28, v61, 0
    v_dot2_f32_bf16 v62, v28, v28, 0
    s_nop 2
    v_permlane32_swap_b32 v27, v62
    v_add_f32 v27, v27, v62
    v_mov_b32 v62, v27
    s_nop 1
    v_permlane16_swap_b32 v27, v62
    v_add_f32 v27, v27, v62
    s_nop 1
    v_add_f32_dpp v27, v27, v27 row_ror:8 row_mask:0xf bank_mask:0xf
    s_nop 1
    v_add_f32_dpp v27, v27, v27 row_ror:4 row_mask:0xf bank_mask:0xf
    s_nop 1
    v_add_f32_dpp v27, v27, v27 row_ror:2 row_mask:0xf bank_mask:0xf
    s_nop 1
    v_add_f32_dpp v27, v27, v27 row_ror:1 row_mask:0xf bank_mask:0xf
    v_min_u32 v27, -2, v27
    s_mov_b32 exec_lo, 0x1
    s_mov_b32 exec_hi, 0x1
    s_cmp_eq_u32 s55, 0
    s_cbranch_scc1 L_gs_216
    buffer_store_dword v27, v34, s[40:43], s67 offen
L_gb_217:
    s_mov_b64 exec, -1
L_skip_215:
    s_cmp_eq_u32 s30, 7
    s_cbranch_scc0 L_done
    s_cmp_eq_u32 s31, 0
    s_cbranch_scc0 L_done
    v_lshlrev_b32 v60, 16, v4
    v_add_f32 v2, v2, v60
    v_and_b32 v60, 0xffff0000, v4
    v_add_f32 v3, v3, v60
    v_and_b32 v60, 31, v0
    v_min_u32 v60, 19, v60
    s_mul_i32 s57, s54, 160
    v_lshrrev_b32 v7, 5, v0
    v_lshlrev_b32 v7, 2, v7
    v_add_u32 v7, s57, v7
    v_lshl_add_u32 v7, v60, 3, v7
    s_add_u32 s57, s62, 56448
    v_min_u32 v9, 19, v0
    v_lshlrev_b32 v9, 2, v9
    buffer_load_dword v12, v9, s[40:43], s57 offen sc1
    s_waitcnt vmcnt(0)
L_pw_218:
    v_cmp_eq_u32 vcc, -1, v12
    s_cbranch_vccnz L_pr_219
    s_mov_b32 s57, 1404928
    buffer_load_dwordx4 v[12:15], v5, s[40:43], s57 offen sc1
    s_mov_b32 s58, 1410048
    buffer_load_dwordx4 v[16:19], v5, s[40:43], s58 offen sc1
    s_mov_b32 s59, 1415168
    buffer_load_dwordx4 v[20:23], v5, s[40:43], s59 offen sc1
    s_mov_b32 s60, 1420288
    buffer_load_dwordx4 v[24:27], v5, s[40:43], s60 offen sc1
L_gw_220:
    s_waitcnt vmcnt(2)
    v_pk_add_f32 v[28:29], v[12:13], v[16:17]
    v_pk_add_f32 v[30:31], v[14:15], v[18:19]
    s_waitcnt vmcnt(1)
    v_pk_add_f32 v[28:29], v[28:29], v[20:21]
    v_pk_add_f32 v[30:31], v[30:31], v[22:23]
    s_waitcnt vmcnt(0)
    v_pk_add_f32 v[28:29], v[28:29], v[24:25]
    v_pk_add_f32 v[30:31], v[30:31], v[26:27]
    s_nop 1
    v_permlane32_swap_b32 v28, v30
    v_permlane32_swap_b32 v29, v31
    v_pk_add_f32 v[28:29], v[28:29], v[30:31]
L_pad20:
    s_cbranch_execz L_pad21
    v_pk_add_f32 v[28:29], v[28:29], v[2:3]
    v_cmp_u_f32 vcc, v28, v29
    s_cbranch_vccnz L_gr_221
L_gk_222:
    v_cvt_pk_bf16_f32 v28, v28, v29
    global_store_dword v7, v28, s[24:25]
    s_branch L_done
L_gs_26:
    buffer_store_dword v27, v34, s[40:43], s67 offen sc1
    s_branch L_gb_27
L_gs_29:
    buffer_store_dword v12, v34, s[40:43], s59 offen sc1
    s_branch L_gb_30
L_cr_41:
    s_sub_u32 s56, s56, 1
    s_cbranch_scc1 L_done
    global_load_dword v2, v3, s[26:27] sc1
    s_waitcnt vmcnt(0)
    s_branch L_cw_40
L_far_42:
    s_lshl_b32 s57, s52, 2
    s_add_u32 s57, s57, s72
    s_mov_b64 exec, 1
    buffer_store_dword v0, v0, s[40:43], s57 offen offset:128 sc1
    s_mov_b64 exec, -1
    s_branch L_fb_43
L_cr_55:
    s_sub_u32 s56, s56, 1
    s_cbranch_scc1 L_done
    buffer_load_dword v2, v24, s[40:43], s72 offen sc1
    s_branch L_cw_54
L_gs_62:
    buffer_store_dword v27, v34, s[40:43], s67 offen sc1
    s_branch L_gb_63
L_gs_65:
    buffer_store_dword v12, v34, s[40:43], s59 offen sc1
    s_branch L_gb_66
L_pr_69:
    s_sub_u32 s56, s56, 1
    s_cbranch_scc1 L_done
    buffer_load_dword v17, v16, s[40:43], s72 offen offset:256 sc1
    s_waitcnt vmcnt(0)
    s_branch L_pw_68
L_gs_86:
    buffer_store_dword v22, v23, s[40:43], s57 offen sc1
    s_branch L_gb_87
L_cr_97:
    s_sub_u32 s56, s56, 1
    s_cbranch_scc1 L_done
    global_load_dword v2, v3, s[26:27] offset:4 sc1
    s_branch L_cw_96
L_gs_105:
    buffer_store_dword v56, v21, s[40:43], 0 offen sc1
    s_branch L_gb_106
L_pr_109:
    s_sub_u32 s56, s56, 1
    s_cbranch_scc1 L_done
    buffer_load_dword v18, v5, s[40:43], s59 offen sc1
    buffer_load_dwordx2 v[20:21], v22, s[40:43], s59 offen sc1
    s_waitcnt vmcnt(0)
    s_branch L_pw_108
L_pr_111:
    s_sub_u32 s56, s56, 1
    s_cbranch_scc1 L_done
    buffer_load_dwordx4 v[12:15], v9, s[40:43], s60 offen sc1
    buffer_load_dwordx2 v[16:17], v10, s[40:43], s60 offen offset:1024 sc1
    s_waitcnt vmcnt(0)
    s_branch L_pw_110
L_gs_113:
    buffer_store_dword v0, v0, s[40:43], s57 offen sc1
    s_branch L_gb_114
L_pr_117:
    s_sub_u32 s56, s56, 1
    s_cbranch_scc1 L_done
    buffer_load_dwordx4 v[12:15], v11, s[40:43], s58 offen offset:0 sc1
    buffer_load_dwordx4 v[16:19], v11, s[40:43], s58 offen offset:1024 sc1
    buffer_load_dwordx4 v[20:23], v11, s[40:43], s58 offen offset:2048 sc1
    buffer_load_dwordx4 v[24:27], v11, s[40:43], s59 offen offset:0 sc1
    buffer_load_dwordx4 v[28:31], v11, s[40:43], s59 offen offset:1024 sc1
    buffer_load_dwordx4 v[32:35], v11, s[40:43], s59 offen offset:2048 sc1
    s_waitcnt vmcnt(0)
    s_branch L_pw_116
L_pr_119:
    s_sub_u32 s56, s56, 1
    s_cbranch_scc1 L_done
    buffer_load_dwordx2 v[2:3], v12, s[40:43], s57 offen sc1
    s_waitcnt vmcnt(0)
    s_branch L_pw_118
L_pr_123:
    s_sub_u32 s56, s56, 1
    s_cbranch_scc1 L_done
    buffer_load_dwordx4 v[12:15], v11, s[40:43], s58 offen offset:0 sc1
    buffer_load_dwordx4 v[16:19], v11, s[40:43], s58 offen offset:1024 sc1
    buffer_load_dwordx4 v[20:23], v11, s[40:43], s58 offen offset:2048 sc1
    buffer_load_dwordx4 v[24:27], v11, s[40:43], s59 offen offset:0 sc1
    buffer_load_dwordx4 v[28:31], v11, s[40:43], s59 offen offset:1024 sc1
    buffer_load_dwordx4 v[32:35], v11, s[40:43], s59 offen offset:2048 sc1
    s_waitcnt vmcnt(0)
    s_branch L_pw_122
L_hr_120:
    buffer_load_dwordx4 v[12:15], v11, s[40:43], s58 offen offset:0 sc1
    buffer_load_dwordx4 v[16:19], v11, s[40:43], s58 offen offset:1024 sc1
    buffer_load_dwordx4 v[20:23], v11, s[40:43], s58 offen offset:2048 sc1
    buffer_load_dwordx4 v[24:27], v11, s[40:43], s59 offen offset:0 sc1
    buffer_load_dwordx4 v[28:31], v11, s[40:43], s59 offen offset:1024 sc1
    buffer_load_dwordx4 v[32:35], v11, s[40:43], s59 offen offset:2048 sc1
    s_waitcnt vmcnt(0)
L_pw_122:
    v_max3_u32 v4, v12, v13, v14
L_pad21:
    s_cbranch_execz L_pad22
    v_max3_u32 v4, v4, v15, v16
    v_max3_u32 v4, v4, v17, v18
    v_max3_u32 v4, v4, v19, v20
    v_max3_u32 v4, v4, v21, v22
    v_max3_u32 v4, v4, v23, v24
    v_max3_u32 v4, v4, v25, v26
    v_max3_u32 v4, v4, v27, v28
    v_max3_u32 v4, v4, v29, v30
    v_max3_u32 v4, v4, v31, v32
    v_max3_u32 v4, v4, v33, v34
    v_max_u32 v4, v4, v35
    v_cmp_eq_u32 vcc, -1, v4
    s_cbranch_vccnz L_pr_123
    v_pk_add_f32 v[12:13], v[12:13], v[14:15]
    v_pk_add_f32 v[16:17], v[16:17], v[18:19]
    v_pk_add_f32 v[12:13], v[12:13], v[16:17]
    v_add_f32 v12, v12, v13
    v_pk_add_f32 v[20:21], v[20:21], v[22:23]
    v_pk_add_f32 v[24:25], v[24:25], v[26:27]
    v_pk_add_f32 v[20:21], v[20:21], v[24:25]
    v_add_f32 v13, v20, v21
    v_pk_add_f32 v[28:29], v[28:29], v[30:31]
    v_pk_add_f32 v[32:33], v[32:33], v[34:35]
    v_pk_add_f32 v[28:29], v[28:29], v[32:33]
    v_add_f32 v14, v28, v29
    s_branch L_hk_121
L_gs_125:
    buffer_store_dword v0, v0, s[40:43], s57 offen sc1
    s_branch L_gb_126
L_gs_128:
    buffer_store_dword v12, v34, s[40:43], s60 offen sc1
    s_branch L_gb_129
L_pr_132:
    s_sub_u32 s56, s56, 1
    s_cbranch_scc1 L_done
    buffer_load_dword v12, v9, s[40:43], s57 offen sc1
    s_waitcnt vmcnt(0)
    s_branch L_pw_131
L_gr_134:
    s_sub_u32 s56, s56, 1
    s_cbranch_scc1 L_done
    s_mov_b64 s[74:75], 0
    v_max3_u32 v30, v12, v13, v14
    v_max_u32 v30, v30, v15
    v_cmp_eq_u32 vcc, -1, v30
    s_cbranch_vccz L_gn_136
    s_or_b64 s[74:75], s[74:75], vcc
    s_mov_b64 exec, vcc
    buffer_load_dwordx4 v[12:15], v5, s[40:43], s57 offen sc1
    s_mov_b64 exec, -1
L_gn_136:
    v_max3_u32 v30, v16, v17, v18
    v_max_u32 v30, v30, v19
    v_cmp_eq_u32 vcc, -1, v30
    s_cbranch_vccz L_gn_137
    s_or_b64 s[74:75], s[74:75], vcc
    s_mov_b64 exec, vcc
    buffer_load_dwordx4 v[16:19], v5, s[40:43], s58 offen sc1
    s_mov_b64 exec, -1
L_gn_137:
    v_max3_u32 v30, v20, v21, v22
    v_max_u32 v30, v30, v23
    v_cmp_eq_u32 vcc, -1, v30
    s_cbranch_vccz L_gn_138
    s_or_b64 s[74:75], s[74:75], vcc
    s_mov_b64 exec, vcc
    buffer_load_dwordx4 v[20:23], v5, s[40:43], s59 offen sc1
    s_mov_b64 exec, -1
L_gn_138:
    v_max3_u32 v30, v24, v25, v26
    v_max_u32 v30, v30, v27
    v_cmp_eq_u32 vcc, -1, v30
    s_cbranch_vccz L_gn_139
    s_or_b64 s[74:75], s[74:75], vcc
    s_mov_b64 exec, vcc
    buffer_load_dwordx4 v[24:27], v5, s[40:43], s60 offen sc1
    s_mov_b64 exec, -1
L_gn_139:
    s_cmp_eq_u64 s[74:75], 0
    s_cbranch_scc1 L_gk_135
    s_waitcnt vmcnt(0)
    s_branch L_gw_133
L_gs_141:
    buffer_store_dword v12, v34, s[40:43], s59 offen sc1
    s_branch L_gb_142
L_gs_144:
    buffer_store_dword v27, v34, s[40:43], s67 offen sc1
    s_branch L_gb_145
L_pr_150:
    s_sub_u32 s56, s56, 1
    s_cbranch_scc1 L_done
    buffer_load_dword v12, v9, s[40:43], s57 offen sc1
    s_waitcnt vmcnt(0)
    s_branch L_pw_149
L_gr_152:
    s_sub_u32 s56, s56, 1
    s_cbranch_scc1 L_done
    s_mov_b64 s[74:75], 0
    v_max3_u32 v30, v12, v13, v14
    v_max_u32 v30, v30, v15
    v_cmp_eq_u32 vcc, -1, v30
    s_cbranch_vccz L_gn_154
    s_or_b64 s[74:75], s[74:75], vcc
    s_mov_b64 exec, vcc
L_pad22:
    s_cbranch_execz L_pad23
    buffer_load_dwordx4 v[12:15], v5, s[40:43], s57 offen sc1
    s_mov_b64 exec, -1
L_gn_154:
    v_max3_u32 v30, v16, v17, v18
    v_max_u32 v30, v30, v19
    v_cmp_eq_u32 vcc, -1, v30
    s_cbranch_vccz L_gn_155
    s_or_b64 s[74:75], s[74:75], vcc
    s_mov_b64 exec, vcc
    buffer_load_dwordx4 v[16:19], v5, s[40:43], s58 offen sc1
    s_mov_b64 exec, -1
L_gn_155:
    v_max3_u32 v30, v20, v21, v22
    v_max_u32 v30, v30, v23
    v_cmp_eq_u32 vcc, -1, v30
    s_cbranch_vccz L_gn_156
    s_or_b64 s[74:75], s[74:75], vcc
    s_mov_b64 exec, vcc
    buffer_load_dwordx4 v[20:23], v5, s[40:43], s59 offen sc1
    s_mov_b64 exec, -1
L_gn_156:
    v_max3_u32 v30, v24, v25, v26
    v_max_u32 v30, v30, v27
    v_cmp_eq_u32 vcc, -1, v30
    s_cbranch_vccz L_gn_157
    s_or_b64 s[74:75], s[74:75], vcc
    s_mov_b64 exec, vcc
    buffer_load_dwordx4 v[24:27], v5, s[40:43], s60 offen sc1
    s_mov_b64 exec, -1
L_gn_157:
    s_cmp_eq_u64 s[74:75], 0
    s_cbranch_scc1 L_gk_153
    s_waitcnt vmcnt(0)
    s_branch L_gw_151
L_pr_159:
    s_sub_u32 s56, s56, 1
    s_cbranch_scc1 L_done
    buffer_load_dword v12, v9, s[40:43], s57 offen sc1
    s_waitcnt vmcnt(0)
    s_branch L_pw_158
L_gr_161:
    s_sub_u32 s56, s56, 1
    s_cbranch_scc1 L_done
    s_mov_b64 s[74:75], 0
    v_max3_u32 v30, v12, v13, v14
    v_max_u32 v30, v30, v15
    v_cmp_eq_u32 vcc, -1, v30
    s_cbranch_vccz L_gn_163
    s_or_b64 s[74:75], s[74:75], vcc
    s_mov_b64 exec, vcc
    buffer_load_dwordx4 v[12:15], v5, s[40:43], s57 offen sc1
    s_mov_b64 exec, -1
L_gn_163:
    v_max3_u32 v30, v16, v17, v18
    v_max_u32 v30, v30, v19
    v_cmp_eq_u32 vcc, -1, v30
    s_cbranch_vccz L_gn_164
    s_or_b64 s[74:75], s[74:75], vcc
    s_mov_b64 exec, vcc
    buffer_load_dwordx4 v[16:19], v5, s[40:43], s58 offen sc1
    s_mov_b64 exec, -1
L_gn_164:
    v_max3_u32 v30, v20, v21, v22
    v_max_u32 v30, v30, v23
    v_cmp_eq_u32 vcc, -1, v30
    s_cbranch_vccz L_gn_165
    s_or_b64 s[74:75], s[74:75], vcc
    s_mov_b64 exec, vcc
    buffer_load_dwordx4 v[20:23], v5, s[40:43], s59 offen sc1
    s_mov_b64 exec, -1
L_gn_165:
    v_max3_u32 v30, v24, v25, v26
    v_max_u32 v30, v30, v27
    v_cmp_eq_u32 vcc, -1, v30
    s_cbranch_vccz L_gn_166
    s_or_b64 s[74:75], s[74:75], vcc
    s_mov_b64 exec, vcc
    buffer_load_dwordx4 v[24:27], v5, s[40:43], s60 offen sc1
    s_mov_b64 exec, -1
L_gn_166:
    s_cmp_eq_u64 s[74:75], 0
    s_cbranch_scc1 L_gk_162
    s_waitcnt vmcnt(0)
    s_branch L_gw_160
L_gs_168:
    buffer_store_dword v12, v34, s[40:43], s59 offen sc1
    s_branch L_gb_169
L_gs_171:
    buffer_store_dword v27, v34, s[40:43], s67 offen sc1
    s_branch L_gb_172
L_pr_174:
    s_sub_u32 s56, s56, 1
    s_cbranch_scc1 L_done
    buffer_load_dwordx2 v[8:9], v7, s[40:43], 0 offen sc1
    buffer_load_dwordx4 v[12:15], v5, s[40:43], 0 offen offset:0 sc1
    buffer_load_dwordx4 v[16:19], v5, s[40:43], 0 offen offset:1024 sc1
    buffer_load_dwordx4 v[20:23], v5, s[40:43], 0 offen offset:2048 sc1
    s_waitcnt vmcnt(0)
    s_branch L_pw_173
L_gs_177:
    buffer_store_dword v22, v23, s[40:43], s57 offen sc1
    s_branch L_gb_178
L_old:
    s_waitcnt lgkmcnt(0)
    s_barrier
    s_cmp_lt_u32 s30, 2
    s_cbranch_scc0 L_b2_1
    v_and_b32 v37, 7, v0
    v_lshlrev_b32 v37, 3, v37
    v_add_u32 v37, 159744, v37
    ds_read_b64 v[38:39], v37
    s_lshl_b32 s57, s53, 3
    s_add_u32 s57, s57, s54
    s_lshl_b32 s57, s57, 2
    v_mov_b32 v23, s57
    s_add_u32 s57, s62, 55936
L_pad23:
    s_cbranch_execz L_pad24
    s_waitcnt lgkmcnt(0)
    v_max_f32_dpp v37, v38, v38 row_ror:4 row_mask:0xf bank_mask:0xf
    s_nop 1
    v_max_f32_dpp v37, v37, v37 row_ror:2 row_mask:0xf bank_mask:0xf
    s_nop 1
    v_max_f32_dpp v37, v37, v37 row_ror:1 row_mask:0xf bank_mask:0xf
    v_sub_f32 v38, v38, v37
    v_exp_f32 v38, v38
    s_nop 0
    v_mul_f32 v39, v38, v39
    s_nop 1
    v_add_f32_dpp v39, v39, v39 row_ror:4 row_mask:0xf bank_mask:0xf
    s_nop 1
    v_add_f32_dpp v39, v39, v39 row_ror:2 row_mask:0xf bank_mask:0xf
    s_nop 1
    v_add_f32_dpp v39, v39, v39 row_ror:1 row_mask:0xf bank_mask:0xf
    v_log_f32 v22, v39
    v_rcp_f32 v39, v39
    v_add_f32 v22, v22, v37
    v_min_u32 v22, -2, v22
    v_mul_f32 v38, v38, v39
    s_cmp_eq_u32 s30, 0
    s_cbranch_scc0 L_skip_176
    s_mov_b64 exec, 0x1
    s_cmp_eq_u32 s55, 0
    s_cbranch_scc1 L_gs_177
    buffer_store_dword v22, v23, s[40:43], s57 offen
L_gb_178:
    s_mov_b64 exec, -1
L_skip_176:
    v_readlane_b32 s64, v38, 0
    v_readlane_b32 s65, v38, 1
    v_readlane_b32 s66, v38, 2
    v_readlane_b32 s67, v38, 3
    v_readlane_b32 s68, v38, 4
    v_readlane_b32 s69, v38, 5
    v_readlane_b32 s70, v38, 6
    v_readlane_b32 s71, v38, 7
    s_mul_i32 s57, s30, 48
    v_add_u32 v38, s57, v0
    v_bfe_u32 v20, v38, 5, 2
    v_lshlrev_b32 v20, 8, v20
    v_and_b32 v39, 15, v38
    v_lshl_add_u32 v20, v39, 4, v20
    v_bfe_u32 v39, v38, 4, 1
    v_lshl_add_u32 v20, v39, 3, v20
    v_add_u32 v20, 124928, v20
    s_lshr_b32 s57, s54, 1
    s_lshl_b32 s57, s57, 2
    s_and_b32 s58, s54, 1
    s_add_u32 s57, s57, s58
    s_lshl_b32 s58, s57, 4
    s_lshl_b32 s57, s57, 3
    v_bfe_u32 v21, v0, 3, 2
    v_lshlrev_b32 v21, 8, v21
    v_bfe_u32 v39, v0, 2, 1
    v_lshl_add_u32 v21, v39, 5, v21
    v_and_b32 v39, 3, v0
    v_lshl_add_u32 v21, v39, 2, v21
    v_add_u32 v21, s58, v21
    v_bfe_u32 v38, v0, 3, 1
    v_lshlrev_b32 v38, 8, v38
    v_bfe_u32 v39, v0, 1, 1
    v_lshl_add_u32 v38, v39, 7, v38
    v_bfe_u32 v39, v0, 2, 1
    v_lshl_add_u32 v38, v39, 4, v38
    v_and_b32 v39, 1, v0
    v_lshl_add_u32 v38, v39, 2, v38
    v_add_u32 v38, s57, v38
    v_add_u32 v38, 1024, v38
    v_cmp_gt_u32 vcc, 32, v0
    s_nop 1
    v_cndmask_b32 v21, v38, v21, vcc
    s_lshl_b32 s57, s53, 1
    s_add_u32 s57, s57, s30
    s_mul_i32 s57, s57, 1536
    s_add_u32 s57, s57, s62
    s_add_u32 s57, s57, 12288
    v_add_u32 v21, s57, v21
    s_branch L_b2_1
L_gs_180:
    buffer_store_dword v56, v21, s[40:43], 0 offen sc1
    s_branch L_gb_181
L_pr_183:
    s_sub_u32 s56, s56, 1
    s_cbranch_scc1 L_done
    buffer_load_dword v18, v5, s[40:43], s59 offen sc1
    buffer_load_dwordx2 v[20:21], v22, s[40:43], s59 offen sc1
    s_waitcnt vmcnt(0)
    s_branch L_pw_182
L_pr_185:
    s_sub_u32 s56, s56, 1
    s_cbranch_scc1 L_done
    buffer_load_dwordx4 v[12:15], v9, s[40:43], s60 offen sc1
    buffer_load_dwordx2 v[16:17], v10, s[40:43], s60 offen offset:1024 sc1
L_pad24:
    s_cbranch_execz L_pad25
    s_waitcnt vmcnt(0)
    s_branch L_pw_184
L_gs_187:
    buffer_store_dword v0, v0, s[40:43], s57 offen sc1
    s_branch L_gb_188
L_pr_191:
    s_sub_u32 s56, s56, 1
    s_cbranch_scc1 L_done
    buffer_load_dwordx4 v[12:15], v11, s[40:43], s58 offen offset:0 sc1
    buffer_load_dwordx4 v[16:19], v11, s[40:43], s58 offen offset:1024 sc1
    buffer_load_dwordx4 v[20:23], v11, s[40:43], s58 offen offset:2048 sc1
    buffer_load_dwordx4 v[24:27], v11, s[40:43], s59 offen offset:0 sc1
    buffer_load_dwordx4 v[28:31], v11, s[40:43], s59 offen offset:1024 sc1
    buffer_load_dwordx4 v[32:35], v11, s[40:43], s59 offen offset:2048 sc1
    s_waitcnt vmcnt(0)
    s_branch L_pw_190
L_pr_193:
    s_sub_u32 s56, s56, 1
    s_cbranch_scc1 L_done
    buffer_load_dwordx2 v[2:3], v12, s[40:43], s57 offen sc1
    s_waitcnt vmcnt(0)
    s_branch L_pw_192
L_pr_197:
    s_sub_u32 s56, s56, 1
    s_cbranch_scc1 L_done
    buffer_load_dwordx4 v[12:15], v11, s[40:43], s58 offen offset:0 sc1
    buffer_load_dwordx4 v[16:19], v11, s[40:43], s58 offen offset:1024 sc1
    buffer_load_dwordx4 v[20:23], v11, s[40:43], s58 offen offset:2048 sc1
    buffer_load_dwordx4 v[24:27], v11, s[40:43], s59 offen offset:0 sc1
    buffer_load_dwordx4 v[28:31], v11, s[40:43], s59 offen offset:1024 sc1
    buffer_load_dwordx4 v[32:35], v11, s[40:43], s59 offen offset:2048 sc1
    s_waitcnt vmcnt(0)
    s_branch L_pw_196
L_hr_194:
    buffer_load_dwordx4 v[12:15], v11, s[40:43], s58 offen offset:0 sc1
    buffer_load_dwordx4 v[16:19], v11, s[40:43], s58 offen offset:1024 sc1
    buffer_load_dwordx4 v[20:23], v11, s[40:43], s58 offen offset:2048 sc1
    buffer_load_dwordx4 v[24:27], v11, s[40:43], s59 offen offset:0 sc1
    buffer_load_dwordx4 v[28:31], v11, s[40:43], s59 offen offset:1024 sc1
    buffer_load_dwordx4 v[32:35], v11, s[40:43], s59 offen offset:2048 sc1
    s_waitcnt vmcnt(0)
L_pw_196:
    v_max3_u32 v4, v12, v13, v14
    v_max3_u32 v4, v4, v15, v16
    v_max3_u32 v4, v4, v17, v18
    v_max3_u32 v4, v4, v19, v20
    v_max3_u32 v4, v4, v21, v22
    v_max3_u32 v4, v4, v23, v24
    v_max3_u32 v4, v4, v25, v26
    v_max3_u32 v4, v4, v27, v28
    v_max3_u32 v4, v4, v29, v30
    v_max3_u32 v4, v4, v31, v32
    v_max3_u32 v4, v4, v33, v34
    v_max_u32 v4, v4, v35
    v_cmp_eq_u32 vcc, -1, v4
    s_cbranch_vccnz L_pr_197
    v_pk_add_f32 v[12:13], v[12:13], v[14:15]
    v_pk_add_f32 v[16:17], v[16:17], v[18:19]
    v_pk_add_f32 v[12:13], v[12:13], v[16:17]
    v_add_f32 v12, v12, v13
    v_pk_add_f32 v[20:21], v[20:21], v[22:23]
    v_pk_add_f32 v[24:25], v[24:25], v[26:27]
    v_pk_add_f32 v[20:21], v[20:21], v[24:25]
    v_add_f32 v13, v20, v21
    v_pk_add_f32 v[28:29], v[28:29], v[30:31]
    v_pk_add_f32 v[32:33], v[32:33], v[34:35]
    v_pk_add_f32 v[28:29], v[28:29], v[32:33]
    v_add_f32 v14, v28, v29
    s_branch L_hk_195
L_gs_199:
    buffer_store_dword v0, v0, s[40:43], s57 offen sc1
    s_branch L_gb_200
L_pr_204:
    s_sub_u32 s56, s56, 1
    s_cbranch_scc1 L_done
    buffer_load_dword v12, v9, s[40:43], s57 offen sc1
    s_waitcnt vmcnt(0)
    s_branch L_pw_203
L_gr_206:
    s_sub_u32 s56, s56, 1
    s_cbranch_scc1 L_done
    s_mov_b64 s[74:75], 0
    v_max3_u32 v30, v12, v13, v14
    v_max_u32 v30, v30, v15
    v_cmp_eq_u32 vcc, -1, v30
    s_cbranch_vccz L_gn_208
    s_or_b64 s[74:75], s[74:75], vcc
    s_mov_b64 exec, vcc
    buffer_load_dwordx4 v[12:15], v5, s[40:43], s57 offen sc1
    s_mov_b64 exec, -1
L_gn_208:
    v_max3_u32 v30, v16, v17, v18
L_pad25:
    s_cbranch_execz L_padback
    v_max_u32 v30, v30, v19
    v_cmp_eq_u32 vcc, -1, v30
    s_cbranch_vccz L_gn_209
    s_or_b64 s[74:75], s[74:75], vcc
    s_mov_b64 exec, vcc
    buffer_load_dwordx4 v[16:19], v5, s[40:43], s58 offen sc1
    s_mov_b64 exec, -1
L_gn_209:
    v_max3_u32 v30, v20, v21, v22
    v_max_u32 v30, v30, v23
    v_cmp_eq_u32 vcc, -1, v30
    s_cbranch_vccz L_gn_210
    s_or_b64 s[74:75], s[74:75], vcc
    s_mov_b64 exec, vcc
    buffer_load_dwordx4 v[20:23], v5, s[40:43], s59 offen sc1
    s_mov_b64 exec, -1
L_gn_210:
    v_max3_u32 v30, v24, v25, v26
    v_max_u32 v30, v30, v27
    v_cmp_eq_u32 vcc, -1, v30
    s_cbranch_vccz L_gn_211
    s_or_b64 s[74:75], s[74:75], vcc
    s_mov_b64 exec, vcc
    buffer_load_dwordx4 v[24:27], v5, s[40:43], s60 offen sc1
    s_mov_b64 exec, -1
L_gn_211:
    s_cmp_eq_u64 s[74:75], 0
    s_cbranch_scc1 L_gk_207
    s_waitcnt vmcnt(0)
    s_branch L_gw_205
L_gs_213:
    buffer_store_dword v12, v34, s[40:43], s59 offen sc1
    s_branch L_gb_214
L_gs_216:
    buffer_store_dword v27, v34, s[40:43], s67 offen sc1
    s_branch L_gb_217
L_pr_219:
    s_sub_u32 s56, s56, 1
    s_cbranch_scc1 L_done
    buffer_load_dword v12, v9, s[40:43], s57 offen sc1
    s_waitcnt vmcnt(0)
    s_branch L_pw_218
L_gr_221:
    s_sub_u32 s56, s56, 1
    s_cbranch_scc1 L_done
    s_mov_b64 s[74:75], 0
    v_max3_u32 v30, v12, v13, v14
    v_max_u32 v30, v30, v15
    v_cmp_eq_u32 vcc, -1, v30
    s_cbranch_vccz L_gn_223
    s_or_b64 s[74:75], s[74:75], vcc
    s_mov_b64 exec, vcc
    buffer_load_dwordx4 v[12:15], v5, s[40:43], s57 offen sc1
    s_mov_b64 exec, -1
L_gn_223:
    v_max3_u32 v30, v16, v17, v18
    v_max_u32 v30, v30, v19
    v_cmp_eq_u32 vcc, -1, v30
    s_cbranch_vccz L_gn_224
    s_or_b64 s[74:75], s[74:75], vcc
    s_mov_b64 exec, vcc
    buffer_load_dwordx4 v[16:19], v5, s[40:43], s58 offen sc1
    s_mov_b64 exec, -1
L_gn_224:
    v_max3_u32 v30, v20, v21, v22
    v_max_u32 v30, v30, v23
    v_cmp_eq_u32 vcc, -1, v30
    s_cbranch_vccz L_gn_225
    s_or_b64 s[74:75], s[74:75], vcc
    s_mov_b64 exec, vcc
    buffer_load_dwordx4 v[20:23], v5, s[40:43], s59 offen sc1
    s_mov_b64 exec, -1
L_gn_225:
    v_max3_u32 v30, v24, v25, v26
    v_max_u32 v30, v30, v27
    v_cmp_eq_u32 vcc, -1, v30
    s_cbranch_vccz L_gn_226
    s_or_b64 s[74:75], s[74:75], vcc
    s_mov_b64 exec, vcc
    buffer_load_dwordx4 v[24:27], v5, s[40:43], s60 offen sc1
    s_mov_b64 exec, -1
L_gn_226:
    s_cmp_eq_u64 s[74:75], 0
    s_cbranch_scc1 L_gk_222
    s_waitcnt vmcnt(0)
    s_branch L_gw_220
L_tail_end:
L_spread:
    s_add_u32 s62, s62, 671744
    s_cmp_eq_u32 s30, 5
    s_cbranch_scc0 L_skip_59
    v_mov_b64 v[12:13], -1
    v_mov_b64 v[14:15], -1
    v_lshlrev_b32 v16, 4, v0
    s_mul_i32 s57, s52, 1792
    s_add_u32 s57, s57, s62
    s_mov_b32 exec_lo, 0xffffffff
    s_mov_b32 exec_hi, 0xffff
    buffer_store_dwordx4 v[12:15], v16, s[40:43], s57 offen offset:1024 sc1
    s_mov_b64 exec, -1
    buffer_store_dwordx4 v[12:15], v16, s[40:43], s57 offen sc1
L_skip_59:
    s_cmp_eq_u32 s30, 7
    s_cbranch_scc0 L_skip_60
    v_and_b32 v60, 31, v0
    v_cmp_gt_u32 s[64:65], 20, v60
    v_min_u32 v60, 19, v60
    v_lshrrev_b32 v35, 5, v0
    v_lshlrev_b32 v35, 2, v35
    v_add_u32 v35, 159872, v35
    v_lshl_add_u32 v35, v60, 3, v35
    s_mul_i32 s66, s53, 6400
    s_add_u32 s66, s66, s62
    s_add_u32 s66, s66, 57344
    s_add_u32 s67, s66, 6144
    s_lshl_b32 s57, s54, 3
    v_lshrrev_b32 v34, 5, v0
    v_lshlrev_b32 v34, 2, v34
    v_add_u32 v34, s57, v34
    v_mov_b32 v61, 0x3f803f80
    v_cvt_pk_bf16_f32 v28, v2, v3
L_skip_60:
    s_cmp_eq_u32 s30, 7
    s_cbranch_scc0 L_skip_61
    v_lshlrev_b32 v2, 16, v28
    v_and_b32 v3, 0xffff0000, v28
    v_cndmask_b32 v28, 0, v28, s[64:65]
    v_dot2_f32_bf16 v27, v28, v61, 0
    v_dot2_f32_bf16 v62, v28, v28, 0
    s_nop 2
    v_permlane32_swap_b32 v27, v62
    v_add_f32 v27, v27, v62
    v_mov_b32 v62, v27
    s_nop 1
    v_permlane16_swap_b32 v27, v62
    v_add_f32 v27, v27, v62
    s_nop 1
    v_add_f32_dpp v27, v27, v27 row_ror:8 row_mask:0xf bank_mask:0xf
    s_nop 1
    v_add_f32_dpp v27, v27, v27 row_ror:4 row_mask:0xf bank_mask:0xf
    s_nop 1
    v_add_f32_dpp v27, v27, v27 row_ror:2 row_mask:0xf bank_mask:0xf
    s_nop 1
    v_add_f32_dpp v27, v27, v27 row_ror:1 row_mask:0xf bank_mask:0xf
    v_min_u32 v27, -2, v27
    s_mov_b32 exec_lo, 0x1
    s_mov_b32 exec_hi, 0x1
    s_cmp_eq_u32 s55, 0
    s_cbranch_scc1 L_gs_62
    buffer_store_dword v27, v34, s[40:43], s67 offen
L_gb_63:
    s_mov_b64 exec, -1
L_skip_61:
    s_cmp_lt_u32 s30, 6
    s_cbranch_scc0 L_skip_64
    s_lshr_b32 s57, s30, 1
    s_mul_i32 s57, s57, 1024
    s_and_b32 s58, s30, 1
    s_lshl_b32 s58, s58, 6
    s_add_u32 s57, s57, s58
    v_lshrrev_b32 v18, 5, v0
    v_mul_u32_u24 v18, 6144, v18
    v_bfe_u32 v60, v0, 3, 1
    v_mul_u32_u24 v60, 3072, v60
    v_add_u32 v18, v60, v18
    v_bfe_u32 v60, v0, 4, 1
    v_lshl_add_u32 v18, v60, 9, v18
    v_bfe_u32 v60, v0, 2, 1
    v_lshl_add_u32 v18, v60, 7, v18
    v_and_b32 v60, 3, v0
    v_lshl_add_u32 v18, v60, 3, v18
    v_add_u32 v18, s57, v18
    v_bfe_u32 v19, v0, 4, 1
    v_mul_u32_u24 v19, 3072, v19
    v_bfe_u32 v60, v0, 3, 1
    v_lshl_add_u32 v19, v60, 9, v19
    v_bfe_u32 v60, v0, 2, 1
    v_lshl_add_u32 v19, v60, 7, v19
    v_and_b32 v60, 3, v0
    v_lshl_add_u32 v19, v60, 3, v19
    v_add_u32 v19, s57, v19
    v_add_u32 v19, 24576, v19
    ds_read_b64_tr_b16 v[36:37], v18 offset:0
    ds_read_b64_tr_b16 v[38:39], v18 offset:256
    ds_read_b64_tr_b16 v[40:41], v18 offset:12288
    ds_read_b64_tr_b16 v[42:43], v18 offset:12544
    ds_read_b64_tr_b16 v[44:45], v19 offset:0
    ds_read_b64_tr_b16 v[46:47], v19 offset:256
    ds_read_b64_tr_b16 v[48:49], v18 offset:32
    ds_read_b64_tr_b16 v[50:51], v18 offset:288
    ds_read_b64_tr_b16 v[52:53], v18 offset:12320
    ds_read_b64_tr_b16 v[54:55], v18 offset:12576
    ds_read_b64_tr_b16 v[56:57], v19 offset:32
    ds_read_b64_tr_b16 v[58:59], v19 offset:288
    v_lshrrev_b32 v32, 4, v0
    v_lshlrev_b32 v32, 5, v32
    v_bfe_u32 v60, v0, 1, 1
    v_lshl_add_u32 v32, v60, 4, v32
    v_and_b32 v60, 1, v0
    v_mul_u32_u24 v60, 192, v60
    v_add_u32 v32, v60, v32
    v_add_u32 v32, 159872, v32
    v_lshrrev_b32 v33, 4, v0
    v_lshlrev_b32 v33, 4, v33
    v_bfe_u32 v60, v0, 1, 1
    v_lshl_add_u32 v33, v60, 3, v33
    v_and_b32 v60, 1, v0
    v_mul_u32_u24 v60, 192, v60
    v_add_u32 v33, v60, v33
    v_add_u32 v33, 160000, v33
    v_mov_b64 v[24:25], 0
    v_mov_b64 v[26:27], 0
    v_mov_b64 v[28:29], 0
    v_mov_b64 v[30:31], 0
    s_lshr_b32 s57, s54, 1
    s_lshl_b32 s57, s57, 2
    s_and_b32 s58, s54, 1
    s_add_u32 s57, s57, s58
    s_lshl_b32 s57, s57, 4
    s_lshl_b32 s58, s30, 9
    s_add_u32 s57, s57, s58
    v_bfe_u32 v34, v0, 4, 1
    v_lshlrev_b32 v34, 8, v34
    v_bfe_u32 v60, v0, 1, 1
    v_lshl_add_u32 v34, v60, 5, v34
    v_bfe_u32 v60, v0, 2, 2
    v_lshl_add_u32 v34, v60, 2, v34
    v_lshrrev_b32 v60, 5, v0
    v_mul_u32_u24 v60, 3072, v60
    v_add_u32 v34, v60, v34
    v_add_u32 v34, s57, v34
    s_mul_i32 s59, s53, 6400
    s_add_u32 s59, s59, s62
    s_add_u32 s59, s59, 57344
    s_add_u32 s60, s59, 6144
    ds_read_b128 v[12:15], v32
    ds_read_b64 v[16:17], v33
    s_waitcnt lgkmcnt(1)
    v_smfmac_f32_16x16x64_bf16 v[24:27], v[12:15], v[36:43], v1
    v_smfmac_f32_16x16x64_bf16 v[28:31], v[12:15], v[48:55], v1
    s_waitcnt lgkmcnt(0)
    v_smfmac_f32_16x16x32_bf16 v[24:27], v[16:17], v[44:47], v1
    v_smfmac_f32_16x16x32_bf16 v[28:31], v[16:17], v[56:59], v1
    s_nop 6
    v_add_f32 v12, v24, v26
    s_nop 1
    v_add_f32_dpp v12, v28, v30 quad_perm:[0,1,2,3] row_mask:0x2 bank_mask:0xf
    s_nop 1
    v_add_f32_dpp v12, v25, v27 quad_perm:[0,1,2,3] row_mask:0x4 bank_mask:0xf
    s_nop 1
    v_add_f32_dpp v12, v29, v31 quad_perm:[0,1,2,3] row_mask:0x8 bank_mask:0xf
    s_nop 1
    v_mov_b32_dpp v13, v12 row_shl:1 row_mask:0xf bank_mask:0xf bound_ctrl:0
    v_cvt_pk_bf16_f32 v12, v12, v13
    v_min_u32 v12, -2, v12
    s_mov_b32 exec_lo, 0x55555555
    s_mov_b32 exec_hi, 0x55555555
    s_cmp_eq_u32 s55, 0
    s_cbranch_scc1 L_gs_65
    buffer_store_dword v12, v34, s[40:43], s59 offen
L_gb_66:
    s_mov_b64 exec, -1
L_skip_64:
    s_waitcnt vmcnt(0)
    s_barrier
    s_cmp_eq_u32 s30, 5
    s_cbranch_scc0 L_skip_67
    s_lshl_b32 s57, s52, 2
    s_add_u32 s57, s57, s72
    s_mov_b64 exec, 1
    buffer_store_dword v0, v0, s[40:43], s57 offen offset:256 sc1
    s_mov_b64 exec, -1
    v_and_b32 v16, 31, v0
    v_lshlrev_b32 v16, 2, v16
    buffer_load_dword v17, v16, s[40:43], s72 offen offset:256 sc1
    s_waitcnt vmcnt(0)
L_pw_68:
    v_cmp_eq_u32 vcc, -1, v17
    s_cbranch_vccnz L_pr_69
L_skip_67:
    s_barrier
    s_branch L_spread_back
L_done:
L_exit:
    s_endpgm
.section .rodata,"a"
.p2align 6
.amdhsa_kernel interleave_layers__sliding_block_cached__dense_activation_gelu__decode_kernel
  .amdhsa_next_free_vgpr 256
  .amdhsa_next_free_sgpr 102
  .amdhsa_accum_offset 256
  .amdhsa_group_segment_fixed_size 0
  .amdhsa_kernarg_size 104
  .amdhsa_user_sgpr_count 2
  .amdhsa_user_sgpr_kernarg_segment_ptr 1
  .amdhsa_system_sgpr_workgroup_id_x 1
  .amdhsa_float_denorm_mode_32 3
.end_amdhsa_kernel
```

```asm
; @launch grid=(256,1,1) block=(512,1,1) lds=160320
.amdgcn_target "amdgcn-amd-amdhsa--gfx950"
.text
.fill 64, 4, 0xbf800000
.globl interleave_layers__sliding_block_cached__dense_activation_gelu__decode_kernel
.p2align 8
.type interleave_layers__sliding_block_cached__dense_activation_gelu__decode_kernel,@function
interleave_layers__sliding_block_cached__dense_activation_gelu__decode_kernel:
    s_load_dwordx16 s[4:19], s[0:1], 0
    s_load_dwordx8 s[20:27], s[0:1], 64
    s_load_dwordx2 s[28:29], s[0:1], 96
    s_cmp_ge_u32 s2, 256
    s_cbranch_scc1 L_exit
    s_getpc_b64 s[74:75]
L_pc:
    v_lshlrev_b32 v5, 6, v0
    v_min_u32 v5, L_exit-L_pc, v5
    global_load_dword v59, v5, s[74:75]
    v_lshrrev_b32 v5, 6, v0
    v_and_b32 v0, 63, v0
    v_readfirstlane_b32 s30, v5
    s_and_b32 s31, s2, 7
    s_lshr_b32 s52, s2, 3
    s_and_b32 s53, s52, 3
    s_lshr_b32 s54, s52, 2
    s_lshl_b32 s73, s31, 2
    s_add_u32 s73, s73, s53
    s_mul_i32 s3, s54, 3
    s_add_u32 s3, s3, s53
    s_cmp_eq_u32 s53, 3
    s_cselect_b32 s3, 31, s3
    v_lshrrev_b32 v8, 5, v0
    v_lshlrev_b32 v8, 2, v8
    v_bfe_u32 v60, v0, 4, 1
    v_lshl_add_u32 v8, v60, 0, v8
    v_and_b32 v9, 7, v0
    v_xor_b32 v8, v8, v9
    v_lshrrev_b32 v10, 3, v0
    v_mul_u32_u24 v10, 384, v10
    v_lshl_add_u32 v5, v8, 4, v10
    v_xor_b32 v6, 32, v5
    v_lshrrev_b32 v8, 4, v0
    v_lshlrev_b32 v8, 1, v8
    v_xor_b32 v8, v8, v9
    v_lshl_add_u32 v7, v8, 4, v10
    v_lshrrev_b32 v2, 3, v0
    v_mul_u32_u24 v2, 12288, v2
    v_and_b32 v60, 7, v0
    v_lshl_add_u32 v2, v60, 4, v2
    s_mul_i32 s57, s73, 12582912
    s_mul_i32 s58, s54, 3072
    s_add_u32 s57, s57, s58
    s_add_u32 s57, s57, 11010048
    s_sub_u32 s58, 1572864, s58
    s_mul_i32 s59, s73, 384
    s_mul_i32 s60, s54, 983040
    s_add_u32 s59, s59, s60
    s_sub_u32 s60, 7866368, s59
    s_lshl_b32 s61, s30, 11
    s_add_u32 s61, s61, 92160
    s_mul_i32 s62, s31, 83968
    s_lshl_b32 s72, s31, 9
    s_add_u32 s72, s72, 1425408
    s_mov_b32 s56, 65536
    s_mov_b32 s55, 1
    s_getreg_b32 s63, hwreg(20, 0, 3)
    v_mov_b32 v3, 0
    v_mov_b32 v24, 0
    v_mov_b32 v34, 0
    v_mov_b64 v[12:13], -1
    v_mov_b64 v[14:15], -1
    v_lshlrev_b32 v10, 4, v0
    s_waitcnt lgkmcnt(0)
    s_add_u32 s32, s6, s57
    s_addc_u32 s33, s7, 0
    s_mov_b32 s34, s58
    s_mov_b32 s35, 0x20000
    s_add_u32 s36, s8, s57
    s_addc_u32 s37, s9, 0
    s_mov_b32 s38, s58
    s_mov_b32 s39, 0x20000
    s_mov_b32 s40, s28
    s_mov_b32 s41, s29
    s_mov_b32 s42, 1429504
    s_mov_b32 s43, 0x20000
    s_add_u32 s44, s10, s59
    s_addc_u32 s45, s11, 0
    s_mov_b32 s46, s60
    s_mov_b32 s47, 0x20000
    s_sub_u32 s44, s44, 2048
    s_subb_u32 s45, s45, 0
    s_cmp_eq_u32 s30, 6
    s_cbranch_scc0 L_skip_1
    s_setprio 3
    s_mov_b32 s57, 0
    s_mov_b32 s58, 195584
    s_mov_b32 m0, 92160
L_dma_2:
    s_waitcnt vmcnt(25)
    buffer_load_dwordx4 v5, s[32:35], s57 offen offset:0 nt lds
    s_waitcnt vmcnt(25)
    buffer_load_dwordx4 v6, s[32:35], s58 offen offset:1024 nt lds
    s_add_u32 s57, s57, 24576
    s_add_u32 s58, s58, 24576
    s_add_u32 m0, m0, 2048
    s_cmp_lg_u32 m0, 108544
    s_cbranch_scc1 L_dma_2
    s_mov_b32 s57, 128
    s_mov_b32 s58, 195712
    s_mov_b32 m0, 108544
L_dma_3:
    s_waitcnt vmcnt(25)
    buffer_load_dwordx4 v5, s[32:35], s57 offen offset:0 nt lds
    s_waitcnt vmcnt(25)
    buffer_load_dwordx4 v6, s[32:35], s58 offen offset:1024 nt lds
    s_add_u32 s57, s57, 24576
    s_add_u32 s58, s58, 24576
    s_add_u32 m0, m0, 2048
    s_cmp_lg_u32 m0, 124928
    s_cbranch_scc1 L_dma_3
    s_mov_b32 s57, 2048
    s_mov_b32 s58, 1152
    s_mov_b32 s59, 256
    s_mov_b32 m0, 0
L_dma_4:
    s_waitcnt vmcnt(25)
    buffer_load_dwordx4 v2, s[44:47], s57 offen offset:0 nt lds
    s_waitcnt vmcnt(25)
    buffer_load_dwordx4 v2, s[44:47], s58 offen offset:1024 nt lds
    s_waitcnt vmcnt(25)
    buffer_load_dwordx4 v2, s[44:47], s59 offen offset:2048 nt lds
    s_add_u32 s57, s57, 98304
    s_add_u32 s58, s58, 98304
    s_add_u32 s59, s59, 98304
    s_add_u32 m0, m0, 3072
    s_cmp_lg_u32 m0, 15360
    s_cbranch_scc1 L_dma_4
L_skip_1:
    s_cmp_lt_u32 s3, 20
    s_cselect_b32 s57, 7864320, 0
    s_add_u32 s58, s54, 1
    s_mul_i32 s58, s58, 245760
    s_cmp_lg_u32 s53, 3
    s_cselect_b64 s[48:49], s[12:13], s[16:17]
    s_cselect_b32 s50, s57, s58
    s_mov_b32 s51, 0x20000
    s_cmp_eq_u32 s30, 5
    s_cbranch_scc0 L_skip_5
    s_cmp_eq_u32 s52, 31
    s_cbranch_scc0 L_skip_6
    s_mov_b64 exec, 0xffffff
    buffer_store_dwordx4 v[12:15], v10, s[40:43], s72 offen sc1
    s_mov_b64 exec, -1
L_skip_6:
    s_cmp_lt_u32 s3, 20
    s_cbranch_scc0 L_skip_7
    s_mul_i32 s57, s31, 2560
    s_lshl_b32 s58, s3, 7
    s_add_u32 s58, s58, s57
    s_add_u32 s58, s58, 1343488
    v_bfe_u32 v16, v0, 3, 2
    v_mul_u32_u24 v16, 20480, v16
    v_and_b32 v60, 7, v0
    v_lshl_add_u32 v16, v60, 4, v16
    s_mov_b32 exec_lo, 0xffffffff
    s_mov_b32 exec_hi, 0x0
    buffer_store_dwordx4 v[12:15], v16, s[40:43], s58 offen sc1
L_skip_7:
    s_mul_i32 s57, s52, 1792
    s_add_u32 s57, s57, s62
    s_mov_b32 exec_lo, 0xffffffff
    s_mov_b32 exec_hi, 0xffff
    buffer_store_dwordx4 v[12:15], v10, s[40:43], s57 offen offset:1024
    s_mov_b64 exec, -1
    buffer_store_dwordx4 v[12:15], v10, s[40:43], s57 offen
    s_mov_b64 exec, -1
    v_and_b32 v16, 31, v0
    v_lshlrev_b32 v16, 2, v16
    v_add_u32 v16, 159744, v16
    ds_write_b32 v16, v12
    v_subrev_u32 v16, 8, v0
    v_cmp_gt_u32 vcc, 40, v16
    v_mov_b32 v16, 0x3f803f80
    s_nop 0
    v_cndmask_b32 v18, 0, v16, vcc
    v_min_u32 v16, 55, v0
    v_lshlrev_b32 v16, 2, v16
    v_add_u32 v16, 160096, v16
    ds_write_b32 v16, v18
    v_and_b32 v3, 7, v0
    v_lshlrev_b32 v3, 5, v3
L_skip_5:
    s_cmp_eq_u32 s30, 7
    s_cbranch_scc0 L_skip_8
    v_and_b32 v60, 31, v0
    v_min_u32 v60, 19, v60
    s_mul_i32 s57, s54, 160
    v_lshrrev_b32 v16, 5, v0
    v_lshlrev_b32 v16, 2, v16
    v_add_u32 v16, s57, v16
    v_lshl_add_u32 v16, v60, 3, v16
    global_load_dword v28, v16, s[4:5]
    global_load_dword v4, v16, s[22:23]
L_skip_8:
    v_bfe_u32 v8, v0, 1, 3
    v_lshrrev_b32 v9, 4, v0
    v_xor_b32 v9, v8, v9
    v_bfe_u32 v8, v0, 2, 1
    v_lshlrev_b32 v8, 10, v8
    v_bfe_u32 v60, v0, 3, 1
    v_lshl_add_u32 v8, v60, 9, v8
    v_and_b32 v60, 3, v0
    v_lshl_add_u32 v8, v60, 7, v8
    v_add_u32 v8, s61, v8
    v_lshl_add_u32 v8, v9, 4, v8
    v_xor_b32 v9, 64, v8
    v_bfe_u32 v1, v0, 1, 1
    v_mul_u32_u24 v1, 43690, v1
    v_add_u32 v1, 17476, v1
    s_waitcnt vmcnt(31)
    s_barrier
    ds_read_b128 v[64:67], v8 offset:0
    ds_read_b128 v[68:71], v9 offset:0
    s_cmp_eq_u32 s30, 6
    s_cbranch_scc0 L_skip_9
    s_mov_b32 s57, 256
    s_mov_b32 s58, 195840
    s_mov_b32 m0, 124928
L_dma_10:
    s_waitcnt vmcnt(25)
    buffer_load_dwordx4 v5, s[32:35], s57 offen offset:0 nt lds
    s_waitcnt vmcnt(25)
    buffer_load_dwordx4 v6, s[32:35], s58 offen offset:1024 nt lds
    s_add_u32 s57, s57, 24576
    s_add_u32 s58, s58, 24576
    s_add_u32 m0, m0, 2048
    s_cmp_lg_u32 m0, 141312
    s_cbranch_scc1 L_dma_10
L_skip_9:
    s_waitcnt lgkmcnt(0)
    s_cmp_eq_u32 s30, 5
    s_cbranch_scc0 L_skip_11
    s_cmp_eq_u32 s52, 31
    s_cbranch_scc0 L_skip_12
    s_lshl_b32 s57, s31, 5
    v_mov_b32 v16, s57
    s_add_u32 s57, s63, 1
    v_mov_b32 v12, s57
    s_waitcnt vmcnt(2)
    s_mov_b64 exec, 0x1
    global_store_dword v16, v12, s[26:27] sc1
    s_mov_b64 exec, -1
L_skip_12:
L_skip_11:
    s_waitcnt vmcnt(31)
    s_barrier
    ds_read_b128 v[72:75], v8 offset:16384
    ds_read_b128 v[76:79], v9 offset:16384
    s_cmp_eq_u32 s30, 6
    s_cbranch_scc0 L_skip_13
    s_mov_b32 s57, 493568
    s_mov_b32 s58, 492672
    s_mov_b32 s59, 491776
    s_mov_b32 m0, 15360
L_dma_14:
    s_waitcnt vmcnt(25)
    buffer_load_dwordx4 v2, s[44:47], s57 offen offset:0 nt lds
    s_waitcnt vmcnt(25)
    buffer_load_dwordx4 v2, s[44:47], s58 offen offset:1024 nt lds
    s_waitcnt vmcnt(25)
    buffer_load_dwordx4 v2, s[44:47], s59 offen offset:2048 nt lds
    s_add_u32 s57, s57, 98304
    s_add_u32 s58, s58, 98304
    s_add_u32 s59, s59, 98304
    s_add_u32 m0, m0, 3072
    s_cmp_lg_u32 m0, 30720
    s_cbranch_scc1 L_dma_14
    s_mov_b32 s57, 393216
    s_mov_b32 s58, 588800
    s_mov_b32 m0, 141312
L_dma_15:
    s_waitcnt vmcnt(25)
    buffer_load_dwordx4 v5, s[32:35], s57 offen offset:0 nt lds
    s_waitcnt vmcnt(25)
    buffer_load_dwordx4 v6, s[32:35], s58 offen offset:1024 nt lds
    s_add_u32 s57, s57, 24576
    s_add_u32 s58, s58, 24576
    s_add_u32 m0, m0, 2048
    s_cmp_lg_u32 m0, 157696
    s_cbranch_scc1 L_dma_15
L_skip_13:
    s_waitcnt lgkmcnt(0)
    s_waitcnt vmcnt(31)
    s_barrier
    ds_read_b128 v[80:83], v8 offset:32768
    ds_read_b128 v[84:87], v9 offset:32768
    s_cmp_eq_u32 s30, 6
    s_cbranch_scc0 L_skip_16
    s_cmp_lg_u32 s53, 3
    s_cbranch_scc0 L_wb_17
    s_mul_i32 s57, s31, 983040
    s_lshl_b32 s58, s3, 6
    s_add_u32 s57, s57, s58
    v_bfe_u32 v38, v0, 4, 1
    v_lshlrev_b32 v38, 1, v38
    v_xor_b32 v38, v38, v0
    v_and_b32 v38, 3, v38
    v_lshrrev_b32 v3, 5, v0
    v_mul_u32_u24 v3, 10240, v3
    v_bfe_u32 v39, v0, 4, 1
    v_mul_u32_u24 v39, 2560, v39
    v_add_u32 v3, v39, v3
    v_bfe_u32 v39, v0, 3, 1
    v_mul_u32_u24 v39, 5120, v39
    v_add_u32 v3, v39, v3
    v_bfe_u32 v39, v0, 2, 1
    v_mul_u32_u24 v39, 20480, v39
    v_add_u32 v3, v39, v3
    v_add_u32 v3, s57, v3
    v_lshl_add_u32 v3, v38, 4, v3
    s_mov_b32 s14, 40960
    s_mov_b32 s15, 256
    s_branch L_we_18
L_wb_17:
    s_mul_i32 s57, s31, 384
    s_mul_i32 s58, s54, 245760
    s_add_u32 s57, s57, s58
    v_lshlrev_b32 v3, 4, v0
    v_add_u32 v3, s57, v3
    v_mov_b32 v38, 2688
    v_cmp_lt_u32 vcc, 23, v0
    s_nop 1
    v_cndmask_b32 v38, 0, v38, vcc
    v_add_u32 v3, v38, v3
    v_mov_b32 v38, 0x7f000000
    v_cmp_lt_u32 vcc, 47, v0
    s_nop 1
    v_cndmask_b32 v3, v3, v38, vcc
    s_mov_b32 s14, 12288
    s_mov_b32 s15, 5120
L_we_18:
    s_mul_i32 s57, s14, 0
    s_mov_b32 m0, 30720
    s_waitcnt vmcnt(25)
    buffer_load_dwordx4 v3, s[48:51], s57 offen offset:0 nt lds
    s_mul_i32 s57, s14, 0
    s_add_u32 s57, s57, s15
    s_mov_b32 m0, 30720
    s_waitcnt vmcnt(25)
    buffer_load_dwordx4 v3, s[48:51], s57 offen offset:1024 nt lds
    s_mov_b32 s57, 393344
    s_mov_b32 s58, 588928
    s_mov_b32 m0, 92160
L_dma_19:
    s_waitcnt vmcnt(25)
    buffer_load_dwordx4 v5, s[32:35], s57 offen offset:0 nt lds
    s_waitcnt vmcnt(25)
    buffer_load_dwordx4 v6, s[32:35], s58 offen offset:1024 nt lds
    s_add_u32 s57, s57, 24576
    s_add_u32 s58, s58, 24576
    s_add_u32 m0, m0, 2048
    s_cmp_lg_u32 m0, 108544
    s_cbranch_scc1 L_dma_19
    s_mul_i32 s57, s14, 1
    s_mov_b32 m0, 32768
    s_waitcnt vmcnt(25)
    buffer_load_dwordx4 v3, s[48:51], s57 offen offset:0 nt lds
    s_mul_i32 s57, s14, 1
    s_add_u32 s57, s57, s15
    s_mov_b32 m0, 32768
    s_waitcnt vmcnt(25)
    buffer_load_dwordx4 v3, s[48:51], s57 offen offset:1024 nt lds
    s_mov_b32 s57, 393472
    s_mov_b32 s58, 589056
    s_mov_b32 m0, 108544
L_dma_20:
    s_waitcnt vmcnt(25)
    buffer_load_dwordx4 v5, s[32:35], s57 offen offset:0 nt lds
    s_waitcnt vmcnt(25)
    buffer_load_dwordx4 v6, s[32:35], s58 offen offset:1024 nt lds
    s_add_u32 s57, s57, 24576
    s_add_u32 s58, s58, 24576
    s_add_u32 m0, m0, 2048
    s_cmp_lg_u32 m0, 124928
    s_cbranch_scc1 L_dma_20
L_skip_16:
    s_waitcnt lgkmcnt(0)
    s_cmp_eq_u32 s30, 7
    s_cbranch_scc0 L_skip_21
    v_and_b32 v60, 31, v0
    v_cmp_gt_u32 s[64:65], 20, v60
    v_min_u32 v60, 19, v60
    v_lshrrev_b32 v35, 5, v0
    v_lshlrev_b32 v35, 2, v35
    v_add_u32 v35, 159936, v35
    v_lshl_add_u32 v35, v60, 3, v35
    s_mul_i32 s66, s53, 6400
    s_add_u32 s66, s66, s62
    s_add_u32 s66, s66, 57344
    s_add_u32 s67, s66, 6144
    s_lshl_b32 s57, s54, 3
    v_lshrrev_b32 v34, 5, v0
    v_lshlrev_b32 v34, 2, v34
    v_add_u32 v34, s57, v34
    v_and_b32 v60, 31, v0
    v_mov_b32 v61, 0x7f000000
    v_cmp_ne_u32 vcc, 31, v60
    s_nop 1
    v_cndmask_b32 v34, v34, v61, vcc
    v_mov_b32 v61, 0x3f803f80
    s_waitcnt vmcnt(0)
    ds_write_b32 v35, v28
    s_waitcnt lgkmcnt(0)
L_skip_21:
    s_waitcnt vmcnt(36)
    s_barrier
    ds_read_b128 v[88:91], v8 offset:49152
    ds_read_b128 v[92:95], v9 offset:49152
    s_cmp_eq_u32 s30, 6
    s_cbranch_scc0 L_skip_22
    s_mul_i32 s57, s14, 2
    s_mov_b32 m0, 34816
    s_waitcnt vmcnt(25)
    buffer_load_dwordx4 v3, s[48:51], s57 offen offset:0 nt lds
    s_mul_i32 s57, s14, 2
    s_add_u32 s57, s57, s15
    s_mov_b32 m0, 34816
    s_waitcnt vmcnt(25)
    buffer_load_dwordx4 v3, s[48:51], s57 offen offset:1024 nt lds
    s_mov_b32 s57, 786432
    s_mov_b32 s58, 982016
    s_mov_b32 m0, 124928
L_dma_23:
    s_waitcnt vmcnt(25)
    buffer_load_dwordx4 v5, s[32:35], s57 offen offset:0 nt lds
    s_waitcnt vmcnt(25)
    buffer_load_dwordx4 v6, s[32:35], s58 offen offset:1024 nt lds
    s_add_u32 s57, s57, 24576
    s_add_u32 s58, s58, 24576
    s_add_u32 m0, m0, 2048
    s_cmp_lg_u32 m0, 141312
    s_cbranch_scc1 L_dma_23
L_skip_22:
    s_waitcnt lgkmcnt(0)
    s_cmp_lt_u32 s30, 4
    s_cbranch_scc0 L_skip_24
    s_mov_b64 exec, 0
    s_cmp_eq_u32 s30, 1
    s_cbranch_scc1 L_pad1
    s_cmp_eq_u32 s30, 2
    s_cbranch_scc1 L_pad2
    s_cmp_eq_u32 s30, 3
    s_cbranch_scc1 L_pad3
    s_branch L_pad0
L_padback:
    s_mov_b64 exec, -1
L_skip_24:
    s_cmp_eq_u32 s30, 7
    s_cbranch_scc0 L_skip_25
    v_cndmask_b32 v29, 0, v28, s[64:65]
    v_dot2_f32_bf16 v27, v29, v61, 0
    v_dot2_f32_bf16 v62, v29, v29, 0
    v_lshlrev_b32 v2, 16, v28
    v_and_b32 v3, 0xffff0000, v28
    s_cmp_eq_u32 s55, 0
    v_permlane32_swap_b32 v27, v62
    v_add_f32 v27, v27, v62
    s_nop 1
    v_add_f32_dpp v27, v27, v27 row_ror:8 row_mask:0xf bank_mask:0xf
    s_nop 1
    v_add_f32_dpp v27, v27, v27 row_ror:4 row_mask:0xf bank_mask:0xf
    s_nop 1
    v_add_f32_dpp v27, v27, v27 row_ror:2 row_mask:0xf bank_mask:0xf
    s_nop 1
    v_add_f32_dpp v27, v27, v27 row_ror:1 row_mask:0xf bank_mask:0xf
    s_nop 1
    v_add_f32_dpp v27, v27, v27 row_bcast:15 row_mask:0xa bank_mask:0xf
    v_min_u32 v27, -2, v27
    s_cbranch_scc1 L_gs_26
    buffer_store_dword v27, v34, s[40:43], s67 offen
L_gb_27:
L_skip_25:
    s_cmp_lt_u32 s30, 6
    s_cbranch_scc0 L_skip_28
    s_lshr_b32 s57, s30, 1
    s_mul_i32 s57, s57, 1024
    s_and_b32 s58, s30, 1
    s_lshl_b32 s58, s58, 6
    s_add_u32 s57, s57, s58
    v_lshrrev_b32 v18, 5, v0
    v_mul_u32_u24 v18, 6144, v18
    v_bfe_u32 v60, v0, 3, 1
    v_mul_u32_u24 v60, 3072, v60
    v_add_u32 v18, v60, v18
    v_bfe_u32 v60, v0, 4, 1
    v_lshl_add_u32 v18, v60, 9, v18
    v_bfe_u32 v60, v0, 2, 1
    v_lshl_add_u32 v18, v60, 7, v18
    v_and_b32 v60, 3, v0
    v_lshl_add_u32 v18, v60, 3, v18
    v_add_u32 v18, s57, v18
    v_bfe_u32 v19, v0, 4, 1
    v_mul_u32_u24 v19, 3072, v19
    v_bfe_u32 v60, v0, 3, 1
    v_lshl_add_u32 v19, v60, 9, v19
    v_bfe_u32 v60, v0, 2, 1
    v_lshl_add_u32 v19, v60, 7, v19
    v_and_b32 v60, 3, v0
    v_lshl_add_u32 v19, v60, 3, v19
    v_add_u32 v19, s57, v19
    v_add_u32 v19, 24576, v19
    ds_read_b64_tr_b16 v[36:37], v18 offset:0
    ds_read_b64_tr_b16 v[38:39], v18 offset:256
    ds_read_b64_tr_b16 v[40:41], v18 offset:12288
    ds_read_b64_tr_b16 v[42:43], v18 offset:12544
    ds_read_b64_tr_b16 v[44:45], v19 offset:0
    ds_read_b64_tr_b16 v[46:47], v19 offset:256
    ds_read_b64_tr_b16 v[48:49], v18 offset:32
    ds_read_b64_tr_b16 v[50:51], v18 offset:288
    ds_read_b64_tr_b16 v[52:53], v18 offset:12320
    ds_read_b64_tr_b16 v[54:55], v18 offset:12576
    ds_read_b64_tr_b16 v[56:57], v19 offset:32
    ds_read_b64_tr_b16 v[58:59], v19 offset:288
    v_lshrrev_b32 v32, 4, v0
    v_lshlrev_b32 v32, 5, v32
    v_bfe_u32 v60, v0, 1, 1
    v_lshl_add_u32 v32, v60, 4, v32
    v_and_b32 v60, 1, v0
    v_mul_u32_u24 v60, 192, v60
    v_add_u32 v32, v60, v32
    v_add_u32 v32, 159936, v32
    v_lshrrev_b32 v33, 4, v0
    v_lshlrev_b32 v33, 4, v33
    v_bfe_u32 v60, v0, 1, 1
    v_lshl_add_u32 v33, v60, 3, v33
    v_and_b32 v60, 1, v0
    v_mul_u32_u24 v60, 192, v60
    v_add_u32 v33, v60, v33
    v_add_u32 v33, 160064, v33
    v_mov_b64 v[24:25], 0
    v_mov_b64 v[26:27], 0
    v_mov_b64 v[28:29], 0
    v_mov_b64 v[30:31], 0
    s_lshr_b32 s57, s54, 1
    s_lshl_b32 s57, s57, 2
    s_and_b32 s58, s54, 1
    s_add_u32 s57, s57, s58
    s_lshl_b32 s57, s57, 4
    s_lshl_b32 s58, s30, 9
    s_add_u32 s57, s57, s58
    v_bfe_u32 v34, v0, 4, 1
    v_lshlrev_b32 v34, 8, v34
    v_bfe_u32 v60, v0, 1, 1
    v_lshl_add_u32 v34, v60, 5, v34
    v_bfe_u32 v60, v0, 2, 2
    v_lshl_add_u32 v34, v60, 2, v34
    v_lshrrev_b32 v60, 5, v0
    v_mul_u32_u24 v60, 3072, v60
    v_add_u32 v34, v60, v34
    v_and_b32 v60, 1, v0
    v_lshl_add_u32 v34, v60, 30, v34
    v_add_u32 v34, s57, v34
    s_mul_i32 s59, s53, 6400
    s_add_u32 s59, s59, s62
    s_add_u32 s59, s59, 57344
    s_add_u32 s60, s59, 6144
    ds_read_b128 v[12:15], v32
    ds_read_b64 v[16:17], v33
    s_waitcnt lgkmcnt(1)
    v_smfmac_f32_16x16x64_bf16 v[24:27], v[12:15], v[36:43], v1
    v_smfmac_f32_16x16x64_bf16 v[28:31], v[12:15], v[48:55], v1
    s_waitcnt lgkmcnt(0)
    v_smfmac_f32_16x16x32_bf16 v[24:27], v[16:17], v[44:47], v1
    v_smfmac_f32_16x16x32_bf16 v[28:31], v[16:17], v[56:59], v1
    s_cmp_eq_u32 s55, 0
    s_nop 5
    v_add_f32 v12, v24, v26
    s_nop 1
    v_add_f32_dpp v12, v28, v30 quad_perm:[0,1,2,3] row_mask:0x2 bank_mask:0xf
    s_nop 1
    v_add_f32_dpp v12, v25, v27 quad_perm:[0,1,2,3] row_mask:0x4 bank_mask:0xf
    s_nop 1
    v_add_f32_dpp v12, v29, v31 quad_perm:[0,1,2,3] row_mask:0x8 bank_mask:0xf
    s_nop 1
    v_mov_b32_dpp v13, v12 row_shl:1 row_mask:0xf bank_mask:0xf bound_ctrl:0
    v_cvt_pk_bf16_f32 v12, v12, v13
    v_min_u32 v12, -2, v12
    s_cbranch_scc1 L_gs_29
    buffer_store_dword v12, v34, s[40:43], s59 offen
L_gb_30:
L_skip_28:
    s_cmp_eq_u32 s30, 5
    s_cbranch_scc0 L_skip_31
    global_load_dword v2, v3, s[26:27] sc1
L_skip_31:
    s_waitcnt vmcnt(36)
    s_barrier
    ds_read_b128 v[96:99], v8 offset:0
    ds_read_b128 v[100:103], v9 offset:0
    s_cmp_eq_u32 s30, 6
    s_cbranch_scc0 L_skip_32
    s_mul_i32 s57, s14, 3
    s_mov_b32 m0, 36864
    s_waitcnt vmcnt(25)
    buffer_load_dwordx4 v3, s[48:51], s57 offen offset:0 nt lds
    s_mul_i32 s57, s14, 3
    s_add_u32 s57, s57, s15
    s_mov_b32 m0, 36864
    s_waitcnt vmcnt(25)
    buffer_load_dwordx4 v3, s[48:51], s57 offen offset:1024 nt lds
    s_mov_b32 s57, 786560
    s_mov_b32 s58, 982144
    s_mov_b32 m0, 141312
L_dma_33:
    s_waitcnt vmcnt(25)
    buffer_load_dwordx4 v5, s[32:35], s57 offen offset:0 nt lds
    s_waitcnt vmcnt(25)
    buffer_load_dwordx4 v6, s[32:35], s58 offen offset:1024 nt lds
    s_add_u32 s57, s57, 24576
    s_add_u32 s58, s58, 24576
    s_add_u32 m0, m0, 2048
    s_cmp_lg_u32 m0, 157696
    s_cbranch_scc1 L_dma_33
L_skip_32:
    s_waitcnt lgkmcnt(0)
    s_waitcnt vmcnt(36)
    s_barrier
    ds_read_b128 v[104:107], v8 offset:16384
    ds_read_b128 v[108:111], v9 offset:16384
    s_cmp_eq_u32 s30, 6
    s_cbranch_scc0 L_skip_34
    s_mul_i32 s57, s14, 4
    s_mov_b32 m0, 38912
    s_waitcnt vmcnt(25)
    buffer_load_dwordx4 v3, s[48:51], s57 offen offset:0 nt lds
    s_mul_i32 s57, s14, 4
    s_add_u32 s57, s57, s15
    s_mov_b32 m0, 38912
    s_waitcnt vmcnt(25)
    buffer_load_dwordx4 v3, s[48:51], s57 offen offset:1024 nt lds
    s_mov_b32 s57, 786688
    s_mov_b32 s58, 982272
    s_mov_b32 m0, 92160
L_dma_35:
    s_waitcnt vmcnt(25)
    buffer_load_dwordx4 v5, s[32:35], s57 offen offset:0 nt lds
    s_waitcnt vmcnt(25)
    buffer_load_dwordx4 v6, s[32:35], s58 offen offset:1024 nt lds
    s_add_u32 s57, s57, 24576
    s_add_u32 s58, s58, 24576
    s_add_u32 m0, m0, 2048
    s_cmp_lg_u32 m0, 108544
    s_cbranch_scc1 L_dma_35
L_skip_34:
    s_waitcnt lgkmcnt(0)
    s_cmp_lg_u32 s30, 6
    s_cbranch_scc0 L_skip_36
    s_waitcnt vmcnt(0)
L_skip_36:
    s_waitcnt vmcnt(36)
    s_barrier
    ds_read_b128 v[112:115], v8 offset:32768
    ds_read_b128 v[116:119], v9 offset:32768
    s_cmp_eq_u32 s30, 6
    s_cbranch_scc0 L_skip_37
    s_mul_i32 s57, s14, 5
    s_mov_b32 m0, 40960
    s_waitcnt vmcnt(25)
    buffer_load_dwordx4 v3, s[48:51], s57 offen offset:0 nt lds
    s_mul_i32 s57, s14, 5
    s_add_u32 s57, s57, s15
    s_mov_b32 m0, 40960
    s_waitcnt vmcnt(25)
    buffer_load_dwordx4 v3, s[48:51], s57 offen offset:1024 nt lds
    s_mov_b32 s57, 1179648
    s_mov_b32 s58, 1375232
    s_mov_b32 m0, 108544
L_dma_38:
    s_waitcnt vmcnt(25)
    buffer_load_dwordx4 v5, s[32:35], s57 offen offset:0 nt lds
    s_waitcnt vmcnt(25)
    buffer_load_dwordx4 v6, s[32:35], s58 offen offset:1024 nt lds
    s_add_u32 s57, s57, 24576
    s_add_u32 s58, s58, 24576
    s_add_u32 m0, m0, 2048
    s_cmp_lg_u32 m0, 124928
    s_cbranch_scc1 L_dma_38
L_skip_37:
    s_waitcnt lgkmcnt(0)
    s_cmp_eq_u32 s30, 5
    s_cbranch_scc0 L_skip_39
L_cw_40:
    v_readlane_b32 s57, v2, s31
    s_cmp_eq_u32 s57, 0
    s_cbranch_scc1 L_cr_41
    s_sub_u32 s57, s57, 1
    s_cmp_eq_u32 s57, s63
    s_cselect_b32 s64, 1, 0
    s_cbranch_scc0 L_far_42
    s_lshl_b32 s57, s52, 2
    s_add_u32 s57, s57, s72
    s_mov_b64 exec, 1
    buffer_store_dword v0, v0, s[40:43], s57 offen offset:0
    s_mov_b64 exec, -1
L_fb_43:
L_skip_39:
    s_waitcnt vmcnt(36)
    s_barrier
    ds_read_b128 v[120:123], v8 offset:49152
    ds_read_b128 v[124:127], v9 offset:49152
    s_cmp_eq_u32 s30, 6
    s_cbranch_scc0 L_skip_44
    s_mul_i32 s57, s14, 6
    s_mov_b32 m0, 43008
    s_waitcnt vmcnt(25)
    buffer_load_dwordx4 v3, s[48:51], s57 offen offset:0 nt lds
    s_mul_i32 s57, s14, 6
    s_add_u32 s57, s57, s15
    s_mov_b32 m0, 43008
    s_waitcnt vmcnt(25)
    buffer_load_dwordx4 v3, s[48:51], s57 offen offset:1024 nt lds
    s_mov_b32 s57, 1179776
    s_mov_b32 s58, 1375360
    s_mov_b32 m0, 124928
L_dma_45:
    s_waitcnt vmcnt(25)
    buffer_load_dwordx4 v5, s[32:35], s57 offen offset:0 nt lds
    s_waitcnt vmcnt(25)
    buffer_load_dwordx4 v6, s[32:35], s58 offen offset:1024 nt lds
    s_add_u32 s57, s57, 24576
    s_add_u32 s58, s58, 24576
    s_add_u32 m0, m0, 2048
    s_cmp_lg_u32 m0, 141312
    s_cbranch_scc1 L_dma_45
L_skip_44:
    s_waitcnt lgkmcnt(0)
    s_waitcnt vmcnt(36)
    s_barrier
    ds_read_b128 v[128:131], v8 offset:0
    ds_read_b128 v[132:135], v9 offset:0
    s_cmp_eq_u32 s30, 6
    s_cbranch_scc0 L_skip_46
    s_mul_i32 s57, s14, 7
    s_mov_b32 m0, 45056
    s_waitcnt vmcnt(25)
    buffer_load_dwordx4 v3, s[48:51], s57 offen offset:0 nt lds
    s_mul_i32 s57, s14, 7
    s_add_u32 s57, s57, s15
    s_mov_b32 m0, 45056
    s_waitcnt vmcnt(25)
    buffer_load_dwordx4 v3, s[48:51], s57 offen offset:1024 nt lds
    s_mov_b32 s57, 1179904
    s_mov_b32 s58, 1375488
    s_mov_b32 m0, 141312
L_dma_47:
    s_waitcnt vmcnt(25)
    buffer_load_dwordx4 v5, s[32:35], s57 offen offset:0 nt lds
    s_waitcnt vmcnt(25)
    buffer_load_dwordx4 v6, s[32:35], s58 offen offset:1024 nt lds
    s_add_u32 s57, s57, 24576
    s_add_u32 s58, s58, 24576
    s_add_u32 m0, m0, 2048
    s_cmp_lg_u32 m0, 157696
    s_cbranch_scc1 L_dma_47
L_skip_46:
    s_waitcnt lgkmcnt(0)
    s_cmp_eq_u32 s30, 5
    s_cbranch_scc0 L_skip_48
    v_lshlrev_b32 v24, 2, v0
    buffer_load_dword v2, v24, s[40:43], s72 offen sc1
L_skip_48:
    s_waitcnt vmcnt(36)
    s_barrier
    ds_read_b128 v[136:139], v8 offset:16384
    ds_read_b128 v[140:143], v9 offset:16384
    s_cmp_eq_u32 s30, 6
    s_cbranch_scc0 L_skip_49
    s_mul_i32 s57, s14, 8
    s_mov_b32 m0, 47104
    s_waitcnt vmcnt(25)
    buffer_load_dwordx4 v3, s[48:51], s57 offen offset:0 nt lds
    s_mul_i32 s57, s14, 8
    s_add_u32 s57, s57, s15
    s_mov_b32 m0, 47104
    s_waitcnt vmcnt(25)
    buffer_load_dwordx4 v3, s[48:51], s57 offen offset:1024 nt lds
    s_mov_b32 s57, 0
    s_mov_b32 s58, 392192
    s_mov_b32 m0, 92160
L_dma_50:
    s_waitcnt vmcnt(25)
    buffer_load_dwordx4 v7, s[36:39], s57 offen offset:0 nt lds
    s_waitcnt vmcnt(25)
    buffer_load_dwordx4 v7, s[36:39], s58 offen offset:1024 nt lds
    s_add_u32 s57, s57, 24576
    s_add_u32 s58, s58, 24576
    s_add_u32 m0, m0, 2048
    s_cmp_lg_u32 m0, 108544
    s_cbranch_scc1 L_dma_50
L_skip_49:
    s_waitcnt lgkmcnt(0)
    s_waitcnt vmcnt(36)
    s_barrier
    ds_read_b128 v[144:147], v8 offset:32768
    ds_read_b128 v[148:151], v9 offset:32768
    s_cmp_eq_u32 s30, 6
    s_cbranch_scc0 L_skip_51
    s_mul_i32 s57, s14, 9
    s_mov_b32 m0, 49152
    s_waitcnt vmcnt(25)
    buffer_load_dwordx4 v3, s[48:51], s57 offen offset:0 nt lds
    s_mul_i32 s57, s14, 9
    s_add_u32 s57, s57, s15
    s_mov_b32 m0, 49152
    s_waitcnt vmcnt(25)
    buffer_load_dwordx4 v3, s[48:51], s57 offen offset:1024 nt lds
    s_mov_b32 s57, 128
    s_mov_b32 s58, 392320
    s_mov_b32 m0, 108544
L_dma_52:
    s_waitcnt vmcnt(25)
    buffer_load_dwordx4 v7, s[36:39], s57 offen offset:0 nt lds
    s_waitcnt vmcnt(25)
    buffer_load_dwordx4 v7, s[36:39], s58 offen offset:1024 nt lds
    s_add_u32 s57, s57, 24576
    s_add_u32 s58, s58, 24576
    s_add_u32 m0, m0, 2048
    s_cmp_lg_u32 m0, 124928
    s_cbranch_scc1 L_dma_52
L_skip_51:
    s_waitcnt lgkmcnt(0)
    s_cmp_eq_u32 s30, 5
    s_cbranch_scc0 L_skip_53
L_cw_54:
    s_waitcnt vmcnt(0)
    v_cmp_ne_u32 vcc, -1, v2
    s_mov_b32 s57, 0
    s_cmp_eq_u32 s64, 0
    s_cbranch_scc1 L_cd_56
    s_cmp_lg_u32 vcc_hi, 0
    s_cbranch_scc1 L_cd_56
    s_cmp_lg_u32 vcc_lo, -1
    s_cbranch_scc1 L_cr_55
    s_mov_b32 s57, 1
L_cd_56:
    v_mov_b32 v37, 159872
    v_mov_b32 v38, s57
    ds_write_b32 v37, v38
    s_waitcnt lgkmcnt(0)
L_skip_53:
    s_waitcnt vmcnt(36)
    s_barrier
    ds_read_b128 v[152:155], v8 offset:49152
    ds_read_b128 v[156:159], v9 offset:49152
    s_cmp_eq_u32 s30, 6
    s_cbranch_scc0 L_skip_57
    s_mul_i32 s57, s14, 10
    s_mov_b32 m0, 51200
    s_waitcnt vmcnt(25)
    buffer_load_dwordx4 v3, s[48:51], s57 offen offset:0 nt lds
    s_mul_i32 s57, s14, 10
    s_add_u32 s57, s57, s15
    s_mov_b32 m0, 51200
    s_waitcnt vmcnt(25)
    buffer_load_dwordx4 v3, s[48:51], s57 offen offset:1024 nt lds
    s_mov_b32 s57, 256
    s_mov_b32 s58, 392448
    s_mov_b32 m0, 124928
L_dma_58:
    s_waitcnt vmcnt(25)
    buffer_load_dwordx4 v7, s[36:39], s57 offen offset:0 nt lds
    s_waitcnt vmcnt(25)
    buffer_load_dwordx4 v7, s[36:39], s58 offen offset:1024 nt lds
    s_add_u32 s57, s57, 24576
    s_add_u32 s58, s58, 24576
    s_add_u32 m0, m0, 2048
    s_cmp_lg_u32 m0, 141312
    s_cbranch_scc1 L_dma_58
L_skip_57:
    s_waitcnt lgkmcnt(0)
    v_lshrrev_b32 v8, 2, v0
    v_lshlrev_b32 v8, 7, v8
    v_bfe_u32 v60, v0, 3, 2
    v_lshl_add_u32 v8, v60, 5, v8
    v_and_b32 v60, 3, v0
    v_lshl_add_u32 v8, v60, 3, v8
    v_add_u32 v8, s61, v8
    v_xor_b32 v9, 32, v8
    v_xor_b32 v10, 64, v8
    v_xor_b32 v11, 96, v8
    v_mov_b32 v41, 159872
    ds_read_b32 v42, v41
    s_waitcnt lgkmcnt(0)
    v_readfirstlane_b32 s55, v42
    s_cmp_eq_u32 s55, 0
    s_cbranch_scc1 L_spread
L_spread_back:
    s_cmp_eq_u32 s30, 5
    s_cbranch_scc0 L_skip_70
    s_cmp_eq_u32 s52, 31
    s_cbranch_scc0 L_skip_71
    s_lshl_b32 s57, s31, 5
    v_mov_b32 v16, s57
    v_mov_b32 v12, 1
    s_mov_b64 exec, 0x1
    global_store_dword v16, v12, s[26:27] offset:4 sc1
    s_mov_b64 exec, -1
L_skip_71:
L_skip_70:
    s_cmp_eq_u32 s30, 4
    s_cbranch_scc0 L_skip_72
    s_mul_i32 s59, s53, 6400
    s_add_u32 s59, s59, s62
    s_add_u32 s59, s59, 57344
    s_add_u32 s60, s59, 6144
    v_lshlrev_b32 v16, 4, v0
    s_add_u32 s60, s59, 3072
    s_mov_b32 m0, 79872
    s_nop 0
    buffer_load_dwordx4 v16, s[40:43], s59 offen offset:0 sc1 nt lds
    buffer_load_dwordx4 v16, s[40:43], s59 offen offset:1024 sc1 nt lds
    buffer_load_dwordx4 v16, s[40:43], s59 offen offset:2048 sc1 nt lds
    s_mov_b32 m0, 82944
    s_nop 0
    buffer_load_dwordx4 v16, s[40:43], s60 offen offset:0 sc1 nt lds
    buffer_load_dwordx4 v16, s[40:43], s60 offen offset:1024 sc1 nt lds
    buffer_load_dwordx4 v16, s[40:43], s60 offen offset:2048 sc1 nt lds
    s_mov_b64 exec, 0xf
    buffer_load_dwordx4 v16, s[40:43], s60 offen offset:3072 sc1 nt lds
    s_mov_b64 exec, -1
L_skip_72:
    s_waitcnt vmcnt(36)
    s_barrier
    ds_read_b64_tr_b16 v[160:161], v8 offset:0
    ds_read_b64_tr_b16 v[168:169], v9 offset:0
    ds_read_b64_tr_b16 v[176:177], v10 offset:0
    ds_read_b64_tr_b16 v[184:185], v11 offset:0
    s_cmp_eq_u32 s30, 6
    s_cbranch_scc0 L_skip_73
    s_mul_i32 s57, s14, 11
    s_mov_b32 m0, 53248
    s_waitcnt vmcnt(25)
    buffer_load_dwordx4 v3, s[48:51], s57 offen offset:0 nt lds
    s_mul_i32 s57, s14, 11
    s_add_u32 s57, s57, s15
    s_mov_b32 m0, 53248
    s_waitcnt vmcnt(25)
    buffer_load_dwordx4 v3, s[48:51], s57 offen offset:1024 nt lds
    s_mov_b32 s57, 196608
    s_mov_b32 s58, 588800
    s_mov_b32 m0, 141312
L_dma_74:
    s_waitcnt vmcnt(25)
    buffer_load_dwordx4 v7, s[36:39], s57 offen offset:0 nt lds
    s_waitcnt vmcnt(25)
    buffer_load_dwordx4 v7, s[36:39], s58 offen offset:1024 nt lds
    s_add_u32 s57, s57, 24576
    s_add_u32 s58, s58, 24576
    s_add_u32 m0, m0, 2048
    s_cmp_lg_u32 m0, 157696
    s_cbranch_scc1 L_dma_74
L_skip_73:
    s_waitcnt lgkmcnt(0)
    s_waitcnt vmcnt(36)
    s_barrier
    ds_read_b64_tr_b16 v[192:193], v8 offset:16384
    ds_read_b64_tr_b16 v[200:201], v9 offset:16384
    ds_read_b64_tr_b16 v[208:209], v10 offset:16384
    ds_read_b64_tr_b16 v[216:217], v11 offset:16384
    s_cmp_eq_u32 s30, 6
    s_cbranch_scc0 L_skip_75
    s_mul_i32 s57, s14, 12
    s_mov_b32 m0, 55296
    s_waitcnt vmcnt(25)
    buffer_load_dwordx4 v3, s[48:51], s57 offen offset:0 nt lds
    s_mul_i32 s57, s14, 12
    s_add_u32 s57, s57, s15
    s_mov_b32 m0, 55296
    s_waitcnt vmcnt(25)
    buffer_load_dwordx4 v3, s[48:51], s57 offen offset:1024 nt lds
    s_mov_b32 s57, 196736
    s_mov_b32 s58, 588928
    s_mov_b32 m0, 92160
L_dma_76:
    s_waitcnt vmcnt(25)
    buffer_load_dwordx4 v7, s[36:39], s57 offen offset:0 nt lds
    s_waitcnt vmcnt(25)
    buffer_load_dwordx4 v7, s[36:39], s58 offen offset:1024 nt lds
    s_add_u32 s57, s57, 24576
    s_add_u32 s58, s58, 24576
    s_add_u32 m0, m0, 2048
    s_cmp_lg_u32 m0, 108544
    s_cbranch_scc1 L_dma_76
L_skip_75:
    s_waitcnt lgkmcnt(0)
    s_cmp_eq_u32 s30, 4
    s_cbranch_scc0 L_skip_77
    s_waitcnt vmcnt(0)
L_skip_77:
    s_waitcnt vmcnt(36)
    s_barrier
    ds_read_b64_tr_b16 v[224:225], v8 offset:32768
    ds_read_b64_tr_b16 v[232:233], v9 offset:32768
    ds_read_b64_tr_b16 v[240:241], v10 offset:32768
    ds_read_b64_tr_b16 v[248:249], v11 offset:32768
    s_cmp_eq_u32 s30, 6
    s_cbranch_scc0 L_skip_78
    s_mul_i32 s57, s14, 13
    s_mov_b32 m0, 57344
    s_nop 0
    buffer_load_dwordx4 v3, s[48:51], s57 offen offset:0 nt lds
    s_mul_i32 s57, s14, 13
    s_add_u32 s57, s57, s15
    s_mov_b32 m0, 57344
    s_nop 0
    buffer_load_dwordx4 v3, s[48:51], s57 offen offset:1024 nt lds
    s_mov_b32 s57, 196864
    s_mov_b32 s58, 589056
    s_mov_b32 m0, 108544
L_dma_79:
    s_nop 0
    buffer_load_dwordx4 v7, s[36:39], s57 offen offset:0 nt lds
    buffer_load_dwordx4 v7, s[36:39], s58 offen offset:1024 nt lds
    s_add_u32 s57, s57, 24576
    s_add_u32 s58, s58, 24576
    s_add_u32 m0, m0, 2048
    s_cmp_lg_u32 m0, 124928
    s_cbranch_scc1 L_dma_79
L_skip_78:
    s_waitcnt lgkmcnt(0)
    v_lshlrev_b32 v40, 4, v0
    v_add_u32 v40, 79872, v40
    ds_read_b128 v[12:15], v40 offset:3072
    ds_read_b128 v[16:19], v40 offset:4096
    ds_read_b128 v[20:23], v40 offset:5120
    v_mov_b64 v[24:25], 0
    v_mov_b64 v[26:27], 0
    v_mov_b64 v[28:29], 0
    v_mov_b64 v[30:31], 0
    v_mov_b64 v[32:33], 0
    v_mov_b64 v[34:35], 0
    v_mov_b64 v[36:37], 0
    v_mov_b64 v[38:39], 0
    s_waitcnt lgkmcnt(0)
    v_smfmac_f32_16x16x64_bf16 v[24:27], v[12:15], v[64:71], v1
    v_smfmac_f32_16x16x64_bf16 v[24:27], v[16:19], v[72:79], v1
    v_smfmac_f32_16x16x64_bf16 v[24:27], v[20:23], v[80:87], v1
    v_smfmac_f32_16x16x64_bf16 v[32:35], v[12:15], v[112:119], v1
    v_smfmac_f32_16x16x64_bf16 v[32:35], v[16:19], v[120:127], v1
    v_smfmac_f32_16x16x64_bf16 v[32:35], v[20:23], v[128:135], v1
    v_smfmac_f32_16x16x64_bf16 v[28:31], v[12:15], v[88:95], v1
    v_smfmac_f32_16x16x64_bf16 v[28:31], v[16:19], v[96:103], v1
    v_smfmac_f32_16x16x64_bf16 v[28:31], v[20:23], v[104:111], v1
    v_smfmac_f32_16x16x64_bf16 v[36:39], v[12:15], v[136:143], v1
    s_nop 0
    v_pk_add_f32 v[24:25], v[24:25], v[26:27]
    v_add_f32 v24, v24, v25
    v_smfmac_f32_16x16x64_bf16 v[36:39], v[16:19], v[144:151], v1
    v_pk_add_f32 v[32:33], v[32:33], v[34:35]
    v_add_f32 v32, v32, v33
    v_smfmac_f32_16x16x64_bf16 v[36:39], v[20:23], v[152:159], v1
    s_nop 0
    v_permlane32_swap_b32 v24, v32
    v_add_f32 v24, v24, v32
    v_pk_add_f32 v[28:29], v[28:29], v[30:31]
    v_add_f32 v28, v28, v29
    s_nop 2
    v_pk_add_f32 v[36:37], v[36:37], v[38:39]
    v_add_f32 v36, v36, v37
    s_nop 1
    v_permlane32_swap_b32 v28, v36
    v_add_f32 v28, v28, v36
    s_nop 1
    v_permlane16_swap_b32 v24, v28
    v_add_f32 v6, v24, v28
    s_waitcnt vmcnt(36)
    s_barrier
    ds_read_b64_tr_b16 v[162:163], v8 offset:49152
    ds_read_b64_tr_b16 v[170:171], v9 offset:49152
    ds_read_b64_tr_b16 v[178:179], v10 offset:49152
    ds_read_b64_tr_b16 v[186:187], v11 offset:49152
    s_cmp_eq_u32 s30, 6
    s_cbranch_scc0 L_skip_80
    s_mul_i32 s57, s14, 14
    s_mov_b32 m0, 59392
    s_nop 0
    buffer_load_dwordx4 v3, s[48:51], s57 offen offset:0 nt lds
    s_mul_i32 s57, s14, 14
    s_add_u32 s57, s57, s15
    s_mov_b32 m0, 59392
    s_nop 0
    buffer_load_dwordx4 v3, s[48:51], s57 offen offset:1024 nt lds
    s_mov_b32 s57, 786432
    s_mov_b32 s58, 1178624
    s_mov_b32 m0, 124928
L_dma_81:
    s_nop 0
    buffer_load_dwordx4 v7, s[36:39], s57 offen offset:0 nt lds
    buffer_load_dwordx4 v7, s[36:39], s58 offen offset:1024 nt lds
    s_add_u32 s57, s57, 24576
    s_add_u32 s58, s58, 24576
    s_add_u32 m0, m0, 2048
    s_cmp_lg_u32 m0, 141312
    s_cbranch_scc1 L_dma_81
L_skip_80:
    s_waitcnt lgkmcnt(0)
    v_and_b32 v41, 7, v0
    v_lshlrev_b32 v41, 3, v41
    v_add_u32 v41, 86016, v41
    ds_read_b128 v[12:15], v40 offset:0
    ds_read_b128 v[16:19], v40 offset:1024
    ds_read_b128 v[20:23], v40 offset:2048
    ds_read_b64 v[52:53], v41
    v_mov_b64 v[24:25], 0
    v_mov_b64 v[26:27], 0
    v_mov_b64 v[28:29], 0
    v_mov_b64 v[30:31], 0
    v_mov_b64 v[32:33], 0
    v_mov_b64 v[34:35], 0
    v_mov_b64 v[36:37], 0
    v_mov_b64 v[38:39], 0
    s_waitcnt lgkmcnt(0)
    v_smfmac_f32_16x16x64_bf16 v[24:27], v[12:15], v[64:71], v1
    v_add_f32_dpp v52, v52, v52 row_ror:4 row_mask:0xf bank_mask:0xf
    v_add_f32_dpp v53, v53, v53 row_ror:4 row_mask:0xf bank_mask:0xf
    v_smfmac_f32_16x16x64_bf16 v[24:27], v[16:19], v[72:79], v1
    v_add_f32_dpp v52, v52, v52 row_ror:2 row_mask:0xf bank_mask:0xf
    v_add_f32_dpp v53, v53, v53 row_ror:2 row_mask:0xf bank_mask:0xf
    v_smfmac_f32_16x16x64_bf16 v[24:27], v[20:23], v[80:87], v1
    v_add_f32_dpp v52, v52, v52 row_ror:1 row_mask:0xf bank_mask:0xf
    v_add_f32_dpp v53, v53, v53 row_ror:1 row_mask:0xf bank_mask:0xf
    v_smfmac_f32_16x16x64_bf16 v[32:35], v[12:15], v[112:119], v1
    v_mul_f32 v52, 0x3acccccd, v52
    v_mul_f32 v53, 0x3acccccd, v53
    v_smfmac_f32_16x16x64_bf16 v[32:35], v[16:19], v[120:127], v1
    v_fma_f32 v53, -v52, v52, v53
    v_max_f32 v53, 0, v53
    v_smfmac_f32_16x16x64_bf16 v[32:35], v[20:23], v[128:135], v1
    v_add_f32 v53, 0x3727c5ac, v53
    v_rsq_f32 v53, v53
    v_smfmac_f32_16x16x64_bf16 v[28:31], v[12:15], v[88:95], v1
    v_mul_f32 v53, 0x3dd53b95, v53
    v_mul_f32 v52, -v52, v53
    v_smfmac_f32_16x16x64_bf16 v[28:31], v[16:19], v[96:103], v1
    v_mul_f32 v52, v52, v6
    v_smfmac_f32_16x16x64_bf16 v[28:31], v[20:23], v[104:111], v1
    v_smfmac_f32_16x16x64_bf16 v[36:39], v[12:15], v[136:143], v1
    v_pk_add_f32 v[24:25], v[24:25], v[26:27]
    v_add_f32 v24, v24, v25
    v_smfmac_f32_16x16x64_bf16 v[36:39], v[16:19], v[144:151], v1
    v_pk_add_f32 v[32:33], v[32:33], v[34:35]
    v_add_f32 v32, v32, v33
    v_smfmac_f32_16x16x64_bf16 v[36:39], v[20:23], v[152:159], v1
    s_nop 0
    v_permlane32_swap_b32 v24, v32
    v_add_f32 v24, v24, v32
    v_pk_add_f32 v[28:29], v[28:29], v[30:31]
    v_add_f32 v28, v28, v29
    s_nop 2
    v_pk_add_f32 v[36:37], v[36:37], v[38:39]
    v_add_f32 v36, v36, v37
    s_nop 1
    v_permlane32_swap_b32 v28, v36
    v_add_f32 v28, v28, v36
    s_nop 1
    v_permlane16_swap_b32 v24, v28
    v_add_f32 v24, v24, v28
    v_fma_f32 v24, v24, v53, v52
    s_mov_b32 vcc_lo, 0x55555555
    s_mov_b32 vcc_hi, 0x55555555
    v_max_f32_dpp v20, v24, v24 row_ror:8 row_mask:0xf bank_mask:0xf
    s_nop 1
    v_max_f32_dpp v20, v20, v20 row_ror:4 row_mask:0xf bank_mask:0xf
    s_nop 1
    v_max_f32_dpp v20, v20, v20 row_ror:2 row_mask:0xf bank_mask:0xf
    s_nop 1
    v_max_f32_dpp v20, v20, v20 row_ror:1 row_mask:0xf bank_mask:0xf
    s_nop 1
    v_max_f32_dpp v20, v20, v20 row_bcast:15 row_mask:0xa bank_mask:0xf
    s_nop 1
    v_max_f32_dpp v20, v20, v20 row_bcast:31 row_mask:0xc bank_mask:0xf
    s_nop 0
    v_readlane_b32 s57, v20, 63
    s_nop 1
    v_subrev_f32 v24, s57, v24
    v_exp_f32 v22, v24
    s_nop 1
    v_mov_b32_dpp v23, v22 row_shl:1 row_mask:0xf bank_mask:0xf bound_ctrl:0
    v_cvt_pk_bf16_f32 v23, v22, v23
    v_cndmask_b32 v12, 0, v23, vcc
    v_add_f32_dpp v21, v22, v22 row_ror:8 row_mask:0xf bank_mask:0xf
    s_nop 0
    v_mov_b32_dpp v13, v12 row_shl:4 row_mask:0xf bank_mask:0xf bound_ctrl:0
    v_mov_b32_dpp v14, v12 row_shl:8 row_mask:0xf bank_mask:0xf bound_ctrl:0
    v_mov_b32_dpp v15, v12 row_shl:12 row_mask:0xf bank_mask:0xf bound_ctrl:0
    v_add_f32_dpp v21, v21, v21 row_ror:4 row_mask:0xf bank_mask:0xf
    v_mov_b32_dpp v16, v12 row_shr:1 row_mask:0xf bank_mask:0xf bound_ctrl:0
    v_mov_b64 v[40:41], 0
    v_mov_b64 v[42:43], 0
    v_mov_b64 v[44:45], 0
    v_mov_b64 v[46:47], 0
    v_mov_b64 v[48:49], 0
    v_mov_b64 v[50:51], 0
    v_mov_b64 v[52:53], 0
    v_mov_b64 v[54:55], 0
    v_mov_b64 v[56:57], 0
    v_mov_b64 v[58:59], 0
    v_mov_b64 v[60:61], 0
    v_mov_b64 v[62:63], 0
    s_lshl_b32 s58, s30, 3
    s_add_u32 s58, s58, 159744
    v_mov_b32 v38, s58
    v_lshlrev_b32 v37, 3, v0
    v_add_u32 v37, 157696, v37
    v_cmp_eq_u32 vcc, 63, v0
    s_nop 1
    v_cndmask_b32 v37, v37, v38, vcc
    v_add_f32_dpp v21, v21, v21 row_ror:2 row_mask:0xf bank_mask:0xf
    v_mov_b32_dpp v17, v12 row_shl:3 row_mask:0xf bank_mask:0xf bound_ctrl:0
    s_nop 0
    v_add_f32_dpp v21, v21, v21 row_ror:1 row_mask:0xf bank_mask:0xf
    v_mov_b32_dpp v18, v12 row_shl:7 row_mask:0xf bank_mask:0xf bound_ctrl:0
    s_nop 0
    v_add_f32_dpp v21, v21, v21 row_bcast:15 row_mask:0xa bank_mask:0xf
    v_mov_b32_dpp v19, v12 row_shl:11 row_mask:0xf bank_mask:0xf bound_ctrl:0
    s_nop 0
    v_add_f32_dpp v21, v21, v21 row_bcast:31 row_mask:0xc bank_mask:0xf
    ds_write_b64 v37, v[20:21]
    s_lshl_b32 s57, s30, 12
    v_lshlrev_b32 v36, 4, v0
    v_add_u32 v36, s57, v36
    v_add_u32 v36, 92160, v36
    s_waitcnt lgkmcnt(0)
    s_waitcnt vmcnt(36)
    s_barrier
    ds_read_b64_tr_b16 v[194:195], v8 offset:0
    ds_read_b64_tr_b16 v[202:203], v9 offset:0
    ds_read_b64_tr_b16 v[210:211], v10 offset:0
    ds_read_b64_tr_b16 v[218:219], v11 offset:0
    s_cmp_eq_u32 s30, 6
    s_cbranch_scc0 L_skip_82
    s_mul_i32 s57, s14, 15
    s_mov_b32 m0, 61440
    s_waitcnt vmcnt(25)
    buffer_load_dwordx4 v3, s[48:51], s57 offen offset:0 nt lds
    s_mul_i32 s57, s14, 15
    s_add_u32 s57, s57, s15
    s_mov_b32 m0, 61440
    s_waitcnt vmcnt(25)
    buffer_load_dwordx4 v3, s[48:51], s57 offen offset:1024 nt lds
    s_mov_b32 s57, 786560
    s_mov_b32 s58, 1178752
    s_mov_b32 m0, 141312
L_dma_83:
    s_waitcnt vmcnt(25)
    buffer_load_dwordx4 v7, s[36:39], s57 offen offset:0 nt lds
    s_waitcnt vmcnt(25)
    buffer_load_dwordx4 v7, s[36:39], s58 offen offset:1024 nt lds
    s_add_u32 s57, s57, 24576
    s_add_u32 s58, s58, 24576
    s_add_u32 m0, m0, 2048
    s_cmp_lg_u32 m0, 157696
    s_cbranch_scc1 L_dma_83
L_skip_82:
    s_waitcnt lgkmcnt(0)
    s_cmp_lt_u32 s30, 2
    s_cbranch_scc0 L_skip_84
    s_mul_i32 s57, s30, 48
    v_add_u32 v38, s57, v0
    v_bfe_u32 v2, v38, 5, 2
    v_lshlrev_b32 v2, 10, v2
    v_and_b32 v39, 15, v38
    v_lshl_add_u32 v2, v39, 4, v2
    v_bfe_u32 v39, v38, 4, 1
    v_lshl_add_u32 v2, v39, 3, v2
    v_add_u32 v2, 92160, v2
    s_lshr_b32 s57, s54, 1
    s_lshl_b32 s57, s57, 2
    s_and_b32 s58, s54, 1
    s_add_u32 s57, s57, s58
    s_lshl_b32 s58, s57, 4
    s_lshl_b32 s57, s57, 3
    v_bfe_u32 v3, v0, 3, 2
    v_lshlrev_b32 v3, 8, v3
    v_bfe_u32 v39, v0, 2, 1
    v_lshl_add_u32 v3, v39, 5, v3
    v_and_b32 v39, 3, v0
    v_lshl_add_u32 v3, v39, 2, v3
    v_add_u32 v3, s58, v3
    v_bfe_u32 v38, v0, 3, 1
    v_lshlrev_b32 v38, 8, v38
    v_bfe_u32 v39, v0, 1, 1
    v_lshl_add_u32 v38, v39, 7, v38
    v_bfe_u32 v39, v0, 2, 1
    v_lshl_add_u32 v38, v39, 4, v38
    v_and_b32 v39, 1, v0
    v_lshl_add_u32 v38, v39, 2, v38
    v_add_u32 v38, s57, v38
    v_add_u32 v38, 1024, v38
    v_cmp_gt_u32 vcc, 32, v0
    s_nop 1
    v_cndmask_b32 v3, v38, v3, vcc
    s_lshl_b32 s57, s53, 1
    s_add_u32 s57, s57, s30
    s_mul_i32 s57, s57, 1536
    s_add_u32 s57, s57, s62
    v_add_u32 v3, s57, v3
    v_mov_b32 v38, 0x7f000000
    v_cmp_le_u32 vcc, 48, v0
    s_nop 1
    v_cndmask_b32 v3, v3, v38, vcc
    v_and_b32 v4, 7, v0
    v_lshlrev_b32 v4, 3, v4
    v_add_u32 v4, 159744, v4
    s_lshl_b32 s57, s53, 3
    s_add_u32 s57, s57, s54
    s_lshl_b32 s57, s57, 2
    s_add_u32 s57, s57, s62
    s_add_u32 s57, s57, 55808
    v_add_u32 v23, s30, v0
    v_lshlrev_b32 v23, 24, v23
L_mw_85:
    ds_read_b64 v[38:39], v4 offset:0
    s_waitcnt lgkmcnt(0)
    v_max_f32_dpp v37, v38, v38 row_ror:4 row_mask:0xf bank_mask:0xf
    s_cmp_eq_u32 s55, 0
    s_nop 0
    v_max_f32_dpp v37, v37, v37 row_ror:2 row_mask:0xf bank_mask:0xf
    s_nop 1
    v_max_f32_dpp v37, v37, v37 row_ror:1 row_mask:0xf bank_mask:0xf
    v_sub_f32 v38, v38, v37
    v_exp_f32 v38, v38
    s_nop 0
    v_mul_f32 v39, v38, v39
    s_nop 1
    v_add_f32_dpp v39, v39, v39 row_ror:4 row_mask:0xf bank_mask:0xf
    s_nop 1
    v_add_f32_dpp v39, v39, v39 row_ror:2 row_mask:0xf bank_mask:0xf
    s_nop 1
    v_add_f32_dpp v39, v39, v39 row_ror:1 row_mask:0xf bank_mask:0xf
    v_rcp_f32 v21, v39
    v_log_f32 v22, v39
    v_mul_f32 v38, v38, v21
    v_add_f32 v22, v22, v37
    v_min_u32 v22, -2, v22
    s_cbranch_scc1 L_gs_87
    buffer_store_dword v22, v23, s[40:43], s57 offen
L_gb_88:
    v_readlane_b32 s64, v38, 0
    v_readlane_b32 s65, v38, 1
    v_readlane_b32 s66, v38, 2
    v_readlane_b32 s67, v38, 3
    v_readlane_b32 s68, v38, 4
    v_readlane_b32 s69, v38, 5
    v_readlane_b32 s70, v38, 6
    v_readlane_b32 s71, v38, 7
L_skip_84:
    s_waitcnt vmcnt(36)
    s_barrier
    ds_read_b64_tr_b16 v[226:227], v8 offset:16384
    ds_read_b64_tr_b16 v[234:235], v9 offset:16384
    ds_read_b64_tr_b16 v[242:243], v10 offset:16384
    ds_read_b64_tr_b16 v[250:251], v11 offset:16384
    s_cmp_eq_u32 s30, 6
    s_cbranch_scc0 L_skip_89
    s_mov_b32 s57, 786688
    s_mov_b32 s58, 1178880
    s_mov_b32 m0, 92160
L_dma_90:
    s_waitcnt vmcnt(25)
    buffer_load_dwordx4 v7, s[36:39], s57 offen offset:0 nt lds
    s_waitcnt vmcnt(25)
    buffer_load_dwordx4 v7, s[36:39], s58 offen offset:1024 nt lds
    s_add_u32 s57, s57, 24576
    s_add_u32 s58, s58, 24576
    s_add_u32 m0, m0, 2048
    s_cmp_lg_u32 m0, 108544
    s_cbranch_scc1 L_dma_90
L_skip_89:
    s_waitcnt lgkmcnt(0)
    s_cmp_eq_u32 s30, 5
    s_cbranch_scc0 L_skip_91
    global_load_dword v2, v3, s[26:27] offset:4 sc1
L_skip_91:
    s_waitcnt vmcnt(34)
    s_barrier
    ds_read_b64_tr_b16 v[164:165], v8 offset:32768
    ds_read_b64_tr_b16 v[172:173], v9 offset:32768
    ds_read_b64_tr_b16 v[180:181], v10 offset:32768
    ds_read_b64_tr_b16 v[188:189], v11 offset:32768
    s_cmp_eq_u32 s30, 6
    s_cbranch_scc0 L_skip_92
    s_mov_b32 s57, 983040
    s_mov_b32 s58, 1375232
    s_mov_b32 m0, 108544
L_dma_93:
    s_waitcnt vmcnt(25)
    buffer_load_dwordx4 v7, s[36:39], s57 offen offset:0 nt lds
    s_waitcnt vmcnt(25)
    buffer_load_dwordx4 v7, s[36:39], s58 offen offset:1024 nt lds
    s_add_u32 s57, s57, 24576
    s_add_u32 s58, s58, 24576
    s_add_u32 m0, m0, 2048
    s_cmp_lg_u32 m0, 124928
    s_cbranch_scc1 L_dma_93
L_skip_92:
    s_waitcnt lgkmcnt(0)
    s_waitcnt vmcnt(32)
    s_barrier
    ds_read_b64_tr_b16 v[196:197], v8 offset:49152
    ds_read_b64_tr_b16 v[204:205], v9 offset:49152
    ds_read_b64_tr_b16 v[212:213], v10 offset:49152
    ds_read_b64_tr_b16 v[220:221], v11 offset:49152
    s_cmp_eq_u32 s30, 6
    s_cbranch_scc0 L_skip_94
    s_mov_b32 s57, 983168
    s_mov_b32 s58, 1375360
    s_mov_b32 m0, 124928
L_dma_95:
    s_waitcnt vmcnt(25)
    buffer_load_dwordx4 v7, s[36:39], s57 offen offset:0 nt lds
    s_waitcnt vmcnt(25)
    buffer_load_dwordx4 v7, s[36:39], s58 offen offset:1024 nt lds
    s_add_u32 s57, s57, 24576
    s_add_u32 s58, s58, 24576
    s_add_u32 m0, m0, 2048
    s_cmp_lg_u32 m0, 141312
    s_cbranch_scc1 L_dma_95
L_skip_94:
    s_waitcnt lgkmcnt(0)
    s_cmp_eq_u32 s30, 5
    s_cbranch_scc0 L_skip_96
L_cw_97:
    s_waitcnt vmcnt(0)
    v_cmp_eq_u32 vcc, 0, v2
    s_cbranch_vccnz L_cr_98
L_skip_96:
    s_cmp_eq_u32 s30, 2
    s_cbranch_scc0 L_skip_99
    s_mul_i32 s57, s52, 1792
    s_add_u32 s57, s57, s62
    v_min_u32 v37, 13, v0
    v_lshlrev_b32 v37, 7, v37
    buffer_load_dword v37, v37, s[40:43], s57 offen sc1 nt
L_skip_99:
    s_waitcnt vmcnt(32)
    s_barrier
    ds_read_b64_tr_b16 v[228:229], v8 offset:0
    ds_read_b64_tr_b16 v[236:237], v9 offset:0
    ds_read_b64_tr_b16 v[244:245], v10 offset:0
    ds_read_b64_tr_b16 v[252:253], v11 offset:0
    s_cmp_eq_u32 s30, 6
    s_cbranch_scc0 L_skip_100
    s_mov_b32 s57, 983296
    s_mov_b32 s58, 1375488
    s_mov_b32 m0, 141312
L_dma_101:
    s_waitcnt vmcnt(25)
    buffer_load_dwordx4 v7, s[36:39], s57 offen offset:0 nt lds
    s_waitcnt vmcnt(25)
    buffer_load_dwordx4 v7, s[36:39], s58 offen offset:1024 nt lds
    s_add_u32 s57, s57, 24576
    s_add_u32 s58, s58, 24576
    s_add_u32 m0, m0, 2048
    s_cmp_lg_u32 m0, 157696
    s_cbranch_scc1 L_dma_101
L_skip_100:
    s_waitcnt lgkmcnt(0)
    s_branch L_tail
.p2align 10
L_tail:
L_pad0:
    s_cbranch_execz L_pad4
    s_waitcnt vmcnt(32)
    s_barrier
    ds_read_b64_tr_b16 v[166:167], v8 offset:16384
    ds_read_b64_tr_b16 v[174:175], v9 offset:16384
    ds_read_b64_tr_b16 v[182:183], v10 offset:16384
    ds_read_b64_tr_b16 v[190:191], v11 offset:16384
    s_waitcnt lgkmcnt(0)
    v_smfmac_f32_16x16x64_bf16 v[40:43], v[12:15], v[160:167], v1
    v_smfmac_f32_16x16x64_bf16 v[40:43], v[16:19], v[168:175], v1
    v_smfmac_f32_16x16x64_bf16 v[44:47], v[12:15], v[176:183], v1
    v_smfmac_f32_16x16x64_bf16 v[44:47], v[16:19], v[184:191], v1
    s_cmp_eq_u32 s30, 6
    s_cbranch_scc0 L_skip_102
    s_mul_i32 s57, s14, 16
    s_add_u32 s58, s57, s15
    s_mov_b32 m0, 63488
L_dma_103:
    s_waitcnt vmcnt(33)
    buffer_load_dwordx4 v3, s[48:51], s57 offen offset:0 nt lds
    s_waitcnt vmcnt(33)
    buffer_load_dwordx4 v3, s[48:51], s58 offen offset:1024 nt lds
    s_add_u32 s57, s57, s14
    s_add_u32 s58, s58, s14
    s_add_u32 m0, m0, 2048
    s_cmp_lg_u32 m0, 71680
    s_cbranch_scc1 L_dma_103
    s_mul_i32 s57, s14, 20
    s_add_u32 s58, s57, s15
    s_mov_b32 m0, 71680
L_dma_104:
    s_waitcnt vmcnt(33)
    buffer_load_dwordx4 v3, s[48:51], s57 offen offset:0 nt lds
    s_waitcnt vmcnt(33)
    buffer_load_dwordx4 v3, s[48:51], s58 offen offset:1024 nt lds
    s_add_u32 s57, s57, s14
    s_add_u32 s58, s58, s14
    s_add_u32 m0, m0, 2048
    s_cmp_lg_u32 m0, 79872
    s_cbranch_scc1 L_dma_104
L_skip_102:
    s_nop 3
    v_pk_add_f32 v[24:25], v[40:41], v[42:43]
    s_nop 0
    v_pk_add_f32 v[26:27], v[44:45], v[46:47]
    s_waitcnt vmcnt(32)
    s_barrier
    ds_read_b64_tr_b16 v[198:199], v8 offset:32768
    ds_read_b64_tr_b16 v[206:207], v9 offset:32768
    ds_read_b64_tr_b16 v[214:215], v10 offset:32768
    ds_read_b64_tr_b16 v[222:223], v11 offset:32768
    s_waitcnt lgkmcnt(0)
    v_smfmac_f32_16x16x64_bf16 v[48:51], v[12:15], v[192:199], v1
    v_smfmac_f32_16x16x64_bf16 v[48:51], v[16:19], v[200:207], v1
    v_smfmac_f32_16x16x64_bf16 v[52:55], v[12:15], v[208:215], v1
    v_smfmac_f32_16x16x64_bf16 v[52:55], v[16:19], v[216:223], v1
    s_nop 5
    v_pk_add_f32 v[28:29], v[48:49], v[50:51]
    s_nop 0
    v_pk_add_f32 v[30:31], v[52:53], v[54:55]
    ds_write_b128 v36, v[24:27] offset:0
    ds_write_b128 v36, v[28:31] offset:1024
    s_waitcnt vmcnt(16)
    s_barrier
    ds_read_b64_tr_b16 v[230:231], v8 offset:49152
    ds_read_b64_tr_b16 v[238:239], v9 offset:49152
    ds_read_b64_tr_b16 v[246:247], v10 offset:49152
    ds_read_b64_tr_b16 v[254:255], v11 offset:49152
    s_waitcnt lgkmcnt(0)
    v_smfmac_f32_16x16x64_bf16 v[56:59], v[12:15], v[224:231], v1
    v_smfmac_f32_16x16x64_bf16 v[56:59], v[16:19], v[232:239], v1
    v_smfmac_f32_16x16x64_bf16 v[60:63], v[12:15], v[240:247], v1
    v_smfmac_f32_16x16x64_bf16 v[60:63], v[16:19], v[248:255], v1
    s_setprio 0
    s_cmp_lt_u32 s30, 2
    s_mov_b64 exec, 0xffff
    s_nop 2
    v_pk_add_f32 v[32:33], v[56:57], v[58:59]
    s_nop 0
    v_pk_add_f32 v[34:35], v[60:61], v[62:63]
    ds_write_b128 v36, v[32:35] offset:2048
    s_mov_b64 exec, -1
    s_cbranch_scc1 L_comb_0
    s_waitcnt lgkmcnt(0)
    s_barrier
L_comb_0b:
    s_cmp_eq_u32 s30, 6
    s_cbranch_scc0 L_skip_107
L_pad1:
    s_cbranch_execz L_pad5
    s_waitcnt vmcnt(0)
L_skip_107:
    s_barrier
    s_cmp_lt_u32 s3, 20
    s_cbranch_scc0 L_typeB_0
    s_lshr_b32 s57, s30, 1
    s_lshl_b32 s57, s57, 5
    s_add_u32 s57, s57, s62
    s_add_u32 s59, s57, 55808
    v_and_b32 v5, 7, v0
    v_lshlrev_b32 v5, 2, v5
    v_lshrrev_b32 v22, 4, v0
    v_lshlrev_b32 v22, 3, v22
    buffer_load_dword v18, v5, s[40:43], s59 offen sc1
    buffer_load_dwordx2 v[20:21], v22, s[40:43], s59 offen sc1
    s_mul_i32 s57, s30, 6144
    v_lshrrev_b32 v7, 2, v0
    v_lshlrev_b32 v7, 6, v7
    v_bfe_u32 v60, v0, 4, 1
    v_lshl_add_u32 v7, v60, 5, v7
    v_and_b32 v60, 3, v0
    v_lshl_add_u32 v7, v60, 3, v7
    v_add_u32 v7, s57, v7
    v_add_u32 v7, 30720, v7
    v_xor_b32 v8, 32, v7
    s_mul_i32 s60, s30, 1536
    s_add_u32 s60, s60, s62
    s_add_u32 s60, s60, 0
    v_lshlrev_b32 v9, 4, v0
    v_lshlrev_b32 v10, 3, v0
    ds_read_b64_tr_b16 v[36:37], v7 offset:0
    ds_read_b64_tr_b16 v[38:39], v7 offset:1024
    ds_read_b64_tr_b16 v[40:41], v7 offset:2048
    ds_read_b64_tr_b16 v[42:43], v7 offset:3072
    ds_read_b64_tr_b16 v[44:45], v7 offset:4096
    ds_read_b64_tr_b16 v[46:47], v7 offset:5120
    ds_read_b64_tr_b16 v[48:49], v8 offset:0
    ds_read_b64_tr_b16 v[50:51], v8 offset:1024
    ds_read_b64_tr_b16 v[52:53], v8 offset:2048
    ds_read_b64_tr_b16 v[54:55], v8 offset:3072
    ds_read_b64_tr_b16 v[56:57], v8 offset:4096
    ds_read_b64_tr_b16 v[58:59], v8 offset:5120
    v_mov_b64 v[24:25], 0
    v_mov_b64 v[26:27], 0
    v_mov_b64 v[28:29], 0
    v_mov_b64 v[30:31], 0
    s_lshl_b32 s57, s30, 8
    v_lshlrev_b32 v11, 2, v0
    v_add_u32 v11, s57, v11
    v_add_u32 v11, 157696, v11
    v_lshlrev_b32 v32, 2, v0
    v_add_u32 v32, 157696, v32
    s_mul_i32 s58, s31, 2560
    s_lshl_b32 s57, s3, 7
    s_add_u32 s58, s58, s57
    s_add_u32 s58, s58, 1343488
    v_and_b32 v33, 15, v0
    v_lshlrev_b32 v33, 2, v33
    v_lshrrev_b32 v60, 5, v0
    v_lshl_add_u32 v33, v60, 6, v33
    v_bfe_u32 v60, v0, 4, 1
    v_lshl_add_u32 v33, v60, 30, v33
    s_lshl_b32 s74, s3, 2
    s_add_u32 s74, s74, s62
    s_add_u32 s74, s74, 56064
    s_xor_b32 s75, s30, 3
    v_add_u32 v34, s75, v0
    v_lshlrev_b32 v34, 24, v34
    s_waitcnt vmcnt(0)
L_pw_108:
    v_max3_u32 v19, v18, v20, v21
    v_cmp_eq_u32 vcc, -1, v19
    s_cbranch_vccnz L_pr_109
    buffer_load_dwordx4 v[12:15], v9, s[40:43], s60 offen sc1
    buffer_load_dwordx2 v[16:17], v10, s[40:43], s60 offen offset:1024 sc1
    v_max_f32_dpp v19, v18, v18 row_ror:4 row_mask:0xf bank_mask:0xf
    s_nop 1
    v_max_f32_dpp v19, v19, v19 row_ror:2 row_mask:0xf bank_mask:0xf
    s_nop 1
    v_max_f32_dpp v19, v19, v19 row_ror:1 row_mask:0xf bank_mask:0xf
    v_sub_f32 v18, v18, v19
    v_sub_f32 v20, v20, v19
    v_sub_f32 v21, v21, v19
    v_exp_f32 v18, v18
    v_exp_f32 v20, v20
    v_exp_f32 v21, v21
    v_add_f32_dpp v18, v18, v18 row_ror:4 row_mask:0xf bank_mask:0xf
    s_nop 1
    v_add_f32_dpp v18, v18, v18 row_ror:2 row_mask:0xf bank_mask:0xf
    s_nop 1
    v_add_f32_dpp v18, v18, v18 row_ror:1 row_mask:0xf bank_mask:0xf
L_pad2:
    s_cbranch_execz L_pad6
    v_rcp_f32 v18, v18
    s_nop 0
    v_mul_f32 v20, v20, v18
    v_mul_f32 v21, v21, v18
    s_waitcnt lgkmcnt(0)
    s_waitcnt vmcnt(0)
L_pw_110:
    v_max3_u32 v19, v12, v13, v14
    v_max3_u32 v19, v19, v15, v16
    v_max_u32 v19, v19, v17
    v_cmp_eq_u32 vcc, -1, v19
    s_cbranch_vccnz L_pr_111
    v_smfmac_f32_16x16x64_bf16 v[24:27], v[12:15], v[36:43], v1
    v_smfmac_f32_16x16x64_bf16 v[28:31], v[12:15], v[48:55], v1
    v_smfmac_f32_16x16x32_bf16 v[24:27], v[16:17], v[44:47], v1
    v_smfmac_f32_16x16x32_bf16 v[28:31], v[16:17], v[56:59], v1
    s_nop 6
    v_pk_add_f32 v[24:25], v[24:25], v[26:27]
    v_pk_add_f32 v[28:29], v[28:29], v[30:31]
    v_mul_f32 v24, v24, v20
    v_mul_f32 v28, v28, v20
    v_fmac_f32 v24, v25, v21
    v_fmac_f32 v28, v29, v21
    s_nop 1
    v_permlane32_swap_b32 v24, v28
    v_add_f32 v24, v24, v28
    ds_write_b32 v11, v24
    s_cmp_eq_u32 s30, 2
    s_cbranch_scc1 L_fin_112
    s_cmp_eq_u32 s55, 0
    s_waitcnt lgkmcnt(0)
    s_barrier
    s_cbranch_scc1 L_gs_114
    buffer_store_dword v0, v34, s[40:43], s74 offen
L_gb_115:
L_finb_113:
    s_sub_u32 s57, s30, 5
    s_cmp_lt_u32 s57, 2
    s_cbranch_scc0 L_skip_116
    s_sub_u32 s60, s30, 5
    s_mul_i32 s59, s60, 6144
    s_add_u32 s59, s59, 79872
    s_mov_b32 s44, s20
    s_mov_b32 s45, s21
    s_mov_b32 s46, 1966080
    s_mov_b32 s47, 0x20000
    s_mul_i32 s57, s31, 245760
    s_lshl_b32 s58, s3, 6
    s_add_u32 s57, s57, s58
    s_lshl_b32 s58, s60, 5
    s_add_u32 s57, s57, s58
    v_lshrrev_b32 v5, 1, v0
    v_mul_u32_u24 v5, 1280, v5
    v_and_b32 v60, 1, v0
    v_lshl_add_u32 v5, v60, 4, v5
    v_add_u32 v5, s57, v5
    s_add_u32 m0, s59, 0
    s_mov_b32 s57, 0
    buffer_load_dwordx4 v5, s[44:47], s57 offen nt lds
    s_add_u32 m0, s59, 1024
    s_mov_b32 s57, 40960
    buffer_load_dwordx4 v5, s[44:47], s57 offen nt lds
    s_add_u32 m0, s59, 2048
    s_mov_b32 s57, 81920
    buffer_load_dwordx4 v5, s[44:47], s57 offen nt lds
    s_add_u32 m0, s59, 3072
    s_mov_b32 s57, 122880
    buffer_load_dwordx4 v5, s[44:47], s57 offen nt lds
    s_add_u32 m0, s59, 4096
    s_mov_b32 s57, 163840
    buffer_load_dwordx4 v5, s[44:47], s57 offen nt lds
    s_add_u32 m0, s59, 5120
    s_mov_b32 s57, 204800
    buffer_load_dwordx4 v5, s[44:47], s57 offen nt lds
    s_mul_i32 s57, s31, 384
    v_lshlrev_b32 v5, 1, v0
    v_add_u32 v5, s57, v5
    global_load_ushort v8, v5, s[18:19] offset:0
    global_load_ushort v9, v5, s[18:19] offset:128
    global_load_ushort v10, v5, s[18:19] offset:256
    v_lshlrev_b32 v11, 4, v0
    v_lshrrev_b32 v7, 4, v0
    v_lshlrev_b32 v7, 8, v7
    v_bfe_u32 v60, v0, 2, 2
    v_lshl_add_u32 v7, v60, 5, v7
    v_and_b32 v60, 3, v0
    v_lshl_add_u32 v7, v60, 3, v7
    v_add_u32 v7, s59, v7
    s_mul_i32 s57, s31, 2560
L_pad3:
    s_cbranch_execz L_pad7
    s_lshl_b32 s58, s3, 7
    s_add_u32 s57, s57, s58
    s_lshl_b32 s60, s60, 6
    s_add_u32 s60, s60, s57
    s_add_u32 s60, s60, 1363968
    s_add_u32 s58, s62, 49152
    s_add_u32 s59, s58, 3072
    buffer_load_dwordx4 v[12:15], v11, s[40:43], s58 offen offset:0 sc1
    buffer_load_dwordx4 v[16:19], v11, s[40:43], s58 offen offset:1024 sc1
    buffer_load_dwordx4 v[20:23], v11, s[40:43], s58 offen offset:2048 sc1
    buffer_load_dwordx4 v[24:27], v11, s[40:43], s59 offen offset:0 sc1
    buffer_load_dwordx4 v[28:31], v11, s[40:43], s59 offen offset:1024 sc1
    buffer_load_dwordx4 v[32:35], v11, s[40:43], s59 offen offset:2048 sc1
    s_waitcnt vmcnt(0)
L_pw_117:
    v_max3_u32 v60, v12, v13, v14
    v_max3_u32 v60, v60, v15, v16
    v_max3_u32 v60, v60, v17, v18
    v_max3_u32 v60, v60, v19, v20
    v_max3_u32 v60, v60, v21, v22
    v_max3_u32 v60, v60, v23, v24
    v_max3_u32 v60, v60, v25, v26
    v_max3_u32 v60, v60, v27, v28
    v_max3_u32 v60, v60, v29, v30
    v_max3_u32 v60, v60, v31, v32
    v_max3_u32 v60, v60, v33, v34
    v_max_u32 v60, v60, v35
    v_cmp_eq_u32 vcc, -1, v60
    s_cbranch_vccnz L_pr_118
    ds_read_b64_tr_b16 v[36:37], v7 offset:0
    ds_read_b64_tr_b16 v[38:39], v7 offset:128
    ds_read_b64_tr_b16 v[40:41], v7 offset:1024
    ds_read_b64_tr_b16 v[42:43], v7 offset:1152
    ds_read_b64_tr_b16 v[44:45], v7 offset:2048
    ds_read_b64_tr_b16 v[46:47], v7 offset:2176
    ds_read_b64_tr_b16 v[48:49], v7 offset:3072
    ds_read_b64_tr_b16 v[50:51], v7 offset:3200
    ds_read_b64_tr_b16 v[52:53], v7 offset:4096
    ds_read_b64_tr_b16 v[54:55], v7 offset:4224
    ds_read_b64_tr_b16 v[56:57], v7 offset:5120
    ds_read_b64_tr_b16 v[58:59], v7 offset:5248
    v_pk_add_f32 v[12:13], v[12:13], v[14:15]
    v_pk_add_f32 v[16:17], v[16:17], v[18:19]
    v_pk_add_f32 v[12:13], v[12:13], v[16:17]
    v_add_f32 v4, v12, v13
    v_pk_add_f32 v[20:21], v[20:21], v[22:23]
    v_pk_add_f32 v[24:25], v[24:25], v[26:27]
    v_pk_add_f32 v[20:21], v[20:21], v[24:25]
    v_add_f32 v5, v20, v21
    v_pk_add_f32 v[28:29], v[28:29], v[30:31]
    v_pk_add_f32 v[32:33], v[32:33], v[34:35]
    v_pk_add_f32 v[28:29], v[28:29], v[32:33]
    v_add_f32 v7, v28, v29
    v_lshlrev_b32 v8, 16, v8
    v_lshlrev_b32 v9, 16, v9
    v_lshlrev_b32 v10, 16, v10
    v_mov_b64 v[60:61], 0
    v_mov_b64 v[62:63], 0
    s_add_u32 s58, s62, 36864
    s_add_u32 s57, s62, 55552
    s_add_u32 s59, s58, 3072
    s_mov_b32 s64, 0xbdd2d3e8
    v_and_b32 v12, 7, v0
    v_lshlrev_b32 v12, 3, v12
    buffer_load_dwordx2 v[2:3], v12, s[40:43], s57 offen sc1
    s_waitcnt lgkmcnt(0)
    s_waitcnt vmcnt(0)
L_pw_119:
    v_max_u32 v13, v2, v3
    v_cmp_eq_u32 vcc, -1, v13
    s_cbranch_vccnz L_pr_120
    buffer_load_dwordx4 v[12:15], v11, s[40:43], s58 offen offset:0 sc1
    buffer_load_dwordx4 v[16:19], v11, s[40:43], s58 offen offset:1024 sc1
    buffer_load_dwordx4 v[20:23], v11, s[40:43], s58 offen offset:2048 sc1
    buffer_load_dwordx4 v[24:27], v11, s[40:43], s59 offen offset:0 sc1
    buffer_load_dwordx4 v[28:31], v11, s[40:43], s59 offen offset:1024 sc1
    buffer_load_dwordx4 v[32:35], v11, s[40:43], s59 offen offset:2048 sc1
L_pad4:
    s_cbranch_execz L_pad8
    v_add_f32_dpp v2, v2, v2 row_ror:4 row_mask:0xf bank_mask:0xf
    v_add_f32_dpp v3, v3, v3 row_ror:4 row_mask:0xf bank_mask:0xf
    s_nop 0
    v_add_f32_dpp v2, v2, v2 row_ror:2 row_mask:0xf bank_mask:0xf
    v_add_f32_dpp v3, v3, v3 row_ror:2 row_mask:0xf bank_mask:0xf
    s_nop 0
    v_add_f32_dpp v2, v2, v2 row_ror:1 row_mask:0xf bank_mask:0xf
    v_add_f32_dpp v3, v3, v3 row_ror:1 row_mask:0xf bank_mask:0xf
    v_mul_f32 v2, 0x3acccccd, v2
    v_mul_f32 v3, 0x3acccccd, v3
    v_fma_f32 v3, -v2, v2, v3
    v_max_f32 v3, 0, v3
    v_add_f32 v3, 0x3727c5ac, v3
    v_rsq_f32 v3, v3
    s_nop 0
    v_mul_f32 v2, v2, v3
    v_fma_f32 v8, -v2, v4, v8
    v_fma_f32 v9, -v2, v5, v9
    v_fma_f32 v10, -v2, v7, v10
    v_and_b32 v7, 15, v0
    v_lshlrev_b32 v7, 2, v7
    v_lshrrev_b32 v4, 4, v0
    v_lshl_add_u32 v7, v4, 28, v7
    v_mov_b32 v2, 0xc0135761
    s_lshl_b32 s74, s3, 2
    s_add_u32 s74, s74, s62
    s_add_u32 s74, s74, 56192
    s_xor_b32 s75, s30, 6
    v_add_u32 v5, s75, v0
    v_lshlrev_b32 v5, 24, v5
    s_cmp_eq_u32 s55, 0
    s_waitcnt vmcnt(4)
    v_pk_add_f32 v[12:13], v[12:13], v[14:15]
    v_pk_add_f32 v[16:17], v[16:17], v[18:19]
    v_pk_add_f32 v[12:13], v[12:13], v[16:17]
    v_add_f32 v12, v12, v13
    s_waitcnt vmcnt(2)
    v_pk_add_f32 v[20:21], v[20:21], v[22:23]
    v_pk_add_f32 v[24:25], v[24:25], v[26:27]
    v_pk_add_f32 v[20:21], v[20:21], v[24:25]
    v_add_f32 v13, v20, v21
    s_waitcnt vmcnt(0)
    v_pk_add_f32 v[28:29], v[28:29], v[30:31]
    v_pk_add_f32 v[32:33], v[32:33], v[34:35]
    v_pk_add_f32 v[28:29], v[28:29], v[32:33]
    v_add_f32 v14, v28, v29
    v_add_f32 v15, v12, v13
    v_cmp_u_f32 vcc, v15, v14
    s_cbranch_vccnz L_hr_121
L_hk_122:
    v_fma_f32 v12, v12, v3, v8
    v_fma_f32 v13, v13, v3, v9
    v_fma_f32 v14, v14, v3, v10
    v_mul_f32 v16, v12, v12
    v_mul_f32 v17, v13, v13
    v_mul_f32 v18, v14, v14
    v_fma_f32 v16, v16, s64, v2
    v_fma_f32 v17, v17, s64, v2
    v_fma_f32 v18, v18, s64, v2
    v_mul_f32 v16, v16, v12
    v_mul_f32 v17, v17, v13
    v_mul_f32 v18, v18, v14
    v_exp_f32 v16, v16
    v_exp_f32 v17, v17
    v_exp_f32 v18, v18
    v_add_f32 v16, 1.0, v16
    v_add_f32 v17, 1.0, v17
    v_add_f32 v18, 1.0, v18
    v_rcp_f32 v16, v16
    v_rcp_f32 v17, v17
    v_rcp_f32 v18, v18
    v_mul_f32 v12, v12, v16
    v_mul_f32 v13, v13, v17
    v_mul_f32 v14, v14, v18
    v_mov_b32_dpp v16, v12 row_shl:1 row_mask:0xf bank_mask:0xf bound_ctrl:0
    v_mov_b32_dpp v17, v13 row_shl:1 row_mask:0xf bank_mask:0xf bound_ctrl:0
    v_mov_b32_dpp v18, v14 row_shl:1 row_mask:0xf bank_mask:0xf bound_ctrl:0
    v_cvt_pk_bf16_f32 v20, v12, v16
    v_cvt_pk_bf16_f32 v24, v13, v17
    v_cvt_pk_bf16_f32 v28, v14, v18
    v_mov_b32_dpp v21, v20 row_shl:4 row_mask:0xf bank_mask:0xf bound_ctrl:0
    v_mov_b32_dpp v22, v20 row_shl:8 row_mask:0xf bank_mask:0xf bound_ctrl:0
    v_mov_b32_dpp v23, v20 row_shl:12 row_mask:0xf bank_mask:0xf bound_ctrl:0
    v_mov_b32_dpp v25, v24 row_shl:4 row_mask:0xf bank_mask:0xf bound_ctrl:0
    v_mov_b32_dpp v26, v24 row_shl:8 row_mask:0xf bank_mask:0xf bound_ctrl:0
    v_mov_b32_dpp v27, v24 row_shl:12 row_mask:0xf bank_mask:0xf bound_ctrl:0
L_pad5:
    s_cbranch_execz L_pad9
    v_smfmac_f32_16x16x64_bf16 v[60:63], v[20:23], v[36:43], v1
    v_mov_b32_dpp v29, v28 row_shl:4 row_mask:0xf bank_mask:0xf bound_ctrl:0
    v_mov_b32_dpp v30, v28 row_shl:8 row_mask:0xf bank_mask:0xf bound_ctrl:0
    v_mov_b32_dpp v31, v28 row_shl:12 row_mask:0xf bank_mask:0xf bound_ctrl:0
    v_smfmac_f32_16x16x64_bf16 v[60:63], v[24:27], v[44:51], v1
    s_nop 0
    v_smfmac_f32_16x16x64_bf16 v[60:63], v[28:31], v[52:59], v1
    s_nop 7
    v_add_f32 v60, v60, v62
    v_min_u32 v60, -2, v60
    buffer_store_dword v60, v7, s[40:43], s60 offen sc1
    s_cbranch_scc1 L_gs_125
    buffer_store_dword v0, v5, s[40:43], s74 offen
L_gb_126:
L_skip_116:
    s_branch L_p1
L_typeB_0:
    s_cmp_eq_u32 s53, 3
    s_cbranch_scc0 L_p1
    s_cmp_eq_u32 s30, 7
    s_cbranch_scc1 L_w7_127
    s_cmp_lt_u32 s30, 6
    s_cbranch_scc0 L_skip_129
    s_lshr_b32 s57, s30, 1
    s_mul_i32 s57, s57, 128
    s_and_b32 s58, s30, 1
    s_lshl_b32 s58, s58, 6
    s_add_u32 s57, s57, s58
    v_lshrrev_b32 v18, 5, v0
    v_lshlrev_b32 v18, 13, v18
    v_bfe_u32 v60, v0, 3, 1
    v_lshl_add_u32 v18, v60, 12, v18
    v_bfe_u32 v60, v0, 4, 1
    v_lshl_add_u32 v18, v60, 11, v18
    v_bfe_u32 v60, v0, 2, 1
    v_mul_u32_u24 v60, 384, v60
    v_add_u32 v18, v60, v18
    v_and_b32 v60, 3, v0
    v_lshl_add_u32 v18, v60, 3, v18
    v_add_u32 v18, s57, v18
    v_add_u32 v18, 30720, v18
    v_bfe_u32 v19, v0, 4, 1
    v_lshlrev_b32 v19, 12, v19
    v_bfe_u32 v60, v0, 3, 1
    v_lshl_add_u32 v19, v60, 11, v19
    v_bfe_u32 v60, v0, 2, 1
    v_mul_u32_u24 v60, 384, v60
    v_add_u32 v19, v60, v19
    v_and_b32 v60, 3, v0
    v_lshl_add_u32 v19, v60, 3, v19
    v_add_u32 v19, s57, v19
    v_add_u32 v19, 63488, v19
    ds_read_b64_tr_b16 v[36:37], v18 offset:0
    ds_read_b64_tr_b16 v[38:39], v18 offset:1024
    ds_read_b64_tr_b16 v[40:41], v18 offset:16384
    ds_read_b64_tr_b16 v[42:43], v18 offset:17408
    ds_read_b64_tr_b16 v[44:45], v19 offset:0
    ds_read_b64_tr_b16 v[46:47], v19 offset:1024
    ds_read_b64_tr_b16 v[48:49], v18 offset:32
    ds_read_b64_tr_b16 v[50:51], v18 offset:1056
    ds_read_b64_tr_b16 v[52:53], v18 offset:16416
    ds_read_b64_tr_b16 v[54:55], v18 offset:17440
    ds_read_b64_tr_b16 v[56:57], v19 offset:32
    ds_read_b64_tr_b16 v[58:59], v19 offset:1056
    v_lshrrev_b32 v32, 4, v0
    v_lshlrev_b32 v32, 5, v32
    v_bfe_u32 v60, v0, 1, 1
    v_lshl_add_u32 v32, v60, 4, v32
    v_and_b32 v60, 1, v0
    v_mul_u32_u24 v60, 192, v60
    v_add_u32 v32, v60, v32
    v_add_u32 v32, 159936, v32
    v_lshrrev_b32 v33, 4, v0
    v_lshlrev_b32 v33, 4, v33
    v_bfe_u32 v60, v0, 1, 1
    v_lshl_add_u32 v33, v60, 3, v33
    v_and_b32 v60, 1, v0
    v_mul_u32_u24 v60, 192, v60
    v_add_u32 v33, v60, v33
    v_add_u32 v33, 160064, v33
    v_mov_b64 v[24:25], 0
    v_mov_b64 v[26:27], 0
    v_mov_b64 v[28:29], 0
    v_mov_b64 v[30:31], 0
    s_lshr_b32 s57, s30, 1
L_pad6:
    s_cbranch_execz L_pad10
    s_lshl_b32 s57, s57, 11
    s_and_b32 s58, s30, 1
    s_lshl_b32 s58, s58, 9
    s_add_u32 s57, s57, s58
    s_lshr_b32 s58, s54, 2
    s_lshl_b32 s58, s58, 10
    s_add_u32 s57, s57, s58
    s_and_b32 s58, s54, 3
    s_lshl_b32 s58, s58, 2
    s_add_u32 s57, s57, s58
    v_and_b32 v34, 31, v0
    v_lshlrev_b32 v34, 4, v34
    v_lshrrev_b32 v60, 5, v0
    v_lshl_add_u32 v34, v60, 30, v34
    v_add_u32 v34, s57, v34
    s_add_u32 s59, s62, 36864
    s_add_u32 s60, s62, 55552
    ds_read_b128 v[12:15], v32
    ds_read_b64 v[16:17], v33
    s_waitcnt lgkmcnt(1)
    v_smfmac_f32_16x16x64_bf16 v[24:27], v[12:15], v[36:43], v1
    v_smfmac_f32_16x16x64_bf16 v[28:31], v[12:15], v[48:55], v1
    s_waitcnt lgkmcnt(0)
    v_smfmac_f32_16x16x32_bf16 v[24:27], v[16:17], v[44:47], v1
    v_smfmac_f32_16x16x32_bf16 v[28:31], v[16:17], v[56:59], v1
    s_add_u32 s60, s62, 49152
    s_cmp_eq_u32 s55, 0
    s_nop 4
    v_add_f32 v12, v25, v27
    s_nop 1
    v_add_f32_dpp v12, v29, v31 quad_perm:[0,1,2,3] row_mask:0x2 bank_mask:0xf
    v_min_u32 v12, -2, v12
    s_cbranch_scc1 L_gs_130
    buffer_store_dword v12, v34, s[40:43], s60 offen
L_gb_131:
    v_mov_b64 v[24:25], 0
    v_mov_b64 v[26:27], 0
    v_mov_b64 v[28:29], 0
    v_mov_b64 v[30:31], 0
L_skip_129:
    s_cmp_lt_u32 s30, 6
    s_barrier
    s_cbranch_scc0 L_se_128
    ds_read_b128 v[12:15], v32
    ds_read_b64 v[16:17], v33
    s_waitcnt lgkmcnt(1)
    v_smfmac_f32_16x16x64_bf16 v[24:27], v[12:15], v[36:43], v1
    v_smfmac_f32_16x16x64_bf16 v[28:31], v[12:15], v[48:55], v1
    s_waitcnt lgkmcnt(0)
    v_smfmac_f32_16x16x32_bf16 v[24:27], v[16:17], v[44:47], v1
    v_smfmac_f32_16x16x32_bf16 v[28:31], v[16:17], v[56:59], v1
    s_cmp_eq_u32 s55, 0
    s_nop 5
    v_add_f32 v12, v24, v26
    s_nop 1
    v_add_f32_dpp v12, v28, v30 quad_perm:[0,1,2,3] row_mask:0x2 bank_mask:0xf
    v_min_u32 v12, -2, v12
    s_cbranch_scc1 L_gs_132
    buffer_store_dword v12, v34, s[40:43], s59 offen
L_gb_133:
L_se_128:
L_p1:
    s_cmp_eq_u32 s30, 7
    s_cbranch_scc1 L_w7_145
    s_cmp_lt_u32 s30, 6
    s_cbranch_scc0 L_skip_147
    s_lshr_b32 s57, s30, 1
    s_mul_i32 s57, s57, 1024
    s_and_b32 s58, s30, 1
    s_lshl_b32 s58, s58, 6
    s_add_u32 s57, s57, s58
    v_lshrrev_b32 v18, 5, v0
    v_mul_u32_u24 v18, 6144, v18
    v_bfe_u32 v60, v0, 3, 1
    v_mul_u32_u24 v60, 3072, v60
    v_add_u32 v18, v60, v18
    v_bfe_u32 v60, v0, 4, 1
    v_lshl_add_u32 v18, v60, 9, v18
    v_bfe_u32 v60, v0, 2, 1
    v_lshl_add_u32 v18, v60, 7, v18
    v_and_b32 v60, 3, v0
    v_lshl_add_u32 v18, v60, 3, v18
    v_add_u32 v18, s57, v18
    v_bfe_u32 v19, v0, 4, 1
    v_mul_u32_u24 v19, 3072, v19
    v_bfe_u32 v60, v0, 3, 1
    v_lshl_add_u32 v19, v60, 9, v19
    v_bfe_u32 v60, v0, 2, 1
    v_lshl_add_u32 v19, v60, 7, v19
    v_and_b32 v60, 3, v0
    v_lshl_add_u32 v19, v60, 3, v19
    v_add_u32 v19, s57, v19
    v_add_u32 v19, 24576, v19
    ds_read_b64_tr_b16 v[36:37], v18 offset:0
L_pad7:
    s_cbranch_execz L_pad11
    ds_read_b64_tr_b16 v[38:39], v18 offset:256
    ds_read_b64_tr_b16 v[40:41], v18 offset:12288
    ds_read_b64_tr_b16 v[42:43], v18 offset:12544
    ds_read_b64_tr_b16 v[44:45], v19 offset:0
    ds_read_b64_tr_b16 v[46:47], v19 offset:256
    ds_read_b64_tr_b16 v[48:49], v18 offset:32
    ds_read_b64_tr_b16 v[50:51], v18 offset:288
    ds_read_b64_tr_b16 v[52:53], v18 offset:12320
    ds_read_b64_tr_b16 v[54:55], v18 offset:12576
    ds_read_b64_tr_b16 v[56:57], v19 offset:32
    ds_read_b64_tr_b16 v[58:59], v19 offset:288
    v_lshrrev_b32 v32, 4, v0
    v_lshlrev_b32 v32, 5, v32
    v_bfe_u32 v60, v0, 1, 1
    v_lshl_add_u32 v32, v60, 4, v32
    v_and_b32 v60, 1, v0
    v_mul_u32_u24 v60, 192, v60
    v_add_u32 v32, v60, v32
    v_add_u32 v32, 159936, v32
    v_lshrrev_b32 v33, 4, v0
    v_lshlrev_b32 v33, 4, v33
    v_bfe_u32 v60, v0, 1, 1
    v_lshl_add_u32 v33, v60, 3, v33
    v_and_b32 v60, 1, v0
    v_mul_u32_u24 v60, 192, v60
    v_add_u32 v33, v60, v33
    v_add_u32 v33, 160064, v33
    v_mov_b64 v[24:25], 0
    v_mov_b64 v[26:27], 0
    v_mov_b64 v[28:29], 0
    v_mov_b64 v[30:31], 0
    s_lshr_b32 s57, s54, 1
    s_lshl_b32 s57, s57, 2
    s_and_b32 s58, s54, 1
    s_add_u32 s57, s57, s58
    s_lshl_b32 s57, s57, 4
    s_lshl_b32 s58, s30, 9
    s_add_u32 s57, s57, s58
    v_bfe_u32 v34, v0, 4, 1
    v_lshlrev_b32 v34, 8, v34
    v_bfe_u32 v60, v0, 1, 1
    v_lshl_add_u32 v34, v60, 5, v34
    v_bfe_u32 v60, v0, 2, 2
    v_lshl_add_u32 v34, v60, 2, v34
    v_lshrrev_b32 v60, 5, v0
    v_lshl_add_u32 v34, v60, 29, v34
    v_and_b32 v60, 1, v0
    v_lshl_add_u32 v34, v60, 30, v34
    v_add_u32 v34, s57, v34
    s_mul_i32 s59, s53, 3072
    s_add_u32 s59, s59, s62
    s_add_u32 s59, s59, 24576
    s_lshl_b32 s60, s53, 6
    s_add_u32 s60, s60, s62
    s_add_u32 s60, s60, 55296
L_skip_147:
    s_cmp_lt_u32 s30, 6
    s_barrier
    s_cbranch_scc0 L_se_146
    ds_read_b128 v[12:15], v32
    ds_read_b64 v[16:17], v33
    s_waitcnt lgkmcnt(1)
    v_smfmac_f32_16x16x64_bf16 v[24:27], v[12:15], v[36:43], v1
    v_smfmac_f32_16x16x64_bf16 v[28:31], v[12:15], v[48:55], v1
    s_waitcnt lgkmcnt(0)
    v_smfmac_f32_16x16x32_bf16 v[24:27], v[16:17], v[44:47], v1
    v_smfmac_f32_16x16x32_bf16 v[28:31], v[16:17], v[56:59], v1
    s_cmp_eq_u32 s55, 0
    s_nop 5
    v_add_f32 v12, v24, v26
    s_nop 1
    v_add_f32_dpp v12, v28, v30 quad_perm:[0,1,2,3] row_mask:0x2 bank_mask:0xf
    s_nop 1
    v_mov_b32_dpp v13, v12 row_shl:1 row_mask:0xf bank_mask:0xf bound_ctrl:0
    v_cvt_pk_bf16_f32 v12, v12, v13
    v_min_u32 v12, -2, v12
    s_cbranch_scc1 L_gs_148
    buffer_store_dword v12, v34, s[40:43], s59 offen
L_gb_149:
L_se_146:
    v_lshlrev_b32 v5, 4, v0
    v_add_u32 v5, 124928, v5
    s_mul_i32 s59, s53, 3072
    s_add_u32 s59, s59, s62
    s_add_u32 s59, s59, 24576
    s_lshl_b32 s60, s53, 6
    s_add_u32 s60, s60, s62
    s_add_u32 s60, s60, 55296
L_pad8:
    s_cbranch_execz L_pad12
    s_sub_u32 s57, s30, 1
    s_cmp_lt_u32 s57, 3
    s_cbranch_scc0 L_qo_171
    s_lshl_b32 s57, s57, 10
    s_add_u32 s59, s59, s57
    v_lshlrev_b32 v16, 4, v0
    v_add_u32 v17, s57, v5
    buffer_load_dwordx4 v[12:15], v16, s[40:43], s59 offen sc1
    v_mov_b64 v[24:25], 0
    v_mov_b64 v[26:27], 0
    v_mov_b64 v[28:29], 0
    v_mov_b64 v[30:31], 0
    v_mov_b64 v[32:33], 0
    v_mov_b64 v[34:35], 0
    v_mov_b64 v[36:37], 0
    v_mov_b64 v[38:39], 0
    v_mov_b64 v[40:41], 0
    v_mov_b64 v[42:43], 0
    v_mov_b64 v[44:45], 0
    v_mov_b64 v[46:47], 0
    v_mov_b64 v[48:49], 0
    v_mov_b64 v[50:51], 0
    v_mov_b64 v[52:53], 0
    v_mov_b64 v[54:55], 0
    v_mov_b64 v[56:57], 0
    v_mov_b64 v[58:59], 0
    v_mov_b64 v[60:61], 0
    v_mov_b64 v[62:63], 0
    s_lshl_b32 s58, s30, 3
    s_add_u32 s58, s58, 159808
    v_mov_b32 v11, s58
    v_lshlrev_b32 v10, 3, v0
    v_add_u32 v10, 157696, v10
    v_cmp_eq_u32 vcc, 63, v0
    s_nop 1
    v_cndmask_b32 v10, v10, v11, vcc
    s_lshl_b32 s57, s30, 12
    v_lshlrev_b32 v7, 4, v0
    v_add_u32 v7, s57, v7
    v_add_u32 v7, 92160, v7
    v_mov_b32 v11, 128000
    s_setprio 1
    s_cmp_lt_u32 s30, 4
    s_cbranch_scc0 L_skip_175
    s_setprio 2
L_skip_175:
    s_waitcnt vmcnt(0)
L_pw_173:
    v_max3_u32 v18, v12, v13, v14
    v_max_u32 v18, v18, v15
    v_cmp_eq_u32 vcc, -1, v18
    s_cbranch_vccnz L_pr_174
    ds_write_b128 v17, v[12:15]
    s_waitcnt lgkmcnt(0)
L_qb_172:
    s_barrier
    ds_read_b128 v[12:15], v5 offset:0
    ds_read_b128 v[16:19], v5 offset:1024
    ds_read_b128 v[20:23], v5 offset:2048
    ds_read_b64 v[8:9], v11
    s_cmp_lt_u32 s30, 4
    s_waitcnt lgkmcnt(3)
    v_smfmac_f32_16x16x64_bf16 v[24:27], v[12:15], v[64:71], v1
    s_waitcnt lgkmcnt(2)
    v_smfmac_f32_16x16x64_bf16 v[24:27], v[16:19], v[72:79], v1
    s_waitcnt lgkmcnt(0)
    v_smfmac_f32_16x16x64_bf16 v[24:27], v[20:23], v[80:87], v1
    v_mul_f32 v8, v8, v6
    v_smfmac_f32_16x16x64_bf16 v[32:35], v[12:15], v[112:119], v1
    v_smfmac_f32_16x16x64_bf16 v[32:35], v[16:19], v[120:127], v1
    v_smfmac_f32_16x16x64_bf16 v[32:35], v[20:23], v[128:135], v1
    v_smfmac_f32_16x16x64_bf16 v[28:31], v[12:15], v[88:95], v1
    v_smfmac_f32_16x16x64_bf16 v[28:31], v[16:19], v[96:103], v1
    v_smfmac_f32_16x16x64_bf16 v[28:31], v[20:23], v[104:111], v1
    v_smfmac_f32_16x16x64_bf16 v[36:39], v[12:15], v[136:143], v1
    v_pk_add_f32 v[24:25], v[24:25], v[26:27]
    v_add_f32 v24, v24, v25
    v_smfmac_f32_16x16x64_bf16 v[36:39], v[16:19], v[144:151], v1
    s_nop 0
    v_pk_add_f32 v[32:33], v[32:33], v[34:35]
    v_add_f32 v32, v32, v33
    v_smfmac_f32_16x16x64_bf16 v[36:39], v[20:23], v[152:159], v1
    s_cbranch_scc0 L_lo_179
    s_setprio 0
L_lo_179:
    v_permlane32_swap_b32 v24, v32
    v_add_f32 v24, v24, v32
    v_pk_add_f32 v[28:29], v[28:29], v[30:31]
    v_add_f32 v28, v28, v29
    s_nop 2
    v_pk_add_f32 v[36:37], v[36:37], v[38:39]
    v_add_f32 v36, v36, v37
    s_nop 1
    v_permlane32_swap_b32 v28, v36
    v_add_f32 v28, v28, v36
    s_nop 1
    v_permlane16_swap_b32 v24, v28
    v_add_f32 v24, v24, v28
    v_fma_f32 v24, v24, v9, v8
    s_mov_b32 vcc_lo, 0x55555555
    s_mov_b32 vcc_hi, 0x55555555
L_pad9:
    s_cbranch_execz L_pad13
    v_max_f32_dpp v20, v24, v24 row_ror:8 row_mask:0xf bank_mask:0xf
    s_nop 1
    v_max_f32_dpp v20, v20, v20 row_ror:4 row_mask:0xf bank_mask:0xf
    s_nop 1
    v_max_f32_dpp v20, v20, v20 row_ror:2 row_mask:0xf bank_mask:0xf
    s_nop 1
    v_max_f32_dpp v20, v20, v20 row_ror:1 row_mask:0xf bank_mask:0xf
    s_nop 1
    v_max_f32_dpp v20, v20, v20 row_bcast:15 row_mask:0xa bank_mask:0xf
    s_nop 1
    v_max_f32_dpp v20, v20, v20 row_bcast:31 row_mask:0xc bank_mask:0xf
    s_nop 0
    v_readlane_b32 s57, v20, 63
    s_nop 1
    v_subrev_f32 v24, s57, v24
    v_exp_f32 v22, v24
    s_nop 1
    v_mov_b32_dpp v23, v22 row_shl:1 row_mask:0xf bank_mask:0xf bound_ctrl:0
    v_cvt_pk_bf16_f32 v23, v22, v23
    v_cndmask_b32 v12, 0, v23, vcc
    v_add_f32_dpp v21, v22, v22 row_ror:8 row_mask:0xf bank_mask:0xf
    s_nop 0
    v_mov_b32_dpp v13, v12 row_shl:4 row_mask:0xf bank_mask:0xf bound_ctrl:0
    v_mov_b32_dpp v14, v12 row_shl:8 row_mask:0xf bank_mask:0xf bound_ctrl:0
    v_mov_b32_dpp v15, v12 row_shl:12 row_mask:0xf bank_mask:0xf bound_ctrl:0
    v_add_f32_dpp v21, v21, v21 row_ror:4 row_mask:0xf bank_mask:0xf
    v_mov_b32_dpp v16, v12 row_shr:1 row_mask:0xf bank_mask:0xf bound_ctrl:0
    v_smfmac_f32_16x16x64_bf16 v[40:43], v[12:15], v[160:167], v1
    v_add_f32_dpp v21, v21, v21 row_ror:2 row_mask:0xf bank_mask:0xf
    v_mov_b32_dpp v17, v12 row_shl:3 row_mask:0xf bank_mask:0xf bound_ctrl:0
    v_smfmac_f32_16x16x64_bf16 v[44:47], v[12:15], v[176:183], v1
    v_add_f32_dpp v21, v21, v21 row_ror:1 row_mask:0xf bank_mask:0xf
    v_mov_b32_dpp v18, v12 row_shl:7 row_mask:0xf bank_mask:0xf bound_ctrl:0
    v_smfmac_f32_16x16x64_bf16 v[48:51], v[12:15], v[192:199], v1
    v_add_f32_dpp v21, v21, v21 row_bcast:15 row_mask:0xa bank_mask:0xf
    v_mov_b32_dpp v19, v12 row_shl:11 row_mask:0xf bank_mask:0xf bound_ctrl:0
    v_smfmac_f32_16x16x64_bf16 v[52:55], v[12:15], v[208:215], v1
    v_add_f32_dpp v21, v21, v21 row_bcast:31 row_mask:0xc bank_mask:0xf
    ds_write_b64 v10, v[20:21]
    v_smfmac_f32_16x16x64_bf16 v[40:43], v[16:19], v[168:175], v1
    s_nop 1
    v_smfmac_f32_16x16x64_bf16 v[44:47], v[16:19], v[184:191], v1
    s_nop 1
    v_smfmac_f32_16x16x64_bf16 v[48:51], v[16:19], v[200:207], v1
    s_nop 1
    v_smfmac_f32_16x16x64_bf16 v[52:55], v[16:19], v[216:223], v1
    v_pk_add_f32 v[24:25], v[40:41], v[42:43]
    s_nop 0
    v_smfmac_f32_16x16x64_bf16 v[56:59], v[12:15], v[224:231], v1
    v_pk_add_f32 v[26:27], v[44:45], v[46:47]
    ds_write_b128 v7, v[24:27] offset:0
    v_smfmac_f32_16x16x64_bf16 v[60:63], v[12:15], v[240:247], v1
    v_pk_add_f32 v[28:29], v[48:49], v[50:51]
    s_nop 0
    v_smfmac_f32_16x16x64_bf16 v[56:59], v[16:19], v[232:239], v1
    v_pk_add_f32 v[30:31], v[52:53], v[54:55]
    ds_write_b128 v7, v[28:31] offset:1024
    v_smfmac_f32_16x16x64_bf16 v[60:63], v[16:19], v[248:255], v1
    s_cmp_lt_u32 s30, 2
    s_mov_b64 exec, 0xffff
    s_nop 2
    v_pk_add_f32 v[32:33], v[56:57], v[58:59]
    s_nop 1
    v_pk_add_f32 v[34:35], v[60:61], v[62:63]
    ds_write_b128 v7, v[32:35] offset:2048
    s_mov_b64 exec, -1
    s_setprio 0
    s_cbranch_scc1 L_comb_1
    s_waitcnt lgkmcnt(0)
    s_barrier
L_comb_1b:
    s_cmp_lt_u32 s3, 20
    s_cbranch_scc0 L_typeB_1
    s_lshr_b32 s57, s30, 1
    s_lshl_b32 s57, s57, 5
    s_add_u32 s57, s57, s62
    s_add_u32 s59, s57, 55936
    v_and_b32 v5, 7, v0
    v_lshlrev_b32 v5, 2, v5
    v_lshrrev_b32 v22, 4, v0
    v_lshlrev_b32 v22, 3, v22
L_pad10:
    s_cbranch_execz L_pad14
    buffer_load_dword v18, v5, s[40:43], s59 offen sc1
    buffer_load_dwordx2 v[20:21], v22, s[40:43], s59 offen sc1
    s_mul_i32 s57, s30, 6144
    v_lshrrev_b32 v7, 2, v0
    v_lshlrev_b32 v7, 6, v7
    v_bfe_u32 v60, v0, 4, 1
    v_lshl_add_u32 v7, v60, 5, v7
    v_and_b32 v60, 3, v0
    v_lshl_add_u32 v7, v60, 3, v7
    v_add_u32 v7, s57, v7
    v_add_u32 v7, 30720, v7
    v_xor_b32 v8, 32, v7
    s_mul_i32 s60, s30, 1536
    s_add_u32 s60, s60, s62
    s_add_u32 s60, s60, 12288
    v_lshlrev_b32 v9, 4, v0
    v_lshlrev_b32 v10, 3, v0
    ds_read_b64_tr_b16 v[36:37], v7 offset:0
    ds_read_b64_tr_b16 v[38:39], v7 offset:1024
    ds_read_b64_tr_b16 v[40:41], v7 offset:2048
    ds_read_b64_tr_b16 v[42:43], v7 offset:3072
    ds_read_b64_tr_b16 v[44:45], v7 offset:4096
    ds_read_b64_tr_b16 v[46:47], v7 offset:5120
    ds_read_b64_tr_b16 v[48:49], v8 offset:0
    ds_read_b64_tr_b16 v[50:51], v8 offset:1024
    ds_read_b64_tr_b16 v[52:53], v8 offset:2048
    ds_read_b64_tr_b16 v[54:55], v8 offset:3072
    ds_read_b64_tr_b16 v[56:57], v8 offset:4096
    ds_read_b64_tr_b16 v[58:59], v8 offset:5120
    v_mov_b64 v[24:25], 0
    v_mov_b64 v[26:27], 0
    v_mov_b64 v[28:29], 0
    v_mov_b64 v[30:31], 0
    s_lshl_b32 s57, s30, 8
    v_lshlrev_b32 v11, 2, v0
    v_add_u32 v11, s57, v11
    v_add_u32 v11, 157696, v11
    v_lshlrev_b32 v32, 2, v0
    v_add_u32 v32, 157696, v32
    s_mul_i32 s58, s31, 2560
    s_lshl_b32 s57, s3, 7
    s_add_u32 s58, s58, s57
    s_add_u32 s58, s58, 1384448
    v_and_b32 v33, 15, v0
    v_lshlrev_b32 v33, 2, v33
    v_lshrrev_b32 v60, 5, v0
    v_lshl_add_u32 v33, v60, 6, v33
    v_bfe_u32 v60, v0, 4, 1
    v_lshl_add_u32 v33, v60, 30, v33
    s_lshl_b32 s74, s3, 2
    s_add_u32 s74, s74, s62
    s_add_u32 s74, s74, 56320
    s_xor_b32 s75, s30, 3
    v_add_u32 v34, s75, v0
    v_lshlrev_b32 v34, 24, v34
    s_waitcnt vmcnt(0)
L_pw_186:
    v_max3_u32 v19, v18, v20, v21
    v_cmp_eq_u32 vcc, -1, v19
    s_cbranch_vccnz L_pr_187
    buffer_load_dwordx4 v[12:15], v9, s[40:43], s60 offen sc1
    buffer_load_dwordx2 v[16:17], v10, s[40:43], s60 offen offset:1024 sc1
    v_max_f32_dpp v19, v18, v18 row_ror:4 row_mask:0xf bank_mask:0xf
    s_nop 1
    v_max_f32_dpp v19, v19, v19 row_ror:2 row_mask:0xf bank_mask:0xf
    s_nop 1
    v_max_f32_dpp v19, v19, v19 row_ror:1 row_mask:0xf bank_mask:0xf
    v_sub_f32 v18, v18, v19
    v_sub_f32 v20, v20, v19
    v_sub_f32 v21, v21, v19
    v_exp_f32 v18, v18
    v_exp_f32 v20, v20
    v_exp_f32 v21, v21
    v_add_f32_dpp v18, v18, v18 row_ror:4 row_mask:0xf bank_mask:0xf
    s_nop 1
    v_add_f32_dpp v18, v18, v18 row_ror:2 row_mask:0xf bank_mask:0xf
    s_nop 1
    v_add_f32_dpp v18, v18, v18 row_ror:1 row_mask:0xf bank_mask:0xf
    v_rcp_f32 v18, v18
    s_nop 0
    v_mul_f32 v20, v20, v18
    v_mul_f32 v21, v21, v18
    s_waitcnt lgkmcnt(0)
    s_waitcnt vmcnt(0)
L_pw_188:
    v_max3_u32 v19, v12, v13, v14
    v_max3_u32 v19, v19, v15, v16
    v_max_u32 v19, v19, v17
    v_cmp_eq_u32 vcc, -1, v19
L_pad11:
    s_cbranch_execz L_pad15
    s_cbranch_vccnz L_pr_189
    v_smfmac_f32_16x16x64_bf16 v[24:27], v[12:15], v[36:43], v1
    v_smfmac_f32_16x16x64_bf16 v[28:31], v[12:15], v[48:55], v1
    v_smfmac_f32_16x16x32_bf16 v[24:27], v[16:17], v[44:47], v1
    v_smfmac_f32_16x16x32_bf16 v[28:31], v[16:17], v[56:59], v1
    s_nop 6
    v_pk_add_f32 v[24:25], v[24:25], v[26:27]
    v_pk_add_f32 v[28:29], v[28:29], v[30:31]
    v_mul_f32 v24, v24, v20
    v_mul_f32 v28, v28, v20
    v_fmac_f32 v24, v25, v21
    v_fmac_f32 v28, v29, v21
    s_nop 1
    v_permlane32_swap_b32 v24, v28
    v_add_f32 v24, v24, v28
    ds_write_b32 v11, v24
    s_cmp_eq_u32 s30, 2
    s_cbranch_scc1 L_fin_190
    s_cmp_eq_u32 s55, 0
    s_waitcnt lgkmcnt(0)
    s_barrier
    s_cbranch_scc1 L_gs_192
    buffer_store_dword v0, v34, s[40:43], s74 offen
L_gb_193:
L_finb_191:
    s_sub_u32 s57, s30, 5
    s_cmp_lt_u32 s57, 2
    s_cbranch_scc0 L_skip_194
    s_sub_u32 s60, s30, 5
    s_mul_i32 s59, s60, 6144
    s_add_u32 s59, s59, 79872
    s_mul_i32 s57, s31, 384
    v_lshlrev_b32 v5, 1, v0
    v_add_u32 v5, s57, v5
    global_load_ushort v8, v5, s[18:19] offset:0
    global_load_ushort v9, v5, s[18:19] offset:128
    global_load_ushort v10, v5, s[18:19] offset:256
    v_lshlrev_b32 v11, 4, v0
    v_lshrrev_b32 v7, 4, v0
    v_lshlrev_b32 v7, 8, v7
    v_bfe_u32 v60, v0, 2, 2
    v_lshl_add_u32 v7, v60, 5, v7
    v_and_b32 v60, 3, v0
    v_lshl_add_u32 v7, v60, 3, v7
    v_add_u32 v7, s59, v7
    s_mul_i32 s57, s31, 2560
    s_lshl_b32 s58, s3, 7
    s_add_u32 s57, s57, s58
    s_lshl_b32 s60, s60, 6
    s_add_u32 s60, s60, s57
    s_add_u32 s60, s60, 1404928
    s_add_u32 s58, s62, 49152
    s_add_u32 s59, s58, 3072
    buffer_load_dwordx4 v[12:15], v11, s[40:43], s58 offen offset:0 sc1
    buffer_load_dwordx4 v[16:19], v11, s[40:43], s58 offen offset:1024 sc1
    buffer_load_dwordx4 v[20:23], v11, s[40:43], s58 offen offset:2048 sc1
    buffer_load_dwordx4 v[24:27], v11, s[40:43], s59 offen offset:0 sc1
    buffer_load_dwordx4 v[28:31], v11, s[40:43], s59 offen offset:1024 sc1
    buffer_load_dwordx4 v[32:35], v11, s[40:43], s59 offen offset:2048 sc1
    s_waitcnt vmcnt(0)
L_pw_195:
    v_max3_u32 v60, v12, v13, v14
    v_max3_u32 v60, v60, v15, v16
    v_max3_u32 v60, v60, v17, v18
    v_max3_u32 v60, v60, v19, v20
    v_max3_u32 v60, v60, v21, v22
    v_max3_u32 v60, v60, v23, v24
    v_max3_u32 v60, v60, v25, v26
    v_max3_u32 v60, v60, v27, v28
    v_max3_u32 v60, v60, v29, v30
    v_max3_u32 v60, v60, v31, v32
    v_max3_u32 v60, v60, v33, v34
    v_max_u32 v60, v60, v35
    v_cmp_eq_u32 vcc, -1, v60
    s_cbranch_vccnz L_pr_196
    ds_read_b64_tr_b16 v[36:37], v7 offset:0
    ds_read_b64_tr_b16 v[38:39], v7 offset:128
    ds_read_b64_tr_b16 v[40:41], v7 offset:1024
    ds_read_b64_tr_b16 v[42:43], v7 offset:1152
    ds_read_b64_tr_b16 v[44:45], v7 offset:2048
    ds_read_b64_tr_b16 v[46:47], v7 offset:2176
    ds_read_b64_tr_b16 v[48:49], v7 offset:3072
    ds_read_b64_tr_b16 v[50:51], v7 offset:3200
    ds_read_b64_tr_b16 v[52:53], v7 offset:4096
L_pad12:
    s_cbranch_execz L_pad16
    ds_read_b64_tr_b16 v[54:55], v7 offset:4224
    ds_read_b64_tr_b16 v[56:57], v7 offset:5120
    ds_read_b64_tr_b16 v[58:59], v7 offset:5248
    v_pk_add_f32 v[12:13], v[12:13], v[14:15]
    v_pk_add_f32 v[16:17], v[16:17], v[18:19]
    v_pk_add_f32 v[12:13], v[12:13], v[16:17]
    v_add_f32 v4, v12, v13
    v_pk_add_f32 v[20:21], v[20:21], v[22:23]
    v_pk_add_f32 v[24:25], v[24:25], v[26:27]
    v_pk_add_f32 v[20:21], v[20:21], v[24:25]
    v_add_f32 v5, v20, v21
    v_pk_add_f32 v[28:29], v[28:29], v[30:31]
    v_pk_add_f32 v[32:33], v[32:33], v[34:35]
    v_pk_add_f32 v[28:29], v[28:29], v[32:33]
    v_add_f32 v7, v28, v29
    v_lshlrev_b32 v8, 16, v8
    v_lshlrev_b32 v9, 16, v9
    v_lshlrev_b32 v10, 16, v10
    v_mov_b64 v[60:61], 0
    v_mov_b64 v[62:63], 0
    s_add_u32 s58, s62, 43008
    s_add_u32 s57, s62, 55680
    s_add_u32 s59, s58, 3072
    s_mov_b32 s64, 0xbdd2d3e8
    v_and_b32 v12, 7, v0
    v_lshlrev_b32 v12, 3, v12
    buffer_load_dwordx2 v[2:3], v12, s[40:43], s57 offen sc1
    s_waitcnt lgkmcnt(0)
    s_waitcnt vmcnt(0)
L_pw_197:
    v_max_u32 v13, v2, v3
    v_cmp_eq_u32 vcc, -1, v13
    s_cbranch_vccnz L_pr_198
    buffer_load_dwordx4 v[12:15], v11, s[40:43], s58 offen offset:0 sc1
    buffer_load_dwordx4 v[16:19], v11, s[40:43], s58 offen offset:1024 sc1
    buffer_load_dwordx4 v[20:23], v11, s[40:43], s58 offen offset:2048 sc1
    buffer_load_dwordx4 v[24:27], v11, s[40:43], s59 offen offset:0 sc1
    buffer_load_dwordx4 v[28:31], v11, s[40:43], s59 offen offset:1024 sc1
    buffer_load_dwordx4 v[32:35], v11, s[40:43], s59 offen offset:2048 sc1
    v_add_f32_dpp v2, v2, v2 row_ror:4 row_mask:0xf bank_mask:0xf
    v_add_f32_dpp v3, v3, v3 row_ror:4 row_mask:0xf bank_mask:0xf
    s_nop 0
    v_add_f32_dpp v2, v2, v2 row_ror:2 row_mask:0xf bank_mask:0xf
    v_add_f32_dpp v3, v3, v3 row_ror:2 row_mask:0xf bank_mask:0xf
    s_nop 0
    v_add_f32_dpp v2, v2, v2 row_ror:1 row_mask:0xf bank_mask:0xf
    v_add_f32_dpp v3, v3, v3 row_ror:1 row_mask:0xf bank_mask:0xf
    v_mul_f32 v2, 0x3acccccd, v2
    v_mul_f32 v3, 0x3acccccd, v3
    v_fma_f32 v3, -v2, v2, v3
    v_max_f32 v3, 0, v3
    v_add_f32 v3, 0x3727c5ac, v3
    v_rsq_f32 v3, v3
    s_nop 0
    v_mul_f32 v2, v2, v3
    v_fma_f32 v8, -v2, v4, v8
    v_fma_f32 v9, -v2, v5, v9
    v_fma_f32 v10, -v2, v7, v10
    v_and_b32 v7, 15, v0
    v_lshlrev_b32 v7, 2, v7
    v_lshrrev_b32 v4, 4, v0
    v_lshl_add_u32 v7, v4, 28, v7
    v_mov_b32 v2, 0xc0135761
    s_lshl_b32 s74, s3, 2
    s_add_u32 s74, s74, s62
    s_add_u32 s74, s74, 56448
    s_xor_b32 s75, s30, 6
    v_add_u32 v5, s75, v0
    v_lshlrev_b32 v5, 24, v5
    s_cmp_eq_u32 s55, 0
    s_waitcnt vmcnt(4)
    v_pk_add_f32 v[12:13], v[12:13], v[14:15]
    v_pk_add_f32 v[16:17], v[16:17], v[18:19]
    v_pk_add_f32 v[12:13], v[12:13], v[16:17]
    v_add_f32 v12, v12, v13
    s_waitcnt vmcnt(2)
    v_pk_add_f32 v[20:21], v[20:21], v[22:23]
    v_pk_add_f32 v[24:25], v[24:25], v[26:27]
    v_pk_add_f32 v[20:21], v[20:21], v[24:25]
    v_add_f32 v13, v20, v21
    s_waitcnt vmcnt(0)
    v_pk_add_f32 v[28:29], v[28:29], v[30:31]
L_pad13:
    s_cbranch_execz L_pad17
    v_pk_add_f32 v[32:33], v[32:33], v[34:35]
    v_pk_add_f32 v[28:29], v[28:29], v[32:33]
    v_add_f32 v14, v28, v29
    v_add_f32 v15, v12, v13
    v_cmp_u_f32 vcc, v15, v14
    s_cbranch_vccnz L_hr_199
L_hk_200:
    v_fma_f32 v12, v12, v3, v8
    v_fma_f32 v13, v13, v3, v9
    v_fma_f32 v14, v14, v3, v10
    v_mul_f32 v16, v12, v12
    v_mul_f32 v17, v13, v13
    v_mul_f32 v18, v14, v14
    v_fma_f32 v16, v16, s64, v2
    v_fma_f32 v17, v17, s64, v2
    v_fma_f32 v18, v18, s64, v2
    v_mul_f32 v16, v16, v12
    v_mul_f32 v17, v17, v13
    v_mul_f32 v18, v18, v14
    v_exp_f32 v16, v16
    v_exp_f32 v17, v17
    v_exp_f32 v18, v18
    v_add_f32 v16, 1.0, v16
    v_add_f32 v17, 1.0, v17
    v_add_f32 v18, 1.0, v18
    v_rcp_f32 v16, v16
    v_rcp_f32 v17, v17
    v_rcp_f32 v18, v18
    v_mul_f32 v12, v12, v16
    v_mul_f32 v13, v13, v17
    v_mul_f32 v14, v14, v18
    v_mov_b32_dpp v16, v12 row_shl:1 row_mask:0xf bank_mask:0xf bound_ctrl:0
    v_mov_b32_dpp v17, v13 row_shl:1 row_mask:0xf bank_mask:0xf bound_ctrl:0
    v_mov_b32_dpp v18, v14 row_shl:1 row_mask:0xf bank_mask:0xf bound_ctrl:0
    v_cvt_pk_bf16_f32 v20, v12, v16
    v_cvt_pk_bf16_f32 v24, v13, v17
    v_cvt_pk_bf16_f32 v28, v14, v18
    v_mov_b32_dpp v21, v20 row_shl:4 row_mask:0xf bank_mask:0xf bound_ctrl:0
    v_mov_b32_dpp v22, v20 row_shl:8 row_mask:0xf bank_mask:0xf bound_ctrl:0
    v_mov_b32_dpp v23, v20 row_shl:12 row_mask:0xf bank_mask:0xf bound_ctrl:0
    v_mov_b32_dpp v25, v24 row_shl:4 row_mask:0xf bank_mask:0xf bound_ctrl:0
    v_mov_b32_dpp v26, v24 row_shl:8 row_mask:0xf bank_mask:0xf bound_ctrl:0
    v_mov_b32_dpp v27, v24 row_shl:12 row_mask:0xf bank_mask:0xf bound_ctrl:0
    v_smfmac_f32_16x16x64_bf16 v[60:63], v[20:23], v[36:43], v1
    v_mov_b32_dpp v29, v28 row_shl:4 row_mask:0xf bank_mask:0xf bound_ctrl:0
    v_mov_b32_dpp v30, v28 row_shl:8 row_mask:0xf bank_mask:0xf bound_ctrl:0
    v_mov_b32_dpp v31, v28 row_shl:12 row_mask:0xf bank_mask:0xf bound_ctrl:0
    v_smfmac_f32_16x16x64_bf16 v[60:63], v[24:27], v[44:51], v1
    s_nop 0
    v_smfmac_f32_16x16x64_bf16 v[60:63], v[28:31], v[52:59], v1
    s_nop 7
    v_add_f32 v60, v60, v62
    v_min_u32 v60, -2, v60
    buffer_store_dword v60, v7, s[40:43], s60 offen sc1
    s_cbranch_scc1 L_gs_203
    buffer_store_dword v0, v5, s[40:43], s74 offen
L_gb_204:
L_skip_194:
    s_branch L_done
L_typeB_1:
    s_cmp_eq_u32 s53, 3
    s_cbranch_scc0 L_done
    s_cmp_eq_u32 s30, 7
    s_cbranch_scc1 L_w7_205
    s_cmp_lt_u32 s30, 6
    s_cbranch_scc0 L_skip_207
    s_lshr_b32 s57, s30, 1
    s_mul_i32 s57, s57, 128
    s_and_b32 s58, s30, 1
    s_lshl_b32 s58, s58, 6
    s_add_u32 s57, s57, s58
    v_lshrrev_b32 v18, 5, v0
    v_lshlrev_b32 v18, 13, v18
    v_bfe_u32 v60, v0, 3, 1
    v_lshl_add_u32 v18, v60, 12, v18
    v_bfe_u32 v60, v0, 4, 1
    v_lshl_add_u32 v18, v60, 11, v18
    v_bfe_u32 v60, v0, 2, 1
    v_mul_u32_u24 v60, 384, v60
    v_add_u32 v18, v60, v18
    v_and_b32 v60, 3, v0
    v_lshl_add_u32 v18, v60, 3, v18
    v_add_u32 v18, s57, v18
    v_add_u32 v18, 30720, v18
    v_bfe_u32 v19, v0, 4, 1
    v_lshlrev_b32 v19, 12, v19
    v_bfe_u32 v60, v0, 3, 1
    v_lshl_add_u32 v19, v60, 11, v19
    v_bfe_u32 v60, v0, 2, 1
L_pad14:
    s_cbranch_execz L_pad18
    v_mul_u32_u24 v60, 384, v60
    v_add_u32 v19, v60, v19
    v_and_b32 v60, 3, v0
    v_lshl_add_u32 v19, v60, 3, v19
    v_add_u32 v19, s57, v19
    v_add_u32 v19, 63488, v19
    ds_read_b64_tr_b16 v[36:37], v18 offset:0
    ds_read_b64_tr_b16 v[38:39], v18 offset:1024
    ds_read_b64_tr_b16 v[40:41], v18 offset:16384
    ds_read_b64_tr_b16 v[42:43], v18 offset:17408
    ds_read_b64_tr_b16 v[44:45], v19 offset:0
    ds_read_b64_tr_b16 v[46:47], v19 offset:1024
    ds_read_b64_tr_b16 v[48:49], v18 offset:32
    ds_read_b64_tr_b16 v[50:51], v18 offset:1056
    ds_read_b64_tr_b16 v[52:53], v18 offset:16416
    ds_read_b64_tr_b16 v[54:55], v18 offset:17440
    ds_read_b64_tr_b16 v[56:57], v19 offset:32
    ds_read_b64_tr_b16 v[58:59], v19 offset:1056
    v_lshrrev_b32 v32, 4, v0
    v_lshlrev_b32 v32, 5, v32
    v_bfe_u32 v60, v0, 1, 1
    v_lshl_add_u32 v32, v60, 4, v32
    v_and_b32 v60, 1, v0
    v_mul_u32_u24 v60, 192, v60
    v_add_u32 v32, v60, v32
    v_add_u32 v32, 159936, v32
    v_lshrrev_b32 v33, 4, v0
    v_lshlrev_b32 v33, 4, v33
    v_bfe_u32 v60, v0, 1, 1
    v_lshl_add_u32 v33, v60, 3, v33
    v_and_b32 v60, 1, v0
    v_mul_u32_u24 v60, 192, v60
    v_add_u32 v33, v60, v33
    v_add_u32 v33, 160064, v33
    v_mov_b64 v[24:25], 0
    v_mov_b64 v[26:27], 0
    v_mov_b64 v[28:29], 0
    v_mov_b64 v[30:31], 0
    s_lshr_b32 s57, s30, 1
    s_lshl_b32 s57, s57, 11
    s_and_b32 s58, s30, 1
    s_lshl_b32 s58, s58, 9
    s_add_u32 s57, s57, s58
    s_lshr_b32 s58, s54, 2
    s_lshl_b32 s58, s58, 10
    s_add_u32 s57, s57, s58
    s_and_b32 s58, s54, 3
    s_lshl_b32 s58, s58, 2
    s_add_u32 s57, s57, s58
    v_and_b32 v34, 31, v0
    v_lshlrev_b32 v34, 4, v34
    v_lshrrev_b32 v60, 5, v0
    v_lshl_add_u32 v34, v60, 30, v34
    v_add_u32 v34, s57, v34
    s_add_u32 s59, s62, 43008
    s_add_u32 s60, s62, 55680
L_skip_207:
    s_cmp_lt_u32 s30, 6
    s_barrier
    s_cbranch_scc0 L_se_206
    ds_read_b128 v[12:15], v32
    ds_read_b64 v[16:17], v33
    s_waitcnt lgkmcnt(1)
    v_smfmac_f32_16x16x64_bf16 v[24:27], v[12:15], v[36:43], v1
    v_smfmac_f32_16x16x64_bf16 v[28:31], v[12:15], v[48:55], v1
    s_waitcnt lgkmcnt(0)
    v_smfmac_f32_16x16x32_bf16 v[24:27], v[16:17], v[44:47], v1
    v_smfmac_f32_16x16x32_bf16 v[28:31], v[16:17], v[56:59], v1
    s_cmp_eq_u32 s55, 0
    s_nop 5
    v_add_f32 v12, v24, v26
    s_nop 1
    v_add_f32_dpp v12, v28, v30 quad_perm:[0,1,2,3] row_mask:0x2 bank_mask:0xf
    v_min_u32 v12, -2, v12
    s_cbranch_scc1 L_gs_208
    buffer_store_dword v12, v34, s[40:43], s59 offen
L_gb_209:
L_se_206:
    s_cmp_eq_u32 s30, 7
    s_cbranch_scc0 L_done
    s_cmp_eq_u32 s31, 0
    s_cbranch_scc0 L_done
    v_lshlrev_b32 v60, 16, v4
    v_add_f32 v2, v2, v60
    v_and_b32 v60, 0xffff0000, v4
    v_add_f32 v3, v3, v60
    v_and_b32 v60, 31, v0
    v_min_u32 v60, 19, v60
    s_mul_i32 s57, s54, 160
    v_lshrrev_b32 v7, 5, v0
    v_lshlrev_b32 v7, 2, v7
    v_add_u32 v7, s57, v7
    v_lshl_add_u32 v7, v60, 3, v7
L_pad15:
    s_cbranch_execz L_pad19
    s_add_u32 s57, s62, 56448
    v_min_u32 v9, 19, v0
    v_lshlrev_b32 v9, 2, v9
    buffer_load_dword v12, v9, s[40:43], s57 offen sc1
    s_waitcnt vmcnt(0)
L_pw_221:
    v_cmp_eq_u32 vcc, -1, v12
    s_cbranch_vccnz L_pr_222
    s_mov_b32 s57, 1404928
    buffer_load_dwordx4 v[12:15], v5, s[40:43], s57 offen sc1
    s_mov_b32 s58, 1410048
    buffer_load_dwordx4 v[16:19], v5, s[40:43], s58 offen sc1
    s_mov_b32 s59, 1415168
    buffer_load_dwordx4 v[20:23], v5, s[40:43], s59 offen sc1
    s_mov_b32 s60, 1420288
    buffer_load_dwordx4 v[24:27], v5, s[40:43], s60 offen sc1
L_gw_223:
    s_waitcnt vmcnt(2)
    v_pk_add_f32 v[28:29], v[12:13], v[16:17]
    v_pk_add_f32 v[30:31], v[14:15], v[18:19]
    s_waitcnt vmcnt(1)
    v_pk_add_f32 v[28:29], v[28:29], v[20:21]
    v_pk_add_f32 v[30:31], v[30:31], v[22:23]
    s_waitcnt vmcnt(0)
    v_pk_add_f32 v[28:29], v[28:29], v[24:25]
    v_pk_add_f32 v[30:31], v[30:31], v[26:27]
    s_nop 1
    v_permlane32_swap_b32 v28, v30
    v_permlane32_swap_b32 v29, v31
    v_pk_add_f32 v[28:29], v[28:29], v[30:31]
    v_pk_add_f32 v[28:29], v[28:29], v[2:3]
    v_cmp_u_f32 vcc, v28, v29
    s_cbranch_vccnz L_gr_224
L_gk_225:
    v_cvt_pk_bf16_f32 v28, v28, v29
    global_store_dword v7, v28, s[24:25]
    s_branch L_done
L_gs_26:
    buffer_store_dword v27, v34, s[40:43], s67 offen sc1
    s_branch L_gb_27
L_gs_29:
    buffer_store_dword v12, v34, s[40:43], s59 offen sc1
    s_branch L_gb_30
L_cr_41:
    s_sub_u32 s56, s56, 1
    s_cbranch_scc1 L_done
    global_load_dword v2, v3, s[26:27] sc1
    s_waitcnt vmcnt(0)
    s_branch L_cw_40
L_far_42:
    s_lshl_b32 s57, s52, 2
    s_add_u32 s57, s57, s72
    s_mov_b64 exec, 1
    buffer_store_dword v0, v0, s[40:43], s57 offen offset:128 sc1
    s_mov_b64 exec, -1
    s_branch L_fb_43
L_cr_55:
    s_sub_u32 s56, s56, 1
    s_cbranch_scc1 L_done
    buffer_load_dword v2, v24, s[40:43], s72 offen sc1
    s_branch L_cw_54
L_gs_62:
    buffer_store_dword v27, v34, s[40:43], s67 offen sc1
    s_branch L_gb_63
L_gs_65:
    buffer_store_dword v12, v34, s[40:43], s59 offen sc1
    s_branch L_gb_66
L_pr_69:
    s_sub_u32 s56, s56, 1
    s_cbranch_scc1 L_done
    buffer_load_dword v17, v16, s[40:43], s72 offen offset:256 sc1
    s_waitcnt vmcnt(0)
    s_branch L_pw_68
L_gs_87:
    buffer_store_dword v22, v23, s[40:43], s57 offen sc1
    s_branch L_gb_88
L_cr_98:
    s_sub_u32 s56, s56, 1
    s_cbranch_scc1 L_done
    global_load_dword v2, v3, s[26:27] offset:4 sc1
    s_branch L_cw_97
L_gs_105:
    buffer_store_dword v56, v3, s[40:43], s57 offen sc1
    s_branch L_gb_106
L_comb_0:
    s_mov_b32 s57, 0
    s_cmp_eq_u32 s55, 0
    s_waitcnt lgkmcnt(0)
    s_barrier
    ds_read2st64_b64 v[40:43], v2 offset0:0 offset1:8
    ds_read2st64_b64 v[44:47], v2 offset0:16 offset1:24
    ds_read2st64_b64 v[48:51], v2 offset0:32 offset1:40
    ds_read2st64_b64 v[52:55], v2 offset0:48 offset1:56
    s_waitcnt lgkmcnt(3)
    v_pk_mul_f32 v[56:57], v[40:41], s[64:65] op_sel:[0,0] op_sel_hi:[1,0]
    v_pk_mul_f32 v[58:59], v[42:43], s[64:65] op_sel:[0,1] op_sel_hi:[1,1]
    s_waitcnt lgkmcnt(2)
    v_pk_fma_f32 v[56:57], v[44:45], s[66:67], v[56:57] op_sel:[0,0,0] op_sel_hi:[1,0,1]
    v_pk_fma_f32 v[58:59], v[46:47], s[66:67], v[58:59] op_sel:[0,1,0] op_sel_hi:[1,1,1]
    s_waitcnt lgkmcnt(1)
    v_pk_fma_f32 v[56:57], v[48:49], s[68:69], v[56:57] op_sel:[0,0,0] op_sel_hi:[1,0,1]
    v_pk_fma_f32 v[58:59], v[50:51], s[68:69], v[58:59] op_sel:[0,1,0] op_sel_hi:[1,1,1]
L_pad16:
    s_cbranch_execz L_pad20
    s_waitcnt lgkmcnt(0)
    v_pk_fma_f32 v[56:57], v[52:53], s[70:71], v[56:57] op_sel:[0,0,0] op_sel_hi:[1,0,1]
    v_pk_fma_f32 v[58:59], v[54:55], s[70:71], v[58:59] op_sel:[0,1,0] op_sel_hi:[1,1,1]
    v_pk_add_f32 v[56:57], v[56:57], v[58:59]
    v_cvt_pk_bf16_f32 v56, v56, v57
    v_min_u32 v56, -2, v56
    s_cbranch_scc1 L_gs_105
    buffer_store_dword v56, v3, s[40:43], s57 offen
L_gb_106:
    s_branch L_comb_0b
L_pr_109:
    s_sub_u32 s56, s56, 1
    s_cbranch_scc1 L_done
    buffer_load_dword v18, v5, s[40:43], s59 offen sc1
    buffer_load_dwordx2 v[20:21], v22, s[40:43], s59 offen sc1
    s_waitcnt vmcnt(0)
    s_branch L_pw_108
L_pr_111:
    s_sub_u32 s56, s56, 1
    s_cbranch_scc1 L_done
    buffer_load_dwordx4 v[12:15], v9, s[40:43], s60 offen sc1
    buffer_load_dwordx2 v[16:17], v10, s[40:43], s60 offen offset:1024 sc1
    s_waitcnt vmcnt(0)
    s_branch L_pw_110
L_gs_114:
    buffer_store_dword v0, v34, s[40:43], s74 offen sc1
    s_branch L_gb_115
L_fin_112:
    s_cmp_eq_u32 s55, 0
    s_waitcnt lgkmcnt(0)
    s_barrier
    ds_read2st64_b32 v[12:13], v32 offset0:0 offset1:1
    ds_read2st64_b32 v[14:15], v32 offset0:2 offset1:3
    ds_read2st64_b32 v[16:17], v32 offset0:4 offset1:5
    ds_read2st64_b32 v[18:19], v32 offset0:6 offset1:7
    s_waitcnt lgkmcnt(2)
    v_pk_add_f32 v[12:13], v[12:13], v[14:15]
    s_waitcnt lgkmcnt(0)
    v_pk_add_f32 v[16:17], v[16:17], v[18:19]
    v_pk_add_f32 v[12:13], v[12:13], v[16:17]
    v_add_f32 v14, v12, v13
    v_add_f32 v15, v12, v13
    s_nop 1
    v_permlane16_swap_b32 v14, v15
    v_add_f32 v12, v14, v15
    v_min_u32 v12, -2, v12
    buffer_store_dword v12, v33, s[40:43], s58 offen sc1
    s_branch L_finb_113
L_pr_118:
    s_sub_u32 s56, s56, 1
    s_cbranch_scc1 L_done
    buffer_load_dwordx4 v[12:15], v11, s[40:43], s58 offen offset:0 sc1
    buffer_load_dwordx4 v[16:19], v11, s[40:43], s58 offen offset:1024 sc1
    buffer_load_dwordx4 v[20:23], v11, s[40:43], s58 offen offset:2048 sc1
    buffer_load_dwordx4 v[24:27], v11, s[40:43], s59 offen offset:0 sc1
    buffer_load_dwordx4 v[28:31], v11, s[40:43], s59 offen offset:1024 sc1
    buffer_load_dwordx4 v[32:35], v11, s[40:43], s59 offen offset:2048 sc1
    s_waitcnt vmcnt(0)
    s_branch L_pw_117
L_pr_120:
    s_sub_u32 s56, s56, 1
    s_cbranch_scc1 L_done
    buffer_load_dwordx2 v[2:3], v12, s[40:43], s57 offen sc1
    s_waitcnt vmcnt(0)
    s_branch L_pw_119
L_pr_124:
    s_sub_u32 s56, s56, 1
    s_cbranch_scc1 L_done
    buffer_load_dwordx4 v[12:15], v11, s[40:43], s58 offen offset:0 sc1
    buffer_load_dwordx4 v[16:19], v11, s[40:43], s58 offen offset:1024 sc1
    buffer_load_dwordx4 v[20:23], v11, s[40:43], s58 offen offset:2048 sc1
    buffer_load_dwordx4 v[24:27], v11, s[40:43], s59 offen offset:0 sc1
    buffer_load_dwordx4 v[28:31], v11, s[40:43], s59 offen offset:1024 sc1
    buffer_load_dwordx4 v[32:35], v11, s[40:43], s59 offen offset:2048 sc1
    s_waitcnt vmcnt(0)
    s_branch L_pw_123
L_hr_121:
    buffer_load_dwordx4 v[12:15], v11, s[40:43], s58 offen offset:0 sc1
    buffer_load_dwordx4 v[16:19], v11, s[40:43], s58 offen offset:1024 sc1
    buffer_load_dwordx4 v[20:23], v11, s[40:43], s58 offen offset:2048 sc1
    buffer_load_dwordx4 v[24:27], v11, s[40:43], s59 offen offset:0 sc1
    buffer_load_dwordx4 v[28:31], v11, s[40:43], s59 offen offset:1024 sc1
    buffer_load_dwordx4 v[32:35], v11, s[40:43], s59 offen offset:2048 sc1
    s_waitcnt vmcnt(0)
L_pw_123:
    v_max3_u32 v4, v12, v13, v14
    v_max3_u32 v4, v4, v15, v16
    v_max3_u32 v4, v4, v17, v18
    v_max3_u32 v4, v4, v19, v20
    v_max3_u32 v4, v4, v21, v22
    v_max3_u32 v4, v4, v23, v24
    v_max3_u32 v4, v4, v25, v26
L_pad17:
    s_cbranch_execz L_pad21
    v_max3_u32 v4, v4, v27, v28
    v_max3_u32 v4, v4, v29, v30
    v_max3_u32 v4, v4, v31, v32
    v_max3_u32 v4, v4, v33, v34
    v_max_u32 v4, v4, v35
    v_cmp_eq_u32 vcc, -1, v4
    s_cbranch_vccnz L_pr_124
    v_pk_add_f32 v[12:13], v[12:13], v[14:15]
    v_pk_add_f32 v[16:17], v[16:17], v[18:19]
    v_pk_add_f32 v[12:13], v[12:13], v[16:17]
    v_add_f32 v12, v12, v13
    v_pk_add_f32 v[20:21], v[20:21], v[22:23]
    v_pk_add_f32 v[24:25], v[24:25], v[26:27]
    v_pk_add_f32 v[20:21], v[20:21], v[24:25]
    v_add_f32 v13, v20, v21
    v_pk_add_f32 v[28:29], v[28:29], v[30:31]
    v_pk_add_f32 v[32:33], v[32:33], v[34:35]
    v_pk_add_f32 v[28:29], v[28:29], v[32:33]
    v_add_f32 v14, v28, v29
    s_cmp_eq_u32 s55, 0
    s_branch L_hk_122
L_gs_125:
    buffer_store_dword v0, v5, s[40:43], s74 offen sc1
    s_branch L_gb_126
L_gs_130:
    buffer_store_dword v12, v34, s[40:43], s60 offen sc1
    s_branch L_gb_131
L_gs_132:
    buffer_store_dword v12, v34, s[40:43], s59 offen sc1
    s_branch L_gb_133
L_pr_135:
    s_sub_u32 s56, s56, 1
    s_cbranch_scc1 L_done
    buffer_load_dword v12, v9, s[40:43], s57 offen sc1
    s_waitcnt vmcnt(0)
    s_branch L_pw_134
L_gr_137:
    s_sub_u32 s56, s56, 1
    s_cbranch_scc1 L_done
    s_mov_b64 s[74:75], 0
    v_max3_u32 v30, v12, v13, v14
    v_max_u32 v30, v30, v15
    v_cmp_eq_u32 vcc, -1, v30
    s_cbranch_vccz L_gn_139
    s_or_b64 s[74:75], s[74:75], vcc
    s_mov_b64 exec, vcc
    buffer_load_dwordx4 v[12:15], v5, s[40:43], s57 offen sc1
    s_mov_b64 exec, -1
L_gn_139:
    v_max3_u32 v30, v16, v17, v18
    v_max_u32 v30, v30, v19
    v_cmp_eq_u32 vcc, -1, v30
    s_cbranch_vccz L_gn_140
    s_or_b64 s[74:75], s[74:75], vcc
    s_mov_b64 exec, vcc
    buffer_load_dwordx4 v[16:19], v5, s[40:43], s58 offen sc1
    s_mov_b64 exec, -1
L_gn_140:
    v_max3_u32 v30, v20, v21, v22
    v_max_u32 v30, v30, v23
    v_cmp_eq_u32 vcc, -1, v30
    s_cbranch_vccz L_gn_141
    s_or_b64 s[74:75], s[74:75], vcc
    s_mov_b64 exec, vcc
    buffer_load_dwordx4 v[20:23], v5, s[40:43], s59 offen sc1
    s_mov_b64 exec, -1
L_gn_141:
    v_max3_u32 v30, v24, v25, v26
    v_max_u32 v30, v30, v27
    v_cmp_eq_u32 vcc, -1, v30
    s_cbranch_vccz L_gn_142
    s_or_b64 s[74:75], s[74:75], vcc
    s_mov_b64 exec, vcc
    buffer_load_dwordx4 v[24:27], v5, s[40:43], s60 offen sc1
    s_mov_b64 exec, -1
L_gn_142:
    s_cmp_eq_u64 s[74:75], 0
    s_cbranch_scc1 L_gk_138
    s_waitcnt vmcnt(0)
    s_branch L_gw_136
L_gs_143:
    buffer_store_dword v27, v34, s[40:43], s67 offen sc1
    s_branch L_gb_144
L_w7_127:
    v_and_b32 v60, 31, v0
    v_min_u32 v60, 19, v60
    s_mul_i32 s57, s54, 320
    v_lshrrev_b32 v5, 5, v0
    v_mul_u32_u24 v5, 2560, v5
    v_add_u32 v5, s57, v5
    v_lshl_add_u32 v5, v60, 4, v5
    v_and_b32 v60, 31, v0
    v_cmp_gt_u32 s[64:65], 20, v60
    v_min_u32 v60, 19, v60
    v_lshrrev_b32 v35, 5, v0
    v_lshlrev_b32 v35, 2, v35
    v_add_u32 v35, 159936, v35
    v_lshl_add_u32 v35, v60, 3, v35
    s_add_u32 s66, s62, 36864
    s_add_u32 s67, s62, 55552
    s_lshl_b32 s57, s54, 3
    v_lshrrev_b32 v34, 5, v0
    v_lshlrev_b32 v34, 2, v34
    v_add_u32 v34, s57, v34
L_pad18:
    s_cbranch_execz L_pad22
    v_and_b32 v60, 31, v0
    v_mov_b32 v61, 0x7f000000
    v_cmp_ne_u32 vcc, 31, v60
    s_nop 1
    v_cndmask_b32 v34, v34, v61, vcc
    v_mov_b32 v61, 0x3f803f80
    s_add_u32 s57, s62, 56064
    v_min_u32 v9, 19, v0
    v_lshlrev_b32 v9, 2, v9
    buffer_load_dword v12, v9, s[40:43], s57 offen sc1
    s_waitcnt vmcnt(0)
L_pw_134:
    v_cmp_eq_u32 vcc, -1, v12
    s_cbranch_vccnz L_pr_135
    s_mov_b32 s57, 1343488
    buffer_load_dwordx4 v[12:15], v5, s[40:43], s57 offen sc1
    s_mov_b32 s58, 1348608
    buffer_load_dwordx4 v[16:19], v5, s[40:43], s58 offen sc1
    s_mov_b32 s59, 1353728
    buffer_load_dwordx4 v[20:23], v5, s[40:43], s59 offen sc1
    s_mov_b32 s60, 1358848
    buffer_load_dwordx4 v[24:27], v5, s[40:43], s60 offen sc1
L_gw_136:
    s_waitcnt vmcnt(2)
    v_pk_add_f32 v[28:29], v[12:13], v[16:17]
    v_pk_add_f32 v[30:31], v[14:15], v[18:19]
    s_waitcnt vmcnt(1)
    v_pk_add_f32 v[28:29], v[28:29], v[20:21]
    v_pk_add_f32 v[30:31], v[30:31], v[22:23]
    s_waitcnt vmcnt(0)
    v_pk_add_f32 v[28:29], v[28:29], v[24:25]
    v_pk_add_f32 v[30:31], v[30:31], v[26:27]
    s_nop 1
    v_permlane32_swap_b32 v28, v30
    v_permlane32_swap_b32 v29, v31
    v_pk_add_f32 v[28:29], v[28:29], v[30:31]
    v_pk_add_f32 v[28:29], v[28:29], v[2:3]
    v_cmp_u_f32 vcc, v28, v29
    s_cbranch_vccnz L_gr_137
L_gk_138:
    v_cvt_pk_bf16_f32 v28, v28, v29
    ds_write_b32 v35, v28
    s_waitcnt lgkmcnt(0)
    s_barrier
    v_cndmask_b32 v29, 0, v28, s[64:65]
    v_dot2_f32_bf16 v27, v29, v61, 0
    v_dot2_f32_bf16 v62, v29, v29, 0
    v_lshlrev_b32 v2, 16, v28
    v_and_b32 v3, 0xffff0000, v28
    s_cmp_eq_u32 s55, 0
    v_permlane32_swap_b32 v27, v62
    v_add_f32 v27, v27, v62
    s_nop 1
    v_add_f32_dpp v27, v27, v27 row_ror:8 row_mask:0xf bank_mask:0xf
    s_nop 1
    v_add_f32_dpp v27, v27, v27 row_ror:4 row_mask:0xf bank_mask:0xf
    s_nop 1
    v_add_f32_dpp v27, v27, v27 row_ror:2 row_mask:0xf bank_mask:0xf
    s_nop 1
    v_add_f32_dpp v27, v27, v27 row_ror:1 row_mask:0xf bank_mask:0xf
    s_nop 1
    v_add_f32_dpp v27, v27, v27 row_bcast:15 row_mask:0xa bank_mask:0xf
    v_min_u32 v27, -2, v27
    s_cbranch_scc1 L_gs_143
    buffer_store_dword v27, v34, s[40:43], s67 offen
L_gb_144:
    s_branch L_se_128
L_gs_148:
    buffer_store_dword v12, v34, s[40:43], s59 offen sc1
    s_branch L_gb_149
L_pr_152:
    s_sub_u32 s56, s56, 1
    s_cbranch_scc1 L_done
    buffer_load_dword v12, v9, s[40:43], s57 offen sc1
    s_waitcnt vmcnt(0)
    s_branch L_pw_151
L_gr_154:
    s_sub_u32 s56, s56, 1
    s_cbranch_scc1 L_done
    s_mov_b64 s[74:75], 0
    v_max3_u32 v30, v12, v13, v14
    v_max_u32 v30, v30, v15
    v_cmp_eq_u32 vcc, -1, v30
    s_cbranch_vccz L_gn_156
    s_or_b64 s[74:75], s[74:75], vcc
    s_mov_b64 exec, vcc
    buffer_load_dwordx4 v[12:15], v5, s[40:43], s57 offen sc1
    s_mov_b64 exec, -1
L_gn_156:
    v_max3_u32 v30, v16, v17, v18
    v_max_u32 v30, v30, v19
    v_cmp_eq_u32 vcc, -1, v30
    s_cbranch_vccz L_gn_157
    s_or_b64 s[74:75], s[74:75], vcc
    s_mov_b64 exec, vcc
    buffer_load_dwordx4 v[16:19], v5, s[40:43], s58 offen sc1
    s_mov_b64 exec, -1
L_gn_157:
L_pad19:
    s_cbranch_execz L_pad23
    v_max3_u32 v30, v20, v21, v22
    v_max_u32 v30, v30, v23
    v_cmp_eq_u32 vcc, -1, v30
    s_cbranch_vccz L_gn_158
    s_or_b64 s[74:75], s[74:75], vcc
    s_mov_b64 exec, vcc
    buffer_load_dwordx4 v[20:23], v5, s[40:43], s59 offen sc1
    s_mov_b64 exec, -1
L_gn_158:
    v_max3_u32 v30, v24, v25, v26
    v_max_u32 v30, v30, v27
    v_cmp_eq_u32 vcc, -1, v30
    s_cbranch_vccz L_gn_159
    s_or_b64 s[74:75], s[74:75], vcc
    s_mov_b64 exec, vcc
    buffer_load_dwordx4 v[24:27], v5, s[40:43], s60 offen sc1
    s_mov_b64 exec, -1
L_gn_159:
    s_cmp_eq_u64 s[74:75], 0
    s_cbranch_scc1 L_gk_155
    s_waitcnt vmcnt(0)
    s_branch L_gw_153
L_pr_161:
    s_sub_u32 s56, s56, 1
    s_cbranch_scc1 L_done
    buffer_load_dword v12, v9, s[40:43], s57 offen sc1
    s_waitcnt vmcnt(0)
    s_branch L_pw_160
L_gr_163:
    s_sub_u32 s56, s56, 1
    s_cbranch_scc1 L_done
    s_mov_b64 s[74:75], 0
    v_max3_u32 v30, v12, v13, v14
    v_max_u32 v30, v30, v15
    v_cmp_eq_u32 vcc, -1, v30
    s_cbranch_vccz L_gn_165
    s_or_b64 s[74:75], s[74:75], vcc
    s_mov_b64 exec, vcc
    buffer_load_dwordx4 v[12:15], v5, s[40:43], s57 offen sc1
    s_mov_b64 exec, -1
L_gn_165:
    v_max3_u32 v30, v16, v17, v18
    v_max_u32 v30, v30, v19
    v_cmp_eq_u32 vcc, -1, v30
    s_cbranch_vccz L_gn_166
    s_or_b64 s[74:75], s[74:75], vcc
    s_mov_b64 exec, vcc
    buffer_load_dwordx4 v[16:19], v5, s[40:43], s58 offen sc1
    s_mov_b64 exec, -1
L_gn_166:
    v_max3_u32 v30, v20, v21, v22
    v_max_u32 v30, v30, v23
    v_cmp_eq_u32 vcc, -1, v30
    s_cbranch_vccz L_gn_167
    s_or_b64 s[74:75], s[74:75], vcc
    s_mov_b64 exec, vcc
    buffer_load_dwordx4 v[20:23], v5, s[40:43], s59 offen sc1
    s_mov_b64 exec, -1
L_gn_167:
    v_max3_u32 v30, v24, v25, v26
    v_max_u32 v30, v30, v27
    v_cmp_eq_u32 vcc, -1, v30
    s_cbranch_vccz L_gn_168
    s_or_b64 s[74:75], s[74:75], vcc
    s_mov_b64 exec, vcc
    buffer_load_dwordx4 v[24:27], v5, s[40:43], s60 offen sc1
    s_mov_b64 exec, -1
L_gn_168:
    s_cmp_eq_u64 s[74:75], 0
    s_cbranch_scc1 L_gk_164
    s_waitcnt vmcnt(0)
    s_branch L_gw_162
L_gs_169:
    buffer_store_dword v27, v34, s[40:43], s67 offen sc1
    s_branch L_gb_170
L_w7_145:
    v_and_b32 v60, 31, v0
    v_min_u32 v60, 19, v60
    s_mul_i32 s57, s54, 320
    v_lshrrev_b32 v5, 5, v0
    v_mul_u32_u24 v5, 2560, v5
    v_add_u32 v5, s57, v5
    v_lshl_add_u32 v5, v60, 4, v5
    v_and_b32 v60, 31, v0
    v_cmp_gt_u32 s[64:65], 20, v60
    v_min_u32 v60, 19, v60
    v_lshrrev_b32 v35, 5, v0
    v_lshlrev_b32 v35, 2, v35
    v_add_u32 v35, 159936, v35
    v_lshl_add_u32 v35, v60, 3, v35
    s_mul_i32 s66, s53, 3072
    s_add_u32 s66, s66, s62
    s_add_u32 s66, s66, 24576
    s_lshl_b32 s67, s53, 6
    s_add_u32 s67, s67, s62
    s_add_u32 s67, s67, 55296
    s_lshl_b32 s57, s54, 3
    v_lshrrev_b32 v34, 5, v0
    v_lshlrev_b32 v34, 2, v34
    v_add_u32 v34, s57, v34
    v_and_b32 v60, 31, v0
    v_mov_b32 v61, 0x7f000000
    v_cmp_ne_u32 vcc, 31, v60
    s_nop 1
    v_cndmask_b32 v34, v34, v61, vcc
    v_mov_b32 v61, 0x3f803f80
    s_cmp_lg_u32 s53, 3
    s_cbranch_scc0 L_skip_150
    s_add_u32 s57, s62, 55552
    v_mov_b32 v9, 0
    buffer_load_dword v12, v9, s[40:43], s57 offen sc1
L_pad20:
    s_cbranch_execz L_pad24
    s_waitcnt vmcnt(0)
L_pw_151:
    v_cmp_eq_u32 vcc, -1, v12
    s_cbranch_vccnz L_pr_152
    s_mov_b32 s57, 1343488
    buffer_load_dwordx4 v[12:15], v5, s[40:43], s57 offen sc1
    s_mov_b32 s58, 1348608
    buffer_load_dwordx4 v[16:19], v5, s[40:43], s58 offen sc1
    s_mov_b32 s59, 1353728
    buffer_load_dwordx4 v[20:23], v5, s[40:43], s59 offen sc1
    s_mov_b32 s60, 1358848
    buffer_load_dwordx4 v[24:27], v5, s[40:43], s60 offen sc1
L_gw_153:
    s_waitcnt vmcnt(2)
    v_pk_add_f32 v[28:29], v[12:13], v[16:17]
    v_pk_add_f32 v[30:31], v[14:15], v[18:19]
    s_waitcnt vmcnt(1)
    v_pk_add_f32 v[28:29], v[28:29], v[20:21]
    v_pk_add_f32 v[30:31], v[30:31], v[22:23]
    s_waitcnt vmcnt(0)
    v_pk_add_f32 v[28:29], v[28:29], v[24:25]
    v_pk_add_f32 v[30:31], v[30:31], v[26:27]
    s_nop 1
    v_permlane32_swap_b32 v28, v30
    v_permlane32_swap_b32 v29, v31
    v_pk_add_f32 v[28:29], v[28:29], v[30:31]
    v_pk_add_f32 v[28:29], v[28:29], v[2:3]
    v_cmp_u_f32 vcc, v28, v29
    s_cbranch_vccnz L_gr_154
L_gk_155:
    v_cvt_pk_bf16_f32 v28, v28, v29
    v_lshlrev_b32 v2, 16, v28
    v_and_b32 v3, 0xffff0000, v28
L_skip_150:
    v_lshlrev_b32 v60, 16, v4
    v_add_f32 v2, v2, v60
    v_and_b32 v60, 0xffff0000, v4
    v_add_f32 v3, v3, v60
    s_add_u32 s57, s62, 56192
    v_min_u32 v9, 19, v0
    v_lshlrev_b32 v9, 2, v9
    buffer_load_dword v12, v9, s[40:43], s57 offen sc1
    s_waitcnt vmcnt(0)
L_pw_160:
    v_cmp_eq_u32 vcc, -1, v12
    s_cbranch_vccnz L_pr_161
    s_mov_b32 s57, 1363968
    buffer_load_dwordx4 v[12:15], v5, s[40:43], s57 offen sc1
    s_mov_b32 s58, 1369088
    buffer_load_dwordx4 v[16:19], v5, s[40:43], s58 offen sc1
    s_mov_b32 s59, 1374208
    buffer_load_dwordx4 v[20:23], v5, s[40:43], s59 offen sc1
    s_mov_b32 s60, 1379328
    buffer_load_dwordx4 v[24:27], v5, s[40:43], s60 offen sc1
L_gw_162:
    s_waitcnt vmcnt(2)
    v_pk_add_f32 v[28:29], v[12:13], v[16:17]
    v_pk_add_f32 v[30:31], v[14:15], v[18:19]
    s_waitcnt vmcnt(1)
    v_pk_add_f32 v[28:29], v[28:29], v[20:21]
    v_pk_add_f32 v[30:31], v[30:31], v[22:23]
    s_waitcnt vmcnt(0)
    v_pk_add_f32 v[28:29], v[28:29], v[24:25]
    v_pk_add_f32 v[30:31], v[30:31], v[26:27]
    s_nop 1
    v_permlane32_swap_b32 v28, v30
    v_permlane32_swap_b32 v29, v31
    v_pk_add_f32 v[28:29], v[28:29], v[30:31]
    v_pk_add_f32 v[28:29], v[28:29], v[2:3]
    v_cmp_u_f32 vcc, v28, v29
    s_cbranch_vccnz L_gr_163
L_gk_164:
    v_cvt_pk_bf16_f32 v28, v28, v29
    ds_write_b32 v35, v28
    s_waitcnt lgkmcnt(0)
    s_barrier
    v_cndmask_b32 v29, 0, v28, s[64:65]
    v_dot2_f32_bf16 v27, v29, v61, 0
    v_dot2_f32_bf16 v62, v29, v29, 0
    v_lshlrev_b32 v2, 16, v28
    v_and_b32 v3, 0xffff0000, v28
    s_cmp_eq_u32 s55, 0
    v_permlane32_swap_b32 v27, v62
    v_add_f32 v27, v27, v62
    s_nop 1
    v_add_f32_dpp v27, v27, v27 row_ror:8 row_mask:0xf bank_mask:0xf
    s_nop 1
    v_add_f32_dpp v27, v27, v27 row_ror:4 row_mask:0xf bank_mask:0xf
L_pad21:
    s_cbranch_execz L_pad25
    s_nop 1
    v_add_f32_dpp v27, v27, v27 row_ror:2 row_mask:0xf bank_mask:0xf
    s_nop 1
    v_add_f32_dpp v27, v27, v27 row_ror:1 row_mask:0xf bank_mask:0xf
    s_nop 1
    v_add_f32_dpp v27, v27, v27 row_bcast:15 row_mask:0xa bank_mask:0xf
    v_min_u32 v27, -2, v27
    s_cbranch_scc1 L_gs_169
    buffer_store_dword v27, v34, s[40:43], s67 offen
L_gb_170:
    s_branch L_se_146
L_pr_174:
    s_sub_u32 s56, s56, 1
    s_cbranch_scc1 L_done
    buffer_load_dwordx4 v[12:15], v16, s[40:43], s59 offen sc1
    s_waitcnt vmcnt(0)
    s_branch L_pw_173
L_pr_178:
    s_sub_u32 s56, s56, 1
    s_cbranch_scc1 L_done
    buffer_load_dwordx2 v[8:9], v16, s[40:43], s60 offen sc1
    s_waitcnt vmcnt(0)
    s_branch L_pw_177
L_qo_171:
    v_mov_b64 v[24:25], 0
    v_mov_b64 v[26:27], 0
    v_mov_b64 v[28:29], 0
    v_mov_b64 v[30:31], 0
    v_mov_b64 v[32:33], 0
    v_mov_b64 v[34:35], 0
    v_mov_b64 v[36:37], 0
    v_mov_b64 v[38:39], 0
    v_mov_b64 v[40:41], 0
    v_mov_b64 v[42:43], 0
    v_mov_b64 v[44:45], 0
    v_mov_b64 v[46:47], 0
    v_mov_b64 v[48:49], 0
    v_mov_b64 v[50:51], 0
    v_mov_b64 v[52:53], 0
    v_mov_b64 v[54:55], 0
    v_mov_b64 v[56:57], 0
    v_mov_b64 v[58:59], 0
    v_mov_b64 v[60:61], 0
    v_mov_b64 v[62:63], 0
    s_lshl_b32 s58, s30, 3
    s_add_u32 s58, s58, 159808
    v_mov_b32 v11, s58
    v_lshlrev_b32 v10, 3, v0
    v_add_u32 v10, 157696, v10
    v_cmp_eq_u32 vcc, 63, v0
    s_nop 1
    v_cndmask_b32 v10, v10, v11, vcc
    s_lshl_b32 s57, s30, 12
    v_lshlrev_b32 v7, 4, v0
    v_add_u32 v7, s57, v7
    v_add_u32 v7, 92160, v7
    v_mov_b32 v11, 128000
    s_setprio 1
    s_cmp_lt_u32 s30, 4
    s_cbranch_scc0 L_skip_176
    s_setprio 2
L_skip_176:
    s_cmp_eq_u32 s30, 6
    s_cbranch_scc0 L_qb_172
    v_and_b32 v16, 7, v0
    v_lshlrev_b32 v16, 3, v16
    buffer_load_dwordx2 v[8:9], v16, s[40:43], s60 offen sc1
    s_waitcnt vmcnt(0)
L_pw_177:
    v_max_u32 v18, v8, v9
    v_cmp_eq_u32 vcc, -1, v18
    s_cbranch_vccnz L_pr_178
    v_add_f32_dpp v8, v8, v8 row_ror:4 row_mask:0xf bank_mask:0xf
    v_add_f32_dpp v9, v9, v9 row_ror:4 row_mask:0xf bank_mask:0xf
    s_nop 0
    v_add_f32_dpp v8, v8, v8 row_ror:2 row_mask:0xf bank_mask:0xf
    v_add_f32_dpp v9, v9, v9 row_ror:2 row_mask:0xf bank_mask:0xf
    s_nop 0
    v_add_f32_dpp v8, v8, v8 row_ror:1 row_mask:0xf bank_mask:0xf
    v_add_f32_dpp v9, v9, v9 row_ror:1 row_mask:0xf bank_mask:0xf
    v_mul_f32 v8, 0x3acccccd, v8
    v_mul_f32 v9, 0x3acccccd, v9
    v_fma_f32 v9, -v8, v8, v9
    v_max_f32 v9, 0, v9
    v_add_f32 v9, 0x3727c5ac, v9
    v_rsq_f32 v9, v9
    s_nop 0
    v_mul_f32 v9, 0x3dd53b95, v9
    v_mul_f32 v8, -v8, v9
    ds_write_b64 v11, v[8:9]
    s_waitcnt lgkmcnt(0)
    s_branch L_qb_172
L_mr_181:
    s_sub_u32 s56, s56, 1
    s_cbranch_scc1 L_done
    s_branch L_mw_180
L_gs_182:
    buffer_store_dword v22, v23, s[40:43], s57 offen sc1
    s_branch L_gb_183
L_gs_184:
    buffer_store_dword v56, v3, s[40:43], s57 offen sc1
    s_branch L_gb_185
L_comb_1:
    s_lshl_b32 s57, s53, 3
    s_add_u32 s57, s57, s54
    s_lshl_b32 s57, s57, 2
    s_add_u32 s57, s57, s62
    s_add_u32 s57, s57, 55936
    v_add_u32 v23, s30, v0
    v_lshlrev_b32 v23, 24, v23
L_mw_180:
L_pad22:
    s_cbranch_execz L_padback
    ds_read_b64 v[38:39], v4 offset:64
    s_waitcnt lgkmcnt(0)
    v_cmp_eq_u32 vcc, -1, v39
    s_cbranch_vccnz L_mr_181
    v_max_f32_dpp v37, v38, v38 row_ror:4 row_mask:0xf bank_mask:0xf
    s_cmp_eq_u32 s55, 0
    s_nop 0
    v_max_f32_dpp v37, v37, v37 row_ror:2 row_mask:0xf bank_mask:0xf
    s_nop 1
    v_max_f32_dpp v37, v37, v37 row_ror:1 row_mask:0xf bank_mask:0xf
    v_sub_f32 v38, v38, v37
    v_exp_f32 v38, v38
    s_nop 0
    v_mul_f32 v39, v38, v39
    s_nop 1
    v_add_f32_dpp v39, v39, v39 row_ror:4 row_mask:0xf bank_mask:0xf
    s_nop 1
    v_add_f32_dpp v39, v39, v39 row_ror:2 row_mask:0xf bank_mask:0xf
    s_nop 1
    v_add_f32_dpp v39, v39, v39 row_ror:1 row_mask:0xf bank_mask:0xf
    v_rcp_f32 v21, v39
    v_log_f32 v22, v39
    v_mul_f32 v38, v38, v21
    v_add_f32 v22, v22, v37
    v_min_u32 v22, -2, v22
    s_cbranch_scc1 L_gs_182
    buffer_store_dword v22, v23, s[40:43], s57 offen
L_gb_183:
    v_readlane_b32 s64, v38, 0
    v_readlane_b32 s65, v38, 1
    v_readlane_b32 s66, v38, 2
    v_readlane_b32 s67, v38, 3
    v_readlane_b32 s68, v38, 4
    v_readlane_b32 s69, v38, 5
    v_readlane_b32 s70, v38, 6
    v_readlane_b32 s71, v38, 7
    s_mov_b32 s57, 12288
    s_cmp_eq_u32 s55, 0
    s_waitcnt lgkmcnt(0)
    s_barrier
    ds_read2st64_b64 v[40:43], v2 offset0:0 offset1:8
    ds_read2st64_b64 v[44:47], v2 offset0:16 offset1:24
    ds_read2st64_b64 v[48:51], v2 offset0:32 offset1:40
    ds_read2st64_b64 v[52:55], v2 offset0:48 offset1:56
    s_waitcnt lgkmcnt(3)
    v_pk_mul_f32 v[56:57], v[40:41], s[64:65] op_sel:[0,0] op_sel_hi:[1,0]
    v_pk_mul_f32 v[58:59], v[42:43], s[64:65] op_sel:[0,1] op_sel_hi:[1,1]
    s_waitcnt lgkmcnt(2)
    v_pk_fma_f32 v[56:57], v[44:45], s[66:67], v[56:57] op_sel:[0,0,0] op_sel_hi:[1,0,1]
    v_pk_fma_f32 v[58:59], v[46:47], s[66:67], v[58:59] op_sel:[0,1,0] op_sel_hi:[1,1,1]
    s_waitcnt lgkmcnt(1)
    v_pk_fma_f32 v[56:57], v[48:49], s[68:69], v[56:57] op_sel:[0,0,0] op_sel_hi:[1,0,1]
    v_pk_fma_f32 v[58:59], v[50:51], s[68:69], v[58:59] op_sel:[0,1,0] op_sel_hi:[1,1,1]
    s_waitcnt lgkmcnt(0)
    v_pk_fma_f32 v[56:57], v[52:53], s[70:71], v[56:57] op_sel:[0,0,0] op_sel_hi:[1,0,1]
    v_pk_fma_f32 v[58:59], v[54:55], s[70:71], v[58:59] op_sel:[0,1,0] op_sel_hi:[1,1,1]
    v_pk_add_f32 v[56:57], v[56:57], v[58:59]
    v_cvt_pk_bf16_f32 v56, v56, v57
    v_min_u32 v56, -2, v56
    s_cbranch_scc1 L_gs_184
    buffer_store_dword v56, v3, s[40:43], s57 offen
L_gb_185:
    s_branch L_comb_1b
L_pr_187:
    s_sub_u32 s56, s56, 1
    s_cbranch_scc1 L_done
    buffer_load_dword v18, v5, s[40:43], s59 offen sc1
    buffer_load_dwordx2 v[20:21], v22, s[40:43], s59 offen sc1
    s_waitcnt vmcnt(0)
    s_branch L_pw_186
L_pr_189:
    s_sub_u32 s56, s56, 1
    s_cbranch_scc1 L_done
    buffer_load_dwordx4 v[12:15], v9, s[40:43], s60 offen sc1
    buffer_load_dwordx2 v[16:17], v10, s[40:43], s60 offen offset:1024 sc1
    s_waitcnt vmcnt(0)
    s_branch L_pw_188
L_gs_192:
    buffer_store_dword v0, v34, s[40:43], s74 offen sc1
    s_branch L_gb_193
L_fin_190:
    s_cmp_eq_u32 s55, 0
    s_waitcnt lgkmcnt(0)
    s_barrier
    ds_read2st64_b32 v[12:13], v32 offset0:0 offset1:1
    ds_read2st64_b32 v[14:15], v32 offset0:2 offset1:3
    ds_read2st64_b32 v[16:17], v32 offset0:4 offset1:5
    ds_read2st64_b32 v[18:19], v32 offset0:6 offset1:7
    s_waitcnt lgkmcnt(2)
    v_pk_add_f32 v[12:13], v[12:13], v[14:15]
    s_waitcnt lgkmcnt(0)
L_pad23:
    s_cbranch_execz L_padback
    v_pk_add_f32 v[16:17], v[16:17], v[18:19]
    v_pk_add_f32 v[12:13], v[12:13], v[16:17]
    v_add_f32 v14, v12, v13
    v_add_f32 v15, v12, v13
    s_nop 1
    v_permlane16_swap_b32 v14, v15
    v_add_f32 v12, v14, v15
    v_min_u32 v12, -2, v12
    buffer_store_dword v12, v33, s[40:43], s58 offen sc1
    s_branch L_finb_191
L_pr_196:
    s_sub_u32 s56, s56, 1
    s_cbranch_scc1 L_done
    buffer_load_dwordx4 v[12:15], v11, s[40:43], s58 offen offset:0 sc1
    buffer_load_dwordx4 v[16:19], v11, s[40:43], s58 offen offset:1024 sc1
    buffer_load_dwordx4 v[20:23], v11, s[40:43], s58 offen offset:2048 sc1
    buffer_load_dwordx4 v[24:27], v11, s[40:43], s59 offen offset:0 sc1
    buffer_load_dwordx4 v[28:31], v11, s[40:43], s59 offen offset:1024 sc1
    buffer_load_dwordx4 v[32:35], v11, s[40:43], s59 offen offset:2048 sc1
    s_waitcnt vmcnt(0)
    s_branch L_pw_195
L_pr_198:
    s_sub_u32 s56, s56, 1
    s_cbranch_scc1 L_done
    buffer_load_dwordx2 v[2:3], v12, s[40:43], s57 offen sc1
    s_waitcnt vmcnt(0)
    s_branch L_pw_197
L_pr_202:
    s_sub_u32 s56, s56, 1
    s_cbranch_scc1 L_done
    buffer_load_dwordx4 v[12:15], v11, s[40:43], s58 offen offset:0 sc1
    buffer_load_dwordx4 v[16:19], v11, s[40:43], s58 offen offset:1024 sc1
    buffer_load_dwordx4 v[20:23], v11, s[40:43], s58 offen offset:2048 sc1
    buffer_load_dwordx4 v[24:27], v11, s[40:43], s59 offen offset:0 sc1
    buffer_load_dwordx4 v[28:31], v11, s[40:43], s59 offen offset:1024 sc1
    buffer_load_dwordx4 v[32:35], v11, s[40:43], s59 offen offset:2048 sc1
    s_waitcnt vmcnt(0)
    s_branch L_pw_201
L_hr_199:
    buffer_load_dwordx4 v[12:15], v11, s[40:43], s58 offen offset:0 sc1
    buffer_load_dwordx4 v[16:19], v11, s[40:43], s58 offen offset:1024 sc1
    buffer_load_dwordx4 v[20:23], v11, s[40:43], s58 offen offset:2048 sc1
    buffer_load_dwordx4 v[24:27], v11, s[40:43], s59 offen offset:0 sc1
    buffer_load_dwordx4 v[28:31], v11, s[40:43], s59 offen offset:1024 sc1
    buffer_load_dwordx4 v[32:35], v11, s[40:43], s59 offen offset:2048 sc1
    s_waitcnt vmcnt(0)
L_pw_201:
    v_max3_u32 v4, v12, v13, v14
    v_max3_u32 v4, v4, v15, v16
    v_max3_u32 v4, v4, v17, v18
    v_max3_u32 v4, v4, v19, v20
    v_max3_u32 v4, v4, v21, v22
    v_max3_u32 v4, v4, v23, v24
    v_max3_u32 v4, v4, v25, v26
    v_max3_u32 v4, v4, v27, v28
    v_max3_u32 v4, v4, v29, v30
    v_max3_u32 v4, v4, v31, v32
    v_max3_u32 v4, v4, v33, v34
    v_max_u32 v4, v4, v35
    v_cmp_eq_u32 vcc, -1, v4
    s_cbranch_vccnz L_pr_202
    v_pk_add_f32 v[12:13], v[12:13], v[14:15]
    v_pk_add_f32 v[16:17], v[16:17], v[18:19]
    v_pk_add_f32 v[12:13], v[12:13], v[16:17]
    v_add_f32 v12, v12, v13
    v_pk_add_f32 v[20:21], v[20:21], v[22:23]
    v_pk_add_f32 v[24:25], v[24:25], v[26:27]
    v_pk_add_f32 v[20:21], v[20:21], v[24:25]
    v_add_f32 v13, v20, v21
    v_pk_add_f32 v[28:29], v[28:29], v[30:31]
    v_pk_add_f32 v[32:33], v[32:33], v[34:35]
    v_pk_add_f32 v[28:29], v[28:29], v[32:33]
    v_add_f32 v14, v28, v29
    s_cmp_eq_u32 s55, 0
    s_branch L_hk_200
L_gs_203:
    buffer_store_dword v0, v5, s[40:43], s74 offen sc1
    s_branch L_gb_204
L_gs_208:
    buffer_store_dword v12, v34, s[40:43], s59 offen sc1
    s_branch L_gb_209
L_pr_211:
    s_sub_u32 s56, s56, 1
    s_cbranch_scc1 L_done
    buffer_load_dword v12, v9, s[40:43], s57 offen sc1
    s_waitcnt vmcnt(0)
    s_branch L_pw_210
L_gr_213:
    s_sub_u32 s56, s56, 1
    s_cbranch_scc1 L_done
    s_mov_b64 s[74:75], 0
L_pad24:
    s_cbranch_execz L_padback
    v_max3_u32 v30, v12, v13, v14
    v_max_u32 v30, v30, v15
    v_cmp_eq_u32 vcc, -1, v30
    s_cbranch_vccz L_gn_215
    s_or_b64 s[74:75], s[74:75], vcc
    s_mov_b64 exec, vcc
    buffer_load_dwordx4 v[12:15], v5, s[40:43], s57 offen sc1
    s_mov_b64 exec, -1
L_gn_215:
    v_max3_u32 v30, v16, v17, v18
    v_max_u32 v30, v30, v19
    v_cmp_eq_u32 vcc, -1, v30
    s_cbranch_vccz L_gn_216
    s_or_b64 s[74:75], s[74:75], vcc
    s_mov_b64 exec, vcc
    buffer_load_dwordx4 v[16:19], v5, s[40:43], s58 offen sc1
    s_mov_b64 exec, -1
L_gn_216:
    v_max3_u32 v30, v20, v21, v22
    v_max_u32 v30, v30, v23
    v_cmp_eq_u32 vcc, -1, v30
    s_cbranch_vccz L_gn_217
    s_or_b64 s[74:75], s[74:75], vcc
    s_mov_b64 exec, vcc
    buffer_load_dwordx4 v[20:23], v5, s[40:43], s59 offen sc1
    s_mov_b64 exec, -1
L_gn_217:
    v_max3_u32 v30, v24, v25, v26
    v_max_u32 v30, v30, v27
    v_cmp_eq_u32 vcc, -1, v30
    s_cbranch_vccz L_gn_218
    s_or_b64 s[74:75], s[74:75], vcc
    s_mov_b64 exec, vcc
    buffer_load_dwordx4 v[24:27], v5, s[40:43], s60 offen sc1
    s_mov_b64 exec, -1
L_gn_218:
    s_cmp_eq_u64 s[74:75], 0
    s_cbranch_scc1 L_gk_214
    s_waitcnt vmcnt(0)
    s_branch L_gw_212
L_gs_219:
    buffer_store_dword v27, v34, s[40:43], s67 offen sc1
    s_branch L_gb_220
L_w7_205:
    v_and_b32 v60, 31, v0
    v_min_u32 v60, 19, v60
    s_mul_i32 s57, s54, 320
    v_lshrrev_b32 v5, 5, v0
    v_mul_u32_u24 v5, 2560, v5
    v_add_u32 v5, s57, v5
    v_lshl_add_u32 v5, v60, 4, v5
    v_and_b32 v60, 31, v0
    v_cmp_gt_u32 s[64:65], 20, v60
    v_min_u32 v60, 19, v60
    v_lshrrev_b32 v35, 5, v0
    v_lshlrev_b32 v35, 2, v35
    v_add_u32 v35, 159936, v35
    v_lshl_add_u32 v35, v60, 3, v35
    s_add_u32 s66, s62, 43008
    s_add_u32 s67, s62, 55680
    s_lshl_b32 s57, s54, 3
    v_lshrrev_b32 v34, 5, v0
    v_lshlrev_b32 v34, 2, v34
    v_add_u32 v34, s57, v34
    v_and_b32 v60, 31, v0
    v_mov_b32 v61, 0x7f000000
    v_cmp_ne_u32 vcc, 31, v60
    s_nop 1
    v_cndmask_b32 v34, v34, v61, vcc
    v_mov_b32 v61, 0x3f803f80
    s_add_u32 s57, s62, 56320
    v_min_u32 v9, 19, v0
    v_lshlrev_b32 v9, 2, v9
    buffer_load_dword v12, v9, s[40:43], s57 offen sc1
    s_waitcnt vmcnt(0)
L_pw_210:
    v_cmp_eq_u32 vcc, -1, v12
    s_cbranch_vccnz L_pr_211
    s_mov_b32 s57, 1384448
    buffer_load_dwordx4 v[12:15], v5, s[40:43], s57 offen sc1
    s_mov_b32 s58, 1389568
    buffer_load_dwordx4 v[16:19], v5, s[40:43], s58 offen sc1
    s_mov_b32 s59, 1394688
    buffer_load_dwordx4 v[20:23], v5, s[40:43], s59 offen sc1
    s_mov_b32 s60, 1399808
    buffer_load_dwordx4 v[24:27], v5, s[40:43], s60 offen sc1
L_gw_212:
    s_waitcnt vmcnt(2)
    v_pk_add_f32 v[28:29], v[12:13], v[16:17]
    v_pk_add_f32 v[30:31], v[14:15], v[18:19]
    s_waitcnt vmcnt(1)
    v_pk_add_f32 v[28:29], v[28:29], v[20:21]
    v_pk_add_f32 v[30:31], v[30:31], v[22:23]
    s_waitcnt vmcnt(0)
    v_pk_add_f32 v[28:29], v[28:29], v[24:25]
    v_pk_add_f32 v[30:31], v[30:31], v[26:27]
    s_nop 1
    v_permlane32_swap_b32 v28, v30
    v_permlane32_swap_b32 v29, v31
    v_pk_add_f32 v[28:29], v[28:29], v[30:31]
L_pad25:
    s_cbranch_execz L_padback
    v_pk_add_f32 v[28:29], v[28:29], v[2:3]
    v_cmp_u_f32 vcc, v28, v29
    s_cbranch_vccnz L_gr_213
L_gk_214:
    v_cvt_pk_bf16_f32 v28, v28, v29
    ds_write_b32 v35, v28
    s_waitcnt lgkmcnt(0)
    s_barrier
    v_cndmask_b32 v29, 0, v28, s[64:65]
    v_dot2_f32_bf16 v27, v29, v61, 0
    v_dot2_f32_bf16 v62, v29, v29, 0
    v_lshlrev_b32 v2, 16, v28
    v_and_b32 v3, 0xffff0000, v28
    s_cmp_eq_u32 s55, 0
    v_permlane32_swap_b32 v27, v62
    v_add_f32 v27, v27, v62
    s_nop 1
    v_add_f32_dpp v27, v27, v27 row_ror:8 row_mask:0xf bank_mask:0xf
    s_nop 1
    v_add_f32_dpp v27, v27, v27 row_ror:4 row_mask:0xf bank_mask:0xf
    s_nop 1
    v_add_f32_dpp v27, v27, v27 row_ror:2 row_mask:0xf bank_mask:0xf
    s_nop 1
    v_add_f32_dpp v27, v27, v27 row_ror:1 row_mask:0xf bank_mask:0xf
    s_nop 1
    v_add_f32_dpp v27, v27, v27 row_bcast:15 row_mask:0xa bank_mask:0xf
    v_min_u32 v27, -2, v27
    s_cbranch_scc1 L_gs_219
    buffer_store_dword v27, v34, s[40:43], s67 offen
L_gb_220:
    s_branch L_se_206
L_pr_222:
    s_sub_u32 s56, s56, 1
    s_cbranch_scc1 L_done
    buffer_load_dword v12, v9, s[40:43], s57 offen sc1
    s_waitcnt vmcnt(0)
    s_branch L_pw_221
L_gr_224:
    s_sub_u32 s56, s56, 1
    s_cbranch_scc1 L_done
    s_mov_b64 s[74:75], 0
    v_max3_u32 v30, v12, v13, v14
    v_max_u32 v30, v30, v15
    v_cmp_eq_u32 vcc, -1, v30
    s_cbranch_vccz L_gn_226
    s_or_b64 s[74:75], s[74:75], vcc
    s_mov_b64 exec, vcc
    buffer_load_dwordx4 v[12:15], v5, s[40:43], s57 offen sc1
    s_mov_b64 exec, -1
L_gn_226:
    v_max3_u32 v30, v16, v17, v18
    v_max_u32 v30, v30, v19
    v_cmp_eq_u32 vcc, -1, v30
    s_cbranch_vccz L_gn_227
    s_or_b64 s[74:75], s[74:75], vcc
    s_mov_b64 exec, vcc
    buffer_load_dwordx4 v[16:19], v5, s[40:43], s58 offen sc1
    s_mov_b64 exec, -1
L_gn_227:
    v_max3_u32 v30, v20, v21, v22
    v_max_u32 v30, v30, v23
    v_cmp_eq_u32 vcc, -1, v30
    s_cbranch_vccz L_gn_228
    s_or_b64 s[74:75], s[74:75], vcc
    s_mov_b64 exec, vcc
    buffer_load_dwordx4 v[20:23], v5, s[40:43], s59 offen sc1
    s_mov_b64 exec, -1
L_gn_228:
    v_max3_u32 v30, v24, v25, v26
    v_max_u32 v30, v30, v27
    v_cmp_eq_u32 vcc, -1, v30
    s_cbranch_vccz L_gn_229
    s_or_b64 s[74:75], s[74:75], vcc
    s_mov_b64 exec, vcc
    buffer_load_dwordx4 v[24:27], v5, s[40:43], s60 offen sc1
    s_mov_b64 exec, -1
L_gn_229:
    s_cmp_eq_u64 s[74:75], 0
    s_cbranch_scc1 L_gk_225
    s_waitcnt vmcnt(0)
    s_branch L_gw_223
L_tail_end:
L_spread:
    s_add_u32 s62, s62, 671744
    s_cmp_eq_u32 s30, 5
    s_cbranch_scc0 L_skip_59
    v_mov_b64 v[12:13], -1
    v_mov_b64 v[14:15], -1
    v_lshlrev_b32 v16, 4, v0
    s_mul_i32 s57, s52, 1792
    s_add_u32 s57, s57, s62
    s_mov_b32 exec_lo, 0xffffffff
    s_mov_b32 exec_hi, 0xffff
    buffer_store_dwordx4 v[12:15], v16, s[40:43], s57 offen offset:1024 sc1
    s_mov_b64 exec, -1
    buffer_store_dwordx4 v[12:15], v16, s[40:43], s57 offen sc1
L_skip_59:
    s_cmp_eq_u32 s30, 7
    s_cbranch_scc0 L_skip_60
    v_and_b32 v60, 31, v0
    v_cmp_gt_u32 s[64:65], 20, v60
    v_min_u32 v60, 19, v60
    v_lshrrev_b32 v35, 5, v0
    v_lshlrev_b32 v35, 2, v35
    v_add_u32 v35, 159936, v35
    v_lshl_add_u32 v35, v60, 3, v35
    s_mul_i32 s66, s53, 6400
    s_add_u32 s66, s66, s62
    s_add_u32 s66, s66, 57344
    s_add_u32 s67, s66, 6144
    s_lshl_b32 s57, s54, 3
    v_lshrrev_b32 v34, 5, v0
    v_lshlrev_b32 v34, 2, v34
    v_add_u32 v34, s57, v34
    v_and_b32 v60, 31, v0
    v_mov_b32 v61, 0x7f000000
    v_cmp_ne_u32 vcc, 31, v60
    s_nop 1
    v_cndmask_b32 v34, v34, v61, vcc
    v_mov_b32 v61, 0x3f803f80
    v_cvt_pk_bf16_f32 v28, v2, v3
L_skip_60:
    s_cmp_eq_u32 s30, 7
    s_cbranch_scc0 L_skip_61
    v_cndmask_b32 v29, 0, v28, s[64:65]
    v_dot2_f32_bf16 v27, v29, v61, 0
    v_dot2_f32_bf16 v62, v29, v29, 0
    v_lshlrev_b32 v2, 16, v28
    v_and_b32 v3, 0xffff0000, v28
    s_cmp_eq_u32 s55, 0
    v_permlane32_swap_b32 v27, v62
    v_add_f32 v27, v27, v62
    s_nop 1
    v_add_f32_dpp v27, v27, v27 row_ror:8 row_mask:0xf bank_mask:0xf
    s_nop 1
    v_add_f32_dpp v27, v27, v27 row_ror:4 row_mask:0xf bank_mask:0xf
    s_nop 1
    v_add_f32_dpp v27, v27, v27 row_ror:2 row_mask:0xf bank_mask:0xf
    s_nop 1
    v_add_f32_dpp v27, v27, v27 row_ror:1 row_mask:0xf bank_mask:0xf
    s_nop 1
    v_add_f32_dpp v27, v27, v27 row_bcast:15 row_mask:0xa bank_mask:0xf
    v_min_u32 v27, -2, v27
    s_cbranch_scc1 L_gs_62
    buffer_store_dword v27, v34, s[40:43], s67 offen
L_gb_63:
L_skip_61:
    s_cmp_lt_u32 s30, 6
    s_cbranch_scc0 L_skip_64
    s_lshr_b32 s57, s30, 1
    s_mul_i32 s57, s57, 1024
    s_and_b32 s58, s30, 1
    s_lshl_b32 s58, s58, 6
    s_add_u32 s57, s57, s58
    v_lshrrev_b32 v18, 5, v0
    v_mul_u32_u24 v18, 6144, v18
    v_bfe_u32 v60, v0, 3, 1
    v_mul_u32_u24 v60, 3072, v60
    v_add_u32 v18, v60, v18
    v_bfe_u32 v60, v0, 4, 1
    v_lshl_add_u32 v18, v60, 9, v18
    v_bfe_u32 v60, v0, 2, 1
    v_lshl_add_u32 v18, v60, 7, v18
    v_and_b32 v60, 3, v0
    v_lshl_add_u32 v18, v60, 3, v18
    v_add_u32 v18, s57, v18
    v_bfe_u32 v19, v0, 4, 1
    v_mul_u32_u24 v19, 3072, v19
    v_bfe_u32 v60, v0, 3, 1
    v_lshl_add_u32 v19, v60, 9, v19
    v_bfe_u32 v60, v0, 2, 1
    v_lshl_add_u32 v19, v60, 7, v19
    v_and_b32 v60, 3, v0
    v_lshl_add_u32 v19, v60, 3, v19
    v_add_u32 v19, s57, v19
    v_add_u32 v19, 24576, v19
    ds_read_b64_tr_b16 v[36:37], v18 offset:0
    ds_read_b64_tr_b16 v[38:39], v18 offset:256
    ds_read_b64_tr_b16 v[40:41], v18 offset:12288
    ds_read_b64_tr_b16 v[42:43], v18 offset:12544
    ds_read_b64_tr_b16 v[44:45], v19 offset:0
    ds_read_b64_tr_b16 v[46:47], v19 offset:256
    ds_read_b64_tr_b16 v[48:49], v18 offset:32
    ds_read_b64_tr_b16 v[50:51], v18 offset:288
    ds_read_b64_tr_b16 v[52:53], v18 offset:12320
    ds_read_b64_tr_b16 v[54:55], v18 offset:12576
    ds_read_b64_tr_b16 v[56:57], v19 offset:32
    ds_read_b64_tr_b16 v[58:59], v19 offset:288
    v_lshrrev_b32 v32, 4, v0
    v_lshlrev_b32 v32, 5, v32
    v_bfe_u32 v60, v0, 1, 1
    v_lshl_add_u32 v32, v60, 4, v32
    v_and_b32 v60, 1, v0
    v_mul_u32_u24 v60, 192, v60
    v_add_u32 v32, v60, v32
    v_add_u32 v32, 159936, v32
    v_lshrrev_b32 v33, 4, v0
    v_lshlrev_b32 v33, 4, v33
    v_bfe_u32 v60, v0, 1, 1
    v_lshl_add_u32 v33, v60, 3, v33
    v_and_b32 v60, 1, v0
    v_mul_u32_u24 v60, 192, v60
    v_add_u32 v33, v60, v33
    v_add_u32 v33, 160064, v33
    v_mov_b64 v[24:25], 0
    v_mov_b64 v[26:27], 0
    v_mov_b64 v[28:29], 0
    v_mov_b64 v[30:31], 0
    s_lshr_b32 s57, s54, 1
    s_lshl_b32 s57, s57, 2
    s_and_b32 s58, s54, 1
    s_add_u32 s57, s57, s58
    s_lshl_b32 s57, s57, 4
    s_lshl_b32 s58, s30, 9
    s_add_u32 s57, s57, s58
    v_bfe_u32 v34, v0, 4, 1
    v_lshlrev_b32 v34, 8, v34
    v_bfe_u32 v60, v0, 1, 1
    v_lshl_add_u32 v34, v60, 5, v34
    v_bfe_u32 v60, v0, 2, 2
    v_lshl_add_u32 v34, v60, 2, v34
    v_lshrrev_b32 v60, 5, v0
    v_mul_u32_u24 v60, 3072, v60
    v_add_u32 v34, v60, v34
    v_and_b32 v60, 1, v0
    v_lshl_add_u32 v34, v60, 30, v34
    v_add_u32 v34, s57, v34
    s_mul_i32 s59, s53, 6400
    s_add_u32 s59, s59, s62
    s_add_u32 s59, s59, 57344
    s_add_u32 s60, s59, 6144
    ds_read_b128 v[12:15], v32
    ds_read_b64 v[16:17], v33
    s_waitcnt lgkmcnt(1)
    v_smfmac_f32_16x16x64_bf16 v[24:27], v[12:15], v[36:43], v1
    v_smfmac_f32_16x16x64_bf16 v[28:31], v[12:15], v[48:55], v1
    s_waitcnt lgkmcnt(0)
    v_smfmac_f32_16x16x32_bf16 v[24:27], v[16:17], v[44:47], v1
    v_smfmac_f32_16x16x32_bf16 v[28:31], v[16:17], v[56:59], v1
    s_cmp_eq_u32 s55, 0
    s_nop 5
    v_add_f32 v12, v24, v26
    s_nop 1
    v_add_f32_dpp v12, v28, v30 quad_perm:[0,1,2,3] row_mask:0x2 bank_mask:0xf
    s_nop 1
    v_add_f32_dpp v12, v25, v27 quad_perm:[0,1,2,3] row_mask:0x4 bank_mask:0xf
    s_nop 1
    v_add_f32_dpp v12, v29, v31 quad_perm:[0,1,2,3] row_mask:0x8 bank_mask:0xf
    s_nop 1
    v_mov_b32_dpp v13, v12 row_shl:1 row_mask:0xf bank_mask:0xf bound_ctrl:0
    v_cvt_pk_bf16_f32 v12, v12, v13
    v_min_u32 v12, -2, v12
    s_cbranch_scc1 L_gs_65
    buffer_store_dword v12, v34, s[40:43], s59 offen
L_gb_66:
L_skip_64:
    s_waitcnt vmcnt(0)
    s_barrier
    s_cmp_eq_u32 s30, 5
    s_cbranch_scc0 L_skip_67
    s_lshl_b32 s57, s52, 2
    s_add_u32 s57, s57, s72
    s_mov_b64 exec, 1
    buffer_store_dword v0, v0, s[40:43], s57 offen offset:256 sc1
    s_mov_b64 exec, -1
    v_and_b32 v16, 31, v0
    v_lshlrev_b32 v16, 2, v16
    buffer_load_dword v17, v16, s[40:43], s72 offen offset:256 sc1
    s_waitcnt vmcnt(0)
L_pw_68:
    v_cmp_eq_u32 vcc, -1, v17
    s_cbranch_vccnz L_pr_69
L_skip_67:
    s_barrier
    s_branch L_spread_back
L_done:
L_exit:
    s_endpgm
.section .rodata,"a"
.p2align 6
.amdhsa_kernel interleave_layers__sliding_block_cached__dense_activation_gelu__decode_kernel
  .amdhsa_next_free_vgpr 256
  .amdhsa_next_free_sgpr 102
  .amdhsa_accum_offset 256
  .amdhsa_group_segment_fixed_size 0
  .amdhsa_kernarg_size 104
  .amdhsa_user_sgpr_count 2
  .amdhsa_user_sgpr_kernarg_segment_ptr 1
  .amdhsa_system_sgpr_workgroup_id_x 1
  .amdhsa_float_denorm_mode_32 3
.end_amdhsa_kernel
```

```asm
; @launch grid=(256,1,1) block=(512,1,1) lds=161216
.amdgcn_target "amdgcn-amd-amdhsa--gfx950"
.text
.fill 64, 4, 0xbf800000
.globl interleave_layers__sliding_block_cached__dense_activation_gelu__decode_kernel
.p2align 8
.type interleave_layers__sliding_block_cached__dense_activation_gelu__decode_kernel,@function
interleave_layers__sliding_block_cached__dense_activation_gelu__decode_kernel:
    s_load_dwordx16 s[4:19], s[0:1], 0
    s_load_dwordx8 s[20:27], s[0:1], 64
    s_load_dwordx2 s[28:29], s[0:1], 96
    s_cmp_ge_u32 s2, 256
    s_cbranch_scc1 L_exit
    s_getpc_b64 s[74:75]
L_pc:
    v_lshlrev_b32 v5, 6, v0
    v_min_u32 v5, L_exit-L_pc, v5
    global_load_dword v59, v5, s[74:75]
    v_lshrrev_b32 v5, 6, v0
    v_and_b32 v0, 63, v0
    v_readfirstlane_b32 s30, v5
    s_and_b32 s31, s2, 7
    s_lshr_b32 s52, s2, 3
    s_and_b32 s53, s52, 3
    s_lshr_b32 s54, s52, 2
    s_lshl_b32 s73, s31, 2
    s_add_u32 s73, s73, s53
    s_mul_i32 s3, s54, 3
    s_add_u32 s3, s3, s53
    s_cmp_eq_u32 s53, 3
    s_cselect_b32 s3, 31, s3
    v_lshrrev_b32 v8, 5, v0
    v_lshlrev_b32 v8, 2, v8
    v_bfe_u32 v60, v0, 4, 1
    v_lshl_add_u32 v8, v60, 0, v8
    v_and_b32 v9, 7, v0
    v_xor_b32 v8, v8, v9
    v_lshrrev_b32 v10, 3, v0
    v_mul_u32_u24 v10, 384, v10
    v_lshl_add_u32 v5, v8, 4, v10
    v_xor_b32 v6, 32, v5
    v_lshrrev_b32 v8, 4, v0
    v_lshlrev_b32 v8, 1, v8
    v_xor_b32 v8, v8, v9
    v_lshl_add_u32 v7, v8, 4, v10
    v_lshrrev_b32 v2, 3, v0
    v_mul_u32_u24 v2, 12288, v2
    v_and_b32 v60, 7, v0
    v_lshl_add_u32 v2, v60, 4, v2
    s_mul_i32 s57, s73, 12582912
    s_mul_i32 s58, s54, 3072
    s_add_u32 s57, s57, s58
    s_add_u32 s57, s57, 11010048
    s_sub_u32 s58, 1572864, s58
    s_mul_i32 s59, s73, 384
    s_mul_i32 s60, s54, 983040
    s_add_u32 s59, s59, s60
    s_sub_u32 s60, 7866368, s59
    s_lshl_b32 s61, s30, 11
    s_add_u32 s61, s61, 92160
    s_mul_i32 s62, s31, 83968
    s_lshl_b32 s72, s31, 9
    s_add_u32 s72, s72, 1900544
    s_mov_b32 s56, 65536
    s_mov_b32 s55, 1
    s_getreg_b32 s63, hwreg(20, 0, 3)
    v_mov_b32 v3, 0
    v_mov_b32 v24, 0
    v_mov_b32 v34, 0
    v_mov_b64 v[12:13], -1
    v_mov_b64 v[14:15], -1
    v_lshlrev_b32 v10, 4, v0
    s_waitcnt lgkmcnt(0)
    s_add_u32 s32, s6, s57
    s_addc_u32 s33, s7, 0
    s_mov_b32 s34, s58
    s_mov_b32 s35, 0x20000
    s_add_u32 s36, s8, s57
    s_addc_u32 s37, s9, 0
    s_mov_b32 s38, s58
    s_mov_b32 s39, 0x20000
    s_mov_b32 s40, s28
    s_mov_b32 s41, s29
    s_mov_b32 s42, 1904640
    s_mov_b32 s43, 0x20000
    s_add_u32 s44, s10, s59
    s_addc_u32 s45, s11, 0
    s_mov_b32 s46, s60
    s_mov_b32 s47, 0x20000
    s_sub_u32 s44, s44, 2048
    s_subb_u32 s45, s45, 0
    s_cmp_eq_u32 s30, 6
    s_cbranch_scc0 L_skip_1
    s_setprio 3
    s_mov_b32 s57, 0
    s_mov_b32 s58, 195584
    s_mov_b32 m0, 92160
L_dma_2:
    s_waitcnt vmcnt(25)
    buffer_load_dwordx4 v5, s[32:35], s57 offen offset:0 nt lds
    s_waitcnt vmcnt(25)
    buffer_load_dwordx4 v6, s[32:35], s58 offen offset:1024 nt lds
    s_add_u32 s57, s57, 24576
    s_add_u32 s58, s58, 24576
    s_add_u32 m0, m0, 2048
    s_cmp_lg_u32 m0, 108544
    s_cbranch_scc1 L_dma_2
    s_mov_b32 s57, 128
    s_mov_b32 s58, 195712
    s_mov_b32 m0, 108544
L_dma_3:
    s_waitcnt vmcnt(25)
    buffer_load_dwordx4 v5, s[32:35], s57 offen offset:0 nt lds
    s_waitcnt vmcnt(25)
    buffer_load_dwordx4 v6, s[32:35], s58 offen offset:1024 nt lds
    s_add_u32 s57, s57, 24576
    s_add_u32 s58, s58, 24576
    s_add_u32 m0, m0, 2048
    s_cmp_lg_u32 m0, 124928
    s_cbranch_scc1 L_dma_3
    s_mov_b32 s57, 2048
    s_mov_b32 s58, 1152
    s_mov_b32 s59, 256
    s_mov_b32 m0, 0
L_dma_4:
    s_waitcnt vmcnt(25)
    buffer_load_dwordx4 v2, s[44:47], s57 offen offset:0 nt lds
    s_waitcnt vmcnt(25)
    buffer_load_dwordx4 v2, s[44:47], s58 offen offset:1024 nt lds
    s_waitcnt vmcnt(25)
    buffer_load_dwordx4 v2, s[44:47], s59 offen offset:2048 nt lds
    s_add_u32 s57, s57, 98304
    s_add_u32 s58, s58, 98304
    s_add_u32 s59, s59, 98304
    s_add_u32 m0, m0, 3072
    s_cmp_lg_u32 m0, 15360
    s_cbranch_scc1 L_dma_4
L_skip_1:
    s_cmp_lt_u32 s3, 20
    s_cselect_b32 s57, 7864320, 0
    s_add_u32 s58, s54, 1
    s_mul_i32 s58, s58, 245760
    s_cmp_lg_u32 s53, 3
    s_cselect_b64 s[48:49], s[12:13], s[16:17]
    s_cselect_b32 s50, s57, s58
    s_mov_b32 s51, 0x20000
    s_add_u32 s57, s28, 1343488
    s_sub_u32 s57, 0, s57
    s_and_b32 s57, s57, 0x7fff
    s_add_u32 s57, s57, 1343488
    s_lshr_b32 s58, s31, 1
    s_lshl_b32 s58, s58, 15
    s_add_u32 s6, s57, s58
    s_and_b32 s58, s31, 1
    s_mul_i32 s58, s58, 2560
    s_add_u32 s6, s6, s58
    s_lshl_b32 s58, s3, 7
    s_add_u32 s6, s6, s58
    s_lshr_b32 s58, s63, 2
    s_mul_i32 s58, s58, 8192
    s_add_u32 s7, s57, s58
    s_cmp_eq_u32 s30, 5
    s_cbranch_scc0 L_skip_5
    s_cmp_eq_u32 s52, 31
    s_cbranch_scc0 L_skip_6
    s_mov_b64 exec, 0xffffff
    buffer_store_dwordx4 v[12:15], v10, s[40:43], s72 offen sc1
    s_mov_b64 exec, -1
L_skip_6:
    s_cmp_lt_u32 s3, 20
    s_cbranch_scc0 L_skip_7
    v_bfe_u32 v16, v0, 3, 2
    v_lshlrev_b32 v16, 17, v16
    v_and_b32 v60, 7, v0
    v_lshl_add_u32 v16, v60, 4, v16
    v_lshrrev_b32 v60, 5, v0
    v_lshl_add_u32 v16, v60, 13, v16
    buffer_store_dwordx4 v[12:15], v16, s[40:43], s6 offen sc1
L_skip_7:
    s_mul_i32 s57, s52, 1792
    s_add_u32 s57, s57, s62
    s_mov_b32 exec_lo, 0xffffffff
    s_mov_b32 exec_hi, 0xffff
    buffer_store_dwordx4 v[12:15], v10, s[40:43], s57 offen offset:1024
    s_mov_b64 exec, -1
    buffer_store_dwordx4 v[12:15], v10, s[40:43], s57 offen
    s_mov_b64 exec, -1
    v_lshlrev_b32 v16, 4, v0
    v_add_u32 v16, 159744, v16
    ds_write_b128 v16, v[12:15]
    v_subrev_u32 v16, 8, v0
    v_cmp_gt_u32 vcc, 40, v16
    v_mov_b32 v16, 0x3f803f80
    s_nop 0
    v_cndmask_b32 v18, 0, v16, vcc
    v_min_u32 v16, 55, v0
    v_lshlrev_b32 v16, 2, v16
    v_add_u32 v16, 160992, v16
    ds_write_b32 v16, v18
    v_and_b32 v3, 7, v0
    v_lshlrev_b32 v3, 5, v3
L_skip_5:
    s_cmp_eq_u32 s30, 7
    s_cbranch_scc0 L_skip_8
    v_and_b32 v60, 31, v0
    v_min_u32 v60, 19, v60
    s_mul_i32 s57, s54, 160
    v_lshrrev_b32 v16, 5, v0
    v_lshlrev_b32 v16, 2, v16
    v_add_u32 v16, s57, v16
    v_lshl_add_u32 v16, v60, 3, v16
    global_load_dword v28, v16, s[4:5]
    global_load_dword v4, v16, s[22:23]
L_skip_8:
    v_bfe_u32 v8, v0, 1, 3
    v_lshrrev_b32 v9, 4, v0
    v_xor_b32 v9, v8, v9
    v_bfe_u32 v8, v0, 2, 1
    v_lshlrev_b32 v8, 10, v8
    v_bfe_u32 v60, v0, 3, 1
    v_lshl_add_u32 v8, v60, 9, v8
    v_and_b32 v60, 3, v0
    v_lshl_add_u32 v8, v60, 7, v8
    v_add_u32 v8, s61, v8
    v_lshl_add_u32 v8, v9, 4, v8
    v_xor_b32 v9, 64, v8
    v_bfe_u32 v1, v0, 1, 1
    v_mul_u32_u24 v1, 43690, v1
    v_add_u32 v1, 17476, v1
    s_waitcnt vmcnt(31)
    s_barrier
    ds_read_b128 v[64:67], v8 offset:0
    ds_read_b128 v[68:71], v9 offset:0
    s_cmp_eq_u32 s30, 6
    s_cbranch_scc0 L_skip_9
    s_mov_b32 s57, 256
    s_mov_b32 s58, 195840
    s_mov_b32 m0, 124928
L_dma_10:
    s_waitcnt vmcnt(25)
    buffer_load_dwordx4 v5, s[32:35], s57 offen offset:0 nt lds
    s_waitcnt vmcnt(25)
    buffer_load_dwordx4 v6, s[32:35], s58 offen offset:1024 nt lds
    s_add_u32 s57, s57, 24576
    s_add_u32 s58, s58, 24576
    s_add_u32 m0, m0, 2048
    s_cmp_lg_u32 m0, 141312
    s_cbranch_scc1 L_dma_10
L_skip_9:
    s_waitcnt lgkmcnt(0)
    s_cmp_eq_u32 s30, 5
    s_cbranch_scc0 L_skip_11
    s_cmp_eq_u32 s52, 31
    s_cbranch_scc0 L_skip_12
    s_lshl_b32 s57, s31, 5
    v_mov_b32 v16, s57
    s_add_u32 s57, s63, 1
    v_mov_b32 v12, s57
    s_waitcnt vmcnt(2)
    s_mov_b64 exec, 0x1
    global_store_dword v16, v12, s[26:27] sc1
    s_mov_b64 exec, -1
L_skip_12:
L_skip_11:
    s_waitcnt vmcnt(31)
    s_barrier
    ds_read_b128 v[72:75], v8 offset:16384
    ds_read_b128 v[76:79], v9 offset:16384
    s_cmp_eq_u32 s30, 6
    s_cbranch_scc0 L_skip_13
    s_mov_b32 s57, 493568
    s_mov_b32 s58, 492672
    s_mov_b32 s59, 491776
    s_mov_b32 m0, 15360
L_dma_14:
    s_waitcnt vmcnt(25)
    buffer_load_dwordx4 v2, s[44:47], s57 offen offset:0 nt lds
    s_waitcnt vmcnt(25)
    buffer_load_dwordx4 v2, s[44:47], s58 offen offset:1024 nt lds
    s_waitcnt vmcnt(25)
    buffer_load_dwordx4 v2, s[44:47], s59 offen offset:2048 nt lds
    s_add_u32 s57, s57, 98304
    s_add_u32 s58, s58, 98304
    s_add_u32 s59, s59, 98304
    s_add_u32 m0, m0, 3072
    s_cmp_lg_u32 m0, 30720
    s_cbranch_scc1 L_dma_14
    s_mov_b32 s57, 393216
    s_mov_b32 s58, 588800
    s_mov_b32 m0, 141312
L_dma_15:
    s_waitcnt vmcnt(25)
    buffer_load_dwordx4 v5, s[32:35], s57 offen offset:0 nt lds
    s_waitcnt vmcnt(25)
    buffer_load_dwordx4 v6, s[32:35], s58 offen offset:1024 nt lds
    s_add_u32 s57, s57, 24576
    s_add_u32 s58, s58, 24576
    s_add_u32 m0, m0, 2048
    s_cmp_lg_u32 m0, 157696
    s_cbranch_scc1 L_dma_15
L_skip_13:
    s_waitcnt lgkmcnt(0)
    s_waitcnt vmcnt(31)
    s_barrier
    ds_read_b128 v[80:83], v8 offset:32768
    ds_read_b128 v[84:87], v9 offset:32768
    s_cmp_eq_u32 s30, 6
    s_cbranch_scc0 L_skip_16
    s_cmp_lg_u32 s53, 3
    s_cbranch_scc0 L_wb_17
    s_mul_i32 s57, s31, 983040
    s_lshl_b32 s58, s3, 6
    s_add_u32 s57, s57, s58
    v_bfe_u32 v38, v0, 4, 1
    v_lshlrev_b32 v38, 1, v38
    v_xor_b32 v38, v38, v0
    v_and_b32 v38, 3, v38
    v_lshrrev_b32 v3, 5, v0
    v_mul_u32_u24 v3, 10240, v3
    v_bfe_u32 v39, v0, 4, 1
    v_mul_u32_u24 v39, 2560, v39
    v_add_u32 v3, v39, v3
    v_bfe_u32 v39, v0, 3, 1
    v_mul_u32_u24 v39, 5120, v39
    v_add_u32 v3, v39, v3
    v_bfe_u32 v39, v0, 2, 1
    v_mul_u32_u24 v39, 20480, v39
    v_add_u32 v3, v39, v3
    v_add_u32 v3, s57, v3
    v_lshl_add_u32 v3, v38, 4, v3
    s_mov_b32 s14, 40960
    s_mov_b32 s15, 256
    s_branch L_we_18
L_wb_17:
    s_mul_i32 s57, s31, 384
    s_mul_i32 s58, s54, 245760
    s_add_u32 s57, s57, s58
    v_lshlrev_b32 v3, 4, v0
    v_add_u32 v3, s57, v3
    v_mov_b32 v38, 2688
    v_cmp_lt_u32 vcc, 23, v0
    s_nop 1
    v_cndmask_b32 v38, 0, v38, vcc
    v_add_u32 v3, v38, v3
    v_mov_b32 v38, 0x7f000000
    v_cmp_lt_u32 vcc, 47, v0
    s_nop 1
    v_cndmask_b32 v3, v3, v38, vcc
    s_mov_b32 s14, 12288
    s_mov_b32 s15, 5120
L_we_18:
    s_mul_i32 s57, s14, 0
    s_mov_b32 m0, 30720
    s_waitcnt vmcnt(25)
    buffer_load_dwordx4 v3, s[48:51], s57 offen offset:0 nt lds
    s_mul_i32 s57, s14, 0
    s_add_u32 s57, s57, s15
    s_mov_b32 m0, 30720
    s_waitcnt vmcnt(25)
    buffer_load_dwordx4 v3, s[48:51], s57 offen offset:1024 nt lds
    s_mov_b32 s57, 393344
    s_mov_b32 s58, 588928
    s_mov_b32 m0, 92160
L_dma_19:
    s_waitcnt vmcnt(25)
    buffer_load_dwordx4 v5, s[32:35], s57 offen offset:0 nt lds
    s_waitcnt vmcnt(25)
    buffer_load_dwordx4 v6, s[32:35], s58 offen offset:1024 nt lds
    s_add_u32 s57, s57, 24576
    s_add_u32 s58, s58, 24576
    s_add_u32 m0, m0, 2048
    s_cmp_lg_u32 m0, 108544
    s_cbranch_scc1 L_dma_19
    s_mul_i32 s57, s14, 1
    s_mov_b32 m0, 32768
    s_waitcnt vmcnt(25)
    buffer_load_dwordx4 v3, s[48:51], s57 offen offset:0 nt lds
    s_mul_i32 s57, s14, 1
    s_add_u32 s57, s57, s15
    s_mov_b32 m0, 32768
    s_waitcnt vmcnt(25)
    buffer_load_dwordx4 v3, s[48:51], s57 offen offset:1024 nt lds
    s_mov_b32 s57, 393472
    s_mov_b32 s58, 589056
    s_mov_b32 m0, 108544
L_dma_20:
    s_waitcnt vmcnt(25)
    buffer_load_dwordx4 v5, s[32:35], s57 offen offset:0 nt lds
    s_waitcnt vmcnt(25)
    buffer_load_dwordx4 v6, s[32:35], s58 offen offset:1024 nt lds
    s_add_u32 s57, s57, 24576
    s_add_u32 s58, s58, 24576
    s_add_u32 m0, m0, 2048
    s_cmp_lg_u32 m0, 124928
    s_cbranch_scc1 L_dma_20
L_skip_16:
    s_waitcnt lgkmcnt(0)
    s_cmp_eq_u32 s30, 7
    s_cbranch_scc0 L_skip_21
    v_and_b32 v60, 31, v0
    v_cmp_gt_u32 s[64:65], 20, v60
    v_min_u32 v60, 19, v60
    v_lshrrev_b32 v35, 5, v0
    v_lshlrev_b32 v35, 2, v35
    v_add_u32 v35, 160832, v35
    v_lshl_add_u32 v35, v60, 3, v35
    s_mul_i32 s66, s53, 6400
    s_add_u32 s66, s66, s62
    s_add_u32 s66, s66, 57344
    s_add_u32 s67, s66, 6144
    s_lshl_b32 s57, s54, 3
    v_lshrrev_b32 v34, 5, v0
    v_lshlrev_b32 v34, 2, v34
    v_add_u32 v34, s57, v34
    v_and_b32 v60, 31, v0
    v_mov_b32 v61, 0x7f000000
    v_cmp_ne_u32 vcc, 31, v60
    s_nop 1
    v_cndmask_b32 v34, v34, v61, vcc
    v_mov_b32 v61, 0x3f803f80
    s_waitcnt vmcnt(0)
    ds_write_b32 v35, v28
    s_waitcnt lgkmcnt(0)
L_skip_21:
    s_waitcnt vmcnt(36)
    s_barrier
    ds_read_b128 v[88:91], v8 offset:49152
    ds_read_b128 v[92:95], v9 offset:49152
    s_cmp_eq_u32 s30, 6
    s_cbranch_scc0 L_skip_22
    s_mul_i32 s57, s14, 2
    s_mov_b32 m0, 34816
    s_waitcnt vmcnt(25)
    buffer_load_dwordx4 v3, s[48:51], s57 offen offset:0 nt lds
    s_mul_i32 s57, s14, 2
    s_add_u32 s57, s57, s15
    s_mov_b32 m0, 34816
    s_waitcnt vmcnt(25)
    buffer_load_dwordx4 v3, s[48:51], s57 offen offset:1024 nt lds
    s_mov_b32 s57, 786432
    s_mov_b32 s58, 982016
    s_mov_b32 m0, 124928
L_dma_23:
    s_waitcnt vmcnt(25)
    buffer_load_dwordx4 v5, s[32:35], s57 offen offset:0 nt lds
    s_waitcnt vmcnt(25)
    buffer_load_dwordx4 v6, s[32:35], s58 offen offset:1024 nt lds
    s_add_u32 s57, s57, 24576
    s_add_u32 s58, s58, 24576
    s_add_u32 m0, m0, 2048
    s_cmp_lg_u32 m0, 141312
    s_cbranch_scc1 L_dma_23
L_skip_22:
    s_waitcnt lgkmcnt(0)
    s_cmp_lt_u32 s30, 4
    s_cbranch_scc0 L_skip_24
    s_mov_b64 exec, 0
    s_cmp_eq_u32 s30, 1
    s_cbranch_scc1 L_pad1
    s_cmp_eq_u32 s30, 2
    s_cbranch_scc1 L_pad2
    s_cmp_eq_u32 s30, 3
    s_cbranch_scc1 L_pad3
    s_branch L_pad0
L_padback:
    s_mov_b64 exec, -1
L_skip_24:
    s_cmp_eq_u32 s30, 7
    s_cbranch_scc0 L_skip_25
    v_cndmask_b32 v29, 0, v28, s[64:65]
    v_dot2_f32_bf16 v33, v29, v61, 0
    v_dot2_f32_bf16 v62, v29, v29, 0
    v_lshlrev_b32 v2, 16, v28
    v_and_b32 v3, 0xffff0000, v28
    s_cmp_eq_u32 s55, 0
    v_permlane32_swap_b32 v33, v62
    v_add_f32 v33, v33, v62
    s_nop 1
    v_add_f32_dpp v33, v33, v33 row_ror:8 row_mask:0xf bank_mask:0xf
    s_nop 1
    v_add_f32_dpp v33, v33, v33 row_ror:4 row_mask:0xf bank_mask:0xf
    s_nop 1
    v_add_f32_dpp v33, v33, v33 row_ror:2 row_mask:0xf bank_mask:0xf
    s_nop 1
    v_add_f32_dpp v33, v33, v33 row_ror:1 row_mask:0xf bank_mask:0xf
    s_nop 1
    v_add_f32_dpp v33, v33, v33 row_bcast:15 row_mask:0xa bank_mask:0xf
    v_min_u32 v33, -2, v33
    s_cbranch_scc1 L_gs_26
    buffer_store_dword v33, v34, s[40:43], s67 offen
L_gb_27:
    s_waitcnt vmcnt(1)
L_skip_25:
    s_cmp_lt_u32 s30, 6
    s_cbranch_scc0 L_skip_28
    s_lshr_b32 s57, s30, 1
    s_mul_i32 s57, s57, 1024
    s_and_b32 s58, s30, 1
    s_lshl_b32 s58, s58, 6
    s_add_u32 s57, s57, s58
    v_lshrrev_b32 v18, 5, v0
    v_mul_u32_u24 v18, 6144, v18
    v_bfe_u32 v60, v0, 3, 1
    v_mul_u32_u24 v60, 3072, v60
    v_add_u32 v18, v60, v18
    v_bfe_u32 v60, v0, 4, 1
    v_lshl_add_u32 v18, v60, 9, v18
    v_bfe_u32 v60, v0, 2, 1
    v_lshl_add_u32 v18, v60, 7, v18
    v_and_b32 v60, 3, v0
    v_lshl_add_u32 v18, v60, 3, v18
    v_add_u32 v18, s57, v18
    v_bfe_u32 v19, v0, 4, 1
    v_mul_u32_u24 v19, 3072, v19
    v_bfe_u32 v60, v0, 3, 1
    v_lshl_add_u32 v19, v60, 9, v19
    v_bfe_u32 v60, v0, 2, 1
    v_lshl_add_u32 v19, v60, 7, v19
    v_and_b32 v60, 3, v0
    v_lshl_add_u32 v19, v60, 3, v19
    v_add_u32 v19, s57, v19
    v_add_u32 v19, 24576, v19
    ds_read_b64_tr_b16 v[36:37], v18 offset:0
    ds_read_b64_tr_b16 v[38:39], v18 offset:256
    ds_read_b64_tr_b16 v[40:41], v18 offset:12288
    ds_read_b64_tr_b16 v[42:43], v18 offset:12544
    ds_read_b64_tr_b16 v[44:45], v19 offset:0
    ds_read_b64_tr_b16 v[46:47], v19 offset:256
    ds_read_b64_tr_b16 v[48:49], v18 offset:32
    ds_read_b64_tr_b16 v[50:51], v18 offset:288
    ds_read_b64_tr_b16 v[52:53], v18 offset:12320
    ds_read_b64_tr_b16 v[54:55], v18 offset:12576
    ds_read_b64_tr_b16 v[56:57], v19 offset:32
    ds_read_b64_tr_b16 v[58:59], v19 offset:288
    v_lshrrev_b32 v32, 4, v0
    v_lshlrev_b32 v32, 5, v32
    v_bfe_u32 v60, v0, 1, 1
    v_lshl_add_u32 v32, v60, 4, v32
    v_and_b32 v60, 1, v0
    v_mul_u32_u24 v60, 192, v60
    v_add_u32 v32, v60, v32
    v_add_u32 v32, 160832, v32
    v_lshrrev_b32 v33, 4, v0
    v_lshlrev_b32 v33, 4, v33
    v_bfe_u32 v60, v0, 1, 1
    v_lshl_add_u32 v33, v60, 3, v33
    v_and_b32 v60, 1, v0
    v_mul_u32_u24 v60, 192, v60
    v_add_u32 v33, v60, v33
    v_add_u32 v33, 160960, v33
    v_mov_b64 v[24:25], 0
    v_mov_b64 v[26:27], 0
    v_mov_b64 v[28:29], 0
    v_mov_b64 v[30:31], 0
    s_lshr_b32 s57, s54, 1
    s_lshl_b32 s57, s57, 2
    s_and_b32 s58, s54, 1
    s_add_u32 s57, s57, s58
    s_lshl_b32 s57, s57, 4
    s_lshl_b32 s58, s30, 9
    s_add_u32 s57, s57, s58
    v_bfe_u32 v34, v0, 4, 1
    v_lshlrev_b32 v34, 8, v34
    v_bfe_u32 v60, v0, 1, 1
    v_lshl_add_u32 v34, v60, 5, v34
    v_bfe_u32 v60, v0, 2, 2
    v_lshl_add_u32 v34, v60, 2, v34
    v_lshrrev_b32 v60, 5, v0
    v_mul_u32_u24 v60, 3072, v60
    v_add_u32 v34, v60, v34
    v_and_b32 v60, 1, v0
    v_lshl_add_u32 v34, v60, 30, v34
    v_add_u32 v34, s57, v34
    s_mul_i32 s59, s53, 6400
    s_add_u32 s59, s59, s62
    s_add_u32 s59, s59, 57344
    s_add_u32 s60, s59, 6144
    ds_read_b128 v[12:15], v32
    ds_read_b64 v[16:17], v33
    s_waitcnt lgkmcnt(1)
    v_smfmac_f32_16x16x64_bf16 v[24:27], v[12:15], v[36:43], v1
    v_smfmac_f32_16x16x64_bf16 v[28:31], v[12:15], v[48:55], v1
    s_waitcnt lgkmcnt(0)
    v_smfmac_f32_16x16x32_bf16 v[24:27], v[16:17], v[44:47], v1
    v_smfmac_f32_16x16x32_bf16 v[28:31], v[16:17], v[56:59], v1
    s_cmp_eq_u32 s55, 0
    s_nop 5
    v_add_f32 v12, v24, v26
    s_nop 1
    v_add_f32_dpp v12, v28, v30 quad_perm:[0,1,2,3] row_mask:0x2 bank_mask:0xf
    s_nop 1
    v_add_f32_dpp v12, v25, v27 quad_perm:[0,1,2,3] row_mask:0x4 bank_mask:0xf
    s_nop 1
    v_add_f32_dpp v12, v29, v31 quad_perm:[0,1,2,3] row_mask:0x8 bank_mask:0xf
    s_nop 1
    v_mov_b32_dpp v13, v12 row_shl:1 row_mask:0xf bank_mask:0xf bound_ctrl:0
    v_cvt_pk_bf16_f32 v12, v12, v13
    v_min_u32 v12, -2, v12
    s_cbranch_scc1 L_gs_29
    buffer_store_dword v12, v34, s[40:43], s59 offen
L_gb_30:
L_skip_28:
    s_cmp_eq_u32 s30, 5
    s_cbranch_scc0 L_skip_31
    global_load_dword v2, v3, s[26:27] sc1
L_skip_31:
    s_waitcnt vmcnt(36)
    s_barrier
    ds_read_b128 v[96:99], v8 offset:0
    ds_read_b128 v[100:103], v9 offset:0
    s_cmp_eq_u32 s30, 6
    s_cbranch_scc0 L_skip_32
    s_mul_i32 s57, s14, 3
    s_mov_b32 m0, 36864
    s_waitcnt vmcnt(25)
    buffer_load_dwordx4 v3, s[48:51], s57 offen offset:0 nt lds
    s_mul_i32 s57, s14, 3
    s_add_u32 s57, s57, s15
    s_mov_b32 m0, 36864
    s_waitcnt vmcnt(25)
    buffer_load_dwordx4 v3, s[48:51], s57 offen offset:1024 nt lds
    s_mov_b32 s57, 786560
    s_mov_b32 s58, 982144
    s_mov_b32 m0, 141312
L_dma_33:
    s_waitcnt vmcnt(25)
    buffer_load_dwordx4 v5, s[32:35], s57 offen offset:0 nt lds
    s_waitcnt vmcnt(25)
    buffer_load_dwordx4 v6, s[32:35], s58 offen offset:1024 nt lds
    s_add_u32 s57, s57, 24576
    s_add_u32 s58, s58, 24576
    s_add_u32 m0, m0, 2048
    s_cmp_lg_u32 m0, 157696
    s_cbranch_scc1 L_dma_33
L_skip_32:
    s_waitcnt lgkmcnt(0)
    s_waitcnt vmcnt(36)
    s_barrier
    ds_read_b128 v[104:107], v8 offset:16384
    ds_read_b128 v[108:111], v9 offset:16384
    s_cmp_eq_u32 s30, 6
    s_cbranch_scc0 L_skip_34
    s_mul_i32 s57, s14, 4
    s_mov_b32 m0, 38912
    s_waitcnt vmcnt(25)
    buffer_load_dwordx4 v3, s[48:51], s57 offen offset:0 nt lds
    s_mul_i32 s57, s14, 4
    s_add_u32 s57, s57, s15
    s_mov_b32 m0, 38912
    s_waitcnt vmcnt(25)
    buffer_load_dwordx4 v3, s[48:51], s57 offen offset:1024 nt lds
    s_mov_b32 s57, 786688
    s_mov_b32 s58, 982272
    s_mov_b32 m0, 92160
L_dma_35:
    s_waitcnt vmcnt(25)
    buffer_load_dwordx4 v5, s[32:35], s57 offen offset:0 nt lds
    s_waitcnt vmcnt(25)
    buffer_load_dwordx4 v6, s[32:35], s58 offen offset:1024 nt lds
    s_add_u32 s57, s57, 24576
    s_add_u32 s58, s58, 24576
    s_add_u32 m0, m0, 2048
    s_cmp_lg_u32 m0, 108544
    s_cbranch_scc1 L_dma_35
L_skip_34:
    s_waitcnt lgkmcnt(0)
    s_cmp_lg_u32 s30, 6
    s_cbranch_scc0 L_skip_36
    s_waitcnt vmcnt(0)
L_skip_36:
    s_waitcnt vmcnt(36)
    s_barrier
    ds_read_b128 v[112:115], v8 offset:32768
    ds_read_b128 v[116:119], v9 offset:32768
    s_cmp_eq_u32 s30, 6
    s_cbranch_scc0 L_skip_37
    s_mul_i32 s57, s14, 5
    s_mov_b32 m0, 40960
    s_waitcnt vmcnt(25)
    buffer_load_dwordx4 v3, s[48:51], s57 offen offset:0 nt lds
    s_mul_i32 s57, s14, 5
    s_add_u32 s57, s57, s15
    s_mov_b32 m0, 40960
    s_waitcnt vmcnt(25)
    buffer_load_dwordx4 v3, s[48:51], s57 offen offset:1024 nt lds
    s_mov_b32 s57, 1179648
    s_mov_b32 s58, 1375232
    s_mov_b32 m0, 108544
L_dma_38:
    s_waitcnt vmcnt(25)
    buffer_load_dwordx4 v5, s[32:35], s57 offen offset:0 nt lds
    s_waitcnt vmcnt(25)
    buffer_load_dwordx4 v6, s[32:35], s58 offen offset:1024 nt lds
    s_add_u32 s57, s57, 24576
    s_add_u32 s58, s58, 24576
    s_add_u32 m0, m0, 2048
    s_cmp_lg_u32 m0, 124928
    s_cbranch_scc1 L_dma_38
L_skip_37:
    s_waitcnt lgkmcnt(0)
    s_cmp_eq_u32 s30, 5
    s_cbranch_scc0 L_skip_39
L_cw_40:
    v_readlane_b32 s57, v2, s31
    s_cmp_eq_u32 s57, 0
    s_cbranch_scc1 L_cr_41
    s_sub_u32 s57, s57, 1
    s_cmp_eq_u32 s57, s63
    s_cselect_b32 s64, 1, 0
    s_cbranch_scc0 L_far_42
    s_lshl_b32 s57, s52, 2
    s_add_u32 s57, s57, s72
    s_mov_b64 exec, 1
    buffer_store_dword v0, v0, s[40:43], s57 offen offset:0
    s_mov_b64 exec, -1
L_fb_43:
L_skip_39:
    s_waitcnt vmcnt(36)
    s_barrier
    ds_read_b128 v[120:123], v8 offset:49152
    ds_read_b128 v[124:127], v9 offset:49152
    s_cmp_eq_u32 s30, 6
    s_cbranch_scc0 L_skip_44
    s_mul_i32 s57, s14, 6
    s_mov_b32 m0, 43008
    s_waitcnt vmcnt(25)
    buffer_load_dwordx4 v3, s[48:51], s57 offen offset:0 nt lds
    s_mul_i32 s57, s14, 6
    s_add_u32 s57, s57, s15
    s_mov_b32 m0, 43008
    s_waitcnt vmcnt(25)
    buffer_load_dwordx4 v3, s[48:51], s57 offen offset:1024 nt lds
    s_mov_b32 s57, 1179776
    s_mov_b32 s58, 1375360
    s_mov_b32 m0, 124928
L_dma_45:
    s_waitcnt vmcnt(25)
    buffer_load_dwordx4 v5, s[32:35], s57 offen offset:0 nt lds
    s_waitcnt vmcnt(25)
    buffer_load_dwordx4 v6, s[32:35], s58 offen offset:1024 nt lds
    s_add_u32 s57, s57, 24576
    s_add_u32 s58, s58, 24576
    s_add_u32 m0, m0, 2048
    s_cmp_lg_u32 m0, 141312
    s_cbranch_scc1 L_dma_45
L_skip_44:
    s_waitcnt lgkmcnt(0)
    s_waitcnt vmcnt(36)
    s_barrier
    ds_read_b128 v[128:131], v8 offset:0
    ds_read_b128 v[132:135], v9 offset:0
    s_cmp_eq_u32 s30, 6
    s_cbranch_scc0 L_skip_46
    s_mul_i32 s57, s14, 7
    s_mov_b32 m0, 45056
    s_waitcnt vmcnt(25)
    buffer_load_dwordx4 v3, s[48:51], s57 offen offset:0 nt lds
    s_mul_i32 s57, s14, 7
    s_add_u32 s57, s57, s15
    s_mov_b32 m0, 45056
    s_waitcnt vmcnt(25)
    buffer_load_dwordx4 v3, s[48:51], s57 offen offset:1024 nt lds
    s_mov_b32 s57, 1179904
    s_mov_b32 s58, 1375488
    s_mov_b32 m0, 141312
L_dma_47:
    s_waitcnt vmcnt(25)
    buffer_load_dwordx4 v5, s[32:35], s57 offen offset:0 nt lds
    s_waitcnt vmcnt(25)
    buffer_load_dwordx4 v6, s[32:35], s58 offen offset:1024 nt lds
    s_add_u32 s57, s57, 24576
    s_add_u32 s58, s58, 24576
    s_add_u32 m0, m0, 2048
    s_cmp_lg_u32 m0, 157696
    s_cbranch_scc1 L_dma_47
L_skip_46:
    s_waitcnt lgkmcnt(0)
    s_cmp_eq_u32 s30, 5
    s_cbranch_scc0 L_skip_48
    v_lshlrev_b32 v24, 2, v0
    buffer_load_dword v2, v24, s[40:43], s72 offen sc1
L_skip_48:
    s_waitcnt vmcnt(36)
    s_barrier
    ds_read_b128 v[136:139], v8 offset:16384
    ds_read_b128 v[140:143], v9 offset:16384
    s_cmp_eq_u32 s30, 6
    s_cbranch_scc0 L_skip_49
    s_mul_i32 s57, s14, 8
    s_mov_b32 m0, 47104
    s_waitcnt vmcnt(25)
    buffer_load_dwordx4 v3, s[48:51], s57 offen offset:0 nt lds
    s_mul_i32 s57, s14, 8
    s_add_u32 s57, s57, s15
    s_mov_b32 m0, 47104
    s_waitcnt vmcnt(25)
    buffer_load_dwordx4 v3, s[48:51], s57 offen offset:1024 nt lds
    s_mov_b32 s57, 0
    s_mov_b32 s58, 392192
    s_mov_b32 m0, 92160
L_dma_50:
    s_waitcnt vmcnt(25)
    buffer_load_dwordx4 v7, s[36:39], s57 offen offset:0 nt lds
    s_waitcnt vmcnt(25)
    buffer_load_dwordx4 v7, s[36:39], s58 offen offset:1024 nt lds
    s_add_u32 s57, s57, 24576
    s_add_u32 s58, s58, 24576
    s_add_u32 m0, m0, 2048
    s_cmp_lg_u32 m0, 108544
    s_cbranch_scc1 L_dma_50
L_skip_49:
    s_waitcnt lgkmcnt(0)
    s_waitcnt vmcnt(36)
    s_barrier
    ds_read_b128 v[144:147], v8 offset:32768
    ds_read_b128 v[148:151], v9 offset:32768
    s_cmp_eq_u32 s30, 6
    s_cbranch_scc0 L_skip_51
    s_mul_i32 s57, s14, 9
    s_mov_b32 m0, 49152
    s_waitcnt vmcnt(25)
    buffer_load_dwordx4 v3, s[48:51], s57 offen offset:0 nt lds
    s_mul_i32 s57, s14, 9
    s_add_u32 s57, s57, s15
    s_mov_b32 m0, 49152
    s_waitcnt vmcnt(25)
    buffer_load_dwordx4 v3, s[48:51], s57 offen offset:1024 nt lds
    s_mov_b32 s57, 128
    s_mov_b32 s58, 392320
    s_mov_b32 m0, 108544
L_dma_52:
    s_waitcnt vmcnt(25)
    buffer_load_dwordx4 v7, s[36:39], s57 offen offset:0 nt lds
    s_waitcnt vmcnt(25)
    buffer_load_dwordx4 v7, s[36:39], s58 offen offset:1024 nt lds
    s_add_u32 s57, s57, 24576
    s_add_u32 s58, s58, 24576
    s_add_u32 m0, m0, 2048
    s_cmp_lg_u32 m0, 124928
    s_cbranch_scc1 L_dma_52
L_skip_51:
    s_waitcnt lgkmcnt(0)
    s_cmp_eq_u32 s30, 5
    s_cbranch_scc0 L_skip_53
L_cw_54:
    s_waitcnt vmcnt(0)
    v_cmp_ne_u32 vcc, -1, v2
    s_mov_b32 s57, 0
    s_cmp_eq_u32 s64, 0
    s_cbranch_scc1 L_cd_56
    s_cmp_lg_u32 vcc_hi, 0
    s_cbranch_scc1 L_cd_56
    s_cmp_lg_u32 vcc_lo, -1
    s_cbranch_scc1 L_cr_55
    s_mov_b32 s57, 1
L_cd_56:
    v_mov_b32 v37, 160768
    v_mov_b32 v38, s57
    ds_write_b32 v37, v38
    s_waitcnt lgkmcnt(0)
L_skip_53:
    s_waitcnt vmcnt(36)
    s_barrier
    ds_read_b128 v[152:155], v8 offset:49152
    ds_read_b128 v[156:159], v9 offset:49152
    s_cmp_eq_u32 s30, 6
    s_cbranch_scc0 L_skip_57
    s_mul_i32 s57, s14, 10
    s_mov_b32 m0, 51200
    s_waitcnt vmcnt(25)
    buffer_load_dwordx4 v3, s[48:51], s57 offen offset:0 nt lds
    s_mul_i32 s57, s14, 10
    s_add_u32 s57, s57, s15
    s_mov_b32 m0, 51200
    s_waitcnt vmcnt(25)
    buffer_load_dwordx4 v3, s[48:51], s57 offen offset:1024 nt lds
    s_mov_b32 s57, 256
    s_mov_b32 s58, 392448
    s_mov_b32 m0, 124928
L_dma_58:
    s_waitcnt vmcnt(25)
    buffer_load_dwordx4 v7, s[36:39], s57 offen offset:0 nt lds
    s_waitcnt vmcnt(25)
    buffer_load_dwordx4 v7, s[36:39], s58 offen offset:1024 nt lds
    s_add_u32 s57, s57, 24576
    s_add_u32 s58, s58, 24576
    s_add_u32 m0, m0, 2048
    s_cmp_lg_u32 m0, 141312
    s_cbranch_scc1 L_dma_58
L_skip_57:
    s_waitcnt lgkmcnt(0)
    v_lshrrev_b32 v8, 2, v0
    v_lshlrev_b32 v8, 7, v8
    v_bfe_u32 v60, v0, 3, 2
    v_lshl_add_u32 v8, v60, 5, v8
    v_and_b32 v60, 3, v0
    v_lshl_add_u32 v8, v60, 3, v8
    v_add_u32 v8, s61, v8
    v_xor_b32 v9, 32, v8
    v_xor_b32 v10, 64, v8
    v_xor_b32 v11, 96, v8
    v_mov_b32 v41, 160768
    ds_read_b32 v42, v41
    s_waitcnt lgkmcnt(0)
    v_readfirstlane_b32 s55, v42
    s_cmp_eq_u32 s55, 0
    s_cbranch_scc1 L_spread
L_spread_back:
    s_cmp_eq_u32 s30, 5
    s_cbranch_scc0 L_skip_70
    s_cmp_eq_u32 s52, 31
    s_cbranch_scc0 L_skip_71
    s_lshl_b32 s57, s31, 5
    v_mov_b32 v16, s57
    v_mov_b32 v12, 1
    s_mov_b64 exec, 0x1
    global_store_dword v16, v12, s[26:27] offset:4 sc1
    s_mov_b64 exec, -1
L_skip_71:
L_skip_70:
    s_cmp_eq_u32 s30, 4
    s_cbranch_scc0 L_skip_72
    s_mul_i32 s59, s53, 6400
    s_add_u32 s59, s59, s62
    s_add_u32 s59, s59, 57344
    s_add_u32 s60, s59, 6144
    v_lshlrev_b32 v16, 4, v0
    s_add_u32 s60, s59, 3072
    s_mov_b32 m0, 79872
    s_nop 0
    buffer_load_dwordx4 v16, s[40:43], s59 offen offset:0 sc1 nt lds
    buffer_load_dwordx4 v16, s[40:43], s59 offen offset:1024 sc1 nt lds
    buffer_load_dwordx4 v16, s[40:43], s59 offen offset:2048 sc1 nt lds
    s_mov_b32 m0, 82944
    s_nop 0
    buffer_load_dwordx4 v16, s[40:43], s60 offen offset:0 sc1 nt lds
    buffer_load_dwordx4 v16, s[40:43], s60 offen offset:1024 sc1 nt lds
    buffer_load_dwordx4 v16, s[40:43], s60 offen offset:2048 sc1 nt lds
    s_mov_b64 exec, 0xf
    buffer_load_dwordx4 v16, s[40:43], s60 offen offset:3072 sc1 nt lds
    s_mov_b64 exec, -1
L_skip_72:
    s_waitcnt vmcnt(36)
    s_barrier
    ds_read_b64_tr_b16 v[160:161], v8 offset:0
    ds_read_b64_tr_b16 v[168:169], v9 offset:0
    ds_read_b64_tr_b16 v[176:177], v10 offset:0
    ds_read_b64_tr_b16 v[184:185], v11 offset:0
    s_cmp_eq_u32 s30, 6
    s_cbranch_scc0 L_skip_73
    s_mul_i32 s57, s14, 11
    s_mov_b32 m0, 53248
    s_waitcnt vmcnt(25)
    buffer_load_dwordx4 v3, s[48:51], s57 offen offset:0 nt lds
    s_mul_i32 s57, s14, 11
    s_add_u32 s57, s57, s15
    s_mov_b32 m0, 53248
    s_waitcnt vmcnt(25)
    buffer_load_dwordx4 v3, s[48:51], s57 offen offset:1024 nt lds
    s_mov_b32 s57, 196608
    s_mov_b32 s58, 588800
    s_mov_b32 m0, 141312
L_dma_74:
    s_waitcnt vmcnt(25)
    buffer_load_dwordx4 v7, s[36:39], s57 offen offset:0 nt lds
    s_waitcnt vmcnt(25)
    buffer_load_dwordx4 v7, s[36:39], s58 offen offset:1024 nt lds
    s_add_u32 s57, s57, 24576
    s_add_u32 s58, s58, 24576
    s_add_u32 m0, m0, 2048
    s_cmp_lg_u32 m0, 157696
    s_cbranch_scc1 L_dma_74
L_skip_73:
    s_waitcnt lgkmcnt(0)
    s_waitcnt vmcnt(36)
    s_barrier
    ds_read_b64_tr_b16 v[192:193], v8 offset:16384
    ds_read_b64_tr_b16 v[200:201], v9 offset:16384
    ds_read_b64_tr_b16 v[208:209], v10 offset:16384
    ds_read_b64_tr_b16 v[216:217], v11 offset:16384
    s_cmp_eq_u32 s30, 6
    s_cbranch_scc0 L_skip_75
    s_mul_i32 s57, s14, 12
    s_mov_b32 m0, 55296
    s_waitcnt vmcnt(25)
    buffer_load_dwordx4 v3, s[48:51], s57 offen offset:0 nt lds
    s_mul_i32 s57, s14, 12
    s_add_u32 s57, s57, s15
    s_mov_b32 m0, 55296
    s_waitcnt vmcnt(25)
    buffer_load_dwordx4 v3, s[48:51], s57 offen offset:1024 nt lds
    s_mov_b32 s57, 196736
    s_mov_b32 s58, 588928
    s_mov_b32 m0, 92160
L_dma_76:
    s_waitcnt vmcnt(25)
    buffer_load_dwordx4 v7, s[36:39], s57 offen offset:0 nt lds
    s_waitcnt vmcnt(25)
    buffer_load_dwordx4 v7, s[36:39], s58 offen offset:1024 nt lds
    s_add_u32 s57, s57, 24576
    s_add_u32 s58, s58, 24576
    s_add_u32 m0, m0, 2048
    s_cmp_lg_u32 m0, 108544
    s_cbranch_scc1 L_dma_76
L_skip_75:
    s_waitcnt lgkmcnt(0)
    s_cmp_eq_u32 s30, 4
    s_cbranch_scc0 L_skip_77
    s_waitcnt vmcnt(0)
L_skip_77:
    s_waitcnt vmcnt(36)
    s_barrier
    ds_read_b64_tr_b16 v[224:225], v8 offset:32768
    ds_read_b64_tr_b16 v[232:233], v9 offset:32768
    ds_read_b64_tr_b16 v[240:241], v10 offset:32768
    ds_read_b64_tr_b16 v[248:249], v11 offset:32768
    s_cmp_eq_u32 s30, 6
    s_cbranch_scc0 L_skip_78
    s_mul_i32 s57, s14, 13
    s_mov_b32 m0, 57344
    s_nop 0
    buffer_load_dwordx4 v3, s[48:51], s57 offen offset:0 nt lds
    s_mul_i32 s57, s14, 13
    s_add_u32 s57, s57, s15
    s_mov_b32 m0, 57344
    s_nop 0
    buffer_load_dwordx4 v3, s[48:51], s57 offen offset:1024 nt lds
    s_mov_b32 s57, 196864
    s_mov_b32 s58, 589056
    s_mov_b32 m0, 108544
L_dma_79:
    s_nop 0
    buffer_load_dwordx4 v7, s[36:39], s57 offen offset:0 nt lds
    buffer_load_dwordx4 v7, s[36:39], s58 offen offset:1024 nt lds
    s_add_u32 s57, s57, 24576
    s_add_u32 s58, s58, 24576
    s_add_u32 m0, m0, 2048
    s_cmp_lg_u32 m0, 124928
    s_cbranch_scc1 L_dma_79
L_skip_78:
    s_waitcnt lgkmcnt(0)
    v_lshlrev_b32 v40, 4, v0
    v_add_u32 v40, 79872, v40
    ds_read_b128 v[12:15], v40 offset:3072
    ds_read_b128 v[16:19], v40 offset:4096
    ds_read_b128 v[20:23], v40 offset:5120
    v_mov_b64 v[24:25], 0
    v_mov_b64 v[26:27], 0
    v_mov_b64 v[28:29], 0
    v_mov_b64 v[30:31], 0
    v_mov_b64 v[32:33], 0
    v_mov_b64 v[34:35], 0
    v_mov_b64 v[36:37], 0
    v_mov_b64 v[38:39], 0
    s_waitcnt lgkmcnt(0)
    v_smfmac_f32_16x16x64_bf16 v[24:27], v[12:15], v[64:71], v1
    v_smfmac_f32_16x16x64_bf16 v[24:27], v[16:19], v[72:79], v1
    v_smfmac_f32_16x16x64_bf16 v[24:27], v[20:23], v[80:87], v1
    v_smfmac_f32_16x16x64_bf16 v[32:35], v[12:15], v[112:119], v1
    v_smfmac_f32_16x16x64_bf16 v[32:35], v[16:19], v[120:127], v1
    v_smfmac_f32_16x16x64_bf16 v[32:35], v[20:23], v[128:135], v1
    v_smfmac_f32_16x16x64_bf16 v[28:31], v[12:15], v[88:95], v1
    v_smfmac_f32_16x16x64_bf16 v[28:31], v[16:19], v[96:103], v1
    v_smfmac_f32_16x16x64_bf16 v[28:31], v[20:23], v[104:111], v1
    v_smfmac_f32_16x16x64_bf16 v[36:39], v[12:15], v[136:143], v1
    s_nop 0
    v_pk_add_f32 v[24:25], v[24:25], v[26:27]
    v_add_f32 v24, v24, v25
    v_smfmac_f32_16x16x64_bf16 v[36:39], v[16:19], v[144:151], v1
    v_pk_add_f32 v[32:33], v[32:33], v[34:35]
    v_add_f32 v32, v32, v33
    v_smfmac_f32_16x16x64_bf16 v[36:39], v[20:23], v[152:159], v1
    s_nop 0
    v_permlane32_swap_b32 v24, v32
    v_add_f32 v24, v24, v32
    v_pk_add_f32 v[28:29], v[28:29], v[30:31]
    v_add_f32 v28, v28, v29
    s_nop 2
    v_pk_add_f32 v[36:37], v[36:37], v[38:39]
    v_add_f32 v36, v36, v37
    s_nop 1
    v_permlane32_swap_b32 v28, v36
    v_add_f32 v28, v28, v36
    s_nop 1
    v_permlane16_swap_b32 v24, v28
    v_add_f32 v6, v24, v28
    s_waitcnt vmcnt(36)
    s_barrier
    ds_read_b64_tr_b16 v[162:163], v8 offset:49152
    ds_read_b64_tr_b16 v[170:171], v9 offset:49152
    ds_read_b64_tr_b16 v[178:179], v10 offset:49152
    ds_read_b64_tr_b16 v[186:187], v11 offset:49152
    s_cmp_eq_u32 s30, 6
    s_cbranch_scc0 L_skip_80
    s_mul_i32 s57, s14, 14
    s_mov_b32 m0, 59392
    s_nop 0
    buffer_load_dwordx4 v3, s[48:51], s57 offen offset:0 nt lds
    s_mul_i32 s57, s14, 14
    s_add_u32 s57, s57, s15
    s_mov_b32 m0, 59392
    s_nop 0
    buffer_load_dwordx4 v3, s[48:51], s57 offen offset:1024 nt lds
    s_mov_b32 s57, 786432
    s_mov_b32 s58, 1178624
    s_mov_b32 m0, 124928
L_dma_81:
    s_nop 0
    buffer_load_dwordx4 v7, s[36:39], s57 offen offset:0 nt lds
    buffer_load_dwordx4 v7, s[36:39], s58 offen offset:1024 nt lds
    s_add_u32 s57, s57, 24576
    s_add_u32 s58, s58, 24576
    s_add_u32 m0, m0, 2048
    s_cmp_lg_u32 m0, 141312
    s_cbranch_scc1 L_dma_81
L_skip_80:
    s_waitcnt lgkmcnt(0)
    v_and_b32 v41, 7, v0
    v_lshlrev_b32 v41, 3, v41
    v_add_u32 v41, 86016, v41
    ds_read_b128 v[12:15], v40 offset:0
    ds_read_b128 v[16:19], v40 offset:1024
    ds_read_b128 v[20:23], v40 offset:2048
    ds_read_b64 v[52:53], v41
    v_mov_b64 v[24:25], 0
    v_mov_b64 v[26:27], 0
    v_mov_b64 v[28:29], 0
    v_mov_b64 v[30:31], 0
    v_mov_b64 v[32:33], 0
    v_mov_b64 v[34:35], 0
    v_mov_b64 v[36:37], 0
    v_mov_b64 v[38:39], 0
    s_waitcnt lgkmcnt(0)
    v_smfmac_f32_16x16x64_bf16 v[24:27], v[12:15], v[64:71], v1
    v_add_f32_dpp v52, v52, v52 row_ror:4 row_mask:0xf bank_mask:0xf
    v_add_f32_dpp v53, v53, v53 row_ror:4 row_mask:0xf bank_mask:0xf
    v_smfmac_f32_16x16x64_bf16 v[24:27], v[16:19], v[72:79], v1
    v_add_f32_dpp v52, v52, v52 row_ror:2 row_mask:0xf bank_mask:0xf
    v_add_f32_dpp v53, v53, v53 row_ror:2 row_mask:0xf bank_mask:0xf
    v_smfmac_f32_16x16x64_bf16 v[24:27], v[20:23], v[80:87], v1
    v_add_f32_dpp v52, v52, v52 row_ror:1 row_mask:0xf bank_mask:0xf
    v_add_f32_dpp v53, v53, v53 row_ror:1 row_mask:0xf bank_mask:0xf
    v_smfmac_f32_16x16x64_bf16 v[32:35], v[12:15], v[112:119], v1
    v_mul_f32 v52, 0x3acccccd, v52
    v_mul_f32 v53, 0x3acccccd, v53
    v_smfmac_f32_16x16x64_bf16 v[32:35], v[16:19], v[120:127], v1
    v_fma_f32 v53, -v52, v52, v53
    v_max_f32 v53, 0, v53
    v_smfmac_f32_16x16x64_bf16 v[32:35], v[20:23], v[128:135], v1
    v_add_f32 v53, 0x3727c5ac, v53
    v_rsq_f32 v53, v53
    v_smfmac_f32_16x16x64_bf16 v[28:31], v[12:15], v[88:95], v1
    v_mul_f32 v53, 0x3dd53b95, v53
    v_mul_f32 v52, -v52, v53
    v_smfmac_f32_16x16x64_bf16 v[28:31], v[16:19], v[96:103], v1
    v_mul_f32 v52, v52, v6
    v_smfmac_f32_16x16x64_bf16 v[28:31], v[20:23], v[104:111], v1
    v_smfmac_f32_16x16x64_bf16 v[36:39], v[12:15], v[136:143], v1
    v_pk_add_f32 v[24:25], v[24:25], v[26:27]
    v_add_f32 v24, v24, v25
    v_smfmac_f32_16x16x64_bf16 v[36:39], v[16:19], v[144:151], v1
    v_pk_add_f32 v[32:33], v[32:33], v[34:35]
    v_add_f32 v32, v32, v33
    v_smfmac_f32_16x16x64_bf16 v[36:39], v[20:23], v[152:159], v1
    s_nop 0
    v_permlane32_swap_b32 v24, v32
    v_add_f32 v24, v24, v32
    v_pk_add_f32 v[28:29], v[28:29], v[30:31]
    v_add_f32 v28, v28, v29
    s_nop 2
    v_pk_add_f32 v[36:37], v[36:37], v[38:39]
    v_add_f32 v36, v36, v37
    s_nop 1
    v_permlane32_swap_b32 v28, v36
    v_add_f32 v28, v28, v36
    s_nop 1
    v_permlane16_swap_b32 v24, v28
    v_add_f32 v24, v24, v28
    v_fma_f32 v24, v24, v53, v52
    s_mov_b32 vcc_lo, 0x55555555
    s_mov_b32 vcc_hi, 0x55555555
    v_max_f32_dpp v20, v24, v24 row_ror:8 row_mask:0xf bank_mask:0xf
    s_nop 1
    v_max_f32_dpp v20, v20, v20 row_ror:4 row_mask:0xf bank_mask:0xf
    s_nop 1
    v_max_f32_dpp v20, v20, v20 row_ror:2 row_mask:0xf bank_mask:0xf
    s_nop 1
    v_max_f32_dpp v20, v20, v20 row_ror:1 row_mask:0xf bank_mask:0xf
    s_nop 1
    v_max_f32_dpp v20, v20, v20 row_bcast:15 row_mask:0xa bank_mask:0xf
    s_nop 1
    v_max_f32_dpp v20, v20, v20 row_bcast:31 row_mask:0xc bank_mask:0xf
    s_nop 0
    v_readlane_b32 s57, v20, 63
    s_nop 1
    v_subrev_f32 v24, s57, v24
    v_exp_f32 v22, v24
    s_nop 1
    v_mov_b32_dpp v23, v22 row_shl:1 row_mask:0xf bank_mask:0xf bound_ctrl:0
    v_cvt_pk_bf16_f32 v23, v22, v23
    v_cndmask_b32 v12, 0, v23, vcc
    v_add_f32_dpp v21, v22, v22 row_ror:8 row_mask:0xf bank_mask:0xf
    s_nop 0
    v_mov_b32_dpp v13, v12 row_shl:4 row_mask:0xf bank_mask:0xf bound_ctrl:0
    v_mov_b32_dpp v14, v12 row_shl:8 row_mask:0xf bank_mask:0xf bound_ctrl:0
    v_mov_b32_dpp v15, v12 row_shl:12 row_mask:0xf bank_mask:0xf bound_ctrl:0
    v_add_f32_dpp v21, v21, v21 row_ror:4 row_mask:0xf bank_mask:0xf
    v_mov_b32_dpp v16, v12 row_shr:1 row_mask:0xf bank_mask:0xf bound_ctrl:0
    v_mov_b64 v[40:41], 0
    v_mov_b64 v[42:43], 0
    v_mov_b64 v[44:45], 0
    v_mov_b64 v[46:47], 0
    v_mov_b64 v[48:49], 0
    v_mov_b64 v[50:51], 0
    v_mov_b64 v[52:53], 0
    v_mov_b64 v[54:55], 0
    v_mov_b64 v[56:57], 0
    v_mov_b64 v[58:59], 0
    v_mov_b64 v[60:61], 0
    v_mov_b64 v[62:63], 0
    s_lshl_b32 s58, s30, 3
    s_add_u32 s58, s58, 159744
    v_mov_b32 v38, s58
    v_lshlrev_b32 v37, 3, v0
    v_add_u32 v37, 157696, v37
    v_cmp_eq_u32 vcc, 63, v0
    s_nop 1
    v_cndmask_b32 v37, v37, v38, vcc
    v_add_f32_dpp v21, v21, v21 row_ror:2 row_mask:0xf bank_mask:0xf
    v_mov_b32_dpp v17, v12 row_shl:3 row_mask:0xf bank_mask:0xf bound_ctrl:0
    s_nop 0
    v_add_f32_dpp v21, v21, v21 row_ror:1 row_mask:0xf bank_mask:0xf
    v_mov_b32_dpp v18, v12 row_shl:7 row_mask:0xf bank_mask:0xf bound_ctrl:0
    s_nop 0
    v_add_f32_dpp v21, v21, v21 row_bcast:15 row_mask:0xa bank_mask:0xf
    v_mov_b32_dpp v19, v12 row_shl:11 row_mask:0xf bank_mask:0xf bound_ctrl:0
    s_nop 0
    v_add_f32_dpp v21, v21, v21 row_bcast:31 row_mask:0xc bank_mask:0xf
    ds_write_b64 v37, v[20:21]
    s_lshl_b32 s57, s30, 12
    v_lshlrev_b32 v36, 4, v0
    v_add_u32 v36, s57, v36
    v_add_u32 v36, 92160, v36
    s_waitcnt lgkmcnt(0)
    s_waitcnt vmcnt(36)
    s_barrier
    ds_read_b64_tr_b16 v[194:195], v8 offset:0
    ds_read_b64_tr_b16 v[202:203], v9 offset:0
    ds_read_b64_tr_b16 v[210:211], v10 offset:0
    ds_read_b64_tr_b16 v[218:219], v11 offset:0
    s_cmp_eq_u32 s30, 6
    s_cbranch_scc0 L_skip_82
    s_mul_i32 s57, s14, 15
    s_mov_b32 m0, 61440
    s_waitcnt vmcnt(25)
    buffer_load_dwordx4 v3, s[48:51], s57 offen offset:0 nt lds
    s_mul_i32 s57, s14, 15
    s_add_u32 s57, s57, s15
    s_mov_b32 m0, 61440
    s_waitcnt vmcnt(25)
    buffer_load_dwordx4 v3, s[48:51], s57 offen offset:1024 nt lds
    s_mov_b32 s57, 786560
    s_mov_b32 s58, 1178752
    s_mov_b32 m0, 141312
L_dma_83:
    s_waitcnt vmcnt(25)
    buffer_load_dwordx4 v7, s[36:39], s57 offen offset:0 nt lds
    s_waitcnt vmcnt(25)
    buffer_load_dwordx4 v7, s[36:39], s58 offen offset:1024 nt lds
    s_add_u32 s57, s57, 24576
    s_add_u32 s58, s58, 24576
    s_add_u32 m0, m0, 2048
    s_cmp_lg_u32 m0, 157696
    s_cbranch_scc1 L_dma_83
L_skip_82:
    s_waitcnt lgkmcnt(0)
    s_cmp_lt_u32 s30, 2
    s_cbranch_scc0 L_skip_84
    s_mul_i32 s57, s30, 48
    v_add_u32 v38, s57, v0
    v_bfe_u32 v2, v38, 5, 2
    v_lshlrev_b32 v2, 10, v2
    v_and_b32 v39, 15, v38
    v_lshl_add_u32 v2, v39, 4, v2
    v_bfe_u32 v39, v38, 4, 1
    v_lshl_add_u32 v2, v39, 3, v2
    v_add_u32 v2, 92160, v2
    s_lshr_b32 s57, s54, 1
    s_lshl_b32 s57, s57, 2
    s_and_b32 s58, s54, 1
    s_add_u32 s57, s57, s58
    s_lshl_b32 s58, s57, 4
    s_lshl_b32 s57, s57, 3
    v_bfe_u32 v3, v0, 3, 2
    v_lshlrev_b32 v3, 8, v3
    v_bfe_u32 v39, v0, 2, 1
    v_lshl_add_u32 v3, v39, 5, v3
    v_and_b32 v39, 3, v0
    v_lshl_add_u32 v3, v39, 2, v3
    v_add_u32 v3, s58, v3
    v_bfe_u32 v38, v0, 3, 1
    v_lshlrev_b32 v38, 8, v38
    v_bfe_u32 v39, v0, 1, 1
    v_lshl_add_u32 v38, v39, 7, v38
    v_bfe_u32 v39, v0, 2, 1
    v_lshl_add_u32 v38, v39, 4, v38
    v_and_b32 v39, 1, v0
    v_lshl_add_u32 v38, v39, 2, v38
    v_add_u32 v38, s57, v38
    v_add_u32 v38, 1024, v38
    v_cmp_gt_u32 vcc, 32, v0
    s_nop 1
    v_cndmask_b32 v3, v38, v3, vcc
    s_lshl_b32 s57, s53, 1
    s_add_u32 s57, s57, s30
    s_mul_i32 s57, s57, 1536
    s_add_u32 s57, s57, s62
    v_add_u32 v3, s57, v3
    v_mov_b32 v38, 0x7f000000
    v_cmp_le_u32 vcc, 48, v0
    s_nop 1
    v_cndmask_b32 v3, v3, v38, vcc
    v_and_b32 v4, 7, v0
    v_lshlrev_b32 v4, 3, v4
    v_add_u32 v4, 159744, v4
    s_lshl_b32 s57, s53, 3
    s_add_u32 s57, s57, s54
    s_lshl_b32 s57, s57, 2
    s_add_u32 s57, s57, s62
    s_add_u32 s57, s57, 55808
    v_add_u32 v23, s30, v0
    v_lshlrev_b32 v23, 24, v23
L_mw_85:
    ds_read_b64 v[38:39], v4 offset:0
    s_waitcnt lgkmcnt(0)
    v_max_f32_dpp v37, v38, v38 row_ror:4 row_mask:0xf bank_mask:0xf
    s_cmp_eq_u32 s55, 0
    s_nop 0
    v_max_f32_dpp v37, v37, v37 row_ror:2 row_mask:0xf bank_mask:0xf
    s_nop 1
    v_max_f32_dpp v37, v37, v37 row_ror:1 row_mask:0xf bank_mask:0xf
    v_sub_f32 v38, v38, v37
    v_exp_f32 v38, v38
    s_nop 0
    v_mul_f32 v39, v38, v39
    s_nop 1
    v_add_f32_dpp v39, v39, v39 row_ror:4 row_mask:0xf bank_mask:0xf
    s_nop 1
    v_add_f32_dpp v39, v39, v39 row_ror:2 row_mask:0xf bank_mask:0xf
    s_nop 1
    v_add_f32_dpp v39, v39, v39 row_ror:1 row_mask:0xf bank_mask:0xf
    v_rcp_f32 v21, v39
    v_log_f32 v22, v39
    v_mul_f32 v38, v38, v21
    v_add_f32 v22, v22, v37
    v_min_u32 v22, -2, v22
    s_cbranch_scc1 L_gs_87
    buffer_store_dword v22, v23, s[40:43], s57 offen
L_gb_88:
    v_readlane_b32 s64, v38, 0
    v_readlane_b32 s65, v38, 1
    v_readlane_b32 s66, v38, 2
    v_readlane_b32 s67, v38, 3
    v_readlane_b32 s68, v38, 4
    v_readlane_b32 s69, v38, 5
    v_readlane_b32 s70, v38, 6
    v_readlane_b32 s71, v38, 7
L_skip_84:
    s_waitcnt vmcnt(36)
    s_barrier
    ds_read_b64_tr_b16 v[226:227], v8 offset:16384
    ds_read_b64_tr_b16 v[234:235], v9 offset:16384
    ds_read_b64_tr_b16 v[242:243], v10 offset:16384
    ds_read_b64_tr_b16 v[250:251], v11 offset:16384
    s_cmp_eq_u32 s30, 6
    s_cbranch_scc0 L_skip_89
    s_mov_b32 s57, 786688
    s_mov_b32 s58, 1178880
    s_mov_b32 m0, 92160
L_dma_90:
    s_waitcnt vmcnt(25)
    buffer_load_dwordx4 v7, s[36:39], s57 offen offset:0 nt lds
    s_waitcnt vmcnt(25)
    buffer_load_dwordx4 v7, s[36:39], s58 offen offset:1024 nt lds
    s_add_u32 s57, s57, 24576
    s_add_u32 s58, s58, 24576
    s_add_u32 m0, m0, 2048
    s_cmp_lg_u32 m0, 108544
    s_cbranch_scc1 L_dma_90
L_skip_89:
    s_waitcnt lgkmcnt(0)
    s_cmp_eq_u32 s30, 5
    s_cbranch_scc0 L_skip_91
    global_load_dword v2, v3, s[26:27] offset:4 sc1
L_skip_91:
    s_waitcnt vmcnt(34)
    s_barrier
    ds_read_b64_tr_b16 v[164:165], v8 offset:32768
    ds_read_b64_tr_b16 v[172:173], v9 offset:32768
    ds_read_b64_tr_b16 v[180:181], v10 offset:32768
    ds_read_b64_tr_b16 v[188:189], v11 offset:32768
    s_cmp_eq_u32 s30, 6
    s_cbranch_scc0 L_skip_92
    s_mov_b32 s57, 983040
    s_mov_b32 s58, 1375232
    s_mov_b32 m0, 108544
L_dma_93:
    s_waitcnt vmcnt(25)
    buffer_load_dwordx4 v7, s[36:39], s57 offen offset:0 nt lds
    s_waitcnt vmcnt(25)
    buffer_load_dwordx4 v7, s[36:39], s58 offen offset:1024 nt lds
    s_add_u32 s57, s57, 24576
    s_add_u32 s58, s58, 24576
    s_add_u32 m0, m0, 2048
    s_cmp_lg_u32 m0, 124928
    s_cbranch_scc1 L_dma_93
L_skip_92:
    s_waitcnt lgkmcnt(0)
    s_waitcnt vmcnt(32)
    s_barrier
    ds_read_b64_tr_b16 v[196:197], v8 offset:49152
    ds_read_b64_tr_b16 v[204:205], v9 offset:49152
    ds_read_b64_tr_b16 v[212:213], v10 offset:49152
    ds_read_b64_tr_b16 v[220:221], v11 offset:49152
    s_cmp_eq_u32 s30, 6
    s_cbranch_scc0 L_skip_94
    s_mov_b32 s57, 983168
    s_mov_b32 s58, 1375360
    s_mov_b32 m0, 124928
L_dma_95:
    s_waitcnt vmcnt(25)
    buffer_load_dwordx4 v7, s[36:39], s57 offen offset:0 nt lds
    s_waitcnt vmcnt(25)
    buffer_load_dwordx4 v7, s[36:39], s58 offen offset:1024 nt lds
    s_add_u32 s57, s57, 24576
    s_add_u32 s58, s58, 24576
    s_add_u32 m0, m0, 2048
    s_cmp_lg_u32 m0, 141312
    s_cbranch_scc1 L_dma_95
L_skip_94:
    s_waitcnt lgkmcnt(0)
    s_cmp_eq_u32 s30, 5
    s_cbranch_scc0 L_skip_96
L_cw_97:
    s_waitcnt vmcnt(0)
    v_cmp_eq_u32 vcc, 0, v2
    s_cbranch_vccnz L_cr_98
L_skip_96:
    s_cmp_eq_u32 s30, 2
    s_cbranch_scc0 L_skip_99
    s_mul_i32 s57, s52, 1792
    s_add_u32 s57, s57, s62
    v_min_u32 v37, 13, v0
    v_lshlrev_b32 v37, 7, v37
    buffer_load_dword v37, v37, s[40:43], s57 offen sc1 nt
L_skip_99:
    s_waitcnt vmcnt(32)
    s_barrier
    ds_read_b64_tr_b16 v[228:229], v8 offset:0
    ds_read_b64_tr_b16 v[236:237], v9 offset:0
    ds_read_b64_tr_b16 v[244:245], v10 offset:0
    ds_read_b64_tr_b16 v[252:253], v11 offset:0
    s_cmp_eq_u32 s30, 6
    s_cbranch_scc0 L_skip_100
    s_mov_b32 s57, 983296
    s_mov_b32 s58, 1375488
    s_mov_b32 m0, 141312
L_dma_101:
    s_waitcnt vmcnt(25)
    buffer_load_dwordx4 v7, s[36:39], s57 offen offset:0 nt lds
    s_waitcnt vmcnt(25)
    buffer_load_dwordx4 v7, s[36:39], s58 offen offset:1024 nt lds
    s_add_u32 s57, s57, 24576
    s_add_u32 s58, s58, 24576
    s_add_u32 m0, m0, 2048
    s_cmp_lg_u32 m0, 157696
    s_cbranch_scc1 L_dma_101
L_skip_100:
    s_waitcnt lgkmcnt(0)
    s_branch L_tail
.p2align 10
L_tail:
L_pad0:
    s_cbranch_execz L_pad4
    s_waitcnt vmcnt(32)
    s_barrier
    ds_read_b64_tr_b16 v[166:167], v8 offset:16384
    ds_read_b64_tr_b16 v[174:175], v9 offset:16384
    ds_read_b64_tr_b16 v[182:183], v10 offset:16384
    ds_read_b64_tr_b16 v[190:191], v11 offset:16384
    s_waitcnt lgkmcnt(0)
    v_smfmac_f32_16x16x64_bf16 v[40:43], v[12:15], v[160:167], v1
    v_smfmac_f32_16x16x64_bf16 v[40:43], v[16:19], v[168:175], v1
    v_smfmac_f32_16x16x64_bf16 v[44:47], v[12:15], v[176:183], v1
    v_smfmac_f32_16x16x64_bf16 v[44:47], v[16:19], v[184:191], v1
    s_cmp_eq_u32 s30, 6
    s_cbranch_scc0 L_skip_102
    s_mul_i32 s57, s14, 16
    s_add_u32 s58, s57, s15
    s_mov_b32 m0, 63488
L_dma_103:
    s_waitcnt vmcnt(33)
    buffer_load_dwordx4 v3, s[48:51], s57 offen offset:0 nt lds
    s_waitcnt vmcnt(33)
    buffer_load_dwordx4 v3, s[48:51], s58 offen offset:1024 nt lds
    s_add_u32 s57, s57, s14
    s_add_u32 s58, s58, s14
    s_add_u32 m0, m0, 2048
    s_cmp_lg_u32 m0, 71680
    s_cbranch_scc1 L_dma_103
    s_mul_i32 s57, s14, 20
    s_add_u32 s58, s57, s15
    s_mov_b32 m0, 71680
L_dma_104:
    s_waitcnt vmcnt(33)
    buffer_load_dwordx4 v3, s[48:51], s57 offen offset:0 nt lds
    s_waitcnt vmcnt(33)
    buffer_load_dwordx4 v3, s[48:51], s58 offen offset:1024 nt lds
    s_add_u32 s57, s57, s14
    s_add_u32 s58, s58, s14
    s_add_u32 m0, m0, 2048
    s_cmp_lg_u32 m0, 79872
    s_cbranch_scc1 L_dma_104
L_skip_102:
    s_nop 3
    v_pk_add_f32 v[24:25], v[40:41], v[42:43]
    s_nop 0
    v_pk_add_f32 v[26:27], v[44:45], v[46:47]
    s_waitcnt vmcnt(32)
    s_barrier
    ds_read_b64_tr_b16 v[198:199], v8 offset:32768
    ds_read_b64_tr_b16 v[206:207], v9 offset:32768
    ds_read_b64_tr_b16 v[214:215], v10 offset:32768
    ds_read_b64_tr_b16 v[222:223], v11 offset:32768
    s_waitcnt lgkmcnt(0)
    v_smfmac_f32_16x16x64_bf16 v[48:51], v[12:15], v[192:199], v1
    v_smfmac_f32_16x16x64_bf16 v[48:51], v[16:19], v[200:207], v1
    v_smfmac_f32_16x16x64_bf16 v[52:55], v[12:15], v[208:215], v1
    v_smfmac_f32_16x16x64_bf16 v[52:55], v[16:19], v[216:223], v1
    s_nop 5
    v_pk_add_f32 v[28:29], v[48:49], v[50:51]
    s_nop 0
    v_pk_add_f32 v[30:31], v[52:53], v[54:55]
    ds_write_b128 v36, v[24:27] offset:0
    ds_write_b128 v36, v[28:31] offset:1024
    s_waitcnt vmcnt(16)
    s_barrier
    ds_read_b64_tr_b16 v[230:231], v8 offset:49152
    ds_read_b64_tr_b16 v[238:239], v9 offset:49152
    ds_read_b64_tr_b16 v[246:247], v10 offset:49152
    ds_read_b64_tr_b16 v[254:255], v11 offset:49152
    s_waitcnt lgkmcnt(0)
    v_smfmac_f32_16x16x64_bf16 v[56:59], v[12:15], v[224:231], v1
    v_smfmac_f32_16x16x64_bf16 v[56:59], v[16:19], v[232:239], v1
    v_smfmac_f32_16x16x64_bf16 v[60:63], v[12:15], v[240:247], v1
    v_smfmac_f32_16x16x64_bf16 v[60:63], v[16:19], v[248:255], v1
    s_setprio 0
    s_cmp_lt_u32 s30, 2
    s_mov_b64 exec, 0xffff
    s_nop 2
    v_pk_add_f32 v[32:33], v[56:57], v[58:59]
    s_nop 0
    v_pk_add_f32 v[34:35], v[60:61], v[62:63]
    ds_write_b128 v36, v[32:35] offset:2048
    s_mov_b64 exec, -1
    s_cbranch_scc1 L_comb_0
    s_waitcnt lgkmcnt(0)
    s_barrier
L_comb_0b:
    s_cmp_eq_u32 s30, 6
    s_cbranch_scc0 L_skip_107
L_pad1:
    s_cbranch_execz L_pad5
    s_waitcnt vmcnt(0)
L_skip_107:
    s_barrier
    s_cmp_lt_u32 s3, 20
    s_cbranch_scc0 L_typeB_0
    s_lshr_b32 s57, s30, 1
    s_lshl_b32 s57, s57, 5
    s_add_u32 s57, s57, s62
    s_add_u32 s59, s57, 55808
    v_and_b32 v5, 7, v0
    v_lshlrev_b32 v5, 2, v5
    v_lshrrev_b32 v22, 4, v0
    v_lshlrev_b32 v22, 3, v22
    buffer_load_dword v18, v5, s[40:43], s59 offen sc1
    buffer_load_dwordx2 v[20:21], v22, s[40:43], s59 offen sc1
    s_mul_i32 s57, s30, 6144
    v_lshrrev_b32 v7, 2, v0
    v_lshlrev_b32 v7, 6, v7
    v_bfe_u32 v60, v0, 4, 1
    v_lshl_add_u32 v7, v60, 5, v7
    v_and_b32 v60, 3, v0
    v_lshl_add_u32 v7, v60, 3, v7
    v_add_u32 v7, s57, v7
    v_add_u32 v7, 30720, v7
    v_xor_b32 v8, 32, v7
    s_mul_i32 s60, s30, 1536
    s_add_u32 s60, s60, s62
    s_add_u32 s60, s60, 0
    v_lshlrev_b32 v9, 4, v0
    v_lshlrev_b32 v10, 3, v0
    ds_read_b64_tr_b16 v[36:37], v7 offset:0
    ds_read_b64_tr_b16 v[38:39], v7 offset:1024
    ds_read_b64_tr_b16 v[40:41], v7 offset:2048
    ds_read_b64_tr_b16 v[42:43], v7 offset:3072
    ds_read_b64_tr_b16 v[44:45], v7 offset:4096
    ds_read_b64_tr_b16 v[46:47], v7 offset:5120
    ds_read_b64_tr_b16 v[48:49], v8 offset:0
    ds_read_b64_tr_b16 v[50:51], v8 offset:1024
    ds_read_b64_tr_b16 v[52:53], v8 offset:2048
    ds_read_b64_tr_b16 v[54:55], v8 offset:3072
    ds_read_b64_tr_b16 v[56:57], v8 offset:4096
    ds_read_b64_tr_b16 v[58:59], v8 offset:5120
    v_mov_b64 v[24:25], 0
    v_mov_b64 v[26:27], 0
    v_mov_b64 v[28:29], 0
    v_mov_b64 v[30:31], 0
    s_lshl_b32 s57, s30, 8
    v_lshlrev_b32 v11, 2, v0
    v_add_u32 v11, s57, v11
    v_add_u32 v11, 157696, v11
    v_lshlrev_b32 v32, 2, v0
    v_add_u32 v32, 157696, v32
    s_add_u32 s58, s6, 0
    s_add_u32 s57, s58, 16384
    v_and_b32 v33, 15, v0
    v_lshlrev_b32 v33, 2, v33
    v_lshrrev_b32 v60, 5, v0
    v_lshl_add_u32 v33, v60, 6, v33
    v_bfe_u32 v60, v0, 4, 1
    v_lshl_add_u32 v33, v60, 13, v33
    s_lshl_b32 s74, s3, 2
    s_add_u32 s74, s74, s62
    s_add_u32 s74, s74, 56064
    s_xor_b32 s75, s30, 3
    v_add_u32 v34, s75, v0
    v_lshlrev_b32 v34, 24, v34
    s_branch L_pw_108
L_pr_109:
    buffer_load_dword v18, v5, s[40:43], s59 offen sc1
    buffer_load_dwordx2 v[20:21], v22, s[40:43], s59 offen sc1
    s_sub_u32 s56, s56, 1
    s_cbranch_scc1 L_done
L_pw_108:
    s_waitcnt vmcnt(0)
    v_max3_u32 v19, v18, v20, v21
    v_cmp_eq_u32 vcc, -1, v19
    s_cbranch_vccnz L_pr_109
    buffer_load_dwordx4 v[12:15], v9, s[40:43], s60 offen sc1
    buffer_load_dwordx2 v[16:17], v10, s[40:43], s60 offen offset:1024 sc1
    v_max_f32_dpp v19, v18, v18 row_ror:4 row_mask:0xf bank_mask:0xf
    s_nop 1
    v_max_f32_dpp v19, v19, v19 row_ror:2 row_mask:0xf bank_mask:0xf
    s_nop 1
    v_max_f32_dpp v19, v19, v19 row_ror:1 row_mask:0xf bank_mask:0xf
    v_sub_f32 v18, v18, v19
    v_sub_f32 v20, v20, v19
    v_sub_f32 v21, v21, v19
    v_exp_f32 v18, v18
    v_exp_f32 v20, v20
    v_exp_f32 v21, v21
    v_add_f32_dpp v18, v18, v18 row_ror:4 row_mask:0xf bank_mask:0xf
    s_nop 1
    v_add_f32_dpp v18, v18, v18 row_ror:2 row_mask:0xf bank_mask:0xf
L_pad2:
    s_cbranch_execz L_pad6
    s_nop 1
    v_add_f32_dpp v18, v18, v18 row_ror:1 row_mask:0xf bank_mask:0xf
    v_rcp_f32 v18, v18
    s_nop 0
    v_mul_f32 v20, v20, v18
    v_mul_f32 v21, v21, v18
    s_waitcnt lgkmcnt(0)
    s_branch L_pw_110
L_pr_111:
    buffer_load_dwordx4 v[12:15], v9, s[40:43], s60 offen sc1
    buffer_load_dwordx2 v[16:17], v10, s[40:43], s60 offen offset:1024 sc1
    s_sub_u32 s56, s56, 1
    s_cbranch_scc1 L_done
L_pw_110:
    s_waitcnt vmcnt(0)
    v_max3_u32 v19, v12, v13, v14
    v_max3_u32 v19, v19, v15, v16
    v_max_u32 v19, v19, v17
    v_cmp_eq_u32 vcc, -1, v19
    s_cbranch_vccnz L_pr_111
    v_smfmac_f32_16x16x64_bf16 v[24:27], v[12:15], v[36:43], v1
    v_smfmac_f32_16x16x64_bf16 v[28:31], v[12:15], v[48:55], v1
    v_smfmac_f32_16x16x32_bf16 v[24:27], v[16:17], v[44:47], v1
    v_smfmac_f32_16x16x32_bf16 v[28:31], v[16:17], v[56:59], v1
    s_nop 6
    v_pk_add_f32 v[24:25], v[24:25], v[26:27]
    v_pk_add_f32 v[28:29], v[28:29], v[30:31]
    v_mul_f32 v24, v24, v20
    v_mul_f32 v28, v28, v20
    v_fmac_f32 v24, v25, v21
    v_fmac_f32 v28, v29, v21
    s_nop 1
    v_permlane32_swap_b32 v24, v28
    v_add_f32 v24, v24, v28
    ds_write_b32 v11, v24
    s_cmp_eq_u32 s30, 2
    s_cbranch_scc1 L_fin_112
    s_cmp_eq_u32 s55, 0
    s_waitcnt lgkmcnt(0)
    s_barrier
    s_cbranch_scc1 L_gs_114
    buffer_store_dword v0, v34, s[40:43], s74 offen
L_gb_115:
L_finb_113:
    s_sub_u32 s57, s30, 4
    s_cmp_lt_u32 s57, 3
    s_cbranch_scc0 L_skip_116
    s_sub_u32 s60, s30, 4
    s_lshl_b32 s59, s60, 12
    s_add_u32 s59, s59, 79872
    s_mov_b32 s44, s20
    s_mov_b32 s45, s21
    s_mov_b32 s46, 1966080
    s_mov_b32 s47, 0x20000
    s_mul_i32 s57, s31, 3
    s_add_u32 s57, s57, s60
    s_mul_i32 s57, s57, 81920
    s_lshl_b32 s58, s3, 6
    s_add_u32 s57, s57, s58
    v_lshrrev_b32 v5, 2, v0
    v_mul_u32_u24 v5, 1280, v5
    v_and_b32 v60, 3, v0
    v_lshl_add_u32 v5, v60, 4, v5
    v_add_u32 v5, s57, v5
    s_add_u32 m0, s59, 0
    s_mov_b32 s57, 0
    buffer_load_dwordx4 v5, s[44:47], s57 offen nt lds
    s_add_u32 m0, s59, 1024
    s_mov_b32 s57, 20480
    buffer_load_dwordx4 v5, s[44:47], s57 offen nt lds
    s_add_u32 m0, s59, 2048
    s_mov_b32 s57, 40960
    buffer_load_dwordx4 v5, s[44:47], s57 offen nt lds
    s_add_u32 m0, s59, 3072
    s_mov_b32 s57, 61440
    buffer_load_dwordx4 v5, s[44:47], s57 offen nt lds
    s_mul_i32 s57, s31, 3
    s_add_u32 s57, s57, s60
    s_lshl_b32 s57, s57, 7
    v_lshlrev_b32 v5, 1, v0
    v_add_u32 v5, s57, v5
    global_load_ushort v8, v5, s[18:19]
    s_lshl_b32 s57, s60, 11
    v_lshlrev_b32 v11, 4, v0
    v_add_u32 v11, s57, v11
    v_lshrrev_b32 v7, 4, v0
    v_lshlrev_b32 v7, 9, v7
    v_bfe_u32 v60, v0, 2, 2
    v_lshl_add_u32 v7, v60, 6, v7
    v_and_b32 v60, 3, v0
    v_lshl_add_u32 v7, v60, 3, v7
    v_add_u32 v7, s59, v7
    s_add_u32 s58, s62, 49152
L_pr_118:
    buffer_load_dwordx4 v[12:15], v11, s[40:43], s58 offen offset:0 sc1
    buffer_load_dwordx4 v[16:19], v11, s[40:43], s58 offen offset:1024 sc1
L_pad3:
    s_cbranch_execz L_pad7
    s_sub_u32 s56, s56, 1
    s_cbranch_scc1 L_done
L_pw_117:
    s_waitcnt vmcnt(0)
    v_max3_u32 v60, v12, v13, v14
    v_max3_u32 v60, v60, v15, v16
    v_max3_u32 v60, v60, v17, v18
    v_max_u32 v60, v60, v19
    v_cmp_eq_u32 vcc, -1, v60
    s_cbranch_vccnz L_pr_118
    ds_read_b64_tr_b16 v[36:37], v7 offset:0
    ds_read_b64_tr_b16 v[38:39], v7 offset:256
    ds_read_b64_tr_b16 v[40:41], v7 offset:2048
    ds_read_b64_tr_b16 v[42:43], v7 offset:2304
    ds_read_b64_tr_b16 v[44:45], v7 offset:32
    ds_read_b64_tr_b16 v[46:47], v7 offset:288
    ds_read_b64_tr_b16 v[48:49], v7 offset:2080
    ds_read_b64_tr_b16 v[50:51], v7 offset:2336
    v_pk_add_f32 v[20:21], v[12:13], v[14:15]
    v_pk_add_f32 v[22:23], v[16:17], v[18:19]
    v_pk_add_f32 v[20:21], v[20:21], v[22:23]
    v_add_f32 v4, v20, v21
    v_lshlrev_b32 v8, 16, v8
    v_mov_b64 v[52:53], 0
    v_mov_b64 v[54:55], 0
    v_mov_b64 v[56:57], 0
    v_mov_b64 v[58:59], 0
    v_mov_b32 v9, 0xbdd2d3e8
    v_mov_b32 v10, 0xc0135761
    s_lshl_b32 s57, s60, 7
    s_add_u32 s57, s57, 159872
    v_lshlrev_b32 v32, 3, v0
    v_add_u32 v32, s57, v32
    v_lshlrev_b32 v33, 3, v0
    v_add_u32 v33, 129024, v33
    v_cmp_gt_u32 vcc, 16, v0
    s_nop 1
    v_cndmask_b32 v32, v33, v32, vcc
    v_and_b32 v33, 15, v0
    v_lshlrev_b32 v33, 3, v33
    v_lshrrev_b32 v60, 5, v0
    v_lshl_add_u32 v33, v60, 2, v33
    v_add_u32 v33, 159872, v33
    v_and_b32 v34, 15, v0
    v_lshlrev_b32 v34, 2, v34
    v_lshrrev_b32 v60, 5, v0
    v_lshl_add_u32 v34, v60, 6, v34
    v_bfe_u32 v60, v0, 4, 1
    v_lshl_add_u32 v34, v60, 13, v34
    s_add_u32 s60, s6, 131072
    s_add_u32 s59, s60, 16384
    s_lshl_b32 s74, s3, 2
    s_add_u32 s74, s74, s62
    s_add_u32 s74, s74, 56192
    s_xor_b32 s75, s30, 4
    v_add_u32 v5, s75, v0
    v_lshlrev_b32 v5, 24, v5
    s_add_u32 s58, s62, 36864
    s_add_u32 s57, s62, 55552
    v_and_b32 v7, 7, v0
    v_lshlrev_b32 v7, 3, v7
    s_waitcnt lgkmcnt(0)
    buffer_load_dwordx2 v[24:25], v7, s[40:43], s57 offen sc1
    buffer_load_dwordx4 v[12:15], v11, s[40:43], s58 offen offset:0 sc1
    buffer_load_dwordx4 v[16:19], v11, s[40:43], s58 offen offset:1024 sc1
    s_sleep 2
L_pr_120:
    buffer_load_dwordx2 v[24:25], v7, s[40:43], s57 offen sc1
    buffer_load_dwordx4 v[12:15], v11, s[40:43], s58 offen offset:0 sc1
    buffer_load_dwordx4 v[16:19], v11, s[40:43], s58 offen offset:1024 sc1
    s_sub_u32 s56, s56, 1
    s_cbranch_scc1 L_done
L_pw_119:
    s_waitcnt vmcnt(5)
    v_max_u32 v26, v24, v25
    v_cmp_eq_u32 vcc, -1, v26
    s_cbranch_vccnz L_pr_120
    buffer_load_dwordx4 v[12:15], v11, s[40:43], s58 offen offset:0 sc1
    buffer_load_dwordx4 v[16:19], v11, s[40:43], s58 offen offset:1024 sc1
    v_add_f32_dpp v2, v24, v24 row_ror:4 row_mask:0xf bank_mask:0xf
    v_add_f32_dpp v3, v25, v25 row_ror:4 row_mask:0xf bank_mask:0xf
    s_nop 0
    v_add_f32_dpp v2, v2, v2 row_ror:2 row_mask:0xf bank_mask:0xf
    v_add_f32_dpp v3, v3, v3 row_ror:2 row_mask:0xf bank_mask:0xf
    s_nop 0
    v_add_f32_dpp v2, v2, v2 row_ror:1 row_mask:0xf bank_mask:0xf
    v_add_f32_dpp v3, v3, v3 row_ror:1 row_mask:0xf bank_mask:0xf
L_pad4:
    s_cbranch_execz L_pad8
    v_mul_f32 v2, 0x3acccccd, v2
    v_mul_f32 v3, 0x3acccccd, v3
    v_fma_f32 v3, -v2, v2, v3
    v_max_f32 v3, 0, v3
    v_add_f32 v3, 0x3727c5ac, v3
    v_rsq_f32 v3, v3
    s_nop 0
    v_mul_f32 v2, v2, v3
    v_fma_f32 v8, -v2, v4, v8
    s_waitcnt vmcnt(5)
L_hw_121:
    v_pk_add_f32 v[20:21], v[12:13], v[14:15]
    v_pk_add_f32 v[22:23], v[16:17], v[18:19]
    v_pk_add_f32 v[20:21], v[20:21], v[22:23]
    v_add_f32 v20, v20, v21
    v_cmp_u_f32 vcc, v20, v20
    v_fma_f32 v20, v20, v3, v8
    s_cbranch_vccnz L_hr_122
L_hk_123:
    v_mul_f32 v21, v20, v20
    v_fma_f32 v21, v21, v9, v10
    v_mul_f32 v21, v21, v20
    v_exp_f32 v21, v21
    s_cmp_eq_u32 s55, 0
    v_add_f32 v21, 1.0, v21
    v_rcp_f32 v21, v21
    s_nop 0
    v_mul_f32 v20, v20, v21
    s_nop 1
    v_mov_b32_dpp v21, v20 row_shl:1 row_mask:0xf bank_mask:0xf bound_ctrl:0
    v_cvt_pk_bf16_f32 v28, v20, v21
    s_nop 1
    v_mov_b32_dpp v29, v28 row_shl:4 row_mask:0xf bank_mask:0xf bound_ctrl:0
    v_mov_b32_dpp v30, v28 row_shl:8 row_mask:0xf bank_mask:0xf bound_ctrl:0
    v_mov_b32_dpp v31, v28 row_shl:12 row_mask:0xf bank_mask:0xf bound_ctrl:0
    s_nop 1
    v_smfmac_f32_16x16x64_bf16 v[52:55], v[28:31], v[36:43], v1
    v_smfmac_f32_16x16x64_bf16 v[56:59], v[28:31], v[44:51], v1
    s_nop 6
    v_add_f32 v22, v52, v54
    v_add_f32 v23, v56, v58
    ds_write_b64 v32, v[22:23]
    s_cmp_eq_u32 s30, 4
    s_cbranch_scc0 L_skip_125
L_xw_126:
    ds_read2_b32 v[20:21], v33 offset0:0 offset1:32
    ds_read_b32 v22, v33 offset:256
    s_cmp_eq_u32 s55, 0
    s_waitcnt lgkmcnt(0)
    v_max3_u32 v23, v20, v21, v22
    v_add_f32 v20, v20, v21
    v_cmp_eq_u32 vcc, -1, v23
    v_add_f32 v20, v20, v22
    s_cbranch_vccnz L_xr_127
    v_min_u32 v20, -2, v20
    buffer_store_dword v20, v34, s[40:43], s60 offen sc1
    s_cbranch_scc1 L_gs_128
    buffer_store_dword v0, v5, s[40:43], s74 offen
L_gb_129:
L_skip_125:
    s_waitcnt vmcnt(0)
L_skip_116:
    s_branch L_p1
L_typeB_0:
    s_cmp_eq_u32 s53, 3
    s_cbranch_scc0 L_p1
    s_cmp_eq_u32 s30, 7
    s_cbranch_scc1 L_w7_130
    s_cmp_lt_u32 s30, 6
    s_cbranch_scc0 L_skip_132
    s_lshr_b32 s57, s30, 1
    s_mul_i32 s57, s57, 128
    s_and_b32 s58, s30, 1
    s_lshl_b32 s58, s58, 6
    s_add_u32 s57, s57, s58
    v_lshrrev_b32 v18, 5, v0
    v_lshlrev_b32 v18, 13, v18
    v_bfe_u32 v60, v0, 3, 1
    v_lshl_add_u32 v18, v60, 12, v18
    v_bfe_u32 v60, v0, 4, 1
    v_lshl_add_u32 v18, v60, 11, v18
    v_bfe_u32 v60, v0, 2, 1
    v_mul_u32_u24 v60, 384, v60
    v_add_u32 v18, v60, v18
    v_and_b32 v60, 3, v0
    v_lshl_add_u32 v18, v60, 3, v18
    v_add_u32 v18, s57, v18
    v_add_u32 v18, 30720, v18
    v_bfe_u32 v19, v0, 4, 1
    v_lshlrev_b32 v19, 12, v19
    v_bfe_u32 v60, v0, 3, 1
    v_lshl_add_u32 v19, v60, 11, v19
    v_bfe_u32 v60, v0, 2, 1
    v_mul_u32_u24 v60, 384, v60
    v_add_u32 v19, v60, v19
    v_and_b32 v60, 3, v0
    v_lshl_add_u32 v19, v60, 3, v19
L_pad5:
    s_cbranch_execz L_pad9
    v_add_u32 v19, s57, v19
    v_add_u32 v19, 63488, v19
    ds_read_b64_tr_b16 v[36:37], v18 offset:0
    ds_read_b64_tr_b16 v[38:39], v18 offset:1024
    ds_read_b64_tr_b16 v[40:41], v18 offset:16384
    ds_read_b64_tr_b16 v[42:43], v18 offset:17408
    ds_read_b64_tr_b16 v[44:45], v19 offset:0
    ds_read_b64_tr_b16 v[46:47], v19 offset:1024
    ds_read_b64_tr_b16 v[48:49], v18 offset:32
    ds_read_b64_tr_b16 v[50:51], v18 offset:1056
    ds_read_b64_tr_b16 v[52:53], v18 offset:16416
    ds_read_b64_tr_b16 v[54:55], v18 offset:17440
    ds_read_b64_tr_b16 v[56:57], v19 offset:32
    ds_read_b64_tr_b16 v[58:59], v19 offset:1056
    v_lshrrev_b32 v32, 4, v0
    v_lshlrev_b32 v32, 5, v32
    v_bfe_u32 v60, v0, 1, 1
    v_lshl_add_u32 v32, v60, 4, v32
    v_and_b32 v60, 1, v0
    v_mul_u32_u24 v60, 192, v60
    v_add_u32 v32, v60, v32
    v_add_u32 v32, 160832, v32
    v_lshrrev_b32 v33, 4, v0
    v_lshlrev_b32 v33, 4, v33
    v_bfe_u32 v60, v0, 1, 1
    v_lshl_add_u32 v33, v60, 3, v33
    v_and_b32 v60, 1, v0
    v_mul_u32_u24 v60, 192, v60
    v_add_u32 v33, v60, v33
    v_add_u32 v33, 160960, v33
    v_mov_b64 v[24:25], 0
    v_mov_b64 v[26:27], 0
    v_mov_b64 v[28:29], 0
    v_mov_b64 v[30:31], 0
    s_lshr_b32 s57, s30, 1
    s_lshl_b32 s57, s57, 11
    s_and_b32 s58, s30, 1
    s_lshl_b32 s58, s58, 9
    s_add_u32 s57, s57, s58
    s_lshr_b32 s58, s54, 2
    s_lshl_b32 s58, s58, 10
    s_add_u32 s57, s57, s58
    s_and_b32 s58, s54, 3
    s_lshl_b32 s58, s58, 2
    s_add_u32 s57, s57, s58
    v_and_b32 v34, 31, v0
    v_lshlrev_b32 v34, 4, v34
    v_lshrrev_b32 v60, 5, v0
    v_lshl_add_u32 v34, v60, 30, v34
    v_add_u32 v34, s57, v34
    s_add_u32 s59, s62, 36864
    s_add_u32 s60, s62, 55552
    ds_read_b128 v[12:15], v32
    ds_read_b64 v[16:17], v33
    s_waitcnt lgkmcnt(1)
    v_smfmac_f32_16x16x64_bf16 v[24:27], v[12:15], v[36:43], v1
    v_smfmac_f32_16x16x64_bf16 v[28:31], v[12:15], v[48:55], v1
    s_waitcnt lgkmcnt(0)
    v_smfmac_f32_16x16x32_bf16 v[24:27], v[16:17], v[44:47], v1
    v_smfmac_f32_16x16x32_bf16 v[28:31], v[16:17], v[56:59], v1
    s_add_u32 s60, s62, 49152
    s_cmp_eq_u32 s55, 0
    s_nop 4
    v_add_f32 v12, v25, v27
    s_nop 1
    v_add_f32_dpp v12, v29, v31 quad_perm:[0,1,2,3] row_mask:0x2 bank_mask:0xf
    v_min_u32 v12, -2, v12
    s_cbranch_scc1 L_gs_133
    buffer_store_dword v12, v34, s[40:43], s60 offen
L_gb_134:
    v_mov_b64 v[24:25], 0
    v_mov_b64 v[26:27], 0
    v_mov_b64 v[28:29], 0
    v_mov_b64 v[30:31], 0
L_skip_132:
    s_cmp_lt_u32 s30, 6
    s_barrier
    s_cbranch_scc0 L_se_131
    ds_read_b128 v[12:15], v32
    ds_read_b64 v[16:17], v33
    s_waitcnt lgkmcnt(1)
    v_smfmac_f32_16x16x64_bf16 v[24:27], v[12:15], v[36:43], v1
    v_smfmac_f32_16x16x64_bf16 v[28:31], v[12:15], v[48:55], v1
    s_waitcnt lgkmcnt(0)
    v_smfmac_f32_16x16x32_bf16 v[24:27], v[16:17], v[44:47], v1
    v_smfmac_f32_16x16x32_bf16 v[28:31], v[16:17], v[56:59], v1
    s_cmp_eq_u32 s55, 0
    s_nop 5
    v_add_f32 v12, v24, v26
L_pad6:
    s_cbranch_execz L_pad10
    s_nop 1
    v_add_f32_dpp v12, v28, v30 quad_perm:[0,1,2,3] row_mask:0x2 bank_mask:0xf
    v_min_u32 v12, -2, v12
    s_cbranch_scc1 L_gs_135
    buffer_store_dword v12, v34, s[40:43], s59 offen
L_gb_136:
L_se_131:
L_p1:
    s_cmp_eq_u32 s30, 7
    s_cbranch_scc1 L_w7_144
    s_cmp_lt_u32 s30, 6
    s_cbranch_scc0 L_skip_146
    s_lshr_b32 s57, s30, 1
    s_mul_i32 s57, s57, 1024
    s_and_b32 s58, s30, 1
    s_lshl_b32 s58, s58, 6
    s_add_u32 s57, s57, s58
    v_lshrrev_b32 v18, 5, v0
    v_mul_u32_u24 v18, 6144, v18
    v_bfe_u32 v60, v0, 3, 1
    v_mul_u32_u24 v60, 3072, v60
    v_add_u32 v18, v60, v18
    v_bfe_u32 v60, v0, 4, 1
    v_lshl_add_u32 v18, v60, 9, v18
    v_bfe_u32 v60, v0, 2, 1
    v_lshl_add_u32 v18, v60, 7, v18
    v_and_b32 v60, 3, v0
    v_lshl_add_u32 v18, v60, 3, v18
    v_add_u32 v18, s57, v18
    v_bfe_u32 v19, v0, 4, 1
    v_mul_u32_u24 v19, 3072, v19
    v_bfe_u32 v60, v0, 3, 1
    v_lshl_add_u32 v19, v60, 9, v19
    v_bfe_u32 v60, v0, 2, 1
    v_lshl_add_u32 v19, v60, 7, v19
    v_and_b32 v60, 3, v0
    v_lshl_add_u32 v19, v60, 3, v19
    v_add_u32 v19, s57, v19
    v_add_u32 v19, 24576, v19
    ds_read_b64_tr_b16 v[36:37], v18 offset:0
    ds_read_b64_tr_b16 v[38:39], v18 offset:256
    ds_read_b64_tr_b16 v[40:41], v18 offset:12288
    ds_read_b64_tr_b16 v[42:43], v18 offset:12544
    ds_read_b64_tr_b16 v[44:45], v19 offset:0
    ds_read_b64_tr_b16 v[46:47], v19 offset:256
    ds_read_b64_tr_b16 v[48:49], v18 offset:32
    ds_read_b64_tr_b16 v[50:51], v18 offset:288
    ds_read_b64_tr_b16 v[52:53], v18 offset:12320
    ds_read_b64_tr_b16 v[54:55], v18 offset:12576
    ds_read_b64_tr_b16 v[56:57], v19 offset:32
    ds_read_b64_tr_b16 v[58:59], v19 offset:288
    v_lshrrev_b32 v32, 4, v0
    v_lshlrev_b32 v32, 5, v32
    v_bfe_u32 v60, v0, 1, 1
    v_lshl_add_u32 v32, v60, 4, v32
    v_and_b32 v60, 1, v0
    v_mul_u32_u24 v60, 192, v60
    v_add_u32 v32, v60, v32
    v_add_u32 v32, 160832, v32
    v_lshrrev_b32 v33, 4, v0
    v_lshlrev_b32 v33, 4, v33
    v_bfe_u32 v60, v0, 1, 1
    v_lshl_add_u32 v33, v60, 3, v33
    v_and_b32 v60, 1, v0
    v_mul_u32_u24 v60, 192, v60
    v_add_u32 v33, v60, v33
    v_add_u32 v33, 160960, v33
    v_mov_b64 v[24:25], 0
    v_mov_b64 v[26:27], 0
    v_mov_b64 v[28:29], 0
    v_mov_b64 v[30:31], 0
    s_lshr_b32 s57, s54, 1
    s_lshl_b32 s57, s57, 2
    s_and_b32 s58, s54, 1
    s_add_u32 s57, s57, s58
    s_lshl_b32 s57, s57, 4
    s_lshl_b32 s58, s30, 9
    s_add_u32 s57, s57, s58
    v_bfe_u32 v34, v0, 4, 1
    v_lshlrev_b32 v34, 8, v34
    v_bfe_u32 v60, v0, 1, 1
    v_lshl_add_u32 v34, v60, 5, v34
    v_bfe_u32 v60, v0, 2, 2
    v_lshl_add_u32 v34, v60, 2, v34
    v_lshrrev_b32 v60, 5, v0
    v_lshl_add_u32 v34, v60, 29, v34
L_pad7:
    s_cbranch_execz L_pad11
    v_and_b32 v60, 1, v0
    v_lshl_add_u32 v34, v60, 30, v34
    v_add_u32 v34, s57, v34
    s_mul_i32 s59, s53, 3072
    s_add_u32 s59, s59, s62
    s_add_u32 s59, s59, 24576
    s_lshl_b32 s60, s53, 6
    s_add_u32 s60, s60, s62
    s_add_u32 s60, s60, 55296
L_skip_146:
    s_cmp_lt_u32 s30, 6
    s_barrier
    s_cbranch_scc0 L_se_145
    ds_read_b128 v[12:15], v32
    ds_read_b64 v[16:17], v33
    s_waitcnt lgkmcnt(1)
    v_smfmac_f32_16x16x64_bf16 v[24:27], v[12:15], v[36:43], v1
    v_smfmac_f32_16x16x64_bf16 v[28:31], v[12:15], v[48:55], v1
    s_waitcnt lgkmcnt(0)
    v_smfmac_f32_16x16x32_bf16 v[24:27], v[16:17], v[44:47], v1
    v_smfmac_f32_16x16x32_bf16 v[28:31], v[16:17], v[56:59], v1
    s_cmp_eq_u32 s55, 0
    s_nop 5
    v_add_f32 v12, v24, v26
    s_nop 1
    v_add_f32_dpp v12, v28, v30 quad_perm:[0,1,2,3] row_mask:0x2 bank_mask:0xf
    s_nop 1
    v_mov_b32_dpp v13, v12 row_shl:1 row_mask:0xf bank_mask:0xf bound_ctrl:0
    v_cvt_pk_bf16_f32 v12, v12, v13
    v_min_u32 v12, -2, v12
    s_cbranch_scc1 L_gs_147
    buffer_store_dword v12, v34, s[40:43], s59 offen
L_gb_148:
L_se_145:
    v_lshlrev_b32 v5, 4, v0
    v_add_u32 v5, 124928, v5
    s_mul_i32 s59, s53, 3072
    s_add_u32 s59, s59, s62
    s_add_u32 s59, s59, 24576
    s_lshl_b32 s60, s53, 6
    s_add_u32 s60, s60, s62
    s_add_u32 s60, s60, 55296
    v_lshlrev_b32 v8, 4, v0
    s_cmp_eq_u32 s30, 2
    s_cbranch_scc1 L_q3_164
    s_cmp_eq_u32 s30, 3
    s_cbranch_scc1 L_q3_168
    s_cmp_eq_u32 s30, 1
    s_cbranch_scc0 L_qo_162
    buffer_load_dwordx4 v[12:15], v8, s[40:43], s59 offen offset:0 sc1
    v_mov_b64 v[24:25], 0
    v_mov_b64 v[26:27], 0
    v_mov_b64 v[28:29], 0
    v_mov_b64 v[30:31], 0
    v_mov_b64 v[32:33], 0
    v_mov_b64 v[34:35], 0
    v_mov_b64 v[36:37], 0
    v_mov_b64 v[38:39], 0
    v_mov_b64 v[40:41], 0
    v_mov_b64 v[42:43], 0
    v_mov_b64 v[44:45], 0
    v_mov_b64 v[46:47], 0
    v_mov_b64 v[48:49], 0
    v_mov_b64 v[50:51], 0
    v_mov_b64 v[52:53], 0
    v_mov_b64 v[54:55], 0
    v_mov_b64 v[56:57], 0
    v_mov_b64 v[58:59], 0
    v_mov_b64 v[60:61], 0
    v_mov_b64 v[62:63], 0
    s_lshl_b32 s58, s30, 3
    s_add_u32 s58, s58, 159808
    v_mov_b32 v11, s58
    v_lshlrev_b32 v10, 3, v0
    v_add_u32 v10, 157696, v10
    v_cmp_eq_u32 vcc, 63, v0
    s_nop 1
    v_cndmask_b32 v10, v10, v11, vcc
    s_lshl_b32 s57, s30, 12
    v_lshlrev_b32 v7, 4, v0
    v_add_u32 v7, s57, v7
    v_add_u32 v7, 92160, v7
    v_mov_b32 v11, 128000
    s_setprio 1
    s_cmp_lt_u32 s30, 4
    s_cbranch_scc0 L_skip_174
    s_setprio 2
L_skip_174:
L_pr_173:
    buffer_load_dwordx4 v[12:15], v8, s[40:43], s59 offen offset:0 sc1
    s_sub_u32 s56, s56, 1
    s_cbranch_scc1 L_done
L_pw_172:
    s_waitcnt vmcnt(1)
    v_max3_u32 v9, v12, v13, v14
    v_max_u32 v9, v9, v15
    v_cmp_eq_u32 vcc, -1, v9
    s_cbranch_vccnz L_pr_173
    ds_write_b128 v5, v[12:15] offset:0
L_qb_163:
    s_waitcnt lgkmcnt(0)
    s_barrier
    ds_read_b128 v[12:15], v5 offset:0
    ds_read_b128 v[16:19], v5 offset:1024
    ds_read_b128 v[20:23], v5 offset:2048
L_pad8:
    s_cbranch_execz L_pad12
    ds_read_b64 v[8:9], v11
    s_cmp_lt_u32 s30, 4
    s_waitcnt lgkmcnt(3)
    v_smfmac_f32_16x16x64_bf16 v[24:27], v[12:15], v[64:71], v1
    s_waitcnt lgkmcnt(2)
    v_smfmac_f32_16x16x64_bf16 v[24:27], v[16:19], v[72:79], v1
    s_waitcnt lgkmcnt(0)
    v_smfmac_f32_16x16x64_bf16 v[24:27], v[20:23], v[80:87], v1
    v_mul_f32 v8, v8, v6
    v_smfmac_f32_16x16x64_bf16 v[32:35], v[12:15], v[112:119], v1
    v_smfmac_f32_16x16x64_bf16 v[32:35], v[16:19], v[120:127], v1
    v_smfmac_f32_16x16x64_bf16 v[32:35], v[20:23], v[128:135], v1
    s_waitcnt vmcnt(0)
    v_smfmac_f32_16x16x64_bf16 v[28:31], v[12:15], v[88:95], v1
    v_smfmac_f32_16x16x64_bf16 v[28:31], v[16:19], v[96:103], v1
    v_smfmac_f32_16x16x64_bf16 v[28:31], v[20:23], v[104:111], v1
    v_smfmac_f32_16x16x64_bf16 v[36:39], v[12:15], v[136:143], v1
    v_pk_add_f32 v[24:25], v[24:25], v[26:27]
    v_add_f32 v24, v24, v25
    v_smfmac_f32_16x16x64_bf16 v[36:39], v[16:19], v[144:151], v1
    v_pk_add_f32 v[32:33], v[32:33], v[34:35]
    v_add_f32 v32, v32, v33
    v_smfmac_f32_16x16x64_bf16 v[36:39], v[20:23], v[152:159], v1
    s_cbranch_scc0 L_lo_178
    s_setprio 0
L_lo_178:
    v_permlane32_swap_b32 v24, v32
    v_add_f32 v24, v24, v32
    v_pk_add_f32 v[28:29], v[28:29], v[30:31]
    v_add_f32 v28, v28, v29
    s_nop 2
    v_pk_add_f32 v[36:37], v[36:37], v[38:39]
    v_add_f32 v36, v36, v37
    s_nop 1
    v_permlane32_swap_b32 v28, v36
    v_add_f32 v28, v28, v36
    s_nop 1
    v_permlane16_swap_b32 v24, v28
    v_add_f32 v24, v24, v28
    v_fma_f32 v24, v24, v9, v8
    s_mov_b32 vcc_lo, 0x55555555
    s_mov_b32 vcc_hi, 0x55555555
    v_max_f32_dpp v20, v24, v24 row_ror:8 row_mask:0xf bank_mask:0xf
    s_nop 1
    v_max_f32_dpp v20, v20, v20 row_ror:4 row_mask:0xf bank_mask:0xf
    s_nop 1
    v_max_f32_dpp v20, v20, v20 row_ror:2 row_mask:0xf bank_mask:0xf
    s_nop 1
    v_max_f32_dpp v20, v20, v20 row_ror:1 row_mask:0xf bank_mask:0xf
    s_nop 1
    v_max_f32_dpp v20, v20, v20 row_bcast:15 row_mask:0xa bank_mask:0xf
    s_nop 1
    v_max_f32_dpp v20, v20, v20 row_bcast:31 row_mask:0xc bank_mask:0xf
    s_nop 0
    v_readlane_b32 s57, v20, 63
    s_nop 1
    v_subrev_f32 v24, s57, v24
    v_exp_f32 v22, v24
    s_nop 1
    v_mov_b32_dpp v23, v22 row_shl:1 row_mask:0xf bank_mask:0xf bound_ctrl:0
    v_cvt_pk_bf16_f32 v23, v22, v23
    v_cndmask_b32 v12, 0, v23, vcc
    v_add_f32_dpp v21, v22, v22 row_ror:8 row_mask:0xf bank_mask:0xf
    s_nop 0
    v_mov_b32_dpp v13, v12 row_shl:4 row_mask:0xf bank_mask:0xf bound_ctrl:0
    v_mov_b32_dpp v14, v12 row_shl:8 row_mask:0xf bank_mask:0xf bound_ctrl:0
    v_mov_b32_dpp v15, v12 row_shl:12 row_mask:0xf bank_mask:0xf bound_ctrl:0
    v_add_f32_dpp v21, v21, v21 row_ror:4 row_mask:0xf bank_mask:0xf
    v_mov_b32_dpp v16, v12 row_shr:1 row_mask:0xf bank_mask:0xf bound_ctrl:0
    v_smfmac_f32_16x16x64_bf16 v[40:43], v[12:15], v[160:167], v1
    v_add_f32_dpp v21, v21, v21 row_ror:2 row_mask:0xf bank_mask:0xf
    v_mov_b32_dpp v17, v12 row_shl:3 row_mask:0xf bank_mask:0xf bound_ctrl:0
    v_smfmac_f32_16x16x64_bf16 v[44:47], v[12:15], v[176:183], v1
    v_add_f32_dpp v21, v21, v21 row_ror:1 row_mask:0xf bank_mask:0xf
    v_mov_b32_dpp v18, v12 row_shl:7 row_mask:0xf bank_mask:0xf bound_ctrl:0
    v_smfmac_f32_16x16x64_bf16 v[48:51], v[12:15], v[192:199], v1
    v_add_f32_dpp v21, v21, v21 row_bcast:15 row_mask:0xa bank_mask:0xf
    v_mov_b32_dpp v19, v12 row_shl:11 row_mask:0xf bank_mask:0xf bound_ctrl:0
    v_smfmac_f32_16x16x64_bf16 v[52:55], v[12:15], v[208:215], v1
    v_add_f32_dpp v21, v21, v21 row_bcast:31 row_mask:0xc bank_mask:0xf
    ds_write_b64 v10, v[20:21]
L_pad9:
    s_cbranch_execz L_pad13
    v_smfmac_f32_16x16x64_bf16 v[40:43], v[16:19], v[168:175], v1
    s_nop 1
    v_smfmac_f32_16x16x64_bf16 v[44:47], v[16:19], v[184:191], v1
    s_nop 1
    v_smfmac_f32_16x16x64_bf16 v[48:51], v[16:19], v[200:207], v1
    s_nop 1
    v_smfmac_f32_16x16x64_bf16 v[52:55], v[16:19], v[216:223], v1
    v_pk_add_f32 v[24:25], v[40:41], v[42:43]
    s_nop 0
    v_smfmac_f32_16x16x64_bf16 v[56:59], v[12:15], v[224:231], v1
    v_pk_add_f32 v[26:27], v[44:45], v[46:47]
    ds_write_b128 v7, v[24:27] offset:0
    v_smfmac_f32_16x16x64_bf16 v[60:63], v[12:15], v[240:247], v1
    v_pk_add_f32 v[28:29], v[48:49], v[50:51]
    s_nop 0
    v_smfmac_f32_16x16x64_bf16 v[56:59], v[16:19], v[232:239], v1
    v_pk_add_f32 v[30:31], v[52:53], v[54:55]
    ds_write_b128 v7, v[28:31] offset:1024
    v_smfmac_f32_16x16x64_bf16 v[60:63], v[16:19], v[248:255], v1
    s_cmp_lt_u32 s30, 2
    s_mov_b64 exec, 0xffff
    s_nop 2
    v_pk_add_f32 v[32:33], v[56:57], v[58:59]
    s_nop 1
    v_pk_add_f32 v[34:35], v[60:61], v[62:63]
    ds_write_b128 v7, v[32:35] offset:2048
    s_mov_b64 exec, -1
    s_setprio 0
    s_cbranch_scc1 L_comb_1
    s_waitcnt lgkmcnt(0)
    s_barrier
L_comb_1b:
    s_cmp_lt_u32 s3, 20
    s_cbranch_scc0 L_typeB_1
    s_lshr_b32 s57, s30, 1
    s_lshl_b32 s57, s57, 5
    s_add_u32 s57, s57, s62
    s_add_u32 s59, s57, 55936
    v_and_b32 v5, 7, v0
    v_lshlrev_b32 v5, 2, v5
    v_lshrrev_b32 v22, 4, v0
    v_lshlrev_b32 v22, 3, v22
    buffer_load_dword v18, v5, s[40:43], s59 offen sc1
    buffer_load_dwordx2 v[20:21], v22, s[40:43], s59 offen sc1
    s_mul_i32 s57, s30, 6144
    v_lshrrev_b32 v7, 2, v0
    v_lshlrev_b32 v7, 6, v7
    v_bfe_u32 v60, v0, 4, 1
    v_lshl_add_u32 v7, v60, 5, v7
    v_and_b32 v60, 3, v0
    v_lshl_add_u32 v7, v60, 3, v7
    v_add_u32 v7, s57, v7
    v_add_u32 v7, 30720, v7
    v_xor_b32 v8, 32, v7
    s_mul_i32 s60, s30, 1536
    s_add_u32 s60, s60, s62
    s_add_u32 s60, s60, 12288
    v_lshlrev_b32 v9, 4, v0
    v_lshlrev_b32 v10, 3, v0
    ds_read_b64_tr_b16 v[36:37], v7 offset:0
    ds_read_b64_tr_b16 v[38:39], v7 offset:1024
    ds_read_b64_tr_b16 v[40:41], v7 offset:2048
    ds_read_b64_tr_b16 v[42:43], v7 offset:3072
    ds_read_b64_tr_b16 v[44:45], v7 offset:4096
    ds_read_b64_tr_b16 v[46:47], v7 offset:5120
    ds_read_b64_tr_b16 v[48:49], v8 offset:0
    ds_read_b64_tr_b16 v[50:51], v8 offset:1024
    ds_read_b64_tr_b16 v[52:53], v8 offset:2048
    ds_read_b64_tr_b16 v[54:55], v8 offset:3072
    ds_read_b64_tr_b16 v[56:57], v8 offset:4096
    ds_read_b64_tr_b16 v[58:59], v8 offset:5120
    v_mov_b64 v[24:25], 0
    v_mov_b64 v[26:27], 0
    v_mov_b64 v[28:29], 0
    v_mov_b64 v[30:31], 0
    s_lshl_b32 s57, s30, 8
    v_lshlrev_b32 v11, 2, v0
    v_add_u32 v11, s57, v11
    v_add_u32 v11, 157696, v11
    v_lshlrev_b32 v32, 2, v0
    v_add_u32 v32, 157696, v32
    s_add_u32 s58, s6, 262144
    s_add_u32 s57, s58, 16384
L_pad10:
    s_cbranch_execz L_pad14
    v_and_b32 v33, 15, v0
    v_lshlrev_b32 v33, 2, v33
    v_lshrrev_b32 v60, 5, v0
    v_lshl_add_u32 v33, v60, 6, v33
    v_bfe_u32 v60, v0, 4, 1
    v_lshl_add_u32 v33, v60, 13, v33
    s_lshl_b32 s74, s3, 2
    s_add_u32 s74, s74, s62
    s_add_u32 s74, s74, 56320
    s_xor_b32 s75, s30, 3
    v_add_u32 v34, s75, v0
    v_lshlrev_b32 v34, 24, v34
    s_branch L_pw_185
L_pr_186:
    buffer_load_dword v18, v5, s[40:43], s59 offen sc1
    buffer_load_dwordx2 v[20:21], v22, s[40:43], s59 offen sc1
    s_sub_u32 s56, s56, 1
    s_cbranch_scc1 L_done
L_pw_185:
    s_waitcnt vmcnt(0)
    v_max3_u32 v19, v18, v20, v21
    v_cmp_eq_u32 vcc, -1, v19
    s_cbranch_vccnz L_pr_186
    buffer_load_dwordx4 v[12:15], v9, s[40:43], s60 offen sc1
    buffer_load_dwordx2 v[16:17], v10, s[40:43], s60 offen offset:1024 sc1
    v_max_f32_dpp v19, v18, v18 row_ror:4 row_mask:0xf bank_mask:0xf
    s_nop 1
    v_max_f32_dpp v19, v19, v19 row_ror:2 row_mask:0xf bank_mask:0xf
    s_nop 1
    v_max_f32_dpp v19, v19, v19 row_ror:1 row_mask:0xf bank_mask:0xf
    v_sub_f32 v18, v18, v19
    v_sub_f32 v20, v20, v19
    v_sub_f32 v21, v21, v19
    v_exp_f32 v18, v18
    v_exp_f32 v20, v20
    v_exp_f32 v21, v21
    v_add_f32_dpp v18, v18, v18 row_ror:4 row_mask:0xf bank_mask:0xf
    s_nop 1
    v_add_f32_dpp v18, v18, v18 row_ror:2 row_mask:0xf bank_mask:0xf
    s_nop 1
    v_add_f32_dpp v18, v18, v18 row_ror:1 row_mask:0xf bank_mask:0xf
    v_rcp_f32 v18, v18
    s_nop 0
    v_mul_f32 v20, v20, v18
    v_mul_f32 v21, v21, v18
    s_waitcnt lgkmcnt(0)
    s_branch L_pw_187
L_pr_188:
    buffer_load_dwordx4 v[12:15], v9, s[40:43], s60 offen sc1
    buffer_load_dwordx2 v[16:17], v10, s[40:43], s60 offen offset:1024 sc1
    s_sub_u32 s56, s56, 1
    s_cbranch_scc1 L_done
L_pw_187:
    s_waitcnt vmcnt(0)
    v_max3_u32 v19, v12, v13, v14
    v_max3_u32 v19, v19, v15, v16
    v_max_u32 v19, v19, v17
    v_cmp_eq_u32 vcc, -1, v19
    s_cbranch_vccnz L_pr_188
    v_smfmac_f32_16x16x64_bf16 v[24:27], v[12:15], v[36:43], v1
    v_smfmac_f32_16x16x64_bf16 v[28:31], v[12:15], v[48:55], v1
    v_smfmac_f32_16x16x32_bf16 v[24:27], v[16:17], v[44:47], v1
    v_smfmac_f32_16x16x32_bf16 v[28:31], v[16:17], v[56:59], v1
    s_nop 6
    v_pk_add_f32 v[24:25], v[24:25], v[26:27]
    v_pk_add_f32 v[28:29], v[28:29], v[30:31]
    v_mul_f32 v24, v24, v20
    v_mul_f32 v28, v28, v20
    v_fmac_f32 v24, v25, v21
    v_fmac_f32 v28, v29, v21
    s_nop 1
    v_permlane32_swap_b32 v24, v28
    v_add_f32 v24, v24, v28
    ds_write_b32 v11, v24
    s_cmp_eq_u32 s30, 2
    s_cbranch_scc1 L_fin_189
    s_cmp_eq_u32 s55, 0
    s_waitcnt lgkmcnt(0)
    s_barrier
    s_cbranch_scc1 L_gs_191
    buffer_store_dword v0, v34, s[40:43], s74 offen
L_gb_192:
L_finb_190:
    s_sub_u32 s57, s30, 4
    s_cmp_lt_u32 s57, 3
    s_cbranch_scc0 L_skip_193
    s_sub_u32 s60, s30, 4
    s_lshl_b32 s59, s60, 12
    s_add_u32 s59, s59, 79872
    s_mul_i32 s57, s31, 3
    s_add_u32 s57, s57, s60
    s_lshl_b32 s57, s57, 7
    v_lshlrev_b32 v5, 1, v0
    v_add_u32 v5, s57, v5
    global_load_ushort v8, v5, s[18:19]
    s_lshl_b32 s57, s60, 11
    v_lshlrev_b32 v11, 4, v0
    v_add_u32 v11, s57, v11
    v_lshrrev_b32 v7, 4, v0
    v_lshlrev_b32 v7, 9, v7
    v_bfe_u32 v60, v0, 2, 2
    v_lshl_add_u32 v7, v60, 6, v7
L_pad11:
    s_cbranch_execz L_pad15
    v_and_b32 v60, 3, v0
    v_lshl_add_u32 v7, v60, 3, v7
    v_add_u32 v7, s59, v7
    s_add_u32 s58, s62, 49152
L_pr_195:
    buffer_load_dwordx4 v[12:15], v11, s[40:43], s58 offen offset:0 sc1
    buffer_load_dwordx4 v[16:19], v11, s[40:43], s58 offen offset:1024 sc1
    s_sub_u32 s56, s56, 1
    s_cbranch_scc1 L_done
L_pw_194:
    s_waitcnt vmcnt(0)
    v_max3_u32 v60, v12, v13, v14
    v_max3_u32 v60, v60, v15, v16
    v_max3_u32 v60, v60, v17, v18
    v_max_u32 v60, v60, v19
    v_cmp_eq_u32 vcc, -1, v60
    s_cbranch_vccnz L_pr_195
    ds_read_b64_tr_b16 v[36:37], v7 offset:0
    ds_read_b64_tr_b16 v[38:39], v7 offset:256
    ds_read_b64_tr_b16 v[40:41], v7 offset:2048
    ds_read_b64_tr_b16 v[42:43], v7 offset:2304
    ds_read_b64_tr_b16 v[44:45], v7 offset:32
    ds_read_b64_tr_b16 v[46:47], v7 offset:288
    ds_read_b64_tr_b16 v[48:49], v7 offset:2080
    ds_read_b64_tr_b16 v[50:51], v7 offset:2336
    v_pk_add_f32 v[20:21], v[12:13], v[14:15]
    v_pk_add_f32 v[22:23], v[16:17], v[18:19]
    v_pk_add_f32 v[20:21], v[20:21], v[22:23]
    v_add_f32 v4, v20, v21
    v_lshlrev_b32 v8, 16, v8
    v_mov_b64 v[52:53], 0
    v_mov_b64 v[54:55], 0
    v_mov_b64 v[56:57], 0
    v_mov_b64 v[58:59], 0
    v_mov_b32 v9, 0xbdd2d3e8
    v_mov_b32 v10, 0xc0135761
    s_lshl_b32 s57, s60, 7
    s_add_u32 s57, s57, 160256
    v_lshlrev_b32 v32, 3, v0
    v_add_u32 v32, s57, v32
    v_lshlrev_b32 v33, 3, v0
    v_add_u32 v33, 129024, v33
    v_cmp_gt_u32 vcc, 16, v0
    s_nop 1
    v_cndmask_b32 v32, v33, v32, vcc
    v_and_b32 v33, 15, v0
    v_lshlrev_b32 v33, 3, v33
    v_lshrrev_b32 v60, 5, v0
    v_lshl_add_u32 v33, v60, 2, v33
    v_add_u32 v33, 160256, v33
    v_and_b32 v34, 15, v0
    v_lshlrev_b32 v34, 2, v34
    v_lshrrev_b32 v60, 5, v0
    v_lshl_add_u32 v34, v60, 6, v34
    v_bfe_u32 v60, v0, 4, 1
    v_lshl_add_u32 v34, v60, 13, v34
    s_add_u32 s60, s6, 393216
    s_add_u32 s59, s60, 16384
    s_lshl_b32 s74, s3, 2
    s_add_u32 s74, s74, s62
    s_add_u32 s74, s74, 56448
    s_xor_b32 s75, s30, 4
    v_add_u32 v5, s75, v0
    v_lshlrev_b32 v5, 24, v5
    s_add_u32 s58, s62, 43008
    s_add_u32 s57, s62, 55680
    v_and_b32 v7, 7, v0
    v_lshlrev_b32 v7, 3, v7
    s_waitcnt lgkmcnt(0)
    buffer_load_dwordx2 v[24:25], v7, s[40:43], s57 offen sc1
    buffer_load_dwordx4 v[12:15], v11, s[40:43], s58 offen offset:0 sc1
    buffer_load_dwordx4 v[16:19], v11, s[40:43], s58 offen offset:1024 sc1
    s_sleep 2
L_pr_197:
    buffer_load_dwordx2 v[24:25], v7, s[40:43], s57 offen sc1
    buffer_load_dwordx4 v[12:15], v11, s[40:43], s58 offen offset:0 sc1
    buffer_load_dwordx4 v[16:19], v11, s[40:43], s58 offen offset:1024 sc1
    s_sub_u32 s56, s56, 1
    s_cbranch_scc1 L_done
L_pw_196:
    s_waitcnt vmcnt(5)
    v_max_u32 v26, v24, v25
    v_cmp_eq_u32 vcc, -1, v26
    s_cbranch_vccnz L_pr_197
    buffer_load_dwordx4 v[12:15], v11, s[40:43], s58 offen offset:0 sc1
    buffer_load_dwordx4 v[16:19], v11, s[40:43], s58 offen offset:1024 sc1
    v_add_f32_dpp v2, v24, v24 row_ror:4 row_mask:0xf bank_mask:0xf
    v_add_f32_dpp v3, v25, v25 row_ror:4 row_mask:0xf bank_mask:0xf
    s_nop 0
L_pad12:
    s_cbranch_execz L_pad16
    v_add_f32_dpp v2, v2, v2 row_ror:2 row_mask:0xf bank_mask:0xf
    v_add_f32_dpp v3, v3, v3 row_ror:2 row_mask:0xf bank_mask:0xf
    s_nop 0
    v_add_f32_dpp v2, v2, v2 row_ror:1 row_mask:0xf bank_mask:0xf
    v_add_f32_dpp v3, v3, v3 row_ror:1 row_mask:0xf bank_mask:0xf
    v_mul_f32 v2, 0x3acccccd, v2
    v_mul_f32 v3, 0x3acccccd, v3
    v_fma_f32 v3, -v2, v2, v3
    v_max_f32 v3, 0, v3
    v_add_f32 v3, 0x3727c5ac, v3
    v_rsq_f32 v3, v3
    s_nop 0
    v_mul_f32 v2, v2, v3
    v_fma_f32 v8, -v2, v4, v8
    s_waitcnt vmcnt(5)
L_hw_198:
    v_pk_add_f32 v[20:21], v[12:13], v[14:15]
    v_pk_add_f32 v[22:23], v[16:17], v[18:19]
    v_pk_add_f32 v[20:21], v[20:21], v[22:23]
    v_add_f32 v20, v20, v21
    v_cmp_u_f32 vcc, v20, v20
    v_fma_f32 v20, v20, v3, v8
    s_cbranch_vccnz L_hr_199
L_hk_200:
    v_mul_f32 v21, v20, v20
    v_fma_f32 v21, v21, v9, v10
    v_mul_f32 v21, v21, v20
    v_exp_f32 v21, v21
    s_cmp_eq_u32 s55, 0
    v_add_f32 v21, 1.0, v21
    v_rcp_f32 v21, v21
    s_nop 0
    v_mul_f32 v20, v20, v21
    s_nop 1
    v_mov_b32_dpp v21, v20 row_shl:1 row_mask:0xf bank_mask:0xf bound_ctrl:0
    v_cvt_pk_bf16_f32 v28, v20, v21
    s_nop 1
    v_mov_b32_dpp v29, v28 row_shl:4 row_mask:0xf bank_mask:0xf bound_ctrl:0
    v_mov_b32_dpp v30, v28 row_shl:8 row_mask:0xf bank_mask:0xf bound_ctrl:0
    v_mov_b32_dpp v31, v28 row_shl:12 row_mask:0xf bank_mask:0xf bound_ctrl:0
    s_nop 1
    v_smfmac_f32_16x16x64_bf16 v[52:55], v[28:31], v[36:43], v1
    v_smfmac_f32_16x16x64_bf16 v[56:59], v[28:31], v[44:51], v1
    s_nop 6
    v_add_f32 v22, v52, v54
    v_add_f32 v23, v56, v58
    ds_write_b64 v32, v[22:23]
    s_cmp_eq_u32 s30, 4
    s_cbranch_scc0 L_skip_202
L_xw_203:
    ds_read2_b32 v[20:21], v33 offset0:0 offset1:32
    ds_read_b32 v22, v33 offset:256
    s_cmp_eq_u32 s55, 0
    s_waitcnt lgkmcnt(0)
    v_max3_u32 v23, v20, v21, v22
    v_add_f32 v20, v20, v21
    v_cmp_eq_u32 vcc, -1, v23
    v_add_f32 v20, v20, v22
    s_cbranch_vccnz L_xr_204
    v_min_u32 v20, -2, v20
    buffer_store_dword v20, v34, s[40:43], s60 offen sc1
    s_cbranch_scc1 L_gs_205
    buffer_store_dword v0, v5, s[40:43], s74 offen
L_gb_206:
L_skip_202:
L_skip_193:
    s_branch L_done
L_typeB_1:
    s_cmp_eq_u32 s53, 3
    s_cbranch_scc0 L_done
    s_cmp_eq_u32 s30, 7
    s_cbranch_scc1 L_w7_207
    s_cmp_lt_u32 s30, 6
    s_cbranch_scc0 L_skip_209
    s_lshr_b32 s57, s30, 1
    s_mul_i32 s57, s57, 128
    s_and_b32 s58, s30, 1
    s_lshl_b32 s58, s58, 6
    s_add_u32 s57, s57, s58
    v_lshrrev_b32 v18, 5, v0
    v_lshlrev_b32 v18, 13, v18
    v_bfe_u32 v60, v0, 3, 1
    v_lshl_add_u32 v18, v60, 12, v18
    v_bfe_u32 v60, v0, 4, 1
    v_lshl_add_u32 v18, v60, 11, v18
    v_bfe_u32 v60, v0, 2, 1
    v_mul_u32_u24 v60, 384, v60
    v_add_u32 v18, v60, v18
    v_and_b32 v60, 3, v0
    v_lshl_add_u32 v18, v60, 3, v18
    v_add_u32 v18, s57, v18
    v_add_u32 v18, 30720, v18
    v_bfe_u32 v19, v0, 4, 1
    v_lshlrev_b32 v19, 12, v19
    v_bfe_u32 v60, v0, 3, 1
    v_lshl_add_u32 v19, v60, 11, v19
L_pad13:
    s_cbranch_execz L_pad17
    v_bfe_u32 v60, v0, 2, 1
    v_mul_u32_u24 v60, 384, v60
    v_add_u32 v19, v60, v19
    v_and_b32 v60, 3, v0
    v_lshl_add_u32 v19, v60, 3, v19
    v_add_u32 v19, s57, v19
    v_add_u32 v19, 63488, v19
    ds_read_b64_tr_b16 v[36:37], v18 offset:0
    ds_read_b64_tr_b16 v[38:39], v18 offset:1024
    ds_read_b64_tr_b16 v[40:41], v18 offset:16384
    ds_read_b64_tr_b16 v[42:43], v18 offset:17408
    ds_read_b64_tr_b16 v[44:45], v19 offset:0
    ds_read_b64_tr_b16 v[46:47], v19 offset:1024
    ds_read_b64_tr_b16 v[48:49], v18 offset:32
    ds_read_b64_tr_b16 v[50:51], v18 offset:1056
    ds_read_b64_tr_b16 v[52:53], v18 offset:16416
    ds_read_b64_tr_b16 v[54:55], v18 offset:17440
    ds_read_b64_tr_b16 v[56:57], v19 offset:32
    ds_read_b64_tr_b16 v[58:59], v19 offset:1056
    v_lshrrev_b32 v32, 4, v0
    v_lshlrev_b32 v32, 5, v32
    v_bfe_u32 v60, v0, 1, 1
    v_lshl_add_u32 v32, v60, 4, v32
    v_and_b32 v60, 1, v0
    v_mul_u32_u24 v60, 192, v60
    v_add_u32 v32, v60, v32
    v_add_u32 v32, 160832, v32
    v_lshrrev_b32 v33, 4, v0
    v_lshlrev_b32 v33, 4, v33
    v_bfe_u32 v60, v0, 1, 1
    v_lshl_add_u32 v33, v60, 3, v33
    v_and_b32 v60, 1, v0
    v_mul_u32_u24 v60, 192, v60
    v_add_u32 v33, v60, v33
    v_add_u32 v33, 160960, v33
    v_mov_b64 v[24:25], 0
    v_mov_b64 v[26:27], 0
    v_mov_b64 v[28:29], 0
    v_mov_b64 v[30:31], 0
    s_lshr_b32 s57, s30, 1
    s_lshl_b32 s57, s57, 11
    s_and_b32 s58, s30, 1
    s_lshl_b32 s58, s58, 9
    s_add_u32 s57, s57, s58
    s_lshr_b32 s58, s54, 2
    s_lshl_b32 s58, s58, 10
    s_add_u32 s57, s57, s58
    s_and_b32 s58, s54, 3
    s_lshl_b32 s58, s58, 2
    s_add_u32 s57, s57, s58
    v_and_b32 v34, 31, v0
    v_lshlrev_b32 v34, 4, v34
    v_lshrrev_b32 v60, 5, v0
    v_lshl_add_u32 v34, v60, 30, v34
    v_add_u32 v34, s57, v34
    s_add_u32 s59, s62, 43008
    s_add_u32 s60, s62, 55680
L_skip_209:
    s_cmp_lt_u32 s30, 6
    s_barrier
    s_cbranch_scc0 L_se_208
    ds_read_b128 v[12:15], v32
    ds_read_b64 v[16:17], v33
    s_waitcnt lgkmcnt(1)
    v_smfmac_f32_16x16x64_bf16 v[24:27], v[12:15], v[36:43], v1
    v_smfmac_f32_16x16x64_bf16 v[28:31], v[12:15], v[48:55], v1
    s_waitcnt lgkmcnt(0)
    v_smfmac_f32_16x16x32_bf16 v[24:27], v[16:17], v[44:47], v1
    v_smfmac_f32_16x16x32_bf16 v[28:31], v[16:17], v[56:59], v1
    s_cmp_eq_u32 s55, 0
    s_nop 5
    v_add_f32 v12, v24, v26
    s_nop 1
    v_add_f32_dpp v12, v28, v30 quad_perm:[0,1,2,3] row_mask:0x2 bank_mask:0xf
    v_min_u32 v12, -2, v12
    s_cbranch_scc1 L_gs_210
    buffer_store_dword v12, v34, s[40:43], s59 offen
L_gb_211:
L_se_208:
    s_cmp_eq_u32 s30, 7
    s_cbranch_scc0 L_done
    s_cmp_eq_u32 s31, 0
    s_cbranch_scc0 L_done
    v_lshlrev_b32 v60, 16, v4
    v_add_f32 v2, v2, v60
    v_and_b32 v60, 0xffff0000, v4
    v_add_f32 v3, v3, v60
    v_and_b32 v60, 31, v0
    v_min_u32 v60, 19, v60
    s_mul_i32 s57, s54, 160
    v_lshrrev_b32 v7, 5, v0
    v_lshlrev_b32 v7, 2, v7
L_pad14:
    s_cbranch_execz L_pad18
    v_add_u32 v7, s57, v7
    v_lshl_add_u32 v7, v60, 3, v7
    s_add_u32 s57, s7, 393216
    s_add_u32 s58, s7, 425984
    s_add_u32 s59, s7, 458752
    s_add_u32 s60, s7, 491520
    s_add_u32 s75, s62, 56448
    v_min_u32 v9, 19, v0
    v_lshlrev_b32 v9, 2, v9
    buffer_load_dword v12, v9, s[40:43], s75 offen sc1
    s_sleep 2
L_pr_223:
    buffer_load_dword v12, v9, s[40:43], s75 offen sc1
    s_sub_u32 s56, s56, 1
    s_cbranch_scc1 L_done
L_pw_222:
    s_waitcnt vmcnt(1)
    v_cmp_eq_u32 vcc, -1, v12
    s_cbranch_vccnz L_pr_223
    buffer_load_dwordx4 v[12:15], v5, s[40:43], s57 offen sc1
    buffer_load_dwordx4 v[16:19], v5, s[40:43], s58 offen sc1
    buffer_load_dwordx4 v[20:23], v5, s[40:43], s59 offen sc1
    buffer_load_dwordx4 v[24:27], v5, s[40:43], s60 offen sc1
    s_sleep 2
L_gw_219:
    buffer_load_dwordx4 v[12:15], v5, s[40:43], s57 offen sc1
    buffer_load_dwordx4 v[16:19], v5, s[40:43], s58 offen sc1
    buffer_load_dwordx4 v[20:23], v5, s[40:43], s59 offen sc1
    buffer_load_dwordx4 v[24:27], v5, s[40:43], s60 offen sc1
    s_sub_u32 s56, s56, 1
    s_cbranch_scc1 L_done
    s_and_b32 s74, s56, 31
    s_waitcnt vmcnt(6)
    v_pk_add_f32 v[28:29], v[12:13], v[16:17]
    v_pk_add_f32 v[30:31], v[14:15], v[18:19]
    s_waitcnt vmcnt(5)
    v_pk_add_f32 v[28:29], v[28:29], v[20:21]
    v_pk_add_f32 v[30:31], v[30:31], v[22:23]
    s_waitcnt vmcnt(4)
    v_pk_add_f32 v[28:29], v[28:29], v[24:25]
    v_pk_add_f32 v[30:31], v[30:31], v[26:27]
    v_pk_add_f32 v[32:33], v[28:29], v[30:31]
    v_cmp_u_f32 vcc, v32, v33
    v_permlane32_swap_b32 v28, v30
    v_permlane32_swap_b32 v29, v31
    s_cbranch_vccnz L_gr_220
L_gk_221:
    v_pk_add_f32 v[28:29], v[28:29], v[30:31]
    v_pk_add_f32 v[28:29], v[28:29], v[2:3]
    v_cvt_pk_bf16_f32 v28, v28, v29
    global_store_dword v7, v28, s[24:25]
    s_branch L_done
L_gs_26:
    buffer_store_dword v33, v34, s[40:43], s67 offen sc1
    s_branch L_gb_27
L_gs_29:
    buffer_store_dword v12, v34, s[40:43], s59 offen sc1
    s_branch L_gb_30
L_cr_41:
    s_sub_u32 s56, s56, 1
    s_cbranch_scc1 L_done
    global_load_dword v2, v3, s[26:27] sc1
    s_waitcnt vmcnt(0)
    s_branch L_cw_40
L_far_42:
    s_lshl_b32 s57, s52, 2
    s_add_u32 s57, s57, s72
    s_mov_b64 exec, 1
    buffer_store_dword v0, v0, s[40:43], s57 offen offset:128 sc1
    s_mov_b64 exec, -1
    s_branch L_fb_43
L_cr_55:
    s_sub_u32 s56, s56, 1
    s_cbranch_scc1 L_done
    buffer_load_dword v2, v24, s[40:43], s72 offen sc1
    s_branch L_cw_54
L_gs_62:
    buffer_store_dword v33, v34, s[40:43], s67 offen sc1
    s_branch L_gb_63
L_gs_65:
    buffer_store_dword v12, v34, s[40:43], s59 offen sc1
    s_branch L_gb_66
L_gs_87:
    buffer_store_dword v22, v23, s[40:43], s57 offen sc1
    s_branch L_gb_88
L_cr_98:
    s_sub_u32 s56, s56, 1
    s_cbranch_scc1 L_done
    global_load_dword v2, v3, s[26:27] offset:4 sc1
    s_branch L_cw_97
L_gs_105:
    buffer_store_dword v56, v3, s[40:43], s57 offen sc1
    s_branch L_gb_106
L_comb_0:
    s_mov_b32 s57, 0
    s_cmp_eq_u32 s55, 0
    s_waitcnt lgkmcnt(0)
    s_barrier
    ds_read2st64_b64 v[40:43], v2 offset0:0 offset1:8
    ds_read2st64_b64 v[44:47], v2 offset0:16 offset1:24
    ds_read2st64_b64 v[48:51], v2 offset0:32 offset1:40
    ds_read2st64_b64 v[52:55], v2 offset0:48 offset1:56
L_pad15:
    s_cbranch_execz L_pad19
    s_waitcnt lgkmcnt(3)
    v_pk_mul_f32 v[56:57], v[40:41], s[64:65] op_sel:[0,0] op_sel_hi:[1,0]
    v_pk_mul_f32 v[58:59], v[42:43], s[64:65] op_sel:[0,1] op_sel_hi:[1,1]
    s_waitcnt lgkmcnt(2)
    v_pk_fma_f32 v[56:57], v[44:45], s[66:67], v[56:57] op_sel:[0,0,0] op_sel_hi:[1,0,1]
    v_pk_fma_f32 v[58:59], v[46:47], s[66:67], v[58:59] op_sel:[0,1,0] op_sel_hi:[1,1,1]
    s_waitcnt lgkmcnt(1)
    v_pk_fma_f32 v[56:57], v[48:49], s[68:69], v[56:57] op_sel:[0,0,0] op_sel_hi:[1,0,1]
    v_pk_fma_f32 v[58:59], v[50:51], s[68:69], v[58:59] op_sel:[0,1,0] op_sel_hi:[1,1,1]
    s_waitcnt lgkmcnt(0)
    v_pk_fma_f32 v[56:57], v[52:53], s[70:71], v[56:57] op_sel:[0,0,0] op_sel_hi:[1,0,1]
    v_pk_fma_f32 v[58:59], v[54:55], s[70:71], v[58:59] op_sel:[0,1,0] op_sel_hi:[1,1,1]
    v_pk_add_f32 v[56:57], v[56:57], v[58:59]
    v_cvt_pk_bf16_f32 v56, v56, v57
    v_min_u32 v56, -2, v56
    s_cbranch_scc1 L_gs_105
    buffer_store_dword v56, v3, s[40:43], s57 offen
L_gb_106:
    s_branch L_comb_0b
L_gs_114:
    buffer_store_dword v0, v34, s[40:43], s74 offen sc1
    s_branch L_gb_115
L_fin_112:
    s_cmp_eq_u32 s55, 0
    s_waitcnt lgkmcnt(0)
    s_barrier
    ds_read2st64_b32 v[12:13], v32 offset0:0 offset1:1
    ds_read2st64_b32 v[14:15], v32 offset0:2 offset1:3
    ds_read2st64_b32 v[16:17], v32 offset0:4 offset1:5
    ds_read2st64_b32 v[18:19], v32 offset0:6 offset1:7
    s_waitcnt lgkmcnt(2)
    v_pk_add_f32 v[12:13], v[12:13], v[14:15]
    s_waitcnt lgkmcnt(0)
    v_pk_add_f32 v[16:17], v[16:17], v[18:19]
    v_pk_add_f32 v[12:13], v[12:13], v[16:17]
    v_add_f32 v14, v12, v13
    v_add_f32 v15, v12, v13
    s_nop 1
    v_permlane16_swap_b32 v14, v15
    v_add_f32 v12, v14, v15
    v_min_u32 v12, -2, v12
    buffer_store_dword v12, v33, s[40:43], s58 offen sc1
    s_branch L_finb_113
L_hr_122:
    s_sub_u32 s56, s56, 1
    s_cbranch_scc1 L_done
    s_and_b32 s64, s56, 15
    s_cbranch_scc1 L_ha_124
    s_waitcnt vmcnt(0)
    v_max3_u32 v21, v12, v13, v14
    v_max3_u32 v21, v21, v15, v16
    v_max3_u32 v21, v21, v17, v18
    v_max_u32 v21, v21, v19
    v_cmp_eq_u32 vcc, -1, v21
    s_cbranch_vccnz L_ha_124
    v_pk_add_f32 v[20:21], v[12:13], v[14:15]
    v_pk_add_f32 v[22:23], v[16:17], v[18:19]
    v_pk_add_f32 v[20:21], v[20:21], v[22:23]
    v_add_f32 v20, v20, v21
    v_fma_f32 v20, v20, v3, v8
    s_branch L_hk_123
L_ha_124:
    buffer_load_dwordx4 v[12:15], v11, s[40:43], s58 offen offset:0 sc1
    buffer_load_dwordx4 v[16:19], v11, s[40:43], s58 offen offset:1024 sc1
    s_waitcnt vmcnt(2)
    s_branch L_hw_121
L_xr_127:
    s_sub_u32 s56, s56, 1
    s_cbranch_scc1 L_done
    s_branch L_xw_126
L_gs_128:
    buffer_store_dword v0, v5, s[40:43], s74 offen sc1
    s_branch L_gb_129
L_gs_133:
    buffer_store_dword v12, v34, s[40:43], s60 offen sc1
    s_branch L_gb_134
L_gs_135:
    buffer_store_dword v12, v34, s[40:43], s59 offen sc1
    s_branch L_gb_136
L_gr_138:
    s_cbranch_scc1 L_gw_137
    s_waitcnt vmcnt(0)
    v_max3_u32 v32, v12, v13, v14
    v_max3_u32 v32, v32, v15, v16
    v_max3_u32 v32, v32, v17, v18
    v_max3_u32 v32, v32, v19, v20
    v_max3_u32 v32, v32, v21, v22
    v_max3_u32 v32, v32, v23, v24
    v_max3_u32 v32, v32, v25, v26
    v_max_u32 v32, v32, v27
    v_cmp_eq_u32 vcc, -1, v32
    s_cbranch_vccnz L_gw_137
    v_pk_add_f32 v[28:29], v[12:13], v[16:17]
    v_pk_add_f32 v[30:31], v[14:15], v[18:19]
    v_pk_add_f32 v[28:29], v[28:29], v[20:21]
L_pad16:
    s_cbranch_execz L_pad20
    v_pk_add_f32 v[30:31], v[30:31], v[22:23]
    v_pk_add_f32 v[28:29], v[28:29], v[24:25]
    v_pk_add_f32 v[30:31], v[30:31], v[26:27]
    s_nop 1
    v_permlane32_swap_b32 v28, v30
    v_permlane32_swap_b32 v29, v31
    s_branch L_gk_139
L_gs_142:
    buffer_store_dword v33, v34, s[40:43], s67 offen sc1
    s_branch L_gb_143
L_w7_130:
    v_and_b32 v60, 31, v0
    v_min_u32 v60, 19, v60
    s_mul_i32 s57, s54, 320
    v_lshrrev_b32 v5, 5, v0
    v_mul_u32_u24 v5, 2560, v5
    v_add_u32 v5, s57, v5
    v_lshl_add_u32 v5, v60, 4, v5
    v_and_b32 v60, 31, v0
    v_cmp_gt_u32 s[64:65], 20, v60
    v_min_u32 v60, 19, v60
    v_lshrrev_b32 v35, 5, v0
    v_lshlrev_b32 v35, 2, v35
    v_add_u32 v35, 160832, v35
    v_lshl_add_u32 v35, v60, 3, v35
    s_add_u32 s66, s62, 36864
    s_add_u32 s67, s62, 55552
    s_lshl_b32 s57, s54, 3
    v_lshrrev_b32 v34, 5, v0
    v_lshlrev_b32 v34, 2, v34
    v_add_u32 v34, s57, v34
    v_and_b32 v60, 31, v0
    v_mov_b32 v61, 0x7f000000
    v_cmp_ne_u32 vcc, 31, v60
    s_nop 1
    v_cndmask_b32 v34, v34, v61, vcc
    v_mov_b32 v61, 0x3f803f80
    s_add_u32 s57, s7, 0
    s_add_u32 s58, s7, 32768
    s_add_u32 s59, s7, 65536
    s_add_u32 s60, s7, 98304
    s_add_u32 s75, s62, 56064
    v_min_u32 v9, 19, v0
    v_lshlrev_b32 v9, 2, v9
    buffer_load_dword v12, v9, s[40:43], s75 offen sc1
    s_sleep 2
L_pr_141:
    buffer_load_dword v12, v9, s[40:43], s75 offen sc1
    s_sub_u32 s56, s56, 1
    s_cbranch_scc1 L_done
L_pw_140:
    s_waitcnt vmcnt(1)
    v_cmp_eq_u32 vcc, -1, v12
    s_cbranch_vccnz L_pr_141
    buffer_load_dwordx4 v[12:15], v5, s[40:43], s57 offen sc1
    buffer_load_dwordx4 v[16:19], v5, s[40:43], s58 offen sc1
    buffer_load_dwordx4 v[20:23], v5, s[40:43], s59 offen sc1
    buffer_load_dwordx4 v[24:27], v5, s[40:43], s60 offen sc1
    s_sleep 2
L_gw_137:
    buffer_load_dwordx4 v[12:15], v5, s[40:43], s57 offen sc1
    buffer_load_dwordx4 v[16:19], v5, s[40:43], s58 offen sc1
    buffer_load_dwordx4 v[20:23], v5, s[40:43], s59 offen sc1
    buffer_load_dwordx4 v[24:27], v5, s[40:43], s60 offen sc1
    s_sub_u32 s56, s56, 1
    s_cbranch_scc1 L_done
    s_and_b32 s74, s56, 31
    s_waitcnt vmcnt(6)
    v_pk_add_f32 v[28:29], v[12:13], v[16:17]
    v_pk_add_f32 v[30:31], v[14:15], v[18:19]
    s_waitcnt vmcnt(5)
    v_pk_add_f32 v[28:29], v[28:29], v[20:21]
    v_pk_add_f32 v[30:31], v[30:31], v[22:23]
    s_waitcnt vmcnt(4)
    v_pk_add_f32 v[28:29], v[28:29], v[24:25]
    v_pk_add_f32 v[30:31], v[30:31], v[26:27]
    v_pk_add_f32 v[32:33], v[28:29], v[30:31]
    v_cmp_u_f32 vcc, v32, v33
    v_permlane32_swap_b32 v28, v30
    v_permlane32_swap_b32 v29, v31
    s_cbranch_vccnz L_gr_138
L_gk_139:
    v_pk_add_f32 v[28:29], v[28:29], v[30:31]
    v_pk_add_f32 v[28:29], v[28:29], v[2:3]
    v_cvt_pk_bf16_f32 v28, v28, v29
    ds_write_b32 v35, v28
    s_waitcnt lgkmcnt(0)
    s_barrier
    v_cndmask_b32 v29, 0, v28, s[64:65]
    v_dot2_f32_bf16 v33, v29, v61, 0
    v_dot2_f32_bf16 v62, v29, v29, 0
L_pad17:
    s_cbranch_execz L_pad21
    v_lshlrev_b32 v2, 16, v28
    v_and_b32 v3, 0xffff0000, v28
    s_cmp_eq_u32 s55, 0
    v_permlane32_swap_b32 v33, v62
    v_add_f32 v33, v33, v62
    s_nop 1
    v_add_f32_dpp v33, v33, v33 row_ror:8 row_mask:0xf bank_mask:0xf
    s_nop 1
    v_add_f32_dpp v33, v33, v33 row_ror:4 row_mask:0xf bank_mask:0xf
    s_nop 1
    v_add_f32_dpp v33, v33, v33 row_ror:2 row_mask:0xf bank_mask:0xf
    s_nop 1
    v_add_f32_dpp v33, v33, v33 row_ror:1 row_mask:0xf bank_mask:0xf
    s_nop 1
    v_add_f32_dpp v33, v33, v33 row_bcast:15 row_mask:0xa bank_mask:0xf
    v_min_u32 v33, -2, v33
    s_cbranch_scc1 L_gs_142
    buffer_store_dword v33, v34, s[40:43], s67 offen
L_gb_143:
    s_waitcnt vmcnt(1)
    s_branch L_se_131
L_gs_147:
    buffer_store_dword v12, v34, s[40:43], s59 offen sc1
    s_branch L_gb_148
L_gr_153:
    s_cbranch_scc1 L_gw_152
    s_waitcnt vmcnt(0)
    v_max3_u32 v32, v12, v13, v14
    v_max3_u32 v32, v32, v15, v16
    v_max3_u32 v32, v32, v17, v18
    v_max3_u32 v32, v32, v19, v20
    v_max3_u32 v32, v32, v21, v22
    v_max3_u32 v32, v32, v23, v24
    v_max3_u32 v32, v32, v25, v26
    v_max_u32 v32, v32, v27
    v_cmp_eq_u32 vcc, -1, v32
    s_cbranch_vccnz L_gw_152
    v_pk_add_f32 v[28:29], v[12:13], v[16:17]
    v_pk_add_f32 v[30:31], v[14:15], v[18:19]
    v_pk_add_f32 v[28:29], v[28:29], v[20:21]
    v_pk_add_f32 v[30:31], v[30:31], v[22:23]
    v_pk_add_f32 v[28:29], v[28:29], v[24:25]
    v_pk_add_f32 v[30:31], v[30:31], v[26:27]
    s_nop 1
    v_permlane32_swap_b32 v28, v30
    v_permlane32_swap_b32 v29, v31
    s_branch L_gk_154
L_gr_156:
    s_cbranch_scc1 L_gw_155
    s_waitcnt vmcnt(0)
    v_max3_u32 v32, v12, v13, v14
    v_max3_u32 v32, v32, v15, v16
    v_max3_u32 v32, v32, v17, v18
    v_max3_u32 v32, v32, v19, v20
    v_max3_u32 v32, v32, v21, v22
    v_max3_u32 v32, v32, v23, v24
    v_max3_u32 v32, v32, v25, v26
    v_max_u32 v32, v32, v27
    v_cmp_eq_u32 vcc, -1, v32
    s_cbranch_vccnz L_gw_155
    v_pk_add_f32 v[28:29], v[12:13], v[16:17]
    v_pk_add_f32 v[30:31], v[14:15], v[18:19]
    v_pk_add_f32 v[28:29], v[28:29], v[20:21]
    v_pk_add_f32 v[30:31], v[30:31], v[22:23]
    v_pk_add_f32 v[28:29], v[28:29], v[24:25]
    v_pk_add_f32 v[30:31], v[30:31], v[26:27]
    s_nop 1
    v_permlane32_swap_b32 v28, v30
    v_permlane32_swap_b32 v29, v31
    s_branch L_gk_157
L_gs_160:
    buffer_store_dword v33, v34, s[40:43], s67 offen sc1
    s_branch L_gb_161
L_w7_144:
    v_and_b32 v60, 31, v0
    v_min_u32 v60, 19, v60
    s_mul_i32 s57, s54, 320
    v_lshrrev_b32 v5, 5, v0
    v_mul_u32_u24 v5, 2560, v5
    v_add_u32 v5, s57, v5
    v_lshl_add_u32 v5, v60, 4, v5
    v_and_b32 v60, 31, v0
    v_cmp_gt_u32 s[64:65], 20, v60
    v_min_u32 v60, 19, v60
    v_lshrrev_b32 v35, 5, v0
    v_lshlrev_b32 v35, 2, v35
    v_add_u32 v35, 160832, v35
    v_lshl_add_u32 v35, v60, 3, v35
    s_mul_i32 s66, s53, 3072
    s_add_u32 s66, s66, s62
L_pad18:
    s_cbranch_execz L_pad22
    s_add_u32 s66, s66, 24576
    s_lshl_b32 s67, s53, 6
    s_add_u32 s67, s67, s62
    s_add_u32 s67, s67, 55296
    s_lshl_b32 s57, s54, 3
    v_lshrrev_b32 v34, 5, v0
    v_lshlrev_b32 v34, 2, v34
    v_add_u32 v34, s57, v34
    v_and_b32 v60, 31, v0
    v_mov_b32 v61, 0x7f000000
    v_cmp_ne_u32 vcc, 31, v60
    s_nop 1
    v_cndmask_b32 v34, v34, v61, vcc
    v_mov_b32 v61, 0x3f803f80
    s_cmp_lg_u32 s53, 3
    s_cbranch_scc0 L_skip_149
    s_add_u32 s57, s62, 55552
    v_mov_b32 v9, 0
L_pr_151:
    buffer_load_dword v12, v9, s[40:43], s57 offen sc1
    s_sub_u32 s56, s56, 1
    s_cbranch_scc1 L_done
L_pw_150:
    s_waitcnt vmcnt(0)
    v_cmp_eq_u32 vcc, -1, v12
    s_cbranch_vccnz L_pr_151
    s_add_u32 s57, s7, 0
    s_add_u32 s58, s7, 32768
    s_add_u32 s59, s7, 65536
    s_add_u32 s60, s7, 98304
L_gw_152:
    buffer_load_dwordx4 v[12:15], v5, s[40:43], s57 offen sc1
    buffer_load_dwordx4 v[16:19], v5, s[40:43], s58 offen sc1
    buffer_load_dwordx4 v[20:23], v5, s[40:43], s59 offen sc1
    buffer_load_dwordx4 v[24:27], v5, s[40:43], s60 offen sc1
    s_sub_u32 s56, s56, 1
    s_cbranch_scc1 L_done
    s_and_b32 s74, s56, 31
    s_waitcnt vmcnt(2)
    v_pk_add_f32 v[28:29], v[12:13], v[16:17]
    v_pk_add_f32 v[30:31], v[14:15], v[18:19]
    s_waitcnt vmcnt(1)
    v_pk_add_f32 v[28:29], v[28:29], v[20:21]
    v_pk_add_f32 v[30:31], v[30:31], v[22:23]
    s_waitcnt vmcnt(0)
    v_pk_add_f32 v[28:29], v[28:29], v[24:25]
    v_pk_add_f32 v[30:31], v[30:31], v[26:27]
    v_pk_add_f32 v[32:33], v[28:29], v[30:31]
    v_cmp_u_f32 vcc, v32, v33
    v_permlane32_swap_b32 v28, v30
    v_permlane32_swap_b32 v29, v31
    s_cbranch_vccnz L_gr_153
L_gk_154:
    v_pk_add_f32 v[28:29], v[28:29], v[30:31]
    v_pk_add_f32 v[28:29], v[28:29], v[2:3]
    v_cvt_pk_bf16_f32 v28, v28, v29
    v_lshlrev_b32 v2, 16, v28
    v_and_b32 v3, 0xffff0000, v28
L_skip_149:
    v_lshlrev_b32 v60, 16, v4
    v_add_f32 v2, v2, v60
    v_and_b32 v60, 0xffff0000, v4
    v_add_f32 v3, v3, v60
    s_add_u32 s57, s7, 131072
    s_add_u32 s58, s7, 163840
    s_add_u32 s59, s7, 196608
    s_add_u32 s60, s7, 229376
    s_add_u32 s75, s62, 56192
    v_min_u32 v9, 19, v0
    v_lshlrev_b32 v9, 2, v9
    buffer_load_dword v12, v9, s[40:43], s75 offen sc1
    s_sleep 2
L_pr_159:
    buffer_load_dword v12, v9, s[40:43], s75 offen sc1
    s_sub_u32 s56, s56, 1
    s_cbranch_scc1 L_done
L_pw_158:
    s_waitcnt vmcnt(1)
    v_cmp_eq_u32 vcc, -1, v12
    s_cbranch_vccnz L_pr_159
    buffer_load_dwordx4 v[12:15], v5, s[40:43], s57 offen sc1
    buffer_load_dwordx4 v[16:19], v5, s[40:43], s58 offen sc1
    buffer_load_dwordx4 v[20:23], v5, s[40:43], s59 offen sc1
    buffer_load_dwordx4 v[24:27], v5, s[40:43], s60 offen sc1
    s_sleep 2
L_gw_155:
    buffer_load_dwordx4 v[12:15], v5, s[40:43], s57 offen sc1
    buffer_load_dwordx4 v[16:19], v5, s[40:43], s58 offen sc1
    buffer_load_dwordx4 v[20:23], v5, s[40:43], s59 offen sc1
    buffer_load_dwordx4 v[24:27], v5, s[40:43], s60 offen sc1
    s_sub_u32 s56, s56, 1
    s_cbranch_scc1 L_done
    s_and_b32 s74, s56, 31
    s_waitcnt vmcnt(6)
    v_pk_add_f32 v[28:29], v[12:13], v[16:17]
L_pad19:
    s_cbranch_execz L_pad23
    v_pk_add_f32 v[30:31], v[14:15], v[18:19]
    s_waitcnt vmcnt(5)
    v_pk_add_f32 v[28:29], v[28:29], v[20:21]
    v_pk_add_f32 v[30:31], v[30:31], v[22:23]
    s_waitcnt vmcnt(4)
    v_pk_add_f32 v[28:29], v[28:29], v[24:25]
    v_pk_add_f32 v[30:31], v[30:31], v[26:27]
    v_pk_add_f32 v[32:33], v[28:29], v[30:31]
    v_cmp_u_f32 vcc, v32, v33
    v_permlane32_swap_b32 v28, v30
    v_permlane32_swap_b32 v29, v31
    s_cbranch_vccnz L_gr_156
L_gk_157:
    v_pk_add_f32 v[28:29], v[28:29], v[30:31]
    v_pk_add_f32 v[28:29], v[28:29], v[2:3]
    v_cvt_pk_bf16_f32 v28, v28, v29
    ds_write_b32 v35, v28
    s_waitcnt lgkmcnt(0)
    s_barrier
    v_cndmask_b32 v29, 0, v28, s[64:65]
    v_dot2_f32_bf16 v33, v29, v61, 0
    v_dot2_f32_bf16 v62, v29, v29, 0
    v_lshlrev_b32 v2, 16, v28
    v_and_b32 v3, 0xffff0000, v28
    s_cmp_eq_u32 s55, 0
    v_permlane32_swap_b32 v33, v62
    v_add_f32 v33, v33, v62
    s_nop 1
    v_add_f32_dpp v33, v33, v33 row_ror:8 row_mask:0xf bank_mask:0xf
    s_nop 1
    v_add_f32_dpp v33, v33, v33 row_ror:4 row_mask:0xf bank_mask:0xf
    s_nop 1
    v_add_f32_dpp v33, v33, v33 row_ror:2 row_mask:0xf bank_mask:0xf
    s_nop 1
    v_add_f32_dpp v33, v33, v33 row_ror:1 row_mask:0xf bank_mask:0xf
    s_nop 1
    v_add_f32_dpp v33, v33, v33 row_bcast:15 row_mask:0xa bank_mask:0xf
    v_min_u32 v33, -2, v33
    s_cbranch_scc1 L_gs_160
    buffer_store_dword v33, v34, s[40:43], s67 offen
L_gb_161:
    s_waitcnt vmcnt(1)
    s_branch L_se_145
L_q3_164:
    buffer_load_dwordx4 v[16:19], v8, s[40:43], s59 offen offset:1024 sc1
    v_mov_b64 v[24:25], 0
    v_mov_b64 v[26:27], 0
    v_mov_b64 v[28:29], 0
    v_mov_b64 v[30:31], 0
    v_mov_b64 v[32:33], 0
    v_mov_b64 v[34:35], 0
    v_mov_b64 v[36:37], 0
    v_mov_b64 v[38:39], 0
    v_mov_b64 v[40:41], 0
    v_mov_b64 v[42:43], 0
    v_mov_b64 v[44:45], 0
    v_mov_b64 v[46:47], 0
    v_mov_b64 v[48:49], 0
    v_mov_b64 v[50:51], 0
    v_mov_b64 v[52:53], 0
    v_mov_b64 v[54:55], 0
    v_mov_b64 v[56:57], 0
    v_mov_b64 v[58:59], 0
    v_mov_b64 v[60:61], 0
    v_mov_b64 v[62:63], 0
    s_lshl_b32 s58, s30, 3
    s_add_u32 s58, s58, 159808
    v_mov_b32 v11, s58
    v_lshlrev_b32 v10, 3, v0
    v_add_u32 v10, 157696, v10
    v_cmp_eq_u32 vcc, 63, v0
    s_nop 1
    v_cndmask_b32 v10, v10, v11, vcc
    s_lshl_b32 s57, s30, 12
    v_lshlrev_b32 v7, 4, v0
    v_add_u32 v7, s57, v7
    v_add_u32 v7, 92160, v7
    v_mov_b32 v11, 128000
    s_setprio 1
    s_cmp_lt_u32 s30, 4
    s_cbranch_scc0 L_skip_167
    s_setprio 2
L_skip_167:
L_pr_166:
    buffer_load_dwordx4 v[16:19], v8, s[40:43], s59 offen offset:1024 sc1
    s_sub_u32 s56, s56, 1
    s_cbranch_scc1 L_done
L_pw_165:
    s_waitcnt vmcnt(1)
    v_max3_u32 v9, v16, v17, v18
    v_max_u32 v9, v9, v19
    v_cmp_eq_u32 vcc, -1, v9
    s_cbranch_vccnz L_pr_166
    ds_write_b128 v5, v[16:19] offset:1024
    s_branch L_qb_163
L_q3_168:
    buffer_load_dwordx4 v[20:23], v8, s[40:43], s59 offen offset:2048 sc1
    v_mov_b64 v[24:25], 0
    v_mov_b64 v[26:27], 0
    v_mov_b64 v[28:29], 0
    v_mov_b64 v[30:31], 0
    v_mov_b64 v[32:33], 0
    v_mov_b64 v[34:35], 0
    v_mov_b64 v[36:37], 0
L_pad20:
    s_cbranch_execz L_pad24
    v_mov_b64 v[38:39], 0
    v_mov_b64 v[40:41], 0
    v_mov_b64 v[42:43], 0
    v_mov_b64 v[44:45], 0
    v_mov_b64 v[46:47], 0
    v_mov_b64 v[48:49], 0
    v_mov_b64 v[50:51], 0
    v_mov_b64 v[52:53], 0
    v_mov_b64 v[54:55], 0
    v_mov_b64 v[56:57], 0
    v_mov_b64 v[58:59], 0
    v_mov_b64 v[60:61], 0
    v_mov_b64 v[62:63], 0
    s_lshl_b32 s58, s30, 3
    s_add_u32 s58, s58, 159808
    v_mov_b32 v11, s58
    v_lshlrev_b32 v10, 3, v0
    v_add_u32 v10, 157696, v10
    v_cmp_eq_u32 vcc, 63, v0
    s_nop 1
    v_cndmask_b32 v10, v10, v11, vcc
    s_lshl_b32 s57, s30, 12
    v_lshlrev_b32 v7, 4, v0
    v_add_u32 v7, s57, v7
    v_add_u32 v7, 92160, v7
    v_mov_b32 v11, 128000
    s_setprio 1
    s_cmp_lt_u32 s30, 4
    s_cbranch_scc0 L_skip_171
    s_setprio 2
L_skip_171:
L_pr_170:
    buffer_load_dwordx4 v[20:23], v8, s[40:43], s59 offen offset:2048 sc1
    s_sub_u32 s56, s56, 1
    s_cbranch_scc1 L_done
L_pw_169:
    s_waitcnt vmcnt(1)
    v_max3_u32 v9, v20, v21, v22
    v_max_u32 v9, v9, v23
    v_cmp_eq_u32 vcc, -1, v9
    s_cbranch_vccnz L_pr_170
    ds_write_b128 v5, v[20:23] offset:2048
    s_branch L_qb_163
L_qo_162:
    v_mov_b64 v[24:25], 0
    v_mov_b64 v[26:27], 0
    v_mov_b64 v[28:29], 0
    v_mov_b64 v[30:31], 0
    v_mov_b64 v[32:33], 0
    v_mov_b64 v[34:35], 0
    v_mov_b64 v[36:37], 0
    v_mov_b64 v[38:39], 0
    v_mov_b64 v[40:41], 0
    v_mov_b64 v[42:43], 0
    v_mov_b64 v[44:45], 0
    v_mov_b64 v[46:47], 0
    v_mov_b64 v[48:49], 0
    v_mov_b64 v[50:51], 0
    v_mov_b64 v[52:53], 0
    v_mov_b64 v[54:55], 0
    v_mov_b64 v[56:57], 0
    v_mov_b64 v[58:59], 0
    v_mov_b64 v[60:61], 0
    v_mov_b64 v[62:63], 0
    s_lshl_b32 s58, s30, 3
    s_add_u32 s58, s58, 159808
    v_mov_b32 v11, s58
    v_lshlrev_b32 v10, 3, v0
    v_add_u32 v10, 157696, v10
    v_cmp_eq_u32 vcc, 63, v0
    s_nop 1
    v_cndmask_b32 v10, v10, v11, vcc
    s_lshl_b32 s57, s30, 12
    v_lshlrev_b32 v7, 4, v0
    v_add_u32 v7, s57, v7
    v_add_u32 v7, 92160, v7
    v_mov_b32 v11, 128000
    s_setprio 1
    s_cmp_lt_u32 s30, 4
    s_cbranch_scc0 L_skip_175
    s_setprio 2
L_skip_175:
    s_cmp_eq_u32 s30, 6
    s_cbranch_scc0 L_qb_163
    v_and_b32 v16, 7, v0
    v_lshlrev_b32 v16, 3, v16
L_pr_177:
    buffer_load_dwordx2 v[8:9], v16, s[40:43], s60 offen sc1
    s_sub_u32 s56, s56, 1
    s_cbranch_scc1 L_done
L_pw_176:
    s_waitcnt vmcnt(0)
    v_max_u32 v18, v8, v9
    v_cmp_eq_u32 vcc, -1, v18
    s_cbranch_vccnz L_pr_177
    v_add_f32_dpp v8, v8, v8 row_ror:4 row_mask:0xf bank_mask:0xf
    v_add_f32_dpp v9, v9, v9 row_ror:4 row_mask:0xf bank_mask:0xf
    s_nop 0
    v_add_f32_dpp v8, v8, v8 row_ror:2 row_mask:0xf bank_mask:0xf
    v_add_f32_dpp v9, v9, v9 row_ror:2 row_mask:0xf bank_mask:0xf
    s_nop 0
    v_add_f32_dpp v8, v8, v8 row_ror:1 row_mask:0xf bank_mask:0xf
    v_add_f32_dpp v9, v9, v9 row_ror:1 row_mask:0xf bank_mask:0xf
    v_mul_f32 v8, 0x3acccccd, v8
    v_mul_f32 v9, 0x3acccccd, v9
    v_fma_f32 v9, -v8, v8, v9
    v_max_f32 v9, 0, v9
    v_add_f32 v9, 0x3727c5ac, v9
    v_rsq_f32 v9, v9
    s_nop 0
    v_mul_f32 v9, 0x3dd53b95, v9
L_pad21:
    s_cbranch_execz L_padback
    v_mul_f32 v8, -v8, v9
    ds_write_b64 v11, v[8:9]
    s_branch L_qb_163
L_mr_180:
    s_sub_u32 s56, s56, 1
    s_cbranch_scc1 L_done
    s_branch L_mw_179
L_gs_181:
    buffer_store_dword v22, v23, s[40:43], s57 offen sc1
    s_branch L_gb_182
L_gs_183:
    buffer_store_dword v56, v3, s[40:43], s57 offen sc1
    s_branch L_gb_184
L_comb_1:
    s_lshl_b32 s57, s53, 3
    s_add_u32 s57, s57, s54
    s_lshl_b32 s57, s57, 2
    s_add_u32 s57, s57, s62
    s_add_u32 s57, s57, 55936
    v_add_u32 v23, s30, v0
    v_lshlrev_b32 v23, 24, v23
L_mw_179:
    ds_read_b64 v[38:39], v4 offset:64
    s_waitcnt lgkmcnt(0)
    v_cmp_eq_u32 vcc, -1, v39
    s_cbranch_vccnz L_mr_180
    v_max_f32_dpp v37, v38, v38 row_ror:4 row_mask:0xf bank_mask:0xf
    s_cmp_eq_u32 s55, 0
    s_nop 0
    v_max_f32_dpp v37, v37, v37 row_ror:2 row_mask:0xf bank_mask:0xf
    s_nop 1
    v_max_f32_dpp v37, v37, v37 row_ror:1 row_mask:0xf bank_mask:0xf
    v_sub_f32 v38, v38, v37
    v_exp_f32 v38, v38
    s_nop 0
    v_mul_f32 v39, v38, v39
    s_nop 1
    v_add_f32_dpp v39, v39, v39 row_ror:4 row_mask:0xf bank_mask:0xf
    s_nop 1
    v_add_f32_dpp v39, v39, v39 row_ror:2 row_mask:0xf bank_mask:0xf
    s_nop 1
    v_add_f32_dpp v39, v39, v39 row_ror:1 row_mask:0xf bank_mask:0xf
    v_rcp_f32 v21, v39
    v_log_f32 v22, v39
    v_mul_f32 v38, v38, v21
    v_add_f32 v22, v22, v37
    v_min_u32 v22, -2, v22
    s_cbranch_scc1 L_gs_181
    buffer_store_dword v22, v23, s[40:43], s57 offen
L_gb_182:
    v_readlane_b32 s64, v38, 0
    v_readlane_b32 s65, v38, 1
    v_readlane_b32 s66, v38, 2
    v_readlane_b32 s67, v38, 3
    v_readlane_b32 s68, v38, 4
    v_readlane_b32 s69, v38, 5
    v_readlane_b32 s70, v38, 6
    v_readlane_b32 s71, v38, 7
    s_mov_b32 s57, 12288
    s_cmp_eq_u32 s55, 0
    s_waitcnt lgkmcnt(0)
    s_barrier
    ds_read2st64_b64 v[40:43], v2 offset0:0 offset1:8
    ds_read2st64_b64 v[44:47], v2 offset0:16 offset1:24
    ds_read2st64_b64 v[48:51], v2 offset0:32 offset1:40
    ds_read2st64_b64 v[52:55], v2 offset0:48 offset1:56
    s_waitcnt lgkmcnt(3)
    v_pk_mul_f32 v[56:57], v[40:41], s[64:65] op_sel:[0,0] op_sel_hi:[1,0]
    v_pk_mul_f32 v[58:59], v[42:43], s[64:65] op_sel:[0,1] op_sel_hi:[1,1]
    s_waitcnt lgkmcnt(2)
    v_pk_fma_f32 v[56:57], v[44:45], s[66:67], v[56:57] op_sel:[0,0,0] op_sel_hi:[1,0,1]
    v_pk_fma_f32 v[58:59], v[46:47], s[66:67], v[58:59] op_sel:[0,1,0] op_sel_hi:[1,1,1]
    s_waitcnt lgkmcnt(1)
    v_pk_fma_f32 v[56:57], v[48:49], s[68:69], v[56:57] op_sel:[0,0,0] op_sel_hi:[1,0,1]
    v_pk_fma_f32 v[58:59], v[50:51], s[68:69], v[58:59] op_sel:[0,1,0] op_sel_hi:[1,1,1]
    s_waitcnt lgkmcnt(0)
    v_pk_fma_f32 v[56:57], v[52:53], s[70:71], v[56:57] op_sel:[0,0,0] op_sel_hi:[1,0,1]
    v_pk_fma_f32 v[58:59], v[54:55], s[70:71], v[58:59] op_sel:[0,1,0] op_sel_hi:[1,1,1]
    v_pk_add_f32 v[56:57], v[56:57], v[58:59]
    v_cvt_pk_bf16_f32 v56, v56, v57
    v_min_u32 v56, -2, v56
    s_cbranch_scc1 L_gs_183
    buffer_store_dword v56, v3, s[40:43], s57 offen
L_gb_184:
    s_branch L_comb_1b
L_gs_191:
    buffer_store_dword v0, v34, s[40:43], s74 offen sc1
    s_branch L_gb_192
L_fin_189:
    s_cmp_eq_u32 s55, 0
    s_waitcnt lgkmcnt(0)
    s_barrier
    ds_read2st64_b32 v[12:13], v32 offset0:0 offset1:1
    ds_read2st64_b32 v[14:15], v32 offset0:2 offset1:3
    ds_read2st64_b32 v[16:17], v32 offset0:4 offset1:5
L_pad22:
    s_cbranch_execz L_padback
    ds_read2st64_b32 v[18:19], v32 offset0:6 offset1:7
    s_waitcnt lgkmcnt(2)
    v_pk_add_f32 v[12:13], v[12:13], v[14:15]
    s_waitcnt lgkmcnt(0)
    v_pk_add_f32 v[16:17], v[16:17], v[18:19]
    v_pk_add_f32 v[12:13], v[12:13], v[16:17]
    v_add_f32 v14, v12, v13
    v_add_f32 v15, v12, v13
    s_nop 1
    v_permlane16_swap_b32 v14, v15
    v_add_f32 v12, v14, v15
    v_min_u32 v12, -2, v12
    buffer_store_dword v12, v33, s[40:43], s58 offen sc1
    s_branch L_finb_190
L_hr_199:
    s_sub_u32 s56, s56, 1
    s_cbranch_scc1 L_done
    s_and_b32 s64, s56, 15
    s_cbranch_scc1 L_ha_201
    s_waitcnt vmcnt(0)
    v_max3_u32 v21, v12, v13, v14
    v_max3_u32 v21, v21, v15, v16
    v_max3_u32 v21, v21, v17, v18
    v_max_u32 v21, v21, v19
    v_cmp_eq_u32 vcc, -1, v21
    s_cbranch_vccnz L_ha_201
    v_pk_add_f32 v[20:21], v[12:13], v[14:15]
    v_pk_add_f32 v[22:23], v[16:17], v[18:19]
    v_pk_add_f32 v[20:21], v[20:21], v[22:23]
    v_add_f32 v20, v20, v21
    v_fma_f32 v20, v20, v3, v8
    s_branch L_hk_200
L_ha_201:
    buffer_load_dwordx4 v[12:15], v11, s[40:43], s58 offen offset:0 sc1
    buffer_load_dwordx4 v[16:19], v11, s[40:43], s58 offen offset:1024 sc1
    s_waitcnt vmcnt(2)
    s_branch L_hw_198
L_xr_204:
    s_sub_u32 s56, s56, 1
    s_cbranch_scc1 L_done
    s_branch L_xw_203
L_gs_205:
    buffer_store_dword v0, v5, s[40:43], s74 offen sc1
    s_branch L_gb_206
L_gs_210:
    buffer_store_dword v12, v34, s[40:43], s59 offen sc1
    s_branch L_gb_211
L_gr_213:
    s_cbranch_scc1 L_gw_212
    s_waitcnt vmcnt(0)
    v_max3_u32 v32, v12, v13, v14
    v_max3_u32 v32, v32, v15, v16
    v_max3_u32 v32, v32, v17, v18
    v_max3_u32 v32, v32, v19, v20
    v_max3_u32 v32, v32, v21, v22
    v_max3_u32 v32, v32, v23, v24
    v_max3_u32 v32, v32, v25, v26
    v_max_u32 v32, v32, v27
    v_cmp_eq_u32 vcc, -1, v32
    s_cbranch_vccnz L_gw_212
    v_pk_add_f32 v[28:29], v[12:13], v[16:17]
    v_pk_add_f32 v[30:31], v[14:15], v[18:19]
    v_pk_add_f32 v[28:29], v[28:29], v[20:21]
    v_pk_add_f32 v[30:31], v[30:31], v[22:23]
    v_pk_add_f32 v[28:29], v[28:29], v[24:25]
    v_pk_add_f32 v[30:31], v[30:31], v[26:27]
    s_nop 1
    v_permlane32_swap_b32 v28, v30
    v_permlane32_swap_b32 v29, v31
    s_branch L_gk_214
L_gs_217:
    buffer_store_dword v33, v34, s[40:43], s67 offen sc1
    s_branch L_gb_218
L_w7_207:
    v_and_b32 v60, 31, v0
    v_min_u32 v60, 19, v60
    s_mul_i32 s57, s54, 320
    v_lshrrev_b32 v5, 5, v0
    v_mul_u32_u24 v5, 2560, v5
    v_add_u32 v5, s57, v5
    v_lshl_add_u32 v5, v60, 4, v5
    v_and_b32 v60, 31, v0
    v_cmp_gt_u32 s[64:65], 20, v60
    v_min_u32 v60, 19, v60
    v_lshrrev_b32 v35, 5, v0
    v_lshlrev_b32 v35, 2, v35
    v_add_u32 v35, 160832, v35
    v_lshl_add_u32 v35, v60, 3, v35
    s_add_u32 s66, s62, 43008
    s_add_u32 s67, s62, 55680
    s_lshl_b32 s57, s54, 3
    v_lshrrev_b32 v34, 5, v0
    v_lshlrev_b32 v34, 2, v34
    v_add_u32 v34, s57, v34
    v_and_b32 v60, 31, v0
    v_mov_b32 v61, 0x7f000000
L_pad23:
    s_cbranch_execz L_padback
    v_cmp_ne_u32 vcc, 31, v60
    s_nop 1
    v_cndmask_b32 v34, v34, v61, vcc
    v_mov_b32 v61, 0x3f803f80
    s_add_u32 s57, s7, 262144
    s_add_u32 s58, s7, 294912
    s_add_u32 s59, s7, 327680
    s_add_u32 s60, s7, 360448
    s_add_u32 s75, s62, 56320
    v_min_u32 v9, 19, v0
    v_lshlrev_b32 v9, 2, v9
    buffer_load_dword v12, v9, s[40:43], s75 offen sc1
    s_sleep 2
L_pr_216:
    buffer_load_dword v12, v9, s[40:43], s75 offen sc1
    s_sub_u32 s56, s56, 1
    s_cbranch_scc1 L_done
L_pw_215:
    s_waitcnt vmcnt(1)
    v_cmp_eq_u32 vcc, -1, v12
    s_cbranch_vccnz L_pr_216
    buffer_load_dwordx4 v[12:15], v5, s[40:43], s57 offen sc1
    buffer_load_dwordx4 v[16:19], v5, s[40:43], s58 offen sc1
    buffer_load_dwordx4 v[20:23], v5, s[40:43], s59 offen sc1
    buffer_load_dwordx4 v[24:27], v5, s[40:43], s60 offen sc1
    s_sleep 2
L_gw_212:
    buffer_load_dwordx4 v[12:15], v5, s[40:43], s57 offen sc1
    buffer_load_dwordx4 v[16:19], v5, s[40:43], s58 offen sc1
    buffer_load_dwordx4 v[20:23], v5, s[40:43], s59 offen sc1
    buffer_load_dwordx4 v[24:27], v5, s[40:43], s60 offen sc1
    s_sub_u32 s56, s56, 1
    s_cbranch_scc1 L_done
    s_and_b32 s74, s56, 31
    s_waitcnt vmcnt(6)
    v_pk_add_f32 v[28:29], v[12:13], v[16:17]
    v_pk_add_f32 v[30:31], v[14:15], v[18:19]
    s_waitcnt vmcnt(5)
    v_pk_add_f32 v[28:29], v[28:29], v[20:21]
    v_pk_add_f32 v[30:31], v[30:31], v[22:23]
    s_waitcnt vmcnt(4)
    v_pk_add_f32 v[28:29], v[28:29], v[24:25]
    v_pk_add_f32 v[30:31], v[30:31], v[26:27]
    v_pk_add_f32 v[32:33], v[28:29], v[30:31]
    v_cmp_u_f32 vcc, v32, v33
    v_permlane32_swap_b32 v28, v30
    v_permlane32_swap_b32 v29, v31
    s_cbranch_vccnz L_gr_213
L_gk_214:
    v_pk_add_f32 v[28:29], v[28:29], v[30:31]
    v_pk_add_f32 v[28:29], v[28:29], v[2:3]
    v_cvt_pk_bf16_f32 v28, v28, v29
    ds_write_b32 v35, v28
    s_waitcnt lgkmcnt(0)
    s_barrier
    v_cndmask_b32 v29, 0, v28, s[64:65]
    v_dot2_f32_bf16 v33, v29, v61, 0
    v_dot2_f32_bf16 v62, v29, v29, 0
    v_lshlrev_b32 v2, 16, v28
    v_and_b32 v3, 0xffff0000, v28
    s_cmp_eq_u32 s55, 0
    v_permlane32_swap_b32 v33, v62
    v_add_f32 v33, v33, v62
    s_nop 1
    v_add_f32_dpp v33, v33, v33 row_ror:8 row_mask:0xf bank_mask:0xf
    s_nop 1
    v_add_f32_dpp v33, v33, v33 row_ror:4 row_mask:0xf bank_mask:0xf
    s_nop 1
    v_add_f32_dpp v33, v33, v33 row_ror:2 row_mask:0xf bank_mask:0xf
    s_nop 1
    v_add_f32_dpp v33, v33, v33 row_ror:1 row_mask:0xf bank_mask:0xf
    s_nop 1
    v_add_f32_dpp v33, v33, v33 row_bcast:15 row_mask:0xa bank_mask:0xf
    v_min_u32 v33, -2, v33
    s_cbranch_scc1 L_gs_217
    buffer_store_dword v33, v34, s[40:43], s67 offen
L_gb_218:
    s_waitcnt vmcnt(1)
    s_branch L_se_208
L_gr_220:
    s_cbranch_scc1 L_gw_219
    s_waitcnt vmcnt(0)
    v_max3_u32 v32, v12, v13, v14
    v_max3_u32 v32, v32, v15, v16
    v_max3_u32 v32, v32, v17, v18
    v_max3_u32 v32, v32, v19, v20
    v_max3_u32 v32, v32, v21, v22
    v_max3_u32 v32, v32, v23, v24
    v_max3_u32 v32, v32, v25, v26
L_pad24:
    s_cbranch_execz L_padback
    v_max_u32 v32, v32, v27
    v_cmp_eq_u32 vcc, -1, v32
    s_cbranch_vccnz L_gw_219
    v_pk_add_f32 v[28:29], v[12:13], v[16:17]
    v_pk_add_f32 v[30:31], v[14:15], v[18:19]
    v_pk_add_f32 v[28:29], v[28:29], v[20:21]
    v_pk_add_f32 v[30:31], v[30:31], v[22:23]
    v_pk_add_f32 v[28:29], v[28:29], v[24:25]
    v_pk_add_f32 v[30:31], v[30:31], v[26:27]
    s_nop 1
    v_permlane32_swap_b32 v28, v30
    v_permlane32_swap_b32 v29, v31
    s_branch L_gk_221
L_tail_end:
L_spread:
    s_add_u32 s62, s62, 671744
    s_cmp_eq_u32 s30, 5
    s_cbranch_scc0 L_skip_59
    v_mov_b64 v[12:13], -1
    v_mov_b64 v[14:15], -1
    v_lshlrev_b32 v16, 4, v0
    s_mul_i32 s57, s52, 1792
    s_add_u32 s57, s57, s62
    s_mov_b32 exec_lo, 0xffffffff
    s_mov_b32 exec_hi, 0xffff
    buffer_store_dwordx4 v[12:15], v16, s[40:43], s57 offen offset:1024 sc1
    s_mov_b64 exec, -1
    buffer_store_dwordx4 v[12:15], v16, s[40:43], s57 offen sc1
L_skip_59:
    s_cmp_eq_u32 s30, 7
    s_cbranch_scc0 L_skip_60
    v_and_b32 v60, 31, v0
    v_cmp_gt_u32 s[64:65], 20, v60
    v_min_u32 v60, 19, v60
    v_lshrrev_b32 v35, 5, v0
    v_lshlrev_b32 v35, 2, v35
    v_add_u32 v35, 160832, v35
    v_lshl_add_u32 v35, v60, 3, v35
    s_mul_i32 s66, s53, 6400
    s_add_u32 s66, s66, s62
    s_add_u32 s66, s66, 57344
    s_add_u32 s67, s66, 6144
    s_lshl_b32 s57, s54, 3
    v_lshrrev_b32 v34, 5, v0
    v_lshlrev_b32 v34, 2, v34
    v_add_u32 v34, s57, v34
    v_and_b32 v60, 31, v0
    v_mov_b32 v61, 0x7f000000
    v_cmp_ne_u32 vcc, 31, v60
    s_nop 1
    v_cndmask_b32 v34, v34, v61, vcc
    v_mov_b32 v61, 0x3f803f80
    v_cvt_pk_bf16_f32 v28, v2, v3
L_skip_60:
    s_cmp_eq_u32 s30, 7
    s_cbranch_scc0 L_skip_61
    v_cndmask_b32 v29, 0, v28, s[64:65]
    v_dot2_f32_bf16 v33, v29, v61, 0
    v_dot2_f32_bf16 v62, v29, v29, 0
    v_lshlrev_b32 v2, 16, v28
    v_and_b32 v3, 0xffff0000, v28
    s_cmp_eq_u32 s55, 0
    v_permlane32_swap_b32 v33, v62
    v_add_f32 v33, v33, v62
    s_nop 1
    v_add_f32_dpp v33, v33, v33 row_ror:8 row_mask:0xf bank_mask:0xf
    s_nop 1
    v_add_f32_dpp v33, v33, v33 row_ror:4 row_mask:0xf bank_mask:0xf
    s_nop 1
    v_add_f32_dpp v33, v33, v33 row_ror:2 row_mask:0xf bank_mask:0xf
    s_nop 1
    v_add_f32_dpp v33, v33, v33 row_ror:1 row_mask:0xf bank_mask:0xf
    s_nop 1
    v_add_f32_dpp v33, v33, v33 row_bcast:15 row_mask:0xa bank_mask:0xf
    v_min_u32 v33, -2, v33
    s_cbranch_scc1 L_gs_62
    buffer_store_dword v33, v34, s[40:43], s67 offen
L_gb_63:
    s_waitcnt vmcnt(1)
L_skip_61:
    s_cmp_lt_u32 s30, 6
    s_cbranch_scc0 L_skip_64
    s_lshr_b32 s57, s30, 1
    s_mul_i32 s57, s57, 1024
    s_and_b32 s58, s30, 1
    s_lshl_b32 s58, s58, 6
    s_add_u32 s57, s57, s58
    v_lshrrev_b32 v18, 5, v0
    v_mul_u32_u24 v18, 6144, v18
    v_bfe_u32 v60, v0, 3, 1
    v_mul_u32_u24 v60, 3072, v60
    v_add_u32 v18, v60, v18
    v_bfe_u32 v60, v0, 4, 1
    v_lshl_add_u32 v18, v60, 9, v18
    v_bfe_u32 v60, v0, 2, 1
    v_lshl_add_u32 v18, v60, 7, v18
    v_and_b32 v60, 3, v0
    v_lshl_add_u32 v18, v60, 3, v18
    v_add_u32 v18, s57, v18
    v_bfe_u32 v19, v0, 4, 1
    v_mul_u32_u24 v19, 3072, v19
    v_bfe_u32 v60, v0, 3, 1
    v_lshl_add_u32 v19, v60, 9, v19
    v_bfe_u32 v60, v0, 2, 1
    v_lshl_add_u32 v19, v60, 7, v19
    v_and_b32 v60, 3, v0
    v_lshl_add_u32 v19, v60, 3, v19
    v_add_u32 v19, s57, v19
    v_add_u32 v19, 24576, v19
    ds_read_b64_tr_b16 v[36:37], v18 offset:0
    ds_read_b64_tr_b16 v[38:39], v18 offset:256
    ds_read_b64_tr_b16 v[40:41], v18 offset:12288
    ds_read_b64_tr_b16 v[42:43], v18 offset:12544
    ds_read_b64_tr_b16 v[44:45], v19 offset:0
    ds_read_b64_tr_b16 v[46:47], v19 offset:256
    ds_read_b64_tr_b16 v[48:49], v18 offset:32
    ds_read_b64_tr_b16 v[50:51], v18 offset:288
    ds_read_b64_tr_b16 v[52:53], v18 offset:12320
    ds_read_b64_tr_b16 v[54:55], v18 offset:12576
    ds_read_b64_tr_b16 v[56:57], v19 offset:32
    ds_read_b64_tr_b16 v[58:59], v19 offset:288
    v_lshrrev_b32 v32, 4, v0
    v_lshlrev_b32 v32, 5, v32
    v_bfe_u32 v60, v0, 1, 1
    v_lshl_add_u32 v32, v60, 4, v32
    v_and_b32 v60, 1, v0
    v_mul_u32_u24 v60, 192, v60
    v_add_u32 v32, v60, v32
    v_add_u32 v32, 160832, v32
    v_lshrrev_b32 v33, 4, v0
    v_lshlrev_b32 v33, 4, v33
    v_bfe_u32 v60, v0, 1, 1
    v_lshl_add_u32 v33, v60, 3, v33
    v_and_b32 v60, 1, v0
    v_mul_u32_u24 v60, 192, v60
    v_add_u32 v33, v60, v33
    v_add_u32 v33, 160960, v33
    v_mov_b64 v[24:25], 0
    v_mov_b64 v[26:27], 0
    v_mov_b64 v[28:29], 0
    v_mov_b64 v[30:31], 0
    s_lshr_b32 s57, s54, 1
    s_lshl_b32 s57, s57, 2
    s_and_b32 s58, s54, 1
    s_add_u32 s57, s57, s58
    s_lshl_b32 s57, s57, 4
    s_lshl_b32 s58, s30, 9
    s_add_u32 s57, s57, s58
    v_bfe_u32 v34, v0, 4, 1
    v_lshlrev_b32 v34, 8, v34
    v_bfe_u32 v60, v0, 1, 1
    v_lshl_add_u32 v34, v60, 5, v34
    v_bfe_u32 v60, v0, 2, 2
    v_lshl_add_u32 v34, v60, 2, v34
    v_lshrrev_b32 v60, 5, v0
    v_mul_u32_u24 v60, 3072, v60
    v_add_u32 v34, v60, v34
    v_and_b32 v60, 1, v0
    v_lshl_add_u32 v34, v60, 30, v34
    v_add_u32 v34, s57, v34
    s_mul_i32 s59, s53, 6400
    s_add_u32 s59, s59, s62
    s_add_u32 s59, s59, 57344
    s_add_u32 s60, s59, 6144
    ds_read_b128 v[12:15], v32
    ds_read_b64 v[16:17], v33
    s_waitcnt lgkmcnt(1)
    v_smfmac_f32_16x16x64_bf16 v[24:27], v[12:15], v[36:43], v1
    v_smfmac_f32_16x16x64_bf16 v[28:31], v[12:15], v[48:55], v1
    s_waitcnt lgkmcnt(0)
    v_smfmac_f32_16x16x32_bf16 v[24:27], v[16:17], v[44:47], v1
    v_smfmac_f32_16x16x32_bf16 v[28:31], v[16:17], v[56:59], v1
    s_cmp_eq_u32 s55, 0
    s_nop 5
    v_add_f32 v12, v24, v26
    s_nop 1
    v_add_f32_dpp v12, v28, v30 quad_perm:[0,1,2,3] row_mask:0x2 bank_mask:0xf
    s_nop 1
    v_add_f32_dpp v12, v25, v27 quad_perm:[0,1,2,3] row_mask:0x4 bank_mask:0xf
    s_nop 1
    v_add_f32_dpp v12, v29, v31 quad_perm:[0,1,2,3] row_mask:0x8 bank_mask:0xf
    s_nop 1
    v_mov_b32_dpp v13, v12 row_shl:1 row_mask:0xf bank_mask:0xf bound_ctrl:0
    v_cvt_pk_bf16_f32 v12, v12, v13
    v_min_u32 v12, -2, v12
    s_cbranch_scc1 L_gs_65
    buffer_store_dword v12, v34, s[40:43], s59 offen
L_gb_66:
L_skip_64:
    s_waitcnt vmcnt(0)
    s_barrier
    s_cmp_eq_u32 s30, 5
    s_cbranch_scc0 L_skip_67
    s_lshl_b32 s57, s52, 2
    s_add_u32 s57, s57, s72
    s_mov_b64 exec, 1
    buffer_store_dword v0, v0, s[40:43], s57 offen offset:256 sc1
    s_mov_b64 exec, -1
    v_and_b32 v16, 31, v0
    v_lshlrev_b32 v16, 2, v16
L_pr_69:
    buffer_load_dword v17, v16, s[40:43], s72 offen offset:256 sc1
    s_sub_u32 s56, s56, 1
    s_cbranch_scc1 L_done
L_pw_68:
    s_waitcnt vmcnt(0)
    v_cmp_eq_u32 vcc, -1, v17
    s_cbranch_vccnz L_pr_69
L_skip_67:
    s_barrier
    s_branch L_spread_back
L_done:
L_exit:
    s_endpgm
.section .rodata,"a"
.p2align 6
.amdhsa_kernel interleave_layers__sliding_block_cached__dense_activation_gelu__decode_kernel
  .amdhsa_next_free_vgpr 256
  .amdhsa_next_free_sgpr 102
  .amdhsa_accum_offset 256
  .amdhsa_group_segment_fixed_size 0
  .amdhsa_kernarg_size 104
  .amdhsa_user_sgpr_count 2
  .amdhsa_user_sgpr_kernarg_segment_ptr 1
  .amdhsa_system_sgpr_workgroup_id_x 1
  .amdhsa_float_denorm_mode_32 3
.end_amdhsa_kernel
```

```asm
; @launch grid=(256,1,1) block=(512,1,1) lds=161216
.amdgcn_target "amdgcn-amd-amdhsa--gfx950"
.text
.fill 64, 4, 0xbf800000
.globl interleave_layers__sliding_block_cached__dense_activation_gelu__decode_kernel
.p2align 8
.type interleave_layers__sliding_block_cached__dense_activation_gelu__decode_kernel,@function
interleave_layers__sliding_block_cached__dense_activation_gelu__decode_kernel:
    s_load_dwordx16 s[4:19], s[0:1], 0
    s_load_dwordx8 s[20:27], s[0:1], 64
    s_load_dwordx2 s[28:29], s[0:1], 96
    s_cmp_ge_u32 s2, 256
    s_cbranch_scc1 L_exit
    s_getpc_b64 s[74:75]
L_pc:
    v_lshlrev_b32 v5, 6, v0
    v_min_u32 v5, L_exit-L_pc, v5
    global_load_dword v59, v5, s[74:75]
    v_lshrrev_b32 v5, 6, v0
    v_and_b32 v0, 63, v0
    v_readfirstlane_b32 s30, v5
    s_and_b32 s31, s2, 7
    s_lshr_b32 s52, s2, 3
    s_and_b32 s53, s52, 3
    s_lshr_b32 s54, s52, 2
    s_lshl_b32 s73, s31, 2
    s_add_u32 s73, s73, s53
    s_mul_i32 s3, s54, 3
    s_add_u32 s3, s3, s53
    s_cmp_eq_u32 s53, 3
    s_cselect_b32 s3, 31, s3
    v_lshrrev_b32 v8, 5, v0
    v_lshlrev_b32 v8, 2, v8
    v_bfe_u32 v60, v0, 4, 1
    v_lshl_add_u32 v8, v60, 0, v8
    v_and_b32 v9, 7, v0
    v_xor_b32 v8, v8, v9
    v_lshrrev_b32 v10, 3, v0
    v_mul_u32_u24 v10, 384, v10
    v_lshl_add_u32 v5, v8, 4, v10
    v_xor_b32 v6, 32, v5
    v_lshrrev_b32 v8, 4, v0
    v_lshlrev_b32 v8, 1, v8
    v_xor_b32 v8, v8, v9
    v_lshl_add_u32 v7, v8, 4, v10
    v_lshrrev_b32 v2, 3, v0
    v_mul_u32_u24 v2, 12288, v2
    v_and_b32 v60, 7, v0
    v_lshl_add_u32 v2, v60, 4, v2
    s_mul_i32 s57, s73, 12582912
    s_mul_i32 s58, s54, 3072
    s_add_u32 s57, s57, s58
    s_add_u32 s57, s57, 11010048
    s_sub_u32 s58, 1572864, s58
    s_mul_i32 s59, s73, 384
    s_mul_i32 s60, s54, 983040
    s_add_u32 s59, s59, s60
    s_sub_u32 s60, 7866368, s59
    s_lshl_b32 s61, s30, 11
    s_add_u32 s61, s61, 92160
    s_mul_i32 s62, s31, 83968
    s_lshl_b32 s72, s31, 9
    s_add_u32 s72, s72, 1900544
    s_mov_b32 s56, 65536
    s_mov_b32 s55, 1
    s_getreg_b32 s63, hwreg(20, 0, 3)
    v_mov_b32 v3, 0
    v_mov_b32 v24, 0
    v_mov_b32 v34, 0
    v_mov_b64 v[12:13], -1
    v_mov_b64 v[14:15], -1
    v_lshlrev_b32 v10, 4, v0
    s_waitcnt lgkmcnt(0)
    s_add_u32 s32, s6, s57
    s_addc_u32 s33, s7, 0
    s_mov_b32 s34, s58
    s_mov_b32 s35, 0x20000
    s_add_u32 s36, s8, s57
    s_addc_u32 s37, s9, 0
    s_mov_b32 s38, s58
    s_mov_b32 s39, 0x20000
    s_mov_b32 s40, s28
    s_mov_b32 s41, s29
    s_mov_b32 s42, 1904640
    s_mov_b32 s43, 0x20000
    s_add_u32 s44, s10, s59
    s_addc_u32 s45, s11, 0
    s_mov_b32 s46, s60
    s_mov_b32 s47, 0x20000
    s_sub_u32 s44, s44, 2048
    s_subb_u32 s45, s45, 0
    s_cmp_eq_u32 s30, 6
    s_cbranch_scc0 L_skip_1
    s_setprio 3
    s_mov_b32 s57, 0
    s_mov_b32 s58, 195584
    s_mov_b32 m0, 92160
L_dma_2:
    s_waitcnt vmcnt(25)
    buffer_load_dwordx4 v5, s[32:35], s57 offen offset:0 nt lds
    s_waitcnt vmcnt(25)
    buffer_load_dwordx4 v6, s[32:35], s58 offen offset:1024 nt lds
    s_add_u32 s57, s57, 24576
    s_add_u32 s58, s58, 24576
    s_add_u32 m0, m0, 2048
    s_cmp_lg_u32 m0, 108544
    s_cbranch_scc1 L_dma_2
    s_mov_b32 s57, 128
    s_mov_b32 s58, 195712
    s_mov_b32 m0, 108544
L_dma_3:
    s_waitcnt vmcnt(25)
    buffer_load_dwordx4 v5, s[32:35], s57 offen offset:0 nt lds
    s_waitcnt vmcnt(25)
    buffer_load_dwordx4 v6, s[32:35], s58 offen offset:1024 nt lds
    s_add_u32 s57, s57, 24576
    s_add_u32 s58, s58, 24576
    s_add_u32 m0, m0, 2048
    s_cmp_lg_u32 m0, 124928
    s_cbranch_scc1 L_dma_3
    s_mov_b32 s57, 2048
    s_mov_b32 s58, 1152
    s_mov_b32 s59, 256
    s_mov_b32 m0, 0
L_dma_4:
    s_waitcnt vmcnt(25)
    buffer_load_dwordx4 v2, s[44:47], s57 offen offset:0 nt lds
    s_waitcnt vmcnt(25)
    buffer_load_dwordx4 v2, s[44:47], s58 offen offset:1024 nt lds
    s_waitcnt vmcnt(25)
    buffer_load_dwordx4 v2, s[44:47], s59 offen offset:2048 nt lds
    s_add_u32 s57, s57, 98304
    s_add_u32 s58, s58, 98304
    s_add_u32 s59, s59, 98304
    s_add_u32 m0, m0, 3072
    s_cmp_lg_u32 m0, 15360
    s_cbranch_scc1 L_dma_4
L_skip_1:
    s_cmp_lt_u32 s3, 20
    s_cselect_b32 s57, 7864320, 0
    s_add_u32 s58, s54, 1
    s_mul_i32 s58, s58, 245760
    s_cmp_lg_u32 s53, 3
    s_cselect_b64 s[48:49], s[12:13], s[16:17]
    s_cselect_b32 s50, s57, s58
    s_mov_b32 s51, 0x20000
    s_add_u32 s57, s28, 1343488
    s_sub_u32 s57, 0, s57
    s_and_b32 s57, s57, 0x7fff
    s_add_u32 s57, s57, 1343488
    s_lshr_b32 s58, s31, 1
    s_lshl_b32 s58, s58, 15
    s_add_u32 s6, s57, s58
    s_and_b32 s58, s31, 1
    s_mul_i32 s58, s58, 2560
    s_add_u32 s6, s6, s58
    s_lshl_b32 s58, s3, 7
    s_add_u32 s6, s6, s58
    s_mov_b32 s8, s57
    s_lshr_b32 s58, s52, 4
    s_lshl_b32 s58, s58, 15
    s_and_b32 s59, s52, 15
    s_lshl_b32 s59, s59, 7
    s_add_u32 s59, s59, s58
    s_add_u32 s59, s59, s57
    s_add_u32 s59, s59, 5120
    s_lshl_b32 s58, s31, 16
    s_add_u32 s59, s59, s58
    s_add_u32 s10, s28, s59
    s_addc_u32 s11, s29, 0
    s_lshr_b32 s58, s63, 2
    s_xor_b32 s58, s58, 0
    s_mul_i32 s58, s58, 8192
    s_add_u32 s7, s57, s58
    s_cmp_eq_u32 s30, 5
    s_cbranch_scc0 L_skip_5
    s_cmp_eq_u32 s52, 31
    s_cbranch_scc0 L_skip_6
    s_mov_b64 exec, 0xffffff
    buffer_store_dwordx4 v[12:15], v10, s[40:43], s72 offen sc1
    s_mov_b64 exec, -1
L_skip_6:
    s_cmp_lt_u32 s3, 20
    s_cbranch_scc0 L_skip_7
    v_bfe_u32 v16, v0, 3, 2
    v_lshlrev_b32 v16, 17, v16
    v_and_b32 v60, 7, v0
    v_lshl_add_u32 v16, v60, 4, v16
    v_lshrrev_b32 v60, 5, v0
    v_lshl_add_u32 v16, v60, 13, v16
    buffer_store_dwordx4 v[12:15], v16, s[40:43], s6 offen sc1
L_skip_7:
    v_and_b32 v16, 7, v0
    v_lshlrev_b32 v16, 4, v16
    v_bfe_u32 v60, v0, 3, 1
    v_lshl_add_u32 v16, v60, 13, v16
    v_lshrrev_b32 v60, 4, v0
    v_lshl_add_u32 v16, v60, 28, v16
    buffer_store_dwordx4 v[12:15], v16, s[40:43], s59 offen sc1
    s_mul_i32 s57, s52, 1792
    s_add_u32 s57, s57, s62
    s_mov_b32 exec_lo, 0xffffffff
    s_mov_b32 exec_hi, 0xffff
    buffer_store_dwordx4 v[12:15], v10, s[40:43], s57 offen offset:1024
    s_mov_b64 exec, -1
    buffer_store_dwordx4 v[12:15], v10, s[40:43], s57 offen
    s_mov_b64 exec, -1
    v_lshlrev_b32 v16, 4, v0
    v_add_u32 v16, 159744, v16
    ds_write_b128 v16, v[12:15]
    v_subrev_u32 v16, 8, v0
    v_cmp_gt_u32 vcc, 40, v16
    v_mov_b32 v16, 0x3f803f80
    s_nop 0
    v_cndmask_b32 v18, 0, v16, vcc
    v_min_u32 v16, 55, v0
    v_lshlrev_b32 v16, 2, v16
    v_add_u32 v16, 160992, v16
    ds_write_b32 v16, v18
    v_and_b32 v3, 7, v0
    v_lshlrev_b32 v3, 5, v3
L_skip_5:
    s_cmp_eq_u32 s30, 7
    s_cbranch_scc0 L_skip_8
    v_and_b32 v60, 31, v0
    v_min_u32 v60, 19, v60
    s_mul_i32 s57, s54, 160
    v_lshrrev_b32 v16, 5, v0
    v_lshlrev_b32 v16, 2, v16
    v_add_u32 v16, s57, v16
    v_lshl_add_u32 v16, v60, 3, v16
    global_load_dword v28, v16, s[4:5]
    global_load_dword v4, v16, s[22:23]
L_skip_8:
    v_bfe_u32 v8, v0, 1, 3
    v_lshrrev_b32 v9, 4, v0
    v_xor_b32 v9, v8, v9
    v_bfe_u32 v8, v0, 2, 1
    v_lshlrev_b32 v8, 10, v8
    v_bfe_u32 v60, v0, 3, 1
    v_lshl_add_u32 v8, v60, 9, v8
    v_and_b32 v60, 3, v0
    v_lshl_add_u32 v8, v60, 7, v8
    v_add_u32 v8, s61, v8
    v_lshl_add_u32 v8, v9, 4, v8
    v_xor_b32 v9, 64, v8
    v_bfe_u32 v1, v0, 1, 1
    v_mul_u32_u24 v1, 43690, v1
    v_add_u32 v1, 17476, v1
    s_waitcnt vmcnt(31)
    s_barrier
    ds_read_b128 v[64:67], v8 offset:0
    ds_read_b128 v[68:71], v9 offset:0
    s_cmp_eq_u32 s30, 6
    s_cbranch_scc0 L_skip_9
    s_mov_b32 s57, 256
    s_mov_b32 s58, 195840
    s_mov_b32 m0, 124928
L_dma_10:
    s_waitcnt vmcnt(25)
    buffer_load_dwordx4 v5, s[32:35], s57 offen offset:0 nt lds
    s_waitcnt vmcnt(25)
    buffer_load_dwordx4 v6, s[32:35], s58 offen offset:1024 nt lds
    s_add_u32 s57, s57, 24576
    s_add_u32 s58, s58, 24576
    s_add_u32 m0, m0, 2048
    s_cmp_lg_u32 m0, 141312
    s_cbranch_scc1 L_dma_10
L_skip_9:
    s_waitcnt lgkmcnt(0)
    s_cmp_eq_u32 s30, 5
    s_cbranch_scc0 L_skip_11
    s_cmp_eq_u32 s52, 31
    s_cbranch_scc0 L_skip_12
    s_lshl_b32 s57, s31, 5
    v_mov_b32 v16, s57
    s_add_u32 s57, s63, 1
    v_mov_b32 v12, s57
    s_waitcnt vmcnt(3)
    s_mov_b64 exec, 0x1
    global_store_dword v16, v12, s[26:27] sc1
    s_mov_b64 exec, -1
L_skip_12:
L_skip_11:
    s_waitcnt vmcnt(31)
    s_barrier
    ds_read_b128 v[72:75], v8 offset:16384
    ds_read_b128 v[76:79], v9 offset:16384
    s_cmp_eq_u32 s30, 6
    s_cbranch_scc0 L_skip_13
    s_mov_b32 s57, 493568
    s_mov_b32 s58, 492672
    s_mov_b32 s59, 491776
    s_mov_b32 m0, 15360
L_dma_14:
    s_waitcnt vmcnt(25)
    buffer_load_dwordx4 v2, s[44:47], s57 offen offset:0 nt lds
    s_waitcnt vmcnt(25)
    buffer_load_dwordx4 v2, s[44:47], s58 offen offset:1024 nt lds
    s_waitcnt vmcnt(25)
    buffer_load_dwordx4 v2, s[44:47], s59 offen offset:2048 nt lds
    s_add_u32 s57, s57, 98304
    s_add_u32 s58, s58, 98304
    s_add_u32 s59, s59, 98304
    s_add_u32 m0, m0, 3072
    s_cmp_lg_u32 m0, 30720
    s_cbranch_scc1 L_dma_14
    s_mov_b32 s57, 393216
    s_mov_b32 s58, 588800
    s_mov_b32 m0, 141312
L_dma_15:
    s_waitcnt vmcnt(25)
    buffer_load_dwordx4 v5, s[32:35], s57 offen offset:0 nt lds
    s_waitcnt vmcnt(25)
    buffer_load_dwordx4 v6, s[32:35], s58 offen offset:1024 nt lds
    s_add_u32 s57, s57, 24576
    s_add_u32 s58, s58, 24576
    s_add_u32 m0, m0, 2048
    s_cmp_lg_u32 m0, 157696
    s_cbranch_scc1 L_dma_15
L_skip_13:
    s_waitcnt lgkmcnt(0)
    s_waitcnt vmcnt(31)
    s_barrier
    ds_read_b128 v[80:83], v8 offset:32768
    ds_read_b128 v[84:87], v9 offset:32768
    s_cmp_eq_u32 s30, 6
    s_cbranch_scc0 L_skip_16
    s_cmp_lg_u32 s53, 3
    s_cbranch_scc0 L_wb_17
    s_mul_i32 s57, s31, 983040
    s_lshl_b32 s58, s3, 6
    s_add_u32 s57, s57, s58
    v_bfe_u32 v38, v0, 4, 1
    v_lshlrev_b32 v38, 1, v38
    v_xor_b32 v38, v38, v0
    v_and_b32 v38, 3, v38
    v_lshrrev_b32 v3, 5, v0
    v_mul_u32_u24 v3, 10240, v3
    v_bfe_u32 v39, v0, 4, 1
    v_mul_u32_u24 v39, 2560, v39
    v_add_u32 v3, v39, v3
    v_bfe_u32 v39, v0, 3, 1
    v_mul_u32_u24 v39, 5120, v39
    v_add_u32 v3, v39, v3
    v_bfe_u32 v39, v0, 2, 1
    v_mul_u32_u24 v39, 20480, v39
    v_add_u32 v3, v39, v3
    v_add_u32 v3, s57, v3
    v_lshl_add_u32 v3, v38, 4, v3
    s_mov_b32 s14, 40960
    s_mov_b32 s15, 256
    s_branch L_we_18
L_wb_17:
    s_mul_i32 s57, s31, 384
    s_mul_i32 s58, s54, 245760
    s_add_u32 s57, s57, s58
    v_lshlrev_b32 v3, 4, v0
    v_add_u32 v3, s57, v3
    v_mov_b32 v38, 2688
    v_cmp_lt_u32 vcc, 23, v0
    s_nop 1
    v_cndmask_b32 v38, 0, v38, vcc
    v_add_u32 v3, v38, v3
    v_mov_b32 v38, 0x7f000000
    v_cmp_lt_u32 vcc, 47, v0
    s_nop 1
    v_cndmask_b32 v3, v3, v38, vcc
    s_mov_b32 s14, 12288
    s_mov_b32 s15, 5120
L_we_18:
    s_mul_i32 s57, s14, 0
    s_mov_b32 m0, 30720
    s_waitcnt vmcnt(25)
    buffer_load_dwordx4 v3, s[48:51], s57 offen offset:0 nt lds
    s_mul_i32 s57, s14, 0
    s_add_u32 s57, s57, s15
    s_mov_b32 m0, 30720
    s_waitcnt vmcnt(25)
    buffer_load_dwordx4 v3, s[48:51], s57 offen offset:1024 nt lds
    s_mov_b32 s57, 393344
    s_mov_b32 s58, 588928
    s_mov_b32 m0, 92160
L_dma_19:
    s_waitcnt vmcnt(25)
    buffer_load_dwordx4 v5, s[32:35], s57 offen offset:0 nt lds
    s_waitcnt vmcnt(25)
    buffer_load_dwordx4 v6, s[32:35], s58 offen offset:1024 nt lds
    s_add_u32 s57, s57, 24576
    s_add_u32 s58, s58, 24576
    s_add_u32 m0, m0, 2048
    s_cmp_lg_u32 m0, 108544
    s_cbranch_scc1 L_dma_19
    s_mul_i32 s57, s14, 1
    s_mov_b32 m0, 32768
    s_waitcnt vmcnt(25)
    buffer_load_dwordx4 v3, s[48:51], s57 offen offset:0 nt lds
    s_mul_i32 s57, s14, 1
    s_add_u32 s57, s57, s15
    s_mov_b32 m0, 32768
    s_waitcnt vmcnt(25)
    buffer_load_dwordx4 v3, s[48:51], s57 offen offset:1024 nt lds
    s_mov_b32 s57, 393472
    s_mov_b32 s58, 589056
    s_mov_b32 m0, 108544
L_dma_20:
    s_waitcnt vmcnt(25)
    buffer_load_dwordx4 v5, s[32:35], s57 offen offset:0 nt lds
    s_waitcnt vmcnt(25)
    buffer_load_dwordx4 v6, s[32:35], s58 offen offset:1024 nt lds
    s_add_u32 s57, s57, 24576
    s_add_u32 s58, s58, 24576
    s_add_u32 m0, m0, 2048
    s_cmp_lg_u32 m0, 124928
    s_cbranch_scc1 L_dma_20
L_skip_16:
    s_waitcnt lgkmcnt(0)
    s_cmp_lt_u32 s30, 5
    s_cbranch_scc0 L_skip_21
    s_waitcnt vmcnt(0)
L_skip_21:
    s_cmp_eq_u32 s30, 7
    s_cbranch_scc0 L_skip_22
    v_and_b32 v60, 31, v0
    v_cmp_gt_u32 s[64:65], 20, v60
    v_min_u32 v60, 19, v60
    v_lshrrev_b32 v35, 5, v0
    v_lshlrev_b32 v35, 2, v35
    v_add_u32 v35, 160832, v35
    v_lshl_add_u32 v35, v60, 3, v35
    s_mul_i32 s66, s53, 6400
    s_add_u32 s66, s66, s62
    s_add_u32 s66, s66, 57344
    s_add_u32 s67, s66, 6144
    s_lshl_b32 s57, s54, 3
    v_lshrrev_b32 v34, 5, v0
    v_lshlrev_b32 v34, 2, v34
    v_add_u32 v34, s57, v34
    v_and_b32 v60, 31, v0
    v_mov_b32 v61, 0x7f000000
    v_cmp_ne_u32 vcc, 31, v60
    s_nop 1
    v_cndmask_b32 v34, v34, v61, vcc
    v_mov_b32 v61, 0x3f803f80
    s_waitcnt vmcnt(0)
    ds_write_b32 v35, v28
    s_waitcnt lgkmcnt(0)
L_skip_22:
    s_cmp_eq_u32 s30, 5
    s_cbranch_scc0 L_skip_23
    s_waitcnt vmcnt(0)
    s_mov_b32 s67, 0
    s_load_dword s66, s[10:11], 0
    s_load_dword s67, s[10:11], 8192
    s_waitcnt lgkmcnt(1)
    s_sleep 1
    s_mov_b32 s65, s67
L_skip_23:
    s_waitcnt vmcnt(36)
    s_barrier
    ds_read_b128 v[88:91], v8 offset:49152
    ds_read_b128 v[92:95], v9 offset:49152
    s_cmp_eq_u32 s30, 6
    s_cbranch_scc0 L_skip_24
    s_mul_i32 s57, s14, 2
    s_mov_b32 m0, 34816
    s_waitcnt vmcnt(25)
    buffer_load_dwordx4 v3, s[48:51], s57 offen offset:0 nt lds
    s_mul_i32 s57, s14, 2
    s_add_u32 s57, s57, s15
    s_mov_b32 m0, 34816
    s_waitcnt vmcnt(25)
    buffer_load_dwordx4 v3, s[48:51], s57 offen offset:1024 nt lds
    s_mov_b32 s57, 786432
    s_mov_b32 s58, 982016
    s_mov_b32 m0, 124928
L_dma_25:
    s_waitcnt vmcnt(25)
    buffer_load_dwordx4 v5, s[32:35], s57 offen offset:0 nt lds
    s_waitcnt vmcnt(25)
    buffer_load_dwordx4 v6, s[32:35], s58 offen offset:1024 nt lds
    s_add_u32 s57, s57, 24576
    s_add_u32 s58, s58, 24576
    s_add_u32 m0, m0, 2048
    s_cmp_lg_u32 m0, 141312
    s_cbranch_scc1 L_dma_25
L_skip_24:
    s_waitcnt lgkmcnt(0)
    s_cmp_lt_u32 s30, 4
    s_cbranch_scc0 L_skip_26
    s_mov_b64 exec, 0
    s_cmp_eq_u32 s30, 1
    s_cbranch_scc1 L_pad1
    s_cmp_eq_u32 s30, 2
    s_cbranch_scc1 L_pad2
    s_cmp_eq_u32 s30, 3
    s_cbranch_scc1 L_pad3
    s_branch L_pad0
L_padback:
    s_mov_b64 exec, -1
L_skip_26:
    s_cmp_eq_u32 s30, 7
    s_cbranch_scc0 L_skip_27
    v_cndmask_b32 v29, 0, v28, s[64:65]
    v_dot2_f32_bf16 v33, v29, v61, 0
    v_dot2_f32_bf16 v62, v29, v29, 0
    v_lshlrev_b32 v2, 16, v28
    v_and_b32 v3, 0xffff0000, v28
    s_cmp_eq_u32 s55, 0
    v_permlane32_swap_b32 v33, v62
    v_add_f32 v33, v33, v62
    s_nop 1
    v_add_f32_dpp v33, v33, v33 row_ror:8 row_mask:0xf bank_mask:0xf
    s_nop 1
    v_add_f32_dpp v33, v33, v33 row_ror:4 row_mask:0xf bank_mask:0xf
    s_nop 1
    v_add_f32_dpp v33, v33, v33 row_ror:2 row_mask:0xf bank_mask:0xf
    s_nop 1
    v_add_f32_dpp v33, v33, v33 row_ror:1 row_mask:0xf bank_mask:0xf
    s_nop 1
    v_add_f32_dpp v33, v33, v33 row_bcast:15 row_mask:0xa bank_mask:0xf
    v_min_u32 v33, -2, v33
    s_cbranch_scc1 L_gs_28
    buffer_store_dword v33, v34, s[40:43], s67 offen
L_gb_29:
    s_waitcnt vmcnt(1)
L_skip_27:
    s_cmp_lt_u32 s30, 6
    s_cbranch_scc0 L_skip_30
    s_lshr_b32 s57, s30, 1
    s_mul_i32 s57, s57, 1024
    s_and_b32 s58, s30, 1
    s_lshl_b32 s58, s58, 6
    s_add_u32 s57, s57, s58
    v_lshrrev_b32 v18, 5, v0
    v_mul_u32_u24 v18, 6144, v18
    v_bfe_u32 v60, v0, 3, 1
    v_mul_u32_u24 v60, 3072, v60
    v_add_u32 v18, v60, v18
    v_bfe_u32 v60, v0, 4, 1
    v_lshl_add_u32 v18, v60, 9, v18
    v_bfe_u32 v60, v0, 2, 1
    v_lshl_add_u32 v18, v60, 7, v18
    v_and_b32 v60, 3, v0
    v_lshl_add_u32 v18, v60, 3, v18
    v_add_u32 v18, s57, v18
    v_bfe_u32 v19, v0, 4, 1
    v_mul_u32_u24 v19, 3072, v19
    v_bfe_u32 v60, v0, 3, 1
    v_lshl_add_u32 v19, v60, 9, v19
    v_bfe_u32 v60, v0, 2, 1
    v_lshl_add_u32 v19, v60, 7, v19
    v_and_b32 v60, 3, v0
    v_lshl_add_u32 v19, v60, 3, v19
    v_add_u32 v19, s57, v19
    v_add_u32 v19, 24576, v19
    ds_read_b64_tr_b16 v[36:37], v18 offset:0
    ds_read_b64_tr_b16 v[38:39], v18 offset:256
    ds_read_b64_tr_b16 v[40:41], v18 offset:12288
    ds_read_b64_tr_b16 v[42:43], v18 offset:12544
    ds_read_b64_tr_b16 v[44:45], v19 offset:0
    ds_read_b64_tr_b16 v[46:47], v19 offset:256
    ds_read_b64_tr_b16 v[48:49], v18 offset:32
    ds_read_b64_tr_b16 v[50:51], v18 offset:288
    ds_read_b64_tr_b16 v[52:53], v18 offset:12320
    ds_read_b64_tr_b16 v[54:55], v18 offset:12576
    ds_read_b64_tr_b16 v[56:57], v19 offset:32
    ds_read_b64_tr_b16 v[58:59], v19 offset:288
    v_lshrrev_b32 v32, 4, v0
    v_lshlrev_b32 v32, 5, v32
    v_bfe_u32 v60, v0, 1, 1
    v_lshl_add_u32 v32, v60, 4, v32
    v_and_b32 v60, 1, v0
    v_mul_u32_u24 v60, 192, v60
    v_add_u32 v32, v60, v32
    v_add_u32 v32, 160832, v32
    v_lshrrev_b32 v33, 4, v0
    v_lshlrev_b32 v33, 4, v33
    v_bfe_u32 v60, v0, 1, 1
    v_lshl_add_u32 v33, v60, 3, v33
    v_and_b32 v60, 1, v0
    v_mul_u32_u24 v60, 192, v60
    v_add_u32 v33, v60, v33
    v_add_u32 v33, 160960, v33
    v_mov_b64 v[24:25], 0
    v_mov_b64 v[26:27], 0
    v_mov_b64 v[28:29], 0
    v_mov_b64 v[30:31], 0
    s_lshr_b32 s57, s54, 1
    s_lshl_b32 s57, s57, 2
    s_and_b32 s58, s54, 1
    s_add_u32 s57, s57, s58
    s_lshl_b32 s57, s57, 4
    s_lshl_b32 s58, s30, 9
    s_add_u32 s57, s57, s58
    v_bfe_u32 v34, v0, 4, 1
    v_lshlrev_b32 v34, 8, v34
    v_bfe_u32 v60, v0, 1, 1
    v_lshl_add_u32 v34, v60, 5, v34
    v_bfe_u32 v60, v0, 2, 2
    v_lshl_add_u32 v34, v60, 2, v34
    v_lshrrev_b32 v60, 5, v0
    v_mul_u32_u24 v60, 3072, v60
    v_add_u32 v34, v60, v34
    v_and_b32 v60, 1, v0
    v_lshl_add_u32 v34, v60, 30, v34
    v_add_u32 v34, s57, v34
    s_mul_i32 s59, s53, 6400
    s_add_u32 s59, s59, s62
    s_add_u32 s59, s59, 57344
    s_add_u32 s60, s59, 6144
    ds_read_b128 v[12:15], v32
    ds_read_b64 v[16:17], v33
    s_waitcnt lgkmcnt(1)
    v_smfmac_f32_16x16x64_bf16 v[24:27], v[12:15], v[36:43], v1
    v_smfmac_f32_16x16x64_bf16 v[28:31], v[12:15], v[48:55], v1
    s_waitcnt lgkmcnt(0)
    v_smfmac_f32_16x16x32_bf16 v[24:27], v[16:17], v[44:47], v1
    v_smfmac_f32_16x16x32_bf16 v[28:31], v[16:17], v[56:59], v1
    s_cmp_eq_u32 s55, 0
    s_nop 5
    v_add_f32 v12, v24, v26
    s_nop 1
    v_add_f32_dpp v12, v28, v30 quad_perm:[0,1,2,3] row_mask:0x2 bank_mask:0xf
    s_nop 1
    v_add_f32_dpp v12, v25, v27 quad_perm:[0,1,2,3] row_mask:0x4 bank_mask:0xf
    s_nop 1
    v_add_f32_dpp v12, v29, v31 quad_perm:[0,1,2,3] row_mask:0x8 bank_mask:0xf
    s_nop 1
    v_mov_b32_dpp v13, v12 row_shl:1 row_mask:0xf bank_mask:0xf bound_ctrl:0
    v_cvt_pk_bf16_f32 v12, v12, v13
    v_min_u32 v12, -2, v12
    s_cbranch_scc1 L_gs_31
    buffer_store_dword v12, v34, s[40:43], s59 offen
L_gb_32:
L_skip_30:
    s_cmp_eq_u32 s30, 5
    s_cbranch_scc0 L_skip_33
    global_load_dword v2, v3, s[26:27] sc1
L_skip_33:
    s_waitcnt vmcnt(36)
    s_barrier
    ds_read_b128 v[96:99], v8 offset:0
    ds_read_b128 v[100:103], v9 offset:0
    s_cmp_eq_u32 s30, 6
    s_cbranch_scc0 L_skip_34
    s_mul_i32 s57, s14, 3
    s_mov_b32 m0, 36864
    s_waitcnt vmcnt(25)
    buffer_load_dwordx4 v3, s[48:51], s57 offen offset:0 nt lds
    s_mul_i32 s57, s14, 3
    s_add_u32 s57, s57, s15
    s_mov_b32 m0, 36864
    s_waitcnt vmcnt(25)
    buffer_load_dwordx4 v3, s[48:51], s57 offen offset:1024 nt lds
    s_mov_b32 s57, 786560
    s_mov_b32 s58, 982144
    s_mov_b32 m0, 141312
L_dma_35:
    s_waitcnt vmcnt(25)
    buffer_load_dwordx4 v5, s[32:35], s57 offen offset:0 nt lds
    s_waitcnt vmcnt(25)
    buffer_load_dwordx4 v6, s[32:35], s58 offen offset:1024 nt lds
    s_add_u32 s57, s57, 24576
    s_add_u32 s58, s58, 24576
    s_add_u32 m0, m0, 2048
    s_cmp_lg_u32 m0, 157696
    s_cbranch_scc1 L_dma_35
L_skip_34:
    s_waitcnt lgkmcnt(0)
    s_waitcnt vmcnt(36)
    s_barrier
    ds_read_b128 v[104:107], v8 offset:16384
    ds_read_b128 v[108:111], v9 offset:16384
    s_cmp_eq_u32 s30, 6
    s_cbranch_scc0 L_skip_36
    s_mul_i32 s57, s14, 4
    s_mov_b32 m0, 38912
    s_waitcnt vmcnt(25)
    buffer_load_dwordx4 v3, s[48:51], s57 offen offset:0 nt lds
    s_mul_i32 s57, s14, 4
    s_add_u32 s57, s57, s15
    s_mov_b32 m0, 38912
    s_waitcnt vmcnt(25)
    buffer_load_dwordx4 v3, s[48:51], s57 offen offset:1024 nt lds
    s_mov_b32 s57, 786688
    s_mov_b32 s58, 982272
    s_mov_b32 m0, 92160
L_dma_37:
    s_waitcnt vmcnt(25)
    buffer_load_dwordx4 v5, s[32:35], s57 offen offset:0 nt lds
    s_waitcnt vmcnt(25)
    buffer_load_dwordx4 v6, s[32:35], s58 offen offset:1024 nt lds
    s_add_u32 s57, s57, 24576
    s_add_u32 s58, s58, 24576
    s_add_u32 m0, m0, 2048
    s_cmp_lg_u32 m0, 108544
    s_cbranch_scc1 L_dma_37
L_skip_36:
    s_waitcnt lgkmcnt(0)
    s_cmp_lg_u32 s30, 6
    s_cbranch_scc0 L_skip_38
    s_waitcnt vmcnt(0)
L_skip_38:
    s_waitcnt vmcnt(36)
    s_barrier
    ds_read_b128 v[112:115], v8 offset:32768
    ds_read_b128 v[116:119], v9 offset:32768
    s_cmp_eq_u32 s30, 6
    s_cbranch_scc0 L_skip_39
    s_mul_i32 s57, s14, 5
    s_mov_b32 m0, 40960
    s_waitcnt vmcnt(25)
    buffer_load_dwordx4 v3, s[48:51], s57 offen offset:0 nt lds
    s_mul_i32 s57, s14, 5
    s_add_u32 s57, s57, s15
    s_mov_b32 m0, 40960
    s_waitcnt vmcnt(25)
    buffer_load_dwordx4 v3, s[48:51], s57 offen offset:1024 nt lds
    s_mov_b32 s57, 1179648
    s_mov_b32 s58, 1375232
    s_mov_b32 m0, 108544
L_dma_40:
    s_waitcnt vmcnt(25)
    buffer_load_dwordx4 v5, s[32:35], s57 offen offset:0 nt lds
    s_waitcnt vmcnt(25)
    buffer_load_dwordx4 v6, s[32:35], s58 offen offset:1024 nt lds
    s_add_u32 s57, s57, 24576
    s_add_u32 s58, s58, 24576
    s_add_u32 m0, m0, 2048
    s_cmp_lg_u32 m0, 124928
    s_cbranch_scc1 L_dma_40
L_skip_39:
    s_waitcnt lgkmcnt(0)
    s_cmp_eq_u32 s30, 5
    s_cbranch_scc0 L_skip_41
L_cw_42:
    v_readlane_b32 s57, v2, s31
    s_cmp_eq_u32 s57, 0
    s_cbranch_scc1 L_cr_43
    s_lshr_b32 s58, s63, 2
    s_xor_b32 s58, s58, s65
    s_and_b32 s58, s58, 1
    v_mov_b32 v25, s58
    s_sub_u32 s57, s57, 1
    s_cmp_eq_u32 s57, s63
    s_cselect_b32 s64, 1, 0
    s_cbranch_scc0 L_far_44
    s_lshl_b32 s57, s52, 2
    s_add_u32 s57, s57, s72
    s_mov_b64 exec, 1
    buffer_store_dword v25, v0, s[40:43], s57 offen offset:0
    s_mov_b64 exec, -1
L_fb_45:
L_skip_41:
    s_waitcnt vmcnt(36)
    s_barrier
    ds_read_b128 v[120:123], v8 offset:49152
    ds_read_b128 v[124:127], v9 offset:49152
    s_cmp_eq_u32 s30, 6
    s_cbranch_scc0 L_skip_46
    s_mul_i32 s57, s14, 6
    s_mov_b32 m0, 43008
    s_waitcnt vmcnt(25)
    buffer_load_dwordx4 v3, s[48:51], s57 offen offset:0 nt lds
    s_mul_i32 s57, s14, 6
    s_add_u32 s57, s57, s15
    s_mov_b32 m0, 43008
    s_waitcnt vmcnt(25)
    buffer_load_dwordx4 v3, s[48:51], s57 offen offset:1024 nt lds
    s_mov_b32 s57, 1179776
    s_mov_b32 s58, 1375360
    s_mov_b32 m0, 124928
L_dma_47:
    s_waitcnt vmcnt(25)
    buffer_load_dwordx4 v5, s[32:35], s57 offen offset:0 nt lds
    s_waitcnt vmcnt(25)
    buffer_load_dwordx4 v6, s[32:35], s58 offen offset:1024 nt lds
    s_add_u32 s57, s57, 24576
    s_add_u32 s58, s58, 24576
    s_add_u32 m0, m0, 2048
    s_cmp_lg_u32 m0, 141312
    s_cbranch_scc1 L_dma_47
L_skip_46:
    s_waitcnt lgkmcnt(0)
    s_waitcnt vmcnt(36)
    s_barrier
    ds_read_b128 v[128:131], v8 offset:0
    ds_read_b128 v[132:135], v9 offset:0
    s_cmp_eq_u32 s30, 6
    s_cbranch_scc0 L_skip_48
    s_mul_i32 s57, s14, 7
    s_mov_b32 m0, 45056
    s_waitcnt vmcnt(25)
    buffer_load_dwordx4 v3, s[48:51], s57 offen offset:0 nt lds
    s_mul_i32 s57, s14, 7
    s_add_u32 s57, s57, s15
    s_mov_b32 m0, 45056
    s_waitcnt vmcnt(25)
    buffer_load_dwordx4 v3, s[48:51], s57 offen offset:1024 nt lds
    s_mov_b32 s57, 1179904
    s_mov_b32 s58, 1375488
    s_mov_b32 m0, 141312
L_dma_49:
    s_waitcnt vmcnt(25)
    buffer_load_dwordx4 v5, s[32:35], s57 offen offset:0 nt lds
    s_waitcnt vmcnt(25)
    buffer_load_dwordx4 v6, s[32:35], s58 offen offset:1024 nt lds
    s_add_u32 s57, s57, 24576
    s_add_u32 s58, s58, 24576
    s_add_u32 m0, m0, 2048
    s_cmp_lg_u32 m0, 157696
    s_cbranch_scc1 L_dma_49
L_skip_48:
    s_waitcnt lgkmcnt(0)
    s_cmp_eq_u32 s30, 5
    s_cbranch_scc0 L_skip_50
    v_lshlrev_b32 v24, 2, v0
    buffer_load_dword v2, v24, s[40:43], s72 offen sc1
L_skip_50:
    s_waitcnt vmcnt(36)
    s_barrier
    ds_read_b128 v[136:139], v8 offset:16384
    ds_read_b128 v[140:143], v9 offset:16384
    s_cmp_eq_u32 s30, 6
    s_cbranch_scc0 L_skip_51
    s_mul_i32 s57, s14, 8
    s_mov_b32 m0, 47104
    s_waitcnt vmcnt(25)
    buffer_load_dwordx4 v3, s[48:51], s57 offen offset:0 nt lds
    s_mul_i32 s57, s14, 8
    s_add_u32 s57, s57, s15
    s_mov_b32 m0, 47104
    s_waitcnt vmcnt(25)
    buffer_load_dwordx4 v3, s[48:51], s57 offen offset:1024 nt lds
    s_mov_b32 s57, 0
    s_mov_b32 s58, 392192
    s_mov_b32 m0, 92160
L_dma_52:
    s_waitcnt vmcnt(25)
    buffer_load_dwordx4 v7, s[36:39], s57 offen offset:0 nt lds
    s_waitcnt vmcnt(25)
    buffer_load_dwordx4 v7, s[36:39], s58 offen offset:1024 nt lds
    s_add_u32 s57, s57, 24576
    s_add_u32 s58, s58, 24576
    s_add_u32 m0, m0, 2048
    s_cmp_lg_u32 m0, 108544
    s_cbranch_scc1 L_dma_52
L_skip_51:
    s_waitcnt lgkmcnt(0)
    s_waitcnt vmcnt(36)
    s_barrier
    ds_read_b128 v[144:147], v8 offset:32768
    ds_read_b128 v[148:151], v9 offset:32768
    s_cmp_eq_u32 s30, 6
    s_cbranch_scc0 L_skip_53
    s_mul_i32 s57, s14, 9
    s_mov_b32 m0, 49152
    s_waitcnt vmcnt(25)
    buffer_load_dwordx4 v3, s[48:51], s57 offen offset:0 nt lds
    s_mul_i32 s57, s14, 9
    s_add_u32 s57, s57, s15
    s_mov_b32 m0, 49152
    s_waitcnt vmcnt(25)
    buffer_load_dwordx4 v3, s[48:51], s57 offen offset:1024 nt lds
    s_mov_b32 s57, 128
    s_mov_b32 s58, 392320
    s_mov_b32 m0, 108544
L_dma_54:
    s_waitcnt vmcnt(25)
    buffer_load_dwordx4 v7, s[36:39], s57 offen offset:0 nt lds
    s_waitcnt vmcnt(25)
    buffer_load_dwordx4 v7, s[36:39], s58 offen offset:1024 nt lds
    s_add_u32 s57, s57, 24576
    s_add_u32 s58, s58, 24576
    s_add_u32 m0, m0, 2048
    s_cmp_lg_u32 m0, 124928
    s_cbranch_scc1 L_dma_54
L_skip_53:
    s_waitcnt lgkmcnt(0)
    s_cmp_eq_u32 s30, 5
    s_cbranch_scc0 L_skip_55
L_cw_56:
    s_waitcnt vmcnt(0)
    v_cmp_ne_u32 vcc, -1, v2
    s_mov_b32 s57, 0
    s_mov_b32 s68, 16
    s_cmp_eq_u32 s64, 0
    s_cbranch_scc1 L_cd_58
    s_cmp_lg_u32 vcc_hi, 0
    s_cbranch_scc1 L_cd_58
    s_cmp_lg_u32 vcc_lo, -1
    s_cbranch_scc1 L_cr_57
    v_cmp_eq_u32 vcc, 1, v2
    s_bcnt1_i32_b32 s68, vcc_lo
    s_mov_b32 s57, 1
L_cd_58:
    v_mov_b32 v37, 160768
    v_mov_b32 v38, s57
    ds_write_b32 v37, v38
    s_waitcnt lgkmcnt(0)
L_skip_55:
    s_waitcnt vmcnt(36)
    s_barrier
    ds_read_b128 v[152:155], v8 offset:49152
    ds_read_b128 v[156:159], v9 offset:49152
    s_cmp_eq_u32 s30, 6
    s_cbranch_scc0 L_skip_59
    s_mul_i32 s57, s14, 10
    s_mov_b32 m0, 51200
    s_waitcnt vmcnt(25)
    buffer_load_dwordx4 v3, s[48:51], s57 offen offset:0 nt lds
    s_mul_i32 s57, s14, 10
    s_add_u32 s57, s57, s15
    s_mov_b32 m0, 51200
    s_waitcnt vmcnt(25)
    buffer_load_dwordx4 v3, s[48:51], s57 offen offset:1024 nt lds
    s_mov_b32 s57, 256
    s_mov_b32 s58, 392448
    s_mov_b32 m0, 124928
L_dma_60:
    s_waitcnt vmcnt(25)
    buffer_load_dwordx4 v7, s[36:39], s57 offen offset:0 nt lds
    s_waitcnt vmcnt(25)
    buffer_load_dwordx4 v7, s[36:39], s58 offen offset:1024 nt lds
    s_add_u32 s57, s57, 24576
    s_add_u32 s58, s58, 24576
    s_add_u32 m0, m0, 2048
    s_cmp_lg_u32 m0, 141312
    s_cbranch_scc1 L_dma_60
L_skip_59:
    s_waitcnt lgkmcnt(0)
    v_lshrrev_b32 v8, 2, v0
    v_lshlrev_b32 v8, 7, v8
    v_bfe_u32 v60, v0, 3, 2
    v_lshl_add_u32 v8, v60, 5, v8
    v_and_b32 v60, 3, v0
    v_lshl_add_u32 v8, v60, 3, v8
    v_add_u32 v8, s61, v8
    v_xor_b32 v9, 32, v8
    v_xor_b32 v10, 64, v8
    v_xor_b32 v11, 96, v8
    v_mov_b32 v41, 160768
    ds_read_b32 v42, v41
    s_waitcnt lgkmcnt(0)
    v_readfirstlane_b32 s55, v42
    s_cmp_eq_u32 s55, 0
    s_cbranch_scc1 L_spread
L_spread_back:
    s_cmp_eq_u32 s30, 5
    s_cbranch_scc0 L_skip_72
    s_cmp_eq_u32 s52, 31
    s_cbranch_scc0 L_skip_73
    s_lshl_b32 s57, s31, 5
    v_mov_b32 v16, s57
    s_add_u32 s57, s68, 1
    v_mov_b32 v12, s57
    s_mov_b64 exec, 0x1
    global_store_dword v16, v12, s[26:27] offset:4 sc1
    s_mov_b64 exec, -1
L_skip_73:
L_skip_72:
    s_cmp_eq_u32 s30, 4
    s_cbranch_scc0 L_skip_74
    s_mul_i32 s59, s53, 6400
    s_add_u32 s59, s59, s62
    s_add_u32 s59, s59, 57344
    s_add_u32 s60, s59, 6144
    v_lshlrev_b32 v16, 4, v0
    s_add_u32 s60, s59, 3072
    s_mov_b32 m0, 79872
    s_nop 0
    buffer_load_dwordx4 v16, s[40:43], s59 offen offset:0 sc1 nt lds
    buffer_load_dwordx4 v16, s[40:43], s59 offen offset:1024 sc1 nt lds
    buffer_load_dwordx4 v16, s[40:43], s59 offen offset:2048 sc1 nt lds
    s_mov_b32 m0, 82944
    s_nop 0
    buffer_load_dwordx4 v16, s[40:43], s60 offen offset:0 sc1 nt lds
    buffer_load_dwordx4 v16, s[40:43], s60 offen offset:1024 sc1 nt lds
    buffer_load_dwordx4 v16, s[40:43], s60 offen offset:2048 sc1 nt lds
    s_mov_b64 exec, 0xf
    buffer_load_dwordx4 v16, s[40:43], s60 offen offset:3072 sc1 nt lds
    s_mov_b64 exec, -1
L_skip_74:
    s_waitcnt vmcnt(36)
    s_barrier
    ds_read_b64_tr_b16 v[160:161], v8 offset:0
    ds_read_b64_tr_b16 v[168:169], v9 offset:0
    ds_read_b64_tr_b16 v[176:177], v10 offset:0
    ds_read_b64_tr_b16 v[184:185], v11 offset:0
    s_cmp_eq_u32 s30, 6
    s_cbranch_scc0 L_skip_75
    s_mul_i32 s57, s14, 11
    s_mov_b32 m0, 53248
    s_waitcnt vmcnt(25)
    buffer_load_dwordx4 v3, s[48:51], s57 offen offset:0 nt lds
    s_mul_i32 s57, s14, 11
    s_add_u32 s57, s57, s15
    s_mov_b32 m0, 53248
    s_waitcnt vmcnt(25)
    buffer_load_dwordx4 v3, s[48:51], s57 offen offset:1024 nt lds
    s_mov_b32 s57, 196608
    s_mov_b32 s58, 588800
    s_mov_b32 m0, 141312
L_dma_76:
    s_waitcnt vmcnt(25)
    buffer_load_dwordx4 v7, s[36:39], s57 offen offset:0 nt lds
    s_waitcnt vmcnt(25)
    buffer_load_dwordx4 v7, s[36:39], s58 offen offset:1024 nt lds
    s_add_u32 s57, s57, 24576
    s_add_u32 s58, s58, 24576
    s_add_u32 m0, m0, 2048
    s_cmp_lg_u32 m0, 157696
    s_cbranch_scc1 L_dma_76
L_skip_75:
    s_waitcnt lgkmcnt(0)
    s_waitcnt vmcnt(36)
    s_barrier
    ds_read_b64_tr_b16 v[192:193], v8 offset:16384
    ds_read_b64_tr_b16 v[200:201], v9 offset:16384
    ds_read_b64_tr_b16 v[208:209], v10 offset:16384
    ds_read_b64_tr_b16 v[216:217], v11 offset:16384
    s_cmp_eq_u32 s30, 6
    s_cbranch_scc0 L_skip_77
    s_mul_i32 s57, s14, 12
    s_mov_b32 m0, 55296
    s_waitcnt vmcnt(25)
    buffer_load_dwordx4 v3, s[48:51], s57 offen offset:0 nt lds
    s_mul_i32 s57, s14, 12
    s_add_u32 s57, s57, s15
    s_mov_b32 m0, 55296
    s_waitcnt vmcnt(25)
    buffer_load_dwordx4 v3, s[48:51], s57 offen offset:1024 nt lds
    s_mov_b32 s57, 196736
    s_mov_b32 s58, 588928
    s_mov_b32 m0, 92160
L_dma_78:
    s_waitcnt vmcnt(25)
    buffer_load_dwordx4 v7, s[36:39], s57 offen offset:0 nt lds
    s_waitcnt vmcnt(25)
    buffer_load_dwordx4 v7, s[36:39], s58 offen offset:1024 nt lds
    s_add_u32 s57, s57, 24576
    s_add_u32 s58, s58, 24576
    s_add_u32 m0, m0, 2048
    s_cmp_lg_u32 m0, 108544
    s_cbranch_scc1 L_dma_78
L_skip_77:
    s_waitcnt lgkmcnt(0)
    s_cmp_eq_u32 s30, 4
    s_cbranch_scc0 L_skip_79
    s_waitcnt vmcnt(0)
L_skip_79:
    s_waitcnt vmcnt(36)
    s_barrier
    ds_read_b64_tr_b16 v[224:225], v8 offset:32768
    ds_read_b64_tr_b16 v[232:233], v9 offset:32768
    ds_read_b64_tr_b16 v[240:241], v10 offset:32768
    ds_read_b64_tr_b16 v[248:249], v11 offset:32768
    s_cmp_eq_u32 s30, 6
    s_cbranch_scc0 L_skip_80
    s_mul_i32 s57, s14, 13
    s_mov_b32 m0, 57344
    s_nop 0
    buffer_load_dwordx4 v3, s[48:51], s57 offen offset:0 nt lds
    s_mul_i32 s57, s14, 13
    s_add_u32 s57, s57, s15
    s_mov_b32 m0, 57344
    s_nop 0
    buffer_load_dwordx4 v3, s[48:51], s57 offen offset:1024 nt lds
    s_mov_b32 s57, 196864
    s_mov_b32 s58, 589056
    s_mov_b32 m0, 108544
L_dma_81:
    s_nop 0
    buffer_load_dwordx4 v7, s[36:39], s57 offen offset:0 nt lds
    buffer_load_dwordx4 v7, s[36:39], s58 offen offset:1024 nt lds
    s_add_u32 s57, s57, 24576
    s_add_u32 s58, s58, 24576
    s_add_u32 m0, m0, 2048
    s_cmp_lg_u32 m0, 124928
    s_cbranch_scc1 L_dma_81
L_skip_80:
    s_waitcnt lgkmcnt(0)
    v_lshlrev_b32 v40, 4, v0
    v_add_u32 v40, 79872, v40
    ds_read_b128 v[12:15], v40 offset:3072
    ds_read_b128 v[16:19], v40 offset:4096
    ds_read_b128 v[20:23], v40 offset:5120
    v_mov_b64 v[24:25], 0
    v_mov_b64 v[26:27], 0
    v_mov_b64 v[28:29], 0
    v_mov_b64 v[30:31], 0
    v_mov_b64 v[32:33], 0
    v_mov_b64 v[34:35], 0
    v_mov_b64 v[36:37], 0
    v_mov_b64 v[38:39], 0
    s_waitcnt lgkmcnt(0)
    v_smfmac_f32_16x16x64_bf16 v[24:27], v[12:15], v[64:71], v1
    v_smfmac_f32_16x16x64_bf16 v[24:27], v[16:19], v[72:79], v1
    v_smfmac_f32_16x16x64_bf16 v[24:27], v[20:23], v[80:87], v1
    v_smfmac_f32_16x16x64_bf16 v[32:35], v[12:15], v[112:119], v1
    v_smfmac_f32_16x16x64_bf16 v[32:35], v[16:19], v[120:127], v1
    v_smfmac_f32_16x16x64_bf16 v[32:35], v[20:23], v[128:135], v1
    v_smfmac_f32_16x16x64_bf16 v[28:31], v[12:15], v[88:95], v1
    v_smfmac_f32_16x16x64_bf16 v[28:31], v[16:19], v[96:103], v1
    v_smfmac_f32_16x16x64_bf16 v[28:31], v[20:23], v[104:111], v1
    v_smfmac_f32_16x16x64_bf16 v[36:39], v[12:15], v[136:143], v1
    s_nop 0
    v_pk_add_f32 v[24:25], v[24:25], v[26:27]
    v_add_f32 v24, v24, v25
    v_smfmac_f32_16x16x64_bf16 v[36:39], v[16:19], v[144:151], v1
    v_pk_add_f32 v[32:33], v[32:33], v[34:35]
    v_add_f32 v32, v32, v33
    v_smfmac_f32_16x16x64_bf16 v[36:39], v[20:23], v[152:159], v1
    s_nop 0
    v_permlane32_swap_b32 v24, v32
    v_add_f32 v24, v24, v32
    v_pk_add_f32 v[28:29], v[28:29], v[30:31]
    v_add_f32 v28, v28, v29
    s_nop 2
    v_pk_add_f32 v[36:37], v[36:37], v[38:39]
    v_add_f32 v36, v36, v37
    s_nop 1
    v_permlane32_swap_b32 v28, v36
    v_add_f32 v28, v28, v36
    s_nop 1
    v_permlane16_swap_b32 v24, v28
    v_add_f32 v6, v24, v28
    s_waitcnt vmcnt(36)
    s_barrier
    ds_read_b64_tr_b16 v[162:163], v8 offset:49152
    ds_read_b64_tr_b16 v[170:171], v9 offset:49152
    ds_read_b64_tr_b16 v[178:179], v10 offset:49152
    ds_read_b64_tr_b16 v[186:187], v11 offset:49152
    s_cmp_eq_u32 s30, 6
    s_cbranch_scc0 L_skip_82
    s_mul_i32 s57, s14, 14
    s_mov_b32 m0, 59392
    s_nop 0
    buffer_load_dwordx4 v3, s[48:51], s57 offen offset:0 nt lds
    s_mul_i32 s57, s14, 14
    s_add_u32 s57, s57, s15
    s_mov_b32 m0, 59392
    s_nop 0
    buffer_load_dwordx4 v3, s[48:51], s57 offen offset:1024 nt lds
    s_mov_b32 s57, 786432
    s_mov_b32 s58, 1178624
    s_mov_b32 m0, 124928
L_dma_83:
    s_nop 0
    buffer_load_dwordx4 v7, s[36:39], s57 offen offset:0 nt lds
    buffer_load_dwordx4 v7, s[36:39], s58 offen offset:1024 nt lds
    s_add_u32 s57, s57, 24576
    s_add_u32 s58, s58, 24576
    s_add_u32 m0, m0, 2048
    s_cmp_lg_u32 m0, 141312
    s_cbranch_scc1 L_dma_83
L_skip_82:
    s_waitcnt lgkmcnt(0)
    v_and_b32 v41, 7, v0
    v_lshlrev_b32 v41, 3, v41
    v_add_u32 v41, 86016, v41
    ds_read_b128 v[12:15], v40 offset:0
    ds_read_b128 v[16:19], v40 offset:1024
    ds_read_b128 v[20:23], v40 offset:2048
    ds_read_b64 v[52:53], v41
    v_mov_b64 v[24:25], 0
    v_mov_b64 v[26:27], 0
    v_mov_b64 v[28:29], 0
    v_mov_b64 v[30:31], 0
    v_mov_b64 v[32:33], 0
    v_mov_b64 v[34:35], 0
    v_mov_b64 v[36:37], 0
    v_mov_b64 v[38:39], 0
    s_waitcnt lgkmcnt(0)
    v_smfmac_f32_16x16x64_bf16 v[24:27], v[12:15], v[64:71], v1
    v_add_f32_dpp v52, v52, v52 row_ror:4 row_mask:0xf bank_mask:0xf
    v_add_f32_dpp v53, v53, v53 row_ror:4 row_mask:0xf bank_mask:0xf
    v_smfmac_f32_16x16x64_bf16 v[24:27], v[16:19], v[72:79], v1
    v_add_f32_dpp v52, v52, v52 row_ror:2 row_mask:0xf bank_mask:0xf
    v_add_f32_dpp v53, v53, v53 row_ror:2 row_mask:0xf bank_mask:0xf
    v_smfmac_f32_16x16x64_bf16 v[24:27], v[20:23], v[80:87], v1
    v_add_f32_dpp v52, v52, v52 row_ror:1 row_mask:0xf bank_mask:0xf
    v_add_f32_dpp v53, v53, v53 row_ror:1 row_mask:0xf bank_mask:0xf
    v_smfmac_f32_16x16x64_bf16 v[32:35], v[12:15], v[112:119], v1
    v_mul_f32 v52, 0x3acccccd, v52
    v_mul_f32 v53, 0x3acccccd, v53
    v_smfmac_f32_16x16x64_bf16 v[32:35], v[16:19], v[120:127], v1
    v_fma_f32 v53, -v52, v52, v53
    v_max_f32 v53, 0, v53
    v_smfmac_f32_16x16x64_bf16 v[32:35], v[20:23], v[128:135], v1
    v_add_f32 v53, 0x3727c5ac, v53
    v_rsq_f32 v53, v53
    v_smfmac_f32_16x16x64_bf16 v[28:31], v[12:15], v[88:95], v1
    v_mul_f32 v53, 0x3dd53b95, v53
    v_mul_f32 v52, -v52, v53
    v_smfmac_f32_16x16x64_bf16 v[28:31], v[16:19], v[96:103], v1
    v_mul_f32 v52, v52, v6
    v_smfmac_f32_16x16x64_bf16 v[28:31], v[20:23], v[104:111], v1
    v_smfmac_f32_16x16x64_bf16 v[36:39], v[12:15], v[136:143], v1
    v_pk_add_f32 v[24:25], v[24:25], v[26:27]
    v_add_f32 v24, v24, v25
    v_smfmac_f32_16x16x64_bf16 v[36:39], v[16:19], v[144:151], v1
    v_pk_add_f32 v[32:33], v[32:33], v[34:35]
    v_add_f32 v32, v32, v33
    v_smfmac_f32_16x16x64_bf16 v[36:39], v[20:23], v[152:159], v1
    s_nop 0
    v_permlane32_swap_b32 v24, v32
    v_add_f32 v24, v24, v32
    v_pk_add_f32 v[28:29], v[28:29], v[30:31]
    v_add_f32 v28, v28, v29
    s_nop 2
    v_pk_add_f32 v[36:37], v[36:37], v[38:39]
    v_add_f32 v36, v36, v37
    s_nop 1
    v_permlane32_swap_b32 v28, v36
    v_add_f32 v28, v28, v36
    s_nop 1
    v_permlane16_swap_b32 v24, v28
    v_add_f32 v24, v24, v28
    v_fma_f32 v24, v24, v53, v52
    s_mov_b32 vcc_lo, 0x55555555
    s_mov_b32 vcc_hi, 0x55555555
    v_max_f32_dpp v20, v24, v24 row_ror:8 row_mask:0xf bank_mask:0xf
    s_nop 1
    v_max_f32_dpp v20, v20, v20 row_ror:4 row_mask:0xf bank_mask:0xf
    s_nop 1
    v_max_f32_dpp v20, v20, v20 row_ror:2 row_mask:0xf bank_mask:0xf
    s_nop 1
    v_max_f32_dpp v20, v20, v20 row_ror:1 row_mask:0xf bank_mask:0xf
    s_nop 1
    v_max_f32_dpp v20, v20, v20 row_bcast:15 row_mask:0xa bank_mask:0xf
    s_nop 1
    v_max_f32_dpp v20, v20, v20 row_bcast:31 row_mask:0xc bank_mask:0xf
    s_nop 0
    v_readlane_b32 s57, v20, 63
    s_nop 1
    v_subrev_f32 v24, s57, v24
    v_exp_f32 v22, v24
    s_nop 1
    v_mov_b32_dpp v23, v22 row_shl:1 row_mask:0xf bank_mask:0xf bound_ctrl:0
    v_cvt_pk_bf16_f32 v23, v22, v23
    v_cndmask_b32 v12, 0, v23, vcc
    v_add_f32_dpp v21, v22, v22 row_ror:8 row_mask:0xf bank_mask:0xf
    s_nop 0
    v_mov_b32_dpp v13, v12 row_shl:4 row_mask:0xf bank_mask:0xf bound_ctrl:0
    v_mov_b32_dpp v14, v12 row_shl:8 row_mask:0xf bank_mask:0xf bound_ctrl:0
    v_mov_b32_dpp v15, v12 row_shl:12 row_mask:0xf bank_mask:0xf bound_ctrl:0
    v_add_f32_dpp v21, v21, v21 row_ror:4 row_mask:0xf bank_mask:0xf
    v_mov_b32_dpp v16, v12 row_shr:1 row_mask:0xf bank_mask:0xf bound_ctrl:0
    v_mov_b64 v[40:41], 0
    v_mov_b64 v[42:43], 0
    v_mov_b64 v[44:45], 0
    v_mov_b64 v[46:47], 0
    v_mov_b64 v[48:49], 0
    v_mov_b64 v[50:51], 0
    v_mov_b64 v[52:53], 0
    v_mov_b64 v[54:55], 0
    v_mov_b64 v[56:57], 0
    v_mov_b64 v[58:59], 0
    v_mov_b64 v[60:61], 0
    v_mov_b64 v[62:63], 0
    s_lshl_b32 s58, s30, 3
    s_add_u32 s58, s58, 159744
    v_mov_b32 v38, s58
    v_lshlrev_b32 v37, 3, v0
    v_add_u32 v37, 157696, v37
    v_cmp_eq_u32 vcc, 63, v0
    s_nop 1
    v_cndmask_b32 v37, v37, v38, vcc
    v_add_f32_dpp v21, v21, v21 row_ror:2 row_mask:0xf bank_mask:0xf
    v_mov_b32_dpp v17, v12 row_shl:3 row_mask:0xf bank_mask:0xf bound_ctrl:0
    s_nop 0
    v_add_f32_dpp v21, v21, v21 row_ror:1 row_mask:0xf bank_mask:0xf
    v_mov_b32_dpp v18, v12 row_shl:7 row_mask:0xf bank_mask:0xf bound_ctrl:0
    s_nop 0
    v_add_f32_dpp v21, v21, v21 row_bcast:15 row_mask:0xa bank_mask:0xf
    v_mov_b32_dpp v19, v12 row_shl:11 row_mask:0xf bank_mask:0xf bound_ctrl:0
    s_nop 0
    v_add_f32_dpp v21, v21, v21 row_bcast:31 row_mask:0xc bank_mask:0xf
    ds_write_b64 v37, v[20:21]
    s_lshl_b32 s57, s30, 12
    v_lshlrev_b32 v36, 4, v0
    v_add_u32 v36, s57, v36
    v_add_u32 v36, 92160, v36
    s_waitcnt lgkmcnt(0)
    s_waitcnt vmcnt(36)
    s_barrier
    ds_read_b64_tr_b16 v[194:195], v8 offset:0
    ds_read_b64_tr_b16 v[202:203], v9 offset:0
    ds_read_b64_tr_b16 v[210:211], v10 offset:0
    ds_read_b64_tr_b16 v[218:219], v11 offset:0
    s_cmp_eq_u32 s30, 6
    s_cbranch_scc0 L_skip_84
    s_mul_i32 s57, s14, 15
    s_mov_b32 m0, 61440
    s_waitcnt vmcnt(25)
    buffer_load_dwordx4 v3, s[48:51], s57 offen offset:0 nt lds
    s_mul_i32 s57, s14, 15
    s_add_u32 s57, s57, s15
    s_mov_b32 m0, 61440
    s_waitcnt vmcnt(25)
    buffer_load_dwordx4 v3, s[48:51], s57 offen offset:1024 nt lds
    s_mov_b32 s57, 786560
    s_mov_b32 s58, 1178752
    s_mov_b32 m0, 141312
L_dma_85:
    s_waitcnt vmcnt(25)
    buffer_load_dwordx4 v7, s[36:39], s57 offen offset:0 nt lds
    s_waitcnt vmcnt(25)
    buffer_load_dwordx4 v7, s[36:39], s58 offen offset:1024 nt lds
    s_add_u32 s57, s57, 24576
    s_add_u32 s58, s58, 24576
    s_add_u32 m0, m0, 2048
    s_cmp_lg_u32 m0, 157696
    s_cbranch_scc1 L_dma_85
L_skip_84:
    s_waitcnt lgkmcnt(0)
    s_cmp_lt_u32 s30, 2
    s_cbranch_scc0 L_skip_86
    s_mul_i32 s57, s30, 48
    v_add_u32 v38, s57, v0
    v_bfe_u32 v2, v38, 5, 2
    v_lshlrev_b32 v2, 10, v2
    v_and_b32 v39, 15, v38
    v_lshl_add_u32 v2, v39, 4, v2
    v_bfe_u32 v39, v38, 4, 1
    v_lshl_add_u32 v2, v39, 3, v2
    v_add_u32 v2, 92160, v2
    s_lshr_b32 s57, s54, 1
    s_lshl_b32 s57, s57, 2
    s_and_b32 s58, s54, 1
    s_add_u32 s57, s57, s58
    s_lshl_b32 s58, s57, 4
    s_lshl_b32 s57, s57, 3
    v_bfe_u32 v3, v0, 3, 2
    v_lshlrev_b32 v3, 8, v3
    v_bfe_u32 v39, v0, 2, 1
    v_lshl_add_u32 v3, v39, 5, v3
    v_and_b32 v39, 3, v0
    v_lshl_add_u32 v3, v39, 2, v3
    v_add_u32 v3, s58, v3
    v_bfe_u32 v38, v0, 3, 1
    v_lshlrev_b32 v38, 8, v38
    v_bfe_u32 v39, v0, 1, 1
    v_lshl_add_u32 v38, v39, 7, v38
    v_bfe_u32 v39, v0, 2, 1
    v_lshl_add_u32 v38, v39, 4, v38
    v_and_b32 v39, 1, v0
    v_lshl_add_u32 v38, v39, 2, v38
    v_add_u32 v38, s57, v38
    v_add_u32 v38, 1024, v38
    v_cmp_gt_u32 vcc, 32, v0
    s_nop 1
    v_cndmask_b32 v3, v38, v3, vcc
    s_lshl_b32 s57, s53, 1
    s_add_u32 s57, s57, s30
    s_mul_i32 s57, s57, 1536
    s_add_u32 s57, s57, s62
    v_add_u32 v3, s57, v3
    v_mov_b32 v38, 0x7f000000
    v_cmp_le_u32 vcc, 48, v0
    s_nop 1
    v_cndmask_b32 v3, v3, v38, vcc
    v_and_b32 v4, 7, v0
    v_lshlrev_b32 v4, 3, v4
    v_add_u32 v4, 159744, v4
    s_lshl_b32 s57, s53, 3
    s_add_u32 s57, s57, s54
    s_lshl_b32 s57, s57, 2
    s_add_u32 s57, s57, s62
    s_add_u32 s57, s57, 55808
    v_add_u32 v23, s30, v0
    v_lshlrev_b32 v23, 24, v23
L_mw_87:
    ds_read_b64 v[38:39], v4 offset:0
    s_waitcnt lgkmcnt(0)
    v_max_f32_dpp v37, v38, v38 row_ror:4 row_mask:0xf bank_mask:0xf
    s_cmp_eq_u32 s55, 0
    s_nop 0
    v_max_f32_dpp v37, v37, v37 row_ror:2 row_mask:0xf bank_mask:0xf
    s_nop 1
    v_max_f32_dpp v37, v37, v37 row_ror:1 row_mask:0xf bank_mask:0xf
    v_sub_f32 v38, v38, v37
    v_exp_f32 v38, v38
    s_nop 0
    v_mul_f32 v39, v38, v39
    s_nop 1
    v_add_f32_dpp v39, v39, v39 row_ror:4 row_mask:0xf bank_mask:0xf
    s_nop 1
    v_add_f32_dpp v39, v39, v39 row_ror:2 row_mask:0xf bank_mask:0xf
    s_nop 1
    v_add_f32_dpp v39, v39, v39 row_ror:1 row_mask:0xf bank_mask:0xf
    v_rcp_f32 v21, v39
    v_log_f32 v22, v39
    v_mul_f32 v38, v38, v21
    v_add_f32 v22, v22, v37
    v_min_u32 v22, -2, v22
    s_cbranch_scc1 L_gs_89
    buffer_store_dword v22, v23, s[40:43], s57 offen
L_gb_90:
    v_readlane_b32 s64, v38, 0
    v_readlane_b32 s65, v38, 1
    v_readlane_b32 s66, v38, 2
    v_readlane_b32 s67, v38, 3
    v_readlane_b32 s68, v38, 4
    v_readlane_b32 s69, v38, 5
    v_readlane_b32 s70, v38, 6
    v_readlane_b32 s71, v38, 7
L_skip_86:
    s_waitcnt vmcnt(36)
    s_barrier
    ds_read_b64_tr_b16 v[226:227], v8 offset:16384
    ds_read_b64_tr_b16 v[234:235], v9 offset:16384
    ds_read_b64_tr_b16 v[242:243], v10 offset:16384
    ds_read_b64_tr_b16 v[250:251], v11 offset:16384
    s_cmp_eq_u32 s30, 6
    s_cbranch_scc0 L_skip_91
    s_mov_b32 s57, 786688
    s_mov_b32 s58, 1178880
    s_mov_b32 m0, 92160
L_dma_92:
    s_waitcnt vmcnt(25)
    buffer_load_dwordx4 v7, s[36:39], s57 offen offset:0 nt lds
    s_waitcnt vmcnt(25)
    buffer_load_dwordx4 v7, s[36:39], s58 offen offset:1024 nt lds
    s_add_u32 s57, s57, 24576
    s_add_u32 s58, s58, 24576
    s_add_u32 m0, m0, 2048
    s_cmp_lg_u32 m0, 108544
    s_cbranch_scc1 L_dma_92
L_skip_91:
    s_waitcnt lgkmcnt(0)
    s_cmp_eq_u32 s30, 5
    s_cbranch_scc0 L_skip_93
    global_load_dword v2, v3, s[26:27] offset:4 sc1
L_skip_93:
    s_waitcnt vmcnt(34)
    s_barrier
    ds_read_b64_tr_b16 v[164:165], v8 offset:32768
    ds_read_b64_tr_b16 v[172:173], v9 offset:32768
    ds_read_b64_tr_b16 v[180:181], v10 offset:32768
    ds_read_b64_tr_b16 v[188:189], v11 offset:32768
    s_cmp_eq_u32 s30, 6
    s_cbranch_scc0 L_skip_94
    s_mov_b32 s57, 983040
    s_mov_b32 s58, 1375232
    s_mov_b32 m0, 108544
L_dma_95:
    s_waitcnt vmcnt(25)
    buffer_load_dwordx4 v7, s[36:39], s57 offen offset:0 nt lds
    s_waitcnt vmcnt(25)
    buffer_load_dwordx4 v7, s[36:39], s58 offen offset:1024 nt lds
    s_add_u32 s57, s57, 24576
    s_add_u32 s58, s58, 24576
    s_add_u32 m0, m0, 2048
    s_cmp_lg_u32 m0, 124928
    s_cbranch_scc1 L_dma_95
L_skip_94:
    s_waitcnt lgkmcnt(0)
    s_waitcnt vmcnt(32)
    s_barrier
    ds_read_b64_tr_b16 v[196:197], v8 offset:49152
    ds_read_b64_tr_b16 v[204:205], v9 offset:49152
    ds_read_b64_tr_b16 v[212:213], v10 offset:49152
    ds_read_b64_tr_b16 v[220:221], v11 offset:49152
    s_cmp_eq_u32 s30, 6
    s_cbranch_scc0 L_skip_96
    s_mov_b32 s57, 983168
    s_mov_b32 s58, 1375360
    s_mov_b32 m0, 124928
L_dma_97:
    s_waitcnt vmcnt(25)
    buffer_load_dwordx4 v7, s[36:39], s57 offen offset:0 nt lds
    s_waitcnt vmcnt(25)
    buffer_load_dwordx4 v7, s[36:39], s58 offen offset:1024 nt lds
    s_add_u32 s57, s57, 24576
    s_add_u32 s58, s58, 24576
    s_add_u32 m0, m0, 2048
    s_cmp_lg_u32 m0, 141312
    s_cbranch_scc1 L_dma_97
L_skip_96:
    s_waitcnt lgkmcnt(0)
    s_cmp_eq_u32 s30, 5
    s_cbranch_scc0 L_skip_98
L_cw_99:
    s_waitcnt vmcnt(0)
    v_cmp_eq_u32 vcc, 0, v2
    s_cbranch_vccnz L_cr_100
    v_add_u32_dpp v2, v2, v2 row_ror:4 row_mask:0xf bank_mask:0xf
    s_nop 1
    v_add_u32_dpp v2, v2, v2 row_ror:2 row_mask:0xf bank_mask:0xf
    s_nop 1
    v_add_u32_dpp v2, v2, v2 row_ror:1 row_mask:0xf bank_mask:0xf
    v_mov_b32 v37, 160772
    ds_write_b32 v37, v2
    s_waitcnt lgkmcnt(0)
L_skip_98:
    s_cmp_eq_u32 s30, 2
    s_cbranch_scc0 L_skip_101
    s_mul_i32 s57, s52, 1792
    s_add_u32 s57, s57, s62
    v_min_u32 v37, 13, v0
    v_lshlrev_b32 v37, 7, v37
    buffer_load_dword v37, v37, s[40:43], s57 offen sc1 nt
L_skip_101:
    s_waitcnt vmcnt(32)
    s_barrier
    ds_read_b64_tr_b16 v[228:229], v8 offset:0
    ds_read_b64_tr_b16 v[236:237], v9 offset:0
    ds_read_b64_tr_b16 v[244:245], v10 offset:0
    ds_read_b64_tr_b16 v[252:253], v11 offset:0
    s_cmp_eq_u32 s30, 6
    s_cbranch_scc0 L_skip_102
    s_mov_b32 s57, 983296
    s_mov_b32 s58, 1375488
    s_mov_b32 m0, 141312
L_dma_103:
    s_waitcnt vmcnt(25)
    buffer_load_dwordx4 v7, s[36:39], s57 offen offset:0 nt lds
    s_waitcnt vmcnt(25)
    buffer_load_dwordx4 v7, s[36:39], s58 offen offset:1024 nt lds
    s_add_u32 s57, s57, 24576
    s_add_u32 s58, s58, 24576
    s_add_u32 m0, m0, 2048
    s_cmp_lg_u32 m0, 157696
    s_cbranch_scc1 L_dma_103
L_skip_102:
    s_waitcnt lgkmcnt(0)
    s_cmp_eq_u32 s30, 7
    s_cbranch_scc0 L_skip_104
    v_mov_b32 v37, 160772
    ds_read_b32 v37, v37
    s_lshr_b32 s58, s63, 2
    s_waitcnt lgkmcnt(0)
    v_readfirstlane_b32 s57, v37
    s_cmp_gt_u32 s57, 136
    s_cselect_b32 s57, 1, 0
    s_xor_b32 s57, s57, s58
    s_lshl_b32 s57, s57, 13
    s_add_u32 s7, s8, s57
L_skip_104:
    s_branch L_tail
.p2align 10
L_tail:
L_pad0:
    s_cbranch_execz L_pad4
    s_waitcnt vmcnt(32)
    s_barrier
    ds_read_b64_tr_b16 v[166:167], v8 offset:16384
    ds_read_b64_tr_b16 v[174:175], v9 offset:16384
    ds_read_b64_tr_b16 v[182:183], v10 offset:16384
    ds_read_b64_tr_b16 v[190:191], v11 offset:16384
    s_waitcnt lgkmcnt(0)
    s_cmp_lt_u32 s30, 5
    s_cbranch_scc0 L_skip_105
    s_waitcnt vmcnt(0)
L_skip_105:
    v_smfmac_f32_16x16x64_bf16 v[40:43], v[12:15], v[160:167], v1
    v_smfmac_f32_16x16x64_bf16 v[40:43], v[16:19], v[168:175], v1
    v_smfmac_f32_16x16x64_bf16 v[44:47], v[12:15], v[176:183], v1
    v_smfmac_f32_16x16x64_bf16 v[44:47], v[16:19], v[184:191], v1
    s_cmp_eq_u32 s30, 6
    s_cbranch_scc0 L_skip_106
    s_mul_i32 s57, s14, 16
    s_add_u32 s58, s57, s15
    s_mov_b32 m0, 63488
L_dma_107:
    s_waitcnt vmcnt(33)
    buffer_load_dwordx4 v3, s[48:51], s57 offen offset:0 nt lds
    s_waitcnt vmcnt(33)
    buffer_load_dwordx4 v3, s[48:51], s58 offen offset:1024 nt lds
    s_add_u32 s57, s57, s14
    s_add_u32 s58, s58, s14
    s_add_u32 m0, m0, 2048
    s_cmp_lg_u32 m0, 71680
    s_cbranch_scc1 L_dma_107
    s_mul_i32 s57, s14, 20
    s_add_u32 s58, s57, s15
    s_mov_b32 m0, 71680
L_dma_108:
    s_waitcnt vmcnt(33)
    buffer_load_dwordx4 v3, s[48:51], s57 offen offset:0 nt lds
    s_waitcnt vmcnt(33)
    buffer_load_dwordx4 v3, s[48:51], s58 offen offset:1024 nt lds
    s_add_u32 s57, s57, s14
    s_add_u32 s58, s58, s14
    s_add_u32 m0, m0, 2048
    s_cmp_lg_u32 m0, 79872
    s_cbranch_scc1 L_dma_108
L_skip_106:
    s_nop 3
    v_pk_add_f32 v[24:25], v[40:41], v[42:43]
    s_nop 0
    v_pk_add_f32 v[26:27], v[44:45], v[46:47]
    s_waitcnt vmcnt(32)
    s_barrier
    ds_read_b64_tr_b16 v[198:199], v8 offset:32768
    ds_read_b64_tr_b16 v[206:207], v9 offset:32768
    ds_read_b64_tr_b16 v[214:215], v10 offset:32768
    ds_read_b64_tr_b16 v[222:223], v11 offset:32768
    s_waitcnt lgkmcnt(0)
    v_smfmac_f32_16x16x64_bf16 v[48:51], v[12:15], v[192:199], v1
    v_smfmac_f32_16x16x64_bf16 v[48:51], v[16:19], v[200:207], v1
    v_smfmac_f32_16x16x64_bf16 v[52:55], v[12:15], v[208:215], v1
    v_smfmac_f32_16x16x64_bf16 v[52:55], v[16:19], v[216:223], v1
    s_nop 5
    v_pk_add_f32 v[28:29], v[48:49], v[50:51]
    s_nop 0
    v_pk_add_f32 v[30:31], v[52:53], v[54:55]
    ds_write_b128 v36, v[24:27] offset:0
    ds_write_b128 v36, v[28:31] offset:1024
    s_waitcnt vmcnt(16)
    s_barrier
    ds_read_b64_tr_b16 v[230:231], v8 offset:49152
    ds_read_b64_tr_b16 v[238:239], v9 offset:49152
    ds_read_b64_tr_b16 v[246:247], v10 offset:49152
    ds_read_b64_tr_b16 v[254:255], v11 offset:49152
    s_waitcnt lgkmcnt(0)
    v_smfmac_f32_16x16x64_bf16 v[56:59], v[12:15], v[224:231], v1
    v_smfmac_f32_16x16x64_bf16 v[56:59], v[16:19], v[232:239], v1
    v_smfmac_f32_16x16x64_bf16 v[60:63], v[12:15], v[240:247], v1
    v_smfmac_f32_16x16x64_bf16 v[60:63], v[16:19], v[248:255], v1
    s_setprio 0
    s_cmp_lt_u32 s30, 2
    s_mov_b64 exec, 0xffff
    s_nop 2
    v_pk_add_f32 v[32:33], v[56:57], v[58:59]
    s_nop 0
    v_pk_add_f32 v[34:35], v[60:61], v[62:63]
    ds_write_b128 v36, v[32:35] offset:2048
    s_mov_b64 exec, -1
    s_cbranch_scc1 L_comb_0
    s_waitcnt lgkmcnt(0)
L_pad1:
    s_cbranch_execz L_pad5
    s_barrier
L_comb_0b:
    s_cmp_eq_u32 s30, 6
    s_cbranch_scc0 L_skip_111
    s_waitcnt vmcnt(0)
L_skip_111:
    s_barrier
    s_cmp_lt_u32 s3, 20
    s_cbranch_scc0 L_typeB_0
    s_lshr_b32 s57, s30, 1
    s_lshl_b32 s57, s57, 5
    s_add_u32 s57, s57, s62
    s_add_u32 s59, s57, 55808
    v_and_b32 v5, 7, v0
    v_lshlrev_b32 v5, 2, v5
    v_lshrrev_b32 v22, 4, v0
    v_lshlrev_b32 v22, 3, v22
    buffer_load_dword v18, v5, s[40:43], s59 offen sc1
    buffer_load_dwordx2 v[20:21], v22, s[40:43], s59 offen sc1
    s_mul_i32 s57, s30, 6144
    v_lshrrev_b32 v7, 2, v0
    v_lshlrev_b32 v7, 6, v7
    v_bfe_u32 v60, v0, 4, 1
    v_lshl_add_u32 v7, v60, 5, v7
    v_and_b32 v60, 3, v0
    v_lshl_add_u32 v7, v60, 3, v7
    v_add_u32 v7, s57, v7
    v_add_u32 v7, 30720, v7
    v_xor_b32 v8, 32, v7
    s_mul_i32 s60, s30, 1536
    s_add_u32 s60, s60, s62
    s_add_u32 s60, s60, 0
    v_lshlrev_b32 v9, 4, v0
    v_lshlrev_b32 v10, 3, v0
    ds_read_b64_tr_b16 v[36:37], v7 offset:0
    ds_read_b64_tr_b16 v[38:39], v7 offset:1024
    ds_read_b64_tr_b16 v[40:41], v7 offset:2048
    ds_read_b64_tr_b16 v[42:43], v7 offset:3072
    ds_read_b64_tr_b16 v[44:45], v7 offset:4096
    ds_read_b64_tr_b16 v[46:47], v7 offset:5120
    ds_read_b64_tr_b16 v[48:49], v8 offset:0
    ds_read_b64_tr_b16 v[50:51], v8 offset:1024
    ds_read_b64_tr_b16 v[52:53], v8 offset:2048
    ds_read_b64_tr_b16 v[54:55], v8 offset:3072
    ds_read_b64_tr_b16 v[56:57], v8 offset:4096
    ds_read_b64_tr_b16 v[58:59], v8 offset:5120
    v_mov_b64 v[24:25], 0
    v_mov_b64 v[26:27], 0
    v_mov_b64 v[28:29], 0
    v_mov_b64 v[30:31], 0
    s_lshl_b32 s57, s30, 8
    v_lshlrev_b32 v11, 2, v0
    v_add_u32 v11, s57, v11
    v_add_u32 v11, 157696, v11
    v_lshlrev_b32 v32, 2, v0
    v_add_u32 v32, 157696, v32
    s_add_u32 s58, s6, 0
    s_add_u32 s57, s58, 16384
    v_and_b32 v33, 15, v0
    v_lshlrev_b32 v33, 2, v33
    v_lshrrev_b32 v60, 5, v0
    v_lshl_add_u32 v33, v60, 6, v33
    v_bfe_u32 v60, v0, 4, 1
    v_lshl_add_u32 v33, v60, 13, v33
    s_lshl_b32 s74, s3, 2
    s_add_u32 s74, s74, s62
    s_add_u32 s74, s74, 56064
    s_xor_b32 s75, s30, 3
    v_add_u32 v34, s75, v0
    v_lshlrev_b32 v34, 24, v34
    s_branch L_pw_112
L_pr_113:
    buffer_load_dword v18, v5, s[40:43], s59 offen sc1
    buffer_load_dwordx2 v[20:21], v22, s[40:43], s59 offen sc1
    s_sub_u32 s56, s56, 1
    s_cbranch_scc1 L_done
L_pw_112:
    s_waitcnt vmcnt(0)
    v_max3_u32 v19, v18, v20, v21
    v_cmp_eq_u32 vcc, -1, v19
    s_cbranch_vccnz L_pr_113
    buffer_load_dwordx4 v[12:15], v9, s[40:43], s60 offen sc1
    buffer_load_dwordx2 v[16:17], v10, s[40:43], s60 offen offset:1024 sc1
    v_max_f32_dpp v19, v18, v18 row_ror:4 row_mask:0xf bank_mask:0xf
    s_nop 1
    v_max_f32_dpp v19, v19, v19 row_ror:2 row_mask:0xf bank_mask:0xf
    s_nop 1
    v_max_f32_dpp v19, v19, v19 row_ror:1 row_mask:0xf bank_mask:0xf
    v_sub_f32 v18, v18, v19
    v_sub_f32 v20, v20, v19
    v_sub_f32 v21, v21, v19
    v_exp_f32 v18, v18
    v_exp_f32 v20, v20
    v_exp_f32 v21, v21
    v_add_f32_dpp v18, v18, v18 row_ror:4 row_mask:0xf bank_mask:0xf
L_pad2:
    s_cbranch_execz L_pad6
    s_nop 1
    v_add_f32_dpp v18, v18, v18 row_ror:2 row_mask:0xf bank_mask:0xf
    s_nop 1
    v_add_f32_dpp v18, v18, v18 row_ror:1 row_mask:0xf bank_mask:0xf
    v_rcp_f32 v18, v18
    s_nop 0
    v_mul_f32 v20, v20, v18
    v_mul_f32 v21, v21, v18
    s_waitcnt lgkmcnt(0)
    s_branch L_pw_114
L_pr_115:
    buffer_load_dwordx4 v[12:15], v9, s[40:43], s60 offen sc1
    buffer_load_dwordx2 v[16:17], v10, s[40:43], s60 offen offset:1024 sc1
    s_sub_u32 s56, s56, 1
    s_cbranch_scc1 L_done
L_pw_114:
    s_waitcnt vmcnt(0)
    v_max3_u32 v19, v12, v13, v14
    v_max3_u32 v19, v19, v15, v16
    v_max_u32 v19, v19, v17
    v_cmp_eq_u32 vcc, -1, v19
    s_cbranch_vccnz L_pr_115
    v_smfmac_f32_16x16x64_bf16 v[24:27], v[12:15], v[36:43], v1
    v_smfmac_f32_16x16x64_bf16 v[28:31], v[12:15], v[48:55], v1
    v_smfmac_f32_16x16x32_bf16 v[24:27], v[16:17], v[44:47], v1
    v_smfmac_f32_16x16x32_bf16 v[28:31], v[16:17], v[56:59], v1
    s_nop 6
    v_pk_add_f32 v[24:25], v[24:25], v[26:27]
    v_pk_add_f32 v[28:29], v[28:29], v[30:31]
    v_mul_f32 v24, v24, v20
    v_mul_f32 v28, v28, v20
    v_fmac_f32 v24, v25, v21
    v_fmac_f32 v28, v29, v21
    s_nop 1
    v_permlane32_swap_b32 v24, v28
    v_add_f32 v24, v24, v28
    ds_write_b32 v11, v24
    s_cmp_eq_u32 s30, 2
    s_cbranch_scc1 L_fin_116
    s_cmp_eq_u32 s55, 0
    s_waitcnt lgkmcnt(0)
    s_barrier
    s_cbranch_scc1 L_gs_118
    buffer_store_dword v0, v34, s[40:43], s74 offen
L_gb_119:
L_finb_117:
    s_sub_u32 s57, s30, 4
    s_cmp_lt_u32 s57, 3
    s_cbranch_scc0 L_skip_120
    s_sub_u32 s60, s30, 4
    s_lshl_b32 s59, s60, 12
    s_add_u32 s59, s59, 79872
    s_mov_b32 s44, s20
    s_mov_b32 s45, s21
    s_mov_b32 s46, 1966080
    s_mov_b32 s47, 0x20000
    s_mul_i32 s57, s31, 3
    s_add_u32 s57, s57, s60
    s_mul_i32 s57, s57, 81920
    s_lshl_b32 s58, s3, 6
    s_add_u32 s57, s57, s58
    v_lshrrev_b32 v5, 2, v0
    v_mul_u32_u24 v5, 1280, v5
    v_and_b32 v60, 3, v0
    v_lshl_add_u32 v5, v60, 4, v5
    v_add_u32 v5, s57, v5
    s_add_u32 m0, s59, 0
    s_mov_b32 s57, 0
    buffer_load_dwordx4 v5, s[44:47], s57 offen nt lds
    s_add_u32 m0, s59, 1024
    s_mov_b32 s57, 20480
    buffer_load_dwordx4 v5, s[44:47], s57 offen nt lds
    s_add_u32 m0, s59, 2048
    s_mov_b32 s57, 40960
    buffer_load_dwordx4 v5, s[44:47], s57 offen nt lds
    s_add_u32 m0, s59, 3072
    s_mov_b32 s57, 61440
    buffer_load_dwordx4 v5, s[44:47], s57 offen nt lds
    s_mul_i32 s57, s31, 3
    s_add_u32 s57, s57, s60
    s_lshl_b32 s57, s57, 7
    v_lshlrev_b32 v5, 1, v0
    v_add_u32 v5, s57, v5
    global_load_ushort v8, v5, s[18:19]
    s_lshl_b32 s57, s60, 11
    v_lshlrev_b32 v11, 4, v0
    v_add_u32 v11, s57, v11
    v_lshrrev_b32 v7, 4, v0
    v_lshlrev_b32 v7, 9, v7
    v_bfe_u32 v60, v0, 2, 2
    v_lshl_add_u32 v7, v60, 6, v7
    v_and_b32 v60, 3, v0
    v_lshl_add_u32 v7, v60, 3, v7
    v_add_u32 v7, s59, v7
    s_add_u32 s58, s62, 49152
L_pr_122:
L_pad3:
    s_cbranch_execz L_pad7
    buffer_load_dwordx4 v[12:15], v11, s[40:43], s58 offen offset:0 sc1
    buffer_load_dwordx4 v[16:19], v11, s[40:43], s58 offen offset:1024 sc1
    s_sub_u32 s56, s56, 1
    s_cbranch_scc1 L_done
L_pw_121:
    s_waitcnt vmcnt(0)
    v_max3_u32 v60, v12, v13, v14
    v_max3_u32 v60, v60, v15, v16
    v_max3_u32 v60, v60, v17, v18
    v_max_u32 v60, v60, v19
    v_cmp_eq_u32 vcc, -1, v60
    s_cbranch_vccnz L_pr_122
    ds_read_b64_tr_b16 v[36:37], v7 offset:0
    ds_read_b64_tr_b16 v[38:39], v7 offset:256
    ds_read_b64_tr_b16 v[40:41], v7 offset:2048
    ds_read_b64_tr_b16 v[42:43], v7 offset:2304
    ds_read_b64_tr_b16 v[44:45], v7 offset:32
    ds_read_b64_tr_b16 v[46:47], v7 offset:288
    ds_read_b64_tr_b16 v[48:49], v7 offset:2080
    ds_read_b64_tr_b16 v[50:51], v7 offset:2336
    v_pk_add_f32 v[20:21], v[12:13], v[14:15]
    v_pk_add_f32 v[22:23], v[16:17], v[18:19]
    v_pk_add_f32 v[20:21], v[20:21], v[22:23]
    v_add_f32 v4, v20, v21
    v_lshlrev_b32 v8, 16, v8
    v_mov_b64 v[52:53], 0
    v_mov_b64 v[54:55], 0
    v_mov_b64 v[56:57], 0
    v_mov_b64 v[58:59], 0
    v_mov_b32 v9, 0xbdd2d3e8
    v_mov_b32 v10, 0xc0135761
    s_lshl_b32 s57, s60, 7
    s_add_u32 s57, s57, 159872
    v_lshlrev_b32 v32, 3, v0
    v_add_u32 v32, s57, v32
    v_lshlrev_b32 v33, 3, v0
    v_add_u32 v33, 129024, v33
    v_cmp_gt_u32 vcc, 16, v0
    s_nop 1
    v_cndmask_b32 v32, v33, v32, vcc
    v_and_b32 v33, 15, v0
    v_lshlrev_b32 v33, 3, v33
    v_lshrrev_b32 v60, 5, v0
    v_lshl_add_u32 v33, v60, 2, v33
    v_add_u32 v33, 159872, v33
    v_and_b32 v34, 15, v0
    v_lshlrev_b32 v34, 2, v34
    v_lshrrev_b32 v60, 5, v0
    v_lshl_add_u32 v34, v60, 6, v34
    v_bfe_u32 v60, v0, 4, 1
    v_lshl_add_u32 v34, v60, 13, v34
    s_add_u32 s60, s6, 131072
    s_add_u32 s59, s60, 16384
    s_lshl_b32 s74, s3, 2
    s_add_u32 s74, s74, s62
    s_add_u32 s74, s74, 56192
    s_xor_b32 s75, s30, 4
    v_add_u32 v5, s75, v0
    v_lshlrev_b32 v5, 24, v5
    s_add_u32 s58, s62, 36864
    s_add_u32 s57, s62, 55552
    v_and_b32 v7, 7, v0
    v_lshlrev_b32 v7, 3, v7
    s_waitcnt lgkmcnt(0)
    buffer_load_dwordx2 v[24:25], v7, s[40:43], s57 offen sc1
    buffer_load_dwordx4 v[12:15], v11, s[40:43], s58 offen offset:0 sc1
    buffer_load_dwordx4 v[16:19], v11, s[40:43], s58 offen offset:1024 sc1
    s_sleep 2
L_pr_124:
    buffer_load_dwordx2 v[24:25], v7, s[40:43], s57 offen sc1
    buffer_load_dwordx4 v[12:15], v11, s[40:43], s58 offen offset:0 sc1
    buffer_load_dwordx4 v[16:19], v11, s[40:43], s58 offen offset:1024 sc1
    s_sub_u32 s56, s56, 1
    s_cbranch_scc1 L_done
L_pw_123:
    s_waitcnt vmcnt(5)
    v_max_u32 v26, v24, v25
    v_cmp_eq_u32 vcc, -1, v26
    s_cbranch_vccnz L_pr_124
    buffer_load_dwordx4 v[12:15], v11, s[40:43], s58 offen offset:0 sc1
    buffer_load_dwordx4 v[16:19], v11, s[40:43], s58 offen offset:1024 sc1
    v_add_f32_dpp v2, v24, v24 row_ror:4 row_mask:0xf bank_mask:0xf
    v_add_f32_dpp v3, v25, v25 row_ror:4 row_mask:0xf bank_mask:0xf
    s_nop 0
    v_add_f32_dpp v2, v2, v2 row_ror:2 row_mask:0xf bank_mask:0xf
    v_add_f32_dpp v3, v3, v3 row_ror:2 row_mask:0xf bank_mask:0xf
    s_nop 0
    v_add_f32_dpp v2, v2, v2 row_ror:1 row_mask:0xf bank_mask:0xf
L_pad4:
    s_cbranch_execz L_pad8
    v_add_f32_dpp v3, v3, v3 row_ror:1 row_mask:0xf bank_mask:0xf
    v_mul_f32 v2, 0x3acccccd, v2
    v_mul_f32 v3, 0x3acccccd, v3
    v_fma_f32 v3, -v2, v2, v3
    v_max_f32 v3, 0, v3
    v_add_f32 v3, 0x3727c5ac, v3
    v_rsq_f32 v3, v3
    s_nop 0
    v_mul_f32 v2, v2, v3
    v_fma_f32 v8, -v2, v4, v8
    s_waitcnt vmcnt(5)
L_hw_125:
    v_pk_add_f32 v[20:21], v[12:13], v[14:15]
    v_pk_add_f32 v[22:23], v[16:17], v[18:19]
    v_pk_add_f32 v[20:21], v[20:21], v[22:23]
    v_add_f32 v20, v20, v21
    v_cmp_u_f32 vcc, v20, v20
    v_fma_f32 v20, v20, v3, v8
    s_cbranch_vccnz L_hr_126
L_hk_127:
    v_mul_f32 v21, v20, v20
    v_fma_f32 v21, v21, v9, v10
    v_mul_f32 v21, v21, v20
    v_exp_f32 v21, v21
    s_cmp_eq_u32 s55, 0
    v_add_f32 v21, 1.0, v21
    v_rcp_f32 v21, v21
    s_nop 0
    v_mul_f32 v20, v20, v21
    s_nop 1
    v_mov_b32_dpp v21, v20 row_shl:1 row_mask:0xf bank_mask:0xf bound_ctrl:0
    v_cvt_pk_bf16_f32 v28, v20, v21
    s_nop 1
    v_mov_b32_dpp v29, v28 row_shl:4 row_mask:0xf bank_mask:0xf bound_ctrl:0
    v_mov_b32_dpp v30, v28 row_shl:8 row_mask:0xf bank_mask:0xf bound_ctrl:0
    v_mov_b32_dpp v31, v28 row_shl:12 row_mask:0xf bank_mask:0xf bound_ctrl:0
    s_nop 1
    v_smfmac_f32_16x16x64_bf16 v[52:55], v[28:31], v[36:43], v1
    v_smfmac_f32_16x16x64_bf16 v[56:59], v[28:31], v[44:51], v1
    s_nop 6
    v_add_f32 v22, v52, v54
    v_add_f32 v23, v56, v58
    ds_write_b64 v32, v[22:23]
    s_cmp_eq_u32 s30, 4
    s_cbranch_scc0 L_skip_129
L_xw_130:
    ds_read2_b32 v[20:21], v33 offset0:0 offset1:32
    ds_read_b32 v22, v33 offset:256
    s_cmp_eq_u32 s55, 0
    s_waitcnt lgkmcnt(0)
    v_max3_u32 v23, v20, v21, v22
    v_add_f32 v20, v20, v21
    v_cmp_eq_u32 vcc, -1, v23
    v_add_f32 v20, v20, v22
    s_cbranch_vccnz L_xr_131
    v_min_u32 v20, -2, v20
    buffer_store_dword v20, v34, s[40:43], s60 offen sc1
    s_cbranch_scc1 L_gs_132
    buffer_store_dword v0, v5, s[40:43], s74 offen
L_gb_133:
L_skip_129:
    s_waitcnt vmcnt(0)
L_skip_120:
    s_branch L_p1
L_typeB_0:
    s_cmp_eq_u32 s53, 3
    s_cbranch_scc0 L_p1
    s_cmp_eq_u32 s30, 7
    s_cbranch_scc1 L_w7_134
    s_cmp_lt_u32 s30, 6
    s_cbranch_scc0 L_skip_136
    s_lshr_b32 s57, s30, 1
    s_mul_i32 s57, s57, 128
    s_and_b32 s58, s30, 1
    s_lshl_b32 s58, s58, 6
    s_add_u32 s57, s57, s58
    v_lshrrev_b32 v18, 5, v0
    v_lshlrev_b32 v18, 13, v18
    v_bfe_u32 v60, v0, 3, 1
    v_lshl_add_u32 v18, v60, 12, v18
    v_bfe_u32 v60, v0, 4, 1
    v_lshl_add_u32 v18, v60, 11, v18
    v_bfe_u32 v60, v0, 2, 1
    v_mul_u32_u24 v60, 384, v60
    v_add_u32 v18, v60, v18
    v_and_b32 v60, 3, v0
    v_lshl_add_u32 v18, v60, 3, v18
    v_add_u32 v18, s57, v18
    v_add_u32 v18, 30720, v18
    v_bfe_u32 v19, v0, 4, 1
    v_lshlrev_b32 v19, 12, v19
    v_bfe_u32 v60, v0, 3, 1
    v_lshl_add_u32 v19, v60, 11, v19
    v_bfe_u32 v60, v0, 2, 1
    v_mul_u32_u24 v60, 384, v60
L_pad5:
    s_cbranch_execz L_pad9
    v_add_u32 v19, v60, v19
    v_and_b32 v60, 3, v0
    v_lshl_add_u32 v19, v60, 3, v19
    v_add_u32 v19, s57, v19
    v_add_u32 v19, 63488, v19
    ds_read_b64_tr_b16 v[36:37], v18 offset:0
    ds_read_b64_tr_b16 v[38:39], v18 offset:1024
    ds_read_b64_tr_b16 v[40:41], v18 offset:16384
    ds_read_b64_tr_b16 v[42:43], v18 offset:17408
    ds_read_b64_tr_b16 v[44:45], v19 offset:0
    ds_read_b64_tr_b16 v[46:47], v19 offset:1024
    ds_read_b64_tr_b16 v[48:49], v18 offset:32
    ds_read_b64_tr_b16 v[50:51], v18 offset:1056
    ds_read_b64_tr_b16 v[52:53], v18 offset:16416
    ds_read_b64_tr_b16 v[54:55], v18 offset:17440
    ds_read_b64_tr_b16 v[56:57], v19 offset:32
    ds_read_b64_tr_b16 v[58:59], v19 offset:1056
    v_lshrrev_b32 v32, 4, v0
    v_lshlrev_b32 v32, 5, v32
    v_bfe_u32 v60, v0, 1, 1
    v_lshl_add_u32 v32, v60, 4, v32
    v_and_b32 v60, 1, v0
    v_mul_u32_u24 v60, 192, v60
    v_add_u32 v32, v60, v32
    v_add_u32 v32, 160832, v32
    v_lshrrev_b32 v33, 4, v0
    v_lshlrev_b32 v33, 4, v33
    v_bfe_u32 v60, v0, 1, 1
    v_lshl_add_u32 v33, v60, 3, v33
    v_and_b32 v60, 1, v0
    v_mul_u32_u24 v60, 192, v60
    v_add_u32 v33, v60, v33
    v_add_u32 v33, 160960, v33
    v_mov_b64 v[24:25], 0
    v_mov_b64 v[26:27], 0
    v_mov_b64 v[28:29], 0
    v_mov_b64 v[30:31], 0
    s_lshr_b32 s57, s30, 1
    s_lshl_b32 s57, s57, 11
    s_and_b32 s58, s30, 1
    s_lshl_b32 s58, s58, 9
    s_add_u32 s57, s57, s58
    s_lshr_b32 s58, s54, 2
    s_lshl_b32 s58, s58, 10
    s_add_u32 s57, s57, s58
    s_and_b32 s58, s54, 3
    s_lshl_b32 s58, s58, 2
    s_add_u32 s57, s57, s58
    v_and_b32 v34, 31, v0
    v_lshlrev_b32 v34, 4, v34
    v_lshrrev_b32 v60, 5, v0
    v_lshl_add_u32 v34, v60, 30, v34
    v_add_u32 v34, s57, v34
    s_add_u32 s59, s62, 36864
    s_add_u32 s60, s62, 55552
    ds_read_b128 v[12:15], v32
    ds_read_b64 v[16:17], v33
    s_waitcnt lgkmcnt(1)
    v_smfmac_f32_16x16x64_bf16 v[24:27], v[12:15], v[36:43], v1
    v_smfmac_f32_16x16x64_bf16 v[28:31], v[12:15], v[48:55], v1
    s_waitcnt lgkmcnt(0)
    v_smfmac_f32_16x16x32_bf16 v[24:27], v[16:17], v[44:47], v1
    v_smfmac_f32_16x16x32_bf16 v[28:31], v[16:17], v[56:59], v1
    s_add_u32 s60, s62, 49152
    s_cmp_eq_u32 s55, 0
    s_nop 4
    v_add_f32 v12, v25, v27
    s_nop 1
    v_add_f32_dpp v12, v29, v31 quad_perm:[0,1,2,3] row_mask:0x2 bank_mask:0xf
    v_min_u32 v12, -2, v12
    s_cbranch_scc1 L_gs_137
    buffer_store_dword v12, v34, s[40:43], s60 offen
L_gb_138:
    v_mov_b64 v[24:25], 0
    v_mov_b64 v[26:27], 0
    v_mov_b64 v[28:29], 0
    v_mov_b64 v[30:31], 0
L_skip_136:
    s_cmp_lt_u32 s30, 6
    s_barrier
    s_cbranch_scc0 L_se_135
    ds_read_b128 v[12:15], v32
    ds_read_b64 v[16:17], v33
    s_waitcnt lgkmcnt(1)
    v_smfmac_f32_16x16x64_bf16 v[24:27], v[12:15], v[36:43], v1
    v_smfmac_f32_16x16x64_bf16 v[28:31], v[12:15], v[48:55], v1
    s_waitcnt lgkmcnt(0)
    v_smfmac_f32_16x16x32_bf16 v[24:27], v[16:17], v[44:47], v1
    v_smfmac_f32_16x16x32_bf16 v[28:31], v[16:17], v[56:59], v1
L_pad6:
    s_cbranch_execz L_pad10
    s_cmp_eq_u32 s55, 0
    s_nop 5
    v_add_f32 v12, v24, v26
    s_nop 1
    v_add_f32_dpp v12, v28, v30 quad_perm:[0,1,2,3] row_mask:0x2 bank_mask:0xf
    v_min_u32 v12, -2, v12
    s_cbranch_scc1 L_gs_139
    buffer_store_dword v12, v34, s[40:43], s59 offen
L_gb_140:
L_se_135:
L_p1:
    s_cmp_eq_u32 s30, 7
    s_cbranch_scc1 L_w7_148
    s_cmp_lt_u32 s30, 6
    s_cbranch_scc0 L_skip_150
    s_lshr_b32 s57, s30, 1
    s_mul_i32 s57, s57, 1024
    s_and_b32 s58, s30, 1
    s_lshl_b32 s58, s58, 6
    s_add_u32 s57, s57, s58
    v_lshrrev_b32 v18, 5, v0
    v_mul_u32_u24 v18, 6144, v18
    v_bfe_u32 v60, v0, 3, 1
    v_mul_u32_u24 v60, 3072, v60
    v_add_u32 v18, v60, v18
    v_bfe_u32 v60, v0, 4, 1
    v_lshl_add_u32 v18, v60, 9, v18
    v_bfe_u32 v60, v0, 2, 1
    v_lshl_add_u32 v18, v60, 7, v18
    v_and_b32 v60, 3, v0
    v_lshl_add_u32 v18, v60, 3, v18
    v_add_u32 v18, s57, v18
    v_bfe_u32 v19, v0, 4, 1
    v_mul_u32_u24 v19, 3072, v19
    v_bfe_u32 v60, v0, 3, 1
    v_lshl_add_u32 v19, v60, 9, v19
    v_bfe_u32 v60, v0, 2, 1
    v_lshl_add_u32 v19, v60, 7, v19
    v_and_b32 v60, 3, v0
    v_lshl_add_u32 v19, v60, 3, v19
    v_add_u32 v19, s57, v19
    v_add_u32 v19, 24576, v19
    ds_read_b64_tr_b16 v[36:37], v18 offset:0
    ds_read_b64_tr_b16 v[38:39], v18 offset:256
    ds_read_b64_tr_b16 v[40:41], v18 offset:12288
    ds_read_b64_tr_b16 v[42:43], v18 offset:12544
    ds_read_b64_tr_b16 v[44:45], v19 offset:0
    ds_read_b64_tr_b16 v[46:47], v19 offset:256
    ds_read_b64_tr_b16 v[48:49], v18 offset:32
    ds_read_b64_tr_b16 v[50:51], v18 offset:288
    ds_read_b64_tr_b16 v[52:53], v18 offset:12320
    ds_read_b64_tr_b16 v[54:55], v18 offset:12576
    ds_read_b64_tr_b16 v[56:57], v19 offset:32
    ds_read_b64_tr_b16 v[58:59], v19 offset:288
    v_lshrrev_b32 v32, 4, v0
    v_lshlrev_b32 v32, 5, v32
    v_bfe_u32 v60, v0, 1, 1
    v_lshl_add_u32 v32, v60, 4, v32
    v_and_b32 v60, 1, v0
    v_mul_u32_u24 v60, 192, v60
    v_add_u32 v32, v60, v32
    v_add_u32 v32, 160832, v32
    v_lshrrev_b32 v33, 4, v0
    v_lshlrev_b32 v33, 4, v33
    v_bfe_u32 v60, v0, 1, 1
    v_lshl_add_u32 v33, v60, 3, v33
    v_and_b32 v60, 1, v0
    v_mul_u32_u24 v60, 192, v60
    v_add_u32 v33, v60, v33
    v_add_u32 v33, 160960, v33
    v_mov_b64 v[24:25], 0
    v_mov_b64 v[26:27], 0
    v_mov_b64 v[28:29], 0
    v_mov_b64 v[30:31], 0
    s_lshr_b32 s57, s54, 1
    s_lshl_b32 s57, s57, 2
    s_and_b32 s58, s54, 1
    s_add_u32 s57, s57, s58
    s_lshl_b32 s57, s57, 4
    s_lshl_b32 s58, s30, 9
    s_add_u32 s57, s57, s58
    v_bfe_u32 v34, v0, 4, 1
    v_lshlrev_b32 v34, 8, v34
    v_bfe_u32 v60, v0, 1, 1
    v_lshl_add_u32 v34, v60, 5, v34
    v_bfe_u32 v60, v0, 2, 2
    v_lshl_add_u32 v34, v60, 2, v34
L_pad7:
    s_cbranch_execz L_pad11
    v_lshrrev_b32 v60, 5, v0
    v_lshl_add_u32 v34, v60, 29, v34
    v_and_b32 v60, 1, v0
    v_lshl_add_u32 v34, v60, 30, v34
    v_add_u32 v34, s57, v34
    s_mul_i32 s59, s53, 3072
    s_add_u32 s59, s59, s62
    s_add_u32 s59, s59, 24576
    s_lshl_b32 s60, s53, 6
    s_add_u32 s60, s60, s62
    s_add_u32 s60, s60, 55296
L_skip_150:
    s_cmp_lt_u32 s30, 6
    s_barrier
    s_cbranch_scc0 L_se_149
    ds_read_b128 v[12:15], v32
    ds_read_b64 v[16:17], v33
    s_waitcnt lgkmcnt(1)
    v_smfmac_f32_16x16x64_bf16 v[24:27], v[12:15], v[36:43], v1
    v_smfmac_f32_16x16x64_bf16 v[28:31], v[12:15], v[48:55], v1
    s_waitcnt lgkmcnt(0)
    v_smfmac_f32_16x16x32_bf16 v[24:27], v[16:17], v[44:47], v1
    v_smfmac_f32_16x16x32_bf16 v[28:31], v[16:17], v[56:59], v1
    s_cmp_eq_u32 s55, 0
    s_nop 5
    v_add_f32 v12, v24, v26
    s_nop 1
    v_add_f32_dpp v12, v28, v30 quad_perm:[0,1,2,3] row_mask:0x2 bank_mask:0xf
    s_nop 1
    v_mov_b32_dpp v13, v12 row_shl:1 row_mask:0xf bank_mask:0xf bound_ctrl:0
    v_cvt_pk_bf16_f32 v12, v12, v13
    v_min_u32 v12, -2, v12
    s_cbranch_scc1 L_gs_151
    buffer_store_dword v12, v34, s[40:43], s59 offen
L_gb_152:
L_se_149:
    v_lshlrev_b32 v5, 4, v0
    v_add_u32 v5, 124928, v5
    s_mul_i32 s59, s53, 3072
    s_add_u32 s59, s59, s62
    s_add_u32 s59, s59, 24576
    s_lshl_b32 s60, s53, 6
    s_add_u32 s60, s60, s62
    s_add_u32 s60, s60, 55296
    v_lshlrev_b32 v8, 4, v0
    s_cmp_eq_u32 s30, 2
    s_cbranch_scc1 L_q3_168
    s_cmp_eq_u32 s30, 3
    s_cbranch_scc1 L_q3_171
    s_cmp_eq_u32 s30, 1
    s_cbranch_scc0 L_qo_166
    buffer_load_dwordx4 v[12:15], v8, s[40:43], s59 offen offset:0 sc1
    v_mov_b64 v[24:25], 0
    v_mov_b64 v[26:27], 0
    v_mov_b64 v[28:29], 0
    v_mov_b64 v[30:31], 0
    v_mov_b64 v[32:33], 0
    v_mov_b64 v[34:35], 0
    v_mov_b64 v[36:37], 0
    v_mov_b64 v[38:39], 0
    v_mov_b64 v[40:41], 0
    v_mov_b64 v[42:43], 0
    v_mov_b64 v[44:45], 0
    v_mov_b64 v[46:47], 0
    v_mov_b64 v[48:49], 0
    v_mov_b64 v[50:51], 0
    v_mov_b64 v[52:53], 0
    v_mov_b64 v[54:55], 0
    v_mov_b64 v[56:57], 0
    v_mov_b64 v[58:59], 0
    v_mov_b64 v[60:61], 0
    v_mov_b64 v[62:63], 0
    s_lshl_b32 s58, s30, 3
    s_add_u32 s58, s58, 159808
    v_mov_b32 v11, s58
    v_lshlrev_b32 v10, 3, v0
    v_add_u32 v10, 157696, v10
    v_cmp_eq_u32 vcc, 63, v0
    s_nop 1
    v_cndmask_b32 v10, v10, v11, vcc
    s_lshl_b32 s57, s30, 12
    v_lshlrev_b32 v7, 4, v0
    v_add_u32 v7, s57, v7
    v_add_u32 v7, 92160, v7
    v_mov_b32 v11, 128000
L_pr_175:
    buffer_load_dwordx4 v[12:15], v8, s[40:43], s59 offen offset:0 sc1
    s_sub_u32 s56, s56, 1
    s_cbranch_scc1 L_done
L_pw_174:
    s_waitcnt vmcnt(1)
    v_max3_u32 v9, v12, v13, v14
    v_max_u32 v9, v9, v15
    v_cmp_eq_u32 vcc, -1, v9
    s_cbranch_vccnz L_pr_175
    ds_write_b128 v5, v[12:15] offset:0
L_qb_167:
    s_waitcnt lgkmcnt(0)
    s_barrier
    ds_read_b128 v[12:15], v5 offset:0
    ds_read_b128 v[16:19], v5 offset:1024
    ds_read_b128 v[20:23], v5 offset:2048
L_pad8:
    s_cbranch_execz L_pad12
    ds_read_b64 v[8:9], v11
    s_cmp_lt_u32 s30, 4
    s_waitcnt lgkmcnt(3)
    v_smfmac_f32_16x16x64_bf16 v[24:27], v[12:15], v[64:71], v1
    s_waitcnt lgkmcnt(2)
    v_smfmac_f32_16x16x64_bf16 v[24:27], v[16:19], v[72:79], v1
    s_waitcnt lgkmcnt(0)
    v_smfmac_f32_16x16x64_bf16 v[24:27], v[20:23], v[80:87], v1
    v_mul_f32 v8, v8, v6
    v_smfmac_f32_16x16x64_bf16 v[32:35], v[12:15], v[112:119], v1
    v_smfmac_f32_16x16x64_bf16 v[32:35], v[16:19], v[120:127], v1
    v_smfmac_f32_16x16x64_bf16 v[32:35], v[20:23], v[128:135], v1
    s_waitcnt vmcnt(0)
    v_smfmac_f32_16x16x64_bf16 v[28:31], v[12:15], v[88:95], v1
    v_smfmac_f32_16x16x64_bf16 v[28:31], v[16:19], v[96:103], v1
    v_smfmac_f32_16x16x64_bf16 v[28:31], v[20:23], v[104:111], v1
    v_smfmac_f32_16x16x64_bf16 v[36:39], v[12:15], v[136:143], v1
    v_pk_add_f32 v[24:25], v[24:25], v[26:27]
    v_add_f32 v24, v24, v25
    v_smfmac_f32_16x16x64_bf16 v[36:39], v[16:19], v[144:151], v1
    v_pk_add_f32 v[32:33], v[32:33], v[34:35]
    v_add_f32 v32, v32, v33
    v_smfmac_f32_16x16x64_bf16 v[36:39], v[20:23], v[152:159], v1
    s_nop 0
    v_permlane32_swap_b32 v24, v32
    v_add_f32 v24, v24, v32
    v_pk_add_f32 v[28:29], v[28:29], v[30:31]
    v_add_f32 v28, v28, v29
    s_nop 2
    v_pk_add_f32 v[36:37], v[36:37], v[38:39]
    v_add_f32 v36, v36, v37
    s_nop 1
    v_permlane32_swap_b32 v28, v36
    v_add_f32 v28, v28, v36
    s_nop 1
    v_permlane16_swap_b32 v24, v28
    v_add_f32 v24, v24, v28
    v_fma_f32 v24, v24, v9, v8
    s_mov_b32 vcc_lo, 0x55555555
    s_mov_b32 vcc_hi, 0x55555555
    v_max_f32_dpp v20, v24, v24 row_ror:8 row_mask:0xf bank_mask:0xf
    s_nop 1
    v_max_f32_dpp v20, v20, v20 row_ror:4 row_mask:0xf bank_mask:0xf
    s_nop 1
    v_max_f32_dpp v20, v20, v20 row_ror:2 row_mask:0xf bank_mask:0xf
    s_nop 1
    v_max_f32_dpp v20, v20, v20 row_ror:1 row_mask:0xf bank_mask:0xf
    s_nop 1
    v_max_f32_dpp v20, v20, v20 row_bcast:15 row_mask:0xa bank_mask:0xf
    s_nop 1
    v_max_f32_dpp v20, v20, v20 row_bcast:31 row_mask:0xc bank_mask:0xf
    s_nop 0
    v_readlane_b32 s57, v20, 63
    s_nop 1
    v_subrev_f32 v24, s57, v24
    v_exp_f32 v22, v24
    s_nop 1
    v_mov_b32_dpp v23, v22 row_shl:1 row_mask:0xf bank_mask:0xf bound_ctrl:0
    v_cvt_pk_bf16_f32 v23, v22, v23
    v_cndmask_b32 v12, 0, v23, vcc
    v_add_f32_dpp v21, v22, v22 row_ror:8 row_mask:0xf bank_mask:0xf
    s_nop 0
    v_mov_b32_dpp v13, v12 row_shl:4 row_mask:0xf bank_mask:0xf bound_ctrl:0
    v_mov_b32_dpp v14, v12 row_shl:8 row_mask:0xf bank_mask:0xf bound_ctrl:0
    v_mov_b32_dpp v15, v12 row_shl:12 row_mask:0xf bank_mask:0xf bound_ctrl:0
    v_add_f32_dpp v21, v21, v21 row_ror:4 row_mask:0xf bank_mask:0xf
    v_mov_b32_dpp v16, v12 row_shr:1 row_mask:0xf bank_mask:0xf bound_ctrl:0
    v_smfmac_f32_16x16x64_bf16 v[40:43], v[12:15], v[160:167], v1
    v_add_f32_dpp v21, v21, v21 row_ror:2 row_mask:0xf bank_mask:0xf
    v_mov_b32_dpp v17, v12 row_shl:3 row_mask:0xf bank_mask:0xf bound_ctrl:0
    v_smfmac_f32_16x16x64_bf16 v[44:47], v[12:15], v[176:183], v1
    v_add_f32_dpp v21, v21, v21 row_ror:1 row_mask:0xf bank_mask:0xf
    v_mov_b32_dpp v18, v12 row_shl:7 row_mask:0xf bank_mask:0xf bound_ctrl:0
    v_smfmac_f32_16x16x64_bf16 v[48:51], v[12:15], v[192:199], v1
    v_add_f32_dpp v21, v21, v21 row_bcast:15 row_mask:0xa bank_mask:0xf
    v_mov_b32_dpp v19, v12 row_shl:11 row_mask:0xf bank_mask:0xf bound_ctrl:0
    v_smfmac_f32_16x16x64_bf16 v[52:55], v[12:15], v[208:215], v1
    v_add_f32_dpp v21, v21, v21 row_bcast:31 row_mask:0xc bank_mask:0xf
    ds_write_b64 v10, v[20:21]
    v_smfmac_f32_16x16x64_bf16 v[40:43], v[16:19], v[168:175], v1
L_pad9:
    s_cbranch_execz L_pad13
    s_nop 1
    v_smfmac_f32_16x16x64_bf16 v[44:47], v[16:19], v[184:191], v1
    s_nop 1
    v_smfmac_f32_16x16x64_bf16 v[48:51], v[16:19], v[200:207], v1
    s_nop 1
    v_smfmac_f32_16x16x64_bf16 v[52:55], v[16:19], v[216:223], v1
    v_pk_add_f32 v[24:25], v[40:41], v[42:43]
    s_nop 0
    v_smfmac_f32_16x16x64_bf16 v[56:59], v[12:15], v[224:231], v1
    v_pk_add_f32 v[26:27], v[44:45], v[46:47]
    ds_write_b128 v7, v[24:27] offset:0
    v_smfmac_f32_16x16x64_bf16 v[60:63], v[12:15], v[240:247], v1
    v_pk_add_f32 v[28:29], v[48:49], v[50:51]
    s_nop 0
    v_smfmac_f32_16x16x64_bf16 v[56:59], v[16:19], v[232:239], v1
    v_pk_add_f32 v[30:31], v[52:53], v[54:55]
    ds_write_b128 v7, v[28:31] offset:1024
    v_smfmac_f32_16x16x64_bf16 v[60:63], v[16:19], v[248:255], v1
    s_cmp_lt_u32 s30, 2
    s_mov_b64 exec, 0xffff
    s_nop 2
    v_pk_add_f32 v[32:33], v[56:57], v[58:59]
    s_nop 1
    v_pk_add_f32 v[34:35], v[60:61], v[62:63]
    ds_write_b128 v7, v[32:35] offset:2048
    s_mov_b64 exec, -1
    s_cbranch_scc1 L_comb_1
    s_waitcnt lgkmcnt(0)
    s_barrier
L_comb_1b:
    s_cmp_lt_u32 s3, 20
    s_cbranch_scc0 L_typeB_1
    s_lshr_b32 s57, s30, 1
    s_lshl_b32 s57, s57, 5
    s_add_u32 s57, s57, s62
    s_add_u32 s59, s57, 55936
    v_and_b32 v5, 7, v0
    v_lshlrev_b32 v5, 2, v5
    v_lshrrev_b32 v22, 4, v0
    v_lshlrev_b32 v22, 3, v22
    buffer_load_dword v18, v5, s[40:43], s59 offen sc1
    buffer_load_dwordx2 v[20:21], v22, s[40:43], s59 offen sc1
    s_mul_i32 s57, s30, 6144
    v_lshrrev_b32 v7, 2, v0
    v_lshlrev_b32 v7, 6, v7
    v_bfe_u32 v60, v0, 4, 1
    v_lshl_add_u32 v7, v60, 5, v7
    v_and_b32 v60, 3, v0
    v_lshl_add_u32 v7, v60, 3, v7
    v_add_u32 v7, s57, v7
    v_add_u32 v7, 30720, v7
    v_xor_b32 v8, 32, v7
    s_mul_i32 s60, s30, 1536
    s_add_u32 s60, s60, s62
    s_add_u32 s60, s60, 12288
    v_lshlrev_b32 v9, 4, v0
    v_lshlrev_b32 v10, 3, v0
    ds_read_b64_tr_b16 v[36:37], v7 offset:0
    ds_read_b64_tr_b16 v[38:39], v7 offset:1024
    ds_read_b64_tr_b16 v[40:41], v7 offset:2048
    ds_read_b64_tr_b16 v[42:43], v7 offset:3072
    ds_read_b64_tr_b16 v[44:45], v7 offset:4096
    ds_read_b64_tr_b16 v[46:47], v7 offset:5120
    ds_read_b64_tr_b16 v[48:49], v8 offset:0
    ds_read_b64_tr_b16 v[50:51], v8 offset:1024
    ds_read_b64_tr_b16 v[52:53], v8 offset:2048
    ds_read_b64_tr_b16 v[54:55], v8 offset:3072
    ds_read_b64_tr_b16 v[56:57], v8 offset:4096
    ds_read_b64_tr_b16 v[58:59], v8 offset:5120
    v_mov_b64 v[24:25], 0
    v_mov_b64 v[26:27], 0
    v_mov_b64 v[28:29], 0
    v_mov_b64 v[30:31], 0
    s_lshl_b32 s57, s30, 8
    v_lshlrev_b32 v11, 2, v0
    v_add_u32 v11, s57, v11
    v_add_u32 v11, 157696, v11
    v_lshlrev_b32 v32, 2, v0
    v_add_u32 v32, 157696, v32
    s_add_u32 s58, s6, 262144
    s_add_u32 s57, s58, 16384
    v_and_b32 v33, 15, v0
    v_lshlrev_b32 v33, 2, v33
    v_lshrrev_b32 v60, 5, v0
L_pad10:
    s_cbranch_execz L_pad14
    v_lshl_add_u32 v33, v60, 6, v33
    v_bfe_u32 v60, v0, 4, 1
    v_lshl_add_u32 v33, v60, 13, v33
    s_lshl_b32 s74, s3, 2
    s_add_u32 s74, s74, s62
    s_add_u32 s74, s74, 56320
    s_xor_b32 s75, s30, 3
    v_add_u32 v34, s75, v0
    v_lshlrev_b32 v34, 24, v34
    s_branch L_pw_184
L_pr_185:
    buffer_load_dword v18, v5, s[40:43], s59 offen sc1
    buffer_load_dwordx2 v[20:21], v22, s[40:43], s59 offen sc1
    s_sub_u32 s56, s56, 1
    s_cbranch_scc1 L_done
L_pw_184:
    s_waitcnt vmcnt(0)
    v_max3_u32 v19, v18, v20, v21
    v_cmp_eq_u32 vcc, -1, v19
    s_cbranch_vccnz L_pr_185
    buffer_load_dwordx4 v[12:15], v9, s[40:43], s60 offen sc1
    buffer_load_dwordx2 v[16:17], v10, s[40:43], s60 offen offset:1024 sc1
    v_max_f32_dpp v19, v18, v18 row_ror:4 row_mask:0xf bank_mask:0xf
    s_nop 1
    v_max_f32_dpp v19, v19, v19 row_ror:2 row_mask:0xf bank_mask:0xf
    s_nop 1
    v_max_f32_dpp v19, v19, v19 row_ror:1 row_mask:0xf bank_mask:0xf
    v_sub_f32 v18, v18, v19
    v_sub_f32 v20, v20, v19
    v_sub_f32 v21, v21, v19
    v_exp_f32 v18, v18
    v_exp_f32 v20, v20
    v_exp_f32 v21, v21
    v_add_f32_dpp v18, v18, v18 row_ror:4 row_mask:0xf bank_mask:0xf
    s_nop 1
    v_add_f32_dpp v18, v18, v18 row_ror:2 row_mask:0xf bank_mask:0xf
    s_nop 1
    v_add_f32_dpp v18, v18, v18 row_ror:1 row_mask:0xf bank_mask:0xf
    v_rcp_f32 v18, v18
    s_nop 0
    v_mul_f32 v20, v20, v18
    v_mul_f32 v21, v21, v18
    s_waitcnt lgkmcnt(0)
    s_branch L_pw_186
L_pr_187:
    buffer_load_dwordx4 v[12:15], v9, s[40:43], s60 offen sc1
    buffer_load_dwordx2 v[16:17], v10, s[40:43], s60 offen offset:1024 sc1
    s_sub_u32 s56, s56, 1
    s_cbranch_scc1 L_done
L_pw_186:
    s_waitcnt vmcnt(0)
    v_max3_u32 v19, v12, v13, v14
    v_max3_u32 v19, v19, v15, v16
    v_max_u32 v19, v19, v17
    v_cmp_eq_u32 vcc, -1, v19
    s_cbranch_vccnz L_pr_187
    v_smfmac_f32_16x16x64_bf16 v[24:27], v[12:15], v[36:43], v1
    v_smfmac_f32_16x16x64_bf16 v[28:31], v[12:15], v[48:55], v1
    v_smfmac_f32_16x16x32_bf16 v[24:27], v[16:17], v[44:47], v1
    v_smfmac_f32_16x16x32_bf16 v[28:31], v[16:17], v[56:59], v1
    s_nop 6
    v_pk_add_f32 v[24:25], v[24:25], v[26:27]
    v_pk_add_f32 v[28:29], v[28:29], v[30:31]
    v_mul_f32 v24, v24, v20
    v_mul_f32 v28, v28, v20
    v_fmac_f32 v24, v25, v21
    v_fmac_f32 v28, v29, v21
    s_nop 1
    v_permlane32_swap_b32 v24, v28
    v_add_f32 v24, v24, v28
    ds_write_b32 v11, v24
    s_cmp_eq_u32 s30, 2
    s_cbranch_scc1 L_fin_188
    s_cmp_eq_u32 s55, 0
    s_waitcnt lgkmcnt(0)
    s_barrier
    s_cbranch_scc1 L_gs_190
    buffer_store_dword v0, v34, s[40:43], s74 offen
L_gb_191:
L_finb_189:
    s_sub_u32 s57, s30, 4
    s_cmp_lt_u32 s57, 3
    s_cbranch_scc0 L_skip_192
    s_sub_u32 s60, s30, 4
    s_lshl_b32 s59, s60, 12
    s_add_u32 s59, s59, 79872
    s_mul_i32 s57, s31, 3
    s_add_u32 s57, s57, s60
    s_lshl_b32 s57, s57, 7
    v_lshlrev_b32 v5, 1, v0
    v_add_u32 v5, s57, v5
    global_load_ushort v8, v5, s[18:19]
    s_lshl_b32 s57, s60, 11
    v_lshlrev_b32 v11, 4, v0
    v_add_u32 v11, s57, v11
    v_lshrrev_b32 v7, 4, v0
    v_lshlrev_b32 v7, 9, v7
    v_bfe_u32 v60, v0, 2, 2
    v_lshl_add_u32 v7, v60, 6, v7
    v_and_b32 v60, 3, v0
    v_lshl_add_u32 v7, v60, 3, v7
L_pad11:
    s_cbranch_execz L_pad15
    v_add_u32 v7, s59, v7
    s_add_u32 s58, s62, 49152
L_pr_194:
    buffer_load_dwordx4 v[12:15], v11, s[40:43], s58 offen offset:0 sc1
    buffer_load_dwordx4 v[16:19], v11, s[40:43], s58 offen offset:1024 sc1
    s_sub_u32 s56, s56, 1
    s_cbranch_scc1 L_done
L_pw_193:
    s_waitcnt vmcnt(0)
    v_max3_u32 v60, v12, v13, v14
    v_max3_u32 v60, v60, v15, v16
    v_max3_u32 v60, v60, v17, v18
    v_max_u32 v60, v60, v19
    v_cmp_eq_u32 vcc, -1, v60
    s_cbranch_vccnz L_pr_194
    ds_read_b64_tr_b16 v[36:37], v7 offset:0
    ds_read_b64_tr_b16 v[38:39], v7 offset:256
    ds_read_b64_tr_b16 v[40:41], v7 offset:2048
    ds_read_b64_tr_b16 v[42:43], v7 offset:2304
    ds_read_b64_tr_b16 v[44:45], v7 offset:32
    ds_read_b64_tr_b16 v[46:47], v7 offset:288
    ds_read_b64_tr_b16 v[48:49], v7 offset:2080
    ds_read_b64_tr_b16 v[50:51], v7 offset:2336
    v_pk_add_f32 v[20:21], v[12:13], v[14:15]
    v_pk_add_f32 v[22:23], v[16:17], v[18:19]
    v_pk_add_f32 v[20:21], v[20:21], v[22:23]
    v_add_f32 v4, v20, v21
    v_lshlrev_b32 v8, 16, v8
    v_mov_b64 v[52:53], 0
    v_mov_b64 v[54:55], 0
    v_mov_b64 v[56:57], 0
    v_mov_b64 v[58:59], 0
    v_mov_b32 v9, 0xbdd2d3e8
    v_mov_b32 v10, 0xc0135761
    s_lshl_b32 s57, s60, 7
    s_add_u32 s57, s57, 160256
    v_lshlrev_b32 v32, 3, v0
    v_add_u32 v32, s57, v32
    v_lshlrev_b32 v33, 3, v0
    v_add_u32 v33, 129024, v33
    v_cmp_gt_u32 vcc, 16, v0
    s_nop 1
    v_cndmask_b32 v32, v33, v32, vcc
    v_and_b32 v33, 15, v0
    v_lshlrev_b32 v33, 3, v33
    v_lshrrev_b32 v60, 5, v0
    v_lshl_add_u32 v33, v60, 2, v33
    v_add_u32 v33, 160256, v33
    v_and_b32 v34, 15, v0
    v_lshlrev_b32 v34, 2, v34
    v_lshrrev_b32 v60, 5, v0
    v_lshl_add_u32 v34, v60, 6, v34
    v_bfe_u32 v60, v0, 4, 1
    v_lshl_add_u32 v34, v60, 13, v34
    s_add_u32 s60, s6, 393216
    s_add_u32 s59, s60, 16384
    s_lshl_b32 s74, s3, 2
    s_add_u32 s74, s74, s62
    s_add_u32 s74, s74, 56448
    s_xor_b32 s75, s30, 4
    v_add_u32 v5, s75, v0
    v_lshlrev_b32 v5, 24, v5
    s_add_u32 s58, s62, 43008
    s_add_u32 s57, s62, 55680
    v_and_b32 v7, 7, v0
    v_lshlrev_b32 v7, 3, v7
    s_waitcnt lgkmcnt(0)
    buffer_load_dwordx2 v[24:25], v7, s[40:43], s57 offen sc1
    buffer_load_dwordx4 v[12:15], v11, s[40:43], s58 offen offset:0 sc1
    buffer_load_dwordx4 v[16:19], v11, s[40:43], s58 offen offset:1024 sc1
    s_sleep 2
L_pr_196:
    buffer_load_dwordx2 v[24:25], v7, s[40:43], s57 offen sc1
    buffer_load_dwordx4 v[12:15], v11, s[40:43], s58 offen offset:0 sc1
    buffer_load_dwordx4 v[16:19], v11, s[40:43], s58 offen offset:1024 sc1
    s_sub_u32 s56, s56, 1
    s_cbranch_scc1 L_done
L_pw_195:
    s_waitcnt vmcnt(5)
    v_max_u32 v26, v24, v25
    v_cmp_eq_u32 vcc, -1, v26
    s_cbranch_vccnz L_pr_196
    buffer_load_dwordx4 v[12:15], v11, s[40:43], s58 offen offset:0 sc1
    buffer_load_dwordx4 v[16:19], v11, s[40:43], s58 offen offset:1024 sc1
    v_add_f32_dpp v2, v24, v24 row_ror:4 row_mask:0xf bank_mask:0xf
    v_add_f32_dpp v3, v25, v25 row_ror:4 row_mask:0xf bank_mask:0xf
    s_nop 0
    v_add_f32_dpp v2, v2, v2 row_ror:2 row_mask:0xf bank_mask:0xf
    v_add_f32_dpp v3, v3, v3 row_ror:2 row_mask:0xf bank_mask:0xf
L_pad12:
    s_cbranch_execz L_pad16
    s_nop 0
    v_add_f32_dpp v2, v2, v2 row_ror:1 row_mask:0xf bank_mask:0xf
    v_add_f32_dpp v3, v3, v3 row_ror:1 row_mask:0xf bank_mask:0xf
    v_mul_f32 v2, 0x3acccccd, v2
    v_mul_f32 v3, 0x3acccccd, v3
    v_fma_f32 v3, -v2, v2, v3
    v_max_f32 v3, 0, v3
    v_add_f32 v3, 0x3727c5ac, v3
    v_rsq_f32 v3, v3
    s_nop 0
    v_mul_f32 v2, v2, v3
    v_fma_f32 v8, -v2, v4, v8
    s_waitcnt vmcnt(5)
L_hw_197:
    v_pk_add_f32 v[20:21], v[12:13], v[14:15]
    v_pk_add_f32 v[22:23], v[16:17], v[18:19]
    v_pk_add_f32 v[20:21], v[20:21], v[22:23]
    v_add_f32 v20, v20, v21
    v_cmp_u_f32 vcc, v20, v20
    v_fma_f32 v20, v20, v3, v8
    s_cbranch_vccnz L_hr_198
L_hk_199:
    v_mul_f32 v21, v20, v20
    v_fma_f32 v21, v21, v9, v10
    v_mul_f32 v21, v21, v20
    v_exp_f32 v21, v21
    s_cmp_eq_u32 s55, 0
    v_add_f32 v21, 1.0, v21
    v_rcp_f32 v21, v21
    s_nop 0
    v_mul_f32 v20, v20, v21
    s_nop 1
    v_mov_b32_dpp v21, v20 row_shl:1 row_mask:0xf bank_mask:0xf bound_ctrl:0
    v_cvt_pk_bf16_f32 v28, v20, v21
    s_nop 1
    v_mov_b32_dpp v29, v28 row_shl:4 row_mask:0xf bank_mask:0xf bound_ctrl:0
    v_mov_b32_dpp v30, v28 row_shl:8 row_mask:0xf bank_mask:0xf bound_ctrl:0
    v_mov_b32_dpp v31, v28 row_shl:12 row_mask:0xf bank_mask:0xf bound_ctrl:0
    s_nop 1
    v_smfmac_f32_16x16x64_bf16 v[52:55], v[28:31], v[36:43], v1
    v_smfmac_f32_16x16x64_bf16 v[56:59], v[28:31], v[44:51], v1
    s_nop 6
    v_add_f32 v22, v52, v54
    v_add_f32 v23, v56, v58
    ds_write_b64 v32, v[22:23]
    s_cmp_eq_u32 s30, 4
    s_cbranch_scc0 L_skip_201
L_xw_202:
    ds_read2_b32 v[20:21], v33 offset0:0 offset1:32
    ds_read_b32 v22, v33 offset:256
    s_cmp_eq_u32 s55, 0
    s_waitcnt lgkmcnt(0)
    v_max3_u32 v23, v20, v21, v22
    v_add_f32 v20, v20, v21
    v_cmp_eq_u32 vcc, -1, v23
    v_add_f32 v20, v20, v22
    s_cbranch_vccnz L_xr_203
    v_min_u32 v20, -2, v20
    buffer_store_dword v20, v34, s[40:43], s60 offen sc1
    s_cbranch_scc1 L_gs_204
    buffer_store_dword v0, v5, s[40:43], s74 offen
L_gb_205:
L_skip_201:
L_skip_192:
    s_branch L_done
L_typeB_1:
    s_cmp_eq_u32 s53, 3
    s_cbranch_scc0 L_done
    s_cmp_eq_u32 s30, 7
    s_cbranch_scc1 L_w7_206
    s_cmp_lt_u32 s30, 6
    s_cbranch_scc0 L_skip_208
    s_lshr_b32 s57, s30, 1
    s_mul_i32 s57, s57, 128
    s_and_b32 s58, s30, 1
    s_lshl_b32 s58, s58, 6
    s_add_u32 s57, s57, s58
    v_lshrrev_b32 v18, 5, v0
    v_lshlrev_b32 v18, 13, v18
    v_bfe_u32 v60, v0, 3, 1
    v_lshl_add_u32 v18, v60, 12, v18
    v_bfe_u32 v60, v0, 4, 1
    v_lshl_add_u32 v18, v60, 11, v18
    v_bfe_u32 v60, v0, 2, 1
    v_mul_u32_u24 v60, 384, v60
    v_add_u32 v18, v60, v18
    v_and_b32 v60, 3, v0
    v_lshl_add_u32 v18, v60, 3, v18
    v_add_u32 v18, s57, v18
    v_add_u32 v18, 30720, v18
    v_bfe_u32 v19, v0, 4, 1
    v_lshlrev_b32 v19, 12, v19
    v_bfe_u32 v60, v0, 3, 1
    v_lshl_add_u32 v19, v60, 11, v19
    v_bfe_u32 v60, v0, 2, 1
L_pad13:
    s_cbranch_execz L_pad17
    v_mul_u32_u24 v60, 384, v60
    v_add_u32 v19, v60, v19
    v_and_b32 v60, 3, v0
    v_lshl_add_u32 v19, v60, 3, v19
    v_add_u32 v19, s57, v19
    v_add_u32 v19, 63488, v19
    ds_read_b64_tr_b16 v[36:37], v18 offset:0
    ds_read_b64_tr_b16 v[38:39], v18 offset:1024
    ds_read_b64_tr_b16 v[40:41], v18 offset:16384
    ds_read_b64_tr_b16 v[42:43], v18 offset:17408
    ds_read_b64_tr_b16 v[44:45], v19 offset:0
    ds_read_b64_tr_b16 v[46:47], v19 offset:1024
    ds_read_b64_tr_b16 v[48:49], v18 offset:32
    ds_read_b64_tr_b16 v[50:51], v18 offset:1056
    ds_read_b64_tr_b16 v[52:53], v18 offset:16416
    ds_read_b64_tr_b16 v[54:55], v18 offset:17440
    ds_read_b64_tr_b16 v[56:57], v19 offset:32
    ds_read_b64_tr_b16 v[58:59], v19 offset:1056
    v_lshrrev_b32 v32, 4, v0
    v_lshlrev_b32 v32, 5, v32
    v_bfe_u32 v60, v0, 1, 1
    v_lshl_add_u32 v32, v60, 4, v32
    v_and_b32 v60, 1, v0
    v_mul_u32_u24 v60, 192, v60
    v_add_u32 v32, v60, v32
    v_add_u32 v32, 160832, v32
    v_lshrrev_b32 v33, 4, v0
    v_lshlrev_b32 v33, 4, v33
    v_bfe_u32 v60, v0, 1, 1
    v_lshl_add_u32 v33, v60, 3, v33
    v_and_b32 v60, 1, v0
    v_mul_u32_u24 v60, 192, v60
    v_add_u32 v33, v60, v33
    v_add_u32 v33, 160960, v33
    v_mov_b64 v[24:25], 0
    v_mov_b64 v[26:27], 0
    v_mov_b64 v[28:29], 0
    v_mov_b64 v[30:31], 0
    s_lshr_b32 s57, s30, 1
    s_lshl_b32 s57, s57, 11
    s_and_b32 s58, s30, 1
    s_lshl_b32 s58, s58, 9
    s_add_u32 s57, s57, s58
    s_lshr_b32 s58, s54, 2
    s_lshl_b32 s58, s58, 10
    s_add_u32 s57, s57, s58
    s_and_b32 s58, s54, 3
    s_lshl_b32 s58, s58, 2
    s_add_u32 s57, s57, s58
    v_and_b32 v34, 31, v0
    v_lshlrev_b32 v34, 4, v34
    v_lshrrev_b32 v60, 5, v0
    v_lshl_add_u32 v34, v60, 30, v34
    v_add_u32 v34, s57, v34
    s_add_u32 s59, s62, 43008
    s_add_u32 s60, s62, 55680
L_skip_208:
    s_cmp_lt_u32 s30, 6
    s_barrier
    s_cbranch_scc0 L_se_207
    ds_read_b128 v[12:15], v32
    ds_read_b64 v[16:17], v33
    s_waitcnt lgkmcnt(1)
    v_smfmac_f32_16x16x64_bf16 v[24:27], v[12:15], v[36:43], v1
    v_smfmac_f32_16x16x64_bf16 v[28:31], v[12:15], v[48:55], v1
    s_waitcnt lgkmcnt(0)
    v_smfmac_f32_16x16x32_bf16 v[24:27], v[16:17], v[44:47], v1
    v_smfmac_f32_16x16x32_bf16 v[28:31], v[16:17], v[56:59], v1
    s_cmp_eq_u32 s55, 0
    s_nop 5
    v_add_f32 v12, v24, v26
    s_nop 1
    v_add_f32_dpp v12, v28, v30 quad_perm:[0,1,2,3] row_mask:0x2 bank_mask:0xf
    v_min_u32 v12, -2, v12
    s_cbranch_scc1 L_gs_209
    buffer_store_dword v12, v34, s[40:43], s59 offen
L_gb_210:
L_se_207:
    s_cmp_eq_u32 s30, 7
    s_cbranch_scc0 L_done
    s_cmp_eq_u32 s31, 0
    s_cbranch_scc0 L_done
    v_lshlrev_b32 v60, 16, v4
    v_add_f32 v2, v2, v60
    v_and_b32 v60, 0xffff0000, v4
    v_add_f32 v3, v3, v60
    v_and_b32 v60, 31, v0
    v_min_u32 v60, 19, v60
    s_mul_i32 s57, s54, 160
    v_lshrrev_b32 v7, 5, v0
    v_lshlrev_b32 v7, 2, v7
    v_add_u32 v7, s57, v7
    v_lshl_add_u32 v7, v60, 3, v7
L_pad14:
    s_cbranch_execz L_pad18
    s_add_u32 s57, s7, 393216
    s_add_u32 s58, s7, 425984
    s_add_u32 s59, s7, 458752
    s_add_u32 s60, s7, 491520
    s_add_u32 s75, s62, 56448
    v_min_u32 v9, 19, v0
    v_lshlrev_b32 v9, 2, v9
    buffer_load_dword v12, v9, s[40:43], s75 offen sc1
    s_sleep 2
L_pr_222:
    buffer_load_dword v12, v9, s[40:43], s75 offen sc1
    s_sub_u32 s56, s56, 1
    s_cbranch_scc1 L_done
L_pw_221:
    s_waitcnt vmcnt(1)
    v_cmp_eq_u32 vcc, -1, v12
    s_cbranch_vccnz L_pr_222
    buffer_load_dwordx4 v[12:15], v5, s[40:43], s57 offen sc1
    buffer_load_dwordx4 v[16:19], v5, s[40:43], s58 offen sc1
    buffer_load_dwordx4 v[20:23], v5, s[40:43], s59 offen sc1
    buffer_load_dwordx4 v[24:27], v5, s[40:43], s60 offen sc1
    s_sleep 2
L_gw_218:
    buffer_load_dwordx4 v[12:15], v5, s[40:43], s57 offen sc1
    buffer_load_dwordx4 v[16:19], v5, s[40:43], s58 offen sc1
    buffer_load_dwordx4 v[20:23], v5, s[40:43], s59 offen sc1
    buffer_load_dwordx4 v[24:27], v5, s[40:43], s60 offen sc1
    s_sub_u32 s56, s56, 1
    s_cbranch_scc1 L_done
    s_and_b32 s74, s56, 31
    s_waitcnt vmcnt(6)
    v_pk_add_f32 v[28:29], v[12:13], v[16:17]
    v_pk_add_f32 v[30:31], v[14:15], v[18:19]
    s_waitcnt vmcnt(5)
    v_pk_add_f32 v[28:29], v[28:29], v[20:21]
    v_pk_add_f32 v[30:31], v[30:31], v[22:23]
    s_waitcnt vmcnt(4)
    v_pk_add_f32 v[28:29], v[28:29], v[24:25]
    v_pk_add_f32 v[30:31], v[30:31], v[26:27]
    v_pk_add_f32 v[32:33], v[28:29], v[30:31]
    v_cmp_u_f32 vcc, v32, v33
    v_permlane32_swap_b32 v28, v30
    v_permlane32_swap_b32 v29, v31
    s_cbranch_vccnz L_gr_219
L_gk_220:
    v_pk_add_f32 v[28:29], v[28:29], v[30:31]
    v_pk_add_f32 v[28:29], v[28:29], v[2:3]
    v_cvt_pk_bf16_f32 v28, v28, v29
    global_store_dword v7, v28, s[24:25]
    s_branch L_done
L_gs_28:
    buffer_store_dword v33, v34, s[40:43], s67 offen sc1
    s_branch L_gb_29
L_gs_31:
    buffer_store_dword v12, v34, s[40:43], s59 offen sc1
    s_branch L_gb_32
L_cr_43:
    s_sub_u32 s56, s56, 1
    s_cbranch_scc1 L_done
    global_load_dword v2, v3, s[26:27] sc1
    s_waitcnt vmcnt(0)
    s_branch L_cw_42
L_far_44:
    s_lshl_b32 s57, s52, 2
    s_add_u32 s57, s57, s72
    s_mov_b64 exec, 1
    buffer_store_dword v25, v0, s[40:43], s57 offen offset:128 sc1
    s_mov_b64 exec, -1
    s_branch L_fb_45
L_cr_57:
    s_sub_u32 s56, s56, 1
    s_cbranch_scc1 L_done
    buffer_load_dword v2, v24, s[40:43], s72 offen sc1
    s_branch L_cw_56
L_gs_64:
    buffer_store_dword v33, v34, s[40:43], s67 offen sc1
    s_branch L_gb_65
L_gs_67:
    buffer_store_dword v12, v34, s[40:43], s59 offen sc1
    s_branch L_gb_68
L_gs_89:
    buffer_store_dword v22, v23, s[40:43], s57 offen sc1
    s_branch L_gb_90
L_cr_100:
    s_sub_u32 s56, s56, 1
    s_cbranch_scc1 L_done
    global_load_dword v2, v3, s[26:27] offset:4 sc1
    s_branch L_cw_99
L_gs_109:
    buffer_store_dword v56, v3, s[40:43], s57 offen sc1
    s_branch L_gb_110
L_comb_0:
    s_mov_b32 s57, 0
    s_cmp_eq_u32 s55, 0
    s_waitcnt lgkmcnt(0)
    s_barrier
    ds_read2st64_b64 v[40:43], v2 offset0:0 offset1:8
    ds_read2st64_b64 v[44:47], v2 offset0:16 offset1:24
    ds_read2st64_b64 v[48:51], v2 offset0:32 offset1:40
    ds_read2st64_b64 v[52:55], v2 offset0:48 offset1:56
    s_waitcnt lgkmcnt(3)
    v_pk_mul_f32 v[56:57], v[40:41], s[64:65] op_sel:[0,0] op_sel_hi:[1,0]
L_pad15:
    s_cbranch_execz L_pad19
    v_pk_mul_f32 v[58:59], v[42:43], s[64:65] op_sel:[0,1] op_sel_hi:[1,1]
    s_waitcnt lgkmcnt(2)
    v_pk_fma_f32 v[56:57], v[44:45], s[66:67], v[56:57] op_sel:[0,0,0] op_sel_hi:[1,0,1]
    v_pk_fma_f32 v[58:59], v[46:47], s[66:67], v[58:59] op_sel:[0,1,0] op_sel_hi:[1,1,1]
    s_waitcnt lgkmcnt(1)
    v_pk_fma_f32 v[56:57], v[48:49], s[68:69], v[56:57] op_sel:[0,0,0] op_sel_hi:[1,0,1]
    v_pk_fma_f32 v[58:59], v[50:51], s[68:69], v[58:59] op_sel:[0,1,0] op_sel_hi:[1,1,1]
    s_waitcnt lgkmcnt(0)
    v_pk_fma_f32 v[56:57], v[52:53], s[70:71], v[56:57] op_sel:[0,0,0] op_sel_hi:[1,0,1]
    v_pk_fma_f32 v[58:59], v[54:55], s[70:71], v[58:59] op_sel:[0,1,0] op_sel_hi:[1,1,1]
    v_pk_add_f32 v[56:57], v[56:57], v[58:59]
    v_cvt_pk_bf16_f32 v56, v56, v57
    v_min_u32 v56, -2, v56
    s_cbranch_scc1 L_gs_109
    buffer_store_dword v56, v3, s[40:43], s57 offen
L_gb_110:
    s_branch L_comb_0b
L_gs_118:
    buffer_store_dword v0, v34, s[40:43], s74 offen sc1
    s_branch L_gb_119
L_fin_116:
    s_cmp_eq_u32 s55, 0
    s_waitcnt lgkmcnt(0)
    s_barrier
    ds_read2st64_b32 v[12:13], v32 offset0:0 offset1:1
    ds_read2st64_b32 v[14:15], v32 offset0:2 offset1:3
    ds_read2st64_b32 v[16:17], v32 offset0:4 offset1:5
    ds_read2st64_b32 v[18:19], v32 offset0:6 offset1:7
    s_waitcnt lgkmcnt(2)
    v_pk_add_f32 v[12:13], v[12:13], v[14:15]
    s_waitcnt lgkmcnt(0)
    v_pk_add_f32 v[16:17], v[16:17], v[18:19]
    v_pk_add_f32 v[12:13], v[12:13], v[16:17]
    v_add_f32 v14, v12, v13
    v_add_f32 v15, v12, v13
    s_nop 1
    v_permlane16_swap_b32 v14, v15
    v_add_f32 v12, v14, v15
    v_min_u32 v12, -2, v12
    buffer_store_dword v12, v33, s[40:43], s58 offen sc1
    s_branch L_finb_117
L_hr_126:
    s_sub_u32 s56, s56, 1
    s_cbranch_scc1 L_done
    s_and_b32 s64, s56, 15
    s_cbranch_scc1 L_ha_128
    s_waitcnt vmcnt(0)
    v_max3_u32 v21, v12, v13, v14
    v_max3_u32 v21, v21, v15, v16
    v_max3_u32 v21, v21, v17, v18
    v_max_u32 v21, v21, v19
    v_cmp_eq_u32 vcc, -1, v21
    s_cbranch_vccnz L_ha_128
    v_pk_add_f32 v[20:21], v[12:13], v[14:15]
    v_pk_add_f32 v[22:23], v[16:17], v[18:19]
    v_pk_add_f32 v[20:21], v[20:21], v[22:23]
    v_add_f32 v20, v20, v21
    v_fma_f32 v20, v20, v3, v8
    s_branch L_hk_127
L_ha_128:
    buffer_load_dwordx4 v[12:15], v11, s[40:43], s58 offen offset:0 sc1
    buffer_load_dwordx4 v[16:19], v11, s[40:43], s58 offen offset:1024 sc1
    s_waitcnt vmcnt(2)
    s_branch L_hw_125
L_xr_131:
    s_sub_u32 s56, s56, 1
    s_cbranch_scc1 L_done
    s_branch L_xw_130
L_gs_132:
    buffer_store_dword v0, v5, s[40:43], s74 offen sc1
    s_branch L_gb_133
L_gs_137:
    buffer_store_dword v12, v34, s[40:43], s60 offen sc1
    s_branch L_gb_138
L_gs_139:
    buffer_store_dword v12, v34, s[40:43], s59 offen sc1
    s_branch L_gb_140
L_gr_142:
    s_cbranch_scc1 L_gw_141
    s_waitcnt vmcnt(0)
    v_max3_u32 v32, v12, v13, v14
    v_max3_u32 v32, v32, v15, v16
    v_max3_u32 v32, v32, v17, v18
    v_max3_u32 v32, v32, v19, v20
    v_max3_u32 v32, v32, v21, v22
    v_max3_u32 v32, v32, v23, v24
    v_max3_u32 v32, v32, v25, v26
    v_max_u32 v32, v32, v27
    v_cmp_eq_u32 vcc, -1, v32
    s_cbranch_vccnz L_gw_141
    v_pk_add_f32 v[28:29], v[12:13], v[16:17]
    v_pk_add_f32 v[30:31], v[14:15], v[18:19]
    v_pk_add_f32 v[28:29], v[28:29], v[20:21]
    v_pk_add_f32 v[30:31], v[30:31], v[22:23]
L_pad16:
    s_cbranch_execz L_pad20
    v_pk_add_f32 v[28:29], v[28:29], v[24:25]
    v_pk_add_f32 v[30:31], v[30:31], v[26:27]
    s_nop 1
    v_permlane32_swap_b32 v28, v30
    v_permlane32_swap_b32 v29, v31
    s_branch L_gk_143
L_gs_146:
    buffer_store_dword v33, v34, s[40:43], s67 offen sc1
    s_branch L_gb_147
L_w7_134:
    v_and_b32 v60, 31, v0
    v_min_u32 v60, 19, v60
    s_mul_i32 s57, s54, 320
    v_lshrrev_b32 v5, 5, v0
    v_mul_u32_u24 v5, 2560, v5
    v_add_u32 v5, s57, v5
    v_lshl_add_u32 v5, v60, 4, v5
    v_and_b32 v60, 31, v0
    v_cmp_gt_u32 s[64:65], 20, v60
    v_min_u32 v60, 19, v60
    v_lshrrev_b32 v35, 5, v0
    v_lshlrev_b32 v35, 2, v35
    v_add_u32 v35, 160832, v35
    v_lshl_add_u32 v35, v60, 3, v35
    s_add_u32 s66, s62, 36864
    s_add_u32 s67, s62, 55552
    s_lshl_b32 s57, s54, 3
    v_lshrrev_b32 v34, 5, v0
    v_lshlrev_b32 v34, 2, v34
    v_add_u32 v34, s57, v34
    v_and_b32 v60, 31, v0
    v_mov_b32 v61, 0x7f000000
    v_cmp_ne_u32 vcc, 31, v60
    s_nop 1
    v_cndmask_b32 v34, v34, v61, vcc
    v_mov_b32 v61, 0x3f803f80
    s_add_u32 s57, s7, 0
    s_add_u32 s58, s7, 32768
    s_add_u32 s59, s7, 65536
    s_add_u32 s60, s7, 98304
    s_add_u32 s75, s62, 56064
    v_min_u32 v9, 19, v0
    v_lshlrev_b32 v9, 2, v9
    buffer_load_dword v12, v9, s[40:43], s75 offen sc1
    s_sleep 2
L_pr_145:
    buffer_load_dword v12, v9, s[40:43], s75 offen sc1
    s_sub_u32 s56, s56, 1
    s_cbranch_scc1 L_done
L_pw_144:
    s_waitcnt vmcnt(1)
    v_cmp_eq_u32 vcc, -1, v12
    s_cbranch_vccnz L_pr_145
    buffer_load_dwordx4 v[12:15], v5, s[40:43], s57 offen sc1
    buffer_load_dwordx4 v[16:19], v5, s[40:43], s58 offen sc1
    buffer_load_dwordx4 v[20:23], v5, s[40:43], s59 offen sc1
    buffer_load_dwordx4 v[24:27], v5, s[40:43], s60 offen sc1
    s_sleep 2
L_gw_141:
    buffer_load_dwordx4 v[12:15], v5, s[40:43], s57 offen sc1
    buffer_load_dwordx4 v[16:19], v5, s[40:43], s58 offen sc1
    buffer_load_dwordx4 v[20:23], v5, s[40:43], s59 offen sc1
    buffer_load_dwordx4 v[24:27], v5, s[40:43], s60 offen sc1
    s_sub_u32 s56, s56, 1
    s_cbranch_scc1 L_done
    s_and_b32 s74, s56, 31
    s_waitcnt vmcnt(6)
    v_pk_add_f32 v[28:29], v[12:13], v[16:17]
    v_pk_add_f32 v[30:31], v[14:15], v[18:19]
    s_waitcnt vmcnt(5)
    v_pk_add_f32 v[28:29], v[28:29], v[20:21]
    v_pk_add_f32 v[30:31], v[30:31], v[22:23]
    s_waitcnt vmcnt(4)
    v_pk_add_f32 v[28:29], v[28:29], v[24:25]
    v_pk_add_f32 v[30:31], v[30:31], v[26:27]
    v_pk_add_f32 v[32:33], v[28:29], v[30:31]
    v_cmp_u_f32 vcc, v32, v33
    v_permlane32_swap_b32 v28, v30
    v_permlane32_swap_b32 v29, v31
    s_cbranch_vccnz L_gr_142
L_gk_143:
    v_pk_add_f32 v[28:29], v[28:29], v[30:31]
    v_pk_add_f32 v[28:29], v[28:29], v[2:3]
    v_cvt_pk_bf16_f32 v28, v28, v29
    ds_write_b32 v35, v28
    s_waitcnt lgkmcnt(0)
    s_barrier
    v_cndmask_b32 v29, 0, v28, s[64:65]
    v_dot2_f32_bf16 v33, v29, v61, 0
    v_dot2_f32_bf16 v62, v29, v29, 0
    v_lshlrev_b32 v2, 16, v28
    v_and_b32 v3, 0xffff0000, v28
L_pad17:
    s_cbranch_execz L_pad21
    s_cmp_eq_u32 s55, 0
    v_permlane32_swap_b32 v33, v62
    v_add_f32 v33, v33, v62
    s_nop 1
    v_add_f32_dpp v33, v33, v33 row_ror:8 row_mask:0xf bank_mask:0xf
    s_nop 1
    v_add_f32_dpp v33, v33, v33 row_ror:4 row_mask:0xf bank_mask:0xf
    s_nop 1
    v_add_f32_dpp v33, v33, v33 row_ror:2 row_mask:0xf bank_mask:0xf
    s_nop 1
    v_add_f32_dpp v33, v33, v33 row_ror:1 row_mask:0xf bank_mask:0xf
    s_nop 1
    v_add_f32_dpp v33, v33, v33 row_bcast:15 row_mask:0xa bank_mask:0xf
    v_min_u32 v33, -2, v33
    s_cbranch_scc1 L_gs_146
    buffer_store_dword v33, v34, s[40:43], s67 offen
L_gb_147:
    s_waitcnt vmcnt(1)
    s_branch L_se_135
L_gs_151:
    buffer_store_dword v12, v34, s[40:43], s59 offen sc1
    s_branch L_gb_152
L_gr_157:
    s_cbranch_scc1 L_gw_156
    s_waitcnt vmcnt(0)
    v_max3_u32 v32, v12, v13, v14
    v_max3_u32 v32, v32, v15, v16
    v_max3_u32 v32, v32, v17, v18
    v_max3_u32 v32, v32, v19, v20
    v_max3_u32 v32, v32, v21, v22
    v_max3_u32 v32, v32, v23, v24
    v_max3_u32 v32, v32, v25, v26
    v_max_u32 v32, v32, v27
    v_cmp_eq_u32 vcc, -1, v32
    s_cbranch_vccnz L_gw_156
    v_pk_add_f32 v[28:29], v[12:13], v[16:17]
    v_pk_add_f32 v[30:31], v[14:15], v[18:19]
    v_pk_add_f32 v[28:29], v[28:29], v[20:21]
    v_pk_add_f32 v[30:31], v[30:31], v[22:23]
    v_pk_add_f32 v[28:29], v[28:29], v[24:25]
    v_pk_add_f32 v[30:31], v[30:31], v[26:27]
    s_nop 1
    v_permlane32_swap_b32 v28, v30
    v_permlane32_swap_b32 v29, v31
    s_branch L_gk_158
L_gr_160:
    s_cbranch_scc1 L_gw_159
    s_waitcnt vmcnt(0)
    v_max3_u32 v32, v12, v13, v14
    v_max3_u32 v32, v32, v15, v16
    v_max3_u32 v32, v32, v17, v18
    v_max3_u32 v32, v32, v19, v20
    v_max3_u32 v32, v32, v21, v22
    v_max3_u32 v32, v32, v23, v24
    v_max3_u32 v32, v32, v25, v26
    v_max_u32 v32, v32, v27
    v_cmp_eq_u32 vcc, -1, v32
    s_cbranch_vccnz L_gw_159
    v_pk_add_f32 v[28:29], v[12:13], v[16:17]
    v_pk_add_f32 v[30:31], v[14:15], v[18:19]
    v_pk_add_f32 v[28:29], v[28:29], v[20:21]
    v_pk_add_f32 v[30:31], v[30:31], v[22:23]
    v_pk_add_f32 v[28:29], v[28:29], v[24:25]
    v_pk_add_f32 v[30:31], v[30:31], v[26:27]
    s_nop 1
    v_permlane32_swap_b32 v28, v30
    v_permlane32_swap_b32 v29, v31
    s_branch L_gk_161
L_gs_164:
    buffer_store_dword v33, v34, s[40:43], s67 offen sc1
    s_branch L_gb_165
L_w7_148:
    v_and_b32 v60, 31, v0
    v_min_u32 v60, 19, v60
    s_mul_i32 s57, s54, 320
    v_lshrrev_b32 v5, 5, v0
    v_mul_u32_u24 v5, 2560, v5
    v_add_u32 v5, s57, v5
    v_lshl_add_u32 v5, v60, 4, v5
    v_and_b32 v60, 31, v0
    v_cmp_gt_u32 s[64:65], 20, v60
    v_min_u32 v60, 19, v60
    v_lshrrev_b32 v35, 5, v0
    v_lshlrev_b32 v35, 2, v35
    v_add_u32 v35, 160832, v35
    v_lshl_add_u32 v35, v60, 3, v35
    s_mul_i32 s66, s53, 3072
    s_add_u32 s66, s66, s62
    s_add_u32 s66, s66, 24576
    s_lshl_b32 s67, s53, 6
L_pad18:
    s_cbranch_execz L_pad22
    s_add_u32 s67, s67, s62
    s_add_u32 s67, s67, 55296
    s_lshl_b32 s57, s54, 3
    v_lshrrev_b32 v34, 5, v0
    v_lshlrev_b32 v34, 2, v34
    v_add_u32 v34, s57, v34
    v_and_b32 v60, 31, v0
    v_mov_b32 v61, 0x7f000000
    v_cmp_ne_u32 vcc, 31, v60
    s_nop 1
    v_cndmask_b32 v34, v34, v61, vcc
    v_mov_b32 v61, 0x3f803f80
    s_cmp_lg_u32 s53, 3
    s_cbranch_scc0 L_skip_153
    s_add_u32 s57, s62, 55552
    v_mov_b32 v9, 0
L_pr_155:
    buffer_load_dword v12, v9, s[40:43], s57 offen sc1
    s_sub_u32 s56, s56, 1
    s_cbranch_scc1 L_done
L_pw_154:
    s_waitcnt vmcnt(0)
    v_cmp_eq_u32 vcc, -1, v12
    s_cbranch_vccnz L_pr_155
    s_add_u32 s57, s7, 0
    s_add_u32 s58, s7, 32768
    s_add_u32 s59, s7, 65536
    s_add_u32 s60, s7, 98304
L_gw_156:
    buffer_load_dwordx4 v[12:15], v5, s[40:43], s57 offen sc1
    buffer_load_dwordx4 v[16:19], v5, s[40:43], s58 offen sc1
    buffer_load_dwordx4 v[20:23], v5, s[40:43], s59 offen sc1
    buffer_load_dwordx4 v[24:27], v5, s[40:43], s60 offen sc1
    s_sub_u32 s56, s56, 1
    s_cbranch_scc1 L_done
    s_and_b32 s74, s56, 31
    s_waitcnt vmcnt(2)
    v_pk_add_f32 v[28:29], v[12:13], v[16:17]
    v_pk_add_f32 v[30:31], v[14:15], v[18:19]
    s_waitcnt vmcnt(1)
    v_pk_add_f32 v[28:29], v[28:29], v[20:21]
    v_pk_add_f32 v[30:31], v[30:31], v[22:23]
    s_waitcnt vmcnt(0)
    v_pk_add_f32 v[28:29], v[28:29], v[24:25]
    v_pk_add_f32 v[30:31], v[30:31], v[26:27]
    v_pk_add_f32 v[32:33], v[28:29], v[30:31]
    v_cmp_u_f32 vcc, v32, v33
    v_permlane32_swap_b32 v28, v30
    v_permlane32_swap_b32 v29, v31
    s_cbranch_vccnz L_gr_157
L_gk_158:
    v_pk_add_f32 v[28:29], v[28:29], v[30:31]
    v_pk_add_f32 v[28:29], v[28:29], v[2:3]
    v_cvt_pk_bf16_f32 v28, v28, v29
    v_lshlrev_b32 v2, 16, v28
    v_and_b32 v3, 0xffff0000, v28
L_skip_153:
    v_lshlrev_b32 v60, 16, v4
    v_add_f32 v2, v2, v60
    v_and_b32 v60, 0xffff0000, v4
    v_add_f32 v3, v3, v60
    s_add_u32 s57, s7, 131072
    s_add_u32 s58, s7, 163840
    s_add_u32 s59, s7, 196608
    s_add_u32 s60, s7, 229376
    s_add_u32 s75, s62, 56192
    v_min_u32 v9, 19, v0
    v_lshlrev_b32 v9, 2, v9
    buffer_load_dword v12, v9, s[40:43], s75 offen sc1
    s_sleep 2
L_pr_163:
    buffer_load_dword v12, v9, s[40:43], s75 offen sc1
    s_sub_u32 s56, s56, 1
    s_cbranch_scc1 L_done
L_pw_162:
    s_waitcnt vmcnt(1)
    v_cmp_eq_u32 vcc, -1, v12
    s_cbranch_vccnz L_pr_163
    buffer_load_dwordx4 v[12:15], v5, s[40:43], s57 offen sc1
    buffer_load_dwordx4 v[16:19], v5, s[40:43], s58 offen sc1
    buffer_load_dwordx4 v[20:23], v5, s[40:43], s59 offen sc1
    buffer_load_dwordx4 v[24:27], v5, s[40:43], s60 offen sc1
    s_sleep 2
L_gw_159:
    buffer_load_dwordx4 v[12:15], v5, s[40:43], s57 offen sc1
    buffer_load_dwordx4 v[16:19], v5, s[40:43], s58 offen sc1
    buffer_load_dwordx4 v[20:23], v5, s[40:43], s59 offen sc1
    buffer_load_dwordx4 v[24:27], v5, s[40:43], s60 offen sc1
    s_sub_u32 s56, s56, 1
    s_cbranch_scc1 L_done
    s_and_b32 s74, s56, 31
    s_waitcnt vmcnt(6)
    v_pk_add_f32 v[28:29], v[12:13], v[16:17]
    v_pk_add_f32 v[30:31], v[14:15], v[18:19]
L_pad19:
    s_cbranch_execz L_pad23
    s_waitcnt vmcnt(5)
    v_pk_add_f32 v[28:29], v[28:29], v[20:21]
    v_pk_add_f32 v[30:31], v[30:31], v[22:23]
    s_waitcnt vmcnt(4)
    v_pk_add_f32 v[28:29], v[28:29], v[24:25]
    v_pk_add_f32 v[30:31], v[30:31], v[26:27]
    v_pk_add_f32 v[32:33], v[28:29], v[30:31]
    v_cmp_u_f32 vcc, v32, v33
    v_permlane32_swap_b32 v28, v30
    v_permlane32_swap_b32 v29, v31
    s_cbranch_vccnz L_gr_160
L_gk_161:
    v_pk_add_f32 v[28:29], v[28:29], v[30:31]
    v_pk_add_f32 v[28:29], v[28:29], v[2:3]
    v_cvt_pk_bf16_f32 v28, v28, v29
    ds_write_b32 v35, v28
    s_waitcnt lgkmcnt(0)
    s_barrier
    v_cndmask_b32 v29, 0, v28, s[64:65]
    v_dot2_f32_bf16 v33, v29, v61, 0
    v_dot2_f32_bf16 v62, v29, v29, 0
    v_lshlrev_b32 v2, 16, v28
    v_and_b32 v3, 0xffff0000, v28
    s_cmp_eq_u32 s55, 0
    v_permlane32_swap_b32 v33, v62
    v_add_f32 v33, v33, v62
    s_nop 1
    v_add_f32_dpp v33, v33, v33 row_ror:8 row_mask:0xf bank_mask:0xf
    s_nop 1
    v_add_f32_dpp v33, v33, v33 row_ror:4 row_mask:0xf bank_mask:0xf
    s_nop 1
    v_add_f32_dpp v33, v33, v33 row_ror:2 row_mask:0xf bank_mask:0xf
    s_nop 1
    v_add_f32_dpp v33, v33, v33 row_ror:1 row_mask:0xf bank_mask:0xf
    s_nop 1
    v_add_f32_dpp v33, v33, v33 row_bcast:15 row_mask:0xa bank_mask:0xf
    v_min_u32 v33, -2, v33
    s_cbranch_scc1 L_gs_164
    buffer_store_dword v33, v34, s[40:43], s67 offen
L_gb_165:
    s_waitcnt vmcnt(1)
    s_branch L_se_149
L_q3_168:
    buffer_load_dwordx4 v[16:19], v8, s[40:43], s59 offen offset:1024 sc1
    v_mov_b64 v[24:25], 0
    v_mov_b64 v[26:27], 0
    v_mov_b64 v[28:29], 0
    v_mov_b64 v[30:31], 0
    v_mov_b64 v[32:33], 0
    v_mov_b64 v[34:35], 0
    v_mov_b64 v[36:37], 0
    v_mov_b64 v[38:39], 0
    v_mov_b64 v[40:41], 0
    v_mov_b64 v[42:43], 0
    v_mov_b64 v[44:45], 0
    v_mov_b64 v[46:47], 0
    v_mov_b64 v[48:49], 0
    v_mov_b64 v[50:51], 0
    v_mov_b64 v[52:53], 0
    v_mov_b64 v[54:55], 0
    v_mov_b64 v[56:57], 0
    v_mov_b64 v[58:59], 0
    v_mov_b64 v[60:61], 0
    v_mov_b64 v[62:63], 0
    s_lshl_b32 s58, s30, 3
    s_add_u32 s58, s58, 159808
    v_mov_b32 v11, s58
    v_lshlrev_b32 v10, 3, v0
    v_add_u32 v10, 157696, v10
    v_cmp_eq_u32 vcc, 63, v0
    s_nop 1
    v_cndmask_b32 v10, v10, v11, vcc
    s_lshl_b32 s57, s30, 12
    v_lshlrev_b32 v7, 4, v0
    v_add_u32 v7, s57, v7
    v_add_u32 v7, 92160, v7
    v_mov_b32 v11, 128000
L_pr_170:
    buffer_load_dwordx4 v[16:19], v8, s[40:43], s59 offen offset:1024 sc1
    s_sub_u32 s56, s56, 1
    s_cbranch_scc1 L_done
L_pw_169:
    s_waitcnt vmcnt(1)
    v_max3_u32 v9, v16, v17, v18
    v_max_u32 v9, v9, v19
    v_cmp_eq_u32 vcc, -1, v9
    s_cbranch_vccnz L_pr_170
    ds_write_b128 v5, v[16:19] offset:1024
    s_branch L_qb_167
L_q3_171:
    buffer_load_dwordx4 v[20:23], v8, s[40:43], s59 offen offset:2048 sc1
    v_mov_b64 v[24:25], 0
    v_mov_b64 v[26:27], 0
    v_mov_b64 v[28:29], 0
    v_mov_b64 v[30:31], 0
    v_mov_b64 v[32:33], 0
    v_mov_b64 v[34:35], 0
    v_mov_b64 v[36:37], 0
    v_mov_b64 v[38:39], 0
    v_mov_b64 v[40:41], 0
    v_mov_b64 v[42:43], 0
    v_mov_b64 v[44:45], 0
    v_mov_b64 v[46:47], 0
    v_mov_b64 v[48:49], 0
    v_mov_b64 v[50:51], 0
L_pad20:
    s_cbranch_execz L_pad24
    v_mov_b64 v[52:53], 0
    v_mov_b64 v[54:55], 0
    v_mov_b64 v[56:57], 0
    v_mov_b64 v[58:59], 0
    v_mov_b64 v[60:61], 0
    v_mov_b64 v[62:63], 0
    s_lshl_b32 s58, s30, 3
    s_add_u32 s58, s58, 159808
    v_mov_b32 v11, s58
    v_lshlrev_b32 v10, 3, v0
    v_add_u32 v10, 157696, v10
    v_cmp_eq_u32 vcc, 63, v0
    s_nop 1
    v_cndmask_b32 v10, v10, v11, vcc
    s_lshl_b32 s57, s30, 12
    v_lshlrev_b32 v7, 4, v0
    v_add_u32 v7, s57, v7
    v_add_u32 v7, 92160, v7
    v_mov_b32 v11, 128000
L_pr_173:
    buffer_load_dwordx4 v[20:23], v8, s[40:43], s59 offen offset:2048 sc1
    s_sub_u32 s56, s56, 1
    s_cbranch_scc1 L_done
L_pw_172:
    s_waitcnt vmcnt(1)
    v_max3_u32 v9, v20, v21, v22
    v_max_u32 v9, v9, v23
    v_cmp_eq_u32 vcc, -1, v9
    s_cbranch_vccnz L_pr_173
    ds_write_b128 v5, v[20:23] offset:2048
    s_branch L_qb_167
L_qo_166:
    v_mov_b64 v[24:25], 0
    v_mov_b64 v[26:27], 0
    v_mov_b64 v[28:29], 0
    v_mov_b64 v[30:31], 0
    v_mov_b64 v[32:33], 0
    v_mov_b64 v[34:35], 0
    v_mov_b64 v[36:37], 0
    v_mov_b64 v[38:39], 0
    v_mov_b64 v[40:41], 0
    v_mov_b64 v[42:43], 0
    v_mov_b64 v[44:45], 0
    v_mov_b64 v[46:47], 0
    v_mov_b64 v[48:49], 0
    v_mov_b64 v[50:51], 0
    v_mov_b64 v[52:53], 0
    v_mov_b64 v[54:55], 0
    v_mov_b64 v[56:57], 0
    v_mov_b64 v[58:59], 0
    v_mov_b64 v[60:61], 0
    v_mov_b64 v[62:63], 0
    s_lshl_b32 s58, s30, 3
    s_add_u32 s58, s58, 159808
    v_mov_b32 v11, s58
    v_lshlrev_b32 v10, 3, v0
    v_add_u32 v10, 157696, v10
    v_cmp_eq_u32 vcc, 63, v0
    s_nop 1
    v_cndmask_b32 v10, v10, v11, vcc
    s_lshl_b32 s57, s30, 12
    v_lshlrev_b32 v7, 4, v0
    v_add_u32 v7, s57, v7
    v_add_u32 v7, 92160, v7
    v_mov_b32 v11, 128000
    s_cmp_eq_u32 s30, 6
    s_cbranch_scc0 L_qb_167
    v_and_b32 v16, 7, v0
    v_lshlrev_b32 v16, 3, v16
L_pr_177:
    buffer_load_dwordx2 v[8:9], v16, s[40:43], s60 offen sc1
    s_sub_u32 s56, s56, 1
    s_cbranch_scc1 L_done
L_pw_176:
    s_waitcnt vmcnt(0)
    v_max_u32 v18, v8, v9
    v_cmp_eq_u32 vcc, -1, v18
    s_cbranch_vccnz L_pr_177
    v_add_f32_dpp v8, v8, v8 row_ror:4 row_mask:0xf bank_mask:0xf
    v_add_f32_dpp v9, v9, v9 row_ror:4 row_mask:0xf bank_mask:0xf
    s_nop 0
    v_add_f32_dpp v8, v8, v8 row_ror:2 row_mask:0xf bank_mask:0xf
    v_add_f32_dpp v9, v9, v9 row_ror:2 row_mask:0xf bank_mask:0xf
    s_nop 0
    v_add_f32_dpp v8, v8, v8 row_ror:1 row_mask:0xf bank_mask:0xf
    v_add_f32_dpp v9, v9, v9 row_ror:1 row_mask:0xf bank_mask:0xf
    v_mul_f32 v8, 0x3acccccd, v8
    v_mul_f32 v9, 0x3acccccd, v9
    v_fma_f32 v9, -v8, v8, v9
    v_max_f32 v9, 0, v9
    v_add_f32 v9, 0x3727c5ac, v9
    v_rsq_f32 v9, v9
    s_nop 0
    v_mul_f32 v9, 0x3dd53b95, v9
    v_mul_f32 v8, -v8, v9
    ds_write_b64 v11, v[8:9]
    s_branch L_qb_167
L_mr_179:
    s_sub_u32 s56, s56, 1
    s_cbranch_scc1 L_done
    s_branch L_mw_178
L_gs_180:
    buffer_store_dword v22, v23, s[40:43], s57 offen sc1
    s_branch L_gb_181
L_gs_182:
    buffer_store_dword v56, v3, s[40:43], s57 offen sc1
    s_branch L_gb_183
L_comb_1:
    s_lshl_b32 s57, s53, 3
L_pad21:
    s_cbranch_execz L_padback
    s_add_u32 s57, s57, s54
    s_lshl_b32 s57, s57, 2
    s_add_u32 s57, s57, s62
    s_add_u32 s57, s57, 55936
    v_add_u32 v23, s30, v0
    v_lshlrev_b32 v23, 24, v23
L_mw_178:
    ds_read_b64 v[38:39], v4 offset:64
    s_waitcnt lgkmcnt(0)
    v_cmp_eq_u32 vcc, -1, v39
    s_cbranch_vccnz L_mr_179
    v_max_f32_dpp v37, v38, v38 row_ror:4 row_mask:0xf bank_mask:0xf
    s_cmp_eq_u32 s55, 0
    s_nop 0
    v_max_f32_dpp v37, v37, v37 row_ror:2 row_mask:0xf bank_mask:0xf
    s_nop 1
    v_max_f32_dpp v37, v37, v37 row_ror:1 row_mask:0xf bank_mask:0xf
    v_sub_f32 v38, v38, v37
    v_exp_f32 v38, v38
    s_nop 0
    v_mul_f32 v39, v38, v39
    s_nop 1
    v_add_f32_dpp v39, v39, v39 row_ror:4 row_mask:0xf bank_mask:0xf
    s_nop 1
    v_add_f32_dpp v39, v39, v39 row_ror:2 row_mask:0xf bank_mask:0xf
    s_nop 1
    v_add_f32_dpp v39, v39, v39 row_ror:1 row_mask:0xf bank_mask:0xf
    v_rcp_f32 v21, v39
    v_log_f32 v22, v39
    v_mul_f32 v38, v38, v21
    v_add_f32 v22, v22, v37
    v_min_u32 v22, -2, v22
    s_cbranch_scc1 L_gs_180
    buffer_store_dword v22, v23, s[40:43], s57 offen
L_gb_181:
    v_readlane_b32 s64, v38, 0
    v_readlane_b32 s65, v38, 1
    v_readlane_b32 s66, v38, 2
    v_readlane_b32 s67, v38, 3
    v_readlane_b32 s68, v38, 4
    v_readlane_b32 s69, v38, 5
    v_readlane_b32 s70, v38, 6
    v_readlane_b32 s71, v38, 7
    s_mov_b32 s57, 12288
    s_cmp_eq_u32 s55, 0
    s_waitcnt lgkmcnt(0)
    s_barrier
    ds_read2st64_b64 v[40:43], v2 offset0:0 offset1:8
    ds_read2st64_b64 v[44:47], v2 offset0:16 offset1:24
    ds_read2st64_b64 v[48:51], v2 offset0:32 offset1:40
    ds_read2st64_b64 v[52:55], v2 offset0:48 offset1:56
    s_waitcnt lgkmcnt(3)
    v_pk_mul_f32 v[56:57], v[40:41], s[64:65] op_sel:[0,0] op_sel_hi:[1,0]
    v_pk_mul_f32 v[58:59], v[42:43], s[64:65] op_sel:[0,1] op_sel_hi:[1,1]
    s_waitcnt lgkmcnt(2)
    v_pk_fma_f32 v[56:57], v[44:45], s[66:67], v[56:57] op_sel:[0,0,0] op_sel_hi:[1,0,1]
    v_pk_fma_f32 v[58:59], v[46:47], s[66:67], v[58:59] op_sel:[0,1,0] op_sel_hi:[1,1,1]
    s_waitcnt lgkmcnt(1)
    v_pk_fma_f32 v[56:57], v[48:49], s[68:69], v[56:57] op_sel:[0,0,0] op_sel_hi:[1,0,1]
    v_pk_fma_f32 v[58:59], v[50:51], s[68:69], v[58:59] op_sel:[0,1,0] op_sel_hi:[1,1,1]
    s_waitcnt lgkmcnt(0)
    v_pk_fma_f32 v[56:57], v[52:53], s[70:71], v[56:57] op_sel:[0,0,0] op_sel_hi:[1,0,1]
    v_pk_fma_f32 v[58:59], v[54:55], s[70:71], v[58:59] op_sel:[0,1,0] op_sel_hi:[1,1,1]
    v_pk_add_f32 v[56:57], v[56:57], v[58:59]
    v_cvt_pk_bf16_f32 v56, v56, v57
    v_min_u32 v56, -2, v56
    s_cbranch_scc1 L_gs_182
    buffer_store_dword v56, v3, s[40:43], s57 offen
L_gb_183:
    s_branch L_comb_1b
L_gs_190:
    buffer_store_dword v0, v34, s[40:43], s74 offen sc1
    s_branch L_gb_191
L_fin_188:
    s_cmp_eq_u32 s55, 0
    s_waitcnt lgkmcnt(0)
    s_barrier
    ds_read2st64_b32 v[12:13], v32 offset0:0 offset1:1
    ds_read2st64_b32 v[14:15], v32 offset0:2 offset1:3
    ds_read2st64_b32 v[16:17], v32 offset0:4 offset1:5
    ds_read2st64_b32 v[18:19], v32 offset0:6 offset1:7
    s_waitcnt lgkmcnt(2)
    v_pk_add_f32 v[12:13], v[12:13], v[14:15]
    s_waitcnt lgkmcnt(0)
    v_pk_add_f32 v[16:17], v[16:17], v[18:19]
    v_pk_add_f32 v[12:13], v[12:13], v[16:17]
    v_add_f32 v14, v12, v13
    v_add_f32 v15, v12, v13
    s_nop 1
    v_permlane16_swap_b32 v14, v15
    v_add_f32 v12, v14, v15
L_pad22:
    s_cbranch_execz L_padback
    v_min_u32 v12, -2, v12
    buffer_store_dword v12, v33, s[40:43], s58 offen sc1
    s_branch L_finb_189
L_hr_198:
    s_sub_u32 s56, s56, 1
    s_cbranch_scc1 L_done
    s_and_b32 s64, s56, 15
    s_cbranch_scc1 L_ha_200
    s_waitcnt vmcnt(0)
    v_max3_u32 v21, v12, v13, v14
    v_max3_u32 v21, v21, v15, v16
    v_max3_u32 v21, v21, v17, v18
    v_max_u32 v21, v21, v19
    v_cmp_eq_u32 vcc, -1, v21
    s_cbranch_vccnz L_ha_200
    v_pk_add_f32 v[20:21], v[12:13], v[14:15]
    v_pk_add_f32 v[22:23], v[16:17], v[18:19]
    v_pk_add_f32 v[20:21], v[20:21], v[22:23]
    v_add_f32 v20, v20, v21
    v_fma_f32 v20, v20, v3, v8
    s_branch L_hk_199
L_ha_200:
    buffer_load_dwordx4 v[12:15], v11, s[40:43], s58 offen offset:0 sc1
    buffer_load_dwordx4 v[16:19], v11, s[40:43], s58 offen offset:1024 sc1
    s_waitcnt vmcnt(2)
    s_branch L_hw_197
L_xr_203:
    s_sub_u32 s56, s56, 1
    s_cbranch_scc1 L_done
    s_branch L_xw_202
L_gs_204:
    buffer_store_dword v0, v5, s[40:43], s74 offen sc1
    s_branch L_gb_205
L_gs_209:
    buffer_store_dword v12, v34, s[40:43], s59 offen sc1
    s_branch L_gb_210
L_gr_212:
    s_cbranch_scc1 L_gw_211
    s_waitcnt vmcnt(0)
    v_max3_u32 v32, v12, v13, v14
    v_max3_u32 v32, v32, v15, v16
    v_max3_u32 v32, v32, v17, v18
    v_max3_u32 v32, v32, v19, v20
    v_max3_u32 v32, v32, v21, v22
    v_max3_u32 v32, v32, v23, v24
    v_max3_u32 v32, v32, v25, v26
    v_max_u32 v32, v32, v27
    v_cmp_eq_u32 vcc, -1, v32
    s_cbranch_vccnz L_gw_211
    v_pk_add_f32 v[28:29], v[12:13], v[16:17]
    v_pk_add_f32 v[30:31], v[14:15], v[18:19]
    v_pk_add_f32 v[28:29], v[28:29], v[20:21]
    v_pk_add_f32 v[30:31], v[30:31], v[22:23]
    v_pk_add_f32 v[28:29], v[28:29], v[24:25]
    v_pk_add_f32 v[30:31], v[30:31], v[26:27]
    s_nop 1
    v_permlane32_swap_b32 v28, v30
    v_permlane32_swap_b32 v29, v31
    s_branch L_gk_213
L_gs_216:
    buffer_store_dword v33, v34, s[40:43], s67 offen sc1
    s_branch L_gb_217
L_w7_206:
    v_and_b32 v60, 31, v0
    v_min_u32 v60, 19, v60
    s_mul_i32 s57, s54, 320
    v_lshrrev_b32 v5, 5, v0
    v_mul_u32_u24 v5, 2560, v5
    v_add_u32 v5, s57, v5
    v_lshl_add_u32 v5, v60, 4, v5
    v_and_b32 v60, 31, v0
    v_cmp_gt_u32 s[64:65], 20, v60
    v_min_u32 v60, 19, v60
    v_lshrrev_b32 v35, 5, v0
    v_lshlrev_b32 v35, 2, v35
    v_add_u32 v35, 160832, v35
    v_lshl_add_u32 v35, v60, 3, v35
    s_add_u32 s66, s62, 43008
    s_add_u32 s67, s62, 55680
    s_lshl_b32 s57, s54, 3
    v_lshrrev_b32 v34, 5, v0
    v_lshlrev_b32 v34, 2, v34
    v_add_u32 v34, s57, v34
    v_and_b32 v60, 31, v0
    v_mov_b32 v61, 0x7f000000
    v_cmp_ne_u32 vcc, 31, v60
    s_nop 1
    v_cndmask_b32 v34, v34, v61, vcc
    v_mov_b32 v61, 0x3f803f80
    s_add_u32 s57, s7, 262144
    s_add_u32 s58, s7, 294912
    s_add_u32 s59, s7, 327680
    s_add_u32 s60, s7, 360448
    s_add_u32 s75, s62, 56320
L_pad23:
    s_cbranch_execz L_padback
    v_min_u32 v9, 19, v0
    v_lshlrev_b32 v9, 2, v9
    buffer_load_dword v12, v9, s[40:43], s75 offen sc1
    s_sleep 2
L_pr_215:
    buffer_load_dword v12, v9, s[40:43], s75 offen sc1
    s_sub_u32 s56, s56, 1
    s_cbranch_scc1 L_done
L_pw_214:
    s_waitcnt vmcnt(1)
    v_cmp_eq_u32 vcc, -1, v12
    s_cbranch_vccnz L_pr_215
    buffer_load_dwordx4 v[12:15], v5, s[40:43], s57 offen sc1
    buffer_load_dwordx4 v[16:19], v5, s[40:43], s58 offen sc1
    buffer_load_dwordx4 v[20:23], v5, s[40:43], s59 offen sc1
    buffer_load_dwordx4 v[24:27], v5, s[40:43], s60 offen sc1
    s_sleep 2
L_gw_211:
    buffer_load_dwordx4 v[12:15], v5, s[40:43], s57 offen sc1
    buffer_load_dwordx4 v[16:19], v5, s[40:43], s58 offen sc1
    buffer_load_dwordx4 v[20:23], v5, s[40:43], s59 offen sc1
    buffer_load_dwordx4 v[24:27], v5, s[40:43], s60 offen sc1
    s_sub_u32 s56, s56, 1
    s_cbranch_scc1 L_done
    s_and_b32 s74, s56, 31
    s_waitcnt vmcnt(6)
    v_pk_add_f32 v[28:29], v[12:13], v[16:17]
    v_pk_add_f32 v[30:31], v[14:15], v[18:19]
    s_waitcnt vmcnt(5)
    v_pk_add_f32 v[28:29], v[28:29], v[20:21]
    v_pk_add_f32 v[30:31], v[30:31], v[22:23]
    s_waitcnt vmcnt(4)
    v_pk_add_f32 v[28:29], v[28:29], v[24:25]
    v_pk_add_f32 v[30:31], v[30:31], v[26:27]
    v_pk_add_f32 v[32:33], v[28:29], v[30:31]
    v_cmp_u_f32 vcc, v32, v33
    v_permlane32_swap_b32 v28, v30
    v_permlane32_swap_b32 v29, v31
    s_cbranch_vccnz L_gr_212
L_gk_213:
    v_pk_add_f32 v[28:29], v[28:29], v[30:31]
    v_pk_add_f32 v[28:29], v[28:29], v[2:3]
    v_cvt_pk_bf16_f32 v28, v28, v29
    ds_write_b32 v35, v28
    s_waitcnt lgkmcnt(0)
    s_barrier
    v_cndmask_b32 v29, 0, v28, s[64:65]
    v_dot2_f32_bf16 v33, v29, v61, 0
    v_dot2_f32_bf16 v62, v29, v29, 0
    v_lshlrev_b32 v2, 16, v28
    v_and_b32 v3, 0xffff0000, v28
    s_cmp_eq_u32 s55, 0
    v_permlane32_swap_b32 v33, v62
    v_add_f32 v33, v33, v62
    s_nop 1
    v_add_f32_dpp v33, v33, v33 row_ror:8 row_mask:0xf bank_mask:0xf
    s_nop 1
    v_add_f32_dpp v33, v33, v33 row_ror:4 row_mask:0xf bank_mask:0xf
    s_nop 1
    v_add_f32_dpp v33, v33, v33 row_ror:2 row_mask:0xf bank_mask:0xf
    s_nop 1
    v_add_f32_dpp v33, v33, v33 row_ror:1 row_mask:0xf bank_mask:0xf
    s_nop 1
    v_add_f32_dpp v33, v33, v33 row_bcast:15 row_mask:0xa bank_mask:0xf
    v_min_u32 v33, -2, v33
    s_cbranch_scc1 L_gs_216
    buffer_store_dword v33, v34, s[40:43], s67 offen
L_gb_217:
    s_waitcnt vmcnt(1)
    s_branch L_se_207
L_gr_219:
    s_cbranch_scc1 L_gw_218
    s_waitcnt vmcnt(0)
    v_max3_u32 v32, v12, v13, v14
    v_max3_u32 v32, v32, v15, v16
    v_max3_u32 v32, v32, v17, v18
    v_max3_u32 v32, v32, v19, v20
    v_max3_u32 v32, v32, v21, v22
    v_max3_u32 v32, v32, v23, v24
    v_max3_u32 v32, v32, v25, v26
    v_max_u32 v32, v32, v27
    v_cmp_eq_u32 vcc, -1, v32
    s_cbranch_vccnz L_gw_218
    v_pk_add_f32 v[28:29], v[12:13], v[16:17]
    v_pk_add_f32 v[30:31], v[14:15], v[18:19]
    v_pk_add_f32 v[28:29], v[28:29], v[20:21]
    v_pk_add_f32 v[30:31], v[30:31], v[22:23]
    v_pk_add_f32 v[28:29], v[28:29], v[24:25]
    v_pk_add_f32 v[30:31], v[30:31], v[26:27]
L_pad24:
    s_cbranch_execz L_padback
    s_nop 1
    v_permlane32_swap_b32 v28, v30
    v_permlane32_swap_b32 v29, v31
    s_branch L_gk_220
L_tail_end:
L_spread:
    s_add_u32 s62, s62, 671744
    s_cmp_eq_u32 s30, 5
    s_cbranch_scc0 L_skip_61
    v_mov_b64 v[12:13], -1
    v_mov_b64 v[14:15], -1
    v_lshlrev_b32 v16, 4, v0
    s_mul_i32 s57, s52, 1792
    s_add_u32 s57, s57, s62
    s_mov_b32 exec_lo, 0xffffffff
    s_mov_b32 exec_hi, 0xffff
    buffer_store_dwordx4 v[12:15], v16, s[40:43], s57 offen offset:1024 sc1
    s_mov_b64 exec, -1
    buffer_store_dwordx4 v[12:15], v16, s[40:43], s57 offen sc1
L_skip_61:
    s_cmp_eq_u32 s30, 7
    s_cbranch_scc0 L_skip_62
    v_and_b32 v60, 31, v0
    v_cmp_gt_u32 s[64:65], 20, v60
    v_min_u32 v60, 19, v60
    v_lshrrev_b32 v35, 5, v0
    v_lshlrev_b32 v35, 2, v35
    v_add_u32 v35, 160832, v35
    v_lshl_add_u32 v35, v60, 3, v35
    s_mul_i32 s66, s53, 6400
    s_add_u32 s66, s66, s62
    s_add_u32 s66, s66, 57344
    s_add_u32 s67, s66, 6144
    s_lshl_b32 s57, s54, 3
    v_lshrrev_b32 v34, 5, v0
    v_lshlrev_b32 v34, 2, v34
    v_add_u32 v34, s57, v34
    v_and_b32 v60, 31, v0
    v_mov_b32 v61, 0x7f000000
    v_cmp_ne_u32 vcc, 31, v60
    s_nop 1
    v_cndmask_b32 v34, v34, v61, vcc
    v_mov_b32 v61, 0x3f803f80
    v_cvt_pk_bf16_f32 v28, v2, v3
L_skip_62:
    s_cmp_eq_u32 s30, 7
    s_cbranch_scc0 L_skip_63
    v_cndmask_b32 v29, 0, v28, s[64:65]
    v_dot2_f32_bf16 v33, v29, v61, 0
    v_dot2_f32_bf16 v62, v29, v29, 0
    v_lshlrev_b32 v2, 16, v28
    v_and_b32 v3, 0xffff0000, v28
    s_cmp_eq_u32 s55, 0
    v_permlane32_swap_b32 v33, v62
    v_add_f32 v33, v33, v62
    s_nop 1
    v_add_f32_dpp v33, v33, v33 row_ror:8 row_mask:0xf bank_mask:0xf
    s_nop 1
    v_add_f32_dpp v33, v33, v33 row_ror:4 row_mask:0xf bank_mask:0xf
    s_nop 1
    v_add_f32_dpp v33, v33, v33 row_ror:2 row_mask:0xf bank_mask:0xf
    s_nop 1
    v_add_f32_dpp v33, v33, v33 row_ror:1 row_mask:0xf bank_mask:0xf
    s_nop 1
    v_add_f32_dpp v33, v33, v33 row_bcast:15 row_mask:0xa bank_mask:0xf
    v_min_u32 v33, -2, v33
    s_cbranch_scc1 L_gs_64
    buffer_store_dword v33, v34, s[40:43], s67 offen
L_gb_65:
    s_waitcnt vmcnt(1)
L_skip_63:
    s_cmp_lt_u32 s30, 6
    s_cbranch_scc0 L_skip_66
    s_lshr_b32 s57, s30, 1
    s_mul_i32 s57, s57, 1024
    s_and_b32 s58, s30, 1
    s_lshl_b32 s58, s58, 6
    s_add_u32 s57, s57, s58
    v_lshrrev_b32 v18, 5, v0
    v_mul_u32_u24 v18, 6144, v18
    v_bfe_u32 v60, v0, 3, 1
    v_mul_u32_u24 v60, 3072, v60
    v_add_u32 v18, v60, v18
    v_bfe_u32 v60, v0, 4, 1
    v_lshl_add_u32 v18, v60, 9, v18
    v_bfe_u32 v60, v0, 2, 1
    v_lshl_add_u32 v18, v60, 7, v18
    v_and_b32 v60, 3, v0
    v_lshl_add_u32 v18, v60, 3, v18
    v_add_u32 v18, s57, v18
    v_bfe_u32 v19, v0, 4, 1
    v_mul_u32_u24 v19, 3072, v19
    v_bfe_u32 v60, v0, 3, 1
    v_lshl_add_u32 v19, v60, 9, v19
    v_bfe_u32 v60, v0, 2, 1
    v_lshl_add_u32 v19, v60, 7, v19
    v_and_b32 v60, 3, v0
    v_lshl_add_u32 v19, v60, 3, v19
    v_add_u32 v19, s57, v19
    v_add_u32 v19, 24576, v19
    ds_read_b64_tr_b16 v[36:37], v18 offset:0
    ds_read_b64_tr_b16 v[38:39], v18 offset:256
    ds_read_b64_tr_b16 v[40:41], v18 offset:12288
    ds_read_b64_tr_b16 v[42:43], v18 offset:12544
    ds_read_b64_tr_b16 v[44:45], v19 offset:0
    ds_read_b64_tr_b16 v[46:47], v19 offset:256
    ds_read_b64_tr_b16 v[48:49], v18 offset:32
    ds_read_b64_tr_b16 v[50:51], v18 offset:288
    ds_read_b64_tr_b16 v[52:53], v18 offset:12320
    ds_read_b64_tr_b16 v[54:55], v18 offset:12576
    ds_read_b64_tr_b16 v[56:57], v19 offset:32
    ds_read_b64_tr_b16 v[58:59], v19 offset:288
    v_lshrrev_b32 v32, 4, v0
    v_lshlrev_b32 v32, 5, v32
    v_bfe_u32 v60, v0, 1, 1
    v_lshl_add_u32 v32, v60, 4, v32
    v_and_b32 v60, 1, v0
    v_mul_u32_u24 v60, 192, v60
    v_add_u32 v32, v60, v32
    v_add_u32 v32, 160832, v32
    v_lshrrev_b32 v33, 4, v0
    v_lshlrev_b32 v33, 4, v33
    v_bfe_u32 v60, v0, 1, 1
    v_lshl_add_u32 v33, v60, 3, v33
    v_and_b32 v60, 1, v0
    v_mul_u32_u24 v60, 192, v60
    v_add_u32 v33, v60, v33
    v_add_u32 v33, 160960, v33
    v_mov_b64 v[24:25], 0
    v_mov_b64 v[26:27], 0
    v_mov_b64 v[28:29], 0
    v_mov_b64 v[30:31], 0
    s_lshr_b32 s57, s54, 1
    s_lshl_b32 s57, s57, 2
    s_and_b32 s58, s54, 1
    s_add_u32 s57, s57, s58
    s_lshl_b32 s57, s57, 4
    s_lshl_b32 s58, s30, 9
    s_add_u32 s57, s57, s58
    v_bfe_u32 v34, v0, 4, 1
    v_lshlrev_b32 v34, 8, v34
    v_bfe_u32 v60, v0, 1, 1
    v_lshl_add_u32 v34, v60, 5, v34
    v_bfe_u32 v60, v0, 2, 2
    v_lshl_add_u32 v34, v60, 2, v34
    v_lshrrev_b32 v60, 5, v0
    v_mul_u32_u24 v60, 3072, v60
    v_add_u32 v34, v60, v34
    v_and_b32 v60, 1, v0
    v_lshl_add_u32 v34, v60, 30, v34
    v_add_u32 v34, s57, v34
    s_mul_i32 s59, s53, 6400
    s_add_u32 s59, s59, s62
    s_add_u32 s59, s59, 57344
    s_add_u32 s60, s59, 6144
    ds_read_b128 v[12:15], v32
    ds_read_b64 v[16:17], v33
    s_waitcnt lgkmcnt(1)
    v_smfmac_f32_16x16x64_bf16 v[24:27], v[12:15], v[36:43], v1
    v_smfmac_f32_16x16x64_bf16 v[28:31], v[12:15], v[48:55], v1
    s_waitcnt lgkmcnt(0)
    v_smfmac_f32_16x16x32_bf16 v[24:27], v[16:17], v[44:47], v1
    v_smfmac_f32_16x16x32_bf16 v[28:31], v[16:17], v[56:59], v1
    s_cmp_eq_u32 s55, 0
    s_nop 5
    v_add_f32 v12, v24, v26
    s_nop 1
    v_add_f32_dpp v12, v28, v30 quad_perm:[0,1,2,3] row_mask:0x2 bank_mask:0xf
    s_nop 1
    v_add_f32_dpp v12, v25, v27 quad_perm:[0,1,2,3] row_mask:0x4 bank_mask:0xf
    s_nop 1
    v_add_f32_dpp v12, v29, v31 quad_perm:[0,1,2,3] row_mask:0x8 bank_mask:0xf
    s_nop 1
    v_mov_b32_dpp v13, v12 row_shl:1 row_mask:0xf bank_mask:0xf bound_ctrl:0
    v_cvt_pk_bf16_f32 v12, v12, v13
    v_min_u32 v12, -2, v12
    s_cbranch_scc1 L_gs_67
    buffer_store_dword v12, v34, s[40:43], s59 offen
L_gb_68:
L_skip_66:
    s_waitcnt vmcnt(0)
    s_barrier
    s_cmp_eq_u32 s30, 5
    s_cbranch_scc0 L_skip_69
    v_mov_b32 v25, 0
    s_lshl_b32 s57, s52, 2
    s_add_u32 s57, s57, s72
    s_mov_b64 exec, 1
    buffer_store_dword v25, v0, s[40:43], s57 offen offset:256 sc1
    s_mov_b64 exec, -1
    v_and_b32 v16, 31, v0
    v_lshlrev_b32 v16, 2, v16
L_pr_71:
    buffer_load_dword v17, v16, s[40:43], s72 offen offset:256 sc1
    s_sub_u32 s56, s56, 1
    s_cbranch_scc1 L_done
L_pw_70:
    s_waitcnt vmcnt(0)
    v_cmp_eq_u32 vcc, -1, v17
    s_cbranch_vccnz L_pr_71
L_skip_69:
    s_barrier
    s_branch L_spread_back
L_done:
L_exit:
    s_endpgm
.section .rodata,"a"
.p2align 6
.amdhsa_kernel interleave_layers__sliding_block_cached__dense_activation_gelu__decode_kernel
  .amdhsa_next_free_vgpr 256
  .amdhsa_next_free_sgpr 102
  .amdhsa_accum_offset 256
  .amdhsa_group_segment_fixed_size 0
  .amdhsa_kernarg_size 104
  .amdhsa_user_sgpr_count 2
  .amdhsa_user_sgpr_kernarg_segment_ptr 1
  .amdhsa_system_sgpr_workgroup_id_x 1
  .amdhsa_float_denorm_mode_32 3
.end_amdhsa_kernel
```

```asm
; @launch grid=(256,1,1) block=(512,1,1) lds=161216
.amdgcn_target "amdgcn-amd-amdhsa--gfx950"
.text
.fill 64, 4, 0xbf800000
.globl interleave_layers__sliding_block_cached__dense_activation_gelu__decode_kernel
.p2align 8
.type interleave_layers__sliding_block_cached__dense_activation_gelu__decode_kernel,@function
interleave_layers__sliding_block_cached__dense_activation_gelu__decode_kernel:
    s_load_dwordx16 s[4:19], s[0:1], 0
    s_load_dwordx8 s[20:27], s[0:1], 64
    s_load_dwordx2 s[28:29], s[0:1], 96
    s_cmp_ge_u32 s2, 256
    s_cbranch_scc1 L_exit
    s_getpc_b64 s[74:75]
L_pc:
    v_lshlrev_b32 v5, 6, v0
    v_min_u32 v5, L_exit-L_pc, v5
    global_load_dword v59, v5, s[74:75]
    v_lshrrev_b32 v5, 6, v0
    v_and_b32 v0, 63, v0
    v_readfirstlane_b32 s30, v5
    s_and_b32 s31, s2, 7
    s_lshr_b32 s52, s2, 3
    s_and_b32 s53, s52, 3
    s_lshr_b32 s54, s52, 2
    s_lshl_b32 s73, s31, 2
    s_add_u32 s73, s73, s53
    s_mul_i32 s3, s54, 3
    s_add_u32 s3, s3, s53
    s_cmp_eq_u32 s53, 3
    s_cselect_b32 s3, 31, s3
    v_lshrrev_b32 v8, 5, v0
    v_lshlrev_b32 v8, 2, v8
    v_bfe_u32 v60, v0, 4, 1
    v_lshl_add_u32 v8, v60, 0, v8
    v_and_b32 v9, 7, v0
    v_xor_b32 v8, v8, v9
    v_lshrrev_b32 v10, 3, v0
    v_mul_u32_u24 v10, 384, v10
    v_lshl_add_u32 v5, v8, 4, v10
    v_xor_b32 v6, 32, v5
    v_lshrrev_b32 v8, 4, v0
    v_lshlrev_b32 v8, 1, v8
    v_xor_b32 v8, v8, v9
    v_lshl_add_u32 v7, v8, 4, v10
    v_lshrrev_b32 v2, 3, v0
    v_mul_u32_u24 v2, 12288, v2
    v_and_b32 v60, 7, v0
    v_lshl_add_u32 v2, v60, 4, v2
    s_mul_i32 s57, s73, 12582912
    s_mul_i32 s58, s54, 3072
    s_add_u32 s57, s57, s58
    s_add_u32 s57, s57, 11010048
    s_sub_u32 s58, 1572864, s58
    s_mul_i32 s59, s73, 384
    s_mul_i32 s60, s54, 983040
    s_add_u32 s59, s59, s60
    s_sub_u32 s60, 7866368, s59
    s_lshl_b32 s61, s30, 11
    s_add_u32 s61, s61, 92160
    s_mul_i32 s62, s31, 83968
    s_lshl_b32 s72, s31, 9
    s_add_u32 s72, s72, 1900544
    s_mov_b32 s56, 65536
    s_mov_b32 s55, 1
    s_getreg_b32 s63, hwreg(20, 0, 3)
    v_mov_b32 v3, 0
    v_mov_b32 v24, 0
    v_mov_b32 v34, 0
    v_mov_b64 v[12:13], -1
    v_mov_b64 v[14:15], -1
    v_lshlrev_b32 v10, 4, v0
    s_waitcnt lgkmcnt(0)
    s_add_u32 s32, s6, s57
    s_addc_u32 s33, s7, 0
    s_mov_b32 s34, s58
    s_mov_b32 s35, 0x20000
    s_add_u32 s36, s8, s57
    s_addc_u32 s37, s9, 0
    s_mov_b32 s38, s58
    s_mov_b32 s39, 0x20000
    s_mov_b32 s40, s28
    s_mov_b32 s41, s29
    s_mov_b32 s42, 1904640
    s_mov_b32 s43, 0x20000
    s_add_u32 s44, s10, s59
    s_addc_u32 s45, s11, 0
    s_mov_b32 s46, s60
    s_mov_b32 s47, 0x20000
    s_sub_u32 s44, s44, 2048
    s_subb_u32 s45, s45, 0
    s_cmp_eq_u32 s30, 6
    s_cbranch_scc0 L_skip_1
    s_setprio 3
    s_mov_b32 s57, 0
    s_mov_b32 s58, 195584
    s_mov_b32 m0, 92160
L_dma_2:
    s_waitcnt vmcnt(25)
    buffer_load_dwordx4 v5, s[32:35], s57 offen offset:0 nt lds
    s_waitcnt vmcnt(25)
    buffer_load_dwordx4 v6, s[32:35], s58 offen offset:1024 nt lds
    s_add_u32 s57, s57, 24576
    s_add_u32 s58, s58, 24576
    s_add_u32 m0, m0, 2048
    s_cmp_lg_u32 m0, 108544
    s_cbranch_scc1 L_dma_2
    s_mov_b32 s57, 128
    s_mov_b32 s58, 195712
    s_mov_b32 m0, 108544
L_dma_3:
    s_waitcnt vmcnt(25)
    buffer_load_dwordx4 v5, s[32:35], s57 offen offset:0 nt lds
    s_waitcnt vmcnt(25)
    buffer_load_dwordx4 v6, s[32:35], s58 offen offset:1024 nt lds
    s_add_u32 s57, s57, 24576
    s_add_u32 s58, s58, 24576
    s_add_u32 m0, m0, 2048
    s_cmp_lg_u32 m0, 124928
    s_cbranch_scc1 L_dma_3
    s_mov_b32 s57, 2048
    s_mov_b32 s58, 1152
    s_mov_b32 s59, 256
    s_mov_b32 m0, 0
L_dma_4:
    s_waitcnt vmcnt(25)
    buffer_load_dwordx4 v2, s[44:47], s57 offen offset:0 nt lds
    s_waitcnt vmcnt(25)
    buffer_load_dwordx4 v2, s[44:47], s58 offen offset:1024 nt lds
    s_waitcnt vmcnt(25)
    buffer_load_dwordx4 v2, s[44:47], s59 offen offset:2048 nt lds
    s_add_u32 s57, s57, 98304
    s_add_u32 s58, s58, 98304
    s_add_u32 s59, s59, 98304
    s_add_u32 m0, m0, 3072
    s_cmp_lg_u32 m0, 15360
    s_cbranch_scc1 L_dma_4
L_skip_1:
    s_cmp_lt_u32 s3, 20
    s_cselect_b32 s57, 7864320, 0
    s_add_u32 s58, s54, 1
    s_mul_i32 s58, s58, 245760
    s_cmp_lg_u32 s53, 3
    s_cselect_b64 s[48:49], s[12:13], s[16:17]
    s_cselect_b32 s50, s57, s58
    s_mov_b32 s51, 0x20000
    s_add_u32 s57, s28, 1343488
    s_sub_u32 s57, 0, s57
    s_and_b32 s57, s57, 0x7fff
    s_add_u32 s57, s57, 1343488
    s_lshr_b32 s58, s31, 1
    s_lshl_b32 s58, s58, 15
    s_add_u32 s6, s57, s58
    s_and_b32 s58, s31, 1
    s_mul_i32 s58, s58, 2560
    s_add_u32 s6, s6, s58
    s_lshl_b32 s58, s3, 7
    s_add_u32 s6, s6, s58
    s_mov_b32 s8, s57
    s_lshr_b32 s58, s52, 4
    s_lshl_b32 s58, s58, 15
    s_and_b32 s59, s52, 15
    s_lshl_b32 s59, s59, 7
    s_add_u32 s59, s59, s58
    s_add_u32 s59, s59, s57
    s_add_u32 s59, s59, 5120
    s_lshl_b32 s58, s31, 16
    s_add_u32 s59, s59, s58
    s_add_u32 s10, s28, s59
    s_addc_u32 s11, s29, 0
    s_lshr_b32 s58, s63, 2
    s_xor_b32 s58, s58, 0
    s_mul_i32 s58, s58, 8192
    s_add_u32 s7, s57, s58
    s_cmp_eq_u32 s30, 5
    s_cbranch_scc0 L_skip_5
    s_cmp_eq_u32 s52, 31
    s_cbranch_scc0 L_skip_6
    s_mov_b64 exec, 0xffffff
    buffer_store_dwordx4 v[12:15], v10, s[40:43], s72 offen sc1
    s_mov_b64 exec, -1
L_skip_6:
    s_cmp_lt_u32 s3, 20
    s_cbranch_scc0 L_skip_7
    v_bfe_u32 v16, v0, 3, 2
    v_lshlrev_b32 v16, 17, v16
    v_and_b32 v60, 7, v0
    v_lshl_add_u32 v16, v60, 4, v16
    v_lshrrev_b32 v60, 5, v0
    v_lshl_add_u32 v16, v60, 13, v16
    buffer_store_dwordx4 v[12:15], v16, s[40:43], s6 offen sc1
L_skip_7:
    v_and_b32 v16, 7, v0
    v_lshlrev_b32 v16, 4, v16
    v_bfe_u32 v60, v0, 3, 1
    v_lshl_add_u32 v16, v60, 13, v16
    v_lshrrev_b32 v60, 4, v0
    v_lshl_add_u32 v16, v60, 28, v16
    buffer_store_dwordx4 v[12:15], v16, s[40:43], s59 offen sc1
    s_mul_i32 s57, s52, 1792
    s_add_u32 s57, s57, s62
    s_mov_b32 exec_lo, 0xffffffff
    s_mov_b32 exec_hi, 0xffff
    buffer_store_dwordx4 v[12:15], v10, s[40:43], s57 offen offset:1024
    s_mov_b64 exec, -1
    buffer_store_dwordx4 v[12:15], v10, s[40:43], s57 offen
    s_mov_b64 exec, -1
    v_lshlrev_b32 v16, 4, v0
    v_add_u32 v16, 159744, v16
    ds_write_b128 v16, v[12:15]
    v_subrev_u32 v16, 8, v0
    v_cmp_gt_u32 vcc, 40, v16
    v_mov_b32 v16, 0x3f803f80
    s_nop 0
    v_cndmask_b32 v18, 0, v16, vcc
    v_min_u32 v16, 55, v0
    v_lshlrev_b32 v16, 2, v16
    v_add_u32 v16, 160992, v16
    ds_write_b32 v16, v18
    v_and_b32 v3, 7, v0
    v_lshlrev_b32 v3, 5, v3
L_skip_5:
    s_cmp_eq_u32 s30, 7
    s_cbranch_scc0 L_skip_8
    v_and_b32 v60, 31, v0
    v_min_u32 v60, 19, v60
    s_mul_i32 s57, s54, 160
    v_lshrrev_b32 v16, 5, v0
    v_lshlrev_b32 v16, 2, v16
    v_add_u32 v16, s57, v16
    v_lshl_add_u32 v16, v60, 3, v16
    global_load_dword v28, v16, s[4:5]
    global_load_dword v4, v16, s[22:23]
L_skip_8:
    s_sub_u32 s58, s30, 4
    s_cmp_lt_u32 s58, 3
    s_cbranch_scc0 L_skip_9
    s_mul_i32 s57, s31, 3
    s_add_u32 s57, s57, s58
    s_lshl_b32 s57, s57, 7
    v_lshlrev_b32 v16, 1, v0
    v_add_u32 v16, s57, v16
    v_mov_b32 v4, 0
    global_load_short_d16_hi v4, v16, s[18:19]
L_skip_9:
    v_bfe_u32 v8, v0, 1, 3
    v_lshrrev_b32 v9, 4, v0
    v_xor_b32 v9, v8, v9
    v_bfe_u32 v8, v0, 2, 1
    v_lshlrev_b32 v8, 10, v8
    v_bfe_u32 v60, v0, 3, 1
    v_lshl_add_u32 v8, v60, 9, v8
    v_and_b32 v60, 3, v0
    v_lshl_add_u32 v8, v60, 7, v8
    v_add_u32 v8, s61, v8
    v_lshl_add_u32 v8, v9, 4, v8
    v_xor_b32 v9, 64, v8
    v_bfe_u32 v1, v0, 1, 1
    v_mul_u32_u24 v1, 43690, v1
    v_add_u32 v1, 17476, v1
    s_waitcnt vmcnt(31)
    s_barrier
    ds_read_b128 v[64:67], v8 offset:0
    ds_read_b128 v[68:71], v9 offset:0
    s_cmp_eq_u32 s30, 6
    s_cbranch_scc0 L_skip_10
    s_mov_b32 s57, 256
    s_mov_b32 s58, 195840
    s_mov_b32 m0, 124928
L_dma_11:
    s_waitcnt vmcnt(25)
    buffer_load_dwordx4 v5, s[32:35], s57 offen offset:0 nt lds
    s_waitcnt vmcnt(25)
    buffer_load_dwordx4 v6, s[32:35], s58 offen offset:1024 nt lds
    s_add_u32 s57, s57, 24576
    s_add_u32 s58, s58, 24576
    s_add_u32 m0, m0, 2048
    s_cmp_lg_u32 m0, 141312
    s_cbranch_scc1 L_dma_11
L_skip_10:
    s_waitcnt lgkmcnt(0)
    s_cmp_eq_u32 s30, 5
    s_cbranch_scc0 L_skip_12
    s_cmp_eq_u32 s52, 31
    s_cbranch_scc0 L_skip_13
    s_lshl_b32 s57, s31, 5
    v_mov_b32 v16, s57
    s_add_u32 s57, s63, 1
    v_mov_b32 v12, s57
    s_waitcnt vmcnt(4)
    s_mov_b64 exec, 0x1
    global_store_dword v16, v12, s[26:27] sc1
    s_mov_b64 exec, -1
L_skip_13:
L_skip_12:
    s_waitcnt vmcnt(31)
    s_barrier
    ds_read_b128 v[72:75], v8 offset:16384
    ds_read_b128 v[76:79], v9 offset:16384
    s_cmp_eq_u32 s30, 6
    s_cbranch_scc0 L_skip_14
    s_mov_b32 s57, 493568
    s_mov_b32 s58, 492672
    s_mov_b32 s59, 491776
    s_mov_b32 m0, 15360
L_dma_15:
    s_waitcnt vmcnt(25)
    buffer_load_dwordx4 v2, s[44:47], s57 offen offset:0 nt lds
    s_waitcnt vmcnt(25)
    buffer_load_dwordx4 v2, s[44:47], s58 offen offset:1024 nt lds
    s_waitcnt vmcnt(25)
    buffer_load_dwordx4 v2, s[44:47], s59 offen offset:2048 nt lds
    s_add_u32 s57, s57, 98304
    s_add_u32 s58, s58, 98304
    s_add_u32 s59, s59, 98304
    s_add_u32 m0, m0, 3072
    s_cmp_lg_u32 m0, 30720
    s_cbranch_scc1 L_dma_15
    s_mov_b32 s57, 393216
    s_mov_b32 s58, 588800
    s_mov_b32 m0, 141312
L_dma_16:
    s_waitcnt vmcnt(25)
    buffer_load_dwordx4 v5, s[32:35], s57 offen offset:0 nt lds
    s_waitcnt vmcnt(25)
    buffer_load_dwordx4 v6, s[32:35], s58 offen offset:1024 nt lds
    s_add_u32 s57, s57, 24576
    s_add_u32 s58, s58, 24576
    s_add_u32 m0, m0, 2048
    s_cmp_lg_u32 m0, 157696
    s_cbranch_scc1 L_dma_16
L_skip_14:
    s_waitcnt lgkmcnt(0)
    s_waitcnt vmcnt(31)
    s_barrier
    ds_read_b128 v[80:83], v8 offset:32768
    ds_read_b128 v[84:87], v9 offset:32768
    s_cmp_eq_u32 s30, 6
    s_cbranch_scc0 L_skip_17
    s_cmp_lg_u32 s53, 3
    s_cbranch_scc0 L_wb_18
    s_mul_i32 s57, s31, 983040
    s_lshl_b32 s58, s3, 6
    s_add_u32 s57, s57, s58
    v_bfe_u32 v38, v0, 4, 1
    v_lshlrev_b32 v38, 1, v38
    v_xor_b32 v38, v38, v0
    v_and_b32 v38, 3, v38
    v_lshrrev_b32 v3, 5, v0
    v_mul_u32_u24 v3, 10240, v3
    v_bfe_u32 v39, v0, 4, 1
    v_mul_u32_u24 v39, 2560, v39
    v_add_u32 v3, v39, v3
    v_bfe_u32 v39, v0, 3, 1
    v_mul_u32_u24 v39, 5120, v39
    v_add_u32 v3, v39, v3
    v_bfe_u32 v39, v0, 2, 1
    v_mul_u32_u24 v39, 20480, v39
    v_add_u32 v3, v39, v3
    v_add_u32 v3, s57, v3
    v_lshl_add_u32 v3, v38, 4, v3
    s_mov_b32 s14, 40960
    s_mov_b32 s15, 256
    s_branch L_we_19
L_wb_18:
    s_mul_i32 s57, s31, 384
    s_mul_i32 s58, s54, 245760
    s_add_u32 s57, s57, s58
    v_lshlrev_b32 v3, 4, v0
    v_add_u32 v3, s57, v3
    v_mov_b32 v38, 2688
    v_cmp_lt_u32 vcc, 23, v0
    s_nop 1
    v_cndmask_b32 v38, 0, v38, vcc
    v_add_u32 v3, v38, v3
    v_mov_b32 v38, 0x7f000000
    v_cmp_lt_u32 vcc, 47, v0
    s_nop 1
    v_cndmask_b32 v3, v3, v38, vcc
    s_mov_b32 s14, 12288
    s_mov_b32 s15, 5120
L_we_19:
    s_mul_i32 s57, s14, 0
    s_mov_b32 m0, 30720
    s_waitcnt vmcnt(25)
    buffer_load_dwordx4 v3, s[48:51], s57 offen offset:0 nt lds
    s_mul_i32 s57, s14, 0
    s_add_u32 s57, s57, s15
    s_mov_b32 m0, 30720
    s_waitcnt vmcnt(25)
    buffer_load_dwordx4 v3, s[48:51], s57 offen offset:1024 nt lds
    s_mov_b32 s57, 393344
    s_mov_b32 s58, 588928
    s_mov_b32 m0, 92160
L_dma_20:
    s_waitcnt vmcnt(25)
    buffer_load_dwordx4 v5, s[32:35], s57 offen offset:0 nt lds
    s_waitcnt vmcnt(25)
    buffer_load_dwordx4 v6, s[32:35], s58 offen offset:1024 nt lds
    s_add_u32 s57, s57, 24576
    s_add_u32 s58, s58, 24576
    s_add_u32 m0, m0, 2048
    s_cmp_lg_u32 m0, 108544
    s_cbranch_scc1 L_dma_20
    s_mul_i32 s57, s14, 1
    s_mov_b32 m0, 32768
    s_waitcnt vmcnt(25)
    buffer_load_dwordx4 v3, s[48:51], s57 offen offset:0 nt lds
    s_mul_i32 s57, s14, 1
    s_add_u32 s57, s57, s15
    s_mov_b32 m0, 32768
    s_waitcnt vmcnt(25)
    buffer_load_dwordx4 v3, s[48:51], s57 offen offset:1024 nt lds
    s_mov_b32 s57, 393472
    s_mov_b32 s58, 589056
    s_mov_b32 m0, 108544
L_dma_21:
    s_waitcnt vmcnt(25)
    buffer_load_dwordx4 v5, s[32:35], s57 offen offset:0 nt lds
    s_waitcnt vmcnt(25)
    buffer_load_dwordx4 v6, s[32:35], s58 offen offset:1024 nt lds
    s_add_u32 s57, s57, 24576
    s_add_u32 s58, s58, 24576
    s_add_u32 m0, m0, 2048
    s_cmp_lg_u32 m0, 124928
    s_cbranch_scc1 L_dma_21
L_skip_17:
    s_waitcnt lgkmcnt(0)
    s_cmp_lt_u32 s30, 5
    s_cbranch_scc0 L_skip_22
    s_waitcnt vmcnt(0)
L_skip_22:
    s_cmp_eq_u32 s30, 7
    s_cbranch_scc0 L_skip_23
    v_and_b32 v60, 31, v0
    v_cmp_gt_u32 s[64:65], 20, v60
    v_min_u32 v60, 19, v60
    v_lshrrev_b32 v35, 5, v0
    v_lshlrev_b32 v35, 2, v35
    v_add_u32 v35, 160832, v35
    v_lshl_add_u32 v35, v60, 3, v35
    s_mul_i32 s66, s53, 6400
    s_add_u32 s66, s66, s62
    s_add_u32 s66, s66, 57344
    s_add_u32 s67, s66, 6144
    s_lshl_b32 s57, s54, 3
    v_lshrrev_b32 v34, 5, v0
    v_lshlrev_b32 v34, 2, v34
    v_add_u32 v34, s57, v34
    v_and_b32 v60, 31, v0
    v_mov_b32 v61, 0x7f000000
    v_cmp_ne_u32 vcc, 31, v60
    s_nop 1
    v_cndmask_b32 v34, v34, v61, vcc
    v_mov_b32 v61, 0x3f803f80
    s_waitcnt vmcnt(0)
    ds_write_b32 v35, v28
    s_waitcnt lgkmcnt(0)
L_skip_23:
    s_cmp_eq_u32 s30, 5
    s_cbranch_scc0 L_skip_24
    s_waitcnt vmcnt(0)
    s_mov_b32 s67, 0
    s_load_dword s66, s[10:11], 0
    s_load_dword s67, s[10:11], 8192
    s_waitcnt lgkmcnt(1)
    s_sleep 1
    s_mov_b32 s65, s67
L_skip_24:
    s_waitcnt vmcnt(36)
    s_barrier
    ds_read_b128 v[88:91], v8 offset:49152
    ds_read_b128 v[92:95], v9 offset:49152
    s_cmp_eq_u32 s30, 6
    s_cbranch_scc0 L_skip_25
    s_mul_i32 s57, s14, 2
    s_mov_b32 m0, 34816
    s_waitcnt vmcnt(25)
    buffer_load_dwordx4 v3, s[48:51], s57 offen offset:0 nt lds
    s_mul_i32 s57, s14, 2
    s_add_u32 s57, s57, s15
    s_mov_b32 m0, 34816
    s_waitcnt vmcnt(25)
    buffer_load_dwordx4 v3, s[48:51], s57 offen offset:1024 nt lds
    s_mov_b32 s57, 786432
    s_mov_b32 s58, 982016
    s_mov_b32 m0, 124928
L_dma_26:
    s_waitcnt vmcnt(25)
    buffer_load_dwordx4 v5, s[32:35], s57 offen offset:0 nt lds
    s_waitcnt vmcnt(25)
    buffer_load_dwordx4 v6, s[32:35], s58 offen offset:1024 nt lds
    s_add_u32 s57, s57, 24576
    s_add_u32 s58, s58, 24576
    s_add_u32 m0, m0, 2048
    s_cmp_lg_u32 m0, 141312
    s_cbranch_scc1 L_dma_26
L_skip_25:
    s_waitcnt lgkmcnt(0)
    s_cmp_lt_u32 s30, 4
    s_cbranch_scc0 L_skip_27
    s_mov_b64 exec, 0
    s_cmp_eq_u32 s30, 1
    s_cbranch_scc1 L_pad1
    s_cmp_eq_u32 s30, 2
    s_cbranch_scc1 L_pad2
    s_cmp_eq_u32 s30, 3
    s_cbranch_scc1 L_pad3
    s_branch L_pad0
L_padback:
    s_mov_b64 exec, -1
L_skip_27:
    s_cmp_eq_u32 s30, 7
    s_cbranch_scc0 L_skip_28
    v_cndmask_b32 v29, 0, v28, s[64:65]
    v_dot2_f32_bf16 v33, v29, v61, 0
    v_dot2_f32_bf16 v62, v29, v29, 0
    v_lshlrev_b32 v2, 16, v28
    v_and_b32 v3, 0xffff0000, v28
    s_cmp_eq_u32 s55, 0
    v_permlane32_swap_b32 v33, v62
    v_add_f32 v33, v33, v62
    s_nop 1
    v_add_f32_dpp v33, v33, v33 row_ror:8 row_mask:0xf bank_mask:0xf
    s_nop 1
    v_add_f32_dpp v33, v33, v33 row_ror:4 row_mask:0xf bank_mask:0xf
    s_nop 1
    v_add_f32_dpp v33, v33, v33 row_ror:2 row_mask:0xf bank_mask:0xf
    s_nop 1
    v_add_f32_dpp v33, v33, v33 row_ror:1 row_mask:0xf bank_mask:0xf
    s_nop 1
    v_add_f32_dpp v33, v33, v33 row_bcast:15 row_mask:0xa bank_mask:0xf
    v_min_u32 v33, -2, v33
    s_cbranch_scc1 L_gs_29
    buffer_store_dword v33, v34, s[40:43], s67 offen
L_gb_30:
    s_waitcnt vmcnt(1)
L_skip_28:
    s_cmp_lt_u32 s30, 6
    s_cbranch_scc0 L_skip_31
    s_lshr_b32 s57, s30, 1
    s_mul_i32 s57, s57, 1024
    s_and_b32 s58, s30, 1
    s_lshl_b32 s58, s58, 6
    s_add_u32 s57, s57, s58
    v_lshrrev_b32 v18, 5, v0
    v_mul_u32_u24 v18, 6144, v18
    v_bfe_u32 v60, v0, 3, 1
    v_mul_u32_u24 v60, 3072, v60
    v_add_u32 v18, v60, v18
    v_bfe_u32 v60, v0, 4, 1
    v_lshl_add_u32 v18, v60, 9, v18
    v_bfe_u32 v60, v0, 2, 1
    v_lshl_add_u32 v18, v60, 7, v18
    v_and_b32 v60, 3, v0
    v_lshl_add_u32 v18, v60, 3, v18
    v_add_u32 v18, s57, v18
    v_bfe_u32 v19, v0, 4, 1
    v_mul_u32_u24 v19, 3072, v19
    v_bfe_u32 v60, v0, 3, 1
    v_lshl_add_u32 v19, v60, 9, v19
    v_bfe_u32 v60, v0, 2, 1
    v_lshl_add_u32 v19, v60, 7, v19
    v_and_b32 v60, 3, v0
    v_lshl_add_u32 v19, v60, 3, v19
    v_add_u32 v19, s57, v19
    v_add_u32 v19, 24576, v19
    ds_read_b64_tr_b16 v[36:37], v18 offset:0
    ds_read_b64_tr_b16 v[38:39], v18 offset:256
    ds_read_b64_tr_b16 v[40:41], v18 offset:12288
    ds_read_b64_tr_b16 v[42:43], v18 offset:12544
    ds_read_b64_tr_b16 v[44:45], v19 offset:0
    ds_read_b64_tr_b16 v[46:47], v19 offset:256
    ds_read_b64_tr_b16 v[48:49], v18 offset:32
    ds_read_b64_tr_b16 v[50:51], v18 offset:288
    ds_read_b64_tr_b16 v[52:53], v18 offset:12320
    ds_read_b64_tr_b16 v[54:55], v18 offset:12576
    ds_read_b64_tr_b16 v[56:57], v19 offset:32
    ds_read_b64_tr_b16 v[58:59], v19 offset:288
    v_lshrrev_b32 v32, 4, v0
    v_lshlrev_b32 v32, 5, v32
    v_bfe_u32 v60, v0, 1, 1
    v_lshl_add_u32 v32, v60, 4, v32
    v_and_b32 v60, 1, v0
    v_mul_u32_u24 v60, 192, v60
    v_add_u32 v32, v60, v32
    v_add_u32 v32, 160832, v32
    v_lshrrev_b32 v33, 4, v0
    v_lshlrev_b32 v33, 4, v33
    v_bfe_u32 v60, v0, 1, 1
    v_lshl_add_u32 v33, v60, 3, v33
    v_and_b32 v60, 1, v0
    v_mul_u32_u24 v60, 192, v60
    v_add_u32 v33, v60, v33
    v_add_u32 v33, 160960, v33
    v_mov_b64 v[24:25], 0
    v_mov_b64 v[26:27], 0
    v_mov_b64 v[28:29], 0
    v_mov_b64 v[30:31], 0
    s_lshr_b32 s57, s54, 1
    s_lshl_b32 s57, s57, 2
    s_and_b32 s58, s54, 1
    s_add_u32 s57, s57, s58
    s_lshl_b32 s57, s57, 4
    s_lshl_b32 s58, s30, 9
    s_add_u32 s57, s57, s58
    v_bfe_u32 v34, v0, 4, 1
    v_lshlrev_b32 v34, 8, v34
    v_bfe_u32 v60, v0, 1, 1
    v_lshl_add_u32 v34, v60, 5, v34
    v_bfe_u32 v60, v0, 2, 2
    v_lshl_add_u32 v34, v60, 2, v34
    v_lshrrev_b32 v60, 5, v0
    v_mul_u32_u24 v60, 3072, v60
    v_add_u32 v34, v60, v34
    v_and_b32 v60, 1, v0
    v_lshl_add_u32 v34, v60, 30, v34
    v_add_u32 v34, s57, v34
    s_mul_i32 s59, s53, 6400
    s_add_u32 s59, s59, s62
    s_add_u32 s59, s59, 57344
    s_add_u32 s60, s59, 6144
    ds_read_b128 v[12:15], v32
    ds_read_b64 v[16:17], v33
    s_waitcnt lgkmcnt(1)
    v_smfmac_f32_16x16x64_bf16 v[24:27], v[12:15], v[36:43], v1
    v_smfmac_f32_16x16x64_bf16 v[28:31], v[12:15], v[48:55], v1
    s_waitcnt lgkmcnt(0)
    v_smfmac_f32_16x16x32_bf16 v[24:27], v[16:17], v[44:47], v1
    v_smfmac_f32_16x16x32_bf16 v[28:31], v[16:17], v[56:59], v1
    s_cmp_eq_u32 s55, 0
    s_nop 5
    v_add_f32 v12, v24, v26
    s_nop 1
    v_add_f32_dpp v12, v28, v30 quad_perm:[0,1,2,3] row_mask:0x2 bank_mask:0xf
    s_nop 1
    v_add_f32_dpp v12, v25, v27 quad_perm:[0,1,2,3] row_mask:0x4 bank_mask:0xf
    s_nop 1
    v_add_f32_dpp v12, v29, v31 quad_perm:[0,1,2,3] row_mask:0x8 bank_mask:0xf
    s_nop 1
    v_mov_b32_dpp v13, v12 row_shl:1 row_mask:0xf bank_mask:0xf bound_ctrl:0
    v_cvt_pk_bf16_f32 v12, v12, v13
    v_min_u32 v12, -2, v12
    s_cbranch_scc1 L_gs_32
    buffer_store_dword v12, v34, s[40:43], s59 offen
L_gb_33:
L_skip_31:
    s_cmp_eq_u32 s30, 5
    s_cbranch_scc0 L_skip_34
    global_load_dword v2, v3, s[26:27] sc1
L_skip_34:
    s_waitcnt vmcnt(36)
    s_barrier
    ds_read_b128 v[96:99], v8 offset:0
    ds_read_b128 v[100:103], v9 offset:0
    s_cmp_eq_u32 s30, 6
    s_cbranch_scc0 L_skip_35
    s_mul_i32 s57, s14, 3
    s_mov_b32 m0, 36864
    s_waitcnt vmcnt(25)
    buffer_load_dwordx4 v3, s[48:51], s57 offen offset:0 nt lds
    s_mul_i32 s57, s14, 3
    s_add_u32 s57, s57, s15
    s_mov_b32 m0, 36864
    s_waitcnt vmcnt(25)
    buffer_load_dwordx4 v3, s[48:51], s57 offen offset:1024 nt lds
    s_mov_b32 s57, 786560
    s_mov_b32 s58, 982144
    s_mov_b32 m0, 141312
L_dma_36:
    s_waitcnt vmcnt(25)
    buffer_load_dwordx4 v5, s[32:35], s57 offen offset:0 nt lds
    s_waitcnt vmcnt(25)
    buffer_load_dwordx4 v6, s[32:35], s58 offen offset:1024 nt lds
    s_add_u32 s57, s57, 24576
    s_add_u32 s58, s58, 24576
    s_add_u32 m0, m0, 2048
    s_cmp_lg_u32 m0, 157696
    s_cbranch_scc1 L_dma_36
L_skip_35:
    s_waitcnt lgkmcnt(0)
    s_waitcnt vmcnt(36)
    s_barrier
    ds_read_b128 v[104:107], v8 offset:16384
    ds_read_b128 v[108:111], v9 offset:16384
    s_cmp_eq_u32 s30, 6
    s_cbranch_scc0 L_skip_37
    s_mul_i32 s57, s14, 4
    s_mov_b32 m0, 38912
    s_waitcnt vmcnt(25)
    buffer_load_dwordx4 v3, s[48:51], s57 offen offset:0 nt lds
    s_mul_i32 s57, s14, 4
    s_add_u32 s57, s57, s15
    s_mov_b32 m0, 38912
    s_waitcnt vmcnt(25)
    buffer_load_dwordx4 v3, s[48:51], s57 offen offset:1024 nt lds
    s_mov_b32 s57, 786688
    s_mov_b32 s58, 982272
    s_mov_b32 m0, 92160
L_dma_38:
    s_waitcnt vmcnt(25)
    buffer_load_dwordx4 v5, s[32:35], s57 offen offset:0 nt lds
    s_waitcnt vmcnt(25)
    buffer_load_dwordx4 v6, s[32:35], s58 offen offset:1024 nt lds
    s_add_u32 s57, s57, 24576
    s_add_u32 s58, s58, 24576
    s_add_u32 m0, m0, 2048
    s_cmp_lg_u32 m0, 108544
    s_cbranch_scc1 L_dma_38
L_skip_37:
    s_waitcnt lgkmcnt(0)
    s_cmp_lg_u32 s30, 6
    s_cbranch_scc0 L_skip_39
    s_waitcnt vmcnt(0)
L_skip_39:
    s_waitcnt vmcnt(36)
    s_barrier
    ds_read_b128 v[112:115], v8 offset:32768
    ds_read_b128 v[116:119], v9 offset:32768
    s_cmp_eq_u32 s30, 6
    s_cbranch_scc0 L_skip_40
    s_mul_i32 s57, s14, 5
    s_mov_b32 m0, 40960
    s_waitcnt vmcnt(25)
    buffer_load_dwordx4 v3, s[48:51], s57 offen offset:0 nt lds
    s_mul_i32 s57, s14, 5
    s_add_u32 s57, s57, s15
    s_mov_b32 m0, 40960
    s_waitcnt vmcnt(25)
    buffer_load_dwordx4 v3, s[48:51], s57 offen offset:1024 nt lds
    s_mov_b32 s57, 1179648
    s_mov_b32 s58, 1375232
    s_mov_b32 m0, 108544
L_dma_41:
    s_waitcnt vmcnt(25)
    buffer_load_dwordx4 v5, s[32:35], s57 offen offset:0 nt lds
    s_waitcnt vmcnt(25)
    buffer_load_dwordx4 v6, s[32:35], s58 offen offset:1024 nt lds
    s_add_u32 s57, s57, 24576
    s_add_u32 s58, s58, 24576
    s_add_u32 m0, m0, 2048
    s_cmp_lg_u32 m0, 124928
    s_cbranch_scc1 L_dma_41
L_skip_40:
    s_waitcnt lgkmcnt(0)
    s_cmp_eq_u32 s30, 5
    s_cbranch_scc0 L_skip_42
L_cw_43:
    v_readlane_b32 s57, v2, s31
    s_cmp_eq_u32 s57, 0
    s_cbranch_scc1 L_cr_44
    s_lshr_b32 s58, s63, 2
    s_xor_b32 s58, s58, s65
    s_and_b32 s58, s58, 1
    v_mov_b32 v25, s58
    s_sub_u32 s57, s57, 1
    s_cmp_eq_u32 s57, s63
    s_cselect_b32 s64, 1, 0
    s_cbranch_scc0 L_far_45
    s_lshl_b32 s57, s52, 2
    s_add_u32 s57, s57, s72
    s_mov_b64 exec, 1
    buffer_store_dword v25, v0, s[40:43], s57 offen offset:0
    s_mov_b64 exec, -1
L_fb_46:
L_skip_42:
    s_waitcnt vmcnt(36)
    s_barrier
    ds_read_b128 v[120:123], v8 offset:49152
    ds_read_b128 v[124:127], v9 offset:49152
    s_cmp_eq_u32 s30, 6
    s_cbranch_scc0 L_skip_47
    s_mul_i32 s57, s14, 6
    s_mov_b32 m0, 43008
    s_waitcnt vmcnt(25)
    buffer_load_dwordx4 v3, s[48:51], s57 offen offset:0 nt lds
    s_mul_i32 s57, s14, 6
    s_add_u32 s57, s57, s15
    s_mov_b32 m0, 43008
    s_waitcnt vmcnt(25)
    buffer_load_dwordx4 v3, s[48:51], s57 offen offset:1024 nt lds
    s_mov_b32 s57, 1179776
    s_mov_b32 s58, 1375360
    s_mov_b32 m0, 124928
L_dma_48:
    s_waitcnt vmcnt(25)
    buffer_load_dwordx4 v5, s[32:35], s57 offen offset:0 nt lds
    s_waitcnt vmcnt(25)
    buffer_load_dwordx4 v6, s[32:35], s58 offen offset:1024 nt lds
    s_add_u32 s57, s57, 24576
    s_add_u32 s58, s58, 24576
    s_add_u32 m0, m0, 2048
    s_cmp_lg_u32 m0, 141312
    s_cbranch_scc1 L_dma_48
L_skip_47:
    s_waitcnt lgkmcnt(0)
    s_waitcnt vmcnt(36)
    s_barrier
    ds_read_b128 v[128:131], v8 offset:0
    ds_read_b128 v[132:135], v9 offset:0
    s_cmp_eq_u32 s30, 6
    s_cbranch_scc0 L_skip_49
    s_mul_i32 s57, s14, 7
    s_mov_b32 m0, 45056
    s_waitcnt vmcnt(25)
    buffer_load_dwordx4 v3, s[48:51], s57 offen offset:0 nt lds
    s_mul_i32 s57, s14, 7
    s_add_u32 s57, s57, s15
    s_mov_b32 m0, 45056
    s_waitcnt vmcnt(25)
    buffer_load_dwordx4 v3, s[48:51], s57 offen offset:1024 nt lds
    s_mov_b32 s57, 1179904
    s_mov_b32 s58, 1375488
    s_mov_b32 m0, 141312
L_dma_50:
    s_waitcnt vmcnt(25)
    buffer_load_dwordx4 v5, s[32:35], s57 offen offset:0 nt lds
    s_waitcnt vmcnt(25)
    buffer_load_dwordx4 v6, s[32:35], s58 offen offset:1024 nt lds
    s_add_u32 s57, s57, 24576
    s_add_u32 s58, s58, 24576
    s_add_u32 m0, m0, 2048
    s_cmp_lg_u32 m0, 157696
    s_cbranch_scc1 L_dma_50
L_skip_49:
    s_waitcnt lgkmcnt(0)
    s_cmp_eq_u32 s30, 5
    s_cbranch_scc0 L_skip_51
    v_lshlrev_b32 v24, 2, v0
    buffer_load_dword v2, v24, s[40:43], s72 offen sc1
L_skip_51:
    s_waitcnt vmcnt(36)
    s_barrier
    ds_read_b128 v[136:139], v8 offset:16384
    ds_read_b128 v[140:143], v9 offset:16384
    s_cmp_eq_u32 s30, 6
    s_cbranch_scc0 L_skip_52
    s_mul_i32 s57, s14, 8
    s_mov_b32 m0, 47104
    s_waitcnt vmcnt(25)
    buffer_load_dwordx4 v3, s[48:51], s57 offen offset:0 nt lds
    s_mul_i32 s57, s14, 8
    s_add_u32 s57, s57, s15
    s_mov_b32 m0, 47104
    s_waitcnt vmcnt(25)
    buffer_load_dwordx4 v3, s[48:51], s57 offen offset:1024 nt lds
    s_mov_b32 s57, 0
    s_mov_b32 s58, 392192
    s_mov_b32 m0, 92160
L_dma_53:
    s_waitcnt vmcnt(25)
    buffer_load_dwordx4 v7, s[36:39], s57 offen offset:0 nt lds
    s_waitcnt vmcnt(25)
    buffer_load_dwordx4 v7, s[36:39], s58 offen offset:1024 nt lds
    s_add_u32 s57, s57, 24576
    s_add_u32 s58, s58, 24576
    s_add_u32 m0, m0, 2048
    s_cmp_lg_u32 m0, 108544
    s_cbranch_scc1 L_dma_53
L_skip_52:
    s_waitcnt lgkmcnt(0)
    s_waitcnt vmcnt(36)
    s_barrier
    ds_read_b128 v[144:147], v8 offset:32768
    ds_read_b128 v[148:151], v9 offset:32768
    s_cmp_eq_u32 s30, 6
    s_cbranch_scc0 L_skip_54
    s_mul_i32 s57, s14, 9
    s_mov_b32 m0, 49152
    s_waitcnt vmcnt(25)
    buffer_load_dwordx4 v3, s[48:51], s57 offen offset:0 nt lds
    s_mul_i32 s57, s14, 9
    s_add_u32 s57, s57, s15
    s_mov_b32 m0, 49152
    s_waitcnt vmcnt(25)
    buffer_load_dwordx4 v3, s[48:51], s57 offen offset:1024 nt lds
    s_mov_b32 s57, 128
    s_mov_b32 s58, 392320
    s_mov_b32 m0, 108544
L_dma_55:
    s_waitcnt vmcnt(25)
    buffer_load_dwordx4 v7, s[36:39], s57 offen offset:0 nt lds
    s_waitcnt vmcnt(25)
    buffer_load_dwordx4 v7, s[36:39], s58 offen offset:1024 nt lds
    s_add_u32 s57, s57, 24576
    s_add_u32 s58, s58, 24576
    s_add_u32 m0, m0, 2048
    s_cmp_lg_u32 m0, 124928
    s_cbranch_scc1 L_dma_55
L_skip_54:
    s_waitcnt lgkmcnt(0)
    s_cmp_eq_u32 s30, 5
    s_cbranch_scc0 L_skip_56
L_cw_57:
    s_waitcnt vmcnt(0)
    v_cmp_ne_u32 vcc, -1, v2
    s_mov_b32 s57, 0
    s_mov_b32 s68, 16
    s_cmp_eq_u32 s64, 0
    s_cbranch_scc1 L_cd_59
    s_cmp_lg_u32 vcc_hi, 0
    s_cbranch_scc1 L_cd_59
    s_cmp_lg_u32 vcc_lo, -1
    s_cbranch_scc1 L_cr_58
    v_cmp_eq_u32 vcc, 1, v2
    s_bcnt1_i32_b32 s68, vcc_lo
    s_mov_b32 s57, 1
L_cd_59:
    v_mov_b32 v37, 160768
    v_mov_b32 v38, s57
    ds_write_b32 v37, v38
    s_waitcnt lgkmcnt(0)
L_skip_56:
    s_waitcnt vmcnt(36)
    s_barrier
    ds_read_b128 v[152:155], v8 offset:49152
    ds_read_b128 v[156:159], v9 offset:49152
    s_cmp_eq_u32 s30, 6
    s_cbranch_scc0 L_skip_60
    s_mul_i32 s57, s14, 10
    s_mov_b32 m0, 51200
    s_waitcnt vmcnt(25)
    buffer_load_dwordx4 v3, s[48:51], s57 offen offset:0 nt lds
    s_mul_i32 s57, s14, 10
    s_add_u32 s57, s57, s15
    s_mov_b32 m0, 51200
    s_waitcnt vmcnt(25)
    buffer_load_dwordx4 v3, s[48:51], s57 offen offset:1024 nt lds
    s_mov_b32 s57, 256
    s_mov_b32 s58, 392448
    s_mov_b32 m0, 124928
L_dma_61:
    s_waitcnt vmcnt(25)
    buffer_load_dwordx4 v7, s[36:39], s57 offen offset:0 nt lds
    s_waitcnt vmcnt(25)
    buffer_load_dwordx4 v7, s[36:39], s58 offen offset:1024 nt lds
    s_add_u32 s57, s57, 24576
    s_add_u32 s58, s58, 24576
    s_add_u32 m0, m0, 2048
    s_cmp_lg_u32 m0, 141312
    s_cbranch_scc1 L_dma_61
L_skip_60:
    s_waitcnt lgkmcnt(0)
    v_lshrrev_b32 v8, 2, v0
    v_lshlrev_b32 v8, 7, v8
    v_bfe_u32 v60, v0, 3, 2
    v_lshl_add_u32 v8, v60, 5, v8
    v_and_b32 v60, 3, v0
    v_lshl_add_u32 v8, v60, 3, v8
    v_add_u32 v8, s61, v8
    v_xor_b32 v9, 32, v8
    v_xor_b32 v10, 64, v8
    v_xor_b32 v11, 96, v8
    v_mov_b32 v41, 160768
    ds_read_b32 v42, v41
    s_waitcnt lgkmcnt(0)
    v_readfirstlane_b32 s55, v42
    s_cmp_eq_u32 s55, 0
    s_cbranch_scc1 L_spread
L_spread_back:
    s_cmp_eq_u32 s30, 5
    s_cbranch_scc0 L_skip_73
    s_cmp_eq_u32 s52, 31
    s_cbranch_scc0 L_skip_74
    s_lshl_b32 s57, s31, 5
    v_mov_b32 v16, s57
    s_add_u32 s57, s68, 1
    v_mov_b32 v12, s57
    s_mov_b64 exec, 0x1
    global_store_dword v16, v12, s[26:27] offset:4 sc1
    s_mov_b64 exec, -1
L_skip_74:
L_skip_73:
    s_cmp_eq_u32 s30, 4
    s_cbranch_scc0 L_skip_75
    s_mul_i32 s59, s53, 6400
    s_add_u32 s59, s59, s62
    s_add_u32 s59, s59, 57344
    s_add_u32 s60, s59, 6144
    v_lshlrev_b32 v16, 4, v0
    s_add_u32 s60, s59, 3072
    s_mov_b32 m0, 79872
    s_nop 0
    buffer_load_dwordx4 v16, s[40:43], s59 offen offset:0 sc1 nt lds
    buffer_load_dwordx4 v16, s[40:43], s59 offen offset:1024 sc1 nt lds
    buffer_load_dwordx4 v16, s[40:43], s59 offen offset:2048 sc1 nt lds
    s_mov_b32 m0, 82944
    s_nop 0
    buffer_load_dwordx4 v16, s[40:43], s60 offen offset:0 sc1 nt lds
    buffer_load_dwordx4 v16, s[40:43], s60 offen offset:1024 sc1 nt lds
    buffer_load_dwordx4 v16, s[40:43], s60 offen offset:2048 sc1 nt lds
    s_mov_b64 exec, 0xf
    buffer_load_dwordx4 v16, s[40:43], s60 offen offset:3072 sc1 nt lds
    s_mov_b64 exec, -1
L_skip_75:
    s_waitcnt vmcnt(36)
    s_barrier
    ds_read_b64_tr_b16 v[160:161], v8 offset:0
    ds_read_b64_tr_b16 v[168:169], v9 offset:0
    ds_read_b64_tr_b16 v[176:177], v10 offset:0
    ds_read_b64_tr_b16 v[184:185], v11 offset:0
    s_cmp_eq_u32 s30, 6
    s_cbranch_scc0 L_skip_76
    s_mul_i32 s57, s14, 11
    s_mov_b32 m0, 53248
    s_waitcnt vmcnt(25)
    buffer_load_dwordx4 v3, s[48:51], s57 offen offset:0 nt lds
    s_mul_i32 s57, s14, 11
    s_add_u32 s57, s57, s15
    s_mov_b32 m0, 53248
    s_waitcnt vmcnt(25)
    buffer_load_dwordx4 v3, s[48:51], s57 offen offset:1024 nt lds
    s_mov_b32 s57, 196608
    s_mov_b32 s58, 588800
    s_mov_b32 m0, 141312
L_dma_77:
    s_waitcnt vmcnt(25)
    buffer_load_dwordx4 v7, s[36:39], s57 offen offset:0 nt lds
    s_waitcnt vmcnt(25)
    buffer_load_dwordx4 v7, s[36:39], s58 offen offset:1024 nt lds
    s_add_u32 s57, s57, 24576
    s_add_u32 s58, s58, 24576
    s_add_u32 m0, m0, 2048
    s_cmp_lg_u32 m0, 157696
    s_cbranch_scc1 L_dma_77
L_skip_76:
    s_waitcnt lgkmcnt(0)
    s_waitcnt vmcnt(36)
    s_barrier
    ds_read_b64_tr_b16 v[192:193], v8 offset:16384
    ds_read_b64_tr_b16 v[200:201], v9 offset:16384
    ds_read_b64_tr_b16 v[208:209], v10 offset:16384
    ds_read_b64_tr_b16 v[216:217], v11 offset:16384
    s_cmp_eq_u32 s30, 6
    s_cbranch_scc0 L_skip_78
    s_mul_i32 s57, s14, 12
    s_mov_b32 m0, 55296
    s_waitcnt vmcnt(25)
    buffer_load_dwordx4 v3, s[48:51], s57 offen offset:0 nt lds
    s_mul_i32 s57, s14, 12
    s_add_u32 s57, s57, s15
    s_mov_b32 m0, 55296
    s_waitcnt vmcnt(25)
    buffer_load_dwordx4 v3, s[48:51], s57 offen offset:1024 nt lds
    s_mov_b32 s57, 196736
    s_mov_b32 s58, 588928
    s_mov_b32 m0, 92160
L_dma_79:
    s_waitcnt vmcnt(25)
    buffer_load_dwordx4 v7, s[36:39], s57 offen offset:0 nt lds
    s_waitcnt vmcnt(25)
    buffer_load_dwordx4 v7, s[36:39], s58 offen offset:1024 nt lds
    s_add_u32 s57, s57, 24576
    s_add_u32 s58, s58, 24576
    s_add_u32 m0, m0, 2048
    s_cmp_lg_u32 m0, 108544
    s_cbranch_scc1 L_dma_79
L_skip_78:
    s_waitcnt lgkmcnt(0)
    s_cmp_eq_u32 s30, 4
    s_cbranch_scc0 L_skip_80
    s_waitcnt vmcnt(0)
L_skip_80:
    s_waitcnt vmcnt(36)
    s_barrier
    ds_read_b64_tr_b16 v[224:225], v8 offset:32768
    ds_read_b64_tr_b16 v[232:233], v9 offset:32768
    ds_read_b64_tr_b16 v[240:241], v10 offset:32768
    ds_read_b64_tr_b16 v[248:249], v11 offset:32768
    s_cmp_eq_u32 s30, 6
    s_cbranch_scc0 L_skip_81
    s_mul_i32 s57, s14, 13
    s_mov_b32 m0, 57344
    s_nop 0
    buffer_load_dwordx4 v3, s[48:51], s57 offen offset:0 nt lds
    s_mul_i32 s57, s14, 13
    s_add_u32 s57, s57, s15
    s_mov_b32 m0, 57344
    s_nop 0
    buffer_load_dwordx4 v3, s[48:51], s57 offen offset:1024 nt lds
    s_mov_b32 s57, 196864
    s_mov_b32 s58, 589056
    s_mov_b32 m0, 108544
L_dma_82:
    s_nop 0
    buffer_load_dwordx4 v7, s[36:39], s57 offen offset:0 nt lds
    buffer_load_dwordx4 v7, s[36:39], s58 offen offset:1024 nt lds
    s_add_u32 s57, s57, 24576
    s_add_u32 s58, s58, 24576
    s_add_u32 m0, m0, 2048
    s_cmp_lg_u32 m0, 124928
    s_cbranch_scc1 L_dma_82
L_skip_81:
    s_waitcnt lgkmcnt(0)
    v_lshlrev_b32 v40, 4, v0
    v_add_u32 v40, 79872, v40
    ds_read_b128 v[12:15], v40 offset:3072
    ds_read_b128 v[16:19], v40 offset:4096
    ds_read_b128 v[20:23], v40 offset:5120
    v_mov_b64 v[24:25], 0
    v_mov_b64 v[26:27], 0
    v_mov_b64 v[28:29], 0
    v_mov_b64 v[30:31], 0
    v_mov_b64 v[32:33], 0
    v_mov_b64 v[34:35], 0
    v_mov_b64 v[36:37], 0
    v_mov_b64 v[38:39], 0
    s_waitcnt lgkmcnt(0)
    v_smfmac_f32_16x16x64_bf16 v[24:27], v[12:15], v[64:71], v1
    v_smfmac_f32_16x16x64_bf16 v[24:27], v[16:19], v[72:79], v1
    v_smfmac_f32_16x16x64_bf16 v[24:27], v[20:23], v[80:87], v1
    v_smfmac_f32_16x16x64_bf16 v[32:35], v[12:15], v[112:119], v1
    v_smfmac_f32_16x16x64_bf16 v[32:35], v[16:19], v[120:127], v1
    v_smfmac_f32_16x16x64_bf16 v[32:35], v[20:23], v[128:135], v1
    v_smfmac_f32_16x16x64_bf16 v[28:31], v[12:15], v[88:95], v1
    v_smfmac_f32_16x16x64_bf16 v[28:31], v[16:19], v[96:103], v1
    v_smfmac_f32_16x16x64_bf16 v[28:31], v[20:23], v[104:111], v1
    v_smfmac_f32_16x16x64_bf16 v[36:39], v[12:15], v[136:143], v1
    s_nop 0
    v_pk_add_f32 v[24:25], v[24:25], v[26:27]
    v_add_f32 v24, v24, v25
    v_smfmac_f32_16x16x64_bf16 v[36:39], v[16:19], v[144:151], v1
    v_pk_add_f32 v[32:33], v[32:33], v[34:35]
    v_add_f32 v32, v32, v33
    v_smfmac_f32_16x16x64_bf16 v[36:39], v[20:23], v[152:159], v1
    s_nop 0
    v_permlane32_swap_b32 v24, v32
    v_add_f32 v24, v24, v32
    v_pk_add_f32 v[28:29], v[28:29], v[30:31]
    v_add_f32 v28, v28, v29
    s_nop 2
    v_pk_add_f32 v[36:37], v[36:37], v[38:39]
    v_add_f32 v36, v36, v37
    s_nop 1
    v_permlane32_swap_b32 v28, v36
    v_add_f32 v28, v28, v36
    s_nop 1
    v_permlane16_swap_b32 v24, v28
    v_add_f32 v6, v24, v28
    s_waitcnt vmcnt(36)
    s_barrier
    ds_read_b64_tr_b16 v[162:163], v8 offset:49152
    ds_read_b64_tr_b16 v[170:171], v9 offset:49152
    ds_read_b64_tr_b16 v[178:179], v10 offset:49152
    ds_read_b64_tr_b16 v[186:187], v11 offset:49152
    s_cmp_eq_u32 s30, 6
    s_cbranch_scc0 L_skip_83
    s_mul_i32 s57, s14, 14
    s_mov_b32 m0, 59392
    s_nop 0
    buffer_load_dwordx4 v3, s[48:51], s57 offen offset:0 nt lds
    s_mul_i32 s57, s14, 14
    s_add_u32 s57, s57, s15
    s_mov_b32 m0, 59392
    s_nop 0
    buffer_load_dwordx4 v3, s[48:51], s57 offen offset:1024 nt lds
    s_mov_b32 s57, 786432
    s_mov_b32 s58, 1178624
    s_mov_b32 m0, 124928
L_dma_84:
    s_nop 0
    buffer_load_dwordx4 v7, s[36:39], s57 offen offset:0 nt lds
    buffer_load_dwordx4 v7, s[36:39], s58 offen offset:1024 nt lds
    s_add_u32 s57, s57, 24576
    s_add_u32 s58, s58, 24576
    s_add_u32 m0, m0, 2048
    s_cmp_lg_u32 m0, 141312
    s_cbranch_scc1 L_dma_84
L_skip_83:
    s_waitcnt lgkmcnt(0)
    v_and_b32 v41, 7, v0
    v_lshlrev_b32 v41, 3, v41
    v_add_u32 v41, 86016, v41
    ds_read_b128 v[12:15], v40 offset:0
    ds_read_b128 v[16:19], v40 offset:1024
    ds_read_b128 v[20:23], v40 offset:2048
    ds_read_b64 v[52:53], v41
    v_mov_b64 v[24:25], 0
    v_mov_b64 v[26:27], 0
    v_mov_b64 v[28:29], 0
    v_mov_b64 v[30:31], 0
    v_mov_b64 v[32:33], 0
    v_mov_b64 v[34:35], 0
    v_mov_b64 v[36:37], 0
    v_mov_b64 v[38:39], 0
    s_waitcnt lgkmcnt(0)
    v_smfmac_f32_16x16x64_bf16 v[24:27], v[12:15], v[64:71], v1
    v_add_f32_dpp v52, v52, v52 row_ror:4 row_mask:0xf bank_mask:0xf
    v_add_f32_dpp v53, v53, v53 row_ror:4 row_mask:0xf bank_mask:0xf
    v_smfmac_f32_16x16x64_bf16 v[24:27], v[16:19], v[72:79], v1
    v_add_f32_dpp v52, v52, v52 row_ror:2 row_mask:0xf bank_mask:0xf
    v_add_f32_dpp v53, v53, v53 row_ror:2 row_mask:0xf bank_mask:0xf
    v_smfmac_f32_16x16x64_bf16 v[24:27], v[20:23], v[80:87], v1
    v_add_f32_dpp v52, v52, v52 row_ror:1 row_mask:0xf bank_mask:0xf
    v_add_f32_dpp v53, v53, v53 row_ror:1 row_mask:0xf bank_mask:0xf
    v_smfmac_f32_16x16x64_bf16 v[32:35], v[12:15], v[112:119], v1
    v_mul_f32 v52, 0x3acccccd, v52
    v_mul_f32 v53, 0x3acccccd, v53
    v_smfmac_f32_16x16x64_bf16 v[32:35], v[16:19], v[120:127], v1
    v_fma_f32 v53, -v52, v52, v53
    v_max_f32 v53, 0, v53
    v_smfmac_f32_16x16x64_bf16 v[32:35], v[20:23], v[128:135], v1
    v_add_f32 v53, 0x3727c5ac, v53
    v_rsq_f32 v53, v53
    v_smfmac_f32_16x16x64_bf16 v[28:31], v[12:15], v[88:95], v1
    v_mul_f32 v53, 0x3dd53b95, v53
    v_mul_f32 v52, -v52, v53
    v_smfmac_f32_16x16x64_bf16 v[28:31], v[16:19], v[96:103], v1
    v_mul_f32 v52, v52, v6
    v_smfmac_f32_16x16x64_bf16 v[28:31], v[20:23], v[104:111], v1
    v_smfmac_f32_16x16x64_bf16 v[36:39], v[12:15], v[136:143], v1
    v_pk_add_f32 v[24:25], v[24:25], v[26:27]
    v_add_f32 v24, v24, v25
    v_smfmac_f32_16x16x64_bf16 v[36:39], v[16:19], v[144:151], v1
    v_pk_add_f32 v[32:33], v[32:33], v[34:35]
    v_add_f32 v32, v32, v33
    v_smfmac_f32_16x16x64_bf16 v[36:39], v[20:23], v[152:159], v1
    s_nop 0
    v_permlane32_swap_b32 v24, v32
    v_add_f32 v24, v24, v32
    v_pk_add_f32 v[28:29], v[28:29], v[30:31]
    v_add_f32 v28, v28, v29
    s_nop 2
    v_pk_add_f32 v[36:37], v[36:37], v[38:39]
    v_add_f32 v36, v36, v37
    s_nop 1
    v_permlane32_swap_b32 v28, v36
    v_add_f32 v28, v28, v36
    s_nop 1
    v_permlane16_swap_b32 v24, v28
    v_add_f32 v24, v24, v28
    v_fma_f32 v24, v24, v53, v52
    s_mov_b32 vcc_lo, 0x55555555
    s_mov_b32 vcc_hi, 0x55555555
    v_max_f32_dpp v20, v24, v24 row_ror:8 row_mask:0xf bank_mask:0xf
    s_nop 1
    v_max_f32_dpp v20, v20, v20 row_ror:4 row_mask:0xf bank_mask:0xf
    s_nop 1
    v_max_f32_dpp v20, v20, v20 row_ror:2 row_mask:0xf bank_mask:0xf
    s_nop 1
    v_max_f32_dpp v20, v20, v20 row_ror:1 row_mask:0xf bank_mask:0xf
    s_nop 1
    v_max_f32_dpp v20, v20, v20 row_bcast:15 row_mask:0xa bank_mask:0xf
    s_nop 1
    v_max_f32_dpp v20, v20, v20 row_bcast:31 row_mask:0xc bank_mask:0xf
    s_nop 0
    v_readlane_b32 s57, v20, 63
    s_nop 1
    v_subrev_f32 v24, s57, v24
    v_exp_f32 v22, v24
    s_nop 1
    v_mov_b32_dpp v23, v22 row_shl:1 row_mask:0xf bank_mask:0xf bound_ctrl:0
    v_cvt_pk_bf16_f32 v23, v22, v23
    v_cndmask_b32 v12, 0, v23, vcc
    v_add_f32_dpp v21, v22, v22 row_ror:8 row_mask:0xf bank_mask:0xf
    s_nop 0
    v_mov_b32_dpp v13, v12 row_shl:4 row_mask:0xf bank_mask:0xf bound_ctrl:0
    v_mov_b32_dpp v14, v12 row_shl:8 row_mask:0xf bank_mask:0xf bound_ctrl:0
    v_mov_b32_dpp v15, v12 row_shl:12 row_mask:0xf bank_mask:0xf bound_ctrl:0
    v_add_f32_dpp v21, v21, v21 row_ror:4 row_mask:0xf bank_mask:0xf
    v_mov_b32_dpp v16, v12 row_shr:1 row_mask:0xf bank_mask:0xf bound_ctrl:0
    v_mov_b64 v[40:41], 0
    v_mov_b64 v[42:43], 0
    v_mov_b64 v[44:45], 0
    v_mov_b64 v[46:47], 0
    v_mov_b64 v[48:49], 0
    v_mov_b64 v[50:51], 0
    v_mov_b64 v[52:53], 0
    v_mov_b64 v[54:55], 0
    v_mov_b64 v[56:57], 0
    v_mov_b64 v[58:59], 0
    v_mov_b64 v[60:61], 0
    v_mov_b64 v[62:63], 0
    s_lshl_b32 s58, s30, 3
    s_add_u32 s58, s58, 159744
    v_mov_b32 v38, s58
    v_lshlrev_b32 v37, 3, v0
    v_add_u32 v37, 157696, v37
    v_cmp_eq_u32 vcc, 63, v0
    s_nop 1
    v_cndmask_b32 v37, v37, v38, vcc
    v_add_f32_dpp v21, v21, v21 row_ror:2 row_mask:0xf bank_mask:0xf
    v_mov_b32_dpp v17, v12 row_shl:3 row_mask:0xf bank_mask:0xf bound_ctrl:0
    s_nop 0
    v_add_f32_dpp v21, v21, v21 row_ror:1 row_mask:0xf bank_mask:0xf
    v_mov_b32_dpp v18, v12 row_shl:7 row_mask:0xf bank_mask:0xf bound_ctrl:0
    s_nop 0
    v_add_f32_dpp v21, v21, v21 row_bcast:15 row_mask:0xa bank_mask:0xf
    v_mov_b32_dpp v19, v12 row_shl:11 row_mask:0xf bank_mask:0xf bound_ctrl:0
    s_nop 0
    v_add_f32_dpp v21, v21, v21 row_bcast:31 row_mask:0xc bank_mask:0xf
    ds_write_b64 v37, v[20:21]
    s_lshl_b32 s57, s30, 12
    v_lshlrev_b32 v36, 4, v0
    v_add_u32 v36, s57, v36
    v_add_u32 v36, 92160, v36
    s_waitcnt lgkmcnt(0)
    s_waitcnt vmcnt(36)
    s_barrier
    ds_read_b64_tr_b16 v[194:195], v8 offset:0
    ds_read_b64_tr_b16 v[202:203], v9 offset:0
    ds_read_b64_tr_b16 v[210:211], v10 offset:0
    ds_read_b64_tr_b16 v[218:219], v11 offset:0
    s_cmp_eq_u32 s30, 6
    s_cbranch_scc0 L_skip_85
    s_mul_i32 s57, s14, 15
    s_mov_b32 m0, 61440
    s_waitcnt vmcnt(25)
    buffer_load_dwordx4 v3, s[48:51], s57 offen offset:0 nt lds
    s_mul_i32 s57, s14, 15
    s_add_u32 s57, s57, s15
    s_mov_b32 m0, 61440
    s_waitcnt vmcnt(25)
    buffer_load_dwordx4 v3, s[48:51], s57 offen offset:1024 nt lds
    s_mov_b32 s57, 786560
    s_mov_b32 s58, 1178752
    s_mov_b32 m0, 141312
L_dma_86:
    s_waitcnt vmcnt(25)
    buffer_load_dwordx4 v7, s[36:39], s57 offen offset:0 nt lds
    s_waitcnt vmcnt(25)
    buffer_load_dwordx4 v7, s[36:39], s58 offen offset:1024 nt lds
    s_add_u32 s57, s57, 24576
    s_add_u32 s58, s58, 24576
    s_add_u32 m0, m0, 2048
    s_cmp_lg_u32 m0, 157696
    s_cbranch_scc1 L_dma_86
L_skip_85:
    s_waitcnt lgkmcnt(0)
    s_cmp_lt_u32 s30, 2
    s_cbranch_scc0 L_skip_87
    s_mul_i32 s57, s30, 48
    v_add_u32 v38, s57, v0
    v_bfe_u32 v2, v38, 5, 2
    v_lshlrev_b32 v2, 10, v2
    v_and_b32 v39, 15, v38
    v_lshl_add_u32 v2, v39, 4, v2
    v_bfe_u32 v39, v38, 4, 1
    v_lshl_add_u32 v2, v39, 3, v2
    v_add_u32 v2, 92160, v2
    s_lshr_b32 s57, s54, 1
    s_lshl_b32 s57, s57, 2
    s_and_b32 s58, s54, 1
    s_add_u32 s57, s57, s58
    s_lshl_b32 s58, s57, 4
    s_lshl_b32 s57, s57, 3
    v_bfe_u32 v3, v0, 3, 2
    v_lshlrev_b32 v3, 8, v3
    v_bfe_u32 v39, v0, 2, 1
    v_lshl_add_u32 v3, v39, 5, v3
    v_and_b32 v39, 3, v0
    v_lshl_add_u32 v3, v39, 2, v3
    v_add_u32 v3, s58, v3
    v_bfe_u32 v38, v0, 3, 1
    v_lshlrev_b32 v38, 8, v38
    v_bfe_u32 v39, v0, 1, 1
    v_lshl_add_u32 v38, v39, 7, v38
    v_bfe_u32 v39, v0, 2, 1
    v_lshl_add_u32 v38, v39, 4, v38
    v_and_b32 v39, 1, v0
    v_lshl_add_u32 v38, v39, 2, v38
    v_add_u32 v38, s57, v38
    v_add_u32 v38, 1024, v38
    v_cmp_gt_u32 vcc, 32, v0
    s_nop 1
    v_cndmask_b32 v3, v38, v3, vcc
    s_lshl_b32 s57, s53, 1
    s_add_u32 s57, s57, s30
    s_mul_i32 s57, s57, 1536
    s_add_u32 s57, s57, s62
    v_add_u32 v3, s57, v3
    v_mov_b32 v38, 0x7f000000
    v_cmp_le_u32 vcc, 48, v0
    s_nop 1
    v_cndmask_b32 v3, v3, v38, vcc
    v_and_b32 v4, 7, v0
    v_lshlrev_b32 v4, 3, v4
    v_add_u32 v4, 159744, v4
    s_lshl_b32 s57, s53, 3
    s_add_u32 s57, s57, s54
    s_lshl_b32 s57, s57, 2
    s_add_u32 s57, s57, s62
    s_add_u32 s57, s57, 55808
    v_add_u32 v23, s30, v0
    v_lshlrev_b32 v23, 24, v23
L_mw_88:
    ds_read_b64 v[38:39], v4 offset:0
    s_waitcnt lgkmcnt(0)
    v_max_f32_dpp v37, v38, v38 row_ror:4 row_mask:0xf bank_mask:0xf
    s_cmp_eq_u32 s55, 0
    s_nop 0
    v_max_f32_dpp v37, v37, v37 row_ror:2 row_mask:0xf bank_mask:0xf
    s_nop 1
    v_max_f32_dpp v37, v37, v37 row_ror:1 row_mask:0xf bank_mask:0xf
    v_sub_f32 v38, v38, v37
    v_exp_f32 v38, v38
    s_nop 0
    v_mul_f32 v39, v38, v39
    s_nop 1
    v_add_f32_dpp v39, v39, v39 row_ror:4 row_mask:0xf bank_mask:0xf
    s_nop 1
    v_add_f32_dpp v39, v39, v39 row_ror:2 row_mask:0xf bank_mask:0xf
    s_nop 1
    v_add_f32_dpp v39, v39, v39 row_ror:1 row_mask:0xf bank_mask:0xf
    v_rcp_f32 v21, v39
    v_log_f32 v22, v39
    v_mul_f32 v38, v38, v21
    v_add_f32 v22, v22, v37
    v_min_u32 v22, -2, v22
    s_cbranch_scc1 L_gs_90
    buffer_store_dword v22, v23, s[40:43], s57 offen
L_gb_91:
    v_readlane_b32 s64, v38, 0
    v_readlane_b32 s65, v38, 1
    v_readlane_b32 s66, v38, 2
    v_readlane_b32 s67, v38, 3
    v_readlane_b32 s68, v38, 4
    v_readlane_b32 s69, v38, 5
    v_readlane_b32 s70, v38, 6
    v_readlane_b32 s71, v38, 7
L_skip_87:
    s_waitcnt vmcnt(36)
    s_barrier
    ds_read_b64_tr_b16 v[226:227], v8 offset:16384
    ds_read_b64_tr_b16 v[234:235], v9 offset:16384
    ds_read_b64_tr_b16 v[242:243], v10 offset:16384
    ds_read_b64_tr_b16 v[250:251], v11 offset:16384
    s_cmp_eq_u32 s30, 6
    s_cbranch_scc0 L_skip_92
    s_mov_b32 s57, 786688
    s_mov_b32 s58, 1178880
    s_mov_b32 m0, 92160
L_dma_93:
    s_waitcnt vmcnt(25)
    buffer_load_dwordx4 v7, s[36:39], s57 offen offset:0 nt lds
    s_waitcnt vmcnt(25)
    buffer_load_dwordx4 v7, s[36:39], s58 offen offset:1024 nt lds
    s_add_u32 s57, s57, 24576
    s_add_u32 s58, s58, 24576
    s_add_u32 m0, m0, 2048
    s_cmp_lg_u32 m0, 108544
    s_cbranch_scc1 L_dma_93
L_skip_92:
    s_waitcnt lgkmcnt(0)
    s_cmp_eq_u32 s30, 5
    s_cbranch_scc0 L_skip_94
    global_load_dword v2, v3, s[26:27] offset:4 sc1
L_skip_94:
    s_waitcnt vmcnt(34)
    s_barrier
    ds_read_b64_tr_b16 v[164:165], v8 offset:32768
    ds_read_b64_tr_b16 v[172:173], v9 offset:32768
    ds_read_b64_tr_b16 v[180:181], v10 offset:32768
    ds_read_b64_tr_b16 v[188:189], v11 offset:32768
    s_cmp_eq_u32 s30, 6
    s_cbranch_scc0 L_skip_95
    s_mov_b32 s57, 983040
    s_mov_b32 s58, 1375232
    s_mov_b32 m0, 108544
L_dma_96:
    s_waitcnt vmcnt(25)
    buffer_load_dwordx4 v7, s[36:39], s57 offen offset:0 nt lds
    s_waitcnt vmcnt(25)
    buffer_load_dwordx4 v7, s[36:39], s58 offen offset:1024 nt lds
    s_add_u32 s57, s57, 24576
    s_add_u32 s58, s58, 24576
    s_add_u32 m0, m0, 2048
    s_cmp_lg_u32 m0, 124928
    s_cbranch_scc1 L_dma_96
L_skip_95:
    s_waitcnt lgkmcnt(0)
    s_waitcnt vmcnt(32)
    s_barrier
    ds_read_b64_tr_b16 v[196:197], v8 offset:49152
    ds_read_b64_tr_b16 v[204:205], v9 offset:49152
    ds_read_b64_tr_b16 v[212:213], v10 offset:49152
    ds_read_b64_tr_b16 v[220:221], v11 offset:49152
    s_cmp_eq_u32 s30, 6
    s_cbranch_scc0 L_skip_97
    s_mov_b32 s57, 983168
    s_mov_b32 s58, 1375360
    s_mov_b32 m0, 124928
L_dma_98:
    s_waitcnt vmcnt(25)
    buffer_load_dwordx4 v7, s[36:39], s57 offen offset:0 nt lds
    s_waitcnt vmcnt(25)
    buffer_load_dwordx4 v7, s[36:39], s58 offen offset:1024 nt lds
    s_add_u32 s57, s57, 24576
    s_add_u32 s58, s58, 24576
    s_add_u32 m0, m0, 2048
    s_cmp_lg_u32 m0, 141312
    s_cbranch_scc1 L_dma_98
L_skip_97:
    s_waitcnt lgkmcnt(0)
    s_cmp_eq_u32 s30, 5
    s_cbranch_scc0 L_skip_99
L_cw_100:
    s_waitcnt vmcnt(0)
    v_cmp_eq_u32 vcc, 0, v2
    s_cbranch_vccnz L_cr_101
    v_add_u32_dpp v2, v2, v2 row_ror:4 row_mask:0xf bank_mask:0xf
    s_nop 1
    v_add_u32_dpp v2, v2, v2 row_ror:2 row_mask:0xf bank_mask:0xf
    s_nop 1
    v_add_u32_dpp v2, v2, v2 row_ror:1 row_mask:0xf bank_mask:0xf
    v_mov_b32 v37, 160772
    ds_write_b32 v37, v2
    s_waitcnt lgkmcnt(0)
L_skip_99:
    s_cmp_eq_u32 s30, 2
    s_cbranch_scc0 L_skip_102
    s_mul_i32 s57, s52, 1792
    s_add_u32 s57, s57, s62
    v_min_u32 v37, 13, v0
    v_lshlrev_b32 v37, 7, v37
    buffer_load_dword v37, v37, s[40:43], s57 offen sc1 nt
L_skip_102:
    s_waitcnt vmcnt(32)
    s_barrier
    ds_read_b64_tr_b16 v[228:229], v8 offset:0
    ds_read_b64_tr_b16 v[236:237], v9 offset:0
    ds_read_b64_tr_b16 v[244:245], v10 offset:0
    ds_read_b64_tr_b16 v[252:253], v11 offset:0
    s_cmp_eq_u32 s30, 6
    s_cbranch_scc0 L_skip_103
    s_mov_b32 s57, 983296
    s_mov_b32 s58, 1375488
    s_mov_b32 m0, 141312
L_dma_104:
    s_waitcnt vmcnt(25)
    buffer_load_dwordx4 v7, s[36:39], s57 offen offset:0 nt lds
    s_waitcnt vmcnt(25)
    buffer_load_dwordx4 v7, s[36:39], s58 offen offset:1024 nt lds
    s_add_u32 s57, s57, 24576
    s_add_u32 s58, s58, 24576
    s_add_u32 m0, m0, 2048
    s_cmp_lg_u32 m0, 157696
    s_cbranch_scc1 L_dma_104
L_skip_103:
    s_waitcnt lgkmcnt(0)
    s_cmp_eq_u32 s30, 7
    s_cbranch_scc0 L_skip_105
    v_mov_b32 v37, 160772
    ds_read_b32 v37, v37
    s_lshr_b32 s58, s63, 2
    s_waitcnt lgkmcnt(0)
    v_readfirstlane_b32 s57, v37
    s_cmp_gt_u32 s57, 136
    s_cselect_b32 s57, 1, 0
    s_xor_b32 s57, s57, s58
    s_lshl_b32 s57, s57, 13
    s_add_u32 s7, s8, s57
L_skip_105:
    s_branch L_tail
.p2align 10
L_tail:
L_pad0:
    s_cbranch_execz L_pad4
    s_waitcnt vmcnt(32)
    s_barrier
    ds_read_b64_tr_b16 v[166:167], v8 offset:16384
    ds_read_b64_tr_b16 v[174:175], v9 offset:16384
    ds_read_b64_tr_b16 v[182:183], v10 offset:16384
    ds_read_b64_tr_b16 v[190:191], v11 offset:16384
    s_waitcnt lgkmcnt(0)
    s_cmp_lt_u32 s30, 5
    s_cbranch_scc0 L_skip_106
    s_waitcnt vmcnt(0)
L_skip_106:
    v_smfmac_f32_16x16x64_bf16 v[40:43], v[12:15], v[160:167], v1
    v_smfmac_f32_16x16x64_bf16 v[40:43], v[16:19], v[168:175], v1
    v_smfmac_f32_16x16x64_bf16 v[44:47], v[12:15], v[176:183], v1
    v_smfmac_f32_16x16x64_bf16 v[44:47], v[16:19], v[184:191], v1
    s_cmp_eq_u32 s30, 6
    s_cbranch_scc0 L_skip_107
    s_mul_i32 s57, s14, 16
    s_add_u32 s58, s57, s15
    s_mov_b32 m0, 63488
L_dma_108:
    s_waitcnt vmcnt(33)
    buffer_load_dwordx4 v3, s[48:51], s57 offen offset:0 nt lds
    s_waitcnt vmcnt(33)
    buffer_load_dwordx4 v3, s[48:51], s58 offen offset:1024 nt lds
    s_add_u32 s57, s57, s14
    s_add_u32 s58, s58, s14
    s_add_u32 m0, m0, 2048
    s_cmp_lg_u32 m0, 71680
    s_cbranch_scc1 L_dma_108
    s_mul_i32 s57, s14, 20
    s_add_u32 s58, s57, s15
    s_mov_b32 m0, 71680
L_dma_109:
    s_waitcnt vmcnt(33)
    buffer_load_dwordx4 v3, s[48:51], s57 offen offset:0 nt lds
    s_waitcnt vmcnt(33)
    buffer_load_dwordx4 v3, s[48:51], s58 offen offset:1024 nt lds
    s_add_u32 s57, s57, s14
    s_add_u32 s58, s58, s14
    s_add_u32 m0, m0, 2048
    s_cmp_lg_u32 m0, 79872
    s_cbranch_scc1 L_dma_109
L_skip_107:
    s_nop 3
    v_pk_add_f32 v[24:25], v[40:41], v[42:43]
    s_nop 0
    v_pk_add_f32 v[26:27], v[44:45], v[46:47]
    s_waitcnt vmcnt(32)
    s_barrier
    ds_read_b64_tr_b16 v[198:199], v8 offset:32768
    ds_read_b64_tr_b16 v[206:207], v9 offset:32768
    ds_read_b64_tr_b16 v[214:215], v10 offset:32768
    ds_read_b64_tr_b16 v[222:223], v11 offset:32768
    s_waitcnt lgkmcnt(0)
    v_smfmac_f32_16x16x64_bf16 v[48:51], v[12:15], v[192:199], v1
    v_smfmac_f32_16x16x64_bf16 v[48:51], v[16:19], v[200:207], v1
    v_smfmac_f32_16x16x64_bf16 v[52:55], v[12:15], v[208:215], v1
    v_smfmac_f32_16x16x64_bf16 v[52:55], v[16:19], v[216:223], v1
    s_nop 5
    v_pk_add_f32 v[28:29], v[48:49], v[50:51]
    s_nop 0
    v_pk_add_f32 v[30:31], v[52:53], v[54:55]
    ds_write_b128 v36, v[24:27] offset:0
    ds_write_b128 v36, v[28:31] offset:1024
    s_waitcnt vmcnt(16)
    s_barrier
    ds_read_b64_tr_b16 v[230:231], v8 offset:49152
    ds_read_b64_tr_b16 v[238:239], v9 offset:49152
    ds_read_b64_tr_b16 v[246:247], v10 offset:49152
    ds_read_b64_tr_b16 v[254:255], v11 offset:49152
    s_waitcnt lgkmcnt(0)
    v_smfmac_f32_16x16x64_bf16 v[56:59], v[12:15], v[224:231], v1
    v_smfmac_f32_16x16x64_bf16 v[56:59], v[16:19], v[232:239], v1
    v_smfmac_f32_16x16x64_bf16 v[60:63], v[12:15], v[240:247], v1
    v_smfmac_f32_16x16x64_bf16 v[60:63], v[16:19], v[248:255], v1
    s_setprio 0
    s_cmp_lt_u32 s30, 2
    s_mov_b64 exec, 0xffff
    s_nop 2
    v_pk_add_f32 v[32:33], v[56:57], v[58:59]
    s_nop 0
    v_pk_add_f32 v[34:35], v[60:61], v[62:63]
    ds_write_b128 v36, v[32:35] offset:2048
    s_mov_b64 exec, -1
    s_cbranch_scc1 L_comb_0
    s_waitcnt lgkmcnt(0)
L_pad1:
    s_cbranch_execz L_pad5
    s_barrier
L_comb_0b:
    s_cmp_eq_u32 s30, 6
    s_cbranch_scc0 L_skip_112
    s_waitcnt vmcnt(0)
L_skip_112:
    s_barrier
    s_cmp_lt_u32 s3, 20
    s_cbranch_scc0 L_typeB_0
    s_lshr_b32 s57, s30, 1
    s_lshl_b32 s57, s57, 5
    s_add_u32 s57, s57, s62
    s_add_u32 s59, s57, 55808
    v_and_b32 v5, 7, v0
    v_lshlrev_b32 v5, 2, v5
    v_lshrrev_b32 v22, 4, v0
    v_lshlrev_b32 v22, 3, v22
    buffer_load_dword v18, v5, s[40:43], s59 offen sc1
    buffer_load_dwordx2 v[20:21], v22, s[40:43], s59 offen sc1
    s_mul_i32 s57, s30, 6144
    v_lshrrev_b32 v7, 2, v0
    v_lshlrev_b32 v7, 6, v7
    v_bfe_u32 v60, v0, 4, 1
    v_lshl_add_u32 v7, v60, 5, v7
    v_and_b32 v60, 3, v0
    v_lshl_add_u32 v7, v60, 3, v7
    v_add_u32 v7, s57, v7
    v_add_u32 v7, 30720, v7
    v_xor_b32 v8, 32, v7
    s_mul_i32 s60, s30, 1536
    s_add_u32 s60, s60, s62
    s_add_u32 s60, s60, 0
    v_lshlrev_b32 v9, 4, v0
    v_lshlrev_b32 v10, 3, v0
    ds_read_b64_tr_b16 v[36:37], v7 offset:0
    ds_read_b64_tr_b16 v[38:39], v7 offset:1024
    ds_read_b64_tr_b16 v[40:41], v7 offset:2048
    ds_read_b64_tr_b16 v[42:43], v7 offset:3072
    ds_read_b64_tr_b16 v[44:45], v7 offset:4096
    ds_read_b64_tr_b16 v[46:47], v7 offset:5120
    ds_read_b64_tr_b16 v[48:49], v8 offset:0
    ds_read_b64_tr_b16 v[50:51], v8 offset:1024
    ds_read_b64_tr_b16 v[52:53], v8 offset:2048
    ds_read_b64_tr_b16 v[54:55], v8 offset:3072
    ds_read_b64_tr_b16 v[56:57], v8 offset:4096
    ds_read_b64_tr_b16 v[58:59], v8 offset:5120
    v_mov_b64 v[24:25], 0
    v_mov_b64 v[26:27], 0
    v_mov_b64 v[28:29], 0
    v_mov_b64 v[30:31], 0
    s_lshl_b32 s57, s30, 8
    v_lshlrev_b32 v11, 2, v0
    v_add_u32 v11, s57, v11
    v_add_u32 v11, 157696, v11
    v_lshlrev_b32 v32, 2, v0
    v_add_u32 v32, 157696, v32
    s_add_u32 s58, s6, 0
    s_add_u32 s57, s58, 16384
    v_and_b32 v33, 15, v0
    v_lshlrev_b32 v33, 2, v33
    v_lshrrev_b32 v60, 5, v0
    v_lshl_add_u32 v33, v60, 6, v33
    v_bfe_u32 v60, v0, 4, 1
    v_lshl_add_u32 v33, v60, 13, v33
    s_lshl_b32 s74, s3, 2
    s_add_u32 s74, s74, s62
    s_add_u32 s74, s74, 56064
    s_xor_b32 s75, s30, 3
    v_add_u32 v34, s75, v0
    v_lshlrev_b32 v34, 24, v34
    s_branch L_pw_113
L_pr_114:
    buffer_load_dword v18, v5, s[40:43], s59 offen sc1
    buffer_load_dwordx2 v[20:21], v22, s[40:43], s59 offen sc1
    s_sub_u32 s56, s56, 1
    s_cbranch_scc1 L_done
L_pw_113:
    s_waitcnt vmcnt(0)
    v_max3_u32 v19, v18, v20, v21
    v_cmp_eq_u32 vcc, -1, v19
    s_cbranch_vccnz L_pr_114
    buffer_load_dwordx4 v[12:15], v9, s[40:43], s60 offen sc1
    buffer_load_dwordx2 v[16:17], v10, s[40:43], s60 offen offset:1024 sc1
    v_max_f32_dpp v19, v18, v18 row_ror:4 row_mask:0xf bank_mask:0xf
    s_nop 1
    v_max_f32_dpp v19, v19, v19 row_ror:2 row_mask:0xf bank_mask:0xf
    s_nop 1
    v_max_f32_dpp v19, v19, v19 row_ror:1 row_mask:0xf bank_mask:0xf
    v_sub_f32 v18, v18, v19
    v_sub_f32 v20, v20, v19
    v_sub_f32 v21, v21, v19
    v_exp_f32 v18, v18
    v_exp_f32 v20, v20
    v_exp_f32 v21, v21
    v_add_f32_dpp v18, v18, v18 row_ror:4 row_mask:0xf bank_mask:0xf
L_pad2:
    s_cbranch_execz L_pad6
    s_nop 1
    v_add_f32_dpp v18, v18, v18 row_ror:2 row_mask:0xf bank_mask:0xf
    s_nop 1
    v_add_f32_dpp v18, v18, v18 row_ror:1 row_mask:0xf bank_mask:0xf
    v_rcp_f32 v18, v18
    s_nop 0
    v_mul_f32 v20, v20, v18
    v_mul_f32 v21, v21, v18
    s_waitcnt lgkmcnt(0)
    s_branch L_pw_115
L_pr_116:
    buffer_load_dwordx4 v[12:15], v9, s[40:43], s60 offen sc1
    buffer_load_dwordx2 v[16:17], v10, s[40:43], s60 offen offset:1024 sc1
    s_sub_u32 s56, s56, 1
    s_cbranch_scc1 L_done
L_pw_115:
    s_waitcnt vmcnt(0)
    v_max3_u32 v19, v12, v13, v14
    v_max3_u32 v19, v19, v15, v16
    v_max_u32 v19, v19, v17
    v_cmp_eq_u32 vcc, -1, v19
    s_cbranch_vccnz L_pr_116
    v_smfmac_f32_16x16x64_bf16 v[24:27], v[12:15], v[36:43], v1
    v_smfmac_f32_16x16x64_bf16 v[28:31], v[12:15], v[48:55], v1
    v_smfmac_f32_16x16x32_bf16 v[24:27], v[16:17], v[44:47], v1
    v_smfmac_f32_16x16x32_bf16 v[28:31], v[16:17], v[56:59], v1
    s_nop 6
    v_pk_add_f32 v[24:25], v[24:25], v[26:27]
    v_pk_add_f32 v[28:29], v[28:29], v[30:31]
    v_mul_f32 v24, v24, v20
    v_mul_f32 v28, v28, v20
    v_fmac_f32 v24, v25, v21
    v_fmac_f32 v28, v29, v21
    s_nop 1
    v_permlane32_swap_b32 v24, v28
    v_add_f32 v24, v24, v28
    ds_write_b32 v11, v24
    s_cmp_eq_u32 s30, 2
    s_cbranch_scc1 L_fin_117
    s_cmp_eq_u32 s55, 0
    s_waitcnt lgkmcnt(0)
    s_barrier
    s_cbranch_scc1 L_gs_119
    buffer_store_dword v0, v34, s[40:43], s74 offen
L_gb_120:
L_finb_118:
    s_sub_u32 s57, s30, 4
    s_cmp_lt_u32 s57, 3
    s_cbranch_scc0 L_skip_121
    s_sub_u32 s60, s30, 4
    s_lshl_b32 s59, s60, 12
    s_add_u32 s59, s59, 79872
    s_lshl_b32 s57, s60, 11
    v_lshlrev_b32 v11, 4, v0
    v_add_u32 v11, s57, v11
    s_add_u32 s58, s62, 49152
    buffer_load_dwordx4 v[12:15], v11, s[40:43], s58 offen offset:0 sc1
    buffer_load_dwordx4 v[16:19], v11, s[40:43], s58 offen offset:1024 sc1
    s_mov_b32 s44, s20
    s_mov_b32 s45, s21
    s_mov_b32 s46, 1966080
    s_mov_b32 s47, 0x20000
    s_mul_i32 s57, s31, 3
    s_add_u32 s57, s57, s60
    s_mul_i32 s57, s57, 81920
    s_lshl_b32 s64, s3, 6
    s_add_u32 s57, s57, s64
    v_lshrrev_b32 v5, 2, v0
    v_mul_u32_u24 v5, 1280, v5
    v_and_b32 v60, 3, v0
    v_lshl_add_u32 v5, v60, 4, v5
    v_add_u32 v5, s57, v5
    s_add_u32 m0, s59, 0
    s_mov_b32 s57, 0
    buffer_load_dwordx4 v5, s[44:47], s57 offen nt lds
    s_add_u32 m0, s59, 1024
    s_mov_b32 s57, 20480
    buffer_load_dwordx4 v5, s[44:47], s57 offen nt lds
    s_add_u32 m0, s59, 2048
    s_mov_b32 s57, 40960
    buffer_load_dwordx4 v5, s[44:47], s57 offen nt lds
    s_add_u32 m0, s59, 3072
    s_mov_b32 s57, 61440
    buffer_load_dwordx4 v5, s[44:47], s57 offen nt lds
    v_lshrrev_b32 v35, 4, v0
    v_lshlrev_b32 v35, 9, v35
    v_bfe_u32 v60, v0, 2, 2
    v_lshl_add_u32 v35, v60, 6, v35
    v_and_b32 v60, 3, v0
    v_lshl_add_u32 v35, v60, 3, v35
    v_add_u32 v35, s59, v35
    s_waitcnt vmcnt(4)
L_sw_122:
    v_max3_u32 v60, v12, v13, v14
L_pad3:
    s_cbranch_execz L_pad7
    v_max3_u32 v60, v60, v15, v16
    v_max3_u32 v60, v60, v17, v18
    v_max_u32 v60, v60, v19
    v_cmp_eq_u32 vcc, -1, v60
    s_cbranch_vccnz L_sr_123
    v_pk_add_f32 v[20:21], v[12:13], v[14:15]
    v_pk_add_f32 v[22:23], v[16:17], v[18:19]
    v_pk_add_f32 v[20:21], v[20:21], v[22:23]
    v_add_f32 v8, v20, v21
    v_mov_b64 v[52:53], 0
    v_mov_b64 v[54:55], 0
    v_mov_b64 v[56:57], 0
    v_mov_b64 v[58:59], 0
    v_mov_b32 v9, 0xbdd2d3e8
    v_mov_b32 v10, 0xc0135761
    s_lshl_b32 s57, s60, 7
    s_add_u32 s57, s57, 159872
    v_lshlrev_b32 v32, 3, v0
    v_add_u32 v32, s57, v32
    v_lshlrev_b32 v33, 3, v0
    v_add_u32 v33, 129024, v33
    v_cmp_gt_u32 vcc, 16, v0
    s_nop 1
    v_cndmask_b32 v32, v33, v32, vcc
    v_and_b32 v33, 15, v0
    v_lshlrev_b32 v33, 3, v33
    v_lshrrev_b32 v60, 5, v0
    v_lshl_add_u32 v33, v60, 2, v33
    v_add_u32 v33, 159872, v33
    v_and_b32 v34, 15, v0
    v_lshlrev_b32 v34, 2, v34
    v_lshrrev_b32 v60, 5, v0
    v_lshl_add_u32 v34, v60, 6, v34
    v_bfe_u32 v60, v0, 4, 1
    v_lshl_add_u32 v34, v60, 13, v34
    s_add_u32 s60, s6, 131072
    s_add_u32 s59, s60, 16384
    s_lshl_b32 s74, s3, 2
    s_add_u32 s74, s74, s62
    s_add_u32 s74, s74, 56448
    s_xor_b32 s75, s30, 4
    s_lshl_b32 s75, s75, 24
    v_and_b32 v5, 3, v0
    v_lshlrev_b32 v5, 7, v5
    v_lshrrev_b32 v60, 2, v0
    v_lshl_add_u32 v5, v60, 24, v5
    v_add_u32 v5, s75, v5
    s_add_u32 s58, s62, 36864
    s_add_u32 s57, s62, 55552
    v_and_b32 v7, 7, v0
    v_lshlrev_b32 v7, 3, v7
    buffer_load_dwordx2 v[24:25], v7, s[40:43], s57 offen sc1
    buffer_load_dwordx4 v[12:15], v11, s[40:43], s58 offen offset:0 sc1
    buffer_load_dwordx4 v[16:19], v11, s[40:43], s58 offen offset:1024 sc1
    s_waitcnt vmcnt(3)
    ds_read_b64_tr_b16 v[36:37], v35 offset:0
    ds_read_b64_tr_b16 v[38:39], v35 offset:256
    ds_read_b64_tr_b16 v[40:41], v35 offset:2048
    ds_read_b64_tr_b16 v[42:43], v35 offset:2304
    ds_read_b64_tr_b16 v[44:45], v35 offset:32
    ds_read_b64_tr_b16 v[46:47], v35 offset:288
    ds_read_b64_tr_b16 v[48:49], v35 offset:2080
    ds_read_b64_tr_b16 v[50:51], v35 offset:2336
    s_waitcnt lgkmcnt(0)
L_pr_125:
    buffer_load_dwordx2 v[24:25], v7, s[40:43], s57 offen sc1
    buffer_load_dwordx4 v[12:15], v11, s[40:43], s58 offen offset:0 sc1
    buffer_load_dwordx4 v[16:19], v11, s[40:43], s58 offen offset:1024 sc1
    s_sub_u32 s56, s56, 1
    s_cbranch_scc1 L_done
L_pw_124:
    s_waitcnt vmcnt(5)
    v_max_u32 v26, v24, v25
    v_cmp_eq_u32 vcc, -1, v26
    s_cbranch_vccnz L_pr_125
    buffer_load_dwordx4 v[12:15], v11, s[40:43], s58 offen offset:0 sc1
    buffer_load_dwordx4 v[16:19], v11, s[40:43], s58 offen offset:1024 sc1
    v_add_f32_dpp v2, v24, v24 row_ror:4 row_mask:0xf bank_mask:0xf
    v_add_f32_dpp v3, v25, v25 row_ror:4 row_mask:0xf bank_mask:0xf
    s_nop 0
    v_add_f32_dpp v2, v2, v2 row_ror:2 row_mask:0xf bank_mask:0xf
    v_add_f32_dpp v3, v3, v3 row_ror:2 row_mask:0xf bank_mask:0xf
    s_nop 0
    v_add_f32_dpp v2, v2, v2 row_ror:1 row_mask:0xf bank_mask:0xf
    v_add_f32_dpp v3, v3, v3 row_ror:1 row_mask:0xf bank_mask:0xf
    v_mul_f32 v2, 0x3acccccd, v2
L_pad4:
    s_cbranch_execz L_pad8
    v_mul_f32 v3, 0x3acccccd, v3
    v_fma_f32 v3, -v2, v2, v3
    v_max_f32 v3, 0, v3
    v_add_f32 v3, 0x3727c5ac, v3
    v_rsq_f32 v3, v3
    s_nop 0
    v_mul_f32 v2, v2, v3
    v_fma_f32 v8, -v2, v8, v4
    s_waitcnt vmcnt(5)
L_hw_126:
    v_pk_add_f32 v[20:21], v[12:13], v[14:15]
    v_pk_add_f32 v[22:23], v[16:17], v[18:19]
    v_pk_add_f32 v[20:21], v[20:21], v[22:23]
    v_add_f32 v20, v20, v21
    v_cmp_u_f32 vcc, v20, v20
    v_fma_f32 v20, v20, v3, v8
    s_cbranch_vccnz L_hr_127
L_hk_128:
    v_mul_f32 v21, v20, v20
    v_fma_f32 v21, v21, v9, v10
    v_mul_f32 v21, v21, v20
    v_exp_f32 v21, v21
    s_cmp_eq_u32 s55, 0
    v_add_f32 v21, 1.0, v21
    v_rcp_f32 v21, v21
    s_nop 0
    v_mul_f32 v20, v20, v21
    s_nop 1
    v_mov_b32_dpp v21, v20 row_shl:1 row_mask:0xf bank_mask:0xf bound_ctrl:0
    v_cvt_pk_bf16_f32 v28, v20, v21
    s_nop 1
    v_mov_b32_dpp v29, v28 row_shl:4 row_mask:0xf bank_mask:0xf bound_ctrl:0
    v_mov_b32_dpp v30, v28 row_shl:8 row_mask:0xf bank_mask:0xf bound_ctrl:0
    v_mov_b32_dpp v31, v28 row_shl:12 row_mask:0xf bank_mask:0xf bound_ctrl:0
    s_nop 1
    v_smfmac_f32_16x16x64_bf16 v[52:55], v[28:31], v[36:43], v1
    v_smfmac_f32_16x16x64_bf16 v[56:59], v[28:31], v[44:51], v1
    s_nop 6
    v_add_f32 v22, v52, v54
    v_add_f32 v23, v56, v58
    ds_write_b64 v32, v[22:23]
    s_cmp_eq_u32 s30, 4
    s_cbranch_scc0 L_skip_130
L_xw_131:
    ds_read2_b32 v[20:21], v33 offset0:0 offset1:32
    ds_read_b32 v22, v33 offset:256
    s_cmp_eq_u32 s55, 0
    s_waitcnt lgkmcnt(0)
    v_max3_u32 v23, v20, v21, v22
    v_add_f32 v20, v20, v21
    v_cmp_eq_u32 vcc, -1, v23
    v_add_f32 v20, v20, v22
    s_cbranch_vccnz L_xr_132
    v_min_u32 v20, -2, v20
    buffer_store_dword v20, v34, s[40:43], s60 offen sc1
    s_cbranch_scc1 L_gs_133
    buffer_store_dword v0, v5, s[40:43], s74 offen
L_gb_134:
L_skip_130:
    s_waitcnt vmcnt(0)
L_skip_121:
    s_branch L_p1
L_typeB_0:
    s_cmp_eq_u32 s53, 3
    s_cbranch_scc0 L_p1
    s_cmp_eq_u32 s30, 7
    s_cbranch_scc1 L_w7_135
    s_cmp_lt_u32 s30, 6
    s_cbranch_scc0 L_skip_137
    s_lshr_b32 s57, s30, 1
    s_mul_i32 s57, s57, 128
    s_and_b32 s58, s30, 1
    s_lshl_b32 s58, s58, 6
    s_add_u32 s57, s57, s58
    v_lshrrev_b32 v18, 5, v0
    v_lshlrev_b32 v18, 13, v18
    v_bfe_u32 v60, v0, 3, 1
    v_lshl_add_u32 v18, v60, 12, v18
    v_bfe_u32 v60, v0, 4, 1
    v_lshl_add_u32 v18, v60, 11, v18
    v_bfe_u32 v60, v0, 2, 1
    v_mul_u32_u24 v60, 384, v60
    v_add_u32 v18, v60, v18
    v_and_b32 v60, 3, v0
    v_lshl_add_u32 v18, v60, 3, v18
    v_add_u32 v18, s57, v18
    v_add_u32 v18, 30720, v18
    v_bfe_u32 v19, v0, 4, 1
    v_lshlrev_b32 v19, 12, v19
    v_bfe_u32 v60, v0, 3, 1
    v_lshl_add_u32 v19, v60, 11, v19
    v_bfe_u32 v60, v0, 2, 1
    v_mul_u32_u24 v60, 384, v60
    v_add_u32 v19, v60, v19
    v_and_b32 v60, 3, v0
    v_lshl_add_u32 v19, v60, 3, v19
    v_add_u32 v19, s57, v19
L_pad5:
    s_cbranch_execz L_pad9
    v_add_u32 v19, 63488, v19
    ds_read_b64_tr_b16 v[36:37], v18 offset:0
    ds_read_b64_tr_b16 v[38:39], v18 offset:1024
    ds_read_b64_tr_b16 v[40:41], v18 offset:16384
    ds_read_b64_tr_b16 v[42:43], v18 offset:17408
    ds_read_b64_tr_b16 v[44:45], v19 offset:0
    ds_read_b64_tr_b16 v[46:47], v19 offset:1024
    ds_read_b64_tr_b16 v[48:49], v18 offset:32
    ds_read_b64_tr_b16 v[50:51], v18 offset:1056
    ds_read_b64_tr_b16 v[52:53], v18 offset:16416
    ds_read_b64_tr_b16 v[54:55], v18 offset:17440
    ds_read_b64_tr_b16 v[56:57], v19 offset:32
    ds_read_b64_tr_b16 v[58:59], v19 offset:1056
    v_lshrrev_b32 v32, 4, v0
    v_lshlrev_b32 v32, 5, v32
    v_bfe_u32 v60, v0, 1, 1
    v_lshl_add_u32 v32, v60, 4, v32
    v_and_b32 v60, 1, v0
    v_mul_u32_u24 v60, 192, v60
    v_add_u32 v32, v60, v32
    v_add_u32 v32, 160832, v32
    v_lshrrev_b32 v33, 4, v0
    v_lshlrev_b32 v33, 4, v33
    v_bfe_u32 v60, v0, 1, 1
    v_lshl_add_u32 v33, v60, 3, v33
    v_and_b32 v60, 1, v0
    v_mul_u32_u24 v60, 192, v60
    v_add_u32 v33, v60, v33
    v_add_u32 v33, 160960, v33
    v_mov_b64 v[24:25], 0
    v_mov_b64 v[26:27], 0
    v_mov_b64 v[28:29], 0
    v_mov_b64 v[30:31], 0
    s_lshr_b32 s57, s30, 1
    s_lshl_b32 s57, s57, 11
    s_and_b32 s58, s30, 1
    s_lshl_b32 s58, s58, 9
    s_add_u32 s57, s57, s58
    s_lshr_b32 s58, s54, 2
    s_lshl_b32 s58, s58, 10
    s_add_u32 s57, s57, s58
    s_and_b32 s58, s54, 3
    s_lshl_b32 s58, s58, 2
    s_add_u32 s57, s57, s58
    v_and_b32 v34, 31, v0
    v_lshlrev_b32 v34, 4, v34
    v_lshrrev_b32 v60, 5, v0
    v_lshl_add_u32 v34, v60, 30, v34
    v_add_u32 v34, s57, v34
    s_add_u32 s59, s62, 36864
    s_add_u32 s60, s62, 55552
    ds_read_b128 v[12:15], v32
    ds_read_b64 v[16:17], v33
    s_waitcnt lgkmcnt(1)
    v_smfmac_f32_16x16x64_bf16 v[24:27], v[12:15], v[36:43], v1
    v_smfmac_f32_16x16x64_bf16 v[28:31], v[12:15], v[48:55], v1
    s_waitcnt lgkmcnt(0)
    v_smfmac_f32_16x16x32_bf16 v[24:27], v[16:17], v[44:47], v1
    v_smfmac_f32_16x16x32_bf16 v[28:31], v[16:17], v[56:59], v1
    s_add_u32 s60, s62, 49152
    s_cmp_eq_u32 s55, 0
    s_nop 4
    v_add_f32 v12, v25, v27
    s_nop 1
    v_add_f32_dpp v12, v29, v31 quad_perm:[0,1,2,3] row_mask:0x2 bank_mask:0xf
    v_min_u32 v12, -2, v12
    s_cbranch_scc1 L_gs_138
    buffer_store_dword v12, v34, s[40:43], s60 offen
L_gb_139:
    v_mov_b64 v[24:25], 0
    v_mov_b64 v[26:27], 0
    v_mov_b64 v[28:29], 0
    v_mov_b64 v[30:31], 0
L_skip_137:
    s_cmp_lt_u32 s30, 6
    s_barrier
    s_cbranch_scc0 L_se_136
    ds_read_b128 v[12:15], v32
    ds_read_b64 v[16:17], v33
    s_waitcnt lgkmcnt(1)
    v_smfmac_f32_16x16x64_bf16 v[24:27], v[12:15], v[36:43], v1
    v_smfmac_f32_16x16x64_bf16 v[28:31], v[12:15], v[48:55], v1
    s_waitcnt lgkmcnt(0)
    v_smfmac_f32_16x16x32_bf16 v[24:27], v[16:17], v[44:47], v1
    v_smfmac_f32_16x16x32_bf16 v[28:31], v[16:17], v[56:59], v1
    s_cmp_eq_u32 s55, 0
    s_nop 5
    v_add_f32 v12, v24, v26
    s_nop 1
    v_add_f32_dpp v12, v28, v30 quad_perm:[0,1,2,3] row_mask:0x2 bank_mask:0xf
L_pad6:
    s_cbranch_execz L_pad10
    v_min_u32 v12, -2, v12
    s_cbranch_scc1 L_gs_140
    buffer_store_dword v12, v34, s[40:43], s59 offen
L_gb_141:
L_se_136:
L_p1:
    s_cmp_eq_u32 s30, 7
    s_cbranch_scc1 L_w7_149
    s_cmp_lt_u32 s30, 6
    s_cbranch_scc0 L_skip_151
    s_lshr_b32 s57, s30, 1
    s_mul_i32 s57, s57, 1024
    s_and_b32 s58, s30, 1
    s_lshl_b32 s58, s58, 6
    s_add_u32 s57, s57, s58
    v_lshrrev_b32 v18, 5, v0
    v_mul_u32_u24 v18, 6144, v18
    v_bfe_u32 v60, v0, 3, 1
    v_mul_u32_u24 v60, 3072, v60
    v_add_u32 v18, v60, v18
    v_bfe_u32 v60, v0, 4, 1
    v_lshl_add_u32 v18, v60, 9, v18
    v_bfe_u32 v60, v0, 2, 1
    v_lshl_add_u32 v18, v60, 7, v18
    v_and_b32 v60, 3, v0
    v_lshl_add_u32 v18, v60, 3, v18
    v_add_u32 v18, s57, v18
    v_bfe_u32 v19, v0, 4, 1
    v_mul_u32_u24 v19, 3072, v19
    v_bfe_u32 v60, v0, 3, 1
    v_lshl_add_u32 v19, v60, 9, v19
    v_bfe_u32 v60, v0, 2, 1
    v_lshl_add_u32 v19, v60, 7, v19
    v_and_b32 v60, 3, v0
    v_lshl_add_u32 v19, v60, 3, v19
    v_add_u32 v19, s57, v19
    v_add_u32 v19, 24576, v19
    ds_read_b64_tr_b16 v[36:37], v18 offset:0
    ds_read_b64_tr_b16 v[38:39], v18 offset:256
    ds_read_b64_tr_b16 v[40:41], v18 offset:12288
    ds_read_b64_tr_b16 v[42:43], v18 offset:12544
    ds_read_b64_tr_b16 v[44:45], v19 offset:0
    ds_read_b64_tr_b16 v[46:47], v19 offset:256
    ds_read_b64_tr_b16 v[48:49], v18 offset:32
    ds_read_b64_tr_b16 v[50:51], v18 offset:288
    ds_read_b64_tr_b16 v[52:53], v18 offset:12320
    ds_read_b64_tr_b16 v[54:55], v18 offset:12576
    ds_read_b64_tr_b16 v[56:57], v19 offset:32
    ds_read_b64_tr_b16 v[58:59], v19 offset:288
    v_lshrrev_b32 v32, 4, v0
    v_lshlrev_b32 v32, 5, v32
    v_bfe_u32 v60, v0, 1, 1
    v_lshl_add_u32 v32, v60, 4, v32
    v_and_b32 v60, 1, v0
    v_mul_u32_u24 v60, 192, v60
    v_add_u32 v32, v60, v32
    v_add_u32 v32, 160832, v32
    v_lshrrev_b32 v33, 4, v0
    v_lshlrev_b32 v33, 4, v33
    v_bfe_u32 v60, v0, 1, 1
    v_lshl_add_u32 v33, v60, 3, v33
    v_and_b32 v60, 1, v0
    v_mul_u32_u24 v60, 192, v60
    v_add_u32 v33, v60, v33
    v_add_u32 v33, 160960, v33
    v_mov_b64 v[24:25], 0
    v_mov_b64 v[26:27], 0
    v_mov_b64 v[28:29], 0
    v_mov_b64 v[30:31], 0
    s_lshr_b32 s57, s54, 1
    s_lshl_b32 s57, s57, 2
    s_and_b32 s58, s54, 1
    s_add_u32 s57, s57, s58
    s_lshl_b32 s57, s57, 4
    s_lshl_b32 s58, s30, 9
    s_add_u32 s57, s57, s58
    v_bfe_u32 v34, v0, 4, 1
    v_lshlrev_b32 v34, 8, v34
    v_bfe_u32 v60, v0, 1, 1
    v_lshl_add_u32 v34, v60, 5, v34
    v_bfe_u32 v60, v0, 2, 2
    v_lshl_add_u32 v34, v60, 2, v34
    v_lshrrev_b32 v60, 5, v0
    v_lshl_add_u32 v34, v60, 29, v34
    v_and_b32 v60, 1, v0
L_pad7:
    s_cbranch_execz L_pad11
    v_lshl_add_u32 v34, v60, 30, v34
    v_add_u32 v34, s57, v34
    s_mul_i32 s59, s53, 3072
    s_add_u32 s59, s59, s62
    s_add_u32 s59, s59, 24576
    s_lshl_b32 s60, s53, 6
    s_add_u32 s60, s60, s62
    s_add_u32 s60, s60, 55296
L_skip_151:
    s_cmp_lt_u32 s30, 6
    s_barrier
    s_cbranch_scc0 L_se_150
    ds_read_b128 v[12:15], v32
    ds_read_b64 v[16:17], v33
    s_waitcnt lgkmcnt(1)
    v_smfmac_f32_16x16x64_bf16 v[24:27], v[12:15], v[36:43], v1
    v_smfmac_f32_16x16x64_bf16 v[28:31], v[12:15], v[48:55], v1
    s_waitcnt lgkmcnt(0)
    v_smfmac_f32_16x16x32_bf16 v[24:27], v[16:17], v[44:47], v1
    v_smfmac_f32_16x16x32_bf16 v[28:31], v[16:17], v[56:59], v1
    s_cmp_eq_u32 s55, 0
    s_nop 5
    v_add_f32 v12, v24, v26
    s_nop 1
    v_add_f32_dpp v12, v28, v30 quad_perm:[0,1,2,3] row_mask:0x2 bank_mask:0xf
    s_nop 1
    v_mov_b32_dpp v13, v12 row_shl:1 row_mask:0xf bank_mask:0xf bound_ctrl:0
    v_cvt_pk_bf16_f32 v12, v12, v13
    v_min_u32 v12, -2, v12
    s_cbranch_scc1 L_gs_152
    buffer_store_dword v12, v34, s[40:43], s59 offen
L_gb_153:
L_se_150:
    v_lshlrev_b32 v5, 4, v0
    v_add_u32 v5, 124928, v5
    s_mul_i32 s59, s53, 3072
    s_add_u32 s59, s59, s62
    s_add_u32 s59, s59, 24576
    s_lshl_b32 s60, s53, 6
    s_add_u32 s60, s60, s62
    s_add_u32 s60, s60, 55296
    v_lshlrev_b32 v8, 4, v0
    s_cmp_eq_u32 s30, 2
    s_cbranch_scc1 L_q3_169
    s_cmp_eq_u32 s30, 3
    s_cbranch_scc1 L_q3_172
    s_cmp_eq_u32 s30, 1
    s_cbranch_scc0 L_qo_167
    buffer_load_dwordx4 v[12:15], v8, s[40:43], s59 offen offset:0 sc1
    v_mov_b64 v[24:25], 0
    v_mov_b64 v[26:27], 0
    v_mov_b64 v[28:29], 0
    v_mov_b64 v[30:31], 0
    v_mov_b64 v[32:33], 0
    v_mov_b64 v[34:35], 0
    v_mov_b64 v[36:37], 0
    v_mov_b64 v[38:39], 0
    v_mov_b64 v[40:41], 0
    v_mov_b64 v[42:43], 0
    v_mov_b64 v[44:45], 0
    v_mov_b64 v[46:47], 0
    v_mov_b64 v[48:49], 0
    v_mov_b64 v[50:51], 0
    v_mov_b64 v[52:53], 0
    v_mov_b64 v[54:55], 0
    v_mov_b64 v[56:57], 0
    v_mov_b64 v[58:59], 0
    v_mov_b64 v[60:61], 0
    v_mov_b64 v[62:63], 0
    s_lshl_b32 s58, s30, 3
    s_add_u32 s58, s58, 159808
    v_mov_b32 v11, s58
    v_lshlrev_b32 v10, 3, v0
    v_add_u32 v10, 157696, v10
    v_cmp_eq_u32 vcc, 63, v0
    s_nop 1
    v_cndmask_b32 v10, v10, v11, vcc
    s_lshl_b32 s57, s30, 12
    v_lshlrev_b32 v7, 4, v0
    v_add_u32 v7, s57, v7
    v_add_u32 v7, 92160, v7
    v_mov_b32 v11, 128000
L_pr_176:
    buffer_load_dwordx4 v[12:15], v8, s[40:43], s59 offen offset:0 sc1
    s_sub_u32 s56, s56, 1
    s_cbranch_scc1 L_done
L_pw_175:
    s_waitcnt vmcnt(1)
    v_max3_u32 v9, v12, v13, v14
    v_max_u32 v9, v9, v15
    v_cmp_eq_u32 vcc, -1, v9
    s_cbranch_vccnz L_pr_176
    ds_write_b128 v5, v[12:15] offset:0
L_qb_168:
    s_waitcnt lgkmcnt(0)
    s_barrier
    ds_read_b128 v[12:15], v5 offset:0
    ds_read_b128 v[16:19], v5 offset:1024
    ds_read_b128 v[20:23], v5 offset:2048
    ds_read_b64 v[8:9], v11
    s_cmp_lt_u32 s30, 4
    s_waitcnt lgkmcnt(3)
    v_smfmac_f32_16x16x64_bf16 v[24:27], v[12:15], v[64:71], v1
L_pad8:
    s_cbranch_execz L_pad12
    s_waitcnt lgkmcnt(2)
    v_smfmac_f32_16x16x64_bf16 v[24:27], v[16:19], v[72:79], v1
    s_waitcnt lgkmcnt(0)
    v_smfmac_f32_16x16x64_bf16 v[24:27], v[20:23], v[80:87], v1
    v_mul_f32 v8, v8, v6
    v_smfmac_f32_16x16x64_bf16 v[32:35], v[12:15], v[112:119], v1
    v_smfmac_f32_16x16x64_bf16 v[32:35], v[16:19], v[120:127], v1
    v_smfmac_f32_16x16x64_bf16 v[32:35], v[20:23], v[128:135], v1
    s_waitcnt vmcnt(0)
    v_smfmac_f32_16x16x64_bf16 v[28:31], v[12:15], v[88:95], v1
    v_smfmac_f32_16x16x64_bf16 v[28:31], v[16:19], v[96:103], v1
    v_smfmac_f32_16x16x64_bf16 v[28:31], v[20:23], v[104:111], v1
    v_smfmac_f32_16x16x64_bf16 v[36:39], v[12:15], v[136:143], v1
    v_pk_add_f32 v[24:25], v[24:25], v[26:27]
    v_add_f32 v24, v24, v25
    v_smfmac_f32_16x16x64_bf16 v[36:39], v[16:19], v[144:151], v1
    v_pk_add_f32 v[32:33], v[32:33], v[34:35]
    v_add_f32 v32, v32, v33
    v_smfmac_f32_16x16x64_bf16 v[36:39], v[20:23], v[152:159], v1
    s_nop 0
    v_permlane32_swap_b32 v24, v32
    v_add_f32 v24, v24, v32
    v_pk_add_f32 v[28:29], v[28:29], v[30:31]
    v_add_f32 v28, v28, v29
    s_nop 2
    v_pk_add_f32 v[36:37], v[36:37], v[38:39]
    v_add_f32 v36, v36, v37
    s_nop 1
    v_permlane32_swap_b32 v28, v36
    v_add_f32 v28, v28, v36
    s_nop 1
    v_permlane16_swap_b32 v24, v28
    v_add_f32 v24, v24, v28
    v_fma_f32 v24, v24, v9, v8
    s_mov_b32 vcc_lo, 0x55555555
    s_mov_b32 vcc_hi, 0x55555555
    v_max_f32_dpp v20, v24, v24 row_ror:8 row_mask:0xf bank_mask:0xf
    s_nop 1
    v_max_f32_dpp v20, v20, v20 row_ror:4 row_mask:0xf bank_mask:0xf
    s_nop 1
    v_max_f32_dpp v20, v20, v20 row_ror:2 row_mask:0xf bank_mask:0xf
    s_nop 1
    v_max_f32_dpp v20, v20, v20 row_ror:1 row_mask:0xf bank_mask:0xf
    s_nop 1
    v_max_f32_dpp v20, v20, v20 row_bcast:15 row_mask:0xa bank_mask:0xf
    s_nop 1
    v_max_f32_dpp v20, v20, v20 row_bcast:31 row_mask:0xc bank_mask:0xf
    s_nop 0
    v_readlane_b32 s57, v20, 63
    s_nop 1
    v_subrev_f32 v24, s57, v24
    v_exp_f32 v22, v24
    s_nop 1
    v_mov_b32_dpp v23, v22 row_shl:1 row_mask:0xf bank_mask:0xf bound_ctrl:0
    v_cvt_pk_bf16_f32 v23, v22, v23
    v_cndmask_b32 v12, 0, v23, vcc
    v_add_f32_dpp v21, v22, v22 row_ror:8 row_mask:0xf bank_mask:0xf
    s_nop 0
    v_mov_b32_dpp v13, v12 row_shl:4 row_mask:0xf bank_mask:0xf bound_ctrl:0
    v_mov_b32_dpp v14, v12 row_shl:8 row_mask:0xf bank_mask:0xf bound_ctrl:0
    v_mov_b32_dpp v15, v12 row_shl:12 row_mask:0xf bank_mask:0xf bound_ctrl:0
    v_add_f32_dpp v21, v21, v21 row_ror:4 row_mask:0xf bank_mask:0xf
    v_mov_b32_dpp v16, v12 row_shr:1 row_mask:0xf bank_mask:0xf bound_ctrl:0
    v_smfmac_f32_16x16x64_bf16 v[40:43], v[12:15], v[160:167], v1
    v_add_f32_dpp v21, v21, v21 row_ror:2 row_mask:0xf bank_mask:0xf
    v_mov_b32_dpp v17, v12 row_shl:3 row_mask:0xf bank_mask:0xf bound_ctrl:0
    v_smfmac_f32_16x16x64_bf16 v[44:47], v[12:15], v[176:183], v1
    v_add_f32_dpp v21, v21, v21 row_ror:1 row_mask:0xf bank_mask:0xf
    v_mov_b32_dpp v18, v12 row_shl:7 row_mask:0xf bank_mask:0xf bound_ctrl:0
    v_smfmac_f32_16x16x64_bf16 v[48:51], v[12:15], v[192:199], v1
    v_add_f32_dpp v21, v21, v21 row_bcast:15 row_mask:0xa bank_mask:0xf
    v_mov_b32_dpp v19, v12 row_shl:11 row_mask:0xf bank_mask:0xf bound_ctrl:0
    v_smfmac_f32_16x16x64_bf16 v[52:55], v[12:15], v[208:215], v1
    v_add_f32_dpp v21, v21, v21 row_bcast:31 row_mask:0xc bank_mask:0xf
    ds_write_b64 v10, v[20:21]
    v_smfmac_f32_16x16x64_bf16 v[40:43], v[16:19], v[168:175], v1
    s_nop 1
    v_smfmac_f32_16x16x64_bf16 v[44:47], v[16:19], v[184:191], v1
    s_nop 1
L_pad9:
    s_cbranch_execz L_pad13
    v_smfmac_f32_16x16x64_bf16 v[48:51], v[16:19], v[200:207], v1
    s_nop 1
    v_smfmac_f32_16x16x64_bf16 v[52:55], v[16:19], v[216:223], v1
    v_pk_add_f32 v[24:25], v[40:41], v[42:43]
    s_nop 0
    v_smfmac_f32_16x16x64_bf16 v[56:59], v[12:15], v[224:231], v1
    v_pk_add_f32 v[26:27], v[44:45], v[46:47]
    ds_write_b128 v7, v[24:27] offset:0
    v_smfmac_f32_16x16x64_bf16 v[60:63], v[12:15], v[240:247], v1
    v_pk_add_f32 v[28:29], v[48:49], v[50:51]
    s_nop 0
    v_smfmac_f32_16x16x64_bf16 v[56:59], v[16:19], v[232:239], v1
    v_pk_add_f32 v[30:31], v[52:53], v[54:55]
    ds_write_b128 v7, v[28:31] offset:1024
    v_smfmac_f32_16x16x64_bf16 v[60:63], v[16:19], v[248:255], v1
    s_cmp_lt_u32 s30, 2
    s_mov_b64 exec, 0xffff
    s_nop 2
    v_pk_add_f32 v[32:33], v[56:57], v[58:59]
    s_nop 1
    v_pk_add_f32 v[34:35], v[60:61], v[62:63]
    ds_write_b128 v7, v[32:35] offset:2048
    s_mov_b64 exec, -1
    s_cbranch_scc1 L_comb_1
    s_waitcnt lgkmcnt(0)
    s_barrier
L_comb_1b:
    s_cmp_lt_u32 s3, 20
    s_cbranch_scc0 L_typeB_1
    s_lshr_b32 s57, s30, 1
    s_lshl_b32 s57, s57, 5
    s_add_u32 s57, s57, s62
    s_add_u32 s59, s57, 55936
    v_and_b32 v5, 7, v0
    v_lshlrev_b32 v5, 2, v5
    v_lshrrev_b32 v22, 4, v0
    v_lshlrev_b32 v22, 3, v22
    buffer_load_dword v18, v5, s[40:43], s59 offen sc1
    buffer_load_dwordx2 v[20:21], v22, s[40:43], s59 offen sc1
    s_mul_i32 s57, s30, 6144
    v_lshrrev_b32 v7, 2, v0
    v_lshlrev_b32 v7, 6, v7
    v_bfe_u32 v60, v0, 4, 1
    v_lshl_add_u32 v7, v60, 5, v7
    v_and_b32 v60, 3, v0
    v_lshl_add_u32 v7, v60, 3, v7
    v_add_u32 v7, s57, v7
    v_add_u32 v7, 30720, v7
    v_xor_b32 v8, 32, v7
    s_mul_i32 s60, s30, 1536
    s_add_u32 s60, s60, s62
    s_add_u32 s60, s60, 12288
    v_lshlrev_b32 v9, 4, v0
    v_lshlrev_b32 v10, 3, v0
    ds_read_b64_tr_b16 v[36:37], v7 offset:0
    ds_read_b64_tr_b16 v[38:39], v7 offset:1024
    ds_read_b64_tr_b16 v[40:41], v7 offset:2048
    ds_read_b64_tr_b16 v[42:43], v7 offset:3072
    ds_read_b64_tr_b16 v[44:45], v7 offset:4096
    ds_read_b64_tr_b16 v[46:47], v7 offset:5120
    ds_read_b64_tr_b16 v[48:49], v8 offset:0
    ds_read_b64_tr_b16 v[50:51], v8 offset:1024
    ds_read_b64_tr_b16 v[52:53], v8 offset:2048
    ds_read_b64_tr_b16 v[54:55], v8 offset:3072
    ds_read_b64_tr_b16 v[56:57], v8 offset:4096
    ds_read_b64_tr_b16 v[58:59], v8 offset:5120
    v_mov_b64 v[24:25], 0
    v_mov_b64 v[26:27], 0
    v_mov_b64 v[28:29], 0
    v_mov_b64 v[30:31], 0
    s_lshl_b32 s57, s30, 8
    v_lshlrev_b32 v11, 2, v0
    v_add_u32 v11, s57, v11
    v_add_u32 v11, 157696, v11
    v_lshlrev_b32 v32, 2, v0
    v_add_u32 v32, 157696, v32
    s_add_u32 s58, s6, 262144
    s_add_u32 s57, s58, 16384
    v_and_b32 v33, 15, v0
    v_lshlrev_b32 v33, 2, v33
    v_lshrrev_b32 v60, 5, v0
    v_lshl_add_u32 v33, v60, 6, v33
    v_bfe_u32 v60, v0, 4, 1
    v_lshl_add_u32 v33, v60, 13, v33
L_pad10:
    s_cbranch_execz L_pad14
    s_lshl_b32 s74, s3, 2
    s_add_u32 s74, s74, s62
    s_add_u32 s74, s74, 56192
    s_xor_b32 s75, s30, 2
    v_add_u32 v34, s75, v0
    v_lshlrev_b32 v34, 24, v34
    s_branch L_pw_185
L_pr_186:
    buffer_load_dword v18, v5, s[40:43], s59 offen sc1
    buffer_load_dwordx2 v[20:21], v22, s[40:43], s59 offen sc1
    s_sub_u32 s56, s56, 1
    s_cbranch_scc1 L_done
L_pw_185:
    s_waitcnt vmcnt(0)
    v_max3_u32 v19, v18, v20, v21
    v_cmp_eq_u32 vcc, -1, v19
    s_cbranch_vccnz L_pr_186
    buffer_load_dwordx4 v[12:15], v9, s[40:43], s60 offen sc1
    buffer_load_dwordx2 v[16:17], v10, s[40:43], s60 offen offset:1024 sc1
    v_max_f32_dpp v19, v18, v18 row_ror:4 row_mask:0xf bank_mask:0xf
    s_nop 1
    v_max_f32_dpp v19, v19, v19 row_ror:2 row_mask:0xf bank_mask:0xf
    s_nop 1
    v_max_f32_dpp v19, v19, v19 row_ror:1 row_mask:0xf bank_mask:0xf
    v_sub_f32 v18, v18, v19
    v_sub_f32 v20, v20, v19
    v_sub_f32 v21, v21, v19
    v_exp_f32 v18, v18
    v_exp_f32 v20, v20
    v_exp_f32 v21, v21
    v_add_f32_dpp v18, v18, v18 row_ror:4 row_mask:0xf bank_mask:0xf
    s_nop 1
    v_add_f32_dpp v18, v18, v18 row_ror:2 row_mask:0xf bank_mask:0xf
    s_nop 1
    v_add_f32_dpp v18, v18, v18 row_ror:1 row_mask:0xf bank_mask:0xf
    v_rcp_f32 v18, v18
    s_nop 0
    v_mul_f32 v20, v20, v18
    v_mul_f32 v21, v21, v18
    s_waitcnt lgkmcnt(0)
    s_branch L_pw_187
L_pr_188:
    buffer_load_dwordx4 v[12:15], v9, s[40:43], s60 offen sc1
    buffer_load_dwordx2 v[16:17], v10, s[40:43], s60 offen offset:1024 sc1
    s_sub_u32 s56, s56, 1
    s_cbranch_scc1 L_done
L_pw_187:
    s_waitcnt vmcnt(0)
    v_max3_u32 v19, v12, v13, v14
    v_max3_u32 v19, v19, v15, v16
    v_max_u32 v19, v19, v17
    v_cmp_eq_u32 vcc, -1, v19
    s_cbranch_vccnz L_pr_188
    v_smfmac_f32_16x16x64_bf16 v[24:27], v[12:15], v[36:43], v1
    v_smfmac_f32_16x16x64_bf16 v[28:31], v[12:15], v[48:55], v1
    v_smfmac_f32_16x16x32_bf16 v[24:27], v[16:17], v[44:47], v1
    v_smfmac_f32_16x16x32_bf16 v[28:31], v[16:17], v[56:59], v1
    s_nop 6
    v_pk_add_f32 v[24:25], v[24:25], v[26:27]
    v_pk_add_f32 v[28:29], v[28:29], v[30:31]
    v_mul_f32 v24, v24, v20
    v_mul_f32 v28, v28, v20
    v_fmac_f32 v24, v25, v21
    v_fmac_f32 v28, v29, v21
    s_nop 1
    v_permlane32_swap_b32 v24, v28
    v_add_f32 v24, v24, v28
    ds_write_b32 v11, v24
    s_cmp_eq_u32 s30, 2
    s_cbranch_scc1 L_fin_189
    s_cmp_eq_u32 s55, 0
    s_waitcnt lgkmcnt(0)
    s_barrier
L_finb_190:
    s_sub_u32 s57, s30, 4
    s_cmp_lt_u32 s57, 3
    s_cbranch_scc0 L_skip_193
    s_sub_u32 s60, s30, 4
    s_lshl_b32 s59, s60, 12
    s_add_u32 s59, s59, 79872
    s_lshl_b32 s57, s60, 11
    v_lshlrev_b32 v11, 4, v0
    v_add_u32 v11, s57, v11
    s_add_u32 s58, s62, 49152
    buffer_load_dwordx4 v[12:15], v11, s[40:43], s58 offen offset:0 sc1
    buffer_load_dwordx4 v[16:19], v11, s[40:43], s58 offen offset:1024 sc1
    v_lshrrev_b32 v35, 4, v0
    v_lshlrev_b32 v35, 9, v35
    v_bfe_u32 v60, v0, 2, 2
    v_lshl_add_u32 v35, v60, 6, v35
    v_and_b32 v60, 3, v0
    v_lshl_add_u32 v35, v60, 3, v35
    v_add_u32 v35, s59, v35
    s_waitcnt vmcnt(0)
L_sw_194:
    v_max3_u32 v60, v12, v13, v14
    v_max3_u32 v60, v60, v15, v16
    v_max3_u32 v60, v60, v17, v18
    v_max_u32 v60, v60, v19
L_pad11:
    s_cbranch_execz L_pad15
    v_cmp_eq_u32 vcc, -1, v60
    s_cbranch_vccnz L_sr_195
    v_pk_add_f32 v[20:21], v[12:13], v[14:15]
    v_pk_add_f32 v[22:23], v[16:17], v[18:19]
    v_pk_add_f32 v[20:21], v[20:21], v[22:23]
    v_add_f32 v8, v20, v21
    v_mov_b64 v[52:53], 0
    v_mov_b64 v[54:55], 0
    v_mov_b64 v[56:57], 0
    v_mov_b64 v[58:59], 0
    v_mov_b32 v9, 0xbdd2d3e8
    v_mov_b32 v10, 0xc0135761
    s_lshl_b32 s57, s60, 7
    s_add_u32 s57, s57, 160256
    v_lshlrev_b32 v32, 3, v0
    v_add_u32 v32, s57, v32
    v_lshlrev_b32 v33, 3, v0
    v_add_u32 v33, 129024, v33
    v_cmp_gt_u32 vcc, 16, v0
    s_nop 1
    v_cndmask_b32 v32, v33, v32, vcc
    v_and_b32 v33, 15, v0
    v_lshlrev_b32 v33, 3, v33
    v_lshrrev_b32 v60, 5, v0
    v_lshl_add_u32 v33, v60, 2, v33
    v_add_u32 v33, 160256, v33
    v_and_b32 v34, 15, v0
    v_lshlrev_b32 v34, 2, v34
    v_lshrrev_b32 v60, 5, v0
    v_lshl_add_u32 v34, v60, 6, v34
    v_bfe_u32 v60, v0, 4, 1
    v_lshl_add_u32 v34, v60, 13, v34
    s_add_u32 s60, s6, 393216
    s_add_u32 s59, s60, 16384
    s_lshl_b32 s74, s3, 2
    s_add_u32 s74, s74, s62
    s_add_u32 s74, s74, 56320
    s_xor_b32 s75, s30, 4
    v_add_u32 v5, s75, v0
    v_lshlrev_b32 v5, 24, v5
    s_add_u32 s58, s62, 43008
    s_add_u32 s57, s62, 55680
    v_and_b32 v7, 7, v0
    v_lshlrev_b32 v7, 3, v7
    buffer_load_dwordx2 v[24:25], v7, s[40:43], s57 offen sc1
    buffer_load_dwordx4 v[12:15], v11, s[40:43], s58 offen offset:0 sc1
    buffer_load_dwordx4 v[16:19], v11, s[40:43], s58 offen offset:1024 sc1
    ds_read_b64_tr_b16 v[36:37], v35 offset:0
    ds_read_b64_tr_b16 v[38:39], v35 offset:256
    ds_read_b64_tr_b16 v[40:41], v35 offset:2048
    ds_read_b64_tr_b16 v[42:43], v35 offset:2304
    ds_read_b64_tr_b16 v[44:45], v35 offset:32
    ds_read_b64_tr_b16 v[46:47], v35 offset:288
    ds_read_b64_tr_b16 v[48:49], v35 offset:2080
    ds_read_b64_tr_b16 v[50:51], v35 offset:2336
    s_waitcnt lgkmcnt(0)
L_pr_197:
    buffer_load_dwordx2 v[24:25], v7, s[40:43], s57 offen sc1
    buffer_load_dwordx4 v[12:15], v11, s[40:43], s58 offen offset:0 sc1
    buffer_load_dwordx4 v[16:19], v11, s[40:43], s58 offen offset:1024 sc1
    s_sub_u32 s56, s56, 1
    s_cbranch_scc1 L_done
L_pw_196:
    s_waitcnt vmcnt(5)
    v_max_u32 v26, v24, v25
    v_cmp_eq_u32 vcc, -1, v26
    s_cbranch_vccnz L_pr_197
    buffer_load_dwordx4 v[12:15], v11, s[40:43], s58 offen offset:0 sc1
    buffer_load_dwordx4 v[16:19], v11, s[40:43], s58 offen offset:1024 sc1
    v_add_f32_dpp v2, v24, v24 row_ror:4 row_mask:0xf bank_mask:0xf
    v_add_f32_dpp v3, v25, v25 row_ror:4 row_mask:0xf bank_mask:0xf
    s_nop 0
    v_add_f32_dpp v2, v2, v2 row_ror:2 row_mask:0xf bank_mask:0xf
    v_add_f32_dpp v3, v3, v3 row_ror:2 row_mask:0xf bank_mask:0xf
    s_nop 0
    v_add_f32_dpp v2, v2, v2 row_ror:1 row_mask:0xf bank_mask:0xf
    v_add_f32_dpp v3, v3, v3 row_ror:1 row_mask:0xf bank_mask:0xf
    v_mul_f32 v2, 0x3acccccd, v2
    v_mul_f32 v3, 0x3acccccd, v3
    v_fma_f32 v3, -v2, v2, v3
    v_max_f32 v3, 0, v3
    v_add_f32 v3, 0x3727c5ac, v3
    v_rsq_f32 v3, v3
    s_nop 0
    v_mul_f32 v2, v2, v3
    v_fma_f32 v8, -v2, v8, v4
L_pad12:
    s_cbranch_execz L_pad16
    s_waitcnt vmcnt(5)
L_hw_198:
    v_pk_add_f32 v[20:21], v[12:13], v[14:15]
    v_pk_add_f32 v[22:23], v[16:17], v[18:19]
    v_pk_add_f32 v[20:21], v[20:21], v[22:23]
    v_add_f32 v20, v20, v21
    v_cmp_u_f32 vcc, v20, v20
    v_fma_f32 v20, v20, v3, v8
    s_cbranch_vccnz L_hr_199
L_hk_200:
    v_mul_f32 v21, v20, v20
    v_fma_f32 v21, v21, v9, v10
    v_mul_f32 v21, v21, v20
    v_exp_f32 v21, v21
    s_cmp_eq_u32 s55, 0
    v_add_f32 v21, 1.0, v21
    v_rcp_f32 v21, v21
    s_nop 0
    v_mul_f32 v20, v20, v21
    s_nop 1
    v_mov_b32_dpp v21, v20 row_shl:1 row_mask:0xf bank_mask:0xf bound_ctrl:0
    v_cvt_pk_bf16_f32 v28, v20, v21
    s_nop 1
    v_mov_b32_dpp v29, v28 row_shl:4 row_mask:0xf bank_mask:0xf bound_ctrl:0
    v_mov_b32_dpp v30, v28 row_shl:8 row_mask:0xf bank_mask:0xf bound_ctrl:0
    v_mov_b32_dpp v31, v28 row_shl:12 row_mask:0xf bank_mask:0xf bound_ctrl:0
    s_nop 1
    v_smfmac_f32_16x16x64_bf16 v[52:55], v[28:31], v[36:43], v1
    v_smfmac_f32_16x16x64_bf16 v[56:59], v[28:31], v[44:51], v1
    s_nop 6
    v_add_f32 v22, v52, v54
    v_add_f32 v23, v56, v58
    ds_write_b64 v32, v[22:23]
    s_cmp_eq_u32 s30, 4
    s_cbranch_scc0 L_skip_202
L_xw_203:
    ds_read2_b32 v[20:21], v33 offset0:0 offset1:32
    ds_read_b32 v22, v33 offset:256
    s_cmp_eq_u32 s55, 0
    s_waitcnt lgkmcnt(0)
    v_max3_u32 v23, v20, v21, v22
    v_add_f32 v20, v20, v21
    v_cmp_eq_u32 vcc, -1, v23
    v_add_f32 v20, v20, v22
    s_cbranch_vccnz L_xr_204
    v_min_u32 v20, -2, v20
    buffer_store_dword v20, v34, s[40:43], s60 offen sc1
    s_cbranch_scc1 L_gs_205
    buffer_store_dword v0, v5, s[40:43], s74 offen
L_gb_206:
L_skip_202:
L_skip_193:
    s_branch L_done
L_typeB_1:
    s_cmp_eq_u32 s53, 3
    s_cbranch_scc0 L_done
    s_cmp_eq_u32 s30, 7
    s_cbranch_scc1 L_w7_207
    s_cmp_lt_u32 s30, 6
    s_cbranch_scc0 L_skip_209
    s_lshr_b32 s57, s30, 1
    s_mul_i32 s57, s57, 128
    s_and_b32 s58, s30, 1
    s_lshl_b32 s58, s58, 6
    s_add_u32 s57, s57, s58
    v_lshrrev_b32 v18, 5, v0
    v_lshlrev_b32 v18, 13, v18
    v_bfe_u32 v60, v0, 3, 1
    v_lshl_add_u32 v18, v60, 12, v18
    v_bfe_u32 v60, v0, 4, 1
    v_lshl_add_u32 v18, v60, 11, v18
    v_bfe_u32 v60, v0, 2, 1
    v_mul_u32_u24 v60, 384, v60
    v_add_u32 v18, v60, v18
    v_and_b32 v60, 3, v0
    v_lshl_add_u32 v18, v60, 3, v18
    v_add_u32 v18, s57, v18
    v_add_u32 v18, 30720, v18
    v_bfe_u32 v19, v0, 4, 1
    v_lshlrev_b32 v19, 12, v19
    v_bfe_u32 v60, v0, 3, 1
    v_lshl_add_u32 v19, v60, 11, v19
    v_bfe_u32 v60, v0, 2, 1
    v_mul_u32_u24 v60, 384, v60
    v_add_u32 v19, v60, v19
    v_and_b32 v60, 3, v0
    v_lshl_add_u32 v19, v60, 3, v19
    v_add_u32 v19, s57, v19
    v_add_u32 v19, 63488, v19
    ds_read_b64_tr_b16 v[36:37], v18 offset:0
    ds_read_b64_tr_b16 v[38:39], v18 offset:1024
    ds_read_b64_tr_b16 v[40:41], v18 offset:16384
    ds_read_b64_tr_b16 v[42:43], v18 offset:17408
    ds_read_b64_tr_b16 v[44:45], v19 offset:0
L_pad13:
    s_cbranch_execz L_pad17
    ds_read_b64_tr_b16 v[46:47], v19 offset:1024
    ds_read_b64_tr_b16 v[48:49], v18 offset:32
    ds_read_b64_tr_b16 v[50:51], v18 offset:1056
    ds_read_b64_tr_b16 v[52:53], v18 offset:16416
    ds_read_b64_tr_b16 v[54:55], v18 offset:17440
    ds_read_b64_tr_b16 v[56:57], v19 offset:32
    ds_read_b64_tr_b16 v[58:59], v19 offset:1056
    v_lshrrev_b32 v32, 4, v0
    v_lshlrev_b32 v32, 5, v32
    v_bfe_u32 v60, v0, 1, 1
    v_lshl_add_u32 v32, v60, 4, v32
    v_and_b32 v60, 1, v0
    v_mul_u32_u24 v60, 192, v60
    v_add_u32 v32, v60, v32
    v_add_u32 v32, 160832, v32
    v_lshrrev_b32 v33, 4, v0
    v_lshlrev_b32 v33, 4, v33
    v_bfe_u32 v60, v0, 1, 1
    v_lshl_add_u32 v33, v60, 3, v33
    v_and_b32 v60, 1, v0
    v_mul_u32_u24 v60, 192, v60
    v_add_u32 v33, v60, v33
    v_add_u32 v33, 160960, v33
    v_mov_b64 v[24:25], 0
    v_mov_b64 v[26:27], 0
    v_mov_b64 v[28:29], 0
    v_mov_b64 v[30:31], 0
    s_lshr_b32 s57, s30, 1
    s_lshl_b32 s57, s57, 11
    s_and_b32 s58, s30, 1
    s_lshl_b32 s58, s58, 9
    s_add_u32 s57, s57, s58
    s_lshr_b32 s58, s54, 2
    s_lshl_b32 s58, s58, 10
    s_add_u32 s57, s57, s58
    s_and_b32 s58, s54, 3
    s_lshl_b32 s58, s58, 2
    s_add_u32 s57, s57, s58
    v_and_b32 v34, 31, v0
    v_lshlrev_b32 v34, 4, v34
    v_lshrrev_b32 v60, 5, v0
    v_lshl_add_u32 v34, v60, 30, v34
    v_add_u32 v34, s57, v34
    s_add_u32 s59, s62, 43008
    s_add_u32 s60, s62, 55680
L_skip_209:
    s_cmp_lt_u32 s30, 6
    s_barrier
    s_cbranch_scc0 L_se_208
    ds_read_b128 v[12:15], v32
    ds_read_b64 v[16:17], v33
    s_waitcnt lgkmcnt(1)
    v_smfmac_f32_16x16x64_bf16 v[24:27], v[12:15], v[36:43], v1
    v_smfmac_f32_16x16x64_bf16 v[28:31], v[12:15], v[48:55], v1
    s_waitcnt lgkmcnt(0)
    v_smfmac_f32_16x16x32_bf16 v[24:27], v[16:17], v[44:47], v1
    v_smfmac_f32_16x16x32_bf16 v[28:31], v[16:17], v[56:59], v1
    s_cmp_eq_u32 s55, 0
    s_nop 5
    v_add_f32 v12, v24, v26
    s_nop 1
    v_add_f32_dpp v12, v28, v30 quad_perm:[0,1,2,3] row_mask:0x2 bank_mask:0xf
    v_min_u32 v12, -2, v12
    s_cbranch_scc1 L_gs_210
    buffer_store_dword v12, v34, s[40:43], s59 offen
L_gb_211:
L_se_208:
    s_cmp_eq_u32 s30, 7
    s_cbranch_scc0 L_done
    s_cmp_eq_u32 s31, 0
    s_cbranch_scc0 L_done
    v_lshlrev_b32 v60, 16, v4
    v_add_f32 v2, v2, v60
    v_and_b32 v60, 0xffff0000, v4
    v_add_f32 v3, v3, v60
    v_and_b32 v60, 31, v0
    v_min_u32 v60, 19, v60
    s_mul_i32 s57, s54, 160
    v_lshrrev_b32 v7, 5, v0
    v_lshlrev_b32 v7, 2, v7
    v_add_u32 v7, s57, v7
    v_lshl_add_u32 v7, v60, 3, v7
    s_add_u32 s57, s7, 393216
    s_add_u32 s58, s7, 425984
    s_add_u32 s59, s7, 458752
    s_add_u32 s60, s7, 491520
    s_add_u32 s75, s62, 56320
    v_min_u32 v9, 19, v0
    v_lshlrev_b32 v9, 2, v9
    buffer_load_dword v12, v9, s[40:43], s75 offen sc1
    s_sleep 2
L_pr_223:
    buffer_load_dword v12, v9, s[40:43], s75 offen sc1
    s_sub_u32 s56, s56, 1
    s_cbranch_scc1 L_done
L_pw_222:
L_pad14:
    s_cbranch_execz L_pad18
    s_waitcnt vmcnt(1)
    v_cmp_eq_u32 vcc, -1, v12
    s_cbranch_vccnz L_pr_223
    buffer_load_dwordx4 v[12:15], v5, s[40:43], s57 offen sc1
    buffer_load_dwordx4 v[16:19], v5, s[40:43], s58 offen sc1
    buffer_load_dwordx4 v[20:23], v5, s[40:43], s59 offen sc1
    buffer_load_dwordx4 v[24:27], v5, s[40:43], s60 offen sc1
    s_sleep 2
L_gw_219:
    buffer_load_dwordx4 v[12:15], v5, s[40:43], s57 offen sc1
    buffer_load_dwordx4 v[16:19], v5, s[40:43], s58 offen sc1
    buffer_load_dwordx4 v[20:23], v5, s[40:43], s59 offen sc1
    buffer_load_dwordx4 v[24:27], v5, s[40:43], s60 offen sc1
    s_sub_u32 s56, s56, 1
    s_cbranch_scc1 L_done
    s_and_b32 s74, s56, 31
    s_waitcnt vmcnt(6)
    v_pk_add_f32 v[28:29], v[12:13], v[16:17]
    v_pk_add_f32 v[30:31], v[14:15], v[18:19]
    s_waitcnt vmcnt(5)
    v_pk_add_f32 v[28:29], v[28:29], v[20:21]
    v_pk_add_f32 v[30:31], v[30:31], v[22:23]
    s_waitcnt vmcnt(4)
    v_pk_add_f32 v[28:29], v[28:29], v[24:25]
    v_pk_add_f32 v[30:31], v[30:31], v[26:27]
    v_pk_add_f32 v[32:33], v[28:29], v[30:31]
    v_cmp_u_f32 vcc, v32, v33
    v_permlane32_swap_b32 v28, v30
    v_permlane32_swap_b32 v29, v31
    s_cbranch_vccnz L_gr_220
L_gk_221:
    v_pk_add_f32 v[28:29], v[28:29], v[30:31]
    v_pk_add_f32 v[28:29], v[28:29], v[2:3]
    v_cvt_pk_bf16_f32 v28, v28, v29
    global_store_dword v7, v28, s[24:25]
    s_branch L_done
L_gs_29:
    buffer_store_dword v33, v34, s[40:43], s67 offen sc1
    s_branch L_gb_30
L_gs_32:
    buffer_store_dword v12, v34, s[40:43], s59 offen sc1
    s_branch L_gb_33
L_cr_44:
    s_sub_u32 s56, s56, 1
    s_cbranch_scc1 L_done
    global_load_dword v2, v3, s[26:27] sc1
    s_waitcnt vmcnt(0)
    s_branch L_cw_43
L_far_45:
    s_lshl_b32 s57, s52, 2
    s_add_u32 s57, s57, s72
    s_mov_b64 exec, 1
    buffer_store_dword v25, v0, s[40:43], s57 offen offset:128 sc1
    s_mov_b64 exec, -1
    s_branch L_fb_46
L_cr_58:
    s_sub_u32 s56, s56, 1
    s_cbranch_scc1 L_done
    buffer_load_dword v2, v24, s[40:43], s72 offen sc1
    s_branch L_cw_57
L_gs_65:
    buffer_store_dword v33, v34, s[40:43], s67 offen sc1
    s_branch L_gb_66
L_gs_68:
    buffer_store_dword v12, v34, s[40:43], s59 offen sc1
    s_branch L_gb_69
L_gs_90:
    buffer_store_dword v22, v23, s[40:43], s57 offen sc1
    s_branch L_gb_91
L_cr_101:
    s_sub_u32 s56, s56, 1
    s_cbranch_scc1 L_done
    global_load_dword v2, v3, s[26:27] offset:4 sc1
    s_branch L_cw_100
L_gs_110:
    buffer_store_dword v56, v3, s[40:43], s57 offen sc1
    s_branch L_gb_111
L_comb_0:
    s_mov_b32 s57, 0
    s_cmp_eq_u32 s55, 0
    s_waitcnt lgkmcnt(0)
    s_barrier
    ds_read2st64_b64 v[40:43], v2 offset0:0 offset1:8
    ds_read2st64_b64 v[44:47], v2 offset0:16 offset1:24
    ds_read2st64_b64 v[48:51], v2 offset0:32 offset1:40
    ds_read2st64_b64 v[52:55], v2 offset0:48 offset1:56
    s_waitcnt lgkmcnt(3)
    v_pk_mul_f32 v[56:57], v[40:41], s[64:65] op_sel:[0,0] op_sel_hi:[1,0]
    v_pk_mul_f32 v[58:59], v[42:43], s[64:65] op_sel:[0,1] op_sel_hi:[1,1]
    s_waitcnt lgkmcnt(2)
    v_pk_fma_f32 v[56:57], v[44:45], s[66:67], v[56:57] op_sel:[0,0,0] op_sel_hi:[1,0,1]
    v_pk_fma_f32 v[58:59], v[46:47], s[66:67], v[58:59] op_sel:[0,1,0] op_sel_hi:[1,1,1]
    s_waitcnt lgkmcnt(1)
    v_pk_fma_f32 v[56:57], v[48:49], s[68:69], v[56:57] op_sel:[0,0,0] op_sel_hi:[1,0,1]
    v_pk_fma_f32 v[58:59], v[50:51], s[68:69], v[58:59] op_sel:[0,1,0] op_sel_hi:[1,1,1]
    s_waitcnt lgkmcnt(0)
    v_pk_fma_f32 v[56:57], v[52:53], s[70:71], v[56:57] op_sel:[0,0,0] op_sel_hi:[1,0,1]
    v_pk_fma_f32 v[58:59], v[54:55], s[70:71], v[58:59] op_sel:[0,1,0] op_sel_hi:[1,1,1]
    v_pk_add_f32 v[56:57], v[56:57], v[58:59]
L_pad15:
    s_cbranch_execz L_pad19
    v_cvt_pk_bf16_f32 v56, v56, v57
    v_min_u32 v56, -2, v56
    s_cbranch_scc1 L_gs_110
    buffer_store_dword v56, v3, s[40:43], s57 offen
L_gb_111:
    s_branch L_comb_0b
L_gs_119:
    buffer_store_dword v0, v34, s[40:43], s74 offen sc1
    s_branch L_gb_120
L_fin_117:
    s_cmp_eq_u32 s55, 0
    s_waitcnt lgkmcnt(0)
    s_barrier
    ds_read2st64_b32 v[12:13], v32 offset0:0 offset1:1
    ds_read2st64_b32 v[14:15], v32 offset0:2 offset1:3
    ds_read2st64_b32 v[16:17], v32 offset0:4 offset1:5
    ds_read2st64_b32 v[18:19], v32 offset0:6 offset1:7
    s_waitcnt lgkmcnt(2)
    v_pk_add_f32 v[12:13], v[12:13], v[14:15]
    s_waitcnt lgkmcnt(0)
    v_pk_add_f32 v[16:17], v[16:17], v[18:19]
    v_pk_add_f32 v[12:13], v[12:13], v[16:17]
    v_add_f32 v14, v12, v13
    v_add_f32 v15, v12, v13
    s_nop 1
    v_permlane16_swap_b32 v14, v15
    v_add_f32 v12, v14, v15
    v_min_u32 v12, -2, v12
    buffer_store_dword v12, v33, s[40:43], s58 offen sc1
    s_branch L_finb_118
L_sr_123:
    buffer_load_dwordx4 v[12:15], v11, s[40:43], s58 offen offset:0 sc1
    buffer_load_dwordx4 v[16:19], v11, s[40:43], s58 offen offset:1024 sc1
    s_sub_u32 s56, s56, 1
    s_cbranch_scc1 L_done
    s_waitcnt vmcnt(0)
    s_branch L_sw_122
L_hr_127:
    s_sub_u32 s56, s56, 1
    s_cbranch_scc1 L_done
    s_and_b32 s64, s56, 15
    s_cbranch_scc1 L_ha_129
    s_waitcnt vmcnt(0)
    v_max3_u32 v21, v12, v13, v14
    v_max3_u32 v21, v21, v15, v16
    v_max3_u32 v21, v21, v17, v18
    v_max_u32 v21, v21, v19
    v_cmp_eq_u32 vcc, -1, v21
    s_cbranch_vccnz L_ha_129
    v_pk_add_f32 v[20:21], v[12:13], v[14:15]
    v_pk_add_f32 v[22:23], v[16:17], v[18:19]
    v_pk_add_f32 v[20:21], v[20:21], v[22:23]
    v_add_f32 v20, v20, v21
    v_fma_f32 v20, v20, v3, v8
    s_branch L_hk_128
L_ha_129:
    buffer_load_dwordx4 v[12:15], v11, s[40:43], s58 offen offset:0 sc1
    buffer_load_dwordx4 v[16:19], v11, s[40:43], s58 offen offset:1024 sc1
    s_waitcnt vmcnt(2)
    s_branch L_hw_126
L_xr_132:
    s_sub_u32 s56, s56, 1
    s_cbranch_scc1 L_done
    s_branch L_xw_131
L_gs_133:
    buffer_store_dword v0, v5, s[40:43], s74 offen sc1
    s_branch L_gb_134
L_gs_138:
    buffer_store_dword v12, v34, s[40:43], s60 offen sc1
    s_branch L_gb_139
L_gs_140:
    buffer_store_dword v12, v34, s[40:43], s59 offen sc1
    s_branch L_gb_141
L_gr_143:
    s_cbranch_scc1 L_gw_142
    s_waitcnt vmcnt(0)
    v_max3_u32 v32, v12, v13, v14
    v_max3_u32 v32, v32, v15, v16
    v_max3_u32 v32, v32, v17, v18
    v_max3_u32 v32, v32, v19, v20
    v_max3_u32 v32, v32, v21, v22
    v_max3_u32 v32, v32, v23, v24
    v_max3_u32 v32, v32, v25, v26
    v_max_u32 v32, v32, v27
    v_cmp_eq_u32 vcc, -1, v32
    s_cbranch_vccnz L_gw_142
    v_pk_add_f32 v[28:29], v[12:13], v[16:17]
    v_pk_add_f32 v[30:31], v[14:15], v[18:19]
    v_pk_add_f32 v[28:29], v[28:29], v[20:21]
    v_pk_add_f32 v[30:31], v[30:31], v[22:23]
    v_pk_add_f32 v[28:29], v[28:29], v[24:25]
    v_pk_add_f32 v[30:31], v[30:31], v[26:27]
    s_nop 1
    v_permlane32_swap_b32 v28, v30
    v_permlane32_swap_b32 v29, v31
    s_branch L_gk_144
L_gs_147:
    buffer_store_dword v33, v34, s[40:43], s67 offen sc1
    s_branch L_gb_148
L_w7_135:
L_pad16:
    s_cbranch_execz L_pad20
    v_and_b32 v60, 31, v0
    v_min_u32 v60, 19, v60
    s_mul_i32 s57, s54, 320
    v_lshrrev_b32 v5, 5, v0
    v_mul_u32_u24 v5, 2560, v5
    v_add_u32 v5, s57, v5
    v_lshl_add_u32 v5, v60, 4, v5
    v_and_b32 v60, 31, v0
    v_cmp_gt_u32 s[64:65], 20, v60
    v_min_u32 v60, 19, v60
    v_lshrrev_b32 v35, 5, v0
    v_lshlrev_b32 v35, 2, v35
    v_add_u32 v35, 160832, v35
    v_lshl_add_u32 v35, v60, 3, v35
    s_add_u32 s66, s62, 36864
    s_add_u32 s67, s62, 55552
    s_lshl_b32 s57, s54, 3
    v_lshrrev_b32 v34, 5, v0
    v_lshlrev_b32 v34, 2, v34
    v_add_u32 v34, s57, v34
    v_and_b32 v60, 31, v0
    v_mov_b32 v61, 0x7f000000
    v_cmp_ne_u32 vcc, 31, v60
    s_nop 1
    v_cndmask_b32 v34, v34, v61, vcc
    v_mov_b32 v61, 0x3f803f80
    s_add_u32 s57, s7, 0
    s_add_u32 s58, s7, 32768
    s_add_u32 s59, s7, 65536
    s_add_u32 s60, s7, 98304
    s_add_u32 s75, s62, 56064
    v_min_u32 v9, 19, v0
    v_lshlrev_b32 v9, 2, v9
    buffer_load_dword v12, v9, s[40:43], s75 offen sc1
    s_sleep 2
L_pr_146:
    buffer_load_dword v12, v9, s[40:43], s75 offen sc1
    s_sub_u32 s56, s56, 1
    s_cbranch_scc1 L_done
L_pw_145:
    s_waitcnt vmcnt(1)
    v_cmp_eq_u32 vcc, -1, v12
    s_cbranch_vccnz L_pr_146
    buffer_load_dwordx4 v[12:15], v5, s[40:43], s57 offen sc1
    buffer_load_dwordx4 v[16:19], v5, s[40:43], s58 offen sc1
    buffer_load_dwordx4 v[20:23], v5, s[40:43], s59 offen sc1
    buffer_load_dwordx4 v[24:27], v5, s[40:43], s60 offen sc1
    s_sleep 2
L_gw_142:
    buffer_load_dwordx4 v[12:15], v5, s[40:43], s57 offen sc1
    buffer_load_dwordx4 v[16:19], v5, s[40:43], s58 offen sc1
    buffer_load_dwordx4 v[20:23], v5, s[40:43], s59 offen sc1
    buffer_load_dwordx4 v[24:27], v5, s[40:43], s60 offen sc1
    s_sub_u32 s56, s56, 1
    s_cbranch_scc1 L_done
    s_and_b32 s74, s56, 31
    s_waitcnt vmcnt(6)
    v_pk_add_f32 v[28:29], v[12:13], v[16:17]
    v_pk_add_f32 v[30:31], v[14:15], v[18:19]
    s_waitcnt vmcnt(5)
    v_pk_add_f32 v[28:29], v[28:29], v[20:21]
    v_pk_add_f32 v[30:31], v[30:31], v[22:23]
    s_waitcnt vmcnt(4)
    v_pk_add_f32 v[28:29], v[28:29], v[24:25]
    v_pk_add_f32 v[30:31], v[30:31], v[26:27]
    v_pk_add_f32 v[32:33], v[28:29], v[30:31]
    v_cmp_u_f32 vcc, v32, v33
    v_permlane32_swap_b32 v28, v30
    v_permlane32_swap_b32 v29, v31
    s_cbranch_vccnz L_gr_143
L_gk_144:
    v_pk_add_f32 v[28:29], v[28:29], v[30:31]
    v_pk_add_f32 v[28:29], v[28:29], v[2:3]
    v_cvt_pk_bf16_f32 v28, v28, v29
    ds_write_b32 v35, v28
    s_waitcnt lgkmcnt(0)
    s_barrier
    v_cndmask_b32 v29, 0, v28, s[64:65]
    v_dot2_f32_bf16 v33, v29, v61, 0
    v_dot2_f32_bf16 v62, v29, v29, 0
    v_lshlrev_b32 v2, 16, v28
    v_and_b32 v3, 0xffff0000, v28
    s_cmp_eq_u32 s55, 0
    v_permlane32_swap_b32 v33, v62
    v_add_f32 v33, v33, v62
    s_nop 1
    v_add_f32_dpp v33, v33, v33 row_ror:8 row_mask:0xf bank_mask:0xf
    s_nop 1
    v_add_f32_dpp v33, v33, v33 row_ror:4 row_mask:0xf bank_mask:0xf
    s_nop 1
L_pad17:
    s_cbranch_execz L_pad21
    v_add_f32_dpp v33, v33, v33 row_ror:2 row_mask:0xf bank_mask:0xf
    s_nop 1
    v_add_f32_dpp v33, v33, v33 row_ror:1 row_mask:0xf bank_mask:0xf
    s_nop 1
    v_add_f32_dpp v33, v33, v33 row_bcast:15 row_mask:0xa bank_mask:0xf
    v_min_u32 v33, -2, v33
    s_cbranch_scc1 L_gs_147
    buffer_store_dword v33, v34, s[40:43], s67 offen
L_gb_148:
    s_waitcnt vmcnt(1)
    s_branch L_se_136
L_gs_152:
    buffer_store_dword v12, v34, s[40:43], s59 offen sc1
    s_branch L_gb_153
L_gr_158:
    s_cbranch_scc1 L_gw_157
    s_waitcnt vmcnt(0)
    v_max3_u32 v32, v12, v13, v14
    v_max3_u32 v32, v32, v15, v16
    v_max3_u32 v32, v32, v17, v18
    v_max3_u32 v32, v32, v19, v20
    v_max3_u32 v32, v32, v21, v22
    v_max3_u32 v32, v32, v23, v24
    v_max3_u32 v32, v32, v25, v26
    v_max_u32 v32, v32, v27
    v_cmp_eq_u32 vcc, -1, v32
    s_cbranch_vccnz L_gw_157
    v_pk_add_f32 v[28:29], v[12:13], v[16:17]
    v_pk_add_f32 v[30:31], v[14:15], v[18:19]
    v_pk_add_f32 v[28:29], v[28:29], v[20:21]
    v_pk_add_f32 v[30:31], v[30:31], v[22:23]
    v_pk_add_f32 v[28:29], v[28:29], v[24:25]
    v_pk_add_f32 v[30:31], v[30:31], v[26:27]
    s_nop 1
    v_permlane32_swap_b32 v28, v30
    v_permlane32_swap_b32 v29, v31
    s_branch L_gk_159
L_gr_161:
    s_cbranch_scc1 L_gw_160
    s_waitcnt vmcnt(0)
    v_max3_u32 v32, v12, v13, v14
    v_max3_u32 v32, v32, v15, v16
    v_max3_u32 v32, v32, v17, v18
    v_max3_u32 v32, v32, v19, v20
    v_max3_u32 v32, v32, v21, v22
    v_max3_u32 v32, v32, v23, v24
    v_max3_u32 v32, v32, v25, v26
    v_max_u32 v32, v32, v27
    v_cmp_eq_u32 vcc, -1, v32
    s_cbranch_vccnz L_gw_160
    v_pk_add_f32 v[28:29], v[12:13], v[16:17]
    v_pk_add_f32 v[30:31], v[14:15], v[18:19]
    v_pk_add_f32 v[28:29], v[28:29], v[20:21]
    v_pk_add_f32 v[30:31], v[30:31], v[22:23]
    v_pk_add_f32 v[28:29], v[28:29], v[24:25]
    v_pk_add_f32 v[30:31], v[30:31], v[26:27]
    s_nop 1
    v_permlane32_swap_b32 v28, v30
    v_permlane32_swap_b32 v29, v31
    s_branch L_gk_162
L_gs_165:
    buffer_store_dword v33, v34, s[40:43], s67 offen sc1
    s_branch L_gb_166
L_w7_149:
    v_and_b32 v60, 31, v0
    v_min_u32 v60, 19, v60
    s_mul_i32 s57, s54, 320
    v_lshrrev_b32 v5, 5, v0
    v_mul_u32_u24 v5, 2560, v5
    v_add_u32 v5, s57, v5
    v_lshl_add_u32 v5, v60, 4, v5
    v_and_b32 v60, 31, v0
    v_cmp_gt_u32 s[64:65], 20, v60
    v_min_u32 v60, 19, v60
    v_lshrrev_b32 v35, 5, v0
    v_lshlrev_b32 v35, 2, v35
    v_add_u32 v35, 160832, v35
    v_lshl_add_u32 v35, v60, 3, v35
    s_mul_i32 s66, s53, 3072
    s_add_u32 s66, s66, s62
    s_add_u32 s66, s66, 24576
    s_lshl_b32 s67, s53, 6
    s_add_u32 s67, s67, s62
    s_add_u32 s67, s67, 55296
    s_lshl_b32 s57, s54, 3
    v_lshrrev_b32 v34, 5, v0
    v_lshlrev_b32 v34, 2, v34
    v_add_u32 v34, s57, v34
    v_and_b32 v60, 31, v0
    v_mov_b32 v61, 0x7f000000
    v_cmp_ne_u32 vcc, 31, v60
L_pad18:
    s_cbranch_execz L_pad22
    s_nop 1
    v_cndmask_b32 v34, v34, v61, vcc
    v_mov_b32 v61, 0x3f803f80
    s_cmp_lg_u32 s53, 3
    s_cbranch_scc0 L_skip_154
    s_add_u32 s57, s62, 55552
    v_mov_b32 v9, 0
L_pr_156:
    buffer_load_dword v12, v9, s[40:43], s57 offen sc1
    s_sub_u32 s56, s56, 1
    s_cbranch_scc1 L_done
L_pw_155:
    s_waitcnt vmcnt(0)
    v_cmp_eq_u32 vcc, -1, v12
    s_cbranch_vccnz L_pr_156
    s_add_u32 s57, s7, 0
    s_add_u32 s58, s7, 32768
    s_add_u32 s59, s7, 65536
    s_add_u32 s60, s7, 98304
L_gw_157:
    buffer_load_dwordx4 v[12:15], v5, s[40:43], s57 offen sc1
    buffer_load_dwordx4 v[16:19], v5, s[40:43], s58 offen sc1
    buffer_load_dwordx4 v[20:23], v5, s[40:43], s59 offen sc1
    buffer_load_dwordx4 v[24:27], v5, s[40:43], s60 offen sc1
    s_sub_u32 s56, s56, 1
    s_cbranch_scc1 L_done
    s_and_b32 s74, s56, 31
    s_waitcnt vmcnt(2)
    v_pk_add_f32 v[28:29], v[12:13], v[16:17]
    v_pk_add_f32 v[30:31], v[14:15], v[18:19]
    s_waitcnt vmcnt(1)
    v_pk_add_f32 v[28:29], v[28:29], v[20:21]
    v_pk_add_f32 v[30:31], v[30:31], v[22:23]
    s_waitcnt vmcnt(0)
    v_pk_add_f32 v[28:29], v[28:29], v[24:25]
    v_pk_add_f32 v[30:31], v[30:31], v[26:27]
    v_pk_add_f32 v[32:33], v[28:29], v[30:31]
    v_cmp_u_f32 vcc, v32, v33
    v_permlane32_swap_b32 v28, v30
    v_permlane32_swap_b32 v29, v31
    s_cbranch_vccnz L_gr_158
L_gk_159:
    v_pk_add_f32 v[28:29], v[28:29], v[30:31]
    v_pk_add_f32 v[28:29], v[28:29], v[2:3]
    v_cvt_pk_bf16_f32 v28, v28, v29
    v_lshlrev_b32 v2, 16, v28
    v_and_b32 v3, 0xffff0000, v28
L_skip_154:
    v_lshlrev_b32 v60, 16, v4
    v_add_f32 v2, v2, v60
    v_and_b32 v60, 0xffff0000, v4
    v_add_f32 v3, v3, v60
    s_add_u32 s57, s7, 131072
    s_add_u32 s58, s7, 163840
    s_add_u32 s59, s7, 196608
    s_add_u32 s60, s7, 229376
    s_add_u32 s75, s62, 56448
    s_lshl_b32 s74, s53, 7
    s_add_u32 s75, s75, s74
    v_min_u32 v9, 19, v0
    v_lshlrev_b32 v9, 2, v9
    buffer_load_dword v12, v9, s[40:43], s75 offen sc1
    s_sleep 2
L_pr_164:
    buffer_load_dword v12, v9, s[40:43], s75 offen sc1
    s_sub_u32 s56, s56, 1
    s_cbranch_scc1 L_done
L_pw_163:
    s_waitcnt vmcnt(1)
    v_cmp_eq_u32 vcc, -1, v12
    s_cbranch_vccnz L_pr_164
    buffer_load_dwordx4 v[12:15], v5, s[40:43], s57 offen sc1
    buffer_load_dwordx4 v[16:19], v5, s[40:43], s58 offen sc1
    buffer_load_dwordx4 v[20:23], v5, s[40:43], s59 offen sc1
    buffer_load_dwordx4 v[24:27], v5, s[40:43], s60 offen sc1
    s_sleep 2
L_gw_160:
    buffer_load_dwordx4 v[12:15], v5, s[40:43], s57 offen sc1
    buffer_load_dwordx4 v[16:19], v5, s[40:43], s58 offen sc1
    buffer_load_dwordx4 v[20:23], v5, s[40:43], s59 offen sc1
    buffer_load_dwordx4 v[24:27], v5, s[40:43], s60 offen sc1
    s_sub_u32 s56, s56, 1
    s_cbranch_scc1 L_done
    s_and_b32 s74, s56, 31
    s_waitcnt vmcnt(6)
    v_pk_add_f32 v[28:29], v[12:13], v[16:17]
    v_pk_add_f32 v[30:31], v[14:15], v[18:19]
    s_waitcnt vmcnt(5)
    v_pk_add_f32 v[28:29], v[28:29], v[20:21]
    v_pk_add_f32 v[30:31], v[30:31], v[22:23]
    s_waitcnt vmcnt(4)
    v_pk_add_f32 v[28:29], v[28:29], v[24:25]
    v_pk_add_f32 v[30:31], v[30:31], v[26:27]
L_pad19:
    s_cbranch_execz L_pad23
    v_pk_add_f32 v[32:33], v[28:29], v[30:31]
    v_cmp_u_f32 vcc, v32, v33
    v_permlane32_swap_b32 v28, v30
    v_permlane32_swap_b32 v29, v31
    s_cbranch_vccnz L_gr_161
L_gk_162:
    v_pk_add_f32 v[28:29], v[28:29], v[30:31]
    v_pk_add_f32 v[28:29], v[28:29], v[2:3]
    v_cvt_pk_bf16_f32 v28, v28, v29
    ds_write_b32 v35, v28
    s_waitcnt lgkmcnt(0)
    s_barrier
    v_cndmask_b32 v29, 0, v28, s[64:65]
    v_dot2_f32_bf16 v33, v29, v61, 0
    v_dot2_f32_bf16 v62, v29, v29, 0
    v_lshlrev_b32 v2, 16, v28
    v_and_b32 v3, 0xffff0000, v28
    s_cmp_eq_u32 s55, 0
    v_permlane32_swap_b32 v33, v62
    v_add_f32 v33, v33, v62
    s_nop 1
    v_add_f32_dpp v33, v33, v33 row_ror:8 row_mask:0xf bank_mask:0xf
    s_nop 1
    v_add_f32_dpp v33, v33, v33 row_ror:4 row_mask:0xf bank_mask:0xf
    s_nop 1
    v_add_f32_dpp v33, v33, v33 row_ror:2 row_mask:0xf bank_mask:0xf
    s_nop 1
    v_add_f32_dpp v33, v33, v33 row_ror:1 row_mask:0xf bank_mask:0xf
    s_nop 1
    v_add_f32_dpp v33, v33, v33 row_bcast:15 row_mask:0xa bank_mask:0xf
    v_min_u32 v33, -2, v33
    s_cbranch_scc1 L_gs_165
    buffer_store_dword v33, v34, s[40:43], s67 offen
L_gb_166:
    s_waitcnt vmcnt(1)
    s_branch L_se_150
L_q3_169:
    buffer_load_dwordx4 v[16:19], v8, s[40:43], s59 offen offset:1024 sc1
    v_mov_b64 v[24:25], 0
    v_mov_b64 v[26:27], 0
    v_mov_b64 v[28:29], 0
    v_mov_b64 v[30:31], 0
    v_mov_b64 v[32:33], 0
    v_mov_b64 v[34:35], 0
    v_mov_b64 v[36:37], 0
    v_mov_b64 v[38:39], 0
    v_mov_b64 v[40:41], 0
    v_mov_b64 v[42:43], 0
    v_mov_b64 v[44:45], 0
    v_mov_b64 v[46:47], 0
    v_mov_b64 v[48:49], 0
    v_mov_b64 v[50:51], 0
    v_mov_b64 v[52:53], 0
    v_mov_b64 v[54:55], 0
    v_mov_b64 v[56:57], 0
    v_mov_b64 v[58:59], 0
    v_mov_b64 v[60:61], 0
    v_mov_b64 v[62:63], 0
    s_lshl_b32 s58, s30, 3
    s_add_u32 s58, s58, 159808
    v_mov_b32 v11, s58
    v_lshlrev_b32 v10, 3, v0
    v_add_u32 v10, 157696, v10
    v_cmp_eq_u32 vcc, 63, v0
    s_nop 1
    v_cndmask_b32 v10, v10, v11, vcc
    s_lshl_b32 s57, s30, 12
    v_lshlrev_b32 v7, 4, v0
    v_add_u32 v7, s57, v7
    v_add_u32 v7, 92160, v7
    v_mov_b32 v11, 128000
L_pr_171:
    buffer_load_dwordx4 v[16:19], v8, s[40:43], s59 offen offset:1024 sc1
    s_sub_u32 s56, s56, 1
    s_cbranch_scc1 L_done
L_pw_170:
    s_waitcnt vmcnt(1)
    v_max3_u32 v9, v16, v17, v18
    v_max_u32 v9, v9, v19
    v_cmp_eq_u32 vcc, -1, v9
    s_cbranch_vccnz L_pr_171
    ds_write_b128 v5, v[16:19] offset:1024
    s_branch L_qb_168
L_q3_172:
    buffer_load_dwordx4 v[20:23], v8, s[40:43], s59 offen offset:2048 sc1
    v_mov_b64 v[24:25], 0
    v_mov_b64 v[26:27], 0
    v_mov_b64 v[28:29], 0
    v_mov_b64 v[30:31], 0
    v_mov_b64 v[32:33], 0
    v_mov_b64 v[34:35], 0
    v_mov_b64 v[36:37], 0
    v_mov_b64 v[38:39], 0
    v_mov_b64 v[40:41], 0
    v_mov_b64 v[42:43], 0
    v_mov_b64 v[44:45], 0
    v_mov_b64 v[46:47], 0
    v_mov_b64 v[48:49], 0
    v_mov_b64 v[50:51], 0
    v_mov_b64 v[52:53], 0
    v_mov_b64 v[54:55], 0
    v_mov_b64 v[56:57], 0
    v_mov_b64 v[58:59], 0
    v_mov_b64 v[60:61], 0
    v_mov_b64 v[62:63], 0
    s_lshl_b32 s58, s30, 3
    s_add_u32 s58, s58, 159808
L_pad20:
    s_cbranch_execz L_pad24
    v_mov_b32 v11, s58
    v_lshlrev_b32 v10, 3, v0
    v_add_u32 v10, 157696, v10
    v_cmp_eq_u32 vcc, 63, v0
    s_nop 1
    v_cndmask_b32 v10, v10, v11, vcc
    s_lshl_b32 s57, s30, 12
    v_lshlrev_b32 v7, 4, v0
    v_add_u32 v7, s57, v7
    v_add_u32 v7, 92160, v7
    v_mov_b32 v11, 128000
L_pr_174:
    buffer_load_dwordx4 v[20:23], v8, s[40:43], s59 offen offset:2048 sc1
    s_sub_u32 s56, s56, 1
    s_cbranch_scc1 L_done
L_pw_173:
    s_waitcnt vmcnt(1)
    v_max3_u32 v9, v20, v21, v22
    v_max_u32 v9, v9, v23
    v_cmp_eq_u32 vcc, -1, v9
    s_cbranch_vccnz L_pr_174
    ds_write_b128 v5, v[20:23] offset:2048
    s_branch L_qb_168
L_qo_167:
    v_mov_b64 v[24:25], 0
    v_mov_b64 v[26:27], 0
    v_mov_b64 v[28:29], 0
    v_mov_b64 v[30:31], 0
    v_mov_b64 v[32:33], 0
    v_mov_b64 v[34:35], 0
    v_mov_b64 v[36:37], 0
    v_mov_b64 v[38:39], 0
    v_mov_b64 v[40:41], 0
    v_mov_b64 v[42:43], 0
    v_mov_b64 v[44:45], 0
    v_mov_b64 v[46:47], 0
    v_mov_b64 v[48:49], 0
    v_mov_b64 v[50:51], 0
    v_mov_b64 v[52:53], 0
    v_mov_b64 v[54:55], 0
    v_mov_b64 v[56:57], 0
    v_mov_b64 v[58:59], 0
    v_mov_b64 v[60:61], 0
    v_mov_b64 v[62:63], 0
    s_lshl_b32 s58, s30, 3
    s_add_u32 s58, s58, 159808
    v_mov_b32 v11, s58
    v_lshlrev_b32 v10, 3, v0
    v_add_u32 v10, 157696, v10
    v_cmp_eq_u32 vcc, 63, v0
    s_nop 1
    v_cndmask_b32 v10, v10, v11, vcc
    s_lshl_b32 s57, s30, 12
    v_lshlrev_b32 v7, 4, v0
    v_add_u32 v7, s57, v7
    v_add_u32 v7, 92160, v7
    v_mov_b32 v11, 128000
    s_cmp_eq_u32 s30, 6
    s_cbranch_scc0 L_qb_168
    v_and_b32 v16, 7, v0
    v_lshlrev_b32 v16, 3, v16
L_pr_178:
    buffer_load_dwordx2 v[8:9], v16, s[40:43], s60 offen sc1
    s_sub_u32 s56, s56, 1
    s_cbranch_scc1 L_done
L_pw_177:
    s_waitcnt vmcnt(0)
    v_max_u32 v18, v8, v9
    v_cmp_eq_u32 vcc, -1, v18
    s_cbranch_vccnz L_pr_178
    v_add_f32_dpp v8, v8, v8 row_ror:4 row_mask:0xf bank_mask:0xf
    v_add_f32_dpp v9, v9, v9 row_ror:4 row_mask:0xf bank_mask:0xf
    s_nop 0
    v_add_f32_dpp v8, v8, v8 row_ror:2 row_mask:0xf bank_mask:0xf
    v_add_f32_dpp v9, v9, v9 row_ror:2 row_mask:0xf bank_mask:0xf
    s_nop 0
    v_add_f32_dpp v8, v8, v8 row_ror:1 row_mask:0xf bank_mask:0xf
    v_add_f32_dpp v9, v9, v9 row_ror:1 row_mask:0xf bank_mask:0xf
    v_mul_f32 v8, 0x3acccccd, v8
    v_mul_f32 v9, 0x3acccccd, v9
    v_fma_f32 v9, -v8, v8, v9
    v_max_f32 v9, 0, v9
    v_add_f32 v9, 0x3727c5ac, v9
    v_rsq_f32 v9, v9
    s_nop 0
    v_mul_f32 v9, 0x3dd53b95, v9
    v_mul_f32 v8, -v8, v9
    ds_write_b64 v11, v[8:9]
    s_branch L_qb_168
L_mr_180:
    s_sub_u32 s56, s56, 1
    s_cbranch_scc1 L_done
    s_branch L_mw_179
L_gs_181:
    buffer_store_dword v22, v23, s[40:43], s57 offen sc1
    s_branch L_gb_182
L_gs_183:
    buffer_store_dword v56, v3, s[40:43], s57 offen sc1
    s_branch L_gb_184
L_comb_1:
    s_lshl_b32 s57, s53, 3
    s_add_u32 s57, s57, s54
    s_lshl_b32 s57, s57, 2
    s_add_u32 s57, s57, s62
    s_add_u32 s57, s57, 55936
    v_add_u32 v23, s30, v0
    v_lshlrev_b32 v23, 24, v23
L_mw_179:
    ds_read_b64 v[38:39], v4 offset:64
L_pad21:
    s_cbranch_execz L_padback
    s_waitcnt lgkmcnt(0)
    v_cmp_eq_u32 vcc, -1, v39
    s_cbranch_vccnz L_mr_180
    v_max_f32_dpp v37, v38, v38 row_ror:4 row_mask:0xf bank_mask:0xf
    s_cmp_eq_u32 s55, 0
    s_nop 0
    v_max_f32_dpp v37, v37, v37 row_ror:2 row_mask:0xf bank_mask:0xf
    s_nop 1
    v_max_f32_dpp v37, v37, v37 row_ror:1 row_mask:0xf bank_mask:0xf
    v_sub_f32 v38, v38, v37
    v_exp_f32 v38, v38
    s_nop 0
    v_mul_f32 v39, v38, v39
    s_nop 1
    v_add_f32_dpp v39, v39, v39 row_ror:4 row_mask:0xf bank_mask:0xf
    s_nop 1
    v_add_f32_dpp v39, v39, v39 row_ror:2 row_mask:0xf bank_mask:0xf
    s_nop 1
    v_add_f32_dpp v39, v39, v39 row_ror:1 row_mask:0xf bank_mask:0xf
    v_rcp_f32 v21, v39
    v_log_f32 v22, v39
    v_mul_f32 v38, v38, v21
    v_add_f32 v22, v22, v37
    v_min_u32 v22, -2, v22
    s_cbranch_scc1 L_gs_181
    buffer_store_dword v22, v23, s[40:43], s57 offen
L_gb_182:
    v_readlane_b32 s64, v38, 0
    v_readlane_b32 s65, v38, 1
    v_readlane_b32 s66, v38, 2
    v_readlane_b32 s67, v38, 3
    v_readlane_b32 s68, v38, 4
    v_readlane_b32 s69, v38, 5
    v_readlane_b32 s70, v38, 6
    v_readlane_b32 s71, v38, 7
    s_mov_b32 s57, 12288
    s_cmp_eq_u32 s55, 0
    s_waitcnt lgkmcnt(0)
    s_barrier
    ds_read2st64_b64 v[40:43], v2 offset0:0 offset1:8
    ds_read2st64_b64 v[44:47], v2 offset0:16 offset1:24
    ds_read2st64_b64 v[48:51], v2 offset0:32 offset1:40
    ds_read2st64_b64 v[52:55], v2 offset0:48 offset1:56
    s_waitcnt lgkmcnt(3)
    v_pk_mul_f32 v[56:57], v[40:41], s[64:65] op_sel:[0,0] op_sel_hi:[1,0]
    v_pk_mul_f32 v[58:59], v[42:43], s[64:65] op_sel:[0,1] op_sel_hi:[1,1]
    s_waitcnt lgkmcnt(2)
    v_pk_fma_f32 v[56:57], v[44:45], s[66:67], v[56:57] op_sel:[0,0,0] op_sel_hi:[1,0,1]
    v_pk_fma_f32 v[58:59], v[46:47], s[66:67], v[58:59] op_sel:[0,1,0] op_sel_hi:[1,1,1]
    s_waitcnt lgkmcnt(1)
    v_pk_fma_f32 v[56:57], v[48:49], s[68:69], v[56:57] op_sel:[0,0,0] op_sel_hi:[1,0,1]
    v_pk_fma_f32 v[58:59], v[50:51], s[68:69], v[58:59] op_sel:[0,1,0] op_sel_hi:[1,1,1]
    s_waitcnt lgkmcnt(0)
    v_pk_fma_f32 v[56:57], v[52:53], s[70:71], v[56:57] op_sel:[0,0,0] op_sel_hi:[1,0,1]
    v_pk_fma_f32 v[58:59], v[54:55], s[70:71], v[58:59] op_sel:[0,1,0] op_sel_hi:[1,1,1]
    v_pk_add_f32 v[56:57], v[56:57], v[58:59]
    v_cvt_pk_bf16_f32 v56, v56, v57
    v_min_u32 v56, -2, v56
    s_cbranch_scc1 L_gs_183
    buffer_store_dword v56, v3, s[40:43], s57 offen
L_gb_184:
    s_branch L_comb_1b
L_gs_191:
    buffer_store_dword v0, v34, s[40:43], s74 offen sc1
    s_branch L_gb_192
L_fin_189:
    s_cmp_eq_u32 s55, 0
    s_waitcnt lgkmcnt(0)
    s_barrier
    ds_read2st64_b32 v[12:13], v32 offset0:0 offset1:1
    ds_read2st64_b32 v[14:15], v32 offset0:2 offset1:3
    ds_read2st64_b32 v[16:17], v32 offset0:4 offset1:5
    ds_read2st64_b32 v[18:19], v32 offset0:6 offset1:7
    s_waitcnt lgkmcnt(2)
    v_pk_add_f32 v[12:13], v[12:13], v[14:15]
    s_waitcnt lgkmcnt(0)
    v_pk_add_f32 v[16:17], v[16:17], v[18:19]
    v_pk_add_f32 v[12:13], v[12:13], v[16:17]
    v_add_f32 v14, v12, v13
    v_add_f32 v15, v12, v13
    s_nop 1
    v_permlane16_swap_b32 v14, v15
    v_add_f32 v12, v14, v15
    v_min_u32 v12, -2, v12
    buffer_store_dword v12, v33, s[40:43], s58 offen sc1
    s_cbranch_scc1 L_gs_191
    buffer_store_dword v0, v34, s[40:43], s74 offen
L_gb_192:
    s_branch L_finb_190
L_sr_195:
    buffer_load_dwordx4 v[12:15], v11, s[40:43], s58 offen offset:0 sc1
L_pad22:
    s_cbranch_execz L_padback
    buffer_load_dwordx4 v[16:19], v11, s[40:43], s58 offen offset:1024 sc1
    s_sub_u32 s56, s56, 1
    s_cbranch_scc1 L_done
    s_waitcnt vmcnt(0)
    s_branch L_sw_194
L_hr_199:
    s_sub_u32 s56, s56, 1
    s_cbranch_scc1 L_done
    s_and_b32 s64, s56, 15
    s_cbranch_scc1 L_ha_201
    s_waitcnt vmcnt(0)
    v_max3_u32 v21, v12, v13, v14
    v_max3_u32 v21, v21, v15, v16
    v_max3_u32 v21, v21, v17, v18
    v_max_u32 v21, v21, v19
    v_cmp_eq_u32 vcc, -1, v21
    s_cbranch_vccnz L_ha_201
    v_pk_add_f32 v[20:21], v[12:13], v[14:15]
    v_pk_add_f32 v[22:23], v[16:17], v[18:19]
    v_pk_add_f32 v[20:21], v[20:21], v[22:23]
    v_add_f32 v20, v20, v21
    v_fma_f32 v20, v20, v3, v8
    s_branch L_hk_200
L_ha_201:
    buffer_load_dwordx4 v[12:15], v11, s[40:43], s58 offen offset:0 sc1
    buffer_load_dwordx4 v[16:19], v11, s[40:43], s58 offen offset:1024 sc1
    s_waitcnt vmcnt(2)
    s_branch L_hw_198
L_xr_204:
    s_sub_u32 s56, s56, 1
    s_cbranch_scc1 L_done
    s_branch L_xw_203
L_gs_205:
    buffer_store_dword v0, v5, s[40:43], s74 offen sc1
    s_branch L_gb_206
L_gs_210:
    buffer_store_dword v12, v34, s[40:43], s59 offen sc1
    s_branch L_gb_211
L_gr_213:
    s_cbranch_scc1 L_gw_212
    s_waitcnt vmcnt(0)
    v_max3_u32 v32, v12, v13, v14
    v_max3_u32 v32, v32, v15, v16
    v_max3_u32 v32, v32, v17, v18
    v_max3_u32 v32, v32, v19, v20
    v_max3_u32 v32, v32, v21, v22
    v_max3_u32 v32, v32, v23, v24
    v_max3_u32 v32, v32, v25, v26
    v_max_u32 v32, v32, v27
    v_cmp_eq_u32 vcc, -1, v32
    s_cbranch_vccnz L_gw_212
    v_pk_add_f32 v[28:29], v[12:13], v[16:17]
    v_pk_add_f32 v[30:31], v[14:15], v[18:19]
    v_pk_add_f32 v[28:29], v[28:29], v[20:21]
    v_pk_add_f32 v[30:31], v[30:31], v[22:23]
    v_pk_add_f32 v[28:29], v[28:29], v[24:25]
    v_pk_add_f32 v[30:31], v[30:31], v[26:27]
    s_nop 1
    v_permlane32_swap_b32 v28, v30
    v_permlane32_swap_b32 v29, v31
    s_branch L_gk_214
L_gs_217:
    buffer_store_dword v33, v34, s[40:43], s67 offen sc1
    s_branch L_gb_218
L_w7_207:
    v_and_b32 v60, 31, v0
    v_min_u32 v60, 19, v60
    s_mul_i32 s57, s54, 320
    v_lshrrev_b32 v5, 5, v0
    v_mul_u32_u24 v5, 2560, v5
    v_add_u32 v5, s57, v5
    v_lshl_add_u32 v5, v60, 4, v5
    v_and_b32 v60, 31, v0
    v_cmp_gt_u32 s[64:65], 20, v60
    v_min_u32 v60, 19, v60
    v_lshrrev_b32 v35, 5, v0
    v_lshlrev_b32 v35, 2, v35
    v_add_u32 v35, 160832, v35
    v_lshl_add_u32 v35, v60, 3, v35
    s_add_u32 s66, s62, 43008
    s_add_u32 s67, s62, 55680
    s_lshl_b32 s57, s54, 3
    v_lshrrev_b32 v34, 5, v0
    v_lshlrev_b32 v34, 2, v34
    v_add_u32 v34, s57, v34
    v_and_b32 v60, 31, v0
    v_mov_b32 v61, 0x7f000000
    v_cmp_ne_u32 vcc, 31, v60
    s_nop 1
    v_cndmask_b32 v34, v34, v61, vcc
    v_mov_b32 v61, 0x3f803f80
    s_add_u32 s57, s7, 262144
    s_add_u32 s58, s7, 294912
    s_add_u32 s59, s7, 327680
    s_add_u32 s60, s7, 360448
L_pad23:
    s_cbranch_execz L_padback
    s_add_u32 s75, s62, 56192
    v_min_u32 v9, 19, v0
    v_lshlrev_b32 v9, 2, v9
    buffer_load_dword v12, v9, s[40:43], s75 offen sc1
    s_sleep 2
L_pr_216:
    buffer_load_dword v12, v9, s[40:43], s75 offen sc1
    s_sub_u32 s56, s56, 1
    s_cbranch_scc1 L_done
L_pw_215:
    s_waitcnt vmcnt(1)
    v_cmp_eq_u32 vcc, -1, v12
    s_cbranch_vccnz L_pr_216
    buffer_load_dwordx4 v[12:15], v5, s[40:43], s57 offen sc1
    buffer_load_dwordx4 v[16:19], v5, s[40:43], s58 offen sc1
    buffer_load_dwordx4 v[20:23], v5, s[40:43], s59 offen sc1
    buffer_load_dwordx4 v[24:27], v5, s[40:43], s60 offen sc1
    s_sleep 2
L_gw_212:
    buffer_load_dwordx4 v[12:15], v5, s[40:43], s57 offen sc1
    buffer_load_dwordx4 v[16:19], v5, s[40:43], s58 offen sc1
    buffer_load_dwordx4 v[20:23], v5, s[40:43], s59 offen sc1
    buffer_load_dwordx4 v[24:27], v5, s[40:43], s60 offen sc1
    s_sub_u32 s56, s56, 1
    s_cbranch_scc1 L_done
    s_and_b32 s74, s56, 31
    s_waitcnt vmcnt(6)
    v_pk_add_f32 v[28:29], v[12:13], v[16:17]
    v_pk_add_f32 v[30:31], v[14:15], v[18:19]
    s_waitcnt vmcnt(5)
    v_pk_add_f32 v[28:29], v[28:29], v[20:21]
    v_pk_add_f32 v[30:31], v[30:31], v[22:23]
    s_waitcnt vmcnt(4)
    v_pk_add_f32 v[28:29], v[28:29], v[24:25]
    v_pk_add_f32 v[30:31], v[30:31], v[26:27]
    v_pk_add_f32 v[32:33], v[28:29], v[30:31]
    v_cmp_u_f32 vcc, v32, v33
    v_permlane32_swap_b32 v28, v30
    v_permlane32_swap_b32 v29, v31
    s_cbranch_vccnz L_gr_213
L_gk_214:
    v_pk_add_f32 v[28:29], v[28:29], v[30:31]
    v_pk_add_f32 v[28:29], v[28:29], v[2:3]
    v_cvt_pk_bf16_f32 v28, v28, v29
    ds_write_b32 v35, v28
    s_waitcnt lgkmcnt(0)
    s_barrier
    v_cndmask_b32 v29, 0, v28, s[64:65]
    v_dot2_f32_bf16 v33, v29, v61, 0
    v_dot2_f32_bf16 v62, v29, v29, 0
    v_lshlrev_b32 v2, 16, v28
    v_and_b32 v3, 0xffff0000, v28
    s_cmp_eq_u32 s55, 0
    v_permlane32_swap_b32 v33, v62
    v_add_f32 v33, v33, v62
    s_nop 1
    v_add_f32_dpp v33, v33, v33 row_ror:8 row_mask:0xf bank_mask:0xf
    s_nop 1
    v_add_f32_dpp v33, v33, v33 row_ror:4 row_mask:0xf bank_mask:0xf
    s_nop 1
    v_add_f32_dpp v33, v33, v33 row_ror:2 row_mask:0xf bank_mask:0xf
    s_nop 1
    v_add_f32_dpp v33, v33, v33 row_ror:1 row_mask:0xf bank_mask:0xf
    s_nop 1
    v_add_f32_dpp v33, v33, v33 row_bcast:15 row_mask:0xa bank_mask:0xf
    v_min_u32 v33, -2, v33
    s_cbranch_scc1 L_gs_217
    buffer_store_dword v33, v34, s[40:43], s67 offen
L_gb_218:
    s_waitcnt vmcnt(1)
    s_branch L_se_208
L_gr_220:
    s_cbranch_scc1 L_gw_219
    s_waitcnt vmcnt(0)
    v_max3_u32 v32, v12, v13, v14
    v_max3_u32 v32, v32, v15, v16
    v_max3_u32 v32, v32, v17, v18
    v_max3_u32 v32, v32, v19, v20
    v_max3_u32 v32, v32, v21, v22
    v_max3_u32 v32, v32, v23, v24
    v_max3_u32 v32, v32, v25, v26
    v_max_u32 v32, v32, v27
    v_cmp_eq_u32 vcc, -1, v32
    s_cbranch_vccnz L_gw_219
    v_pk_add_f32 v[28:29], v[12:13], v[16:17]
    v_pk_add_f32 v[30:31], v[14:15], v[18:19]
    v_pk_add_f32 v[28:29], v[28:29], v[20:21]
    v_pk_add_f32 v[30:31], v[30:31], v[22:23]
    v_pk_add_f32 v[28:29], v[28:29], v[24:25]
L_pad24:
    s_cbranch_execz L_padback
    v_pk_add_f32 v[30:31], v[30:31], v[26:27]
    s_nop 1
    v_permlane32_swap_b32 v28, v30
    v_permlane32_swap_b32 v29, v31
    s_branch L_gk_221
L_tail_end:
L_spread:
    s_add_u32 s62, s62, 671744
    s_cmp_eq_u32 s30, 5
    s_cbranch_scc0 L_skip_62
    v_mov_b64 v[12:13], -1
    v_mov_b64 v[14:15], -1
    v_lshlrev_b32 v16, 4, v0
    s_mul_i32 s57, s52, 1792
    s_add_u32 s57, s57, s62
    s_mov_b32 exec_lo, 0xffffffff
    s_mov_b32 exec_hi, 0xffff
    buffer_store_dwordx4 v[12:15], v16, s[40:43], s57 offen offset:1024 sc1
    s_mov_b64 exec, -1
    buffer_store_dwordx4 v[12:15], v16, s[40:43], s57 offen sc1
L_skip_62:
    s_cmp_eq_u32 s30, 7
    s_cbranch_scc0 L_skip_63
    v_and_b32 v60, 31, v0
    v_cmp_gt_u32 s[64:65], 20, v60
    v_min_u32 v60, 19, v60
    v_lshrrev_b32 v35, 5, v0
    v_lshlrev_b32 v35, 2, v35
    v_add_u32 v35, 160832, v35
    v_lshl_add_u32 v35, v60, 3, v35
    s_mul_i32 s66, s53, 6400
    s_add_u32 s66, s66, s62
    s_add_u32 s66, s66, 57344
    s_add_u32 s67, s66, 6144
    s_lshl_b32 s57, s54, 3
    v_lshrrev_b32 v34, 5, v0
    v_lshlrev_b32 v34, 2, v34
    v_add_u32 v34, s57, v34
    v_and_b32 v60, 31, v0
    v_mov_b32 v61, 0x7f000000
    v_cmp_ne_u32 vcc, 31, v60
    s_nop 1
    v_cndmask_b32 v34, v34, v61, vcc
    v_mov_b32 v61, 0x3f803f80
    v_cvt_pk_bf16_f32 v28, v2, v3
L_skip_63:
    s_cmp_eq_u32 s30, 7
    s_cbranch_scc0 L_skip_64
    v_cndmask_b32 v29, 0, v28, s[64:65]
    v_dot2_f32_bf16 v33, v29, v61, 0
    v_dot2_f32_bf16 v62, v29, v29, 0
    v_lshlrev_b32 v2, 16, v28
    v_and_b32 v3, 0xffff0000, v28
    s_cmp_eq_u32 s55, 0
    v_permlane32_swap_b32 v33, v62
    v_add_f32 v33, v33, v62
    s_nop 1
    v_add_f32_dpp v33, v33, v33 row_ror:8 row_mask:0xf bank_mask:0xf
    s_nop 1
    v_add_f32_dpp v33, v33, v33 row_ror:4 row_mask:0xf bank_mask:0xf
    s_nop 1
    v_add_f32_dpp v33, v33, v33 row_ror:2 row_mask:0xf bank_mask:0xf
    s_nop 1
    v_add_f32_dpp v33, v33, v33 row_ror:1 row_mask:0xf bank_mask:0xf
    s_nop 1
    v_add_f32_dpp v33, v33, v33 row_bcast:15 row_mask:0xa bank_mask:0xf
    v_min_u32 v33, -2, v33
    s_cbranch_scc1 L_gs_65
    buffer_store_dword v33, v34, s[40:43], s67 offen
L_gb_66:
    s_waitcnt vmcnt(1)
L_skip_64:
    s_cmp_lt_u32 s30, 6
    s_cbranch_scc0 L_skip_67
    s_lshr_b32 s57, s30, 1
    s_mul_i32 s57, s57, 1024
    s_and_b32 s58, s30, 1
    s_lshl_b32 s58, s58, 6
    s_add_u32 s57, s57, s58
    v_lshrrev_b32 v18, 5, v0
    v_mul_u32_u24 v18, 6144, v18
    v_bfe_u32 v60, v0, 3, 1
    v_mul_u32_u24 v60, 3072, v60
    v_add_u32 v18, v60, v18
    v_bfe_u32 v60, v0, 4, 1
    v_lshl_add_u32 v18, v60, 9, v18
    v_bfe_u32 v60, v0, 2, 1
    v_lshl_add_u32 v18, v60, 7, v18
    v_and_b32 v60, 3, v0
    v_lshl_add_u32 v18, v60, 3, v18
    v_add_u32 v18, s57, v18
    v_bfe_u32 v19, v0, 4, 1
    v_mul_u32_u24 v19, 3072, v19
    v_bfe_u32 v60, v0, 3, 1
    v_lshl_add_u32 v19, v60, 9, v19
    v_bfe_u32 v60, v0, 2, 1
    v_lshl_add_u32 v19, v60, 7, v19
    v_and_b32 v60, 3, v0
    v_lshl_add_u32 v19, v60, 3, v19
    v_add_u32 v19, s57, v19
    v_add_u32 v19, 24576, v19
    ds_read_b64_tr_b16 v[36:37], v18 offset:0
    ds_read_b64_tr_b16 v[38:39], v18 offset:256
    ds_read_b64_tr_b16 v[40:41], v18 offset:12288
    ds_read_b64_tr_b16 v[42:43], v18 offset:12544
    ds_read_b64_tr_b16 v[44:45], v19 offset:0
    ds_read_b64_tr_b16 v[46:47], v19 offset:256
    ds_read_b64_tr_b16 v[48:49], v18 offset:32
    ds_read_b64_tr_b16 v[50:51], v18 offset:288
    ds_read_b64_tr_b16 v[52:53], v18 offset:12320
    ds_read_b64_tr_b16 v[54:55], v18 offset:12576
    ds_read_b64_tr_b16 v[56:57], v19 offset:32
    ds_read_b64_tr_b16 v[58:59], v19 offset:288
    v_lshrrev_b32 v32, 4, v0
    v_lshlrev_b32 v32, 5, v32
    v_bfe_u32 v60, v0, 1, 1
    v_lshl_add_u32 v32, v60, 4, v32
    v_and_b32 v60, 1, v0
    v_mul_u32_u24 v60, 192, v60
    v_add_u32 v32, v60, v32
    v_add_u32 v32, 160832, v32
    v_lshrrev_b32 v33, 4, v0
    v_lshlrev_b32 v33, 4, v33
    v_bfe_u32 v60, v0, 1, 1
    v_lshl_add_u32 v33, v60, 3, v33
    v_and_b32 v60, 1, v0
    v_mul_u32_u24 v60, 192, v60
    v_add_u32 v33, v60, v33
    v_add_u32 v33, 160960, v33
    v_mov_b64 v[24:25], 0
    v_mov_b64 v[26:27], 0
    v_mov_b64 v[28:29], 0
    v_mov_b64 v[30:31], 0
    s_lshr_b32 s57, s54, 1
    s_lshl_b32 s57, s57, 2
    s_and_b32 s58, s54, 1
    s_add_u32 s57, s57, s58
    s_lshl_b32 s57, s57, 4
    s_lshl_b32 s58, s30, 9
    s_add_u32 s57, s57, s58
    v_bfe_u32 v34, v0, 4, 1
    v_lshlrev_b32 v34, 8, v34
    v_bfe_u32 v60, v0, 1, 1
    v_lshl_add_u32 v34, v60, 5, v34
    v_bfe_u32 v60, v0, 2, 2
    v_lshl_add_u32 v34, v60, 2, v34
    v_lshrrev_b32 v60, 5, v0
    v_mul_u32_u24 v60, 3072, v60
    v_add_u32 v34, v60, v34
    v_and_b32 v60, 1, v0
    v_lshl_add_u32 v34, v60, 30, v34
    v_add_u32 v34, s57, v34
    s_mul_i32 s59, s53, 6400
    s_add_u32 s59, s59, s62
    s_add_u32 s59, s59, 57344
    s_add_u32 s60, s59, 6144
    ds_read_b128 v[12:15], v32
    ds_read_b64 v[16:17], v33
    s_waitcnt lgkmcnt(1)
    v_smfmac_f32_16x16x64_bf16 v[24:27], v[12:15], v[36:43], v1
    v_smfmac_f32_16x16x64_bf16 v[28:31], v[12:15], v[48:55], v1
    s_waitcnt lgkmcnt(0)
    v_smfmac_f32_16x16x32_bf16 v[24:27], v[16:17], v[44:47], v1
    v_smfmac_f32_16x16x32_bf16 v[28:31], v[16:17], v[56:59], v1
    s_cmp_eq_u32 s55, 0
    s_nop 5
    v_add_f32 v12, v24, v26
    s_nop 1
    v_add_f32_dpp v12, v28, v30 quad_perm:[0,1,2,3] row_mask:0x2 bank_mask:0xf
    s_nop 1
    v_add_f32_dpp v12, v25, v27 quad_perm:[0,1,2,3] row_mask:0x4 bank_mask:0xf
    s_nop 1
    v_add_f32_dpp v12, v29, v31 quad_perm:[0,1,2,3] row_mask:0x8 bank_mask:0xf
    s_nop 1
    v_mov_b32_dpp v13, v12 row_shl:1 row_mask:0xf bank_mask:0xf bound_ctrl:0
    v_cvt_pk_bf16_f32 v12, v12, v13
    v_min_u32 v12, -2, v12
    s_cbranch_scc1 L_gs_68
    buffer_store_dword v12, v34, s[40:43], s59 offen
L_gb_69:
L_skip_67:
    s_waitcnt vmcnt(0)
    s_barrier
    s_cmp_eq_u32 s30, 5
    s_cbranch_scc0 L_skip_70
    v_mov_b32 v25, 0
    s_lshl_b32 s57, s52, 2
    s_add_u32 s57, s57, s72
    s_mov_b64 exec, 1
    buffer_store_dword v25, v0, s[40:43], s57 offen offset:256 sc1
    s_mov_b64 exec, -1
    v_and_b32 v16, 31, v0
    v_lshlrev_b32 v16, 2, v16
L_pr_72:
    buffer_load_dword v17, v16, s[40:43], s72 offen offset:256 sc1
    s_sub_u32 s56, s56, 1
    s_cbranch_scc1 L_done
L_pw_71:
    s_waitcnt vmcnt(0)
    v_cmp_eq_u32 vcc, -1, v17
    s_cbranch_vccnz L_pr_72
L_skip_70:
    s_barrier
    s_branch L_spread_back
L_done:
L_exit:
    s_endpgm
.section .rodata,"a"
.p2align 6
.amdhsa_kernel interleave_layers__sliding_block_cached__dense_activation_gelu__decode_kernel
  .amdhsa_next_free_vgpr 256
  .amdhsa_next_free_sgpr 102
  .amdhsa_accum_offset 256
  .amdhsa_group_segment_fixed_size 0
  .amdhsa_kernarg_size 104
  .amdhsa_user_sgpr_count 2
  .amdhsa_user_sgpr_kernarg_segment_ptr 1
  .amdhsa_system_sgpr_workgroup_id_x 1
  .amdhsa_float_denorm_mode_32 3
.end_amdhsa_kernel
```

```asm
; @launch grid=(256,1,1) block=(512,1,1) lds=161216
.amdgcn_target "amdgcn-amd-amdhsa--gfx950"
.text
.fill 64, 4, 0xbf800000
.globl interleave_layers__sliding_block_cached__dense_activation_gelu__decode_kernel
.p2align 8
.type interleave_layers__sliding_block_cached__dense_activation_gelu__decode_kernel,@function
interleave_layers__sliding_block_cached__dense_activation_gelu__decode_kernel:
    s_load_dwordx16 s[4:19], s[0:1], 0
    s_load_dwordx8 s[20:27], s[0:1], 64
    s_load_dwordx2 s[28:29], s[0:1], 96
    s_cmp_ge_u32 s2, 256
    s_cbranch_scc1 L_exit
    s_getpc_b64 s[74:75]
L_pc:
    v_lshlrev_b32 v5, 6, v0
    v_min_u32 v5, L_exit-L_pc, v5
    global_load_dword v59, v5, s[74:75]
    v_lshrrev_b32 v5, 6, v0
    v_and_b32 v0, 63, v0
    v_readfirstlane_b32 s30, v5
    s_and_b32 s31, s2, 7
    s_lshr_b32 s52, s2, 3
    s_and_b32 s53, s52, 3
    s_lshr_b32 s54, s52, 2
    s_lshl_b32 s73, s31, 2
    s_add_u32 s73, s73, s53
    s_mul_i32 s3, s54, 3
    s_add_u32 s3, s3, s53
    s_cmp_eq_u32 s53, 3
    s_cselect_b32 s3, 31, s3
    s_cselect_b32 s70, 0, 0
    s_cmp_lt_u32 s3, 20
    s_cselect_b32 s70, 1, s70
    v_lshrrev_b32 v8, 5, v0
    v_lshlrev_b32 v8, 2, v8
    v_bfe_u32 v60, v0, 4, 1
    v_lshl_add_u32 v8, v60, 0, v8
    v_and_b32 v9, 7, v0
    v_xor_b32 v8, v8, v9
    v_lshrrev_b32 v10, 3, v0
    v_mul_u32_u24 v10, 384, v10
    v_lshl_add_u32 v5, v8, 4, v10
    v_xor_b32 v6, 32, v5
    v_lshrrev_b32 v8, 4, v0
    v_lshlrev_b32 v8, 1, v8
    v_xor_b32 v8, v8, v9
    v_lshl_add_u32 v7, v8, 4, v10
    v_lshrrev_b32 v2, 3, v0
    v_mul_u32_u24 v2, 12288, v2
    v_and_b32 v60, 7, v0
    v_lshl_add_u32 v2, v60, 4, v2
    s_mul_i32 s57, s73, 12582912
    s_mul_i32 s58, s54, 3072
    s_add_u32 s57, s57, s58
    s_add_u32 s57, s57, 11009024
    s_sub_u32 s58, 1573888, s58
    s_and_b32 s71, s73, 7
    s_mul_i32 s59, s73, 384
    s_mul_i32 s60, s54, 983040
    s_add_u32 s59, s59, s60
    s_sub_u32 s60, 7866368, s59
    s_lshl_b32 s61, s30, 11
    s_add_u32 s61, s61, 92160
    s_mul_i32 s62, s31, 83968
    s_lshl_b32 s72, s31, 9
    s_add_u32 s72, s72, 1900544
    s_mov_b32 s56, 65536
    s_mov_b32 s55, 1
    s_getreg_b32 s63, hwreg(20, 0, 3)
    s_andn2_b32 s64, 1, s63
    s_mul_i32 s64, s64, 1
    s_add_u32 s70, s70, s64
    v_mov_b32 v3, 0
    v_mov_b32 v4, 0
    v_mov_b32 v24, 0
    v_mov_b32 v34, 0
    v_mov_b64 v[12:13], -1
    v_mov_b64 v[14:15], -1
    v_lshlrev_b32 v10, 4, v0
    s_waitcnt lgkmcnt(0)
    s_add_u32 s32, s6, s57
    s_addc_u32 s33, s7, 0
    s_mov_b32 s34, s58
    s_mov_b32 s35, 0x20000
    s_add_u32 s36, s8, s57
    s_addc_u32 s37, s9, 0
    s_mov_b32 s38, s58
    s_mov_b32 s39, 0x20000
    s_mov_b32 s40, s28
    s_mov_b32 s41, s29
    s_mov_b32 s42, 1904640
    s_mov_b32 s43, 0x20000
    s_add_u32 s44, s10, s59
    s_addc_u32 s45, s11, 0
    s_mov_b32 s46, s60
    s_mov_b32 s47, 0x20000
    s_sub_u32 s44, s44, 2048
    s_subb_u32 s45, s45, 0
    s_cmp_eq_u32 s30, 6
    s_cbranch_scc0 L_skip_1
    s_setprio 3
    s_xor_b32 s57, s71, 0
    s_mul_i32 s57, s57, 196608
    s_add_u32 s57, s57, 1024
    s_xor_b32 s58, s71, 1
    s_mul_i32 s58, s58, 196608
    s_add_u32 s58, s58, 0
    s_mov_b32 m0, 92160
L_dma_2:
    s_nop 0
    buffer_load_dwordx4 v5, s[32:35], s57 offen offset:0 nt lds
    buffer_load_dwordx4 v6, s[32:35], s58 offen offset:1024 nt lds
    s_add_u32 s57, s57, 24576
    s_add_u32 s58, s58, 24576
    s_add_u32 m0, m0, 2048
    s_cmp_lg_u32 m0, 108544
    s_cbranch_scc1 L_dma_2
    s_xor_b32 s57, s71, 0
    s_mul_i32 s57, s57, 196608
    s_add_u32 s57, s57, 1152
    s_xor_b32 s58, s71, 1
    s_mul_i32 s58, s58, 196608
    s_add_u32 s58, s58, 128
    s_mov_b32 m0, 108544
L_dma_3:
    s_waitcnt vmcnt(23)
    s_cmp_ge_u32 s70, 2
    s_cbranch_scc1 L_go_4
    s_waitcnt vmcnt(22)
    s_cmp_ge_u32 s70, 1
    s_cbranch_scc1 L_go_4
    s_waitcnt vmcnt(21)
L_go_4:
    buffer_load_dwordx4 v5, s[32:35], s57 offen offset:0 nt lds
    buffer_load_dwordx4 v6, s[32:35], s58 offen offset:1024 nt lds
    s_add_u32 s57, s57, 24576
    s_add_u32 s58, s58, 24576
    s_add_u32 m0, m0, 2048
    s_cmp_lg_u32 m0, 124928
    s_cbranch_scc1 L_dma_3
    s_mov_b32 s57, 2048
    s_mov_b32 s58, 1152
    s_mov_b32 s59, 256
    s_mov_b32 m0, 0
L_dma_5:
    s_waitcnt vmcnt(23)
    s_cmp_ge_u32 s70, 2
    s_cbranch_scc1 L_go_6
    s_waitcnt vmcnt(22)
    s_cmp_ge_u32 s70, 1
    s_cbranch_scc1 L_go_6
    s_waitcnt vmcnt(21)
L_go_6:
    buffer_load_dwordx4 v2, s[44:47], s57 offen offset:0 nt lds
    buffer_load_dwordx4 v2, s[44:47], s58 offen offset:1024 nt lds
    buffer_load_dwordx4 v2, s[44:47], s59 offen offset:2048 nt lds
    s_add_u32 s57, s57, 98304
    s_add_u32 s58, s58, 98304
    s_add_u32 s59, s59, 98304
    s_add_u32 m0, m0, 3072
    s_cmp_lg_u32 m0, 15360
    s_cbranch_scc1 L_dma_5
L_skip_1:
    s_cmp_lt_u32 s3, 20
    s_cselect_b32 s57, 7864320, 0
    s_add_u32 s58, s54, 1
    s_mul_i32 s58, s58, 245760
    s_cmp_lg_u32 s53, 3
    s_cselect_b64 s[48:49], s[12:13], s[16:17]
    s_cselect_b32 s50, s57, s58
    s_mov_b32 s51, 0x20000
    s_add_u32 s57, s28, 1343488
    s_sub_u32 s57, 0, s57
    s_and_b32 s57, s57, 0x7fff
    s_add_u32 s57, s57, 1343488
    s_lshr_b32 s58, s31, 1
    s_lshl_b32 s58, s58, 15
    s_add_u32 s6, s57, s58
    s_and_b32 s58, s31, 1
    s_mul_i32 s58, s58, 2560
    s_add_u32 s6, s6, s58
    s_lshl_b32 s58, s3, 7
    s_add_u32 s6, s6, s58
    s_mov_b32 s8, s57
    s_lshr_b32 s58, s52, 4
    s_lshl_b32 s58, s58, 15
    s_and_b32 s59, s52, 15
    s_lshl_b32 s59, s59, 7
    s_add_u32 s59, s59, s58
    s_add_u32 s59, s59, s57
    s_add_u32 s59, s59, 5120
    s_lshl_b32 s58, s31, 16
    s_add_u32 s59, s59, s58
    s_add_u32 s10, s28, s59
    s_addc_u32 s11, s29, 0
    s_lshr_b32 s58, s63, 2
    s_xor_b32 s58, s58, 0
    s_mul_i32 s58, s58, 8192
    s_add_u32 s7, s57, s58
    s_cmp_eq_u32 s30, 5
    s_cbranch_scc0 L_skip_7
    s_cmp_eq_u32 s52, 31
    s_cbranch_scc0 L_skip_8
    s_mov_b64 exec, 0xffffff
    buffer_store_dwordx4 v[12:15], v10, s[40:43], s72 offen sc1
    s_mov_b64 exec, -1
L_skip_8:
    s_cmp_lt_u32 s3, 20
    s_cbranch_scc0 L_skip_9
    v_and_b32 v16, 7, v0
    v_lshlrev_b32 v16, 4, v16
    v_bfe_u32 v17, v0, 3, 1
    v_lshl_add_u32 v16, v17, 13, v16
    v_lshrrev_b32 v17, 4, v0
    v_lshl_add_u32 v16, v17, 17, v16
    s_add_u32 s57, s6, 0
    buffer_store_dwordx4 v[12:15], v16, s[40:43], s57 offen sc1
L_skip_9:
    s_sub_u32 s58, s3, 20
    s_cmp_lt_u32 s58, 4
    s_cselect_b32 s59, s59, 0x7f000000
    v_and_b32 v16, 7, v0
    v_lshlrev_b32 v16, 4, v16
    v_bfe_u32 v60, v0, 3, 1
    v_lshl_add_u32 v16, v60, 13, v16
    v_lshrrev_b32 v60, 4, v0
    v_lshl_add_u32 v16, v60, 28, v16
    buffer_store_dwordx4 v[12:15], v16, s[40:43], s59 offen sc1
    s_mul_i32 s57, s52, 1792
    s_add_u32 s57, s57, s62
    s_mov_b32 exec_lo, 0xffffffff
    s_mov_b32 exec_hi, 0xffff
    buffer_store_dwordx4 v[12:15], v10, s[40:43], s57 offen offset:1024
    s_mov_b64 exec, -1
    buffer_store_dwordx4 v[12:15], v10, s[40:43], s57 offen
    s_mov_b64 exec, -1
    v_lshlrev_b32 v16, 4, v0
    v_add_u32 v16, 159744, v16
    ds_write_b128 v16, v[12:15]
    v_subrev_u32 v16, 8, v0
    v_cmp_gt_u32 vcc, 40, v16
    v_mov_b32 v16, 0x3f803f80
    s_nop 0
    v_cndmask_b32 v18, 0, v16, vcc
    v_min_u32 v16, 55, v0
    v_lshlrev_b32 v16, 2, v16
    v_add_u32 v16, 160992, v16
    ds_write_b32 v16, v18
    v_and_b32 v3, 7, v0
    v_lshlrev_b32 v3, 5, v3
L_skip_7:
    s_cmp_eq_u32 s30, 7
    s_cbranch_scc0 L_skip_10
    v_and_b32 v60, 31, v0
    v_min_u32 v60, 19, v60
    s_mul_i32 s57, s54, 160
    v_lshrrev_b32 v16, 5, v0
    v_lshlrev_b32 v16, 2, v16
    v_add_u32 v16, s57, v16
    v_lshl_add_u32 v16, v60, 3, v16
    global_load_dword v28, v16, s[4:5]
    global_load_dword v4, v16, s[22:23]
L_skip_10:
    s_sub_u32 s58, s30, 4
    s_cmp_lt_u32 s58, 3
    s_cbranch_scc0 L_skip_11
    s_mul_i32 s57, s31, 3
    s_add_u32 s57, s57, s58
    s_lshl_b32 s57, s57, 7
    v_lshlrev_b32 v16, 1, v0
    v_add_u32 v16, s57, v16
    global_load_short_d16_hi v4, v16, s[18:19]
L_skip_11:
    v_bfe_u32 v8, v0, 1, 3
    v_lshrrev_b32 v9, 4, v0
    v_xor_b32 v9, v8, v9
    v_bfe_u32 v8, v0, 2, 1
    v_lshlrev_b32 v8, 10, v8
    v_bfe_u32 v60, v0, 3, 1
    v_lshl_add_u32 v8, v60, 9, v8
    v_and_b32 v60, 3, v0
    v_lshl_add_u32 v8, v60, 7, v8
    v_add_u32 v8, s61, v8
    v_lshl_add_u32 v8, v9, 4, v8
    v_xor_b32 v9, 64, v8
    v_bfe_u32 v1, v0, 1, 1
    v_mul_u32_u24 v1, 43690, v1
    v_add_u32 v1, 17476, v1
    s_waitcnt vmcnt(31)
    s_barrier
    ds_read_b128 v[64:67], v8 offset:0
    ds_read_b128 v[68:71], v9 offset:0
    s_cmp_eq_u32 s30, 6
    s_cbranch_scc0 L_skip_12
    s_xor_b32 s57, s71, 0
    s_mul_i32 s57, s57, 196608
    s_add_u32 s57, s57, 1280
    s_xor_b32 s58, s71, 1
    s_mul_i32 s58, s58, 196608
    s_add_u32 s58, s58, 256
    s_mov_b32 m0, 124928
L_dma_13:
    s_waitcnt vmcnt(23)
    s_cmp_ge_u32 s70, 2
    s_cbranch_scc1 L_go_14
    s_waitcnt vmcnt(22)
    s_cmp_ge_u32 s70, 1
    s_cbranch_scc1 L_go_14
    s_waitcnt vmcnt(21)
L_go_14:
    buffer_load_dwordx4 v5, s[32:35], s57 offen offset:0 nt lds
    buffer_load_dwordx4 v6, s[32:35], s58 offen offset:1024 nt lds
    s_add_u32 s57, s57, 24576
    s_add_u32 s58, s58, 24576
    s_add_u32 m0, m0, 2048
    s_cmp_lg_u32 m0, 141312
    s_cbranch_scc1 L_dma_13
L_skip_12:
    s_waitcnt lgkmcnt(0)
    s_cmp_eq_u32 s30, 5
    s_cbranch_scc0 L_skip_15
    s_cmp_eq_u32 s52, 31
    s_cbranch_scc0 L_skip_16
    s_lshl_b32 s57, s31, 5
    v_mov_b32 v16, s57
    s_add_u32 s57, s63, 1
    v_mov_b32 v12, s57
    s_waitcnt vmcnt(4)
    s_mov_b64 exec, 0x1
    global_store_dword v16, v12, s[26:27] sc1
    s_mov_b64 exec, -1
L_skip_16:
L_skip_15:
    s_waitcnt vmcnt(31)
    s_barrier
    ds_read_b128 v[72:75], v8 offset:16384
    ds_read_b128 v[76:79], v9 offset:16384
    s_cmp_eq_u32 s30, 6
    s_cbranch_scc0 L_skip_17
    s_mov_b32 s57, 493568
    s_mov_b32 s58, 492672
    s_mov_b32 s59, 491776
    s_mov_b32 m0, 15360
L_dma_18:
    s_waitcnt vmcnt(23)
    s_cmp_ge_u32 s70, 2
    s_cbranch_scc1 L_go_19
    s_waitcnt vmcnt(22)
    s_cmp_ge_u32 s70, 1
    s_cbranch_scc1 L_go_19
    s_waitcnt vmcnt(21)
L_go_19:
    buffer_load_dwordx4 v2, s[44:47], s57 offen offset:0 nt lds
    buffer_load_dwordx4 v2, s[44:47], s58 offen offset:1024 nt lds
    buffer_load_dwordx4 v2, s[44:47], s59 offen offset:2048 nt lds
    s_add_u32 s57, s57, 98304
    s_add_u32 s58, s58, 98304
    s_add_u32 s59, s59, 98304
    s_add_u32 m0, m0, 3072
    s_cmp_lg_u32 m0, 30720
    s_cbranch_scc1 L_dma_18
    s_xor_b32 s57, s71, 2
    s_mul_i32 s57, s57, 196608
    s_add_u32 s57, s57, 1024
    s_xor_b32 s58, s71, 3
    s_mul_i32 s58, s58, 196608
    s_add_u32 s58, s58, 0
    s_mov_b32 m0, 141312
L_dma_20:
    s_waitcnt vmcnt(23)
    s_cmp_ge_u32 s70, 2
    s_cbranch_scc1 L_go_21
    s_waitcnt vmcnt(22)
    s_cmp_ge_u32 s70, 1
    s_cbranch_scc1 L_go_21
    s_waitcnt vmcnt(21)
L_go_21:
    buffer_load_dwordx4 v5, s[32:35], s57 offen offset:0 nt lds
    buffer_load_dwordx4 v6, s[32:35], s58 offen offset:1024 nt lds
    s_add_u32 s57, s57, 24576
    s_add_u32 s58, s58, 24576
    s_add_u32 m0, m0, 2048
    s_cmp_lg_u32 m0, 157696
    s_cbranch_scc1 L_dma_20
L_skip_17:
    s_waitcnt lgkmcnt(0)
    s_cmp_lt_u32 s30, 4
    s_cbranch_scc0 L_skip_22
    s_mov_b64 exec, 0
    s_cmp_eq_u32 s30, 1
    s_cbranch_scc1 L_pad1
    s_cmp_eq_u32 s30, 2
    s_cbranch_scc1 L_pad2
    s_cmp_eq_u32 s30, 3
    s_cbranch_scc1 L_pad3
    s_branch L_pad0
L_padback:
    s_mov_b64 exec, -1
L_skip_22:
    s_waitcnt vmcnt(31)
    s_barrier
    ds_read_b128 v[80:83], v8 offset:32768
    ds_read_b128 v[84:87], v9 offset:32768
    s_cmp_eq_u32 s30, 6
    s_cbranch_scc0 L_skip_23
    s_cmp_lg_u32 s53, 3
    s_cbranch_scc0 L_wb_24
    s_mul_i32 s57, s31, 983040
    s_lshl_b32 s58, s3, 6
    s_add_u32 s57, s57, s58
    v_bfe_u32 v38, v0, 4, 1
    v_lshlrev_b32 v38, 1, v38
    v_xor_b32 v38, v38, v0
    v_and_b32 v38, 3, v38
    v_lshrrev_b32 v3, 5, v0
    v_mul_u32_u24 v3, 10240, v3
    v_bfe_u32 v39, v0, 4, 1
    v_mul_u32_u24 v39, 2560, v39
    v_add_u32 v3, v39, v3
    v_bfe_u32 v39, v0, 3, 1
    v_mul_u32_u24 v39, 5120, v39
    v_add_u32 v3, v39, v3
    v_bfe_u32 v39, v0, 2, 1
    v_mul_u32_u24 v39, 20480, v39
    v_add_u32 v3, v39, v3
    v_add_u32 v3, s57, v3
    v_lshl_add_u32 v3, v38, 4, v3
    s_mov_b32 s14, 40960
    s_mov_b32 s15, 256
    s_branch L_we_25
L_wb_24:
    s_mul_i32 s57, s31, 384
    s_mul_i32 s58, s54, 245760
    s_add_u32 s57, s57, s58
    v_lshlrev_b32 v3, 4, v0
    v_add_u32 v3, s57, v3
    v_mov_b32 v38, 2688
    v_cmp_lt_u32 vcc, 23, v0
    s_nop 1
    v_cndmask_b32 v38, 0, v38, vcc
    v_add_u32 v3, v38, v3
    v_mov_b32 v38, 0x7f000000
    v_cmp_lt_u32 vcc, 47, v0
    s_nop 1
    v_cndmask_b32 v3, v3, v38, vcc
    s_mov_b32 s14, 12288
    s_mov_b32 s15, 5120
L_we_25:
    s_mul_i32 s57, s14, 0
    s_mov_b32 m0, 30720
    s_nop 0
    buffer_load_dwordx4 v3, s[48:51], s57 offen offset:0 nt lds
    s_mul_i32 s57, s14, 0
    s_add_u32 s57, s57, s15
    s_mov_b32 m0, 30720
    s_nop 0
    buffer_load_dwordx4 v3, s[48:51], s57 offen offset:1024 nt lds
    s_xor_b32 s57, s71, 2
    s_mul_i32 s57, s57, 196608
    s_add_u32 s57, s57, 1152
    s_xor_b32 s58, s71, 3
    s_mul_i32 s58, s58, 196608
    s_add_u32 s58, s58, 128
    s_mov_b32 m0, 92160
L_dma_26:
    s_waitcnt vmcnt(23)
    s_cmp_ge_u32 s70, 2
    s_cbranch_scc1 L_go_27
    s_waitcnt vmcnt(22)
    s_cmp_ge_u32 s70, 1
    s_cbranch_scc1 L_go_27
    s_waitcnt vmcnt(21)
L_go_27:
    buffer_load_dwordx4 v5, s[32:35], s57 offen offset:0 nt lds
    buffer_load_dwordx4 v6, s[32:35], s58 offen offset:1024 nt lds
    s_add_u32 s57, s57, 24576
    s_add_u32 s58, s58, 24576
    s_add_u32 m0, m0, 2048
    s_cmp_lg_u32 m0, 108544
    s_cbranch_scc1 L_dma_26
    s_mul_i32 s57, s14, 1
    s_mov_b32 m0, 32768
    s_nop 0
    buffer_load_dwordx4 v3, s[48:51], s57 offen offset:0 nt lds
    s_mul_i32 s57, s14, 1
    s_add_u32 s57, s57, s15
    s_mov_b32 m0, 32768
    s_nop 0
    buffer_load_dwordx4 v3, s[48:51], s57 offen offset:1024 nt lds
    s_xor_b32 s57, s71, 2
    s_mul_i32 s57, s57, 196608
    s_add_u32 s57, s57, 1280
    s_xor_b32 s58, s71, 3
    s_mul_i32 s58, s58, 196608
    s_add_u32 s58, s58, 256
    s_mov_b32 m0, 108544
L_dma_28:
    s_waitcnt vmcnt(23)
    s_cmp_ge_u32 s70, 2
    s_cbranch_scc1 L_go_29
    s_waitcnt vmcnt(22)
    s_cmp_ge_u32 s70, 1
    s_cbranch_scc1 L_go_29
    s_waitcnt vmcnt(21)
L_go_29:
    buffer_load_dwordx4 v5, s[32:35], s57 offen offset:0 nt lds
    buffer_load_dwordx4 v6, s[32:35], s58 offen offset:1024 nt lds
    s_add_u32 s57, s57, 24576
    s_add_u32 s58, s58, 24576
    s_add_u32 m0, m0, 2048
    s_cmp_lg_u32 m0, 124928
    s_cbranch_scc1 L_dma_28
L_skip_23:
    s_waitcnt lgkmcnt(0)
    s_cmp_lt_u32 s30, 5
    s_cbranch_scc0 L_skip_30
    s_waitcnt vmcnt(0)
L_skip_30:
    s_cmp_eq_u32 s30, 7
    s_cbranch_scc0 L_skip_31
    v_and_b32 v60, 31, v0
    v_cmp_gt_u32 s[64:65], 20, v60
    v_min_u32 v60, 19, v60
    v_lshrrev_b32 v35, 5, v0
    v_lshlrev_b32 v35, 2, v35
    v_add_u32 v35, 160832, v35
    v_lshl_add_u32 v35, v60, 3, v35
    s_mul_i32 s66, s53, 6400
    s_add_u32 s66, s66, s62
    s_add_u32 s66, s66, 57344
    s_add_u32 s67, s66, 6144
    s_lshl_b32 s57, s54, 3
    v_lshrrev_b32 v34, 5, v0
    v_lshlrev_b32 v34, 2, v34
    v_add_u32 v34, s57, v34
    v_and_b32 v60, 31, v0
    v_mov_b32 v61, 0x7f000000
    v_cmp_ne_u32 vcc, 31, v60
    s_nop 1
    v_cndmask_b32 v34, v34, v61, vcc
    v_mov_b32 v61, 0x3f803f80
    s_waitcnt vmcnt(0)
    ds_write_b32 v35, v28
    s_waitcnt lgkmcnt(0)
L_skip_31:
    s_cmp_eq_u32 s30, 5
    s_cbranch_scc0 L_skip_32
    s_waitcnt vmcnt(0)
    s_lshr_b32 s65, s63, 2
    s_sub_u32 s58, s3, 20
    s_cmp_lt_u32 s58, 4
    s_cbranch_scc0 L_skip_33
    s_mov_b32 s67, 0
    s_load_dword s66, s[10:11], 0
    s_load_dword s67, s[10:11], 8192
    s_waitcnt lgkmcnt(1)
    s_sleep 1
    s_mov_b32 s65, s67
L_skip_33:
L_skip_32:
    s_waitcnt vmcnt(36)
    s_barrier
    ds_read_b128 v[88:91], v8 offset:49152
    ds_read_b128 v[92:95], v9 offset:49152
    s_cmp_eq_u32 s30, 6
    s_cbranch_scc0 L_skip_34
    s_mul_i32 s57, s14, 2
    s_mov_b32 m0, 34816
    s_nop 0
    buffer_load_dwordx4 v3, s[48:51], s57 offen offset:0 nt lds
    s_mul_i32 s57, s14, 2
    s_add_u32 s57, s57, s15
    s_mov_b32 m0, 34816
    s_nop 0
    buffer_load_dwordx4 v3, s[48:51], s57 offen offset:1024 nt lds
    s_xor_b32 s57, s71, 4
    s_mul_i32 s57, s57, 196608
    s_add_u32 s57, s57, 1024
    s_xor_b32 s58, s71, 5
    s_mul_i32 s58, s58, 196608
    s_add_u32 s58, s58, 0
    s_mov_b32 m0, 124928
L_dma_35:
    s_waitcnt vmcnt(23)
    s_cmp_ge_u32 s70, 2
    s_cbranch_scc1 L_go_36
    s_waitcnt vmcnt(22)
    s_cmp_ge_u32 s70, 1
    s_cbranch_scc1 L_go_36
    s_waitcnt vmcnt(21)
L_go_36:
    buffer_load_dwordx4 v5, s[32:35], s57 offen offset:0 nt lds
    buffer_load_dwordx4 v6, s[32:35], s58 offen offset:1024 nt lds
    s_add_u32 s57, s57, 24576
    s_add_u32 s58, s58, 24576
    s_add_u32 m0, m0, 2048
    s_cmp_lg_u32 m0, 141312
    s_cbranch_scc1 L_dma_35
L_skip_34:
    s_waitcnt lgkmcnt(0)
    s_cmp_eq_u32 s30, 7
    s_cbranch_scc0 L_skip_37
    v_cndmask_b32 v29, 0, v28, s[64:65]
    v_dot2_f32_bf16 v33, v29, v61, 0
    v_dot2_f32_bf16 v62, v29, v29, 0
    v_lshlrev_b32 v2, 16, v28
    v_and_b32 v3, 0xffff0000, v28
    s_cmp_eq_u32 s55, 0
    v_permlane32_swap_b32 v33, v62
    v_add_f32 v33, v33, v62
    s_nop 1
    v_add_f32_dpp v33, v33, v33 row_ror:8 row_mask:0xf bank_mask:0xf
    s_nop 1
    v_add_f32_dpp v33, v33, v33 row_ror:4 row_mask:0xf bank_mask:0xf
    s_nop 1
    v_add_f32_dpp v33, v33, v33 row_ror:2 row_mask:0xf bank_mask:0xf
    s_nop 1
    v_add_f32_dpp v33, v33, v33 row_ror:1 row_mask:0xf bank_mask:0xf
    s_nop 1
    v_add_f32_dpp v33, v33, v33 row_bcast:15 row_mask:0xa bank_mask:0xf
    v_min_u32 v33, -2, v33
    s_cbranch_scc1 L_gs_38
    buffer_store_dword v33, v34, s[40:43], s67 offen
L_gb_39:
    s_waitcnt vmcnt(1)
L_skip_37:
    s_cmp_lt_u32 s30, 6
    s_cbranch_scc0 L_skip_40
    s_lshr_b32 s57, s30, 1
    s_mul_i32 s57, s57, 1024
    s_and_b32 s58, s30, 1
    s_lshl_b32 s58, s58, 6
    s_add_u32 s57, s57, s58
    v_lshrrev_b32 v18, 5, v0
    v_mul_u32_u24 v18, 6144, v18
    v_bfe_u32 v60, v0, 3, 1
    v_mul_u32_u24 v60, 3072, v60
    v_add_u32 v18, v60, v18
    v_bfe_u32 v60, v0, 4, 1
    v_lshl_add_u32 v18, v60, 9, v18
    v_bfe_u32 v60, v0, 2, 1
    v_lshl_add_u32 v18, v60, 7, v18
    v_and_b32 v60, 3, v0
    v_lshl_add_u32 v18, v60, 3, v18
    v_add_u32 v18, s57, v18
    v_bfe_u32 v19, v0, 4, 1
    v_mul_u32_u24 v19, 3072, v19
    v_bfe_u32 v60, v0, 3, 1
    v_lshl_add_u32 v19, v60, 9, v19
    v_bfe_u32 v60, v0, 2, 1
    v_lshl_add_u32 v19, v60, 7, v19
    v_and_b32 v60, 3, v0
    v_lshl_add_u32 v19, v60, 3, v19
    v_add_u32 v19, s57, v19
    v_add_u32 v19, 24576, v19
    ds_read_b64_tr_b16 v[36:37], v18 offset:0
    ds_read_b64_tr_b16 v[38:39], v18 offset:256
    ds_read_b64_tr_b16 v[40:41], v18 offset:12288
    ds_read_b64_tr_b16 v[42:43], v18 offset:12544
    ds_read_b64_tr_b16 v[44:45], v19 offset:0
    ds_read_b64_tr_b16 v[46:47], v19 offset:256
    ds_read_b64_tr_b16 v[48:49], v18 offset:32
    ds_read_b64_tr_b16 v[50:51], v18 offset:288
    ds_read_b64_tr_b16 v[52:53], v18 offset:12320
    ds_read_b64_tr_b16 v[54:55], v18 offset:12576
    ds_read_b64_tr_b16 v[56:57], v19 offset:32
    ds_read_b64_tr_b16 v[58:59], v19 offset:288
    v_lshrrev_b32 v32, 4, v0
    v_lshlrev_b32 v32, 5, v32
    v_bfe_u32 v60, v0, 1, 1
    v_lshl_add_u32 v32, v60, 4, v32
    v_and_b32 v60, 1, v0
    v_mul_u32_u24 v60, 192, v60
    v_add_u32 v32, v60, v32
    v_add_u32 v32, 160832, v32
    v_lshrrev_b32 v33, 4, v0
    v_lshlrev_b32 v33, 4, v33
    v_bfe_u32 v60, v0, 1, 1
    v_lshl_add_u32 v33, v60, 3, v33
    v_and_b32 v60, 1, v0
    v_mul_u32_u24 v60, 192, v60
    v_add_u32 v33, v60, v33
    v_add_u32 v33, 160960, v33
    v_mov_b64 v[24:25], 0
    v_mov_b64 v[26:27], 0
    v_mov_b64 v[28:29], 0
    v_mov_b64 v[30:31], 0
    s_lshl_b32 s57, s54, 1
    s_lshl_b32 s58, s30, 9
    s_add_u32 s57, s57, s58
    v_and_b32 v34, 31, v0
    v_lshlrev_b32 v34, 4, v34
    v_lshrrev_b32 v60, 5, v0
    v_mul_u32_u24 v60, 3072, v60
    v_add_u32 v34, v60, v34
    v_add_u32 v34, s57, v34
    s_mul_i32 s59, s53, 6400
    s_add_u32 s59, s59, s62
    s_add_u32 s59, s59, 57344
    s_add_u32 s60, s59, 6144
    ds_read_b128 v[12:15], v32
    ds_read_b64 v[16:17], v33
    s_waitcnt lgkmcnt(1)
    v_smfmac_f32_16x16x64_bf16 v[24:27], v[12:15], v[36:43], v1
    v_smfmac_f32_16x16x64_bf16 v[28:31], v[12:15], v[48:55], v1
    s_waitcnt lgkmcnt(0)
    v_smfmac_f32_16x16x32_bf16 v[24:27], v[16:17], v[44:47], v1
    v_smfmac_f32_16x16x32_bf16 v[28:31], v[16:17], v[56:59], v1
    s_cmp_eq_u32 s55, 0
    s_nop 5
    v_add_f32 v12, v24, v26
    s_nop 1
    v_add_f32_dpp v12, v28, v30 quad_perm:[0,1,2,3] row_mask:0x2 bank_mask:0xf
    s_nop 1
    v_add_f32_dpp v12, v25, v27 quad_perm:[0,1,2,3] row_mask:0x4 bank_mask:0xf
    s_nop 1
    v_add_f32_dpp v12, v29, v31 quad_perm:[0,1,2,3] row_mask:0x8 bank_mask:0xf
    v_cvt_pk_bf16_f32 v12, v12, v12
    v_min_u32 v12, -2, v12
    s_cbranch_scc1 L_gs_41
    buffer_store_short v12, v34, s[40:43], s59 offen
L_gb_42:
L_skip_40:
    s_cmp_eq_u32 s30, 5
    s_cbranch_scc0 L_skip_43
    global_load_dword v2, v3, s[26:27] sc1
L_skip_43:
    s_waitcnt vmcnt(36)
    s_barrier
    ds_read_b128 v[96:99], v8 offset:0
    ds_read_b128 v[100:103], v9 offset:0
    s_cmp_eq_u32 s30, 6
    s_cbranch_scc0 L_skip_44
    s_mul_i32 s57, s14, 3
    s_mov_b32 m0, 36864
    s_nop 0
    buffer_load_dwordx4 v3, s[48:51], s57 offen offset:0 nt lds
    s_mul_i32 s57, s14, 3
    s_add_u32 s57, s57, s15
    s_mov_b32 m0, 36864
    s_nop 0
    buffer_load_dwordx4 v3, s[48:51], s57 offen offset:1024 nt lds
    s_xor_b32 s57, s71, 4
    s_mul_i32 s57, s57, 196608
    s_add_u32 s57, s57, 1152
    s_xor_b32 s58, s71, 5
    s_mul_i32 s58, s58, 196608
    s_add_u32 s58, s58, 128
    s_mov_b32 m0, 141312
L_dma_45:
    s_waitcnt vmcnt(23)
    s_cmp_ge_u32 s70, 2
    s_cbranch_scc1 L_go_46
    s_waitcnt vmcnt(22)
    s_cmp_ge_u32 s70, 1
    s_cbranch_scc1 L_go_46
    s_waitcnt vmcnt(21)
L_go_46:
    buffer_load_dwordx4 v5, s[32:35], s57 offen offset:0 nt lds
    buffer_load_dwordx4 v6, s[32:35], s58 offen offset:1024 nt lds
    s_add_u32 s57, s57, 24576
    s_add_u32 s58, s58, 24576
    s_add_u32 m0, m0, 2048
    s_cmp_lg_u32 m0, 157696
    s_cbranch_scc1 L_dma_45
L_skip_44:
    s_waitcnt lgkmcnt(0)
    s_waitcnt vmcnt(36)
    s_barrier
    ds_read_b128 v[104:107], v8 offset:16384
    ds_read_b128 v[108:111], v9 offset:16384
    s_cmp_eq_u32 s30, 6
    s_cbranch_scc0 L_skip_47
    s_mul_i32 s57, s14, 4
    s_mov_b32 m0, 38912
    s_nop 0
    buffer_load_dwordx4 v3, s[48:51], s57 offen offset:0 nt lds
    s_mul_i32 s57, s14, 4
    s_add_u32 s57, s57, s15
    s_mov_b32 m0, 38912
    s_nop 0
    buffer_load_dwordx4 v3, s[48:51], s57 offen offset:1024 nt lds
    s_xor_b32 s57, s71, 4
    s_mul_i32 s57, s57, 196608
    s_add_u32 s57, s57, 1280
    s_xor_b32 s58, s71, 5
    s_mul_i32 s58, s58, 196608
    s_add_u32 s58, s58, 256
    s_mov_b32 m0, 92160
L_dma_48:
    s_waitcnt vmcnt(23)
    s_cmp_ge_u32 s70, 2
    s_cbranch_scc1 L_go_49
    s_waitcnt vmcnt(22)
    s_cmp_ge_u32 s70, 1
    s_cbranch_scc1 L_go_49
    s_waitcnt vmcnt(21)
L_go_49:
    buffer_load_dwordx4 v5, s[32:35], s57 offen offset:0 nt lds
    buffer_load_dwordx4 v6, s[32:35], s58 offen offset:1024 nt lds
    s_add_u32 s57, s57, 24576
    s_add_u32 s58, s58, 24576
    s_add_u32 m0, m0, 2048
    s_cmp_lg_u32 m0, 108544
    s_cbranch_scc1 L_dma_48
L_skip_47:
    s_waitcnt lgkmcnt(0)
    s_cmp_lg_u32 s30, 6
    s_cbranch_scc0 L_skip_50
    s_waitcnt vmcnt(0)
L_skip_50:
    s_waitcnt vmcnt(36)
    s_barrier
    ds_read_b128 v[112:115], v8 offset:32768
    ds_read_b128 v[116:119], v9 offset:32768
    s_cmp_eq_u32 s30, 6
    s_cbranch_scc0 L_skip_51
    s_mul_i32 s57, s14, 5
    s_mov_b32 m0, 40960
    s_nop 0
    buffer_load_dwordx4 v3, s[48:51], s57 offen offset:0 nt lds
    s_mul_i32 s57, s14, 5
    s_add_u32 s57, s57, s15
    s_mov_b32 m0, 40960
    s_nop 0
    buffer_load_dwordx4 v3, s[48:51], s57 offen offset:1024 nt lds
    s_xor_b32 s57, s71, 6
    s_mul_i32 s57, s57, 196608
    s_add_u32 s57, s57, 1024
    s_xor_b32 s58, s71, 7
    s_mul_i32 s58, s58, 196608
    s_add_u32 s58, s58, 0
    s_mov_b32 m0, 108544
L_dma_52:
    s_waitcnt vmcnt(23)
    s_cmp_ge_u32 s70, 2
    s_cbranch_scc1 L_go_53
    s_waitcnt vmcnt(22)
    s_cmp_ge_u32 s70, 1
    s_cbranch_scc1 L_go_53
    s_waitcnt vmcnt(21)
L_go_53:
    buffer_load_dwordx4 v5, s[32:35], s57 offen offset:0 nt lds
    buffer_load_dwordx4 v6, s[32:35], s58 offen offset:1024 nt lds
    s_add_u32 s57, s57, 24576
    s_add_u32 s58, s58, 24576
    s_add_u32 m0, m0, 2048
    s_cmp_lg_u32 m0, 124928
    s_cbranch_scc1 L_dma_52
L_skip_51:
    s_waitcnt lgkmcnt(0)
    s_cmp_eq_u32 s30, 5
    s_cbranch_scc0 L_skip_54
L_cw_55:
    v_readlane_b32 s57, v2, s31
    s_cmp_eq_u32 s57, 0
    s_cbranch_scc1 L_cr_56
    s_lshr_b32 s58, s63, 2
    s_xor_b32 s58, s58, s65
    s_and_b32 s58, s58, 1
    v_mov_b32 v25, s58
    s_sub_u32 s57, s57, 1
    s_cmp_eq_u32 s57, s63
    s_cselect_b32 s64, 1, 0
    s_cbranch_scc0 L_far_57
    s_lshl_b32 s57, s52, 2
    s_add_u32 s57, s57, s72
    s_mov_b64 exec, 1
    buffer_store_dword v25, v0, s[40:43], s57 offen offset:0
    s_mov_b64 exec, -1
L_fb_58:
L_skip_54:
    s_waitcnt vmcnt(36)
    s_barrier
    ds_read_b128 v[120:123], v8 offset:49152
    ds_read_b128 v[124:127], v9 offset:49152
    s_cmp_eq_u32 s30, 6
    s_cbranch_scc0 L_skip_59
    s_mul_i32 s57, s14, 6
    s_mov_b32 m0, 43008
    s_nop 0
    buffer_load_dwordx4 v3, s[48:51], s57 offen offset:0 nt lds
    s_mul_i32 s57, s14, 6
    s_add_u32 s57, s57, s15
    s_mov_b32 m0, 43008
    s_nop 0
    buffer_load_dwordx4 v3, s[48:51], s57 offen offset:1024 nt lds
    s_xor_b32 s57, s71, 6
    s_mul_i32 s57, s57, 196608
    s_add_u32 s57, s57, 1152
    s_xor_b32 s58, s71, 7
    s_mul_i32 s58, s58, 196608
    s_add_u32 s58, s58, 128
    s_mov_b32 m0, 124928
L_dma_60:
    s_waitcnt vmcnt(23)
    s_cmp_ge_u32 s70, 2
    s_cbranch_scc1 L_go_61
    s_waitcnt vmcnt(22)
    s_cmp_ge_u32 s70, 1
    s_cbranch_scc1 L_go_61
    s_waitcnt vmcnt(21)
L_go_61:
    buffer_load_dwordx4 v5, s[32:35], s57 offen offset:0 nt lds
    buffer_load_dwordx4 v6, s[32:35], s58 offen offset:1024 nt lds
    s_add_u32 s57, s57, 24576
    s_add_u32 s58, s58, 24576
    s_add_u32 m0, m0, 2048
    s_cmp_lg_u32 m0, 141312
    s_cbranch_scc1 L_dma_60
L_skip_59:
    s_waitcnt lgkmcnt(0)
    s_waitcnt vmcnt(36)
    s_barrier
    ds_read_b128 v[128:131], v8 offset:0
    ds_read_b128 v[132:135], v9 offset:0
    s_cmp_eq_u32 s30, 6
    s_cbranch_scc0 L_skip_62
    s_mul_i32 s57, s14, 7
    s_mov_b32 m0, 45056
    s_nop 0
    buffer_load_dwordx4 v3, s[48:51], s57 offen offset:0 nt lds
    s_mul_i32 s57, s14, 7
    s_add_u32 s57, s57, s15
    s_mov_b32 m0, 45056
    s_nop 0
    buffer_load_dwordx4 v3, s[48:51], s57 offen offset:1024 nt lds
    s_xor_b32 s57, s71, 6
    s_mul_i32 s57, s57, 196608
    s_add_u32 s57, s57, 1280
    s_xor_b32 s58, s71, 7
    s_mul_i32 s58, s58, 196608
    s_add_u32 s58, s58, 256
    s_mov_b32 m0, 141312
L_dma_63:
    s_waitcnt vmcnt(23)
    s_cmp_ge_u32 s70, 2
    s_cbranch_scc1 L_go_64
    s_waitcnt vmcnt(22)
    s_cmp_ge_u32 s70, 1
    s_cbranch_scc1 L_go_64
    s_waitcnt vmcnt(21)
L_go_64:
    buffer_load_dwordx4 v5, s[32:35], s57 offen offset:0 nt lds
    buffer_load_dwordx4 v6, s[32:35], s58 offen offset:1024 nt lds
    s_add_u32 s57, s57, 24576
    s_add_u32 s58, s58, 24576
    s_add_u32 m0, m0, 2048
    s_cmp_lg_u32 m0, 157696
    s_cbranch_scc1 L_dma_63
L_skip_62:
    s_waitcnt lgkmcnt(0)
    s_cmp_eq_u32 s30, 5
    s_cbranch_scc0 L_skip_65
    v_lshlrev_b32 v24, 2, v0
    buffer_load_dword v2, v24, s[40:43], s72 offen sc1
L_skip_65:
    s_waitcnt vmcnt(36)
    s_barrier
    ds_read_b128 v[136:139], v8 offset:16384
    ds_read_b128 v[140:143], v9 offset:16384
    s_cmp_eq_u32 s30, 6
    s_cbranch_scc0 L_skip_66
    s_mul_i32 s57, s14, 8
    s_mov_b32 m0, 47104
    s_nop 0
    buffer_load_dwordx4 v3, s[48:51], s57 offen offset:0 nt lds
    s_mul_i32 s57, s14, 8
    s_add_u32 s57, s57, s15
    s_mov_b32 m0, 47104
    s_nop 0
    buffer_load_dwordx4 v3, s[48:51], s57 offen offset:1024 nt lds
    s_xor_b32 s57, s71, 0
    s_mul_i32 s57, s57, 196608
    s_add_u32 s57, s57, 1024
    s_xor_b32 s58, s71, 2
    s_mul_i32 s58, s58, 196608
    s_add_u32 s58, s58, 0
    s_mov_b32 m0, 92160
L_dma_67:
    s_waitcnt vmcnt(23)
    s_cmp_ge_u32 s70, 2
    s_cbranch_scc1 L_go_68
    s_waitcnt vmcnt(22)
    s_cmp_ge_u32 s70, 1
    s_cbranch_scc1 L_go_68
    s_waitcnt vmcnt(21)
L_go_68:
    buffer_load_dwordx4 v7, s[36:39], s57 offen offset:0 nt lds
    buffer_load_dwordx4 v7, s[36:39], s58 offen offset:1024 nt lds
    s_add_u32 s57, s57, 24576
    s_add_u32 s58, s58, 24576
    s_add_u32 m0, m0, 2048
    s_cmp_lg_u32 m0, 108544
    s_cbranch_scc1 L_dma_67
L_skip_66:
    s_waitcnt lgkmcnt(0)
    s_waitcnt vmcnt(36)
    s_barrier
    ds_read_b128 v[144:147], v8 offset:32768
    ds_read_b128 v[148:151], v9 offset:32768
    s_cmp_eq_u32 s30, 6
    s_cbranch_scc0 L_skip_69
    s_mul_i32 s57, s14, 9
    s_mov_b32 m0, 49152
    s_nop 0
    buffer_load_dwordx4 v3, s[48:51], s57 offen offset:0 nt lds
    s_mul_i32 s57, s14, 9
    s_add_u32 s57, s57, s15
    s_mov_b32 m0, 49152
    s_nop 0
    buffer_load_dwordx4 v3, s[48:51], s57 offen offset:1024 nt lds
    s_xor_b32 s57, s71, 0
    s_mul_i32 s57, s57, 196608
    s_add_u32 s57, s57, 1152
    s_xor_b32 s58, s71, 2
    s_mul_i32 s58, s58, 196608
    s_add_u32 s58, s58, 128
    s_mov_b32 m0, 108544
L_dma_70:
    s_waitcnt vmcnt(23)
    s_cmp_ge_u32 s70, 2
    s_cbranch_scc1 L_go_71
    s_waitcnt vmcnt(22)
    s_cmp_ge_u32 s70, 1
    s_cbranch_scc1 L_go_71
    s_waitcnt vmcnt(21)
L_go_71:
    buffer_load_dwordx4 v7, s[36:39], s57 offen offset:0 nt lds
    buffer_load_dwordx4 v7, s[36:39], s58 offen offset:1024 nt lds
    s_add_u32 s57, s57, 24576
    s_add_u32 s58, s58, 24576
    s_add_u32 m0, m0, 2048
    s_cmp_lg_u32 m0, 124928
    s_cbranch_scc1 L_dma_70
L_skip_69:
    s_waitcnt lgkmcnt(0)
    s_cmp_eq_u32 s30, 5
    s_cbranch_scc0 L_skip_72
L_cw_73:
    s_waitcnt vmcnt(0)
    v_cmp_ne_u32 vcc, -1, v2
    s_mov_b32 s57, 0
    s_mov_b32 s68, 2
    s_cmp_eq_u32 s64, 0
    s_cbranch_scc1 L_cd_75
    s_cmp_lg_u32 vcc_hi, 0
    s_cbranch_scc1 L_cd_75
    s_cmp_lg_u32 vcc_lo, -1
    s_cbranch_scc1 L_cr_74
    v_cmp_eq_u32 vcc, 1, v2
    s_bcnt1_i32_b32 s68, vcc_lo
    s_mov_b32 s57, 1
L_cd_75:
    v_mov_b32 v37, 160768
    v_mov_b32 v38, s57
    ds_write_b32 v37, v38
    s_waitcnt lgkmcnt(0)
L_skip_72:
    s_waitcnt vmcnt(36)
    s_barrier
    ds_read_b128 v[152:155], v8 offset:49152
    ds_read_b128 v[156:159], v9 offset:49152
    s_cmp_eq_u32 s30, 6
    s_cbranch_scc0 L_skip_76
    s_mul_i32 s57, s14, 10
    s_mov_b32 m0, 51200
    s_nop 0
    buffer_load_dwordx4 v3, s[48:51], s57 offen offset:0 nt lds
    s_mul_i32 s57, s14, 10
    s_add_u32 s57, s57, s15
    s_mov_b32 m0, 51200
    s_nop 0
    buffer_load_dwordx4 v3, s[48:51], s57 offen offset:1024 nt lds
    s_xor_b32 s57, s71, 0
    s_mul_i32 s57, s57, 196608
    s_add_u32 s57, s57, 1280
    s_xor_b32 s58, s71, 2
    s_mul_i32 s58, s58, 196608
    s_add_u32 s58, s58, 256
    s_mov_b32 m0, 124928
L_dma_77:
    s_waitcnt vmcnt(23)
    s_cmp_ge_u32 s70, 2
    s_cbranch_scc1 L_go_78
    s_waitcnt vmcnt(22)
    s_cmp_ge_u32 s70, 1
    s_cbranch_scc1 L_go_78
    s_waitcnt vmcnt(21)
L_go_78:
    buffer_load_dwordx4 v7, s[36:39], s57 offen offset:0 nt lds
    buffer_load_dwordx4 v7, s[36:39], s58 offen offset:1024 nt lds
    s_add_u32 s57, s57, 24576
    s_add_u32 s58, s58, 24576
    s_add_u32 m0, m0, 2048
    s_cmp_lg_u32 m0, 141312
    s_cbranch_scc1 L_dma_77
L_skip_76:
    s_waitcnt lgkmcnt(0)
    v_lshrrev_b32 v8, 2, v0
    v_lshlrev_b32 v8, 7, v8
    v_bfe_u32 v60, v0, 3, 2
    v_lshl_add_u32 v8, v60, 5, v8
    v_and_b32 v60, 3, v0
    v_lshl_add_u32 v8, v60, 3, v8
    v_add_u32 v8, s61, v8
    v_xor_b32 v9, 32, v8
    v_xor_b32 v10, 64, v8
    v_xor_b32 v11, 96, v8
    v_mov_b32 v41, 160768
    ds_read_b32 v42, v41
    s_waitcnt lgkmcnt(0)
    v_readfirstlane_b32 s55, v42
    s_cmp_eq_u32 s55, 0
    s_cbranch_scc1 L_spread
L_spread_back:
    s_cmp_eq_u32 s30, 5
    s_cbranch_scc0 L_skip_90
    s_cmp_eq_u32 s52, 31
    s_cbranch_scc0 L_skip_91
    s_lshl_b32 s57, s31, 5
    v_mov_b32 v16, s57
    s_add_u32 s57, s68, 1
    v_mov_b32 v12, s57
    s_mov_b64 exec, 0x1
    global_store_dword v16, v12, s[26:27] offset:4 sc1
    s_mov_b64 exec, -1
L_skip_91:
L_skip_90:
    s_sub_u32 s58, s30, 1
    s_cmp_lt_u32 s58, 4
    s_cbranch_scc0 L_skip_92
    s_mul_i32 s59, s53, 6400
    s_add_u32 s59, s59, s62
    s_add_u32 s59, s59, 57344
    s_add_u32 s60, s59, 6144
    s_lshl_b32 s57, s58, 10
    v_lshlrev_b32 v16, 4, v0
    v_add_u32 v16, s57, v16
    v_and_b32 v17, 7, v0
    v_lshlrev_b32 v17, 3, v17
    s_cmp_eq_u32 s30, 4
    s_cbranch_scc0 L_skip_93
    buffer_load_dwordx2 v[12:13], v17, s[40:43], s60 offen sc1 nt
    s_branch L_skip_92
L_skip_93:
    buffer_load_dwordx4 v[12:15], v16, s[40:43], s59 offen sc1 nt
    buffer_load_dwordx4 v[20:23], v16, s[40:43], s59 offen offset:3072 sc1 nt
L_skip_92:
    s_waitcnt vmcnt(36)
    s_barrier
    ds_read_b64_tr_b16 v[160:161], v8 offset:0
    ds_read_b64_tr_b16 v[168:169], v9 offset:0
    ds_read_b64_tr_b16 v[176:177], v10 offset:0
    ds_read_b64_tr_b16 v[184:185], v11 offset:0
    s_cmp_eq_u32 s30, 6
    s_cbranch_scc0 L_skip_94
    s_mul_i32 s57, s14, 11
    s_mov_b32 m0, 53248
    s_nop 0
    buffer_load_dwordx4 v3, s[48:51], s57 offen offset:0 nt lds
    s_mul_i32 s57, s14, 11
    s_add_u32 s57, s57, s15
    s_mov_b32 m0, 53248
    s_nop 0
    buffer_load_dwordx4 v3, s[48:51], s57 offen offset:1024 nt lds
    s_xor_b32 s57, s71, 1
    s_mul_i32 s57, s57, 196608
    s_add_u32 s57, s57, 1024
    s_xor_b32 s58, s71, 3
    s_mul_i32 s58, s58, 196608
    s_add_u32 s58, s58, 0
    s_mov_b32 m0, 141312
L_dma_95:
    s_waitcnt vmcnt(23)
    s_cmp_ge_u32 s70, 2
    s_cbranch_scc1 L_go_96
    s_waitcnt vmcnt(22)
    s_cmp_ge_u32 s70, 1
    s_cbranch_scc1 L_go_96
    s_waitcnt vmcnt(21)
L_go_96:
    buffer_load_dwordx4 v7, s[36:39], s57 offen offset:0 nt lds
    buffer_load_dwordx4 v7, s[36:39], s58 offen offset:1024 nt lds
    s_add_u32 s57, s57, 24576
    s_add_u32 s58, s58, 24576
    s_add_u32 m0, m0, 2048
    s_cmp_lg_u32 m0, 157696
    s_cbranch_scc1 L_dma_95
L_skip_94:
    s_waitcnt lgkmcnt(0)
    s_waitcnt vmcnt(36)
    s_barrier
    ds_read_b64_tr_b16 v[192:193], v8 offset:16384
    ds_read_b64_tr_b16 v[200:201], v9 offset:16384
    ds_read_b64_tr_b16 v[208:209], v10 offset:16384
    ds_read_b64_tr_b16 v[216:217], v11 offset:16384
    s_cmp_eq_u32 s30, 6
    s_cbranch_scc0 L_skip_97
    s_mul_i32 s57, s14, 12
    s_mov_b32 m0, 55296
    s_nop 0
    buffer_load_dwordx4 v3, s[48:51], s57 offen offset:0 nt lds
    s_mul_i32 s57, s14, 12
    s_add_u32 s57, s57, s15
    s_mov_b32 m0, 55296
    s_nop 0
    buffer_load_dwordx4 v3, s[48:51], s57 offen offset:1024 nt lds
    s_xor_b32 s57, s71, 1
    s_mul_i32 s57, s57, 196608
    s_add_u32 s57, s57, 1152
    s_xor_b32 s58, s71, 3
    s_mul_i32 s58, s58, 196608
    s_add_u32 s58, s58, 128
    s_mov_b32 m0, 92160
L_dma_98:
    s_waitcnt vmcnt(23)
    s_cmp_ge_u32 s70, 2
    s_cbranch_scc1 L_go_99
    s_waitcnt vmcnt(22)
    s_cmp_ge_u32 s70, 1
    s_cbranch_scc1 L_go_99
    s_waitcnt vmcnt(21)
L_go_99:
    buffer_load_dwordx4 v7, s[36:39], s57 offen offset:0 nt lds
    buffer_load_dwordx4 v7, s[36:39], s58 offen offset:1024 nt lds
    s_add_u32 s57, s57, 24576
    s_add_u32 s58, s58, 24576
    s_add_u32 m0, m0, 2048
    s_cmp_lg_u32 m0, 108544
    s_cbranch_scc1 L_dma_98
L_skip_97:
    s_waitcnt lgkmcnt(0)
    s_sub_u32 s58, s30, 1
    s_cmp_lt_u32 s58, 4
    s_cbranch_scc0 L_skip_100
    s_waitcnt vmcnt(0)
    s_cmp_eq_u32 s30, 4
    s_cbranch_scc0 L_skip_101
    v_add_f32_dpp v12, v12, v12 row_ror:4 row_mask:0xf bank_mask:0xf
    v_add_f32_dpp v13, v13, v13 row_ror:4 row_mask:0xf bank_mask:0xf
    s_nop 0
    v_add_f32_dpp v12, v12, v12 row_ror:2 row_mask:0xf bank_mask:0xf
    v_add_f32_dpp v13, v13, v13 row_ror:2 row_mask:0xf bank_mask:0xf
    s_nop 0
    v_add_f32_dpp v12, v12, v12 row_ror:1 row_mask:0xf bank_mask:0xf
    v_add_f32_dpp v13, v13, v13 row_ror:1 row_mask:0xf bank_mask:0xf
    v_mul_f32 v12, 0x3acccccd, v12
    v_mul_f32 v13, 0x3acccccd, v13
    v_fma_f32 v13, -v12, v12, v13
    v_max_f32 v13, 0, v13
    v_add_f32 v13, 0x3727c5ac, v13
    v_rsq_f32 v13, v13
    s_nop 0
    v_mul_f32 v13, 0x3dd53b95, v13
    v_mul_f32 v12, -v12, v13
    v_mov_b32 v16, 80640
    ds_write_b64 v16, v[12:13]
    s_waitcnt lgkmcnt(0)
    s_branch L_skip_100
L_skip_101:
    s_lshl_b32 s57, s58, 7
    v_lshrrev_b32 v16, 4, v0
    v_lshlrev_b32 v16, 5, v16
    v_bfe_u32 v60, v0, 1, 1
    v_lshl_add_u32 v16, v60, 4, v16
    v_bfe_u32 v60, v0, 2, 2
    v_lshl_add_u32 v16, v60, 2, v16
    v_and_b32 v60, 1, v0
    v_lshl_add_u32 v16, v60, 1, v16
    v_add_u32 v16, s57, v16
    v_add_u32 v16, 79872, v16
    v_mov_b32 v17, 0x3f803f80
    v_dot2_f32_bf16 v24, v12, v17, 0
    v_dot2_f32_bf16 v25, v13, v17, 0
    v_dot2_f32_bf16 v24, v14, v17, v24
    v_dot2_f32_bf16 v25, v15, v17, v25
    s_nop 2
    v_add_f32 v24, v24, v25
    v_cvt_pk_bf16_f32 v24, v24, v24
    ds_write_b16 v16, v24 offset:0
    v_dot2_f32_bf16 v24, v20, v17, 0
    v_dot2_f32_bf16 v25, v21, v17, 0
    v_dot2_f32_bf16 v24, v22, v17, v24
    v_dot2_f32_bf16 v25, v23, v17, v25
    s_nop 2
    v_add_f32 v24, v24, v25
    v_cvt_pk_bf16_f32 v24, v24, v24
    ds_write_b16 v16, v24 offset:384
    s_waitcnt lgkmcnt(0)
L_skip_100:
    s_waitcnt vmcnt(36)
    s_barrier
    ds_read_b64_tr_b16 v[224:225], v8 offset:32768
    ds_read_b64_tr_b16 v[232:233], v9 offset:32768
    ds_read_b64_tr_b16 v[240:241], v10 offset:32768
    ds_read_b64_tr_b16 v[248:249], v11 offset:32768
    s_cmp_eq_u32 s30, 6
    s_cbranch_scc0 L_skip_102
    s_mul_i32 s57, s14, 13
    s_mov_b32 m0, 57344
    s_nop 0
    buffer_load_dwordx4 v3, s[48:51], s57 offen offset:0 nt lds
    s_mul_i32 s57, s14, 13
    s_add_u32 s57, s57, s15
    s_mov_b32 m0, 57344
    s_nop 0
    buffer_load_dwordx4 v3, s[48:51], s57 offen offset:1024 nt lds
    s_xor_b32 s57, s71, 1
    s_mul_i32 s57, s57, 196608
    s_add_u32 s57, s57, 1280
    s_xor_b32 s58, s71, 3
    s_mul_i32 s58, s58, 196608
    s_add_u32 s58, s58, 256
    s_mov_b32 m0, 108544
L_dma_103:
    s_nop 0
    buffer_load_dwordx4 v7, s[36:39], s57 offen offset:0 nt lds
    buffer_load_dwordx4 v7, s[36:39], s58 offen offset:1024 nt lds
    s_add_u32 s57, s57, 24576
    s_add_u32 s58, s58, 24576
    s_add_u32 m0, m0, 2048
    s_cmp_lg_u32 m0, 124928
    s_cbranch_scc1 L_dma_103
L_skip_102:
    s_waitcnt lgkmcnt(0)
    v_lshrrev_b32 v5, 4, v0
    v_lshlrev_b32 v5, 5, v5
    v_bfe_u32 v60, v0, 1, 1
    v_lshl_add_u32 v5, v60, 4, v5
    v_add_u32 v5, 79872, v5
    ds_read_b128 v[12:15], v5 offset:384
    ds_read_b128 v[16:19], v5 offset:512
    ds_read_b128 v[20:23], v5 offset:640
    v_mov_b64 v[24:25], 0
    v_mov_b64 v[26:27], 0
    v_mov_b64 v[28:29], 0
    v_mov_b64 v[30:31], 0
    v_mov_b64 v[32:33], 0
    v_mov_b64 v[34:35], 0
    v_mov_b64 v[36:37], 0
    v_mov_b64 v[38:39], 0
    v_mov_b64 v[40:41], 0
    v_mov_b64 v[42:43], 0
    v_mov_b64 v[44:45], 0
    v_mov_b64 v[46:47], 0
    s_lshl_b32 s57, s30, 7
    s_add_u32 s57, s57, 158720
    v_lshrrev_b32 v54, 4, v0
    v_lshlrev_b32 v54, 5, v54
    v_bfe_u32 v60, v0, 1, 1
    v_lshl_add_u32 v54, v60, 4, v54
    v_bfe_u32 v60, v0, 2, 2
    v_lshl_add_u32 v54, v60, 2, v54
    v_and_b32 v60, 1, v0
    v_lshl_add_u32 v54, v60, 1, v54
    v_add_u32 v54, s57, v54
    v_lshrrev_b32 v61, 4, v0
    v_lshlrev_b32 v61, 5, v61
    v_bfe_u32 v60, v0, 1, 1
    v_lshl_add_u32 v61, v60, 4, v61
    v_add_u32 v61, s57, v61
    v_bfe_u32 v62, v0, 2, 2
    v_lshlrev_b32 v62, 1, v62
    v_and_b32 v60, 1, v0
    v_lshl_add_u32 v62, v60, 0, v62
    v_mov_b32 v60, 160992
    v_cmp_eq_u32 vcc, 0, v62
    s_nop 1
    v_cndmask_b32 v48, v60, v61, vcc
    v_cmp_eq_u32 vcc, 1, v62
    s_nop 1
    v_cndmask_b32 v49, v60, v61, vcc
    v_cmp_eq_u32 vcc, 2, v62
    s_nop 1
    v_cndmask_b32 v50, v60, v61, vcc
    v_cmp_eq_u32 vcc, 3, v62
    s_nop 1
    v_cndmask_b32 v51, v60, v61, vcc
    v_cmp_eq_u32 vcc, 4, v62
    s_nop 1
    v_cndmask_b32 v52, v60, v61, vcc
    v_cmp_eq_u32 vcc, 5, v62
    s_nop 1
    v_cndmask_b32 v53, v60, v61, vcc
    s_lshl_b32 s58, s30, 2
    s_add_u32 s58, s58, 159744
    v_mov_b32 v60, s58
    v_lshlrev_b32 v55, 2, v0
    v_add_u32 v55, 157696, v55
    v_cmp_eq_u32 vcc, 63, v0
    s_nop 1
    v_cndmask_b32 v55, v55, v60, vcc
    v_and_b32 v62, 7, v0
    v_lshlrev_b32 v62, 2, v62
    v_add_u32 v62, 159744, v62
    s_lshl_b32 s57, s30, 11
    v_lshlrev_b32 v63, 4, v0
    v_add_u32 v63, s57, v63
    v_add_u32 v63, 92160, v63
    s_waitcnt lgkmcnt(0)
    v_smfmac_f32_16x16x64_bf16 v[24:27], v[12:15], v[64:71], v1
    v_smfmac_f32_16x16x64_bf16 v[24:27], v[16:19], v[72:79], v1
    v_smfmac_f32_16x16x64_bf16 v[24:27], v[20:23], v[80:87], v1
    v_smfmac_f32_16x16x64_bf16 v[28:31], v[12:15], v[88:95], v1
    v_smfmac_f32_16x16x64_bf16 v[28:31], v[16:19], v[96:103], v1
    v_smfmac_f32_16x16x64_bf16 v[28:31], v[20:23], v[104:111], v1
    v_smfmac_f32_16x16x64_bf16 v[32:35], v[12:15], v[112:119], v1
    v_smfmac_f32_16x16x64_bf16 v[32:35], v[16:19], v[120:127], v1
    v_smfmac_f32_16x16x64_bf16 v[32:35], v[20:23], v[128:135], v1
    v_smfmac_f32_16x16x64_bf16 v[36:39], v[12:15], v[136:143], v1
    v_smfmac_f32_16x16x64_bf16 v[36:39], v[16:19], v[144:151], v1
    v_smfmac_f32_16x16x64_bf16 v[36:39], v[20:23], v[152:159], v1
    v_add_f32_dpp v6, v24, v26 quad_perm:[0,1,2,3] row_mask:0x1 bank_mask:0xf
    s_nop 1
    v_add_f32_dpp v6, v28, v30 quad_perm:[0,1,2,3] row_mask:0x2 bank_mask:0xf
    s_nop 1
    v_add_f32_dpp v6, v32, v34 quad_perm:[0,1,2,3] row_mask:0x4 bank_mask:0xf
    s_nop 1
    v_add_f32_dpp v6, v36, v38 quad_perm:[0,1,2,3] row_mask:0x8 bank_mask:0xf
    s_waitcnt vmcnt(36)
    s_barrier
    ds_read_b64_tr_b16 v[162:163], v8 offset:49152
    ds_read_b64_tr_b16 v[170:171], v9 offset:49152
    ds_read_b64_tr_b16 v[178:179], v10 offset:49152
    ds_read_b64_tr_b16 v[186:187], v11 offset:49152
    s_cmp_eq_u32 s30, 6
    s_cbranch_scc0 L_skip_104
    s_mul_i32 s57, s14, 14
    s_mov_b32 m0, 59392
    s_nop 0
    buffer_load_dwordx4 v3, s[48:51], s57 offen offset:0 nt lds
    s_mul_i32 s57, s14, 14
    s_add_u32 s57, s57, s15
    s_mov_b32 m0, 59392
    s_nop 0
    buffer_load_dwordx4 v3, s[48:51], s57 offen offset:1024 nt lds
    s_xor_b32 s57, s71, 4
    s_mul_i32 s57, s57, 196608
    s_add_u32 s57, s57, 1024
    s_xor_b32 s58, s71, 6
    s_mul_i32 s58, s58, 196608
    s_add_u32 s58, s58, 0
    s_mov_b32 m0, 124928
L_dma_105:
    s_nop 0
    buffer_load_dwordx4 v7, s[36:39], s57 offen offset:0 nt lds
    buffer_load_dwordx4 v7, s[36:39], s58 offen offset:1024 nt lds
    s_add_u32 s57, s57, 24576
    s_add_u32 s58, s58, 24576
    s_add_u32 m0, m0, 2048
    s_cmp_lg_u32 m0, 141312
    s_cbranch_scc1 L_dma_105
L_skip_104:
    s_waitcnt lgkmcnt(0)
    v_mov_b32 v56, 80640
    ds_read_b128 v[12:15], v5 offset:0
    ds_read_b128 v[16:19], v5 offset:128
    ds_read_b128 v[20:23], v5 offset:256
    ds_read_b64 v[56:57], v56
    v_mov_b64 v[24:25], 0
    v_mov_b64 v[26:27], 0
    v_mov_b64 v[28:29], 0
    v_mov_b64 v[30:31], 0
    v_mov_b64 v[32:33], 0
    v_mov_b64 v[34:35], 0
    v_mov_b64 v[36:37], 0
    v_mov_b64 v[38:39], 0
    s_waitcnt lgkmcnt(0)
    v_smfmac_f32_16x16x64_bf16 v[24:27], v[12:15], v[64:71], v1
    v_smfmac_f32_16x16x64_bf16 v[24:27], v[16:19], v[72:79], v1
    v_smfmac_f32_16x16x64_bf16 v[24:27], v[20:23], v[80:87], v1
    v_smfmac_f32_16x16x64_bf16 v[28:31], v[12:15], v[88:95], v1
    v_smfmac_f32_16x16x64_bf16 v[28:31], v[16:19], v[96:103], v1
    v_smfmac_f32_16x16x64_bf16 v[28:31], v[20:23], v[104:111], v1
    v_smfmac_f32_16x16x64_bf16 v[32:35], v[12:15], v[112:119], v1
    v_smfmac_f32_16x16x64_bf16 v[32:35], v[16:19], v[120:127], v1
    v_smfmac_f32_16x16x64_bf16 v[32:35], v[20:23], v[128:135], v1
    v_smfmac_f32_16x16x64_bf16 v[36:39], v[12:15], v[136:143], v1
    v_smfmac_f32_16x16x64_bf16 v[36:39], v[16:19], v[144:151], v1
    v_smfmac_f32_16x16x64_bf16 v[36:39], v[20:23], v[152:159], v1
    v_add_f32_dpp v61, v24, v26 quad_perm:[0,1,2,3] row_mask:0x1 bank_mask:0xf
    v_mul_f32 v56, v56, v6
    s_nop 0
    v_add_f32_dpp v61, v28, v30 quad_perm:[0,1,2,3] row_mask:0x2 bank_mask:0xf
    s_nop 1
    v_add_f32_dpp v61, v32, v34 quad_perm:[0,1,2,3] row_mask:0x4 bank_mask:0xf
    s_nop 1
    v_add_f32_dpp v61, v36, v38 quad_perm:[0,1,2,3] row_mask:0x8 bank_mask:0xf
    v_fma_f32 v36, v61, v57, v56
    s_nop 1
    v_max_f32_dpp v37, v36, v36 row_ror:8 row_mask:0xf bank_mask:0xf
    s_nop 1
    v_max_f32_dpp v37, v37, v37 row_ror:4 row_mask:0xf bank_mask:0xf
    s_nop 1
    v_max_f32_dpp v37, v37, v37 row_ror:2 row_mask:0xf bank_mask:0xf
    s_nop 1
    v_max_f32_dpp v37, v37, v37 row_ror:1 row_mask:0xf bank_mask:0xf
    s_nop 1
    v_max_f32_dpp v37, v37, v37 row_bcast:15 row_mask:0xa bank_mask:0xf
    s_nop 1
    v_max_f32_dpp v37, v37, v37 row_bcast:31 row_mask:0xc bank_mask:0xf
    s_nop 0
    v_readlane_b32 s64, v37, 63
    ds_write_b32 v55, v37
    s_nop 0
    v_subrev_f32 v36, s64, v36
    v_exp_f32 v36, v36
    s_nop 0
    v_cvt_pk_bf16_f32 v39, v36, v36
    ds_write_b16 v54, v39
    ds_read_b128 v[12:15], v48
    ds_read_b128 v[16:19], v49
    ds_read_b128 v[20:23], v50
    ds_read_b128 v[24:27], v51
    ds_read_b128 v[28:31], v52
    ds_read_b128 v[32:35], v53
    v_add_f32_dpp v38, v36, v36 row_ror:8 row_mask:0xf bank_mask:0xf
    s_nop 1
    v_add_f32_dpp v38, v38, v38 row_ror:4 row_mask:0xf bank_mask:0xf
    s_nop 1
    v_add_f32_dpp v38, v38, v38 row_ror:2 row_mask:0xf bank_mask:0xf
    s_nop 1
    v_add_f32_dpp v38, v38, v38 row_ror:1 row_mask:0xf bank_mask:0xf
    s_nop 1
    v_add_f32_dpp v38, v38, v38 row_bcast:15 row_mask:0xa bank_mask:0xf
    s_nop 1
    v_add_f32_dpp v38, v38, v38 row_bcast:31 row_mask:0xc bank_mask:0xf
    s_waitcnt lgkmcnt(0)
    s_waitcnt vmcnt(36)
    s_barrier
    ds_read_b64_tr_b16 v[194:195], v8 offset:0
    ds_read_b64_tr_b16 v[202:203], v9 offset:0
    ds_read_b64_tr_b16 v[210:211], v10 offset:0
    ds_read_b64_tr_b16 v[218:219], v11 offset:0
    s_cmp_eq_u32 s30, 6
    s_cbranch_scc0 L_skip_106
    s_mul_i32 s57, s14, 15
    s_mov_b32 m0, 61440
    s_nop 0
    buffer_load_dwordx4 v3, s[48:51], s57 offen offset:0 nt lds
    s_mul_i32 s57, s14, 15
    s_add_u32 s57, s57, s15
    s_mov_b32 m0, 61440
    s_nop 0
    buffer_load_dwordx4 v3, s[48:51], s57 offen offset:1024 nt lds
    s_xor_b32 s57, s71, 4
    s_mul_i32 s57, s57, 196608
    s_add_u32 s57, s57, 1152
    s_xor_b32 s58, s71, 6
    s_mul_i32 s58, s58, 196608
    s_add_u32 s58, s58, 128
    s_mov_b32 m0, 141312
L_dma_107:
    s_waitcnt vmcnt(23)
    s_cmp_ge_u32 s70, 2
    s_cbranch_scc1 L_go_108
    s_waitcnt vmcnt(22)
    s_cmp_ge_u32 s70, 1
    s_cbranch_scc1 L_go_108
    s_waitcnt vmcnt(21)
L_go_108:
    buffer_load_dwordx4 v7, s[36:39], s57 offen offset:0 nt lds
    buffer_load_dwordx4 v7, s[36:39], s58 offen offset:1024 nt lds
    s_add_u32 s57, s57, 24576
    s_add_u32 s58, s58, 24576
    s_add_u32 m0, m0, 2048
    s_cmp_lg_u32 m0, 157696
    s_cbranch_scc1 L_dma_107
L_skip_106:
    s_waitcnt lgkmcnt(0)
    ds_read_b32 v36, v62
    s_waitcnt lgkmcnt(0)
    v_max_f32_dpp v37, v36, v36 row_ror:4 row_mask:0xf bank_mask:0xf
    s_nop 1
    v_max_f32_dpp v37, v37, v37 row_ror:2 row_mask:0xf bank_mask:0xf
    s_nop 1
    v_max_f32_dpp v37, v37, v37 row_ror:1 row_mask:0xf bank_mask:0xf
    v_sub_f32 v39, s64, v37
    v_exp_f32 v39, v39
    s_cmp_lt_u32 s30, 2
    s_cbranch_scc0 L_skip_109
    s_lshl_b32 s57, s30, 3
    v_lshlrev_b32 v2, 4, v0
    v_add_u32 v2, s57, v2
    v_add_u32 v2, 92160, v2
    v_mov_b32 v60, 94192
    v_cmp_le_u32 vcc, 48, v0
    s_nop 1
    v_cndmask_b32 v2, v2, v60, vcc
    s_lshr_b32 s57, s54, 1
    s_lshl_b32 s57, s57, 2
    s_and_b32 s58, s54, 1
    s_add_u32 s57, s57, s58
    s_lshl_b32 s58, s57, 4
    s_lshl_b32 s57, s57, 3
    v_bfe_u32 v3, v0, 3, 2
    v_lshlrev_b32 v3, 8, v3
    v_bfe_u32 v61, v0, 2, 1
    v_lshl_add_u32 v3, v61, 5, v3
    v_and_b32 v61, 3, v0
    v_lshl_add_u32 v3, v61, 2, v3
    v_add_u32 v3, s58, v3
    v_bfe_u32 v60, v0, 3, 1
    v_lshlrev_b32 v60, 8, v60
    v_bfe_u32 v61, v0, 1, 1
    v_lshl_add_u32 v60, v61, 7, v60
    v_bfe_u32 v61, v0, 2, 1
    v_lshl_add_u32 v60, v61, 4, v60
    v_and_b32 v61, 1, v0
    v_lshl_add_u32 v60, v61, 2, v60
    v_add_u32 v60, s57, v60
    v_add_u32 v60, 1024, v60
    v_cmp_gt_u32 vcc, 32, v0
    s_nop 1
    v_cndmask_b32 v3, v60, v3, vcc
    s_lshl_b32 s57, s53, 1
    s_add_u32 s57, s57, s30
    s_mul_i32 s57, s57, 1536
    s_add_u32 s57, s57, s62
    v_add_u32 v3, s57, v3
    v_mov_b32 v60, 0x7f000000
    v_cmp_le_u32 vcc, 48, v0
    s_nop 1
    v_cndmask_b32 v3, v3, v60, vcc
    s_lshl_b32 s57, s53, 3
    s_add_u32 s57, s57, s54
    s_lshl_b32 s57, s57, 2
    s_lshl_b32 s58, s30, 24
    s_add_u32 s57, s57, s58
    v_mov_b32 v4, s57
    v_mov_b32 v60, 0x7f000000
    v_cmp_ne_u32 vcc, 48, v0
    s_nop 1
    v_cndmask_b32 v4, v4, v60, vcc
    s_add_u32 s58, s62, 25088
    v_min_u32 v37, -2, v37
    s_cmp_eq_u32 s55, 0
    s_cbranch_scc1 L_gs_110
    buffer_store_dword v37, v4, s[40:43], s58 offen
L_gb_111:
L_skip_109:
    s_waitcnt vmcnt(36)
    s_barrier
    ds_read_b64_tr_b16 v[226:227], v8 offset:16384
    ds_read_b64_tr_b16 v[234:235], v9 offset:16384
    ds_read_b64_tr_b16 v[242:243], v10 offset:16384
    ds_read_b64_tr_b16 v[250:251], v11 offset:16384
    s_cmp_eq_u32 s30, 6
    s_cbranch_scc0 L_skip_112
    s_xor_b32 s57, s71, 4
    s_mul_i32 s57, s57, 196608
    s_add_u32 s57, s57, 1280
    s_xor_b32 s58, s71, 6
    s_mul_i32 s58, s58, 196608
    s_add_u32 s58, s58, 256
    s_mov_b32 m0, 92160
L_dma_113:
    s_nop 0
    buffer_load_dwordx4 v7, s[36:39], s57 offen offset:0 nt lds
    buffer_load_dwordx4 v7, s[36:39], s58 offen offset:1024 nt lds
    s_add_u32 s57, s57, 24576
    s_add_u32 s58, s58, 24576
    s_add_u32 m0, m0, 2048
    s_cmp_lg_u32 m0, 108544
    s_cbranch_scc1 L_dma_113
L_skip_112:
    s_waitcnt lgkmcnt(0)
    s_cmp_eq_u32 s30, 5
    s_cbranch_scc0 L_skip_114
    global_load_dword v2, v3, s[26:27] offset:4 sc1
L_skip_114:
    s_waitcnt vmcnt(34)
    s_barrier
    ds_read_b64_tr_b16 v[164:165], v8 offset:32768
    ds_read_b64_tr_b16 v[172:173], v9 offset:32768
    ds_read_b64_tr_b16 v[180:181], v10 offset:32768
    ds_read_b64_tr_b16 v[188:189], v11 offset:32768
    s_cmp_eq_u32 s30, 6
    s_cbranch_scc0 L_skip_115
    s_xor_b32 s57, s71, 5
    s_mul_i32 s57, s57, 196608
    s_add_u32 s57, s57, 1024
    s_xor_b32 s58, s71, 7
    s_mul_i32 s58, s58, 196608
    s_add_u32 s58, s58, 0
    s_mov_b32 m0, 108544
L_dma_116:
    s_nop 0
    buffer_load_dwordx4 v7, s[36:39], s57 offen offset:0 nt lds
    buffer_load_dwordx4 v7, s[36:39], s58 offen offset:1024 nt lds
    s_add_u32 s57, s57, 24576
    s_add_u32 s58, s58, 24576
    s_add_u32 m0, m0, 2048
    s_cmp_lg_u32 m0, 124928
    s_cbranch_scc1 L_dma_116
L_skip_115:
    s_waitcnt lgkmcnt(0)
    s_waitcnt vmcnt(32)
    s_barrier
    ds_read_b64_tr_b16 v[196:197], v8 offset:49152
    ds_read_b64_tr_b16 v[204:205], v9 offset:49152
    ds_read_b64_tr_b16 v[212:213], v10 offset:49152
    ds_read_b64_tr_b16 v[220:221], v11 offset:49152
    s_cmp_eq_u32 s30, 6
    s_cbranch_scc0 L_skip_117
    s_xor_b32 s57, s71, 5
    s_mul_i32 s57, s57, 196608
    s_add_u32 s57, s57, 1152
    s_xor_b32 s58, s71, 7
    s_mul_i32 s58, s58, 196608
    s_add_u32 s58, s58, 128
    s_mov_b32 m0, 124928
L_dma_118:
    s_nop 0
    buffer_load_dwordx4 v7, s[36:39], s57 offen offset:0 nt lds
    buffer_load_dwordx4 v7, s[36:39], s58 offen offset:1024 nt lds
    s_add_u32 s57, s57, 24576
    s_add_u32 s58, s58, 24576
    s_add_u32 m0, m0, 2048
    s_cmp_lg_u32 m0, 141312
    s_cbranch_scc1 L_dma_118
L_skip_117:
    s_waitcnt lgkmcnt(0)
    s_cmp_eq_u32 s30, 5
    s_cbranch_scc0 L_skip_119
L_cw_120:
    s_waitcnt vmcnt(0)
    v_cmp_eq_u32 vcc, 0, v2
    s_cbranch_vccnz L_cr_121
    v_add_u32_dpp v2, v2, v2 row_ror:4 row_mask:0xf bank_mask:0xf
    s_nop 1
    v_add_u32_dpp v2, v2, v2 row_ror:2 row_mask:0xf bank_mask:0xf
    s_nop 1
    v_add_u32_dpp v2, v2, v2 row_ror:1 row_mask:0xf bank_mask:0xf
    v_mov_b32 v60, 160772
    ds_write_b32 v60, v2
    s_waitcnt lgkmcnt(0)
L_skip_119:
    s_cmp_eq_u32 s30, 2
    s_cbranch_scc0 L_skip_122
    s_sub_u32 s57, s3, 20
    s_cmp_lt_u32 s57, 4
    s_cbranch_scc0 L_skip_123
    s_sub_u32 s57, s3, 20
    s_lshl_b32 s57, s57, 6
    v_add_u32 v58, s57, v0
    v_min_u32 v58, 206, v58
    v_lshlrev_b32 v58, 7, v58
    s_add_u32 s57, s62, 0
    buffer_load_dword v58, v58, s[40:43], s57 offen sc1 nt
    s_sub_u32 s57, s3, 20
    s_lshl_b32 s57, s57, 6
    v_add_u32 v59, s57, v0
    v_min_u32 v59, 239, v59
    v_lshlrev_b32 v59, 7, v59
    s_add_u32 s57, s62, 26496
    buffer_load_dword v59, v59, s[40:43], s57 offen sc1 nt
L_skip_123:
L_skip_122:
    s_waitcnt vmcnt(32)
    s_barrier
    ds_read_b64_tr_b16 v[228:229], v8 offset:0
    ds_read_b64_tr_b16 v[236:237], v9 offset:0
    ds_read_b64_tr_b16 v[244:245], v10 offset:0
    ds_read_b64_tr_b16 v[252:253], v11 offset:0
    s_cmp_eq_u32 s30, 6
    s_cbranch_scc0 L_skip_124
    s_xor_b32 s57, s71, 5
    s_mul_i32 s57, s57, 196608
    s_add_u32 s57, s57, 1280
    s_xor_b32 s58, s71, 7
    s_mul_i32 s58, s58, 196608
    s_add_u32 s58, s58, 256
    s_mov_b32 m0, 141312
L_dma_125:
    s_nop 0
    buffer_load_dwordx4 v7, s[36:39], s57 offen offset:0 nt lds
    buffer_load_dwordx4 v7, s[36:39], s58 offen offset:1024 nt lds
    s_add_u32 s57, s57, 24576
    s_add_u32 s58, s58, 24576
    s_add_u32 m0, m0, 2048
    s_cmp_lg_u32 m0, 157696
    s_cbranch_scc1 L_dma_125
L_skip_124:
    s_waitcnt lgkmcnt(0)
    s_cmp_eq_u32 s30, 7
    s_cbranch_scc0 L_skip_126
    v_mov_b32 v60, 160772
    ds_read_b32 v60, v60
    s_lshr_b32 s58, s63, 2
    s_waitcnt lgkmcnt(0)
    v_readfirstlane_b32 s57, v60
    s_cmp_gt_u32 s57, 24
    s_cselect_b32 s57, 1, 0
    s_xor_b32 s57, s57, s58
    s_lshl_b32 s57, s57, 13
    s_add_u32 s7, s8, s57
L_skip_126:
    s_branch L_tail
.p2align 10
L_tail:
L_pad0:
    s_cbranch_execz L_pad4
    s_waitcnt vmcnt(32)
    s_barrier
    ds_read_b64_tr_b16 v[166:167], v8 offset:16384
    ds_read_b64_tr_b16 v[174:175], v9 offset:16384
    ds_read_b64_tr_b16 v[182:183], v10 offset:16384
    ds_read_b64_tr_b16 v[190:191], v11 offset:16384
    s_waitcnt lgkmcnt(0)
    s_cmp_lt_u32 s30, 5
    s_cbranch_scc0 L_skip_127
    s_waitcnt vmcnt(0)
L_skip_127:
    v_smfmac_f32_16x16x64_bf16 v[40:43], v[12:15], v[160:167], v1
    v_smfmac_f32_16x16x64_bf16 v[40:43], v[16:19], v[168:175], v1
    v_smfmac_f32_16x16x64_bf16 v[40:43], v[20:23], v[176:183], v1
    v_smfmac_f32_16x16x64_bf16 v[40:43], v[24:27], v[184:191], v1
    s_cmp_eq_u32 s30, 6
    s_cbranch_scc0 L_skip_128
    s_mul_i32 s57, s14, 16
    s_add_u32 s58, s57, s15
    s_mov_b32 m0, 63488
L_dma_129:
    s_nop 0
    buffer_load_dwordx4 v3, s[48:51], s57 offen offset:0 nt lds
    buffer_load_dwordx4 v3, s[48:51], s58 offen offset:1024 nt lds
    s_add_u32 s57, s57, s14
    s_add_u32 s58, s58, s14
    s_add_u32 m0, m0, 2048
    s_cmp_lg_u32 m0, 71680
    s_cbranch_scc1 L_dma_129
    s_mul_i32 s57, s14, 20
    s_add_u32 s58, s57, s15
    s_mov_b32 m0, 71680
L_dma_130:
    s_nop 0
    buffer_load_dwordx4 v3, s[48:51], s57 offen offset:0 nt lds
    buffer_load_dwordx4 v3, s[48:51], s58 offen offset:1024 nt lds
    s_add_u32 s57, s57, s14
    s_add_u32 s58, s58, s14
    s_add_u32 m0, m0, 2048
    s_cmp_lg_u32 m0, 79872
    s_cbranch_scc1 L_dma_130
L_skip_128:
    s_waitcnt vmcnt(32)
    s_barrier
    ds_read_b64_tr_b16 v[198:199], v8 offset:32768
    ds_read_b64_tr_b16 v[206:207], v9 offset:32768
    ds_read_b64_tr_b16 v[214:215], v10 offset:32768
    ds_read_b64_tr_b16 v[222:223], v11 offset:32768
    s_waitcnt lgkmcnt(0)
    v_smfmac_f32_16x16x64_bf16 v[40:43], v[28:31], v[192:199], v1
    v_smfmac_f32_16x16x64_bf16 v[40:43], v[32:35], v[200:207], v1
    v_smfmac_f32_16x16x64_bf16 v[44:47], v[12:15], v[208:215], v1
    v_smfmac_f32_16x16x64_bf16 v[44:47], v[16:19], v[216:223], v1
    v_mul_f32 v38, v38, v39
    ds_write_b32 v63, v38 offset:1024
    s_waitcnt vmcnt(16)
    s_barrier
    ds_read_b64_tr_b16 v[230:231], v8 offset:49152
    ds_read_b64_tr_b16 v[238:239], v9 offset:49152
    ds_read_b64_tr_b16 v[246:247], v10 offset:49152
    ds_read_b64_tr_b16 v[254:255], v11 offset:49152
    s_waitcnt lgkmcnt(0)
    v_smfmac_f32_16x16x64_bf16 v[44:47], v[20:23], v[224:231], v1
    v_smfmac_f32_16x16x64_bf16 v[44:47], v[24:27], v[232:239], v1
    v_smfmac_f32_16x16x64_bf16 v[44:47], v[28:31], v[240:247], v1
    v_smfmac_f32_16x16x64_bf16 v[44:47], v[32:35], v[248:255], v1
    s_setprio 0
    s_cmp_lt_u32 s30, 2
    v_pk_add_f32 v[40:41], v[40:41], v[42:43]
    s_nop 4
    v_pk_add_f32 v[42:43], v[44:45], v[46:47]
    v_pk_mul_f32 v[40:41], v[40:41], v[38:39] op_sel:[0,1] op_sel_hi:[1,1]
    v_pk_mul_f32 v[42:43], v[42:43], v[38:39] op_sel:[0,1] op_sel_hi:[1,1]
    ds_write_b128 v63, v[40:43]
    s_cbranch_scc1 L_comb_0
    s_waitcnt lgkmcnt(0)
    s_barrier
L_comb_0b:
    s_cmp_eq_u32 s30, 6
    s_cbranch_scc0 L_skip_135
    s_waitcnt vmcnt(0)
L_skip_135:
    s_barrier
    s_cmp_lt_u32 s3, 20
    s_cbranch_scc0 L_typeB_0
    s_lshr_b32 s57, s30, 1
    s_lshl_b32 s57, s57, 5
    s_add_u32 s57, s57, s62
    s_add_u32 s59, s57, 25088
    v_and_b32 v5, 7, v0
    v_lshlrev_b32 v5, 2, v5
    v_lshrrev_b32 v22, 4, v0
L_pad1:
    s_cbranch_execz L_pad5
    v_lshlrev_b32 v22, 3, v22
    buffer_load_dword v18, v5, s[40:43], s59 offen sc1
    buffer_load_dwordx2 v[20:21], v22, s[40:43], s59 offen sc1
    s_mul_i32 s60, s30, 1536
    s_add_u32 s60, s60, s62
    s_add_u32 s60, s60, 0
    v_lshlrev_b32 v9, 4, v0
    v_lshlrev_b32 v10, 3, v0
    s_mul_i32 s57, s30, 6144
    v_lshrrev_b32 v7, 2, v0
    v_lshlrev_b32 v7, 6, v7
    v_bfe_u32 v60, v0, 4, 1
    v_lshl_add_u32 v7, v60, 5, v7
    v_and_b32 v60, 3, v0
    v_lshl_add_u32 v7, v60, 3, v7
    v_add_u32 v7, s57, v7
    v_add_u32 v7, 30720, v7
    v_xor_b32 v8, 32, v7
    ds_read_b64_tr_b16 v[36:37], v7 offset:0
    ds_read_b64_tr_b16 v[38:39], v7 offset:1024
    ds_read_b64_tr_b16 v[40:41], v7 offset:2048
    ds_read_b64_tr_b16 v[42:43], v7 offset:3072
    ds_read_b64_tr_b16 v[44:45], v7 offset:4096
    ds_read_b64_tr_b16 v[46:47], v7 offset:5120
    ds_read_b64_tr_b16 v[48:49], v8 offset:0
    ds_read_b64_tr_b16 v[50:51], v8 offset:1024
    ds_read_b64_tr_b16 v[52:53], v8 offset:2048
    ds_read_b64_tr_b16 v[54:55], v8 offset:3072
    ds_read_b64_tr_b16 v[56:57], v8 offset:4096
    ds_read_b64_tr_b16 v[58:59], v8 offset:5120
    v_mov_b64 v[24:25], 0
    v_mov_b64 v[26:27], 0
    v_mov_b64 v[28:29], 0
    v_mov_b64 v[30:31], 0
    s_lshl_b32 s57, s30, 8
    v_lshlrev_b32 v11, 2, v0
    v_add_u32 v11, s57, v11
    v_add_u32 v11, 157696, v11
    v_lshlrev_b32 v32, 2, v0
    v_add_u32 v32, 157696, v32
    s_add_u32 s58, s6, 0
    s_add_u32 s57, s58, 16384
    v_and_b32 v33, 15, v0
    v_lshlrev_b32 v33, 2, v33
    v_lshrrev_b32 v60, 5, v0
    v_lshl_add_u32 v33, v60, 6, v33
    v_bfe_u32 v60, v0, 4, 1
    v_lshl_add_u32 v33, v60, 13, v33
    s_lshl_b32 s74, s3, 2
    s_add_u32 s74, s74, s62
    s_add_u32 s74, s74, 25600
    s_xor_b32 s75, s30, 3
    v_add_u32 v34, s75, v0
    v_lshlrev_b32 v34, 24, v34
    s_branch L_pw_136
L_pr_137:
    buffer_load_dword v18, v5, s[40:43], s59 offen sc1
    buffer_load_dwordx2 v[20:21], v22, s[40:43], s59 offen sc1
    s_sub_u32 s56, s56, 1
    s_cbranch_scc1 L_done
L_pw_136:
    s_waitcnt vmcnt(0)
    v_max3_u32 v19, v18, v20, v21
    v_cmp_eq_u32 vcc, -1, v19
    s_cbranch_vccnz L_pr_137
    buffer_load_dwordx4 v[12:15], v9, s[40:43], s60 offen sc1
    buffer_load_dwordx2 v[16:17], v10, s[40:43], s60 offen offset:1024 sc1
    buffer_load_dword v23, v5, s[40:43], s59 offen offset:128 sc1
    v_max_f32_dpp v19, v18, v18 row_ror:4 row_mask:0xf bank_mask:0xf
    s_nop 1
    v_max_f32_dpp v19, v19, v19 row_ror:2 row_mask:0xf bank_mask:0xf
    s_nop 1
    v_max_f32_dpp v19, v19, v19 row_ror:1 row_mask:0xf bank_mask:0xf
    v_sub_f32 v18, v18, v19
    v_sub_f32 v20, v20, v19
    v_sub_f32 v21, v21, v19
    v_exp_f32 v18, v18
    v_exp_f32 v20, v20
    v_exp_f32 v21, v21
    s_waitcnt lgkmcnt(0)
    s_branch L_pw_138
L_pr_139:
    buffer_load_dwordx4 v[12:15], v9, s[40:43], s60 offen sc1
    buffer_load_dwordx2 v[16:17], v10, s[40:43], s60 offen offset:1024 sc1
    buffer_load_dword v23, v5, s[40:43], s59 offen offset:128 sc1
    s_sub_u32 s56, s56, 1
    s_cbranch_scc1 L_done
L_pw_138:
    s_waitcnt vmcnt(0)
    v_max3_u32 v19, v12, v13, v14
    v_max3_u32 v19, v19, v15, v16
L_pad2:
    s_cbranch_execz L_pad6
    v_max3_u32 v19, v19, v17, v23
    v_cmp_eq_u32 vcc, -1, v19
    s_cbranch_vccnz L_pr_139
    v_smfmac_f32_16x16x64_bf16 v[24:27], v[12:15], v[36:43], v1
    v_mul_f32 v18, v18, v23
    v_smfmac_f32_16x16x64_bf16 v[28:31], v[12:15], v[48:55], v1
    v_smfmac_f32_16x16x32_bf16 v[24:27], v[16:17], v[44:47], v1
    v_add_f32_dpp v18, v18, v18 row_ror:4 row_mask:0xf bank_mask:0xf
    v_smfmac_f32_16x16x32_bf16 v[28:31], v[16:17], v[56:59], v1
    s_nop 0
    v_add_f32_dpp v18, v18, v18 row_ror:2 row_mask:0xf bank_mask:0xf
    s_nop 1
    v_add_f32_dpp v18, v18, v18 row_ror:1 row_mask:0xf bank_mask:0xf
    v_rcp_f32 v18, v18
    v_pk_add_f32 v[24:25], v[24:25], v[26:27]
    s_nop 0
    v_pk_add_f32 v[28:29], v[28:29], v[30:31]
    v_pk_mul_f32 v[20:21], v[20:21], v[18:19] op_sel:[0,0] op_sel_hi:[1,0]
    v_mul_f32 v24, v24, v20
    v_mul_f32 v28, v28, v20
    v_fmac_f32 v24, v25, v21
    v_fmac_f32 v28, v29, v21
    s_nop 1
    v_permlane32_swap_b32 v24, v28
    v_add_f32 v24, v24, v28
    ds_write_b32 v11, v24
    s_cmp_eq_u32 s30, 2
    s_cbranch_scc1 L_fin_140
    s_cmp_eq_u32 s55, 0
    s_waitcnt lgkmcnt(0)
    s_barrier
    s_cbranch_scc1 L_gs_142
    buffer_store_dword v0, v34, s[40:43], s74 offen
L_gb_143:
L_finb_141:
    s_sub_u32 s57, s30, 4
    s_cmp_lt_u32 s57, 3
    s_cbranch_scc0 L_skip_144
    s_sub_u32 s60, s30, 4
    s_lshl_b32 s59, s60, 12
    s_add_u32 s59, s59, 79872
    s_lshl_b32 s57, s60, 11
    v_lshlrev_b32 v11, 4, v0
    v_add_u32 v11, s57, v11
    s_add_u32 s58, s62, 18432
    buffer_load_dwordx4 v[12:15], v11, s[40:43], s58 offen offset:0 sc1
    buffer_load_dwordx4 v[16:19], v11, s[40:43], s58 offen offset:1024 sc1
    s_mov_b32 s44, s20
    s_mov_b32 s45, s21
    s_mov_b32 s46, 1966080
    s_mov_b32 s47, 0x20000
    s_mul_i32 s57, s31, 3
    s_add_u32 s57, s57, s60
    s_mul_i32 s57, s57, 81920
    s_lshl_b32 s64, s3, 6
    s_add_u32 s57, s57, s64
    v_lshrrev_b32 v5, 2, v0
    v_mul_u32_u24 v5, 1280, v5
    v_and_b32 v60, 3, v0
    v_lshl_add_u32 v5, v60, 4, v5
    v_add_u32 v5, s57, v5
    s_add_u32 m0, s59, 0
    s_mov_b32 s57, 0
    buffer_load_dwordx4 v5, s[44:47], s57 offen nt lds
    s_add_u32 m0, s59, 1024
    s_mov_b32 s57, 20480
    buffer_load_dwordx4 v5, s[44:47], s57 offen nt lds
    s_add_u32 m0, s59, 2048
    s_mov_b32 s57, 40960
    buffer_load_dwordx4 v5, s[44:47], s57 offen nt lds
    s_add_u32 m0, s59, 3072
    s_mov_b32 s57, 61440
    buffer_load_dwordx4 v5, s[44:47], s57 offen nt lds
    v_lshrrev_b32 v35, 4, v0
    v_lshlrev_b32 v35, 9, v35
    v_bfe_u32 v60, v0, 2, 2
    v_lshl_add_u32 v35, v60, 6, v35
    v_and_b32 v60, 3, v0
    v_lshl_add_u32 v35, v60, 3, v35
    v_add_u32 v35, s59, v35
    s_waitcnt vmcnt(4)
L_sw_145:
    v_max3_u32 v60, v12, v13, v14
    v_max3_u32 v60, v60, v15, v16
    v_max3_u32 v60, v60, v17, v18
    v_max_u32 v60, v60, v19
    v_cmp_eq_u32 vcc, -1, v60
    s_cbranch_vccnz L_sr_146
    v_pk_add_f32 v[20:21], v[12:13], v[14:15]
    v_pk_add_f32 v[22:23], v[16:17], v[18:19]
L_pad3:
    s_cbranch_execz L_pad7
    v_pk_add_f32 v[20:21], v[20:21], v[22:23]
    v_add_f32 v8, v20, v21
    v_mov_b64 v[52:53], 0
    v_mov_b64 v[54:55], 0
    v_mov_b64 v[56:57], 0
    v_mov_b64 v[58:59], 0
    v_mov_b32 v9, 0xbdd2d3e8
    v_mov_b32 v10, 0xc0135761
    s_lshl_b32 s57, s60, 7
    s_add_u32 s57, s57, 159872
    v_lshlrev_b32 v32, 3, v0
    v_add_u32 v32, s57, v32
    v_lshlrev_b32 v33, 3, v0
    v_add_u32 v33, 129024, v33
    v_cmp_gt_u32 vcc, 16, v0
    s_nop 1
    v_cndmask_b32 v32, v33, v32, vcc
    v_and_b32 v33, 15, v0
    v_lshlrev_b32 v33, 3, v33
    v_lshrrev_b32 v60, 5, v0
    v_lshl_add_u32 v33, v60, 2, v33
    v_add_u32 v33, 159872, v33
    v_and_b32 v34, 15, v0
    v_lshlrev_b32 v34, 2, v34
    v_lshrrev_b32 v60, 5, v0
    v_lshl_add_u32 v34, v60, 6, v34
    v_bfe_u32 v60, v0, 4, 1
    v_lshl_add_u32 v34, v60, 13, v34
    s_add_u32 s60, s6, 131072
    s_add_u32 s59, s60, 16384
    s_lshl_b32 s74, s3, 2
    s_add_u32 s74, s74, s62
    s_add_u32 s74, s74, 25984
    s_xor_b32 s75, s30, 4
    s_lshl_b32 s75, s75, 24
    v_and_b32 v5, 3, v0
    v_lshlrev_b32 v5, 7, v5
    v_lshrrev_b32 v60, 2, v0
    v_lshl_add_u32 v5, v60, 24, v5
    v_add_u32 v5, s75, v5
    s_add_u32 s58, s62, 12288
    s_add_u32 s57, s62, 24832
    v_and_b32 v7, 7, v0
    v_lshlrev_b32 v7, 3, v7
    buffer_load_dwordx2 v[24:25], v7, s[40:43], s57 offen sc1
    buffer_load_dwordx4 v[12:15], v11, s[40:43], s58 offen offset:0 sc1
    buffer_load_dwordx4 v[16:19], v11, s[40:43], s58 offen offset:1024 sc1
    s_waitcnt vmcnt(3)
    ds_read_b64_tr_b16 v[36:37], v35 offset:0
    ds_read_b64_tr_b16 v[38:39], v35 offset:256
    ds_read_b64_tr_b16 v[40:41], v35 offset:2048
    ds_read_b64_tr_b16 v[42:43], v35 offset:2304
    ds_read_b64_tr_b16 v[44:45], v35 offset:32
    ds_read_b64_tr_b16 v[46:47], v35 offset:288
    ds_read_b64_tr_b16 v[48:49], v35 offset:2080
    ds_read_b64_tr_b16 v[50:51], v35 offset:2336
    s_waitcnt lgkmcnt(0)
L_pr_148:
    buffer_load_dwordx2 v[24:25], v7, s[40:43], s57 offen sc1
    buffer_load_dwordx4 v[12:15], v11, s[40:43], s58 offen offset:0 sc1
    buffer_load_dwordx4 v[16:19], v11, s[40:43], s58 offen offset:1024 sc1
    s_sub_u32 s56, s56, 1
    s_cbranch_scc1 L_done
L_pw_147:
    s_waitcnt vmcnt(5)
    v_max_u32 v26, v24, v25
    v_cmp_eq_u32 vcc, -1, v26
    s_cbranch_vccnz L_pr_148
    buffer_load_dwordx4 v[12:15], v11, s[40:43], s58 offen offset:0 sc1
    buffer_load_dwordx4 v[16:19], v11, s[40:43], s58 offen offset:1024 sc1
    v_add_f32_dpp v2, v24, v24 row_ror:4 row_mask:0xf bank_mask:0xf
    v_add_f32_dpp v3, v25, v25 row_ror:4 row_mask:0xf bank_mask:0xf
    s_nop 0
    v_add_f32_dpp v2, v2, v2 row_ror:2 row_mask:0xf bank_mask:0xf
    v_add_f32_dpp v3, v3, v3 row_ror:2 row_mask:0xf bank_mask:0xf
    s_nop 0
    v_add_f32_dpp v2, v2, v2 row_ror:1 row_mask:0xf bank_mask:0xf
    v_add_f32_dpp v3, v3, v3 row_ror:1 row_mask:0xf bank_mask:0xf
    v_mul_f32 v2, 0x3acccccd, v2
    v_mul_f32 v3, 0x3acccccd, v3
    v_fma_f32 v3, -v2, v2, v3
    v_max_f32 v3, 0, v3
    v_add_f32 v3, 0x3727c5ac, v3
    v_rsq_f32 v3, v3
    s_nop 0
    v_mul_f32 v2, v2, v3
L_pad4:
    s_cbranch_execz L_pad8
    v_fma_f32 v8, -v2, v8, v4
    s_waitcnt vmcnt(5)
L_hw_149:
    v_pk_add_f32 v[20:21], v[12:13], v[14:15]
    v_pk_add_f32 v[22:23], v[16:17], v[18:19]
    v_pk_add_f32 v[20:21], v[20:21], v[22:23]
    v_add_f32 v20, v20, v21
    v_cmp_u_f32 vcc, v20, v20
    v_fma_f32 v20, v20, v3, v8
    s_cbranch_vccnz L_hr_150
L_hk_151:
    v_mul_f32 v21, v20, v20
    v_fma_f32 v21, v21, v9, v10
    v_mul_f32 v21, v21, v20
    v_exp_f32 v21, v21
    s_cmp_eq_u32 s55, 0
    v_add_f32 v21, 1.0, v21
    v_rcp_f32 v21, v21
    s_nop 0
    v_mul_f32 v20, v20, v21
    s_nop 1
    v_mov_b32_dpp v21, v20 row_shl:1 row_mask:0xf bank_mask:0xf bound_ctrl:0
    v_cvt_pk_bf16_f32 v28, v20, v21
    s_nop 1
    v_mov_b32_dpp v29, v28 row_shl:4 row_mask:0xf bank_mask:0xf bound_ctrl:0
    v_mov_b32_dpp v30, v28 row_shl:8 row_mask:0xf bank_mask:0xf bound_ctrl:0
    v_mov_b32_dpp v31, v28 row_shl:12 row_mask:0xf bank_mask:0xf bound_ctrl:0
    s_nop 1
    v_smfmac_f32_16x16x64_bf16 v[52:55], v[28:31], v[36:43], v1
    v_smfmac_f32_16x16x64_bf16 v[56:59], v[28:31], v[44:51], v1
    s_nop 6
    v_add_f32 v22, v52, v54
    v_add_f32 v23, v56, v58
    ds_write_b64 v32, v[22:23]
    s_cmp_eq_u32 s30, 4
    s_cbranch_scc0 L_skip_153
L_xw_154:
    ds_read2_b32 v[20:21], v33 offset0:0 offset1:32
    ds_read_b32 v22, v33 offset:256
    s_cmp_eq_u32 s55, 0
    s_waitcnt lgkmcnt(0)
    v_max3_u32 v23, v20, v21, v22
    v_add_f32 v20, v20, v21
    v_cmp_eq_u32 vcc, -1, v23
    v_add_f32 v20, v20, v22
    s_cbranch_vccnz L_xr_155
    v_min_u32 v20, -2, v20
    buffer_store_dword v20, v34, s[40:43], s60 offen sc1
    s_cbranch_scc1 L_gs_156
    buffer_store_dword v0, v5, s[40:43], s74 offen
L_gb_157:
L_skip_153:
    s_waitcnt vmcnt(0)
L_skip_144:
    s_branch L_p1
L_typeB_0:
    s_cmp_eq_u32 s53, 3
    s_cbranch_scc0 L_p1
    s_cmp_eq_u32 s30, 7
    s_cbranch_scc1 L_w7_158
    s_cmp_lt_u32 s30, 6
    s_cbranch_scc0 L_skip_160
    s_lshr_b32 s57, s30, 1
    s_mul_i32 s57, s57, 128
    s_and_b32 s58, s30, 1
    s_lshl_b32 s58, s58, 6
    s_add_u32 s57, s57, s58
    v_lshrrev_b32 v18, 5, v0
    v_lshlrev_b32 v18, 13, v18
    v_bfe_u32 v60, v0, 3, 1
    v_lshl_add_u32 v18, v60, 12, v18
    v_bfe_u32 v60, v0, 4, 1
    v_lshl_add_u32 v18, v60, 11, v18
    v_bfe_u32 v60, v0, 2, 1
    v_mul_u32_u24 v60, 384, v60
    v_add_u32 v18, v60, v18
    v_and_b32 v60, 3, v0
    v_lshl_add_u32 v18, v60, 3, v18
    v_add_u32 v18, s57, v18
    v_add_u32 v18, 30720, v18
    v_bfe_u32 v19, v0, 4, 1
    v_lshlrev_b32 v19, 12, v19
    v_bfe_u32 v60, v0, 3, 1
    v_lshl_add_u32 v19, v60, 11, v19
    v_bfe_u32 v60, v0, 2, 1
    v_mul_u32_u24 v60, 384, v60
    v_add_u32 v19, v60, v19
    v_and_b32 v60, 3, v0
    v_lshl_add_u32 v19, v60, 3, v19
    v_add_u32 v19, s57, v19
    v_add_u32 v19, 63488, v19
    ds_read_b64_tr_b16 v[36:37], v18 offset:0
    ds_read_b64_tr_b16 v[38:39], v18 offset:1024
    ds_read_b64_tr_b16 v[40:41], v18 offset:16384
    ds_read_b64_tr_b16 v[42:43], v18 offset:17408
L_pad5:
    s_cbranch_execz L_pad9
    ds_read_b64_tr_b16 v[44:45], v19 offset:0
    ds_read_b64_tr_b16 v[46:47], v19 offset:1024
    ds_read_b64_tr_b16 v[48:49], v18 offset:32
    ds_read_b64_tr_b16 v[50:51], v18 offset:1056
    ds_read_b64_tr_b16 v[52:53], v18 offset:16416
    ds_read_b64_tr_b16 v[54:55], v18 offset:17440
    ds_read_b64_tr_b16 v[56:57], v19 offset:32
    ds_read_b64_tr_b16 v[58:59], v19 offset:1056
    v_lshrrev_b32 v32, 4, v0
    v_lshlrev_b32 v32, 5, v32
    v_bfe_u32 v60, v0, 1, 1
    v_lshl_add_u32 v32, v60, 4, v32
    v_and_b32 v60, 1, v0
    v_mul_u32_u24 v60, 192, v60
    v_add_u32 v32, v60, v32
    v_add_u32 v32, 160832, v32
    v_lshrrev_b32 v33, 4, v0
    v_lshlrev_b32 v33, 4, v33
    v_bfe_u32 v60, v0, 1, 1
    v_lshl_add_u32 v33, v60, 3, v33
    v_and_b32 v60, 1, v0
    v_mul_u32_u24 v60, 192, v60
    v_add_u32 v33, v60, v33
    v_add_u32 v33, 160960, v33
    v_mov_b64 v[24:25], 0
    v_mov_b64 v[26:27], 0
    v_mov_b64 v[28:29], 0
    v_mov_b64 v[30:31], 0
    s_lshr_b32 s57, s30, 1
    s_lshl_b32 s57, s57, 11
    s_and_b32 s58, s30, 1
    s_lshl_b32 s58, s58, 9
    s_add_u32 s57, s57, s58
    s_lshr_b32 s58, s54, 2
    s_lshl_b32 s58, s58, 10
    s_add_u32 s57, s57, s58
    s_and_b32 s58, s54, 3
    s_lshl_b32 s58, s58, 2
    s_add_u32 s57, s57, s58
    v_and_b32 v34, 31, v0
    v_lshlrev_b32 v34, 4, v34
    v_lshrrev_b32 v60, 5, v0
    v_lshl_add_u32 v34, v60, 30, v34
    v_add_u32 v34, s57, v34
    s_add_u32 s59, s62, 12288
    s_add_u32 s60, s62, 24832
    ds_read_b128 v[12:15], v32
    ds_read_b64 v[16:17], v33
    s_waitcnt lgkmcnt(1)
    v_smfmac_f32_16x16x64_bf16 v[24:27], v[12:15], v[36:43], v1
    v_smfmac_f32_16x16x64_bf16 v[28:31], v[12:15], v[48:55], v1
    s_waitcnt lgkmcnt(0)
    v_smfmac_f32_16x16x32_bf16 v[24:27], v[16:17], v[44:47], v1
    v_smfmac_f32_16x16x32_bf16 v[28:31], v[16:17], v[56:59], v1
    s_add_u32 s60, s62, 18432
    s_cmp_eq_u32 s55, 0
    s_nop 4
    v_add_f32 v12, v25, v27
    s_nop 1
    v_add_f32_dpp v12, v29, v31 quad_perm:[0,1,2,3] row_mask:0x2 bank_mask:0xf
    v_min_u32 v12, -2, v12
    s_cbranch_scc1 L_gs_161
    buffer_store_dword v12, v34, s[40:43], s60 offen
L_gb_162:
    v_mov_b64 v[24:25], 0
    v_mov_b64 v[26:27], 0
    v_mov_b64 v[28:29], 0
    v_mov_b64 v[30:31], 0
L_skip_160:
    s_cmp_lt_u32 s30, 6
    s_barrier
    s_cbranch_scc0 L_se_159
    ds_read_b128 v[12:15], v32
    ds_read_b64 v[16:17], v33
    s_waitcnt lgkmcnt(1)
    v_smfmac_f32_16x16x64_bf16 v[24:27], v[12:15], v[36:43], v1
    v_smfmac_f32_16x16x64_bf16 v[28:31], v[12:15], v[48:55], v1
    s_waitcnt lgkmcnt(0)
    v_smfmac_f32_16x16x32_bf16 v[24:27], v[16:17], v[44:47], v1
    v_smfmac_f32_16x16x32_bf16 v[28:31], v[16:17], v[56:59], v1
    s_cmp_eq_u32 s55, 0
    s_nop 5
    v_add_f32 v12, v24, v26
    s_nop 1
    v_add_f32_dpp v12, v28, v30 quad_perm:[0,1,2,3] row_mask:0x2 bank_mask:0xf
    v_min_u32 v12, -2, v12
    s_cbranch_scc1 L_gs_163
    buffer_store_dword v12, v34, s[40:43], s59 offen
L_gb_164:
L_se_159:
L_p1:
    s_cmp_eq_u32 s30, 7
    s_cbranch_scc1 L_w7_172
    s_cmp_lt_u32 s30, 6
    s_cbranch_scc0 L_skip_174
    s_lshr_b32 s57, s30, 1
L_pad6:
    s_cbranch_execz L_pad10
    s_mul_i32 s57, s57, 1024
    s_and_b32 s58, s30, 1
    s_lshl_b32 s58, s58, 6
    s_add_u32 s57, s57, s58
    v_lshrrev_b32 v18, 5, v0
    v_mul_u32_u24 v18, 6144, v18
    v_bfe_u32 v60, v0, 3, 1
    v_mul_u32_u24 v60, 3072, v60
    v_add_u32 v18, v60, v18
    v_bfe_u32 v60, v0, 4, 1
    v_lshl_add_u32 v18, v60, 9, v18
    v_bfe_u32 v60, v0, 2, 1
    v_lshl_add_u32 v18, v60, 7, v18
    v_and_b32 v60, 3, v0
    v_lshl_add_u32 v18, v60, 3, v18
    v_add_u32 v18, s57, v18
    v_bfe_u32 v19, v0, 4, 1
    v_mul_u32_u24 v19, 3072, v19
    v_bfe_u32 v60, v0, 3, 1
    v_lshl_add_u32 v19, v60, 9, v19
    v_bfe_u32 v60, v0, 2, 1
    v_lshl_add_u32 v19, v60, 7, v19
    v_and_b32 v60, 3, v0
    v_lshl_add_u32 v19, v60, 3, v19
    v_add_u32 v19, s57, v19
    v_add_u32 v19, 24576, v19
    ds_read_b64_tr_b16 v[36:37], v18 offset:0
    ds_read_b64_tr_b16 v[38:39], v18 offset:256
    ds_read_b64_tr_b16 v[40:41], v18 offset:12288
    ds_read_b64_tr_b16 v[42:43], v18 offset:12544
    ds_read_b64_tr_b16 v[44:45], v19 offset:0
    ds_read_b64_tr_b16 v[46:47], v19 offset:256
    ds_read_b64_tr_b16 v[48:49], v18 offset:32
    ds_read_b64_tr_b16 v[50:51], v18 offset:288
    ds_read_b64_tr_b16 v[52:53], v18 offset:12320
    ds_read_b64_tr_b16 v[54:55], v18 offset:12576
    ds_read_b64_tr_b16 v[56:57], v19 offset:32
    ds_read_b64_tr_b16 v[58:59], v19 offset:288
    v_lshrrev_b32 v32, 4, v0
    v_lshlrev_b32 v32, 5, v32
    v_bfe_u32 v60, v0, 1, 1
    v_lshl_add_u32 v32, v60, 4, v32
    v_and_b32 v60, 1, v0
    v_mul_u32_u24 v60, 192, v60
    v_add_u32 v32, v60, v32
    v_add_u32 v32, 160832, v32
    v_lshrrev_b32 v33, 4, v0
    v_lshlrev_b32 v33, 4, v33
    v_bfe_u32 v60, v0, 1, 1
    v_lshl_add_u32 v33, v60, 3, v33
    v_and_b32 v60, 1, v0
    v_mul_u32_u24 v60, 192, v60
    v_add_u32 v33, v60, v33
    v_add_u32 v33, 160960, v33
    v_mov_b64 v[24:25], 0
    v_mov_b64 v[26:27], 0
    v_mov_b64 v[28:29], 0
    v_mov_b64 v[30:31], 0
    s_lshl_b32 s57, s54, 1
    s_lshl_b32 s58, s30, 9
    s_add_u32 s57, s57, s58
    v_and_b32 v34, 31, v0
    v_lshlrev_b32 v34, 4, v34
    v_lshrrev_b32 v60, 5, v0
    v_lshl_add_u32 v34, v60, 30, v34
    v_add_u32 v34, s57, v34
    s_mul_i32 s59, s53, 3072
    s_add_u32 s59, s59, s62
    s_add_u32 s59, s59, 44928
    s_lshl_b32 s60, s53, 6
    s_add_u32 s60, s60, s62
    s_add_u32 s60, s60, 24576
L_skip_174:
    s_cmp_lt_u32 s30, 6
    s_barrier
    s_cbranch_scc0 L_se_173
    ds_read_b128 v[12:15], v32
    ds_read_b64 v[16:17], v33
    s_waitcnt lgkmcnt(1)
    v_smfmac_f32_16x16x64_bf16 v[24:27], v[12:15], v[36:43], v1
    v_smfmac_f32_16x16x64_bf16 v[28:31], v[12:15], v[48:55], v1
    s_waitcnt lgkmcnt(0)
    v_smfmac_f32_16x16x32_bf16 v[24:27], v[16:17], v[44:47], v1
L_pad7:
    s_cbranch_execz L_pad11
    v_smfmac_f32_16x16x32_bf16 v[28:31], v[16:17], v[56:59], v1
    s_cmp_eq_u32 s55, 0
    s_nop 5
    v_add_f32 v12, v24, v26
    s_nop 1
    v_add_f32_dpp v12, v28, v30 quad_perm:[0,1,2,3] row_mask:0x2 bank_mask:0xf
    v_cvt_pk_bf16_f32 v12, v12, v12
    v_min_u32 v12, -2, v12
    s_cbranch_scc1 L_gs_175
    buffer_store_short v12, v34, s[40:43], s59 offen
L_gb_176:
L_se_173:
    s_mul_i32 s59, s53, 3072
    s_add_u32 s59, s59, s62
    s_add_u32 s59, s59, 44928
    s_lshl_b32 s60, s53, 6
    s_add_u32 s60, s60, s62
    s_add_u32 s60, s60, 24576
    s_sub_u32 s64, s30, 1
    s_cmp_lt_u32 s64, 3
    s_cbranch_scc0 L_qo_190
    s_lshl_b32 s57, s64, 10
    v_lshlrev_b32 v7, 4, v0
    v_add_u32 v7, s57, v7
    buffer_load_dwordx4 v[56:59], v7, s[40:43], s59 offen sc1
    v_mov_b64 v[24:25], 0
    v_mov_b64 v[26:27], 0
    v_mov_b64 v[28:29], 0
    v_mov_b64 v[30:31], 0
    v_mov_b64 v[32:33], 0
    v_mov_b64 v[34:35], 0
    v_mov_b64 v[36:37], 0
    v_mov_b64 v[38:39], 0
    v_mov_b64 v[40:41], 0
    v_mov_b64 v[42:43], 0
    v_mov_b64 v[44:45], 0
    v_mov_b64 v[46:47], 0
    s_lshl_b32 s57, s30, 7
    s_add_u32 s57, s57, 158720
    v_lshrrev_b32 v54, 4, v0
    v_lshlrev_b32 v54, 5, v54
    v_bfe_u32 v60, v0, 1, 1
    v_lshl_add_u32 v54, v60, 4, v54
    v_bfe_u32 v60, v0, 2, 2
    v_lshl_add_u32 v54, v60, 2, v54
    v_and_b32 v60, 1, v0
    v_lshl_add_u32 v54, v60, 1, v54
    v_add_u32 v54, s57, v54
    v_lshrrev_b32 v61, 4, v0
    v_lshlrev_b32 v61, 5, v61
    v_bfe_u32 v60, v0, 1, 1
    v_lshl_add_u32 v61, v60, 4, v61
    v_add_u32 v61, s57, v61
    v_bfe_u32 v62, v0, 2, 2
    v_lshlrev_b32 v62, 1, v62
    v_and_b32 v60, 1, v0
    v_lshl_add_u32 v62, v60, 0, v62
    v_mov_b32 v60, 160992
    v_cmp_eq_u32 vcc, 0, v62
    s_nop 1
    v_cndmask_b32 v48, v60, v61, vcc
    v_cmp_eq_u32 vcc, 1, v62
    s_nop 1
    v_cndmask_b32 v49, v60, v61, vcc
    v_cmp_eq_u32 vcc, 2, v62
    s_nop 1
    v_cndmask_b32 v50, v60, v61, vcc
    v_cmp_eq_u32 vcc, 3, v62
    s_nop 1
    v_cndmask_b32 v51, v60, v61, vcc
    v_cmp_eq_u32 vcc, 4, v62
    s_nop 1
    v_cndmask_b32 v52, v60, v61, vcc
    v_cmp_eq_u32 vcc, 5, v62
    s_nop 1
    v_cndmask_b32 v53, v60, v61, vcc
    s_lshl_b32 s58, s30, 2
    s_add_u32 s58, s58, 159808
    v_mov_b32 v60, s58
    v_lshlrev_b32 v55, 2, v0
    v_add_u32 v55, 157696, v55
    v_cmp_eq_u32 vcc, 63, v0
    s_nop 1
    v_cndmask_b32 v55, v55, v60, vcc
    v_and_b32 v62, 7, v0
    v_lshlrev_b32 v62, 2, v62
    v_add_u32 v62, 159808, v62
    s_lshl_b32 s57, s30, 11
    v_lshlrev_b32 v63, 4, v0
    v_add_u32 v63, s57, v63
    v_add_u32 v63, 92160, v63
    v_lshrrev_b32 v5, 4, v0
    v_lshlrev_b32 v5, 5, v5
    v_bfe_u32 v60, v0, 1, 1
    v_lshl_add_u32 v5, v60, 4, v5
    v_add_u32 v5, 124928, v5
    v_mov_b32 v8, 125440
    s_lshl_b32 s57, s64, 7
    v_lshrrev_b32 v9, 4, v0
    v_lshlrev_b32 v9, 5, v9
    v_bfe_u32 v60, v0, 1, 1
L_pad8:
    s_cbranch_execz L_pad12
    v_lshl_add_u32 v9, v60, 4, v9
    v_bfe_u32 v60, v0, 2, 2
    v_lshl_add_u32 v9, v60, 2, v9
    v_and_b32 v60, 1, v0
    v_lshl_add_u32 v9, v60, 1, v9
    v_add_u32 v9, s57, v9
    v_add_u32 v9, 124928, v9
    v_mov_b32 v10, 0x3f803f80
L_qw_192:
    buffer_load_dwordx4 v[56:59], v7, s[40:43], s59 offen sc1
    s_sub_u32 s56, s56, 1
    s_cbranch_scc1 L_done
    s_and_b32 s57, s56, 31
    s_waitcnt vmcnt(1)
    v_dot2_f32_bf16 v60, v56, v10, 0
    v_dot2_f32_bf16 v61, v57, v10, 0
    v_dot2_f32_bf16 v60, v58, v10, v60
    v_dot2_f32_bf16 v61, v59, v10, v61
    s_nop 2
    v_add_f32 v60, v60, v61
    v_cmp_u_f32 vcc, v60, v60
    v_cvt_pk_bf16_f32 v60, v60, v60
    s_cbranch_vccnz L_qr_193
L_qk_194:
    ds_write_b16 v9, v60
L_qb_191:
    s_waitcnt lgkmcnt(0)
    s_barrier
    ds_read_b128 v[12:15], v5 offset:0
    ds_read_b128 v[16:19], v5 offset:128
    ds_read_b128 v[20:23], v5 offset:256
    ds_read_b64 v[8:9], v8
    s_waitcnt lgkmcnt(1)
    v_smfmac_f32_16x16x64_bf16 v[24:27], v[12:15], v[64:71], v1
    v_smfmac_f32_16x16x64_bf16 v[24:27], v[16:19], v[72:79], v1
    v_smfmac_f32_16x16x64_bf16 v[24:27], v[20:23], v[80:87], v1
    v_smfmac_f32_16x16x64_bf16 v[28:31], v[12:15], v[88:95], v1
    v_smfmac_f32_16x16x64_bf16 v[28:31], v[16:19], v[96:103], v1
    v_smfmac_f32_16x16x64_bf16 v[28:31], v[20:23], v[104:111], v1
    v_smfmac_f32_16x16x64_bf16 v[32:35], v[12:15], v[112:119], v1
    v_smfmac_f32_16x16x64_bf16 v[32:35], v[16:19], v[120:127], v1
    v_smfmac_f32_16x16x64_bf16 v[32:35], v[20:23], v[128:135], v1
    v_smfmac_f32_16x16x64_bf16 v[36:39], v[12:15], v[136:143], v1
    v_smfmac_f32_16x16x64_bf16 v[36:39], v[16:19], v[144:151], v1
    v_smfmac_f32_16x16x64_bf16 v[36:39], v[20:23], v[152:159], v1
    v_add_f32_dpp v61, v24, v26 quad_perm:[0,1,2,3] row_mask:0x1 bank_mask:0xf
    s_waitcnt vmcnt(0) lgkmcnt(0)
    v_mul_f32 v8, v8, v6
    v_add_f32_dpp v61, v28, v30 quad_perm:[0,1,2,3] row_mask:0x2 bank_mask:0xf
    s_nop 1
    v_add_f32_dpp v61, v32, v34 quad_perm:[0,1,2,3] row_mask:0x4 bank_mask:0xf
    s_nop 1
    v_add_f32_dpp v61, v36, v38 quad_perm:[0,1,2,3] row_mask:0x8 bank_mask:0xf
    v_fma_f32 v36, v61, v9, v8
    s_nop 1
    v_max_f32_dpp v37, v36, v36 row_ror:8 row_mask:0xf bank_mask:0xf
    s_nop 1
    v_max_f32_dpp v37, v37, v37 row_ror:4 row_mask:0xf bank_mask:0xf
    s_nop 1
    v_max_f32_dpp v37, v37, v37 row_ror:2 row_mask:0xf bank_mask:0xf
    s_nop 1
    v_max_f32_dpp v37, v37, v37 row_ror:1 row_mask:0xf bank_mask:0xf
    s_nop 1
    v_max_f32_dpp v37, v37, v37 row_bcast:15 row_mask:0xa bank_mask:0xf
    s_nop 1
    v_max_f32_dpp v37, v37, v37 row_bcast:31 row_mask:0xc bank_mask:0xf
    s_nop 0
    v_readlane_b32 s64, v37, 63
    ds_write_b32 v55, v37
    s_nop 0
    v_subrev_f32 v36, s64, v36
    v_exp_f32 v36, v36
    s_nop 0
    v_cvt_pk_bf16_f32 v39, v36, v36
    ds_write_b16 v54, v39
    ds_read_b128 v[12:15], v48
    ds_read_b128 v[16:19], v49
    ds_read_b128 v[20:23], v50
    ds_read_b128 v[24:27], v51
    ds_read_b128 v[28:31], v52
L_pad9:
    s_cbranch_execz L_pad13
    ds_read_b128 v[32:35], v53
    v_add_f32_dpp v38, v36, v36 row_ror:8 row_mask:0xf bank_mask:0xf
    s_nop 1
    v_add_f32_dpp v38, v38, v38 row_ror:4 row_mask:0xf bank_mask:0xf
    s_nop 1
    v_add_f32_dpp v38, v38, v38 row_ror:2 row_mask:0xf bank_mask:0xf
    s_nop 1
    v_add_f32_dpp v38, v38, v38 row_ror:1 row_mask:0xf bank_mask:0xf
    s_nop 1
    v_add_f32_dpp v38, v38, v38 row_bcast:15 row_mask:0xa bank_mask:0xf
    s_nop 1
    v_add_f32_dpp v38, v38, v38 row_bcast:31 row_mask:0xc bank_mask:0xf
    ds_read_b32 v36, v62
    s_waitcnt lgkmcnt(6)
    v_smfmac_f32_16x16x64_bf16 v[40:43], v[12:15], v[160:167], v1
    v_smfmac_f32_16x16x64_bf16 v[44:47], v[12:15], v[208:215], v1
    s_waitcnt lgkmcnt(5)
    v_smfmac_f32_16x16x64_bf16 v[40:43], v[16:19], v[168:175], v1
    v_smfmac_f32_16x16x64_bf16 v[44:47], v[16:19], v[216:223], v1
    s_waitcnt lgkmcnt(0)
    v_cmp_eq_u32 vcc, -1, v36
    v_smfmac_f32_16x16x64_bf16 v[40:43], v[20:23], v[176:183], v1
    v_max_f32_dpp v37, v36, v36 row_ror:4 row_mask:0xf bank_mask:0xf
    v_smfmac_f32_16x16x64_bf16 v[44:47], v[20:23], v[224:231], v1
    v_smfmac_f32_16x16x64_bf16 v[40:43], v[24:27], v[184:191], v1
    v_max_f32_dpp v37, v37, v37 row_ror:2 row_mask:0xf bank_mask:0xf
    v_smfmac_f32_16x16x64_bf16 v[44:47], v[24:27], v[232:239], v1
    v_smfmac_f32_16x16x64_bf16 v[40:43], v[28:31], v[192:199], v1
    v_max_f32_dpp v37, v37, v37 row_ror:1 row_mask:0xf bank_mask:0xf
    v_smfmac_f32_16x16x64_bf16 v[44:47], v[28:31], v[240:247], v1
    v_sub_f32 v39, s64, v37
    v_smfmac_f32_16x16x64_bf16 v[40:43], v[32:35], v[200:207], v1
    v_exp_f32 v39, v39
    v_smfmac_f32_16x16x64_bf16 v[44:47], v[32:35], v[248:255], v1
    s_cbranch_vccnz L_mr_197
L_mk_198:
    v_mul_f32 v38, v38, v39
    ds_write_b32 v63, v38 offset:1024
    s_cmp_lt_u32 s30, 2
    s_nop 1
    v_pk_add_f32 v[40:41], v[40:41], v[42:43]
    s_nop 0
    v_pk_add_f32 v[42:43], v[44:45], v[46:47]
    v_pk_mul_f32 v[40:41], v[40:41], v[38:39] op_sel:[0,1] op_sel_hi:[1,1]
    v_pk_mul_f32 v[42:43], v[42:43], v[38:39] op_sel:[0,1] op_sel_hi:[1,1]
    ds_write_b128 v63, v[40:43]
    s_cbranch_scc1 L_comb_1
    s_waitcnt lgkmcnt(0)
    s_barrier
L_comb_1b:
    s_cmp_lt_u32 s3, 20
    s_cbranch_scc0 L_typeB_1
    s_lshr_b32 s57, s30, 1
    s_lshl_b32 s57, s57, 5
    s_add_u32 s57, s57, s62
    s_add_u32 s59, s57, 25344
    v_and_b32 v5, 7, v0
    v_lshlrev_b32 v5, 2, v5
    v_lshrrev_b32 v22, 4, v0
    v_lshlrev_b32 v22, 3, v22
    buffer_load_dword v18, v5, s[40:43], s59 offen sc1
    buffer_load_dwordx2 v[20:21], v22, s[40:43], s59 offen sc1
    s_mul_i32 s60, s30, 1536
    s_add_u32 s60, s60, s62
    s_add_u32 s60, s60, 26496
    v_lshlrev_b32 v9, 4, v0
    v_lshlrev_b32 v10, 3, v0
    s_mul_i32 s57, s30, 6144
    v_lshrrev_b32 v7, 2, v0
    v_lshlrev_b32 v7, 6, v7
    v_bfe_u32 v60, v0, 4, 1
    v_lshl_add_u32 v7, v60, 5, v7
    v_and_b32 v60, 3, v0
    v_lshl_add_u32 v7, v60, 3, v7
    v_add_u32 v7, s57, v7
    v_add_u32 v7, 30720, v7
    v_xor_b32 v8, 32, v7
    ds_read_b64_tr_b16 v[36:37], v7 offset:0
    ds_read_b64_tr_b16 v[38:39], v7 offset:1024
    ds_read_b64_tr_b16 v[40:41], v7 offset:2048
    ds_read_b64_tr_b16 v[42:43], v7 offset:3072
    ds_read_b64_tr_b16 v[44:45], v7 offset:4096
    ds_read_b64_tr_b16 v[46:47], v7 offset:5120
    ds_read_b64_tr_b16 v[48:49], v8 offset:0
L_pad10:
    s_cbranch_execz L_pad14
    ds_read_b64_tr_b16 v[50:51], v8 offset:1024
    ds_read_b64_tr_b16 v[52:53], v8 offset:2048
    ds_read_b64_tr_b16 v[54:55], v8 offset:3072
    ds_read_b64_tr_b16 v[56:57], v8 offset:4096
    ds_read_b64_tr_b16 v[58:59], v8 offset:5120
    v_mov_b64 v[24:25], 0
    v_mov_b64 v[26:27], 0
    v_mov_b64 v[28:29], 0
    v_mov_b64 v[30:31], 0
    s_lshl_b32 s57, s30, 8
    v_lshlrev_b32 v11, 2, v0
    v_add_u32 v11, s57, v11
    v_add_u32 v11, 157696, v11
    v_lshlrev_b32 v32, 2, v0
    v_add_u32 v32, 157696, v32
    s_add_u32 s58, s6, 262144
    s_add_u32 s57, s58, 16384
    v_and_b32 v33, 15, v0
    v_lshlrev_b32 v33, 2, v33
    v_lshrrev_b32 v60, 5, v0
    v_lshl_add_u32 v33, v60, 6, v33
    v_bfe_u32 v60, v0, 4, 1
    v_lshl_add_u32 v33, v60, 13, v33
    s_lshl_b32 s74, s3, 2
    s_add_u32 s74, s74, s62
    s_add_u32 s74, s74, 25728
    s_xor_b32 s75, s30, 2
    v_add_u32 v34, s75, v0
    v_lshlrev_b32 v34, 24, v34
    s_branch L_pw_205
L_pr_206:
    buffer_load_dword v18, v5, s[40:43], s59 offen sc1
    buffer_load_dwordx2 v[20:21], v22, s[40:43], s59 offen sc1
    s_sub_u32 s56, s56, 1
    s_cbranch_scc1 L_done
L_pw_205:
    s_waitcnt vmcnt(0)
    v_max3_u32 v19, v18, v20, v21
    v_cmp_eq_u32 vcc, -1, v19
    s_cbranch_vccnz L_pr_206
    buffer_load_dwordx4 v[12:15], v9, s[40:43], s60 offen sc1
    buffer_load_dwordx2 v[16:17], v10, s[40:43], s60 offen offset:1024 sc1
    buffer_load_dword v23, v5, s[40:43], s59 offen offset:128 sc1
    v_max_f32_dpp v19, v18, v18 row_ror:4 row_mask:0xf bank_mask:0xf
    s_nop 1
    v_max_f32_dpp v19, v19, v19 row_ror:2 row_mask:0xf bank_mask:0xf
    s_nop 1
    v_max_f32_dpp v19, v19, v19 row_ror:1 row_mask:0xf bank_mask:0xf
    v_sub_f32 v18, v18, v19
    v_sub_f32 v20, v20, v19
    v_sub_f32 v21, v21, v19
    v_exp_f32 v18, v18
    v_exp_f32 v20, v20
    v_exp_f32 v21, v21
    s_waitcnt lgkmcnt(0)
    s_branch L_pw_207
L_pr_208:
    buffer_load_dwordx4 v[12:15], v9, s[40:43], s60 offen sc1
    buffer_load_dwordx2 v[16:17], v10, s[40:43], s60 offen offset:1024 sc1
    buffer_load_dword v23, v5, s[40:43], s59 offen offset:128 sc1
    s_sub_u32 s56, s56, 1
    s_cbranch_scc1 L_done
L_pw_207:
    s_waitcnt vmcnt(0)
    v_max3_u32 v19, v12, v13, v14
    v_max3_u32 v19, v19, v15, v16
    v_max3_u32 v19, v19, v17, v23
    v_cmp_eq_u32 vcc, -1, v19
    s_cbranch_vccnz L_pr_208
    v_smfmac_f32_16x16x64_bf16 v[24:27], v[12:15], v[36:43], v1
    v_mul_f32 v18, v18, v23
    v_smfmac_f32_16x16x64_bf16 v[28:31], v[12:15], v[48:55], v1
    v_smfmac_f32_16x16x32_bf16 v[24:27], v[16:17], v[44:47], v1
    v_add_f32_dpp v18, v18, v18 row_ror:4 row_mask:0xf bank_mask:0xf
    v_smfmac_f32_16x16x32_bf16 v[28:31], v[16:17], v[56:59], v1
    s_nop 0
    v_add_f32_dpp v18, v18, v18 row_ror:2 row_mask:0xf bank_mask:0xf
    s_nop 1
    v_add_f32_dpp v18, v18, v18 row_ror:1 row_mask:0xf bank_mask:0xf
    v_rcp_f32 v18, v18
    v_pk_add_f32 v[24:25], v[24:25], v[26:27]
    s_nop 0
    v_pk_add_f32 v[28:29], v[28:29], v[30:31]
    v_pk_mul_f32 v[20:21], v[20:21], v[18:19] op_sel:[0,0] op_sel_hi:[1,0]
    v_mul_f32 v24, v24, v20
    v_mul_f32 v28, v28, v20
    v_fmac_f32 v24, v25, v21
    v_fmac_f32 v28, v29, v21
    s_nop 1
    v_permlane32_swap_b32 v24, v28
    v_add_f32 v24, v24, v28
    ds_write_b32 v11, v24
L_pad11:
    s_cbranch_execz L_pad15
    s_cmp_eq_u32 s30, 2
    s_cbranch_scc1 L_fin_209
    s_cmp_eq_u32 s55, 0
    s_waitcnt lgkmcnt(0)
    s_barrier
L_finb_210:
    s_sub_u32 s57, s30, 4
    s_cmp_lt_u32 s57, 3
    s_cbranch_scc0 L_skip_213
    s_sub_u32 s60, s30, 4
    s_lshl_b32 s59, s60, 12
    s_add_u32 s59, s59, 79872
    s_lshl_b32 s57, s60, 11
    v_lshlrev_b32 v11, 4, v0
    v_add_u32 v11, s57, v11
    s_add_u32 s58, s62, 18432
    buffer_load_dwordx4 v[12:15], v11, s[40:43], s58 offen offset:0 sc1
    buffer_load_dwordx4 v[16:19], v11, s[40:43], s58 offen offset:1024 sc1
    v_lshrrev_b32 v35, 4, v0
    v_lshlrev_b32 v35, 9, v35
    v_bfe_u32 v60, v0, 2, 2
    v_lshl_add_u32 v35, v60, 6, v35
    v_and_b32 v60, 3, v0
    v_lshl_add_u32 v35, v60, 3, v35
    v_add_u32 v35, s59, v35
    s_waitcnt vmcnt(0)
L_sw_214:
    v_max3_u32 v60, v12, v13, v14
    v_max3_u32 v60, v60, v15, v16
    v_max3_u32 v60, v60, v17, v18
    v_max_u32 v60, v60, v19
    v_cmp_eq_u32 vcc, -1, v60
    s_cbranch_vccnz L_sr_215
    v_pk_add_f32 v[20:21], v[12:13], v[14:15]
    v_pk_add_f32 v[22:23], v[16:17], v[18:19]
    v_pk_add_f32 v[20:21], v[20:21], v[22:23]
    v_add_f32 v8, v20, v21
    v_mov_b64 v[52:53], 0
    v_mov_b64 v[54:55], 0
    v_mov_b64 v[56:57], 0
    v_mov_b64 v[58:59], 0
    v_mov_b32 v9, 0xbdd2d3e8
    v_mov_b32 v10, 0xc0135761
    s_lshl_b32 s57, s60, 7
    s_add_u32 s57, s57, 160256
    v_lshlrev_b32 v32, 3, v0
    v_add_u32 v32, s57, v32
    v_lshlrev_b32 v33, 3, v0
    v_add_u32 v33, 129024, v33
    v_cmp_gt_u32 vcc, 16, v0
    s_nop 1
    v_cndmask_b32 v32, v33, v32, vcc
    v_and_b32 v33, 15, v0
    v_lshlrev_b32 v33, 3, v33
    v_lshrrev_b32 v60, 5, v0
    v_lshl_add_u32 v33, v60, 2, v33
    v_add_u32 v33, 160256, v33
    v_and_b32 v34, 15, v0
    v_lshlrev_b32 v34, 2, v34
    v_lshrrev_b32 v60, 5, v0
    v_lshl_add_u32 v34, v60, 6, v34
    v_bfe_u32 v60, v0, 4, 1
    v_lshl_add_u32 v34, v60, 13, v34
    s_add_u32 s60, s6, 393216
    s_add_u32 s59, s60, 16384
    s_lshl_b32 s74, s3, 2
    s_add_u32 s74, s74, s62
    s_add_u32 s74, s74, 25856
    s_xor_b32 s75, s30, 4
    v_add_u32 v5, s75, v0
    v_lshlrev_b32 v5, 24, v5
    s_add_u32 s58, s62, 38784
    s_add_u32 s57, s62, 24960
    v_and_b32 v7, 7, v0
    v_lshlrev_b32 v7, 3, v7
    buffer_load_dwordx2 v[24:25], v7, s[40:43], s57 offen sc1
    buffer_load_dwordx4 v[12:15], v11, s[40:43], s58 offen offset:0 sc1
    buffer_load_dwordx4 v[16:19], v11, s[40:43], s58 offen offset:1024 sc1
    ds_read_b64_tr_b16 v[36:37], v35 offset:0
    ds_read_b64_tr_b16 v[38:39], v35 offset:256
    ds_read_b64_tr_b16 v[40:41], v35 offset:2048
    ds_read_b64_tr_b16 v[42:43], v35 offset:2304
    ds_read_b64_tr_b16 v[44:45], v35 offset:32
    ds_read_b64_tr_b16 v[46:47], v35 offset:288
    ds_read_b64_tr_b16 v[48:49], v35 offset:2080
    ds_read_b64_tr_b16 v[50:51], v35 offset:2336
    s_waitcnt lgkmcnt(0)
L_pr_217:
    buffer_load_dwordx2 v[24:25], v7, s[40:43], s57 offen sc1
    buffer_load_dwordx4 v[12:15], v11, s[40:43], s58 offen offset:0 sc1
L_pad12:
    s_cbranch_execz L_pad16
    buffer_load_dwordx4 v[16:19], v11, s[40:43], s58 offen offset:1024 sc1
    s_sub_u32 s56, s56, 1
    s_cbranch_scc1 L_done
L_pw_216:
    s_waitcnt vmcnt(5)
    v_max_u32 v26, v24, v25
    v_cmp_eq_u32 vcc, -1, v26
    s_cbranch_vccnz L_pr_217
    buffer_load_dwordx4 v[12:15], v11, s[40:43], s58 offen offset:0 sc1
    buffer_load_dwordx4 v[16:19], v11, s[40:43], s58 offen offset:1024 sc1
    v_add_f32_dpp v2, v24, v24 row_ror:4 row_mask:0xf bank_mask:0xf
    v_add_f32_dpp v3, v25, v25 row_ror:4 row_mask:0xf bank_mask:0xf
    s_nop 0
    v_add_f32_dpp v2, v2, v2 row_ror:2 row_mask:0xf bank_mask:0xf
    v_add_f32_dpp v3, v3, v3 row_ror:2 row_mask:0xf bank_mask:0xf
    s_nop 0
    v_add_f32_dpp v2, v2, v2 row_ror:1 row_mask:0xf bank_mask:0xf
    v_add_f32_dpp v3, v3, v3 row_ror:1 row_mask:0xf bank_mask:0xf
    v_mul_f32 v2, 0x3acccccd, v2
    v_mul_f32 v3, 0x3acccccd, v3
    v_fma_f32 v3, -v2, v2, v3
    v_max_f32 v3, 0, v3
    v_add_f32 v3, 0x3727c5ac, v3
    v_rsq_f32 v3, v3
    s_nop 0
    v_mul_f32 v2, v2, v3
    v_fma_f32 v8, -v2, v8, v4
    s_waitcnt vmcnt(5)
L_hw_218:
    v_pk_add_f32 v[20:21], v[12:13], v[14:15]
    v_pk_add_f32 v[22:23], v[16:17], v[18:19]
    v_pk_add_f32 v[20:21], v[20:21], v[22:23]
    v_add_f32 v20, v20, v21
    v_cmp_u_f32 vcc, v20, v20
    v_fma_f32 v20, v20, v3, v8
    s_cbranch_vccnz L_hr_219
L_hk_220:
    v_mul_f32 v21, v20, v20
    v_fma_f32 v21, v21, v9, v10
    v_mul_f32 v21, v21, v20
    v_exp_f32 v21, v21
    s_cmp_eq_u32 s55, 0
    v_add_f32 v21, 1.0, v21
    v_rcp_f32 v21, v21
    s_nop 0
    v_mul_f32 v20, v20, v21
    s_nop 1
    v_mov_b32_dpp v21, v20 row_shl:1 row_mask:0xf bank_mask:0xf bound_ctrl:0
    v_cvt_pk_bf16_f32 v28, v20, v21
    s_nop 1
    v_mov_b32_dpp v29, v28 row_shl:4 row_mask:0xf bank_mask:0xf bound_ctrl:0
    v_mov_b32_dpp v30, v28 row_shl:8 row_mask:0xf bank_mask:0xf bound_ctrl:0
    v_mov_b32_dpp v31, v28 row_shl:12 row_mask:0xf bank_mask:0xf bound_ctrl:0
    s_nop 1
    v_smfmac_f32_16x16x64_bf16 v[52:55], v[28:31], v[36:43], v1
    v_smfmac_f32_16x16x64_bf16 v[56:59], v[28:31], v[44:51], v1
    s_nop 6
    v_add_f32 v22, v52, v54
    v_add_f32 v23, v56, v58
    ds_write_b64 v32, v[22:23]
    s_cmp_eq_u32 s30, 4
    s_cbranch_scc0 L_skip_222
L_xw_223:
    ds_read2_b32 v[20:21], v33 offset0:0 offset1:32
    ds_read_b32 v22, v33 offset:256
    s_cmp_eq_u32 s55, 0
    s_waitcnt lgkmcnt(0)
    v_max3_u32 v23, v20, v21, v22
    v_add_f32 v20, v20, v21
    v_cmp_eq_u32 vcc, -1, v23
    v_add_f32 v20, v20, v22
    s_cbranch_vccnz L_xr_224
    v_min_u32 v20, -2, v20
    buffer_store_dword v20, v34, s[40:43], s60 offen sc1
    s_cbranch_scc1 L_gs_225
    buffer_store_dword v0, v5, s[40:43], s74 offen
L_gb_226:
L_skip_222:
L_skip_213:
    s_branch L_done
L_typeB_1:
    s_cmp_eq_u32 s53, 3
    s_cbranch_scc0 L_done
    s_cmp_eq_u32 s30, 7
    s_cbranch_scc1 L_w7_227
    s_cmp_lt_u32 s30, 6
    s_cbranch_scc0 L_skip_229
    s_lshr_b32 s57, s30, 1
    s_mul_i32 s57, s57, 128
    s_and_b32 s58, s30, 1
    s_lshl_b32 s58, s58, 6
    s_add_u32 s57, s57, s58
    v_lshrrev_b32 v18, 5, v0
    v_lshlrev_b32 v18, 13, v18
    v_bfe_u32 v60, v0, 3, 1
    v_lshl_add_u32 v18, v60, 12, v18
    v_bfe_u32 v60, v0, 4, 1
    v_lshl_add_u32 v18, v60, 11, v18
L_pad13:
    s_cbranch_execz L_pad17
    v_bfe_u32 v60, v0, 2, 1
    v_mul_u32_u24 v60, 384, v60
    v_add_u32 v18, v60, v18
    v_and_b32 v60, 3, v0
    v_lshl_add_u32 v18, v60, 3, v18
    v_add_u32 v18, s57, v18
    v_add_u32 v18, 30720, v18
    v_bfe_u32 v19, v0, 4, 1
    v_lshlrev_b32 v19, 12, v19
    v_bfe_u32 v60, v0, 3, 1
    v_lshl_add_u32 v19, v60, 11, v19
    v_bfe_u32 v60, v0, 2, 1
    v_mul_u32_u24 v60, 384, v60
    v_add_u32 v19, v60, v19
    v_and_b32 v60, 3, v0
    v_lshl_add_u32 v19, v60, 3, v19
    v_add_u32 v19, s57, v19
    v_add_u32 v19, 63488, v19
    ds_read_b64_tr_b16 v[36:37], v18 offset:0
    ds_read_b64_tr_b16 v[38:39], v18 offset:1024
    ds_read_b64_tr_b16 v[40:41], v18 offset:16384
    ds_read_b64_tr_b16 v[42:43], v18 offset:17408
    ds_read_b64_tr_b16 v[44:45], v19 offset:0
    ds_read_b64_tr_b16 v[46:47], v19 offset:1024
    ds_read_b64_tr_b16 v[48:49], v18 offset:32
    ds_read_b64_tr_b16 v[50:51], v18 offset:1056
    ds_read_b64_tr_b16 v[52:53], v18 offset:16416
    ds_read_b64_tr_b16 v[54:55], v18 offset:17440
    ds_read_b64_tr_b16 v[56:57], v19 offset:32
    ds_read_b64_tr_b16 v[58:59], v19 offset:1056
    v_lshrrev_b32 v32, 4, v0
    v_lshlrev_b32 v32, 5, v32
    v_bfe_u32 v60, v0, 1, 1
    v_lshl_add_u32 v32, v60, 4, v32
    v_and_b32 v60, 1, v0
    v_mul_u32_u24 v60, 192, v60
    v_add_u32 v32, v60, v32
    v_add_u32 v32, 160832, v32
    v_lshrrev_b32 v33, 4, v0
    v_lshlrev_b32 v33, 4, v33
    v_bfe_u32 v60, v0, 1, 1
    v_lshl_add_u32 v33, v60, 3, v33
    v_and_b32 v60, 1, v0
    v_mul_u32_u24 v60, 192, v60
    v_add_u32 v33, v60, v33
    v_add_u32 v33, 160960, v33
    v_mov_b64 v[24:25], 0
    v_mov_b64 v[26:27], 0
    v_mov_b64 v[28:29], 0
    v_mov_b64 v[30:31], 0
    s_lshr_b32 s57, s30, 1
    s_lshl_b32 s57, s57, 11
    s_and_b32 s58, s30, 1
    s_lshl_b32 s58, s58, 9
    s_add_u32 s57, s57, s58
    s_lshr_b32 s58, s54, 2
    s_lshl_b32 s58, s58, 10
    s_add_u32 s57, s57, s58
    s_and_b32 s58, s54, 3
    s_lshl_b32 s58, s58, 2
    s_add_u32 s57, s57, s58
    v_and_b32 v34, 31, v0
    v_lshlrev_b32 v34, 4, v34
    v_lshrrev_b32 v60, 5, v0
    v_lshl_add_u32 v34, v60, 30, v34
    v_add_u32 v34, s57, v34
    s_add_u32 s59, s62, 38784
    s_add_u32 s60, s62, 24960
L_skip_229:
    s_cmp_lt_u32 s30, 6
    s_barrier
    s_cbranch_scc0 L_se_228
    ds_read_b128 v[12:15], v32
    ds_read_b64 v[16:17], v33
    s_waitcnt lgkmcnt(1)
    v_smfmac_f32_16x16x64_bf16 v[24:27], v[12:15], v[36:43], v1
    v_smfmac_f32_16x16x64_bf16 v[28:31], v[12:15], v[48:55], v1
    s_waitcnt lgkmcnt(0)
    v_smfmac_f32_16x16x32_bf16 v[24:27], v[16:17], v[44:47], v1
    v_smfmac_f32_16x16x32_bf16 v[28:31], v[16:17], v[56:59], v1
    s_cmp_eq_u32 s55, 0
    s_nop 5
    v_add_f32 v12, v24, v26
    s_nop 1
    v_add_f32_dpp v12, v28, v30 quad_perm:[0,1,2,3] row_mask:0x2 bank_mask:0xf
    v_min_u32 v12, -2, v12
L_pad14:
    s_cbranch_execz L_pad18
    s_cbranch_scc1 L_gs_230
    buffer_store_dword v12, v34, s[40:43], s59 offen
L_gb_231:
L_se_228:
    s_cmp_eq_u32 s30, 7
    s_cbranch_scc0 L_done
    s_cmp_eq_u32 s31, 0
    s_cbranch_scc0 L_done
    v_lshlrev_b32 v60, 16, v4
    v_add_f32 v2, v2, v60
    v_and_b32 v60, 0xffff0000, v4
    v_add_f32 v3, v3, v60
    v_and_b32 v60, 31, v0
    v_min_u32 v60, 19, v60
    s_mul_i32 s57, s54, 160
    v_lshrrev_b32 v7, 5, v0
    v_lshlrev_b32 v7, 2, v7
    v_add_u32 v7, s57, v7
    v_lshl_add_u32 v7, v60, 3, v7
    s_add_u32 s57, s7, 393216
    s_add_u32 s58, s7, 425984
    s_add_u32 s59, s7, 458752
    s_add_u32 s60, s7, 491520
    s_add_u32 s75, s62, 25856
    v_min_u32 v9, 19, v0
    v_lshlrev_b32 v9, 2, v9
    buffer_load_dword v12, v9, s[40:43], s75 offen sc1
    s_sleep 2
L_pr_243:
    buffer_load_dword v12, v9, s[40:43], s75 offen sc1
    s_sub_u32 s56, s56, 1
    s_cbranch_scc1 L_done
L_pw_242:
    s_waitcnt vmcnt(1)
    v_cmp_eq_u32 vcc, -1, v12
    s_cbranch_vccnz L_pr_243
    buffer_load_dwordx4 v[12:15], v5, s[40:43], s57 offen sc1
    buffer_load_dwordx4 v[16:19], v5, s[40:43], s58 offen sc1
    buffer_load_dwordx4 v[20:23], v5, s[40:43], s59 offen sc1
    buffer_load_dwordx4 v[24:27], v5, s[40:43], s60 offen sc1
    s_sleep 2
L_gw_239:
    buffer_load_dwordx4 v[12:15], v5, s[40:43], s57 offen sc1
    buffer_load_dwordx4 v[16:19], v5, s[40:43], s58 offen sc1
    buffer_load_dwordx4 v[20:23], v5, s[40:43], s59 offen sc1
    buffer_load_dwordx4 v[24:27], v5, s[40:43], s60 offen sc1
    s_sub_u32 s56, s56, 1
    s_cbranch_scc1 L_done
    s_and_b32 s74, s56, 31
    s_waitcnt vmcnt(6)
    v_pk_add_f32 v[28:29], v[12:13], v[16:17]
    v_pk_add_f32 v[30:31], v[14:15], v[18:19]
    s_waitcnt vmcnt(5)
    v_pk_add_f32 v[28:29], v[28:29], v[20:21]
    v_pk_add_f32 v[30:31], v[30:31], v[22:23]
    s_waitcnt vmcnt(4)
    v_pk_add_f32 v[28:29], v[28:29], v[24:25]
    v_pk_add_f32 v[30:31], v[30:31], v[26:27]
    v_pk_add_f32 v[32:33], v[28:29], v[30:31]
    v_cmp_u_f32 vcc, v32, v33
    v_permlane32_swap_b32 v28, v30
    v_permlane32_swap_b32 v29, v31
    s_cbranch_vccnz L_gr_240
L_gk_241:
    v_pk_add_f32 v[28:29], v[28:29], v[30:31]
    v_pk_add_f32 v[28:29], v[28:29], v[2:3]
    v_cvt_pk_bf16_f32 v28, v28, v29
    global_store_dword v7, v28, s[24:25]
    s_branch L_done
L_gs_38:
    buffer_store_dword v33, v34, s[40:43], s67 offen sc1
    s_branch L_gb_39
L_gs_41:
    buffer_store_short v12, v34, s[40:43], s59 offen sc1
    s_branch L_gb_42
L_cr_56:
    s_sub_u32 s56, s56, 1
    s_cbranch_scc1 L_done
    global_load_dword v2, v3, s[26:27] sc1
    s_waitcnt vmcnt(0)
    s_branch L_cw_55
L_far_57:
    s_lshl_b32 s57, s52, 2
    s_add_u32 s57, s57, s72
    s_mov_b64 exec, 1
    buffer_store_dword v25, v0, s[40:43], s57 offen offset:128 sc1
    s_mov_b64 exec, -1
    s_branch L_fb_58
L_cr_74:
    s_sub_u32 s56, s56, 1
    s_cbranch_scc1 L_done
    buffer_load_dword v2, v24, s[40:43], s72 offen sc1
    s_branch L_cw_73
L_gs_82:
    buffer_store_dword v33, v34, s[40:43], s67 offen sc1
    s_branch L_gb_83
L_gs_85:
    buffer_store_short v12, v34, s[40:43], s59 offen sc1
    s_branch L_gb_86
L_gs_110:
    buffer_store_dword v37, v4, s[40:43], s58 offen sc1
    s_branch L_gb_111
L_cr_121:
    s_sub_u32 s56, s56, 1
L_pad15:
    s_cbranch_execz L_pad19
    s_cbranch_scc1 L_done
    global_load_dword v2, v3, s[26:27] offset:4 sc1
    s_branch L_cw_120
L_gs_131:
    buffer_store_dword v42, v3, s[40:43], s57 offen sc1
    s_branch L_gb_132
L_gs_133:
    buffer_store_dword v40, v4, s[40:43], s58 offen sc1
    s_branch L_gb_134
L_comb_0:
    s_mov_b32 s57, 0
    s_add_u32 s58, s62, 25216
    s_cmp_eq_u32 s55, 0
    s_waitcnt lgkmcnt(0)
    s_barrier
    ds_read2st64_b64 v[40:43], v2 offset0:0 offset1:4
    ds_read2st64_b64 v[44:47], v2 offset0:8 offset1:12
    ds_read2st64_b64 v[48:51], v2 offset0:16 offset1:20
    ds_read2st64_b64 v[52:55], v2 offset0:24 offset1:28
    s_waitcnt lgkmcnt(2)
    v_pk_add_f32 v[40:41], v[40:41], v[42:43]
    v_pk_add_f32 v[44:45], v[44:45], v[46:47]
    v_pk_add_f32 v[40:41], v[40:41], v[44:45]
    s_waitcnt lgkmcnt(0)
    v_pk_add_f32 v[48:49], v[48:49], v[50:51]
    v_pk_add_f32 v[52:53], v[52:53], v[54:55]
    v_pk_add_f32 v[40:41], v[40:41], v[48:49]
    v_pk_add_f32 v[40:41], v[40:41], v[52:53]
    v_cvt_pk_bf16_f32 v42, v40, v41
    v_min_u32 v40, -2, v40
    v_min_u32 v42, -2, v42
    s_cbranch_scc1 L_gs_131
    buffer_store_dword v42, v3, s[40:43], s57 offen
L_gb_132:
    s_cbranch_scc1 L_gs_133
    buffer_store_dword v40, v4, s[40:43], s58 offen
L_gb_134:
    s_branch L_comb_0b
L_gs_142:
    buffer_store_dword v0, v34, s[40:43], s74 offen sc1
    s_branch L_gb_143
L_fin_140:
    s_cmp_eq_u32 s55, 0
    s_waitcnt lgkmcnt(0)
    s_barrier
    ds_read2st64_b32 v[12:13], v32 offset0:0 offset1:1
    ds_read2st64_b32 v[14:15], v32 offset0:2 offset1:3
    ds_read2st64_b32 v[16:17], v32 offset0:4 offset1:5
    ds_read2st64_b32 v[18:19], v32 offset0:6 offset1:7
    s_waitcnt lgkmcnt(2)
    v_pk_add_f32 v[12:13], v[12:13], v[14:15]
    s_waitcnt lgkmcnt(0)
    v_pk_add_f32 v[16:17], v[16:17], v[18:19]
    v_pk_add_f32 v[12:13], v[12:13], v[16:17]
    v_add_f32 v14, v12, v13
    v_add_f32 v15, v12, v13
    s_nop 1
    v_permlane16_swap_b32 v14, v15
    v_add_f32 v12, v14, v15
    v_min_u32 v12, -2, v12
    buffer_store_dword v12, v33, s[40:43], s58 offen sc1
    s_branch L_finb_141
L_sr_146:
    buffer_load_dwordx4 v[12:15], v11, s[40:43], s58 offen offset:0 sc1
    buffer_load_dwordx4 v[16:19], v11, s[40:43], s58 offen offset:1024 sc1
    s_sub_u32 s56, s56, 1
    s_cbranch_scc1 L_done
    s_waitcnt vmcnt(0)
    s_branch L_sw_145
L_hr_150:
    s_sub_u32 s56, s56, 1
    s_cbranch_scc1 L_done
    s_and_b32 s64, s56, 15
    s_cbranch_scc1 L_ha_152
    s_waitcnt vmcnt(0)
    v_max3_u32 v21, v12, v13, v14
    v_max3_u32 v21, v21, v15, v16
    v_max3_u32 v21, v21, v17, v18
    v_max_u32 v21, v21, v19
    v_cmp_eq_u32 vcc, -1, v21
    s_cbranch_vccnz L_ha_152
    v_pk_add_f32 v[20:21], v[12:13], v[14:15]
    v_pk_add_f32 v[22:23], v[16:17], v[18:19]
    v_pk_add_f32 v[20:21], v[20:21], v[22:23]
    v_add_f32 v20, v20, v21
    v_fma_f32 v20, v20, v3, v8
    s_branch L_hk_151
L_ha_152:
    buffer_load_dwordx4 v[12:15], v11, s[40:43], s58 offen offset:0 sc1
    buffer_load_dwordx4 v[16:19], v11, s[40:43], s58 offen offset:1024 sc1
    s_waitcnt vmcnt(2)
    s_branch L_hw_149
L_xr_155:
    s_sub_u32 s56, s56, 1
    s_cbranch_scc1 L_done
    s_branch L_xw_154
L_gs_156:
    buffer_store_dword v0, v5, s[40:43], s74 offen sc1
    s_branch L_gb_157
L_gs_161:
    buffer_store_dword v12, v34, s[40:43], s60 offen sc1
L_pad16:
    s_cbranch_execz L_pad20
    s_branch L_gb_162
L_gs_163:
    buffer_store_dword v12, v34, s[40:43], s59 offen sc1
    s_branch L_gb_164
L_gr_166:
    s_cbranch_scc1 L_gw_165
    s_waitcnt vmcnt(0)
    v_max3_u32 v32, v12, v13, v14
    v_max3_u32 v32, v32, v15, v16
    v_max3_u32 v32, v32, v17, v18
    v_max3_u32 v32, v32, v19, v20
    v_max3_u32 v32, v32, v21, v22
    v_max3_u32 v32, v32, v23, v24
    v_max3_u32 v32, v32, v25, v26
    v_max_u32 v32, v32, v27
    v_cmp_eq_u32 vcc, -1, v32
    s_cbranch_vccnz L_gw_165
    v_pk_add_f32 v[28:29], v[12:13], v[16:17]
    v_pk_add_f32 v[30:31], v[14:15], v[18:19]
    v_pk_add_f32 v[28:29], v[28:29], v[20:21]
    v_pk_add_f32 v[30:31], v[30:31], v[22:23]
    v_pk_add_f32 v[28:29], v[28:29], v[24:25]
    v_pk_add_f32 v[30:31], v[30:31], v[26:27]
    s_nop 1
    v_permlane32_swap_b32 v28, v30
    v_permlane32_swap_b32 v29, v31
    s_branch L_gk_167
L_gs_170:
    buffer_store_dword v33, v34, s[40:43], s67 offen sc1
    s_branch L_gb_171
L_w7_158:
    v_and_b32 v60, 31, v0
    v_min_u32 v60, 19, v60
    s_mul_i32 s57, s54, 320
    v_lshrrev_b32 v5, 5, v0
    v_mul_u32_u24 v5, 2560, v5
    v_add_u32 v5, s57, v5
    v_lshl_add_u32 v5, v60, 4, v5
    v_and_b32 v60, 31, v0
    v_cmp_gt_u32 s[64:65], 20, v60
    v_min_u32 v60, 19, v60
    v_lshrrev_b32 v35, 5, v0
    v_lshlrev_b32 v35, 2, v35
    v_add_u32 v35, 160832, v35
    v_lshl_add_u32 v35, v60, 3, v35
    s_add_u32 s66, s62, 12288
    s_add_u32 s67, s62, 24832
    s_lshl_b32 s57, s54, 3
    v_lshrrev_b32 v34, 5, v0
    v_lshlrev_b32 v34, 2, v34
    v_add_u32 v34, s57, v34
    v_and_b32 v60, 31, v0
    v_mov_b32 v61, 0x7f000000
    v_cmp_ne_u32 vcc, 31, v60
    s_nop 1
    v_cndmask_b32 v34, v34, v61, vcc
    v_mov_b32 v61, 0x3f803f80
    s_add_u32 s57, s7, 0
    s_add_u32 s58, s7, 32768
    s_add_u32 s59, s7, 65536
    s_add_u32 s60, s7, 98304
    s_add_u32 s75, s62, 25600
    v_min_u32 v9, 19, v0
    v_lshlrev_b32 v9, 2, v9
    buffer_load_dword v12, v9, s[40:43], s75 offen sc1
    s_sleep 2
L_pr_169:
    buffer_load_dword v12, v9, s[40:43], s75 offen sc1
    s_sub_u32 s56, s56, 1
    s_cbranch_scc1 L_done
L_pw_168:
    s_waitcnt vmcnt(1)
    v_cmp_eq_u32 vcc, -1, v12
    s_cbranch_vccnz L_pr_169
    buffer_load_dwordx4 v[12:15], v5, s[40:43], s57 offen sc1
    buffer_load_dwordx4 v[16:19], v5, s[40:43], s58 offen sc1
    buffer_load_dwordx4 v[20:23], v5, s[40:43], s59 offen sc1
    buffer_load_dwordx4 v[24:27], v5, s[40:43], s60 offen sc1
    s_sleep 2
L_gw_165:
    buffer_load_dwordx4 v[12:15], v5, s[40:43], s57 offen sc1
    buffer_load_dwordx4 v[16:19], v5, s[40:43], s58 offen sc1
    buffer_load_dwordx4 v[20:23], v5, s[40:43], s59 offen sc1
    buffer_load_dwordx4 v[24:27], v5, s[40:43], s60 offen sc1
    s_sub_u32 s56, s56, 1
    s_cbranch_scc1 L_done
    s_and_b32 s74, s56, 31
    s_waitcnt vmcnt(6)
    v_pk_add_f32 v[28:29], v[12:13], v[16:17]
    v_pk_add_f32 v[30:31], v[14:15], v[18:19]
    s_waitcnt vmcnt(5)
    v_pk_add_f32 v[28:29], v[28:29], v[20:21]
L_pad17:
    s_cbranch_execz L_pad21
    v_pk_add_f32 v[30:31], v[30:31], v[22:23]
    s_waitcnt vmcnt(4)
    v_pk_add_f32 v[28:29], v[28:29], v[24:25]
    v_pk_add_f32 v[30:31], v[30:31], v[26:27]
    v_pk_add_f32 v[32:33], v[28:29], v[30:31]
    v_cmp_u_f32 vcc, v32, v33
    v_permlane32_swap_b32 v28, v30
    v_permlane32_swap_b32 v29, v31
    s_cbranch_vccnz L_gr_166
L_gk_167:
    v_pk_add_f32 v[28:29], v[28:29], v[30:31]
    v_pk_add_f32 v[28:29], v[28:29], v[2:3]
    v_cvt_pk_bf16_f32 v28, v28, v29
    ds_write_b32 v35, v28
    s_waitcnt lgkmcnt(0)
    s_barrier
    v_cndmask_b32 v29, 0, v28, s[64:65]
    v_dot2_f32_bf16 v33, v29, v61, 0
    v_dot2_f32_bf16 v62, v29, v29, 0
    v_lshlrev_b32 v2, 16, v28
    v_and_b32 v3, 0xffff0000, v28
    s_cmp_eq_u32 s55, 0
    v_permlane32_swap_b32 v33, v62
    v_add_f32 v33, v33, v62
    s_nop 1
    v_add_f32_dpp v33, v33, v33 row_ror:8 row_mask:0xf bank_mask:0xf
    s_nop 1
    v_add_f32_dpp v33, v33, v33 row_ror:4 row_mask:0xf bank_mask:0xf
    s_nop 1
    v_add_f32_dpp v33, v33, v33 row_ror:2 row_mask:0xf bank_mask:0xf
    s_nop 1
    v_add_f32_dpp v33, v33, v33 row_ror:1 row_mask:0xf bank_mask:0xf
    s_nop 1
    v_add_f32_dpp v33, v33, v33 row_bcast:15 row_mask:0xa bank_mask:0xf
    v_min_u32 v33, -2, v33
    s_cbranch_scc1 L_gs_170
    buffer_store_dword v33, v34, s[40:43], s67 offen
L_gb_171:
    s_waitcnt vmcnt(1)
    s_branch L_se_159
L_gs_175:
    buffer_store_short v12, v34, s[40:43], s59 offen sc1
    s_branch L_gb_176
L_gr_181:
    s_cbranch_scc1 L_gw_180
    s_waitcnt vmcnt(0)
    v_max3_u32 v32, v12, v13, v14
    v_max3_u32 v32, v32, v15, v16
    v_max3_u32 v32, v32, v17, v18
    v_max3_u32 v32, v32, v19, v20
    v_max3_u32 v32, v32, v21, v22
    v_max3_u32 v32, v32, v23, v24
    v_max3_u32 v32, v32, v25, v26
    v_max_u32 v32, v32, v27
    v_cmp_eq_u32 vcc, -1, v32
    s_cbranch_vccnz L_gw_180
    v_pk_add_f32 v[28:29], v[12:13], v[16:17]
    v_pk_add_f32 v[30:31], v[14:15], v[18:19]
    v_pk_add_f32 v[28:29], v[28:29], v[20:21]
    v_pk_add_f32 v[30:31], v[30:31], v[22:23]
    v_pk_add_f32 v[28:29], v[28:29], v[24:25]
    v_pk_add_f32 v[30:31], v[30:31], v[26:27]
    s_nop 1
    v_permlane32_swap_b32 v28, v30
    v_permlane32_swap_b32 v29, v31
    s_branch L_gk_182
L_gr_184:
    s_cbranch_scc1 L_gw_183
    s_waitcnt vmcnt(0)
    v_max3_u32 v32, v12, v13, v14
    v_max3_u32 v32, v32, v15, v16
    v_max3_u32 v32, v32, v17, v18
    v_max3_u32 v32, v32, v19, v20
    v_max3_u32 v32, v32, v21, v22
    v_max3_u32 v32, v32, v23, v24
    v_max3_u32 v32, v32, v25, v26
    v_max_u32 v32, v32, v27
    v_cmp_eq_u32 vcc, -1, v32
    s_cbranch_vccnz L_gw_183
    v_pk_add_f32 v[28:29], v[12:13], v[16:17]
    v_pk_add_f32 v[30:31], v[14:15], v[18:19]
    v_pk_add_f32 v[28:29], v[28:29], v[20:21]
    v_pk_add_f32 v[30:31], v[30:31], v[22:23]
    v_pk_add_f32 v[28:29], v[28:29], v[24:25]
    v_pk_add_f32 v[30:31], v[30:31], v[26:27]
    s_nop 1
L_pad18:
    s_cbranch_execz L_pad22
    v_permlane32_swap_b32 v28, v30
    v_permlane32_swap_b32 v29, v31
    s_branch L_gk_185
L_gs_188:
    buffer_store_dword v33, v34, s[40:43], s67 offen sc1
    s_branch L_gb_189
L_w7_172:
    v_and_b32 v60, 31, v0
    v_min_u32 v60, 19, v60
    s_mul_i32 s57, s54, 320
    v_lshrrev_b32 v5, 5, v0
    v_mul_u32_u24 v5, 2560, v5
    v_add_u32 v5, s57, v5
    v_lshl_add_u32 v5, v60, 4, v5
    v_and_b32 v60, 31, v0
    v_cmp_gt_u32 s[64:65], 20, v60
    v_min_u32 v60, 19, v60
    v_lshrrev_b32 v35, 5, v0
    v_lshlrev_b32 v35, 2, v35
    v_add_u32 v35, 160832, v35
    v_lshl_add_u32 v35, v60, 3, v35
    s_mul_i32 s66, s53, 3072
    s_add_u32 s66, s66, s62
    s_add_u32 s66, s66, 44928
    s_lshl_b32 s67, s53, 6
    s_add_u32 s67, s67, s62
    s_add_u32 s67, s67, 24576
    s_lshl_b32 s57, s54, 3
    v_lshrrev_b32 v34, 5, v0
    v_lshlrev_b32 v34, 2, v34
    v_add_u32 v34, s57, v34
    v_and_b32 v60, 31, v0
    v_mov_b32 v61, 0x7f000000
    v_cmp_ne_u32 vcc, 31, v60
    s_nop 1
    v_cndmask_b32 v34, v34, v61, vcc
    v_mov_b32 v61, 0x3f803f80
    s_cmp_lg_u32 s53, 3
    s_cbranch_scc0 L_skip_177
    s_add_u32 s57, s62, 24832
    v_mov_b32 v9, 0
L_pr_179:
    buffer_load_dword v12, v9, s[40:43], s57 offen sc1
    s_sub_u32 s56, s56, 1
    s_cbranch_scc1 L_done
L_pw_178:
    s_waitcnt vmcnt(0)
    v_cmp_eq_u32 vcc, -1, v12
    s_cbranch_vccnz L_pr_179
    s_add_u32 s57, s7, 0
    s_add_u32 s58, s7, 32768
    s_add_u32 s59, s7, 65536
    s_add_u32 s60, s7, 98304
L_gw_180:
    buffer_load_dwordx4 v[12:15], v5, s[40:43], s57 offen sc1
    buffer_load_dwordx4 v[16:19], v5, s[40:43], s58 offen sc1
    buffer_load_dwordx4 v[20:23], v5, s[40:43], s59 offen sc1
    buffer_load_dwordx4 v[24:27], v5, s[40:43], s60 offen sc1
    s_sub_u32 s56, s56, 1
    s_cbranch_scc1 L_done
    s_and_b32 s74, s56, 31
    s_waitcnt vmcnt(2)
    v_pk_add_f32 v[28:29], v[12:13], v[16:17]
    v_pk_add_f32 v[30:31], v[14:15], v[18:19]
    s_waitcnt vmcnt(1)
    v_pk_add_f32 v[28:29], v[28:29], v[20:21]
    v_pk_add_f32 v[30:31], v[30:31], v[22:23]
    s_waitcnt vmcnt(0)
    v_pk_add_f32 v[28:29], v[28:29], v[24:25]
    v_pk_add_f32 v[30:31], v[30:31], v[26:27]
    v_pk_add_f32 v[32:33], v[28:29], v[30:31]
    v_cmp_u_f32 vcc, v32, v33
    v_permlane32_swap_b32 v28, v30
    v_permlane32_swap_b32 v29, v31
    s_cbranch_vccnz L_gr_181
L_gk_182:
    v_pk_add_f32 v[28:29], v[28:29], v[30:31]
    v_pk_add_f32 v[28:29], v[28:29], v[2:3]
    v_cvt_pk_bf16_f32 v28, v28, v29
    v_lshlrev_b32 v2, 16, v28
    v_and_b32 v3, 0xffff0000, v28
L_skip_177:
    v_lshlrev_b32 v60, 16, v4
    v_add_f32 v2, v2, v60
    v_and_b32 v60, 0xffff0000, v4
    v_add_f32 v3, v3, v60
    s_add_u32 s57, s7, 131072
    s_add_u32 s58, s7, 163840
    s_add_u32 s59, s7, 196608
    s_add_u32 s60, s7, 229376
    s_add_u32 s75, s62, 25984
    s_lshl_b32 s74, s53, 7
    s_add_u32 s75, s75, s74
    v_min_u32 v9, 19, v0
    v_lshlrev_b32 v9, 2, v9
    buffer_load_dword v12, v9, s[40:43], s75 offen sc1
L_pad19:
    s_cbranch_execz L_pad23
    s_sleep 2
L_pr_187:
    buffer_load_dword v12, v9, s[40:43], s75 offen sc1
    s_sub_u32 s56, s56, 1
    s_cbranch_scc1 L_done
L_pw_186:
    s_waitcnt vmcnt(1)
    v_cmp_eq_u32 vcc, -1, v12
    s_cbranch_vccnz L_pr_187
    buffer_load_dwordx4 v[12:15], v5, s[40:43], s57 offen sc1
    buffer_load_dwordx4 v[16:19], v5, s[40:43], s58 offen sc1
    buffer_load_dwordx4 v[20:23], v5, s[40:43], s59 offen sc1
    buffer_load_dwordx4 v[24:27], v5, s[40:43], s60 offen sc1
    s_sleep 2
L_gw_183:
    buffer_load_dwordx4 v[12:15], v5, s[40:43], s57 offen sc1
    buffer_load_dwordx4 v[16:19], v5, s[40:43], s58 offen sc1
    buffer_load_dwordx4 v[20:23], v5, s[40:43], s59 offen sc1
    buffer_load_dwordx4 v[24:27], v5, s[40:43], s60 offen sc1
    s_sub_u32 s56, s56, 1
    s_cbranch_scc1 L_done
    s_and_b32 s74, s56, 31
    s_waitcnt vmcnt(6)
    v_pk_add_f32 v[28:29], v[12:13], v[16:17]
    v_pk_add_f32 v[30:31], v[14:15], v[18:19]
    s_waitcnt vmcnt(5)
    v_pk_add_f32 v[28:29], v[28:29], v[20:21]
    v_pk_add_f32 v[30:31], v[30:31], v[22:23]
    s_waitcnt vmcnt(4)
    v_pk_add_f32 v[28:29], v[28:29], v[24:25]
    v_pk_add_f32 v[30:31], v[30:31], v[26:27]
    v_pk_add_f32 v[32:33], v[28:29], v[30:31]
    v_cmp_u_f32 vcc, v32, v33
    v_permlane32_swap_b32 v28, v30
    v_permlane32_swap_b32 v29, v31
    s_cbranch_vccnz L_gr_184
L_gk_185:
    v_pk_add_f32 v[28:29], v[28:29], v[30:31]
    v_pk_add_f32 v[28:29], v[28:29], v[2:3]
    v_cvt_pk_bf16_f32 v28, v28, v29
    ds_write_b32 v35, v28
    s_waitcnt lgkmcnt(0)
    s_barrier
    v_cndmask_b32 v29, 0, v28, s[64:65]
    v_dot2_f32_bf16 v33, v29, v61, 0
    v_dot2_f32_bf16 v62, v29, v29, 0
    v_lshlrev_b32 v2, 16, v28
    v_and_b32 v3, 0xffff0000, v28
    s_cmp_eq_u32 s55, 0
    v_permlane32_swap_b32 v33, v62
    v_add_f32 v33, v33, v62
    s_nop 1
    v_add_f32_dpp v33, v33, v33 row_ror:8 row_mask:0xf bank_mask:0xf
    s_nop 1
    v_add_f32_dpp v33, v33, v33 row_ror:4 row_mask:0xf bank_mask:0xf
    s_nop 1
    v_add_f32_dpp v33, v33, v33 row_ror:2 row_mask:0xf bank_mask:0xf
    s_nop 1
    v_add_f32_dpp v33, v33, v33 row_ror:1 row_mask:0xf bank_mask:0xf
    s_nop 1
    v_add_f32_dpp v33, v33, v33 row_bcast:15 row_mask:0xa bank_mask:0xf
    v_min_u32 v33, -2, v33
    s_cbranch_scc1 L_gs_188
    buffer_store_dword v33, v34, s[40:43], s67 offen
L_gb_189:
    s_waitcnt vmcnt(1)
    s_branch L_se_173
L_qr_193:
    s_cbranch_scc1 L_qw_192
    s_waitcnt vmcnt(0)
    v_pk_max_u16 v60, v56, v57
    v_pk_max_u16 v61, v58, v59
    v_pk_max_u16 v60, v60, v61
    v_lshlrev_b32 v61, 16, v60
    v_max_u32 v60, v60, v61
    v_cmp_le_u32 vcc, 0xffff0000, v60
    s_cbranch_vccnz L_qw_192
    v_dot2_f32_bf16 v60, v56, v10, 0
    v_dot2_f32_bf16 v61, v57, v10, 0
    v_dot2_f32_bf16 v60, v58, v10, v60
    v_dot2_f32_bf16 v61, v59, v10, v61
    s_nop 2
    v_add_f32 v60, v60, v61
    v_cvt_pk_bf16_f32 v60, v60, v60
    s_branch L_qk_194
L_qo_190:
    v_mov_b64 v[24:25], 0
    v_mov_b64 v[26:27], 0
    v_mov_b64 v[28:29], 0
    v_mov_b64 v[30:31], 0
    v_mov_b64 v[32:33], 0
    v_mov_b64 v[34:35], 0
    v_mov_b64 v[36:37], 0
    v_mov_b64 v[38:39], 0
L_pad20:
    s_cbranch_execz L_padback
    v_mov_b64 v[40:41], 0
    v_mov_b64 v[42:43], 0
    v_mov_b64 v[44:45], 0
    v_mov_b64 v[46:47], 0
    s_lshl_b32 s57, s30, 7
    s_add_u32 s57, s57, 158720
    v_lshrrev_b32 v54, 4, v0
    v_lshlrev_b32 v54, 5, v54
    v_bfe_u32 v60, v0, 1, 1
    v_lshl_add_u32 v54, v60, 4, v54
    v_bfe_u32 v60, v0, 2, 2
    v_lshl_add_u32 v54, v60, 2, v54
    v_and_b32 v60, 1, v0
    v_lshl_add_u32 v54, v60, 1, v54
    v_add_u32 v54, s57, v54
    v_lshrrev_b32 v61, 4, v0
    v_lshlrev_b32 v61, 5, v61
    v_bfe_u32 v60, v0, 1, 1
    v_lshl_add_u32 v61, v60, 4, v61
    v_add_u32 v61, s57, v61
    v_bfe_u32 v62, v0, 2, 2
    v_lshlrev_b32 v62, 1, v62
    v_and_b32 v60, 1, v0
    v_lshl_add_u32 v62, v60, 0, v62
    v_mov_b32 v60, 160992
    v_cmp_eq_u32 vcc, 0, v62
    s_nop 1
    v_cndmask_b32 v48, v60, v61, vcc
    v_cmp_eq_u32 vcc, 1, v62
    s_nop 1
    v_cndmask_b32 v49, v60, v61, vcc
    v_cmp_eq_u32 vcc, 2, v62
    s_nop 1
    v_cndmask_b32 v50, v60, v61, vcc
    v_cmp_eq_u32 vcc, 3, v62
    s_nop 1
    v_cndmask_b32 v51, v60, v61, vcc
    v_cmp_eq_u32 vcc, 4, v62
    s_nop 1
    v_cndmask_b32 v52, v60, v61, vcc
    v_cmp_eq_u32 vcc, 5, v62
    s_nop 1
    v_cndmask_b32 v53, v60, v61, vcc
    s_lshl_b32 s58, s30, 2
    s_add_u32 s58, s58, 159808
    v_mov_b32 v60, s58
    v_lshlrev_b32 v55, 2, v0
    v_add_u32 v55, 157696, v55
    v_cmp_eq_u32 vcc, 63, v0
    s_nop 1
    v_cndmask_b32 v55, v55, v60, vcc
    v_and_b32 v62, 7, v0
    v_lshlrev_b32 v62, 2, v62
    v_add_u32 v62, 159808, v62
    s_lshl_b32 s57, s30, 11
    v_lshlrev_b32 v63, 4, v0
    v_add_u32 v63, s57, v63
    v_add_u32 v63, 92160, v63
    v_lshrrev_b32 v5, 4, v0
    v_lshlrev_b32 v5, 5, v5
    v_bfe_u32 v60, v0, 1, 1
    v_lshl_add_u32 v5, v60, 4, v5
    v_add_u32 v5, 124928, v5
    v_mov_b32 v8, 125440
    s_cmp_eq_u32 s30, 6
    s_cbranch_scc0 L_qb_191
    v_and_b32 v16, 7, v0
    v_lshlrev_b32 v16, 3, v16
L_pr_196:
    buffer_load_dwordx2 v[10:11], v16, s[40:43], s60 offen sc1
    s_sub_u32 s56, s56, 1
    s_cbranch_scc1 L_done
L_pw_195:
    s_waitcnt vmcnt(0)
    v_max_u32 v18, v10, v11
    v_cmp_eq_u32 vcc, -1, v18
    s_cbranch_vccnz L_pr_196
    v_add_f32_dpp v10, v10, v10 row_ror:4 row_mask:0xf bank_mask:0xf
    v_add_f32_dpp v11, v11, v11 row_ror:4 row_mask:0xf bank_mask:0xf
    s_nop 0
    v_add_f32_dpp v10, v10, v10 row_ror:2 row_mask:0xf bank_mask:0xf
    v_add_f32_dpp v11, v11, v11 row_ror:2 row_mask:0xf bank_mask:0xf
    s_nop 0
    v_add_f32_dpp v10, v10, v10 row_ror:1 row_mask:0xf bank_mask:0xf
    v_add_f32_dpp v11, v11, v11 row_ror:1 row_mask:0xf bank_mask:0xf
    v_mul_f32 v10, 0x3acccccd, v10
    v_mul_f32 v11, 0x3acccccd, v11
    v_fma_f32 v11, -v10, v10, v11
    v_max_f32 v11, 0, v11
    v_add_f32 v11, 0x3727c5ac, v11
    v_rsq_f32 v11, v11
    s_nop 0
    v_mul_f32 v11, 0x3dd53b95, v11
    v_mul_f32 v10, -v10, v11
    ds_write_b64 v8, v[10:11]
    s_branch L_qb_191
L_mr_197:
L_pad21:
    s_cbranch_execz L_padback
    ds_read_b32 v36, v62
    s_sub_u32 s56, s56, 1
    s_cbranch_scc1 L_done
    s_waitcnt lgkmcnt(0)
    v_cmp_eq_u32 vcc, -1, v36
    s_cbranch_vccnz L_mr_197
    v_max_f32_dpp v37, v36, v36 row_ror:4 row_mask:0xf bank_mask:0xf
    s_nop 1
    v_max_f32_dpp v37, v37, v37 row_ror:2 row_mask:0xf bank_mask:0xf
    s_nop 1
    v_max_f32_dpp v37, v37, v37 row_ror:1 row_mask:0xf bank_mask:0xf
    v_sub_f32 v39, s64, v37
    v_exp_f32 v39, v39
    s_branch L_mk_198
L_gs_199:
    buffer_store_dword v37, v4, s[40:43], s58 offen sc1
    s_branch L_gb_200
L_gs_201:
    buffer_store_dword v42, v3, s[40:43], s57 offen sc1
    s_branch L_gb_202
L_gs_203:
    buffer_store_dword v40, v4, s[40:43], s58 offen sc1
    s_branch L_gb_204
L_comb_1:
    s_add_u32 s58, s62, 25344
    v_min_u32 v37, -2, v37
    s_cmp_eq_u32 s55, 0
    s_cbranch_scc1 L_gs_199
    buffer_store_dword v37, v4, s[40:43], s58 offen
L_gb_200:
    s_mov_b32 s57, 26496
    s_add_u32 s58, s62, 25472
    s_cmp_eq_u32 s55, 0
    s_waitcnt lgkmcnt(0)
    s_barrier
    ds_read2st64_b64 v[40:43], v2 offset0:0 offset1:4
    ds_read2st64_b64 v[44:47], v2 offset0:8 offset1:12
    ds_read2st64_b64 v[48:51], v2 offset0:16 offset1:20
    ds_read2st64_b64 v[52:55], v2 offset0:24 offset1:28
    s_waitcnt lgkmcnt(2)
    v_pk_add_f32 v[40:41], v[40:41], v[42:43]
    v_pk_add_f32 v[44:45], v[44:45], v[46:47]
    v_pk_add_f32 v[40:41], v[40:41], v[44:45]
    s_waitcnt lgkmcnt(0)
    v_pk_add_f32 v[48:49], v[48:49], v[50:51]
    v_pk_add_f32 v[52:53], v[52:53], v[54:55]
    v_pk_add_f32 v[40:41], v[40:41], v[48:49]
    v_pk_add_f32 v[40:41], v[40:41], v[52:53]
    v_cvt_pk_bf16_f32 v42, v40, v41
    v_min_u32 v40, -2, v40
    v_min_u32 v42, -2, v42
    s_cbranch_scc1 L_gs_201
    buffer_store_dword v42, v3, s[40:43], s57 offen
L_gb_202:
    s_cbranch_scc1 L_gs_203
    buffer_store_dword v40, v4, s[40:43], s58 offen
L_gb_204:
    s_branch L_comb_1b
L_gs_211:
    buffer_store_dword v0, v34, s[40:43], s74 offen sc1
    s_branch L_gb_212
L_fin_209:
    s_cmp_eq_u32 s55, 0
    s_waitcnt lgkmcnt(0)
    s_barrier
    ds_read2st64_b32 v[12:13], v32 offset0:0 offset1:1
    ds_read2st64_b32 v[14:15], v32 offset0:2 offset1:3
    ds_read2st64_b32 v[16:17], v32 offset0:4 offset1:5
    ds_read2st64_b32 v[18:19], v32 offset0:6 offset1:7
    s_waitcnt lgkmcnt(2)
    v_pk_add_f32 v[12:13], v[12:13], v[14:15]
    s_waitcnt lgkmcnt(0)
    v_pk_add_f32 v[16:17], v[16:17], v[18:19]
    v_pk_add_f32 v[12:13], v[12:13], v[16:17]
    v_add_f32 v14, v12, v13
    v_add_f32 v15, v12, v13
    s_nop 1
    v_permlane16_swap_b32 v14, v15
    v_add_f32 v12, v14, v15
    v_min_u32 v12, -2, v12
    buffer_store_dword v12, v33, s[40:43], s58 offen sc1
    s_cbranch_scc1 L_gs_211
    buffer_store_dword v0, v34, s[40:43], s74 offen
L_gb_212:
    s_branch L_finb_210
L_sr_215:
    buffer_load_dwordx4 v[12:15], v11, s[40:43], s58 offen offset:0 sc1
    buffer_load_dwordx4 v[16:19], v11, s[40:43], s58 offen offset:1024 sc1
    s_sub_u32 s56, s56, 1
    s_cbranch_scc1 L_done
    s_waitcnt vmcnt(0)
    s_branch L_sw_214
L_hr_219:
    s_sub_u32 s56, s56, 1
    s_cbranch_scc1 L_done
    s_and_b32 s64, s56, 15
    s_cbranch_scc1 L_ha_221
    s_waitcnt vmcnt(0)
    v_max3_u32 v21, v12, v13, v14
    v_max3_u32 v21, v21, v15, v16
L_pad22:
    s_cbranch_execz L_padback
    v_max3_u32 v21, v21, v17, v18
    v_max_u32 v21, v21, v19
    v_cmp_eq_u32 vcc, -1, v21
    s_cbranch_vccnz L_ha_221
    v_pk_add_f32 v[20:21], v[12:13], v[14:15]
    v_pk_add_f32 v[22:23], v[16:17], v[18:19]
    v_pk_add_f32 v[20:21], v[20:21], v[22:23]
    v_add_f32 v20, v20, v21
    v_fma_f32 v20, v20, v3, v8
    s_branch L_hk_220
L_ha_221:
    buffer_load_dwordx4 v[12:15], v11, s[40:43], s58 offen offset:0 sc1
    buffer_load_dwordx4 v[16:19], v11, s[40:43], s58 offen offset:1024 sc1
    s_waitcnt vmcnt(2)
    s_branch L_hw_218
L_xr_224:
    s_sub_u32 s56, s56, 1
    s_cbranch_scc1 L_done
    s_branch L_xw_223
L_gs_225:
    buffer_store_dword v0, v5, s[40:43], s74 offen sc1
    s_branch L_gb_226
L_gs_230:
    buffer_store_dword v12, v34, s[40:43], s59 offen sc1
    s_branch L_gb_231
L_gr_233:
    s_cbranch_scc1 L_gw_232
    s_waitcnt vmcnt(0)
    v_max3_u32 v32, v12, v13, v14
    v_max3_u32 v32, v32, v15, v16
    v_max3_u32 v32, v32, v17, v18
    v_max3_u32 v32, v32, v19, v20
    v_max3_u32 v32, v32, v21, v22
    v_max3_u32 v32, v32, v23, v24
    v_max3_u32 v32, v32, v25, v26
    v_max_u32 v32, v32, v27
    v_cmp_eq_u32 vcc, -1, v32
    s_cbranch_vccnz L_gw_232
    v_pk_add_f32 v[28:29], v[12:13], v[16:17]
    v_pk_add_f32 v[30:31], v[14:15], v[18:19]
    v_pk_add_f32 v[28:29], v[28:29], v[20:21]
    v_pk_add_f32 v[30:31], v[30:31], v[22:23]
    v_pk_add_f32 v[28:29], v[28:29], v[24:25]
    v_pk_add_f32 v[30:31], v[30:31], v[26:27]
    s_nop 1
    v_permlane32_swap_b32 v28, v30
    v_permlane32_swap_b32 v29, v31
    s_branch L_gk_234
L_gs_237:
    buffer_store_dword v33, v34, s[40:43], s67 offen sc1
    s_branch L_gb_238
L_w7_227:
    v_and_b32 v60, 31, v0
    v_min_u32 v60, 19, v60
    s_mul_i32 s57, s54, 320
    v_lshrrev_b32 v5, 5, v0
    v_mul_u32_u24 v5, 2560, v5
    v_add_u32 v5, s57, v5
    v_lshl_add_u32 v5, v60, 4, v5
    v_and_b32 v60, 31, v0
    v_cmp_gt_u32 s[64:65], 20, v60
    v_min_u32 v60, 19, v60
    v_lshrrev_b32 v35, 5, v0
    v_lshlrev_b32 v35, 2, v35
    v_add_u32 v35, 160832, v35
    v_lshl_add_u32 v35, v60, 3, v35
    s_add_u32 s66, s62, 38784
    s_add_u32 s67, s62, 24960
    s_lshl_b32 s57, s54, 3
    v_lshrrev_b32 v34, 5, v0
    v_lshlrev_b32 v34, 2, v34
    v_add_u32 v34, s57, v34
    v_and_b32 v60, 31, v0
    v_mov_b32 v61, 0x7f000000
    v_cmp_ne_u32 vcc, 31, v60
    s_nop 1
    v_cndmask_b32 v34, v34, v61, vcc
    v_mov_b32 v61, 0x3f803f80
    s_add_u32 s57, s7, 262144
    s_add_u32 s58, s7, 294912
    s_add_u32 s59, s7, 327680
    s_add_u32 s60, s7, 360448
    s_add_u32 s75, s62, 25728
    v_min_u32 v9, 19, v0
    v_lshlrev_b32 v9, 2, v9
    buffer_load_dword v12, v9, s[40:43], s75 offen sc1
    s_sleep 2
L_pr_236:
    buffer_load_dword v12, v9, s[40:43], s75 offen sc1
    s_sub_u32 s56, s56, 1
    s_cbranch_scc1 L_done
L_pw_235:
    s_waitcnt vmcnt(1)
    v_cmp_eq_u32 vcc, -1, v12
    s_cbranch_vccnz L_pr_236
    buffer_load_dwordx4 v[12:15], v5, s[40:43], s57 offen sc1
L_pad23:
    s_cbranch_execz L_padback
    buffer_load_dwordx4 v[16:19], v5, s[40:43], s58 offen sc1
    buffer_load_dwordx4 v[20:23], v5, s[40:43], s59 offen sc1
    buffer_load_dwordx4 v[24:27], v5, s[40:43], s60 offen sc1
    s_sleep 2
L_gw_232:
    buffer_load_dwordx4 v[12:15], v5, s[40:43], s57 offen sc1
    buffer_load_dwordx4 v[16:19], v5, s[40:43], s58 offen sc1
    buffer_load_dwordx4 v[20:23], v5, s[40:43], s59 offen sc1
    buffer_load_dwordx4 v[24:27], v5, s[40:43], s60 offen sc1
    s_sub_u32 s56, s56, 1
    s_cbranch_scc1 L_done
    s_and_b32 s74, s56, 31
    s_waitcnt vmcnt(6)
    v_pk_add_f32 v[28:29], v[12:13], v[16:17]
    v_pk_add_f32 v[30:31], v[14:15], v[18:19]
    s_waitcnt vmcnt(5)
    v_pk_add_f32 v[28:29], v[28:29], v[20:21]
    v_pk_add_f32 v[30:31], v[30:31], v[22:23]
    s_waitcnt vmcnt(4)
    v_pk_add_f32 v[28:29], v[28:29], v[24:25]
    v_pk_add_f32 v[30:31], v[30:31], v[26:27]
    v_pk_add_f32 v[32:33], v[28:29], v[30:31]
    v_cmp_u_f32 vcc, v32, v33
    v_permlane32_swap_b32 v28, v30
    v_permlane32_swap_b32 v29, v31
    s_cbranch_vccnz L_gr_233
L_gk_234:
    v_pk_add_f32 v[28:29], v[28:29], v[30:31]
    v_pk_add_f32 v[28:29], v[28:29], v[2:3]
    v_cvt_pk_bf16_f32 v28, v28, v29
    ds_write_b32 v35, v28
    s_waitcnt lgkmcnt(0)
    s_barrier
    v_cndmask_b32 v29, 0, v28, s[64:65]
    v_dot2_f32_bf16 v33, v29, v61, 0
    v_dot2_f32_bf16 v62, v29, v29, 0
    v_lshlrev_b32 v2, 16, v28
    v_and_b32 v3, 0xffff0000, v28
    s_cmp_eq_u32 s55, 0
    v_permlane32_swap_b32 v33, v62
    v_add_f32 v33, v33, v62
    s_nop 1
    v_add_f32_dpp v33, v33, v33 row_ror:8 row_mask:0xf bank_mask:0xf
    s_nop 1
    v_add_f32_dpp v33, v33, v33 row_ror:4 row_mask:0xf bank_mask:0xf
    s_nop 1
    v_add_f32_dpp v33, v33, v33 row_ror:2 row_mask:0xf bank_mask:0xf
    s_nop 1
    v_add_f32_dpp v33, v33, v33 row_ror:1 row_mask:0xf bank_mask:0xf
    s_nop 1
    v_add_f32_dpp v33, v33, v33 row_bcast:15 row_mask:0xa bank_mask:0xf
    v_min_u32 v33, -2, v33
    s_cbranch_scc1 L_gs_237
    buffer_store_dword v33, v34, s[40:43], s67 offen
L_gb_238:
    s_waitcnt vmcnt(1)
    s_branch L_se_228
L_gr_240:
    s_cbranch_scc1 L_gw_239
    s_waitcnt vmcnt(0)
    v_max3_u32 v32, v12, v13, v14
    v_max3_u32 v32, v32, v15, v16
    v_max3_u32 v32, v32, v17, v18
    v_max3_u32 v32, v32, v19, v20
    v_max3_u32 v32, v32, v21, v22
    v_max3_u32 v32, v32, v23, v24
    v_max3_u32 v32, v32, v25, v26
    v_max_u32 v32, v32, v27
    v_cmp_eq_u32 vcc, -1, v32
    s_cbranch_vccnz L_gw_239
    v_pk_add_f32 v[28:29], v[12:13], v[16:17]
    v_pk_add_f32 v[30:31], v[14:15], v[18:19]
    v_pk_add_f32 v[28:29], v[28:29], v[20:21]
    v_pk_add_f32 v[30:31], v[30:31], v[22:23]
    v_pk_add_f32 v[28:29], v[28:29], v[24:25]
    v_pk_add_f32 v[30:31], v[30:31], v[26:27]
    s_nop 1
    v_permlane32_swap_b32 v28, v30
    v_permlane32_swap_b32 v29, v31
    s_branch L_gk_241
L_tail_end:
L_spread:
    s_add_u32 s62, s62, 671744
    s_cmp_eq_u32 s30, 5
    s_cbranch_scc0 L_skip_79
    v_mov_b64 v[12:13], -1
    v_mov_b64 v[14:15], -1
    v_lshlrev_b32 v16, 4, v0
    s_mul_i32 s57, s52, 1792
    s_add_u32 s57, s57, s62
    s_mov_b32 exec_lo, 0xffffffff
    s_mov_b32 exec_hi, 0xffff
    buffer_store_dwordx4 v[12:15], v16, s[40:43], s57 offen offset:1024 sc1
    s_mov_b64 exec, -1
    buffer_store_dwordx4 v[12:15], v16, s[40:43], s57 offen sc1
L_skip_79:
    s_cmp_eq_u32 s30, 7
    s_cbranch_scc0 L_skip_80
    v_and_b32 v60, 31, v0
    v_cmp_gt_u32 s[64:65], 20, v60
    v_min_u32 v60, 19, v60
    v_lshrrev_b32 v35, 5, v0
    v_lshlrev_b32 v35, 2, v35
    v_add_u32 v35, 160832, v35
    v_lshl_add_u32 v35, v60, 3, v35
    s_mul_i32 s66, s53, 6400
    s_add_u32 s66, s66, s62
    s_add_u32 s66, s66, 57344
    s_add_u32 s67, s66, 6144
    s_lshl_b32 s57, s54, 3
    v_lshrrev_b32 v34, 5, v0
    v_lshlrev_b32 v34, 2, v34
    v_add_u32 v34, s57, v34
    v_and_b32 v60, 31, v0
    v_mov_b32 v61, 0x7f000000
    v_cmp_ne_u32 vcc, 31, v60
    s_nop 1
    v_cndmask_b32 v34, v34, v61, vcc
    v_mov_b32 v61, 0x3f803f80
    v_cvt_pk_bf16_f32 v28, v2, v3
L_skip_80:
    s_cmp_eq_u32 s30, 7
    s_cbranch_scc0 L_skip_81
    v_cndmask_b32 v29, 0, v28, s[64:65]
    v_dot2_f32_bf16 v33, v29, v61, 0
    v_dot2_f32_bf16 v62, v29, v29, 0
    v_lshlrev_b32 v2, 16, v28
    v_and_b32 v3, 0xffff0000, v28
    s_cmp_eq_u32 s55, 0
    v_permlane32_swap_b32 v33, v62
    v_add_f32 v33, v33, v62
    s_nop 1
    v_add_f32_dpp v33, v33, v33 row_ror:8 row_mask:0xf bank_mask:0xf
    s_nop 1
    v_add_f32_dpp v33, v33, v33 row_ror:4 row_mask:0xf bank_mask:0xf
    s_nop 1
    v_add_f32_dpp v33, v33, v33 row_ror:2 row_mask:0xf bank_mask:0xf
    s_nop 1
    v_add_f32_dpp v33, v33, v33 row_ror:1 row_mask:0xf bank_mask:0xf
    s_nop 1
    v_add_f32_dpp v33, v33, v33 row_bcast:15 row_mask:0xa bank_mask:0xf
    v_min_u32 v33, -2, v33
    s_cbranch_scc1 L_gs_82
    buffer_store_dword v33, v34, s[40:43], s67 offen
L_gb_83:
    s_waitcnt vmcnt(1)
L_skip_81:
    s_cmp_lt_u32 s30, 6
    s_cbranch_scc0 L_skip_84
    s_lshr_b32 s57, s30, 1
    s_mul_i32 s57, s57, 1024
    s_and_b32 s58, s30, 1
    s_lshl_b32 s58, s58, 6
    s_add_u32 s57, s57, s58
    v_lshrrev_b32 v18, 5, v0
    v_mul_u32_u24 v18, 6144, v18
    v_bfe_u32 v60, v0, 3, 1
    v_mul_u32_u24 v60, 3072, v60
    v_add_u32 v18, v60, v18
    v_bfe_u32 v60, v0, 4, 1
    v_lshl_add_u32 v18, v60, 9, v18
    v_bfe_u32 v60, v0, 2, 1
    v_lshl_add_u32 v18, v60, 7, v18
    v_and_b32 v60, 3, v0
    v_lshl_add_u32 v18, v60, 3, v18
    v_add_u32 v18, s57, v18
    v_bfe_u32 v19, v0, 4, 1
    v_mul_u32_u24 v19, 3072, v19
    v_bfe_u32 v60, v0, 3, 1
    v_lshl_add_u32 v19, v60, 9, v19
    v_bfe_u32 v60, v0, 2, 1
    v_lshl_add_u32 v19, v60, 7, v19
    v_and_b32 v60, 3, v0
    v_lshl_add_u32 v19, v60, 3, v19
    v_add_u32 v19, s57, v19
    v_add_u32 v19, 24576, v19
    ds_read_b64_tr_b16 v[36:37], v18 offset:0
    ds_read_b64_tr_b16 v[38:39], v18 offset:256
    ds_read_b64_tr_b16 v[40:41], v18 offset:12288
    ds_read_b64_tr_b16 v[42:43], v18 offset:12544
    ds_read_b64_tr_b16 v[44:45], v19 offset:0
    ds_read_b64_tr_b16 v[46:47], v19 offset:256
    ds_read_b64_tr_b16 v[48:49], v18 offset:32
    ds_read_b64_tr_b16 v[50:51], v18 offset:288
    ds_read_b64_tr_b16 v[52:53], v18 offset:12320
    ds_read_b64_tr_b16 v[54:55], v18 offset:12576
    ds_read_b64_tr_b16 v[56:57], v19 offset:32
    ds_read_b64_tr_b16 v[58:59], v19 offset:288
    v_lshrrev_b32 v32, 4, v0
    v_lshlrev_b32 v32, 5, v32
    v_bfe_u32 v60, v0, 1, 1
    v_lshl_add_u32 v32, v60, 4, v32
    v_and_b32 v60, 1, v0
    v_mul_u32_u24 v60, 192, v60
    v_add_u32 v32, v60, v32
    v_add_u32 v32, 160832, v32
    v_lshrrev_b32 v33, 4, v0
    v_lshlrev_b32 v33, 4, v33
    v_bfe_u32 v60, v0, 1, 1
    v_lshl_add_u32 v33, v60, 3, v33
    v_and_b32 v60, 1, v0
    v_mul_u32_u24 v60, 192, v60
    v_add_u32 v33, v60, v33
    v_add_u32 v33, 160960, v33
    v_mov_b64 v[24:25], 0
    v_mov_b64 v[26:27], 0
    v_mov_b64 v[28:29], 0
    v_mov_b64 v[30:31], 0
    s_lshl_b32 s57, s54, 1
    s_lshl_b32 s58, s30, 9
    s_add_u32 s57, s57, s58
    v_and_b32 v34, 31, v0
    v_lshlrev_b32 v34, 4, v34
    v_lshrrev_b32 v60, 5, v0
    v_mul_u32_u24 v60, 3072, v60
    v_add_u32 v34, v60, v34
    v_add_u32 v34, s57, v34
    s_mul_i32 s59, s53, 6400
    s_add_u32 s59, s59, s62
    s_add_u32 s59, s59, 57344
    s_add_u32 s60, s59, 6144
    ds_read_b128 v[12:15], v32
    ds_read_b64 v[16:17], v33
    s_waitcnt lgkmcnt(1)
    v_smfmac_f32_16x16x64_bf16 v[24:27], v[12:15], v[36:43], v1
    v_smfmac_f32_16x16x64_bf16 v[28:31], v[12:15], v[48:55], v1
    s_waitcnt lgkmcnt(0)
    v_smfmac_f32_16x16x32_bf16 v[24:27], v[16:17], v[44:47], v1
    v_smfmac_f32_16x16x32_bf16 v[28:31], v[16:17], v[56:59], v1
    s_cmp_eq_u32 s55, 0
    s_nop 5
    v_add_f32 v12, v24, v26
    s_nop 1
    v_add_f32_dpp v12, v28, v30 quad_perm:[0,1,2,3] row_mask:0x2 bank_mask:0xf
    s_nop 1
    v_add_f32_dpp v12, v25, v27 quad_perm:[0,1,2,3] row_mask:0x4 bank_mask:0xf
    s_nop 1
    v_add_f32_dpp v12, v29, v31 quad_perm:[0,1,2,3] row_mask:0x8 bank_mask:0xf
    v_cvt_pk_bf16_f32 v12, v12, v12
    v_min_u32 v12, -2, v12
    s_cbranch_scc1 L_gs_85
    buffer_store_short v12, v34, s[40:43], s59 offen
L_gb_86:
L_skip_84:
    s_waitcnt vmcnt(0)
    s_barrier
    s_cmp_eq_u32 s30, 5
    s_cbranch_scc0 L_skip_87
    v_mov_b32 v25, 0
    s_lshl_b32 s57, s52, 2
    s_add_u32 s57, s57, s72
    s_mov_b64 exec, 1
    buffer_store_dword v25, v0, s[40:43], s57 offen offset:256 sc1
    s_mov_b64 exec, -1
    v_and_b32 v16, 31, v0
    v_lshlrev_b32 v16, 2, v16
L_pr_89:
    buffer_load_dword v17, v16, s[40:43], s72 offen offset:256 sc1
    s_sub_u32 s56, s56, 1
    s_cbranch_scc1 L_done
L_pw_88:
    s_waitcnt vmcnt(0)
    v_cmp_eq_u32 vcc, -1, v17
    s_cbranch_vccnz L_pr_89
L_skip_87:
    s_barrier
    s_branch L_spread_back
L_done:
L_exit:
    s_endpgm
.section .rodata,"a"
.p2align 6
.amdhsa_kernel interleave_layers__sliding_block_cached__dense_activation_gelu__decode_kernel
  .amdhsa_next_free_vgpr 256
  .amdhsa_next_free_sgpr 102
  .amdhsa_accum_offset 256
  .amdhsa_group_segment_fixed_size 0
  .amdhsa_kernarg_size 104
  .amdhsa_user_sgpr_count 2
  .amdhsa_user_sgpr_kernarg_segment_ptr 1
  .amdhsa_system_sgpr_workgroup_id_x 1
  .amdhsa_float_denorm_mode_32 3
.end_amdhsa_kernel
```

```asm
; @launch grid=(256,1,1) block=(512,1,1) lds=161216
.amdgcn_target "amdgcn-amd-amdhsa--gfx950"
.text
.fill 64, 4, 0xbf800000
.globl interleave_layers__sliding_block_cached__dense_activation_gelu__decode_kernel
.p2align 8
.type interleave_layers__sliding_block_cached__dense_activation_gelu__decode_kernel,@function
interleave_layers__sliding_block_cached__dense_activation_gelu__decode_kernel:
    s_load_dwordx16 s[4:19], s[0:1], 0
    s_load_dwordx8 s[20:27], s[0:1], 64
    s_load_dwordx2 s[28:29], s[0:1], 96
    s_cmp_ge_u32 s2, 256
    s_cbranch_scc1 L_exit
    s_getpc_b64 s[74:75]
L_pc:
    v_lshlrev_b32 v5, 6, v0
    v_min_u32 v5, L_exit-L_pc, v5
    global_load_dword v63, v5, s[74:75]
    v_lshrrev_b32 v5, 6, v0
    v_and_b32 v0, 63, v0
    v_readfirstlane_b32 s30, v5
    s_and_b32 s31, s2, 7
    s_lshr_b32 s52, s2, 3
    s_and_b32 s53, s52, 3
    s_lshr_b32 s54, s52, 2
    s_lshl_b32 s73, s31, 2
    s_add_u32 s73, s73, s53
    s_mul_i32 s3, s54, 3
    s_add_u32 s3, s3, s53
    s_cmp_eq_u32 s53, 3
    s_cselect_b32 s3, 31, s3
    s_cselect_b32 s70, 0, 0
    s_cmp_lt_u32 s3, 20
    s_cselect_b32 s70, 1, s70
    v_lshrrev_b32 v8, 5, v0
    v_lshlrev_b32 v8, 2, v8
    v_bfe_u32 v60, v0, 4, 1
    v_lshl_add_u32 v8, v60, 0, v8
    v_and_b32 v9, 7, v0
    v_xor_b32 v8, v8, v9
    v_lshrrev_b32 v10, 3, v0
    v_mul_u32_u24 v10, 384, v10
    v_lshl_add_u32 v5, v8, 4, v10
    v_xor_b32 v6, 32, v5
    v_lshrrev_b32 v8, 4, v0
    v_lshlrev_b32 v8, 1, v8
    v_xor_b32 v8, v8, v9
    v_lshl_add_u32 v7, v8, 4, v10
    v_lshrrev_b32 v2, 3, v0
    v_mul_u32_u24 v2, 12288, v2
    v_and_b32 v60, 7, v0
    v_lshl_add_u32 v2, v60, 4, v2
    s_mul_i32 s57, s73, 12582912
    s_mul_i32 s58, s54, 3072
    s_add_u32 s57, s57, s58
    s_add_u32 s57, s57, 11009024
    s_sub_u32 s58, 1573888, s58
    s_and_b32 s71, s73, 7
    s_mul_i32 s59, s73, 384
    s_mul_i32 s60, s54, 983040
    s_add_u32 s59, s59, s60
    s_sub_u32 s60, 7866368, s59
    s_lshl_b32 s61, s30, 11
    s_add_u32 s61, s61, 92160
    s_mul_i32 s62, s31, 86016
    s_lshl_b32 s72, s31, 9
    s_add_u32 s72, s72, 1933312
    s_mov_b32 s56, 65536
    s_mov_b32 s55, 1
    s_getreg_b32 s63, hwreg(20, 0, 3)
    s_andn2_b32 s64, 1, s63
    s_mul_i32 s64, s64, 1
    s_add_u32 s70, s70, s64
    v_mov_b32 v3, 0
    v_mov_b32 v4, 0
    v_mov_b32 v11, 0
    v_mov_b32 v24, 0
    v_mov_b32 v34, 0
    v_mov_b64 v[12:13], -1
    v_mov_b64 v[14:15], -1
    v_lshlrev_b32 v10, 4, v0
    s_waitcnt lgkmcnt(0)
    s_add_u32 s32, s6, s57
    s_addc_u32 s33, s7, 0
    s_mov_b32 s34, s58
    s_mov_b32 s35, 0x20000
    s_add_u32 s36, s8, s57
    s_addc_u32 s37, s9, 0
    s_mov_b32 s38, s58
    s_mov_b32 s39, 0x20000
    s_mov_b32 s40, s28
    s_mov_b32 s41, s29
    s_mov_b32 s42, 1937408
    s_mov_b32 s43, 0x20000
    s_add_u32 s44, s10, s59
    s_addc_u32 s45, s11, 0
    s_mov_b32 s46, s60
    s_mov_b32 s47, 0x20000
    s_sub_u32 s44, s44, 2048
    s_subb_u32 s45, s45, 0
    s_cmp_eq_u32 s30, 6
    s_cbranch_scc0 L_skip_1
    s_setprio 3
    s_xor_b32 s57, s71, 0
    s_mul_i32 s57, s57, 196608
    s_add_u32 s57, s57, 1024
    s_xor_b32 s58, s71, 1
    s_mul_i32 s58, s58, 196608
    s_add_u32 s58, s58, 0
    s_mov_b32 m0, 92160
L_dma_2:
    s_nop 0
    buffer_load_dwordx4 v5, s[32:35], s57 offen offset:0 nt lds
    buffer_load_dwordx4 v6, s[32:35], s58 offen offset:1024 nt lds
    s_add_u32 s57, s57, 24576
    s_add_u32 s58, s58, 24576
    s_add_u32 m0, m0, 2048
    s_cmp_lg_u32 m0, 108544
    s_cbranch_scc1 L_dma_2
    s_xor_b32 s57, s71, 0
    s_mul_i32 s57, s57, 196608
    s_add_u32 s57, s57, 1152
    s_xor_b32 s58, s71, 1
    s_mul_i32 s58, s58, 196608
    s_add_u32 s58, s58, 128
    s_mov_b32 m0, 108544
L_dma_3:
    s_waitcnt vmcnt(23)
    s_cmp_ge_u32 s70, 2
    s_cbranch_scc1 L_go_4
    s_waitcnt vmcnt(22)
    s_cmp_ge_u32 s70, 1
    s_cbranch_scc1 L_go_4
    s_waitcnt vmcnt(21)
L_go_4:
    buffer_load_dwordx4 v5, s[32:35], s57 offen offset:0 nt lds
    buffer_load_dwordx4 v6, s[32:35], s58 offen offset:1024 nt lds
    s_add_u32 s57, s57, 24576
    s_add_u32 s58, s58, 24576
    s_add_u32 m0, m0, 2048
    s_cmp_lg_u32 m0, 124928
    s_cbranch_scc1 L_dma_3
    s_mov_b32 s57, 2048
    s_mov_b32 s58, 1152
    s_mov_b32 s59, 256
    s_mov_b32 m0, 0
L_dma_5:
    s_waitcnt vmcnt(23)
    s_cmp_ge_u32 s70, 2
    s_cbranch_scc1 L_go_6
    s_waitcnt vmcnt(22)
    s_cmp_ge_u32 s70, 1
    s_cbranch_scc1 L_go_6
    s_waitcnt vmcnt(21)
L_go_6:
    buffer_load_dwordx4 v2, s[44:47], s57 offen offset:0 nt lds
    buffer_load_dwordx4 v2, s[44:47], s58 offen offset:1024 nt lds
    buffer_load_dwordx4 v2, s[44:47], s59 offen offset:2048 nt lds
    s_add_u32 s57, s57, 98304
    s_add_u32 s58, s58, 98304
    s_add_u32 s59, s59, 98304
    s_add_u32 m0, m0, 3072
    s_cmp_lg_u32 m0, 15360
    s_cbranch_scc1 L_dma_5
L_skip_1:
    s_cmp_lt_u32 s3, 20
    s_cselect_b32 s57, 7864320, 0
    s_add_u32 s58, s54, 1
    s_mul_i32 s58, s58, 245760
    s_cmp_lg_u32 s53, 3
    s_cselect_b64 s[48:49], s[12:13], s[16:17]
    s_cselect_b32 s50, s57, s58
    s_mov_b32 s51, 0x20000
    s_add_u32 s57, s28, 1376256
    s_sub_u32 s57, 0, s57
    s_and_b32 s57, s57, 0x7fff
    s_add_u32 s57, s57, 1376256
    s_lshr_b32 s58, s31, 1
    s_lshl_b32 s58, s58, 15
    s_add_u32 s6, s57, s58
    s_and_b32 s58, s31, 1
    s_mul_i32 s58, s58, 2560
    s_add_u32 s6, s6, s58
    s_lshl_b32 s58, s3, 7
    s_add_u32 s6, s6, s58
    s_mov_b32 s8, s57
    s_lshr_b32 s58, s52, 4
    s_lshl_b32 s58, s58, 15
    s_and_b32 s59, s52, 15
    s_lshl_b32 s59, s59, 7
    s_add_u32 s59, s59, s58
    s_add_u32 s59, s59, s57
    s_add_u32 s59, s59, 5120
    s_lshl_b32 s58, s31, 16
    s_add_u32 s59, s59, s58
    s_add_u32 s10, s28, s59
    s_addc_u32 s11, s29, 0
    s_lshr_b32 s58, s63, 2
    s_xor_b32 s58, s58, 0
    s_mul_i32 s58, s58, 8192
    s_add_u32 s7, s57, s58
    s_cmp_eq_u32 s30, 5
    s_cbranch_scc0 L_skip_7
    s_cmp_eq_u32 s52, 31
    s_cbranch_scc0 L_skip_8
    s_mov_b64 exec, 0xffffff
    buffer_store_dwordx4 v[12:15], v10, s[40:43], s72 offen sc1
    s_mov_b64 exec, -1
L_skip_8:
    s_cmp_lt_u32 s3, 20
    s_cbranch_scc0 L_skip_9
    v_and_b32 v16, 7, v0
    v_lshlrev_b32 v16, 4, v16
    v_bfe_u32 v17, v0, 3, 1
    v_lshl_add_u32 v16, v17, 13, v16
    v_lshrrev_b32 v17, 4, v0
    v_lshl_add_u32 v16, v17, 17, v16
    s_add_u32 s57, s6, 0
    buffer_store_dwordx4 v[12:15], v16, s[40:43], s57 offen sc1
L_skip_9:
    s_sub_u32 s58, s3, 20
    s_cmp_lt_u32 s58, 4
    s_cselect_b32 s59, s59, 0x7f000000
    v_and_b32 v16, 7, v0
    v_lshlrev_b32 v16, 4, v16
    v_bfe_u32 v60, v0, 3, 1
    v_lshl_add_u32 v16, v60, 13, v16
    v_lshrrev_b32 v60, 4, v0
    v_lshl_add_u32 v16, v60, 28, v16
    buffer_store_dwordx4 v[12:15], v16, s[40:43], s59 offen sc1
    s_mul_i32 s57, s52, 1840
    s_add_u32 s57, s57, s62
    s_mov_b32 exec_lo, 0xffffffff
    s_mov_b32 exec_hi, 0x7ffff
    buffer_store_dwordx4 v[12:15], v10, s[40:43], s57 offen offset:1024
    s_mov_b64 exec, -1
    buffer_store_dwordx4 v[12:15], v10, s[40:43], s57 offen
    s_mov_b64 exec, -1
    v_lshlrev_b32 v16, 4, v0
    v_add_u32 v16, 159744, v16
    ds_write_b128 v16, v[12:15]
    v_subrev_u32 v16, 8, v0
    v_cmp_gt_u32 vcc, 40, v16
    v_mov_b32 v16, 0x3f803f80
    s_nop 0
    v_cndmask_b32 v18, 0, v16, vcc
    v_min_u32 v16, 55, v0
    v_lshlrev_b32 v16, 2, v16
    v_add_u32 v16, 160992, v16
    ds_write_b32 v16, v18
    v_and_b32 v3, 7, v0
    v_lshlrev_b32 v3, 5, v3
L_skip_7:
    s_cmp_eq_u32 s30, 7
    s_cbranch_scc0 L_skip_10
    v_and_b32 v60, 31, v0
    v_min_u32 v60, 19, v60
    s_mul_i32 s57, s54, 160
    v_lshrrev_b32 v16, 5, v0
    v_lshlrev_b32 v16, 2, v16
    v_add_u32 v16, s57, v16
    v_lshl_add_u32 v16, v60, 3, v16
    global_load_dword v28, v16, s[4:5]
    global_load_dword v4, v16, s[22:23]
L_skip_10:
    s_sub_u32 s58, s30, 4
    s_cmp_lt_u32 s58, 3
    s_cbranch_scc0 L_skip_11
    s_mul_i32 s57, s31, 3
    s_add_u32 s57, s57, s58
    s_lshl_b32 s57, s57, 7
    v_lshlrev_b32 v16, 1, v0
    v_add_u32 v16, s57, v16
    global_load_short_d16_hi v4, v16, s[18:19]
L_skip_11:
    v_bfe_u32 v8, v0, 1, 3
    v_lshrrev_b32 v9, 4, v0
    v_xor_b32 v9, v8, v9
    v_bfe_u32 v8, v0, 2, 1
    v_lshlrev_b32 v8, 10, v8
    v_bfe_u32 v60, v0, 3, 1
    v_lshl_add_u32 v8, v60, 9, v8
    v_and_b32 v60, 3, v0
    v_lshl_add_u32 v8, v60, 7, v8
    v_add_u32 v8, s61, v8
    v_lshl_add_u32 v8, v9, 4, v8
    v_xor_b32 v9, 64, v8
    v_bfe_u32 v1, v0, 1, 1
    v_mul_u32_u24 v1, 43690, v1
    v_add_u32 v1, 17476, v1
    s_waitcnt vmcnt(31)
    s_barrier
    ds_read_b128 v[64:67], v8 offset:0
    ds_read_b128 v[68:71], v9 offset:0
    s_cmp_eq_u32 s30, 6
    s_cbranch_scc0 L_skip_12
    s_xor_b32 s57, s71, 0
    s_mul_i32 s57, s57, 196608
    s_add_u32 s57, s57, 1280
    s_xor_b32 s58, s71, 1
    s_mul_i32 s58, s58, 196608
    s_add_u32 s58, s58, 256
    s_mov_b32 m0, 124928
L_dma_13:
    s_waitcnt vmcnt(23)
    s_cmp_ge_u32 s70, 2
    s_cbranch_scc1 L_go_14
    s_waitcnt vmcnt(22)
    s_cmp_ge_u32 s70, 1
    s_cbranch_scc1 L_go_14
    s_waitcnt vmcnt(21)
L_go_14:
    buffer_load_dwordx4 v5, s[32:35], s57 offen offset:0 nt lds
    buffer_load_dwordx4 v6, s[32:35], s58 offen offset:1024 nt lds
    s_add_u32 s57, s57, 24576
    s_add_u32 s58, s58, 24576
    s_add_u32 m0, m0, 2048
    s_cmp_lg_u32 m0, 141312
    s_cbranch_scc1 L_dma_13
L_skip_12:
    s_waitcnt lgkmcnt(0)
    s_cmp_eq_u32 s30, 5
    s_cbranch_scc0 L_skip_15
    s_cmp_eq_u32 s52, 31
    s_cbranch_scc0 L_skip_16
    s_lshl_b32 s57, s31, 5
    v_mov_b32 v16, s57
    s_add_u32 s57, s63, 1
    v_mov_b32 v12, s57
    s_waitcnt vmcnt(4)
    s_mov_b64 exec, 0x1
    global_store_dword v16, v12, s[26:27] sc1
    s_mov_b64 exec, -1
L_skip_16:
L_skip_15:
    s_waitcnt vmcnt(31)
    s_barrier
    ds_read_b128 v[72:75], v8 offset:16384
    ds_read_b128 v[76:79], v9 offset:16384
    s_cmp_eq_u32 s30, 6
    s_cbranch_scc0 L_skip_17
    s_mov_b32 s57, 493568
    s_mov_b32 s58, 492672
    s_mov_b32 s59, 491776
    s_mov_b32 m0, 15360
L_dma_18:
    s_waitcnt vmcnt(23)
    s_cmp_ge_u32 s70, 2
    s_cbranch_scc1 L_go_19
    s_waitcnt vmcnt(22)
    s_cmp_ge_u32 s70, 1
    s_cbranch_scc1 L_go_19
    s_waitcnt vmcnt(21)
L_go_19:
    buffer_load_dwordx4 v2, s[44:47], s57 offen offset:0 nt lds
    buffer_load_dwordx4 v2, s[44:47], s58 offen offset:1024 nt lds
    buffer_load_dwordx4 v2, s[44:47], s59 offen offset:2048 nt lds
    s_add_u32 s57, s57, 98304
    s_add_u32 s58, s58, 98304
    s_add_u32 s59, s59, 98304
    s_add_u32 m0, m0, 3072
    s_cmp_lg_u32 m0, 30720
    s_cbranch_scc1 L_dma_18
    s_xor_b32 s57, s71, 2
    s_mul_i32 s57, s57, 196608
    s_add_u32 s57, s57, 1024
    s_xor_b32 s58, s71, 3
    s_mul_i32 s58, s58, 196608
    s_add_u32 s58, s58, 0
    s_mov_b32 m0, 141312
L_dma_20:
    s_waitcnt vmcnt(23)
    s_cmp_ge_u32 s70, 2
    s_cbranch_scc1 L_go_21
    s_waitcnt vmcnt(22)
    s_cmp_ge_u32 s70, 1
    s_cbranch_scc1 L_go_21
    s_waitcnt vmcnt(21)
L_go_21:
    buffer_load_dwordx4 v5, s[32:35], s57 offen offset:0 nt lds
    buffer_load_dwordx4 v6, s[32:35], s58 offen offset:1024 nt lds
    s_add_u32 s57, s57, 24576
    s_add_u32 s58, s58, 24576
    s_add_u32 m0, m0, 2048
    s_cmp_lg_u32 m0, 157696
    s_cbranch_scc1 L_dma_20
L_skip_17:
    s_waitcnt lgkmcnt(0)
    s_cmp_lt_u32 s30, 4
    s_cbranch_scc0 L_skip_22
    s_mov_b64 exec, 0
    s_cmp_eq_u32 s30, 1
    s_cbranch_scc1 L_pad1
    s_cmp_eq_u32 s30, 2
    s_cbranch_scc1 L_pad2
    s_cmp_eq_u32 s30, 3
    s_cbranch_scc1 L_pad3
    s_branch L_pad0
L_padback:
    s_mov_b64 exec, -1
L_skip_22:
    s_waitcnt vmcnt(31)
    s_barrier
    ds_read_b128 v[80:83], v8 offset:32768
    ds_read_b128 v[84:87], v9 offset:32768
    s_cmp_eq_u32 s30, 6
    s_cbranch_scc0 L_skip_23
    s_cmp_lg_u32 s53, 3
    s_cbranch_scc0 L_wb_24
    s_mul_i32 s57, s31, 983040
    s_lshl_b32 s58, s3, 6
    s_add_u32 s57, s57, s58
    v_bfe_u32 v38, v0, 4, 1
    v_lshlrev_b32 v38, 1, v38
    v_xor_b32 v38, v38, v0
    v_and_b32 v38, 3, v38
    v_lshrrev_b32 v3, 5, v0
    v_mul_u32_u24 v3, 10240, v3
    v_bfe_u32 v39, v0, 4, 1
    v_mul_u32_u24 v39, 2560, v39
    v_add_u32 v3, v39, v3
    v_bfe_u32 v39, v0, 3, 1
    v_mul_u32_u24 v39, 5120, v39
    v_add_u32 v3, v39, v3
    v_bfe_u32 v39, v0, 2, 1
    v_mul_u32_u24 v39, 20480, v39
    v_add_u32 v3, v39, v3
    v_add_u32 v3, s57, v3
    v_lshl_add_u32 v3, v38, 4, v3
    s_mov_b32 s14, 40960
    s_mov_b32 s15, 256
    s_branch L_we_25
L_wb_24:
    s_mul_i32 s57, s31, 384
    s_mul_i32 s58, s54, 245760
    s_add_u32 s57, s57, s58
    v_lshlrev_b32 v3, 4, v0
    v_add_u32 v3, s57, v3
    v_mov_b32 v38, 2688
    v_cmp_lt_u32 vcc, 23, v0
    s_nop 1
    v_cndmask_b32 v38, 0, v38, vcc
    v_add_u32 v3, v38, v3
    v_mov_b32 v38, 0x7f000000
    v_cmp_lt_u32 vcc, 47, v0
    s_nop 1
    v_cndmask_b32 v3, v3, v38, vcc
    s_mov_b32 s14, 12288
    s_mov_b32 s15, 5120
L_we_25:
    s_mul_i32 s57, s14, 0
    s_mov_b32 m0, 30720
    s_nop 0
    buffer_load_dwordx4 v3, s[48:51], s57 offen offset:0 nt lds
    s_mul_i32 s57, s14, 0
    s_add_u32 s57, s57, s15
    s_mov_b32 m0, 30720
    s_nop 0
    buffer_load_dwordx4 v3, s[48:51], s57 offen offset:1024 nt lds
    s_xor_b32 s57, s71, 2
    s_mul_i32 s57, s57, 196608
    s_add_u32 s57, s57, 1152
    s_xor_b32 s58, s71, 3
    s_mul_i32 s58, s58, 196608
    s_add_u32 s58, s58, 128
    s_mov_b32 m0, 92160
L_dma_26:
    s_waitcnt vmcnt(23)
    s_cmp_ge_u32 s70, 2
    s_cbranch_scc1 L_go_27
    s_waitcnt vmcnt(22)
    s_cmp_ge_u32 s70, 1
    s_cbranch_scc1 L_go_27
    s_waitcnt vmcnt(21)
L_go_27:
    buffer_load_dwordx4 v5, s[32:35], s57 offen offset:0 nt lds
    buffer_load_dwordx4 v6, s[32:35], s58 offen offset:1024 nt lds
    s_add_u32 s57, s57, 24576
    s_add_u32 s58, s58, 24576
    s_add_u32 m0, m0, 2048
    s_cmp_lg_u32 m0, 108544
    s_cbranch_scc1 L_dma_26
    s_mul_i32 s57, s14, 1
    s_mov_b32 m0, 32768
    s_nop 0
    buffer_load_dwordx4 v3, s[48:51], s57 offen offset:0 nt lds
    s_mul_i32 s57, s14, 1
    s_add_u32 s57, s57, s15
    s_mov_b32 m0, 32768
    s_nop 0
    buffer_load_dwordx4 v3, s[48:51], s57 offen offset:1024 nt lds
    s_xor_b32 s57, s71, 2
    s_mul_i32 s57, s57, 196608
    s_add_u32 s57, s57, 1280
    s_xor_b32 s58, s71, 3
    s_mul_i32 s58, s58, 196608
    s_add_u32 s58, s58, 256
    s_mov_b32 m0, 108544
L_dma_28:
    s_waitcnt vmcnt(23)
    s_cmp_ge_u32 s70, 2
    s_cbranch_scc1 L_go_29
    s_waitcnt vmcnt(22)
    s_cmp_ge_u32 s70, 1
    s_cbranch_scc1 L_go_29
    s_waitcnt vmcnt(21)
L_go_29:
    buffer_load_dwordx4 v5, s[32:35], s57 offen offset:0 nt lds
    buffer_load_dwordx4 v6, s[32:35], s58 offen offset:1024 nt lds
    s_add_u32 s57, s57, 24576
    s_add_u32 s58, s58, 24576
    s_add_u32 m0, m0, 2048
    s_cmp_lg_u32 m0, 124928
    s_cbranch_scc1 L_dma_28
L_skip_23:
    s_waitcnt lgkmcnt(0)
    s_cmp_lt_u32 s30, 5
    s_cbranch_scc0 L_skip_30
    s_waitcnt vmcnt(0)
L_skip_30:
    s_cmp_eq_u32 s30, 7
    s_cbranch_scc0 L_skip_31
    v_and_b32 v60, 31, v0
    v_cmp_gt_u32 s[64:65], 20, v60
    v_min_u32 v60, 19, v60
    v_lshrrev_b32 v35, 5, v0
    v_lshlrev_b32 v35, 2, v35
    v_add_u32 v35, 160832, v35
    v_lshl_add_u32 v35, v60, 3, v35
    s_mul_i32 s66, s53, 6400
    s_add_u32 s66, s66, s62
    s_add_u32 s66, s66, 58880
    s_add_u32 s67, s66, 6144
    s_lshl_b32 s57, s54, 3
    v_lshrrev_b32 v34, 5, v0
    v_lshlrev_b32 v34, 2, v34
    v_add_u32 v34, s57, v34
    v_and_b32 v60, 31, v0
    v_mov_b32 v61, 0x7f000000
    v_cmp_ne_u32 vcc, 31, v60
    s_nop 1
    v_cndmask_b32 v34, v34, v61, vcc
    v_mov_b32 v61, 0x3f803f80
    s_waitcnt vmcnt(0)
    ds_write_b32 v35, v28
    s_waitcnt lgkmcnt(0)
L_skip_31:
    s_cmp_eq_u32 s30, 5
    s_cbranch_scc0 L_skip_32
    s_waitcnt vmcnt(0)
    s_lshr_b32 s65, s63, 2
    s_sub_u32 s58, s3, 20
    s_cmp_lt_u32 s58, 4
    s_cbranch_scc0 L_skip_33
    s_mov_b32 s67, 0
    s_load_dword s66, s[10:11], 0
    s_load_dword s67, s[10:11], 8192
    s_waitcnt lgkmcnt(1)
    s_sleep 1
    s_mov_b32 s65, s67
L_skip_33:
L_skip_32:
    s_waitcnt vmcnt(36)
    s_barrier
    ds_read_b128 v[88:91], v8 offset:49152
    ds_read_b128 v[92:95], v9 offset:49152
    s_cmp_eq_u32 s30, 6
    s_cbranch_scc0 L_skip_34
    s_mul_i32 s57, s14, 2
    s_mov_b32 m0, 34816
    s_nop 0
    buffer_load_dwordx4 v3, s[48:51], s57 offen offset:0 nt lds
    s_mul_i32 s57, s14, 2
    s_add_u32 s57, s57, s15
    s_mov_b32 m0, 34816
    s_nop 0
    buffer_load_dwordx4 v3, s[48:51], s57 offen offset:1024 nt lds
    s_xor_b32 s57, s71, 4
    s_mul_i32 s57, s57, 196608
    s_add_u32 s57, s57, 1024
    s_xor_b32 s58, s71, 5
    s_mul_i32 s58, s58, 196608
    s_add_u32 s58, s58, 0
    s_mov_b32 m0, 124928
L_dma_35:
    s_waitcnt vmcnt(23)
    s_cmp_ge_u32 s70, 2
    s_cbranch_scc1 L_go_36
    s_waitcnt vmcnt(22)
    s_cmp_ge_u32 s70, 1
    s_cbranch_scc1 L_go_36
    s_waitcnt vmcnt(21)
L_go_36:
    buffer_load_dwordx4 v5, s[32:35], s57 offen offset:0 nt lds
    buffer_load_dwordx4 v6, s[32:35], s58 offen offset:1024 nt lds
    s_add_u32 s57, s57, 24576
    s_add_u32 s58, s58, 24576
    s_add_u32 m0, m0, 2048
    s_cmp_lg_u32 m0, 141312
    s_cbranch_scc1 L_dma_35
L_skip_34:
    s_waitcnt lgkmcnt(0)
    s_cmp_eq_u32 s30, 7
    s_cbranch_scc0 L_skip_37
    v_cndmask_b32 v29, 0, v28, s[64:65]
    v_dot2_f32_bf16 v33, v29, v61, 0
    v_dot2_f32_bf16 v32, v29, v29, 0
    v_lshlrev_b32 v2, 16, v28
    v_and_b32 v3, 0xffff0000, v28
    s_cmp_eq_u32 s55, 0
    v_permlane32_swap_b32 v33, v32
    v_add_f32 v33, v33, v32
    s_nop 1
    v_add_f32_dpp v33, v33, v33 row_ror:8 row_mask:0xf bank_mask:0xf
    s_nop 1
    v_add_f32_dpp v33, v33, v33 row_ror:4 row_mask:0xf bank_mask:0xf
    s_nop 1
    v_add_f32_dpp v33, v33, v33 row_ror:2 row_mask:0xf bank_mask:0xf
    s_nop 1
    v_add_f32_dpp v33, v33, v33 row_ror:1 row_mask:0xf bank_mask:0xf
    s_nop 1
    v_add_f32_dpp v33, v33, v33 row_bcast:15 row_mask:0xa bank_mask:0xf
    v_min_u32 v33, -2, v33
    s_cbranch_scc1 L_gs_38
    buffer_store_dword v33, v34, s[40:43], s67 offen
L_gb_39:
    s_waitcnt vmcnt(1)
L_skip_37:
    s_cmp_lt_u32 s30, 6
    s_cbranch_scc0 L_skip_40
    s_lshr_b32 s57, s30, 1
    s_mul_i32 s57, s57, 1024
    s_and_b32 s58, s30, 1
    s_lshl_b32 s58, s58, 6
    s_add_u32 s57, s57, s58
    v_lshrrev_b32 v18, 5, v0
    v_mul_u32_u24 v18, 6144, v18
    v_bfe_u32 v60, v0, 3, 1
    v_mul_u32_u24 v60, 3072, v60
    v_add_u32 v18, v60, v18
    v_bfe_u32 v60, v0, 4, 1
    v_lshl_add_u32 v18, v60, 9, v18
    v_bfe_u32 v60, v0, 2, 1
    v_lshl_add_u32 v18, v60, 7, v18
    v_and_b32 v60, 3, v0
    v_lshl_add_u32 v18, v60, 3, v18
    v_add_u32 v18, s57, v18
    v_bfe_u32 v19, v0, 4, 1
    v_mul_u32_u24 v19, 3072, v19
    v_bfe_u32 v60, v0, 3, 1
    v_lshl_add_u32 v19, v60, 9, v19
    v_bfe_u32 v60, v0, 2, 1
    v_lshl_add_u32 v19, v60, 7, v19
    v_and_b32 v60, 3, v0
    v_lshl_add_u32 v19, v60, 3, v19
    v_add_u32 v19, s57, v19
    v_add_u32 v19, 24576, v19
    ds_read_b64_tr_b16 v[28:29], v18 offset:0
    ds_read_b64_tr_b16 v[30:31], v18 offset:256
    ds_read_b64_tr_b16 v[32:33], v18 offset:12288
    ds_read_b64_tr_b16 v[34:35], v18 offset:12544
    ds_read_b64_tr_b16 v[36:37], v19 offset:0
    ds_read_b64_tr_b16 v[38:39], v19 offset:256
    ds_read_b64_tr_b16 v[40:41], v18 offset:32
    ds_read_b64_tr_b16 v[42:43], v18 offset:288
    ds_read_b64_tr_b16 v[44:45], v18 offset:12320
    ds_read_b64_tr_b16 v[46:47], v18 offset:12576
    ds_read_b64_tr_b16 v[48:49], v19 offset:32
    ds_read_b64_tr_b16 v[50:51], v19 offset:288
    v_lshrrev_b32 v52, 4, v0
    v_lshlrev_b32 v52, 5, v52
    v_bfe_u32 v60, v0, 1, 1
    v_lshl_add_u32 v52, v60, 4, v52
    v_and_b32 v60, 1, v0
    v_mul_u32_u24 v60, 192, v60
    v_add_u32 v52, v60, v52
    v_add_u32 v52, 160832, v52
    v_lshrrev_b32 v53, 4, v0
    v_lshlrev_b32 v53, 4, v53
    v_bfe_u32 v60, v0, 1, 1
    v_lshl_add_u32 v53, v60, 3, v53
    v_and_b32 v60, 1, v0
    v_mul_u32_u24 v60, 192, v60
    v_add_u32 v53, v60, v53
    v_add_u32 v53, 160960, v53
    v_mov_b64 v[20:21], 0
    v_mov_b64 v[22:23], 0
    v_mov_b64 v[24:25], 0
    v_mov_b64 v[26:27], 0
    s_lshl_b32 s57, s54, 1
    s_lshl_b32 s58, s30, 9
    s_add_u32 s57, s57, s58
    v_and_b32 v54, 31, v0
    v_lshlrev_b32 v54, 4, v54
    v_lshrrev_b32 v60, 5, v0
    v_mul_u32_u24 v60, 3072, v60
    v_add_u32 v54, v60, v54
    v_add_u32 v54, s57, v54
    s_mul_i32 s59, s53, 6400
    s_add_u32 s59, s59, s62
    s_add_u32 s59, s59, 58880
    s_add_u32 s60, s59, 6144
    ds_read_b128 v[12:15], v52
    ds_read_b64 v[16:17], v53
    s_waitcnt lgkmcnt(1)
    v_smfmac_f32_16x16x64_bf16 v[20:23], v[12:15], v[28:35], v1
    v_smfmac_f32_16x16x64_bf16 v[24:27], v[12:15], v[40:47], v1
    s_waitcnt lgkmcnt(0)
    v_smfmac_f32_16x16x32_bf16 v[20:23], v[16:17], v[36:39], v1
    v_smfmac_f32_16x16x32_bf16 v[24:27], v[16:17], v[48:51], v1
    s_cmp_eq_u32 s55, 0
    s_nop 5
    v_add_f32 v12, v20, v22
    s_nop 1
    v_add_f32_dpp v12, v24, v26 quad_perm:[0,1,2,3] row_mask:0x2 bank_mask:0xf
    s_nop 1
    v_add_f32_dpp v12, v21, v23 quad_perm:[0,1,2,3] row_mask:0x4 bank_mask:0xf
    s_nop 1
    v_add_f32_dpp v12, v25, v27 quad_perm:[0,1,2,3] row_mask:0x8 bank_mask:0xf
    v_cvt_pk_bf16_f32 v12, v12, v12
    v_min_u32 v12, -2, v12
    s_cbranch_scc1 L_gs_41
    buffer_store_short v12, v54, s[40:43], s59 offen
L_gb_42:
L_skip_40:
    s_cmp_eq_u32 s30, 5
    s_cbranch_scc0 L_skip_43
    global_load_dword v2, v3, s[26:27] sc1
L_skip_43:
    s_waitcnt vmcnt(36)
    s_barrier
    ds_read_b128 v[96:99], v8 offset:0
    ds_read_b128 v[100:103], v9 offset:0
    s_cmp_eq_u32 s30, 6
    s_cbranch_scc0 L_skip_44
    s_mul_i32 s57, s14, 3
    s_mov_b32 m0, 36864
    s_nop 0
    buffer_load_dwordx4 v3, s[48:51], s57 offen offset:0 nt lds
    s_mul_i32 s57, s14, 3
    s_add_u32 s57, s57, s15
    s_mov_b32 m0, 36864
    s_nop 0
    buffer_load_dwordx4 v3, s[48:51], s57 offen offset:1024 nt lds
    s_xor_b32 s57, s71, 4
    s_mul_i32 s57, s57, 196608
    s_add_u32 s57, s57, 1152
    s_xor_b32 s58, s71, 5
    s_mul_i32 s58, s58, 196608
    s_add_u32 s58, s58, 128
    s_mov_b32 m0, 141312
L_dma_45:
    s_waitcnt vmcnt(23)
    s_cmp_ge_u32 s70, 2
    s_cbranch_scc1 L_go_46
    s_waitcnt vmcnt(22)
    s_cmp_ge_u32 s70, 1
    s_cbranch_scc1 L_go_46
    s_waitcnt vmcnt(21)
L_go_46:
    buffer_load_dwordx4 v5, s[32:35], s57 offen offset:0 nt lds
    buffer_load_dwordx4 v6, s[32:35], s58 offen offset:1024 nt lds
    s_add_u32 s57, s57, 24576
    s_add_u32 s58, s58, 24576
    s_add_u32 m0, m0, 2048
    s_cmp_lg_u32 m0, 157696
    s_cbranch_scc1 L_dma_45
L_skip_44:
    s_waitcnt lgkmcnt(0)
    s_waitcnt vmcnt(36)
    s_barrier
    ds_read_b128 v[104:107], v8 offset:16384
    ds_read_b128 v[108:111], v9 offset:16384
    s_cmp_eq_u32 s30, 6
    s_cbranch_scc0 L_skip_47
    s_mul_i32 s57, s14, 4
    s_mov_b32 m0, 38912
    s_nop 0
    buffer_load_dwordx4 v3, s[48:51], s57 offen offset:0 nt lds
    s_mul_i32 s57, s14, 4
    s_add_u32 s57, s57, s15
    s_mov_b32 m0, 38912
    s_nop 0
    buffer_load_dwordx4 v3, s[48:51], s57 offen offset:1024 nt lds
    s_xor_b32 s57, s71, 4
    s_mul_i32 s57, s57, 196608
    s_add_u32 s57, s57, 1280
    s_xor_b32 s58, s71, 5
    s_mul_i32 s58, s58, 196608
    s_add_u32 s58, s58, 256
    s_mov_b32 m0, 92160
L_dma_48:
    s_waitcnt vmcnt(23)
    s_cmp_ge_u32 s70, 2
    s_cbranch_scc1 L_go_49
    s_waitcnt vmcnt(22)
    s_cmp_ge_u32 s70, 1
    s_cbranch_scc1 L_go_49
    s_waitcnt vmcnt(21)
L_go_49:
    buffer_load_dwordx4 v5, s[32:35], s57 offen offset:0 nt lds
    buffer_load_dwordx4 v6, s[32:35], s58 offen offset:1024 nt lds
    s_add_u32 s57, s57, 24576
    s_add_u32 s58, s58, 24576
    s_add_u32 m0, m0, 2048
    s_cmp_lg_u32 m0, 108544
    s_cbranch_scc1 L_dma_48
L_skip_47:
    s_waitcnt lgkmcnt(0)
    s_cmp_lg_u32 s30, 6
    s_cbranch_scc0 L_skip_50
    s_waitcnt vmcnt(0)
L_skip_50:
    s_waitcnt vmcnt(36)
    s_barrier
    ds_read_b128 v[112:115], v8 offset:32768
    ds_read_b128 v[116:119], v9 offset:32768
    s_cmp_eq_u32 s30, 6
    s_cbranch_scc0 L_skip_51
    s_mul_i32 s57, s14, 5
    s_mov_b32 m0, 40960
    s_nop 0
    buffer_load_dwordx4 v3, s[48:51], s57 offen offset:0 nt lds
    s_mul_i32 s57, s14, 5
    s_add_u32 s57, s57, s15
    s_mov_b32 m0, 40960
    s_nop 0
    buffer_load_dwordx4 v3, s[48:51], s57 offen offset:1024 nt lds
    s_xor_b32 s57, s71, 6
    s_mul_i32 s57, s57, 196608
    s_add_u32 s57, s57, 1024
    s_xor_b32 s58, s71, 7
    s_mul_i32 s58, s58, 196608
    s_add_u32 s58, s58, 0
    s_mov_b32 m0, 108544
L_dma_52:
    s_waitcnt vmcnt(23)
    s_cmp_ge_u32 s70, 2
    s_cbranch_scc1 L_go_53
    s_waitcnt vmcnt(22)
    s_cmp_ge_u32 s70, 1
    s_cbranch_scc1 L_go_53
    s_waitcnt vmcnt(21)
L_go_53:
    buffer_load_dwordx4 v5, s[32:35], s57 offen offset:0 nt lds
    buffer_load_dwordx4 v6, s[32:35], s58 offen offset:1024 nt lds
    s_add_u32 s57, s57, 24576
    s_add_u32 s58, s58, 24576
    s_add_u32 m0, m0, 2048
    s_cmp_lg_u32 m0, 124928
    s_cbranch_scc1 L_dma_52
L_skip_51:
    s_waitcnt lgkmcnt(0)
    s_cmp_eq_u32 s30, 5
    s_cbranch_scc0 L_skip_54
L_cw_55:
    v_readlane_b32 s57, v2, s31
    s_cmp_eq_u32 s57, 0
    s_cbranch_scc1 L_cr_56
    s_lshr_b32 s58, s63, 2
    s_xor_b32 s58, s58, s65
    s_and_b32 s58, s58, 1
    v_mov_b32 v25, s58
    s_sub_u32 s57, s57, 1
    s_cmp_eq_u32 s57, s63
    s_cselect_b32 s64, 1, 0
    s_cbranch_scc0 L_far_57
    s_lshl_b32 s57, s52, 2
    s_add_u32 s57, s57, s72
    s_mov_b64 exec, 1
    buffer_store_dword v25, v0, s[40:43], s57 offen offset:0
    s_mov_b64 exec, -1
L_fb_58:
L_skip_54:
    s_waitcnt vmcnt(36)
    s_barrier
    ds_read_b128 v[120:123], v8 offset:49152
    ds_read_b128 v[124:127], v9 offset:49152
    s_cmp_eq_u32 s30, 6
    s_cbranch_scc0 L_skip_59
    s_mul_i32 s57, s14, 6
    s_mov_b32 m0, 43008
    s_nop 0
    buffer_load_dwordx4 v3, s[48:51], s57 offen offset:0 nt lds
    s_mul_i32 s57, s14, 6
    s_add_u32 s57, s57, s15
    s_mov_b32 m0, 43008
    s_nop 0
    buffer_load_dwordx4 v3, s[48:51], s57 offen offset:1024 nt lds
    s_xor_b32 s57, s71, 6
    s_mul_i32 s57, s57, 196608
    s_add_u32 s57, s57, 1152
    s_xor_b32 s58, s71, 7
    s_mul_i32 s58, s58, 196608
    s_add_u32 s58, s58, 128
    s_mov_b32 m0, 124928
L_dma_60:
    s_waitcnt vmcnt(23)
    s_cmp_ge_u32 s70, 2
    s_cbranch_scc1 L_go_61
    s_waitcnt vmcnt(22)
    s_cmp_ge_u32 s70, 1
    s_cbranch_scc1 L_go_61
    s_waitcnt vmcnt(21)
L_go_61:
    buffer_load_dwordx4 v5, s[32:35], s57 offen offset:0 nt lds
    buffer_load_dwordx4 v6, s[32:35], s58 offen offset:1024 nt lds
    s_add_u32 s57, s57, 24576
    s_add_u32 s58, s58, 24576
    s_add_u32 m0, m0, 2048
    s_cmp_lg_u32 m0, 141312
    s_cbranch_scc1 L_dma_60
L_skip_59:
    s_waitcnt lgkmcnt(0)
    s_waitcnt vmcnt(36)
    s_barrier
    ds_read_b128 v[128:131], v8 offset:0
    ds_read_b128 v[132:135], v9 offset:0
    s_cmp_eq_u32 s30, 6
    s_cbranch_scc0 L_skip_62
    s_mul_i32 s57, s14, 7
    s_mov_b32 m0, 45056
    s_nop 0
    buffer_load_dwordx4 v3, s[48:51], s57 offen offset:0 nt lds
    s_mul_i32 s57, s14, 7
    s_add_u32 s57, s57, s15
    s_mov_b32 m0, 45056
    s_nop 0
    buffer_load_dwordx4 v3, s[48:51], s57 offen offset:1024 nt lds
    s_xor_b32 s57, s71, 6
    s_mul_i32 s57, s57, 196608
    s_add_u32 s57, s57, 1280
    s_xor_b32 s58, s71, 7
    s_mul_i32 s58, s58, 196608
    s_add_u32 s58, s58, 256
    s_mov_b32 m0, 141312
L_dma_63:
    s_waitcnt vmcnt(23)
    s_cmp_ge_u32 s70, 2
    s_cbranch_scc1 L_go_64
    s_waitcnt vmcnt(22)
    s_cmp_ge_u32 s70, 1
    s_cbranch_scc1 L_go_64
    s_waitcnt vmcnt(21)
L_go_64:
    buffer_load_dwordx4 v5, s[32:35], s57 offen offset:0 nt lds
    buffer_load_dwordx4 v6, s[32:35], s58 offen offset:1024 nt lds
    s_add_u32 s57, s57, 24576
    s_add_u32 s58, s58, 24576
    s_add_u32 m0, m0, 2048
    s_cmp_lg_u32 m0, 157696
    s_cbranch_scc1 L_dma_63
L_skip_62:
    s_waitcnt lgkmcnt(0)
    s_cmp_eq_u32 s30, 5
    s_cbranch_scc0 L_skip_65
    v_lshlrev_b32 v24, 2, v0
    buffer_load_dword v2, v24, s[40:43], s72 offen sc1
L_skip_65:
    s_waitcnt vmcnt(36)
    s_barrier
    ds_read_b128 v[136:139], v8 offset:16384
    ds_read_b128 v[140:143], v9 offset:16384
    s_cmp_eq_u32 s30, 6
    s_cbranch_scc0 L_skip_66
    s_mul_i32 s57, s14, 8
    s_mov_b32 m0, 47104
    s_nop 0
    buffer_load_dwordx4 v3, s[48:51], s57 offen offset:0 nt lds
    s_mul_i32 s57, s14, 8
    s_add_u32 s57, s57, s15
    s_mov_b32 m0, 47104
    s_nop 0
    buffer_load_dwordx4 v3, s[48:51], s57 offen offset:1024 nt lds
    s_xor_b32 s57, s71, 0
    s_mul_i32 s57, s57, 196608
    s_add_u32 s57, s57, 1024
    s_xor_b32 s58, s71, 2
    s_mul_i32 s58, s58, 196608
    s_add_u32 s58, s58, 0
    s_mov_b32 m0, 92160
L_dma_67:
    s_waitcnt vmcnt(23)
    s_cmp_ge_u32 s70, 2
    s_cbranch_scc1 L_go_68
    s_waitcnt vmcnt(22)
    s_cmp_ge_u32 s70, 1
    s_cbranch_scc1 L_go_68
    s_waitcnt vmcnt(21)
L_go_68:
    buffer_load_dwordx4 v7, s[36:39], s57 offen offset:0 nt lds
    buffer_load_dwordx4 v7, s[36:39], s58 offen offset:1024 nt lds
    s_add_u32 s57, s57, 24576
    s_add_u32 s58, s58, 24576
    s_add_u32 m0, m0, 2048
    s_cmp_lg_u32 m0, 108544
    s_cbranch_scc1 L_dma_67
L_skip_66:
    s_waitcnt lgkmcnt(0)
    s_waitcnt vmcnt(36)
    s_barrier
    ds_read_b128 v[144:147], v8 offset:32768
    ds_read_b128 v[148:151], v9 offset:32768
    s_cmp_eq_u32 s30, 6
    s_cbranch_scc0 L_skip_69
    s_mul_i32 s57, s14, 9
    s_mov_b32 m0, 49152
    s_nop 0
    buffer_load_dwordx4 v3, s[48:51], s57 offen offset:0 nt lds
    s_mul_i32 s57, s14, 9
    s_add_u32 s57, s57, s15
    s_mov_b32 m0, 49152
    s_nop 0
    buffer_load_dwordx4 v3, s[48:51], s57 offen offset:1024 nt lds
    s_xor_b32 s57, s71, 0
    s_mul_i32 s57, s57, 196608
    s_add_u32 s57, s57, 1152
    s_xor_b32 s58, s71, 2
    s_mul_i32 s58, s58, 196608
    s_add_u32 s58, s58, 128
    s_mov_b32 m0, 108544
L_dma_70:
    s_waitcnt vmcnt(23)
    s_cmp_ge_u32 s70, 2
    s_cbranch_scc1 L_go_71
    s_waitcnt vmcnt(22)
    s_cmp_ge_u32 s70, 1
    s_cbranch_scc1 L_go_71
    s_waitcnt vmcnt(21)
L_go_71:
    buffer_load_dwordx4 v7, s[36:39], s57 offen offset:0 nt lds
    buffer_load_dwordx4 v7, s[36:39], s58 offen offset:1024 nt lds
    s_add_u32 s57, s57, 24576
    s_add_u32 s58, s58, 24576
    s_add_u32 m0, m0, 2048
    s_cmp_lg_u32 m0, 124928
    s_cbranch_scc1 L_dma_70
L_skip_69:
    s_waitcnt lgkmcnt(0)
    s_cmp_eq_u32 s30, 5
    s_cbranch_scc0 L_skip_72
L_cw_73:
    s_waitcnt vmcnt(0)
    v_cmp_ne_u32 vcc, -1, v2
    s_mov_b32 s57, 0
    s_mov_b32 s68, 2
    s_cmp_eq_u32 s64, 0
    s_cbranch_scc1 L_cd_75
    s_cmp_lg_u32 vcc_hi, 0
    s_cbranch_scc1 L_cd_75
    s_cmp_lg_u32 vcc_lo, -1
    s_cbranch_scc1 L_cr_74
    v_cmp_eq_u32 vcc, 1, v2
    s_bcnt1_i32_b32 s68, vcc_lo
    s_mov_b32 s57, 1
L_cd_75:
    v_mov_b32 v37, 160768
    v_mov_b32 v38, s57
    ds_write_b32 v37, v38
    s_waitcnt lgkmcnt(0)
L_skip_72:
    s_waitcnt vmcnt(36)
    s_barrier
    ds_read_b128 v[152:155], v8 offset:49152
    ds_read_b128 v[156:159], v9 offset:49152
    s_cmp_eq_u32 s30, 6
    s_cbranch_scc0 L_skip_76
    s_mul_i32 s57, s14, 10
    s_mov_b32 m0, 51200
    s_nop 0
    buffer_load_dwordx4 v3, s[48:51], s57 offen offset:0 nt lds
    s_mul_i32 s57, s14, 10
    s_add_u32 s57, s57, s15
    s_mov_b32 m0, 51200
    s_nop 0
    buffer_load_dwordx4 v3, s[48:51], s57 offen offset:1024 nt lds
    s_xor_b32 s57, s71, 0
    s_mul_i32 s57, s57, 196608
    s_add_u32 s57, s57, 1280
    s_xor_b32 s58, s71, 2
    s_mul_i32 s58, s58, 196608
    s_add_u32 s58, s58, 256
    s_mov_b32 m0, 124928
L_dma_77:
    s_waitcnt vmcnt(23)
    s_cmp_ge_u32 s70, 2
    s_cbranch_scc1 L_go_78
    s_waitcnt vmcnt(22)
    s_cmp_ge_u32 s70, 1
    s_cbranch_scc1 L_go_78
    s_waitcnt vmcnt(21)
L_go_78:
    buffer_load_dwordx4 v7, s[36:39], s57 offen offset:0 nt lds
    buffer_load_dwordx4 v7, s[36:39], s58 offen offset:1024 nt lds
    s_add_u32 s57, s57, 24576
    s_add_u32 s58, s58, 24576
    s_add_u32 m0, m0, 2048
    s_cmp_lg_u32 m0, 141312
    s_cbranch_scc1 L_dma_77
L_skip_76:
    s_waitcnt lgkmcnt(0)
    v_lshrrev_b32 v8, 2, v0
    v_lshlrev_b32 v8, 7, v8
    v_bfe_u32 v60, v0, 3, 2
    v_lshl_add_u32 v8, v60, 5, v8
    v_and_b32 v60, 3, v0
    v_lshl_add_u32 v8, v60, 3, v8
    v_add_u32 v8, s61, v8
    v_xor_b32 v9, 32, v8
    v_xor_b32 v10, 64, v8
    v_xor_b32 v11, 96, v8
    v_mov_b32 v41, 160768
    ds_read_b32 v42, v41
    s_waitcnt lgkmcnt(0)
    v_readfirstlane_b32 s55, v42
    s_cmp_eq_u32 s55, 0
    s_cbranch_scc1 L_spread
L_spread_back:
    s_cmp_eq_u32 s30, 5
    s_cbranch_scc0 L_skip_90
    s_cmp_eq_u32 s52, 31
    s_cbranch_scc0 L_skip_91
    s_lshl_b32 s57, s31, 5
    v_mov_b32 v16, s57
    s_add_u32 s57, s68, 1
    v_mov_b32 v12, s57
    s_mov_b64 exec, 0x1
    global_store_dword v16, v12, s[26:27] offset:4 sc1
    s_mov_b64 exec, -1
L_skip_91:
L_skip_90:
    s_sub_u32 s58, s30, 1
    s_cmp_lt_u32 s58, 4
    s_cbranch_scc0 L_skip_92
    s_mul_i32 s59, s53, 6400
    s_add_u32 s59, s59, s62
    s_add_u32 s59, s59, 58880
    s_add_u32 s60, s59, 6144
    s_lshl_b32 s57, s58, 10
    v_lshlrev_b32 v16, 4, v0
    v_add_u32 v16, s57, v16
    v_and_b32 v17, 7, v0
    v_lshlrev_b32 v17, 3, v17
    s_cmp_eq_u32 s30, 4
    s_cbranch_scc0 L_skip_93
    buffer_load_dwordx2 v[12:13], v17, s[40:43], s60 offen sc1 nt
    s_branch L_skip_92
L_skip_93:
    buffer_load_dwordx4 v[12:15], v16, s[40:43], s59 offen sc1 nt
    buffer_load_dwordx4 v[20:23], v16, s[40:43], s59 offen offset:3072 sc1 nt
L_skip_92:
    s_waitcnt vmcnt(36)
    s_barrier
    ds_read_b64_tr_b16 v[160:161], v8 offset:0
    ds_read_b64_tr_b16 v[168:169], v9 offset:0
    ds_read_b64_tr_b16 v[176:177], v10 offset:0
    ds_read_b64_tr_b16 v[184:185], v11 offset:0
    s_cmp_eq_u32 s30, 6
    s_cbranch_scc0 L_skip_94
    s_mul_i32 s57, s14, 11
    s_mov_b32 m0, 53248
    s_nop 0
    buffer_load_dwordx4 v3, s[48:51], s57 offen offset:0 nt lds
    s_mul_i32 s57, s14, 11
    s_add_u32 s57, s57, s15
    s_mov_b32 m0, 53248
    s_nop 0
    buffer_load_dwordx4 v3, s[48:51], s57 offen offset:1024 nt lds
    s_xor_b32 s57, s71, 1
    s_mul_i32 s57, s57, 196608
    s_add_u32 s57, s57, 1024
    s_xor_b32 s58, s71, 3
    s_mul_i32 s58, s58, 196608
    s_add_u32 s58, s58, 0
    s_mov_b32 m0, 141312
L_dma_95:
    s_waitcnt vmcnt(23)
    s_cmp_ge_u32 s70, 2
    s_cbranch_scc1 L_go_96
    s_waitcnt vmcnt(22)
    s_cmp_ge_u32 s70, 1
    s_cbranch_scc1 L_go_96
    s_waitcnt vmcnt(21)
L_go_96:
    buffer_load_dwordx4 v7, s[36:39], s57 offen offset:0 nt lds
    buffer_load_dwordx4 v7, s[36:39], s58 offen offset:1024 nt lds
    s_add_u32 s57, s57, 24576
    s_add_u32 s58, s58, 24576
    s_add_u32 m0, m0, 2048
    s_cmp_lg_u32 m0, 157696
    s_cbranch_scc1 L_dma_95
L_skip_94:
    s_waitcnt lgkmcnt(0)
    s_waitcnt vmcnt(36)
    s_barrier
    ds_read_b64_tr_b16 v[192:193], v8 offset:16384
    ds_read_b64_tr_b16 v[200:201], v9 offset:16384
    ds_read_b64_tr_b16 v[208:209], v10 offset:16384
    ds_read_b64_tr_b16 v[216:217], v11 offset:16384
    s_cmp_eq_u32 s30, 6
    s_cbranch_scc0 L_skip_97
    s_mul_i32 s57, s14, 12
    s_mov_b32 m0, 55296
    s_nop 0
    buffer_load_dwordx4 v3, s[48:51], s57 offen offset:0 nt lds
    s_mul_i32 s57, s14, 12
    s_add_u32 s57, s57, s15
    s_mov_b32 m0, 55296
    s_nop 0
    buffer_load_dwordx4 v3, s[48:51], s57 offen offset:1024 nt lds
    s_xor_b32 s57, s71, 1
    s_mul_i32 s57, s57, 196608
    s_add_u32 s57, s57, 1152
    s_xor_b32 s58, s71, 3
    s_mul_i32 s58, s58, 196608
    s_add_u32 s58, s58, 128
    s_mov_b32 m0, 92160
L_dma_98:
    s_waitcnt vmcnt(23)
    s_cmp_ge_u32 s70, 2
    s_cbranch_scc1 L_go_99
    s_waitcnt vmcnt(22)
    s_cmp_ge_u32 s70, 1
    s_cbranch_scc1 L_go_99
    s_waitcnt vmcnt(21)
L_go_99:
    buffer_load_dwordx4 v7, s[36:39], s57 offen offset:0 nt lds
    buffer_load_dwordx4 v7, s[36:39], s58 offen offset:1024 nt lds
    s_add_u32 s57, s57, 24576
    s_add_u32 s58, s58, 24576
    s_add_u32 m0, m0, 2048
    s_cmp_lg_u32 m0, 108544
    s_cbranch_scc1 L_dma_98
L_skip_97:
    s_waitcnt lgkmcnt(0)
    s_sub_u32 s58, s30, 1
    s_cmp_lt_u32 s58, 4
    s_cbranch_scc0 L_skip_100
    s_waitcnt vmcnt(0)
    s_cmp_eq_u32 s30, 4
    s_cbranch_scc0 L_skip_101
    v_add_f32_dpp v12, v12, v12 row_ror:4 row_mask:0xf bank_mask:0xf
    v_add_f32_dpp v13, v13, v13 row_ror:4 row_mask:0xf bank_mask:0xf
    s_nop 0
    v_add_f32_dpp v12, v12, v12 row_ror:2 row_mask:0xf bank_mask:0xf
    v_add_f32_dpp v13, v13, v13 row_ror:2 row_mask:0xf bank_mask:0xf
    s_nop 0
    v_add_f32_dpp v12, v12, v12 row_ror:1 row_mask:0xf bank_mask:0xf
    v_add_f32_dpp v13, v13, v13 row_ror:1 row_mask:0xf bank_mask:0xf
    v_mul_f32 v12, 0x3acccccd, v12
    v_mul_f32 v13, 0x3acccccd, v13
    v_fma_f32 v13, -v12, v12, v13
    v_max_f32 v13, 0, v13
    v_add_f32 v13, 0x3727c5ac, v13
    v_rsq_f32 v13, v13
    s_nop 0
    v_mul_f32 v13, 0x3dd53b95, v13
    v_mul_f32 v12, -v12, v13
    v_mov_b32 v16, 80640
    ds_write_b64 v16, v[12:13]
    s_waitcnt lgkmcnt(0)
    s_branch L_skip_100
L_skip_101:
    s_lshl_b32 s57, s58, 7
    v_lshrrev_b32 v16, 4, v0
    v_lshlrev_b32 v16, 5, v16
    v_bfe_u32 v60, v0, 1, 1
    v_lshl_add_u32 v16, v60, 4, v16
    v_bfe_u32 v60, v0, 2, 2
    v_lshl_add_u32 v16, v60, 2, v16
    v_and_b32 v60, 1, v0
    v_lshl_add_u32 v16, v60, 1, v16
    v_add_u32 v16, s57, v16
    v_add_u32 v16, 79872, v16
    v_mov_b32 v17, 0x3f803f80
    v_dot2_f32_bf16 v24, v12, v17, 0
    v_dot2_f32_bf16 v25, v13, v17, 0
    v_dot2_f32_bf16 v24, v14, v17, v24
    v_dot2_f32_bf16 v25, v15, v17, v25
    s_nop 2
    v_add_f32 v24, v24, v25
    v_cvt_pk_bf16_f32 v24, v24, v24
    ds_write_b16 v16, v24 offset:0
    v_dot2_f32_bf16 v24, v20, v17, 0
    v_dot2_f32_bf16 v25, v21, v17, 0
    v_dot2_f32_bf16 v24, v22, v17, v24
    v_dot2_f32_bf16 v25, v23, v17, v25
    s_nop 2
    v_add_f32 v24, v24, v25
    v_cvt_pk_bf16_f32 v24, v24, v24
    ds_write_b16 v16, v24 offset:384
    s_waitcnt lgkmcnt(0)
L_skip_100:
    s_waitcnt vmcnt(36)
    s_barrier
    ds_read_b64_tr_b16 v[224:225], v8 offset:32768
    ds_read_b64_tr_b16 v[232:233], v9 offset:32768
    ds_read_b64_tr_b16 v[240:241], v10 offset:32768
    ds_read_b64_tr_b16 v[248:249], v11 offset:32768
    s_cmp_eq_u32 s30, 6
    s_cbranch_scc0 L_skip_102
    s_mul_i32 s57, s14, 13
    s_mov_b32 m0, 57344
    s_nop 0
    buffer_load_dwordx4 v3, s[48:51], s57 offen offset:0 nt lds
    s_mul_i32 s57, s14, 13
    s_add_u32 s57, s57, s15
    s_mov_b32 m0, 57344
    s_nop 0
    buffer_load_dwordx4 v3, s[48:51], s57 offen offset:1024 nt lds
    s_xor_b32 s57, s71, 1
    s_mul_i32 s57, s57, 196608
    s_add_u32 s57, s57, 1280
    s_xor_b32 s58, s71, 3
    s_mul_i32 s58, s58, 196608
    s_add_u32 s58, s58, 256
    s_mov_b32 m0, 108544
L_dma_103:
    s_nop 0
    buffer_load_dwordx4 v7, s[36:39], s57 offen offset:0 nt lds
    buffer_load_dwordx4 v7, s[36:39], s58 offen offset:1024 nt lds
    s_add_u32 s57, s57, 24576
    s_add_u32 s58, s58, 24576
    s_add_u32 m0, m0, 2048
    s_cmp_lg_u32 m0, 124928
    s_cbranch_scc1 L_dma_103
L_skip_102:
    s_waitcnt lgkmcnt(0)
    v_lshrrev_b32 v5, 4, v0
    v_lshlrev_b32 v5, 5, v5
    v_bfe_u32 v60, v0, 1, 1
    v_lshl_add_u32 v5, v60, 4, v5
    v_add_u32 v5, 79872, v5
    ds_read_b128 v[12:15], v5 offset:384
    ds_read_b128 v[16:19], v5 offset:512
    ds_read_b128 v[20:23], v5 offset:640
    s_lshl_b32 s57, s30, 7
    s_add_u32 s57, s57, 158720
    v_lshrrev_b32 v58, 4, v0
    v_lshlrev_b32 v58, 5, v58
    v_bfe_u32 v60, v0, 1, 1
    v_lshl_add_u32 v58, v60, 4, v58
    v_bfe_u32 v60, v0, 2, 2
    v_lshl_add_u32 v58, v60, 2, v58
    v_and_b32 v60, 1, v0
    v_lshl_add_u32 v58, v60, 1, v58
    v_add_u32 v58, s57, v58
    v_lshrrev_b32 v61, 4, v0
    v_lshlrev_b32 v61, 5, v61
    v_bfe_u32 v60, v0, 1, 1
    v_lshl_add_u32 v61, v60, 4, v61
    v_add_u32 v61, s57, v61
    v_bfe_u32 v62, v0, 2, 2
    v_lshlrev_b32 v62, 1, v62
    v_and_b32 v60, 1, v0
    v_lshl_add_u32 v62, v60, 0, v62
    v_mov_b32 v60, 160992
    v_cmp_eq_u32 vcc, 0, v62
    s_nop 1
    v_cndmask_b32 v52, v60, v61, vcc
    v_cmp_eq_u32 vcc, 1, v62
    s_nop 1
    v_cndmask_b32 v53, v60, v61, vcc
    v_cmp_eq_u32 vcc, 2, v62
    s_nop 1
    v_cndmask_b32 v54, v60, v61, vcc
    v_cmp_eq_u32 vcc, 3, v62
    s_nop 1
    v_cndmask_b32 v55, v60, v61, vcc
    v_cmp_eq_u32 vcc, 4, v62
    s_nop 1
    v_cndmask_b32 v56, v60, v61, vcc
    v_cmp_eq_u32 vcc, 5, v62
    s_nop 1
    v_cndmask_b32 v57, v60, v61, vcc
    s_lshl_b32 s58, s30, 2
    s_add_u32 s58, s58, 159744
    v_mov_b32 v60, s58
    v_lshlrev_b32 v59, 2, v0
    v_add_u32 v59, 157696, v59
    v_cmp_eq_u32 vcc, 63, v0
    s_nop 1
    v_cndmask_b32 v59, v59, v60, vcc
    v_and_b32 v62, 7, v0
    v_lshlrev_b32 v62, 2, v62
    v_add_u32 v62, 159744, v62
    s_lshl_b32 s57, s30, 11
    v_lshlrev_b32 v63, 4, v0
    v_add_u32 v63, s57, v63
    v_add_u32 v63, 92160, v63
    v_mov_b64 v[24:25], 0
    v_mov_b64 v[26:27], 0
    v_mov_b64 v[28:29], 0
    v_mov_b64 v[30:31], 0
    v_mov_b64 v[32:33], 0
    v_mov_b64 v[34:35], 0
    v_mov_b64 v[36:37], 0
    v_mov_b64 v[38:39], 0
    v_mov_b64 v[40:41], 0
    v_mov_b64 v[42:43], 0
    v_mov_b64 v[44:45], 0
    v_mov_b64 v[46:47], 0
    s_waitcnt lgkmcnt(0)
    v_smfmac_f32_16x16x64_bf16 v[24:27], v[12:15], v[64:71], v1
    v_smfmac_f32_16x16x64_bf16 v[24:27], v[16:19], v[72:79], v1
    v_smfmac_f32_16x16x64_bf16 v[24:27], v[20:23], v[80:87], v1
    v_smfmac_f32_16x16x64_bf16 v[28:31], v[12:15], v[88:95], v1
    v_smfmac_f32_16x16x64_bf16 v[28:31], v[16:19], v[96:103], v1
    v_smfmac_f32_16x16x64_bf16 v[28:31], v[20:23], v[104:111], v1
    v_smfmac_f32_16x16x64_bf16 v[32:35], v[12:15], v[112:119], v1
    v_smfmac_f32_16x16x64_bf16 v[32:35], v[16:19], v[120:127], v1
    v_smfmac_f32_16x16x64_bf16 v[32:35], v[20:23], v[128:135], v1
    v_smfmac_f32_16x16x64_bf16 v[36:39], v[12:15], v[136:143], v1
    v_smfmac_f32_16x16x64_bf16 v[36:39], v[16:19], v[144:151], v1
    v_smfmac_f32_16x16x64_bf16 v[36:39], v[20:23], v[152:159], v1
    v_add_f32_dpp v6, v24, v26 quad_perm:[0,1,2,3] row_mask:0x1 bank_mask:0xf
    s_nop 1
    v_add_f32_dpp v6, v28, v30 quad_perm:[0,1,2,3] row_mask:0x2 bank_mask:0xf
    s_nop 1
    v_add_f32_dpp v6, v32, v34 quad_perm:[0,1,2,3] row_mask:0x4 bank_mask:0xf
    s_nop 1
    v_add_f32_dpp v6, v36, v38 quad_perm:[0,1,2,3] row_mask:0x8 bank_mask:0xf
    s_waitcnt vmcnt(36)
    s_barrier
    ds_read_b64_tr_b16 v[162:163], v8 offset:49152
    ds_read_b64_tr_b16 v[170:171], v9 offset:49152
    ds_read_b64_tr_b16 v[178:179], v10 offset:49152
    ds_read_b64_tr_b16 v[186:187], v11 offset:49152
    s_cmp_eq_u32 s30, 6
    s_cbranch_scc0 L_skip_104
    s_mul_i32 s57, s14, 14
    s_mov_b32 m0, 59392
    s_nop 0
    buffer_load_dwordx4 v3, s[48:51], s57 offen offset:0 nt lds
    s_mul_i32 s57, s14, 14
    s_add_u32 s57, s57, s15
    s_mov_b32 m0, 59392
    s_nop 0
    buffer_load_dwordx4 v3, s[48:51], s57 offen offset:1024 nt lds
    s_xor_b32 s57, s71, 4
    s_mul_i32 s57, s57, 196608
    s_add_u32 s57, s57, 1024
    s_xor_b32 s58, s71, 6
    s_mul_i32 s58, s58, 196608
    s_add_u32 s58, s58, 0
    s_mov_b32 m0, 124928
L_dma_105:
    s_nop 0
    buffer_load_dwordx4 v7, s[36:39], s57 offen offset:0 nt lds
    buffer_load_dwordx4 v7, s[36:39], s58 offen offset:1024 nt lds
    s_add_u32 s57, s57, 24576
    s_add_u32 s58, s58, 24576
    s_add_u32 m0, m0, 2048
    s_cmp_lg_u32 m0, 141312
    s_cbranch_scc1 L_dma_105
L_skip_104:
    s_waitcnt lgkmcnt(0)
    v_mov_b32 v48, 80640
    ds_read_b128 v[12:15], v5 offset:0
    ds_read_b128 v[16:19], v5 offset:128
    ds_read_b128 v[20:23], v5 offset:256
    ds_read_b64 v[48:49], v48
    v_mov_b64 v[24:25], 0
    v_mov_b64 v[26:27], 0
    v_mov_b64 v[28:29], 0
    v_mov_b64 v[30:31], 0
    v_mov_b64 v[32:33], 0
    v_mov_b64 v[34:35], 0
    v_mov_b64 v[36:37], 0
    v_mov_b64 v[38:39], 0
    s_waitcnt lgkmcnt(0)
    v_smfmac_f32_16x16x64_bf16 v[24:27], v[12:15], v[64:71], v1
    v_smfmac_f32_16x16x64_bf16 v[24:27], v[16:19], v[72:79], v1
    v_smfmac_f32_16x16x64_bf16 v[24:27], v[20:23], v[80:87], v1
    v_smfmac_f32_16x16x64_bf16 v[28:31], v[12:15], v[88:95], v1
    v_smfmac_f32_16x16x64_bf16 v[28:31], v[16:19], v[96:103], v1
    v_smfmac_f32_16x16x64_bf16 v[28:31], v[20:23], v[104:111], v1
    v_smfmac_f32_16x16x64_bf16 v[32:35], v[12:15], v[112:119], v1
    v_smfmac_f32_16x16x64_bf16 v[32:35], v[16:19], v[120:127], v1
    v_smfmac_f32_16x16x64_bf16 v[32:35], v[20:23], v[128:135], v1
    v_smfmac_f32_16x16x64_bf16 v[36:39], v[12:15], v[136:143], v1
    v_smfmac_f32_16x16x64_bf16 v[36:39], v[16:19], v[144:151], v1
    v_smfmac_f32_16x16x64_bf16 v[36:39], v[20:23], v[152:159], v1
    v_add_f32_dpp v61, v24, v26 quad_perm:[0,1,2,3] row_mask:0x1 bank_mask:0xf
    v_mul_f32 v48, v48, v6
    s_nop 0
    v_add_f32_dpp v61, v28, v30 quad_perm:[0,1,2,3] row_mask:0x2 bank_mask:0xf
    s_nop 1
    v_add_f32_dpp v61, v32, v34 quad_perm:[0,1,2,3] row_mask:0x4 bank_mask:0xf
    s_nop 1
    v_add_f32_dpp v61, v36, v38 quad_perm:[0,1,2,3] row_mask:0x8 bank_mask:0xf
    v_fma_f32 v36, v61, v49, v48
    s_nop 1
    v_max_f32_dpp v37, v36, v36 row_ror:8 row_mask:0xf bank_mask:0xf
    s_nop 1
    v_max_f32_dpp v37, v37, v37 row_ror:4 row_mask:0xf bank_mask:0xf
    s_nop 1
    v_max_f32_dpp v37, v37, v37 row_ror:2 row_mask:0xf bank_mask:0xf
    s_nop 1
    v_max_f32_dpp v37, v37, v37 row_ror:1 row_mask:0xf bank_mask:0xf
    s_nop 1
    v_max_f32_dpp v37, v37, v37 row_bcast:15 row_mask:0xa bank_mask:0xf
    s_nop 1
    v_max_f32_dpp v37, v37, v37 row_bcast:31 row_mask:0xc bank_mask:0xf
    s_nop 0
    v_readlane_b32 s64, v37, 63
    ds_write_b32 v59, v37
    s_nop 0
    v_subrev_f32 v36, s64, v36
    v_exp_f32 v36, v36
    s_nop 0
    v_cvt_pk_bf16_f32 v39, v36, v36
    ds_write_b16 v58, v39
    ds_read_b128 v[12:15], v52
    ds_read_b128 v[16:19], v53
    ds_read_b128 v[20:23], v54
    ds_read_b128 v[24:27], v55
    ds_read_b128 v[28:31], v56
    ds_read_b128 v[32:35], v57
    v_add_f32_dpp v38, v36, v36 row_ror:8 row_mask:0xf bank_mask:0xf
    s_nop 1
    v_add_f32_dpp v38, v38, v38 row_ror:4 row_mask:0xf bank_mask:0xf
    s_nop 1
    v_add_f32_dpp v38, v38, v38 row_ror:2 row_mask:0xf bank_mask:0xf
    s_nop 1
    v_add_f32_dpp v38, v38, v38 row_ror:1 row_mask:0xf bank_mask:0xf
    s_nop 1
    v_add_f32_dpp v38, v38, v38 row_bcast:15 row_mask:0xa bank_mask:0xf
    s_nop 1
    v_add_f32_dpp v38, v38, v38 row_bcast:31 row_mask:0xc bank_mask:0xf
    s_waitcnt lgkmcnt(0)
    s_waitcnt vmcnt(36)
    s_barrier
    ds_read_b64_tr_b16 v[194:195], v8 offset:0
    ds_read_b64_tr_b16 v[202:203], v9 offset:0
    ds_read_b64_tr_b16 v[210:211], v10 offset:0
    ds_read_b64_tr_b16 v[218:219], v11 offset:0
    s_cmp_eq_u32 s30, 6
    s_cbranch_scc0 L_skip_106
    s_mul_i32 s57, s14, 15
    s_mov_b32 m0, 61440
    s_nop 0
    buffer_load_dwordx4 v3, s[48:51], s57 offen offset:0 nt lds
    s_mul_i32 s57, s14, 15
    s_add_u32 s57, s57, s15
    s_mov_b32 m0, 61440
    s_nop 0
    buffer_load_dwordx4 v3, s[48:51], s57 offen offset:1024 nt lds
    s_xor_b32 s57, s71, 4
    s_mul_i32 s57, s57, 196608
    s_add_u32 s57, s57, 1152
    s_xor_b32 s58, s71, 6
    s_mul_i32 s58, s58, 196608
    s_add_u32 s58, s58, 128
    s_mov_b32 m0, 141312
L_dma_107:
    s_waitcnt vmcnt(23)
    s_cmp_ge_u32 s70, 2
    s_cbranch_scc1 L_go_108
    s_waitcnt vmcnt(22)
    s_cmp_ge_u32 s70, 1
    s_cbranch_scc1 L_go_108
    s_waitcnt vmcnt(21)
L_go_108:
    buffer_load_dwordx4 v7, s[36:39], s57 offen offset:0 nt lds
    buffer_load_dwordx4 v7, s[36:39], s58 offen offset:1024 nt lds
    s_add_u32 s57, s57, 24576
    s_add_u32 s58, s58, 24576
    s_add_u32 m0, m0, 2048
    s_cmp_lg_u32 m0, 157696
    s_cbranch_scc1 L_dma_107
L_skip_106:
    s_waitcnt lgkmcnt(0)
    ds_read_b32 v36, v62
    s_waitcnt lgkmcnt(0)
    v_max_f32_dpp v37, v36, v36 row_ror:4 row_mask:0xf bank_mask:0xf
    s_nop 1
    v_max_f32_dpp v37, v37, v37 row_ror:2 row_mask:0xf bank_mask:0xf
    s_nop 1
    v_max_f32_dpp v37, v37, v37 row_ror:1 row_mask:0xf bank_mask:0xf
    v_sub_f32 v39, s64, v37
    v_exp_f32 v39, v39
    s_cmp_lt_u32 s30, 2
    s_cbranch_scc0 L_skip_109
    s_lshl_b32 s57, s30, 3
    v_lshlrev_b32 v2, 4, v0
    v_add_u32 v2, s57, v2
    v_add_u32 v2, 92160, v2
    v_mov_b32 v60, 94192
    v_cmp_le_u32 vcc, 48, v0
    s_nop 1
    v_cndmask_b32 v2, v2, v60, vcc
    s_lshr_b32 s57, s54, 1
    s_lshl_b32 s57, s57, 2
    s_and_b32 s58, s54, 1
    s_add_u32 s57, s57, s58
    s_lshl_b32 s58, s57, 4
    s_lshl_b32 s57, s57, 3
    v_bfe_u32 v3, v0, 3, 2
    v_lshlrev_b32 v3, 8, v3
    v_bfe_u32 v61, v0, 2, 1
    v_lshl_add_u32 v3, v61, 5, v3
    v_and_b32 v61, 3, v0
    v_lshl_add_u32 v3, v61, 2, v3
    v_add_u32 v3, s58, v3
    v_bfe_u32 v60, v0, 3, 1
    v_lshlrev_b32 v60, 8, v60
    v_bfe_u32 v61, v0, 1, 1
    v_lshl_add_u32 v60, v61, 7, v60
    v_bfe_u32 v61, v0, 2, 1
    v_lshl_add_u32 v60, v61, 4, v60
    v_and_b32 v61, 1, v0
    v_lshl_add_u32 v60, v61, 2, v60
    v_add_u32 v60, s57, v60
    v_add_u32 v60, 1024, v60
    v_cmp_gt_u32 vcc, 32, v0
    s_nop 1
    v_cndmask_b32 v3, v60, v3, vcc
    s_lshl_b32 s57, s53, 1
    s_add_u32 s57, s57, s30
    s_mul_i32 s57, s57, 1664
    s_add_u32 s57, s57, s62
    v_add_u32 v3, s57, v3
    v_mov_b32 v60, 0x7f000000
    v_cmp_le_u32 vcc, 48, v0
    s_nop 1
    v_cndmask_b32 v3, v3, v60, vcc
    s_lshl_b32 s58, s54, 2
    s_add_u32 s57, s57, s58
    s_add_u32 s57, s57, 1536
    v_mov_b32 v4, s57
    v_mov_b32 v60, 0x7f000000
    v_cmp_ne_u32 vcc, 48, v0
    s_nop 1
    v_cndmask_b32 v4, v4, v60, vcc
    s_mov_b32 s58, 0
    v_min_u32 v37, -2, v37
    s_cmp_eq_u32 s55, 0
    s_cbranch_scc1 L_gs_110
    buffer_store_dword v37, v4, s[40:43], s58 offen
L_gb_111:
L_skip_109:
    s_waitcnt vmcnt(36)
    s_barrier
    ds_read_b64_tr_b16 v[226:227], v8 offset:16384
    ds_read_b64_tr_b16 v[234:235], v9 offset:16384
    ds_read_b64_tr_b16 v[242:243], v10 offset:16384
    ds_read_b64_tr_b16 v[250:251], v11 offset:16384
    s_cmp_eq_u32 s30, 6
    s_cbranch_scc0 L_skip_112
    s_xor_b32 s57, s71, 4
    s_mul_i32 s57, s57, 196608
    s_add_u32 s57, s57, 1280
    s_xor_b32 s58, s71, 6
    s_mul_i32 s58, s58, 196608
    s_add_u32 s58, s58, 256
    s_mov_b32 m0, 92160
L_dma_113:
    s_nop 0
    buffer_load_dwordx4 v7, s[36:39], s57 offen offset:0 nt lds
    buffer_load_dwordx4 v7, s[36:39], s58 offen offset:1024 nt lds
    s_add_u32 s57, s57, 24576
    s_add_u32 s58, s58, 24576
    s_add_u32 m0, m0, 2048
    s_cmp_lg_u32 m0, 108544
    s_cbranch_scc1 L_dma_113
L_skip_112:
    s_waitcnt lgkmcnt(0)
    s_cmp_eq_u32 s30, 5
    s_cbranch_scc0 L_skip_114
    global_load_dword v2, v3, s[26:27] offset:4 sc1
L_skip_114:
    s_waitcnt vmcnt(34)
    s_barrier
    ds_read_b64_tr_b16 v[164:165], v8 offset:32768
    ds_read_b64_tr_b16 v[172:173], v9 offset:32768
    ds_read_b64_tr_b16 v[180:181], v10 offset:32768
    ds_read_b64_tr_b16 v[188:189], v11 offset:32768
    s_cmp_eq_u32 s30, 6
    s_cbranch_scc0 L_skip_115
    s_xor_b32 s57, s71, 5
    s_mul_i32 s57, s57, 196608
    s_add_u32 s57, s57, 1024
    s_xor_b32 s58, s71, 7
    s_mul_i32 s58, s58, 196608
    s_add_u32 s58, s58, 0
    s_mov_b32 m0, 108544
L_dma_116:
    s_nop 0
    buffer_load_dwordx4 v7, s[36:39], s57 offen offset:0 nt lds
    buffer_load_dwordx4 v7, s[36:39], s58 offen offset:1024 nt lds
    s_add_u32 s57, s57, 24576
    s_add_u32 s58, s58, 24576
    s_add_u32 m0, m0, 2048
    s_cmp_lg_u32 m0, 124928
    s_cbranch_scc1 L_dma_116
L_skip_115:
    s_waitcnt lgkmcnt(0)
    s_waitcnt vmcnt(32)
    s_barrier
    ds_read_b64_tr_b16 v[196:197], v8 offset:49152
    ds_read_b64_tr_b16 v[204:205], v9 offset:49152
    ds_read_b64_tr_b16 v[212:213], v10 offset:49152
    ds_read_b64_tr_b16 v[220:221], v11 offset:49152
    s_cmp_eq_u32 s30, 6
    s_cbranch_scc0 L_skip_117
    s_xor_b32 s57, s71, 5
    s_mul_i32 s57, s57, 196608
    s_add_u32 s57, s57, 1152
    s_xor_b32 s58, s71, 7
    s_mul_i32 s58, s58, 196608
    s_add_u32 s58, s58, 128
    s_mov_b32 m0, 124928
L_dma_118:
    s_nop 0
    buffer_load_dwordx4 v7, s[36:39], s57 offen offset:0 nt lds
    buffer_load_dwordx4 v7, s[36:39], s58 offen offset:1024 nt lds
    s_add_u32 s57, s57, 24576
    s_add_u32 s58, s58, 24576
    s_add_u32 m0, m0, 2048
    s_cmp_lg_u32 m0, 141312
    s_cbranch_scc1 L_dma_118
L_skip_117:
    s_waitcnt lgkmcnt(0)
    s_cmp_eq_u32 s30, 5
    s_cbranch_scc0 L_skip_119
L_cw_120:
    s_waitcnt vmcnt(0)
    v_cmp_eq_u32 vcc, 0, v2
    s_cbranch_vccnz L_cr_121
    v_add_u32_dpp v2, v2, v2 row_ror:4 row_mask:0xf bank_mask:0xf
    s_nop 1
    v_add_u32_dpp v2, v2, v2 row_ror:2 row_mask:0xf bank_mask:0xf
    s_nop 1
    v_add_u32_dpp v2, v2, v2 row_ror:1 row_mask:0xf bank_mask:0xf
    v_mov_b32 v60, 160772
    ds_write_b32 v60, v2
    s_waitcnt lgkmcnt(0)
L_skip_119:
    s_cmp_eq_u32 s30, 2
    s_cbranch_scc0 L_skip_122
    s_sub_u32 s57, s3, 20
    s_cmp_lt_u32 s57, 4
    s_cbranch_scc0 L_skip_123
    s_sub_u32 s57, s3, 20
    s_lshl_b32 s57, s57, 6
    v_add_u32 v50, s57, v0
    v_min_u32 v50, 210, v50
    v_lshlrev_b32 v50, 7, v50
    s_add_u32 s57, s62, 0
    buffer_load_dword v50, v50, s[40:43], s57 offen sc1 nt
    s_sub_u32 s57, s3, 20
    s_lshl_b32 s57, s57, 6
    v_add_u32 v51, s57, v0
    v_min_u32 v51, 247, v51
    v_lshlrev_b32 v51, 7, v51
    s_add_u32 s57, s62, 27008
    buffer_load_dword v51, v51, s[40:43], s57 offen sc1 nt
L_skip_123:
L_skip_122:
    s_waitcnt vmcnt(32)
    s_barrier
    ds_read_b64_tr_b16 v[228:229], v8 offset:0
    ds_read_b64_tr_b16 v[236:237], v9 offset:0
    ds_read_b64_tr_b16 v[244:245], v10 offset:0
    ds_read_b64_tr_b16 v[252:253], v11 offset:0
    s_cmp_eq_u32 s30, 6
    s_cbranch_scc0 L_skip_124
    s_xor_b32 s57, s71, 5
    s_mul_i32 s57, s57, 196608
    s_add_u32 s57, s57, 1280
    s_xor_b32 s58, s71, 7
    s_mul_i32 s58, s58, 196608
    s_add_u32 s58, s58, 256
    s_mov_b32 m0, 141312
L_dma_125:
    s_nop 0
    buffer_load_dwordx4 v7, s[36:39], s57 offen offset:0 nt lds
    buffer_load_dwordx4 v7, s[36:39], s58 offen offset:1024 nt lds
    s_add_u32 s57, s57, 24576
    s_add_u32 s58, s58, 24576
    s_add_u32 m0, m0, 2048
    s_cmp_lg_u32 m0, 157696
    s_cbranch_scc1 L_dma_125
L_skip_124:
    s_waitcnt lgkmcnt(0)
    s_cmp_eq_u32 s30, 7
    s_cbranch_scc0 L_skip_126
    v_mov_b32 v60, 160772
    ds_read_b32 v60, v60
    s_lshr_b32 s58, s63, 2
    s_waitcnt lgkmcnt(0)
    v_readfirstlane_b32 s57, v60
    s_cmp_gt_u32 s57, 24
    s_cselect_b32 s57, 1, 0
    s_xor_b32 s57, s57, s58
    s_lshl_b32 s57, s57, 13
    s_add_u32 s7, s8, s57
L_skip_126:
    s_branch L_tail
.p2align 10
L_tail:
L_pad0:
    s_cbranch_execz L_pad4
    s_waitcnt vmcnt(32)
    s_barrier
    ds_read_b64_tr_b16 v[166:167], v8 offset:16384
    ds_read_b64_tr_b16 v[174:175], v9 offset:16384
    ds_read_b64_tr_b16 v[182:183], v10 offset:16384
    ds_read_b64_tr_b16 v[190:191], v11 offset:16384
    s_waitcnt lgkmcnt(0)
    s_cmp_lt_u32 s30, 5
    s_cbranch_scc0 L_skip_127
    s_waitcnt vmcnt(0)
L_skip_127:
    v_smfmac_f32_16x16x64_bf16 v[40:43], v[12:15], v[160:167], v1
    v_smfmac_f32_16x16x64_bf16 v[40:43], v[16:19], v[168:175], v1
    v_smfmac_f32_16x16x64_bf16 v[40:43], v[20:23], v[176:183], v1
    v_smfmac_f32_16x16x64_bf16 v[40:43], v[24:27], v[184:191], v1
    s_cmp_eq_u32 s30, 6
    s_cbranch_scc0 L_skip_128
    s_mul_i32 s57, s14, 16
    s_add_u32 s58, s57, s15
    s_mov_b32 m0, 63488
L_dma_129:
    s_nop 0
    buffer_load_dwordx4 v3, s[48:51], s57 offen offset:0 nt lds
    buffer_load_dwordx4 v3, s[48:51], s58 offen offset:1024 nt lds
    s_add_u32 s57, s57, s14
    s_add_u32 s58, s58, s14
    s_add_u32 m0, m0, 2048
    s_cmp_lg_u32 m0, 71680
    s_cbranch_scc1 L_dma_129
    s_mul_i32 s57, s14, 20
    s_add_u32 s58, s57, s15
    s_mov_b32 m0, 71680
L_dma_130:
    s_nop 0
    buffer_load_dwordx4 v3, s[48:51], s57 offen offset:0 nt lds
    buffer_load_dwordx4 v3, s[48:51], s58 offen offset:1024 nt lds
    s_add_u32 s57, s57, s14
    s_add_u32 s58, s58, s14
    s_add_u32 m0, m0, 2048
    s_cmp_lg_u32 m0, 79872
    s_cbranch_scc1 L_dma_130
L_skip_128:
    s_waitcnt vmcnt(32)
    s_barrier
    ds_read_b64_tr_b16 v[198:199], v8 offset:32768
    ds_read_b64_tr_b16 v[206:207], v9 offset:32768
    ds_read_b64_tr_b16 v[214:215], v10 offset:32768
    ds_read_b64_tr_b16 v[222:223], v11 offset:32768
    s_waitcnt lgkmcnt(0)
    v_smfmac_f32_16x16x64_bf16 v[40:43], v[28:31], v[192:199], v1
    v_smfmac_f32_16x16x64_bf16 v[40:43], v[32:35], v[200:207], v1
    v_smfmac_f32_16x16x64_bf16 v[44:47], v[12:15], v[208:215], v1
    v_smfmac_f32_16x16x64_bf16 v[44:47], v[16:19], v[216:223], v1
    v_mul_f32 v38, v38, v39
    ds_write_b32 v63, v38 offset:1024
    s_waitcnt vmcnt(16)
    s_barrier
    ds_read_b64_tr_b16 v[230:231], v8 offset:49152
    ds_read_b64_tr_b16 v[238:239], v9 offset:49152
    ds_read_b64_tr_b16 v[246:247], v10 offset:49152
    ds_read_b64_tr_b16 v[254:255], v11 offset:49152
    s_waitcnt lgkmcnt(0)
    v_smfmac_f32_16x16x64_bf16 v[44:47], v[20:23], v[224:231], v1
    v_smfmac_f32_16x16x64_bf16 v[44:47], v[24:27], v[232:239], v1
    v_smfmac_f32_16x16x64_bf16 v[44:47], v[28:31], v[240:247], v1
    v_smfmac_f32_16x16x64_bf16 v[44:47], v[32:35], v[248:255], v1
    s_setprio 0
    s_cmp_lt_u32 s30, 2
    v_pk_add_f32 v[40:41], v[40:41], v[42:43]
    s_nop 4
    v_pk_add_f32 v[42:43], v[44:45], v[46:47]
    v_pk_mul_f32 v[40:41], v[40:41], v[38:39] op_sel:[0,1] op_sel_hi:[1,1]
    v_pk_mul_f32 v[42:43], v[42:43], v[38:39] op_sel:[0,1] op_sel_hi:[1,1]
    ds_write_b128 v63, v[40:43]
    s_cbranch_scc1 L_comb_0
    s_waitcnt lgkmcnt(0)
    s_barrier
L_comb_0b:
    s_cmp_eq_u32 s30, 6
    s_cbranch_scc0 L_skip_135
    s_waitcnt vmcnt(0)
L_skip_135:
    s_barrier
    s_cmp_lt_u32 s3, 20
    s_cbranch_scc0 L_typeB_0
    s_mul_i32 s60, s30, 1664
    s_add_u32 s60, s60, s62
    s_add_u32 s60, s60, 0
    v_and_b32 v5, 7, v0
    v_lshlrev_b32 v5, 2, v5
    v_lshrrev_b32 v22, 4, v0
    v_lshlrev_b32 v22, 3, v22
L_pad1:
    s_cbranch_execz L_pad5
    buffer_load_dword v18, v5, s[40:43], s60 offen offset:1536 sc1
    buffer_load_dwordx2 v[20:21], v22, s[40:43], s60 offen offset:1536 sc1
    v_lshlrev_b32 v9, 4, v0
    v_lshlrev_b32 v10, 3, v0
    s_mul_i32 s57, s30, 6144
    v_lshrrev_b32 v7, 2, v0
    v_lshlrev_b32 v7, 6, v7
    v_bfe_u32 v60, v0, 4, 1
    v_lshl_add_u32 v7, v60, 5, v7
    v_and_b32 v60, 3, v0
    v_lshl_add_u32 v7, v60, 3, v7
    v_add_u32 v7, s57, v7
    v_add_u32 v7, 30720, v7
    v_xor_b32 v8, 32, v7
    ds_read_b64_tr_b16 v[36:37], v7 offset:0
    ds_read_b64_tr_b16 v[38:39], v7 offset:1024
    ds_read_b64_tr_b16 v[40:41], v7 offset:2048
    ds_read_b64_tr_b16 v[42:43], v7 offset:3072
    ds_read_b64_tr_b16 v[44:45], v7 offset:4096
    ds_read_b64_tr_b16 v[46:47], v7 offset:5120
    ds_read_b64_tr_b16 v[48:49], v8 offset:0
    ds_read_b64_tr_b16 v[50:51], v8 offset:1024
    ds_read_b64_tr_b16 v[52:53], v8 offset:2048
    ds_read_b64_tr_b16 v[54:55], v8 offset:3072
    ds_read_b64_tr_b16 v[56:57], v8 offset:4096
    ds_read_b64_tr_b16 v[58:59], v8 offset:5120
    v_mov_b64 v[24:25], 0
    v_mov_b64 v[26:27], 0
    v_mov_b64 v[28:29], 0
    v_mov_b64 v[30:31], 0
    s_lshl_b32 s57, s30, 8
    v_lshlrev_b32 v11, 2, v0
    v_add_u32 v11, s57, v11
    v_add_u32 v11, 157696, v11
    v_lshlrev_b32 v32, 2, v0
    v_add_u32 v32, 157696, v32
    s_add_u32 s58, s6, 0
    s_add_u32 s57, s58, 16384
    v_and_b32 v33, 15, v0
    v_lshlrev_b32 v33, 2, v33
    v_lshrrev_b32 v60, 5, v0
    v_lshl_add_u32 v33, v60, 6, v33
    v_bfe_u32 v60, v0, 4, 1
    v_lshl_add_u32 v33, v60, 13, v33
    s_lshl_b32 s74, s3, 2
    s_add_u32 s74, s74, s62
    s_add_u32 s74, s74, 26112
    s_xor_b32 s75, s30, 3
    v_add_u32 v34, s75, v0
    v_lshlrev_b32 v34, 24, v34
    s_branch L_pw_136
L_pr_137:
    buffer_load_dword v18, v5, s[40:43], s60 offen offset:1536 sc1
    buffer_load_dwordx2 v[20:21], v22, s[40:43], s60 offen offset:1536 sc1
    s_sub_u32 s56, s56, 1
    s_cbranch_scc1 L_done
L_pw_136:
    s_waitcnt vmcnt(0)
    v_max3_u32 v19, v18, v20, v21
    v_cmp_eq_u32 vcc, -1, v19
    s_cbranch_vccnz L_pr_137
    buffer_load_dwordx4 v[12:15], v9, s[40:43], s60 offen sc1
    buffer_load_dwordx2 v[16:17], v10, s[40:43], s60 offen offset:1024 sc1
    buffer_load_dword v23, v5, s[40:43], s60 offen offset:1568 sc1
    v_max_f32_dpp v19, v18, v18 row_ror:4 row_mask:0xf bank_mask:0xf
    s_nop 1
    v_max_f32_dpp v19, v19, v19 row_ror:2 row_mask:0xf bank_mask:0xf
    s_nop 1
    v_max_f32_dpp v19, v19, v19 row_ror:1 row_mask:0xf bank_mask:0xf
    v_sub_f32 v18, v18, v19
    v_sub_f32 v20, v20, v19
    v_sub_f32 v21, v21, v19
    v_exp_f32 v18, v18
    v_exp_f32 v20, v20
    v_exp_f32 v21, v21
    s_waitcnt lgkmcnt(0)
    s_branch L_pw_138
L_pr_139:
    buffer_load_dwordx4 v[12:15], v9, s[40:43], s60 offen sc1
    buffer_load_dwordx2 v[16:17], v10, s[40:43], s60 offen offset:1024 sc1
    buffer_load_dword v23, v5, s[40:43], s60 offen offset:1568 sc1
    s_sub_u32 s56, s56, 1
    s_cbranch_scc1 L_done
L_pw_138:
    s_waitcnt vmcnt(0)
    v_max3_u32 v19, v12, v13, v14
    v_max3_u32 v19, v19, v15, v16
    v_max3_u32 v19, v19, v17, v23
    v_cmp_eq_u32 vcc, -1, v19
    s_cbranch_vccnz L_pr_139
L_pad2:
    s_cbranch_execz L_pad6
    v_smfmac_f32_16x16x64_bf16 v[24:27], v[12:15], v[36:43], v1
    v_mul_f32 v18, v18, v23
    v_smfmac_f32_16x16x64_bf16 v[28:31], v[12:15], v[48:55], v1
    v_smfmac_f32_16x16x32_bf16 v[24:27], v[16:17], v[44:47], v1
    v_add_f32_dpp v18, v18, v18 row_ror:4 row_mask:0xf bank_mask:0xf
    v_smfmac_f32_16x16x32_bf16 v[28:31], v[16:17], v[56:59], v1
    s_nop 0
    v_add_f32_dpp v18, v18, v18 row_ror:2 row_mask:0xf bank_mask:0xf
    s_nop 1
    v_add_f32_dpp v18, v18, v18 row_ror:1 row_mask:0xf bank_mask:0xf
    v_rcp_f32 v18, v18
    v_pk_add_f32 v[24:25], v[24:25], v[26:27]
    s_nop 0
    v_pk_add_f32 v[28:29], v[28:29], v[30:31]
    v_pk_mul_f32 v[20:21], v[20:21], v[18:19] op_sel:[0,0] op_sel_hi:[1,0]
    v_mul_f32 v24, v24, v20
    v_mul_f32 v28, v28, v20
    v_fmac_f32 v24, v25, v21
    v_fmac_f32 v28, v29, v21
    s_nop 1
    v_permlane32_swap_b32 v24, v28
    v_add_f32 v24, v24, v28
    ds_write_b32 v11, v24
    s_cmp_eq_u32 s30, 2
    s_cbranch_scc1 L_fin_140
    s_cmp_eq_u32 s55, 0
    s_waitcnt vmcnt(0) lgkmcnt(0)
    s_barrier
    s_cbranch_scc1 L_gs_142
    buffer_store_dword v0, v34, s[40:43], s74 offen
L_gb_143:
L_finb_141:
    s_sub_u32 s57, s30, 4
    s_cmp_lt_u32 s57, 3
    s_cbranch_scc0 L_skip_144
    s_sub_u32 s60, s30, 4
    s_lshl_b32 s59, s60, 12
    s_add_u32 s59, s59, 79872
    s_lshl_b32 s57, s60, 11
    v_lshlrev_b32 v11, 4, v0
    v_add_u32 v11, s57, v11
    s_add_u32 s58, s62, 19456
    buffer_load_dwordx4 v[12:15], v11, s[40:43], s58 offen offset:0 sc1
    buffer_load_dwordx4 v[16:19], v11, s[40:43], s58 offen offset:1024 sc1
    s_mov_b32 s44, s20
    s_mov_b32 s45, s21
    s_mov_b32 s46, 1966080
    s_mov_b32 s47, 0x20000
    s_mul_i32 s57, s31, 3
    s_add_u32 s57, s57, s60
    s_mul_i32 s57, s57, 81920
    s_lshl_b32 s64, s3, 6
    s_add_u32 s57, s57, s64
    v_lshrrev_b32 v5, 2, v0
    v_mul_u32_u24 v5, 1280, v5
    v_and_b32 v60, 3, v0
    v_lshl_add_u32 v5, v60, 4, v5
    v_add_u32 v5, s57, v5
    s_add_u32 m0, s59, 0
    s_mov_b32 s57, 0
    buffer_load_dwordx4 v5, s[44:47], s57 offen nt lds
    s_add_u32 m0, s59, 1024
    s_mov_b32 s57, 20480
    buffer_load_dwordx4 v5, s[44:47], s57 offen nt lds
    s_add_u32 m0, s59, 2048
    s_mov_b32 s57, 40960
    buffer_load_dwordx4 v5, s[44:47], s57 offen nt lds
    s_add_u32 m0, s59, 3072
    s_mov_b32 s57, 61440
    buffer_load_dwordx4 v5, s[44:47], s57 offen nt lds
    v_lshrrev_b32 v35, 4, v0
    v_lshlrev_b32 v35, 9, v35
    v_bfe_u32 v60, v0, 2, 2
    v_lshl_add_u32 v35, v60, 6, v35
    v_and_b32 v60, 3, v0
    v_lshl_add_u32 v35, v60, 3, v35
    v_add_u32 v35, s59, v35
    s_waitcnt vmcnt(4)
L_sw_145:
    v_max3_u32 v60, v12, v13, v14
    v_max3_u32 v60, v60, v15, v16
    v_max3_u32 v60, v60, v17, v18
    v_max_u32 v60, v60, v19
    v_cmp_eq_u32 vcc, -1, v60
    s_cbranch_vccnz L_sr_146
    v_pk_add_f32 v[20:21], v[12:13], v[14:15]
    v_pk_add_f32 v[22:23], v[16:17], v[18:19]
    v_pk_add_f32 v[20:21], v[20:21], v[22:23]
    v_add_f32 v8, v20, v21
    v_mov_b64 v[52:53], 0
L_pad3:
    s_cbranch_execz L_pad7
    v_mov_b64 v[54:55], 0
    v_mov_b64 v[56:57], 0
    v_mov_b64 v[58:59], 0
    v_mov_b32 v9, 0xbdd2d3e8
    v_mov_b32 v10, 0xc0135761
    s_lshl_b32 s57, s60, 7
    s_add_u32 s57, s57, 159872
    v_lshlrev_b32 v32, 3, v0
    v_add_u32 v32, s57, v32
    v_lshlrev_b32 v33, 3, v0
    v_add_u32 v33, 129024, v33
    v_cmp_gt_u32 vcc, 16, v0
    s_nop 1
    v_cndmask_b32 v32, v33, v32, vcc
    v_and_b32 v33, 15, v0
    v_lshlrev_b32 v33, 3, v33
    v_lshrrev_b32 v60, 5, v0
    v_lshl_add_u32 v33, v60, 2, v33
    v_add_u32 v33, 159872, v33
    v_and_b32 v34, 15, v0
    v_lshlrev_b32 v34, 2, v34
    v_lshrrev_b32 v60, 5, v0
    v_lshl_add_u32 v34, v60, 6, v34
    v_bfe_u32 v60, v0, 4, 1
    v_lshl_add_u32 v34, v60, 13, v34
    s_add_u32 s60, s6, 131072
    s_add_u32 s59, s60, 16384
    s_lshl_b32 s74, s3, 2
    s_add_u32 s74, s74, s62
    s_add_u32 s74, s74, 26496
    s_xor_b32 s75, s30, 4
    s_lshl_b32 s75, s75, 24
    v_and_b32 v5, 3, v0
    v_lshlrev_b32 v5, 7, v5
    v_lshrrev_b32 v60, 2, v0
    v_lshl_add_u32 v5, v60, 24, v5
    v_add_u32 v5, s75, v5
    s_add_u32 s58, s62, 13312
    s_add_u32 s57, s62, 25856
    v_and_b32 v7, 7, v0
    v_lshlrev_b32 v7, 3, v7
    buffer_load_dwordx2 v[24:25], v7, s[40:43], s57 offen sc1
    buffer_load_dwordx4 v[12:15], v11, s[40:43], s58 offen offset:0 sc1
    buffer_load_dwordx4 v[16:19], v11, s[40:43], s58 offen offset:1024 sc1
    s_waitcnt vmcnt(3)
    ds_read_b64_tr_b16 v[36:37], v35 offset:0
    ds_read_b64_tr_b16 v[38:39], v35 offset:256
    ds_read_b64_tr_b16 v[40:41], v35 offset:2048
    ds_read_b64_tr_b16 v[42:43], v35 offset:2304
    ds_read_b64_tr_b16 v[44:45], v35 offset:32
    ds_read_b64_tr_b16 v[46:47], v35 offset:288
    ds_read_b64_tr_b16 v[48:49], v35 offset:2080
    ds_read_b64_tr_b16 v[50:51], v35 offset:2336
    s_waitcnt lgkmcnt(0)
L_pr_148:
    buffer_load_dwordx2 v[24:25], v7, s[40:43], s57 offen sc1
    buffer_load_dwordx4 v[12:15], v11, s[40:43], s58 offen offset:0 sc1
    buffer_load_dwordx4 v[16:19], v11, s[40:43], s58 offen offset:1024 sc1
    s_sub_u32 s56, s56, 1
    s_cbranch_scc1 L_done
L_pw_147:
    s_waitcnt vmcnt(5)
    v_max_u32 v26, v24, v25
    v_cmp_eq_u32 vcc, -1, v26
    s_cbranch_vccnz L_pr_148
    buffer_load_dwordx4 v[12:15], v11, s[40:43], s58 offen offset:0 sc1
    buffer_load_dwordx4 v[16:19], v11, s[40:43], s58 offen offset:1024 sc1
    v_add_f32_dpp v2, v24, v24 row_ror:4 row_mask:0xf bank_mask:0xf
    v_add_f32_dpp v3, v25, v25 row_ror:4 row_mask:0xf bank_mask:0xf
    s_nop 0
    v_add_f32_dpp v2, v2, v2 row_ror:2 row_mask:0xf bank_mask:0xf
    v_add_f32_dpp v3, v3, v3 row_ror:2 row_mask:0xf bank_mask:0xf
    s_nop 0
    v_add_f32_dpp v2, v2, v2 row_ror:1 row_mask:0xf bank_mask:0xf
    v_add_f32_dpp v3, v3, v3 row_ror:1 row_mask:0xf bank_mask:0xf
    v_mul_f32 v2, 0x3acccccd, v2
    v_mul_f32 v3, 0x3acccccd, v3
    v_fma_f32 v3, -v2, v2, v3
    v_max_f32 v3, 0, v3
    v_add_f32 v3, 0x3727c5ac, v3
    v_rsq_f32 v3, v3
    s_nop 0
    v_mul_f32 v2, v2, v3
    v_fma_f32 v8, -v2, v8, v4
    s_waitcnt vmcnt(5)
L_hw_149:
    v_pk_add_f32 v[20:21], v[12:13], v[14:15]
L_pad4:
    s_cbranch_execz L_pad8
    v_pk_add_f32 v[22:23], v[16:17], v[18:19]
    v_pk_add_f32 v[20:21], v[20:21], v[22:23]
    v_add_f32 v20, v20, v21
    v_cmp_u_f32 vcc, v20, v20
    v_fma_f32 v20, v20, v3, v8
    s_cbranch_vccnz L_hr_150
L_hk_151:
    v_mul_f32 v21, v20, v20
    v_fma_f32 v21, v21, v9, v10
    v_mul_f32 v21, v21, v20
    v_exp_f32 v21, v21
    s_cmp_eq_u32 s55, 0
    v_add_f32 v21, 1.0, v21
    v_rcp_f32 v21, v21
    s_nop 0
    v_mul_f32 v20, v20, v21
    s_nop 1
    v_mov_b32_dpp v21, v20 row_shl:1 row_mask:0xf bank_mask:0xf bound_ctrl:0
    v_cvt_pk_bf16_f32 v28, v20, v21
    s_nop 1
    v_mov_b32_dpp v29, v28 row_shl:4 row_mask:0xf bank_mask:0xf bound_ctrl:0
    v_mov_b32_dpp v30, v28 row_shl:8 row_mask:0xf bank_mask:0xf bound_ctrl:0
    v_mov_b32_dpp v31, v28 row_shl:12 row_mask:0xf bank_mask:0xf bound_ctrl:0
    s_nop 1
    v_smfmac_f32_16x16x64_bf16 v[52:55], v[28:31], v[36:43], v1
    v_smfmac_f32_16x16x64_bf16 v[56:59], v[28:31], v[44:51], v1
    s_nop 6
    v_add_f32 v22, v52, v54
    v_add_f32 v23, v56, v58
    ds_write_b64 v32, v[22:23]
    s_cmp_eq_u32 s30, 4
    s_cbranch_scc0 L_skip_153
L_xw_154:
    ds_read2_b32 v[20:21], v33 offset0:0 offset1:32
    ds_read_b32 v22, v33 offset:256
    s_cmp_eq_u32 s55, 0
    s_waitcnt lgkmcnt(0)
    v_max3_u32 v23, v20, v21, v22
    v_add_f32 v20, v20, v21
    v_cmp_eq_u32 vcc, -1, v23
    v_add_f32 v20, v20, v22
    s_cbranch_vccnz L_xr_155
    v_min_u32 v20, -2, v20
    buffer_store_dword v20, v34, s[40:43], s60 offen sc1
    s_cbranch_scc1 L_gs_156
    buffer_store_dword v0, v5, s[40:43], s74 offen
L_gb_157:
    s_waitcnt vmcnt(2)
    s_branch L_pe_158
L_skip_153:
    s_waitcnt vmcnt(0)
L_pe_158:
L_skip_144:
    s_branch L_p1
L_typeB_0:
    s_cmp_eq_u32 s53, 3
    s_cbranch_scc0 L_p1
    s_cmp_eq_u32 s30, 7
    s_cbranch_scc1 L_w7_159
    s_cmp_lt_u32 s30, 6
    s_cbranch_scc0 L_skip_161
    s_lshr_b32 s57, s30, 1
    s_mul_i32 s57, s57, 128
    s_and_b32 s58, s30, 1
    s_lshl_b32 s58, s58, 6
    s_add_u32 s57, s57, s58
    v_lshrrev_b32 v18, 5, v0
    v_lshlrev_b32 v18, 13, v18
    v_bfe_u32 v60, v0, 3, 1
    v_lshl_add_u32 v18, v60, 12, v18
    v_bfe_u32 v60, v0, 4, 1
    v_lshl_add_u32 v18, v60, 11, v18
    v_bfe_u32 v60, v0, 2, 1
    v_mul_u32_u24 v60, 384, v60
    v_add_u32 v18, v60, v18
    v_and_b32 v60, 3, v0
    v_lshl_add_u32 v18, v60, 3, v18
    v_add_u32 v18, s57, v18
    v_add_u32 v18, 30720, v18
    v_bfe_u32 v19, v0, 4, 1
    v_lshlrev_b32 v19, 12, v19
    v_bfe_u32 v60, v0, 3, 1
    v_lshl_add_u32 v19, v60, 11, v19
    v_bfe_u32 v60, v0, 2, 1
    v_mul_u32_u24 v60, 384, v60
    v_add_u32 v19, v60, v19
    v_and_b32 v60, 3, v0
    v_lshl_add_u32 v19, v60, 3, v19
    v_add_u32 v19, s57, v19
    v_add_u32 v19, 63488, v19
    ds_read_b64_tr_b16 v[28:29], v18 offset:0
    ds_read_b64_tr_b16 v[30:31], v18 offset:1024
    ds_read_b64_tr_b16 v[32:33], v18 offset:16384
    ds_read_b64_tr_b16 v[34:35], v18 offset:17408
    ds_read_b64_tr_b16 v[36:37], v19 offset:0
    ds_read_b64_tr_b16 v[38:39], v19 offset:1024
L_pad5:
    s_cbranch_execz L_pad9
    ds_read_b64_tr_b16 v[40:41], v18 offset:32
    ds_read_b64_tr_b16 v[42:43], v18 offset:1056
    ds_read_b64_tr_b16 v[44:45], v18 offset:16416
    ds_read_b64_tr_b16 v[46:47], v18 offset:17440
    ds_read_b64_tr_b16 v[48:49], v19 offset:32
    ds_read_b64_tr_b16 v[50:51], v19 offset:1056
    v_lshrrev_b32 v9, 4, v0
    v_lshlrev_b32 v9, 5, v9
    v_bfe_u32 v60, v0, 1, 1
    v_lshl_add_u32 v9, v60, 4, v9
    v_and_b32 v60, 1, v0
    v_mul_u32_u24 v60, 192, v60
    v_add_u32 v9, v60, v9
    v_add_u32 v9, 160832, v9
    v_lshrrev_b32 v10, 4, v0
    v_lshlrev_b32 v10, 4, v10
    v_bfe_u32 v60, v0, 1, 1
    v_lshl_add_u32 v10, v60, 3, v10
    v_and_b32 v60, 1, v0
    v_mul_u32_u24 v60, 192, v60
    v_add_u32 v10, v60, v10
    v_add_u32 v10, 160960, v10
    v_mov_b64 v[20:21], 0
    v_mov_b64 v[22:23], 0
    v_mov_b64 v[24:25], 0
    v_mov_b64 v[26:27], 0
    s_lshr_b32 s57, s30, 1
    s_lshl_b32 s57, s57, 11
    s_and_b32 s58, s30, 1
    s_lshl_b32 s58, s58, 9
    s_add_u32 s57, s57, s58
    s_lshr_b32 s58, s54, 2
    s_lshl_b32 s58, s58, 10
    s_add_u32 s57, s57, s58
    s_and_b32 s58, s54, 3
    s_lshl_b32 s58, s58, 2
    s_add_u32 s57, s57, s58
    v_and_b32 v11, 31, v0
    v_lshlrev_b32 v11, 4, v11
    v_lshrrev_b32 v60, 5, v0
    v_lshl_add_u32 v11, v60, 30, v11
    v_add_u32 v11, s57, v11
    s_add_u32 s59, s62, 13312
    s_add_u32 s60, s62, 25856
    ds_read_b128 v[12:15], v9
    ds_read_b64 v[16:17], v10
    s_waitcnt lgkmcnt(1)
    v_smfmac_f32_16x16x64_bf16 v[20:23], v[12:15], v[28:35], v1
    v_smfmac_f32_16x16x64_bf16 v[24:27], v[12:15], v[40:47], v1
    s_waitcnt lgkmcnt(0)
    v_smfmac_f32_16x16x32_bf16 v[20:23], v[16:17], v[36:39], v1
    v_smfmac_f32_16x16x32_bf16 v[24:27], v[16:17], v[48:51], v1
    s_add_u32 s60, s62, 19456
    s_cmp_eq_u32 s55, 0
    s_nop 4
    v_add_f32 v12, v21, v23
    s_nop 1
    v_add_f32_dpp v12, v25, v27 quad_perm:[0,1,2,3] row_mask:0x2 bank_mask:0xf
    v_min_u32 v12, -2, v12
    s_cbranch_scc1 L_gs_162
    buffer_store_dword v12, v11, s[40:43], s60 offen
L_gb_163:
    v_mov_b64 v[20:21], 0
    v_mov_b64 v[22:23], 0
    v_mov_b64 v[24:25], 0
    v_mov_b64 v[26:27], 0
L_skip_161:
    s_cmp_lt_u32 s30, 6
    s_barrier
    s_cbranch_scc0 L_se_160
    ds_read_b128 v[12:15], v9
    ds_read_b64 v[16:17], v10
    s_waitcnt lgkmcnt(1)
    v_smfmac_f32_16x16x64_bf16 v[20:23], v[12:15], v[28:35], v1
    v_smfmac_f32_16x16x64_bf16 v[24:27], v[12:15], v[40:47], v1
    s_waitcnt lgkmcnt(0)
    v_smfmac_f32_16x16x32_bf16 v[20:23], v[16:17], v[36:39], v1
    v_smfmac_f32_16x16x32_bf16 v[24:27], v[16:17], v[48:51], v1
    s_cmp_eq_u32 s55, 0
    s_nop 5
    v_add_f32 v12, v20, v22
    s_nop 1
    v_add_f32_dpp v12, v24, v26 quad_perm:[0,1,2,3] row_mask:0x2 bank_mask:0xf
    v_min_u32 v12, -2, v12
    s_cbranch_scc1 L_gs_164
    buffer_store_dword v12, v11, s[40:43], s59 offen
L_gb_165:
L_se_160:
L_p1:
    s_lshl_b32 s57, s30, 7
    s_add_u32 s57, s57, 158720
    v_lshrrev_b32 v58, 4, v0
    v_lshlrev_b32 v58, 5, v58
    v_bfe_u32 v60, v0, 1, 1
    v_lshl_add_u32 v58, v60, 4, v58
L_pad6:
    s_cbranch_execz L_pad10
    v_bfe_u32 v60, v0, 2, 2
    v_lshl_add_u32 v58, v60, 2, v58
    v_and_b32 v60, 1, v0
    v_lshl_add_u32 v58, v60, 1, v58
    v_add_u32 v58, s57, v58
    v_lshrrev_b32 v61, 4, v0
    v_lshlrev_b32 v61, 5, v61
    v_bfe_u32 v60, v0, 1, 1
    v_lshl_add_u32 v61, v60, 4, v61
    v_add_u32 v61, s57, v61
    v_bfe_u32 v62, v0, 2, 2
    v_lshlrev_b32 v62, 1, v62
    v_and_b32 v60, 1, v0
    v_lshl_add_u32 v62, v60, 0, v62
    v_mov_b32 v60, 160992
    v_cmp_eq_u32 vcc, 0, v62
    s_nop 1
    v_cndmask_b32 v52, v60, v61, vcc
    v_cmp_eq_u32 vcc, 1, v62
    s_nop 1
    v_cndmask_b32 v53, v60, v61, vcc
    v_cmp_eq_u32 vcc, 2, v62
    s_nop 1
    v_cndmask_b32 v54, v60, v61, vcc
    v_cmp_eq_u32 vcc, 3, v62
    s_nop 1
    v_cndmask_b32 v55, v60, v61, vcc
    v_cmp_eq_u32 vcc, 4, v62
    s_nop 1
    v_cndmask_b32 v56, v60, v61, vcc
    v_cmp_eq_u32 vcc, 5, v62
    s_nop 1
    v_cndmask_b32 v57, v60, v61, vcc
    s_lshl_b32 s58, s30, 2
    s_add_u32 s58, s58, 159808
    v_mov_b32 v60, s58
    v_lshlrev_b32 v59, 2, v0
    v_add_u32 v59, 157696, v59
    v_cmp_eq_u32 vcc, 63, v0
    s_nop 1
    v_cndmask_b32 v59, v59, v60, vcc
    v_and_b32 v62, 7, v0
    v_lshlrev_b32 v62, 2, v62
    v_add_u32 v62, 159808, v62
    s_lshl_b32 s57, s30, 11
    v_lshlrev_b32 v63, 4, v0
    v_add_u32 v63, s57, v63
    v_add_u32 v63, 92160, v63
    v_mov_b32 v8, 125440
    s_sub_u32 s57, s30, 1
    s_lshl_b32 s57, s57, 10
    v_lshlrev_b32 v7, 4, v0
    v_add_u32 v7, s57, v7
    s_cmp_eq_u32 s30, 7
    s_cbranch_scc1 L_w7_173
    s_cmp_lt_u32 s30, 6
    s_cbranch_scc0 L_skip_175
    s_lshr_b32 s57, s30, 1
    s_mul_i32 s57, s57, 1024
    s_and_b32 s58, s30, 1
    s_lshl_b32 s58, s58, 6
    s_add_u32 s57, s57, s58
    v_lshrrev_b32 v18, 5, v0
    v_mul_u32_u24 v18, 6144, v18
    v_bfe_u32 v60, v0, 3, 1
    v_mul_u32_u24 v60, 3072, v60
    v_add_u32 v18, v60, v18
    v_bfe_u32 v60, v0, 4, 1
    v_lshl_add_u32 v18, v60, 9, v18
    v_bfe_u32 v60, v0, 2, 1
    v_lshl_add_u32 v18, v60, 7, v18
    v_and_b32 v60, 3, v0
    v_lshl_add_u32 v18, v60, 3, v18
    v_add_u32 v18, s57, v18
    v_bfe_u32 v19, v0, 4, 1
    v_mul_u32_u24 v19, 3072, v19
    v_bfe_u32 v60, v0, 3, 1
    v_lshl_add_u32 v19, v60, 9, v19
    v_bfe_u32 v60, v0, 2, 1
    v_lshl_add_u32 v19, v60, 7, v19
    v_and_b32 v60, 3, v0
    v_lshl_add_u32 v19, v60, 3, v19
    v_add_u32 v19, s57, v19
    v_add_u32 v19, 24576, v19
    ds_read_b64_tr_b16 v[28:29], v18 offset:0
    ds_read_b64_tr_b16 v[30:31], v18 offset:256
    ds_read_b64_tr_b16 v[32:33], v18 offset:12288
    ds_read_b64_tr_b16 v[34:35], v18 offset:12544
    ds_read_b64_tr_b16 v[36:37], v19 offset:0
    ds_read_b64_tr_b16 v[38:39], v19 offset:256
L_pad7:
    s_cbranch_execz L_pad11
    ds_read_b64_tr_b16 v[40:41], v18 offset:32
    ds_read_b64_tr_b16 v[42:43], v18 offset:288
    ds_read_b64_tr_b16 v[44:45], v18 offset:12320
    ds_read_b64_tr_b16 v[46:47], v18 offset:12576
    ds_read_b64_tr_b16 v[48:49], v19 offset:32
    ds_read_b64_tr_b16 v[50:51], v19 offset:288
    v_lshrrev_b32 v9, 4, v0
    v_lshlrev_b32 v9, 5, v9
    v_bfe_u32 v60, v0, 1, 1
    v_lshl_add_u32 v9, v60, 4, v9
    v_and_b32 v60, 1, v0
    v_mul_u32_u24 v60, 192, v60
    v_add_u32 v9, v60, v9
    v_add_u32 v9, 160832, v9
    v_lshrrev_b32 v10, 4, v0
    v_lshlrev_b32 v10, 4, v10
    v_bfe_u32 v60, v0, 1, 1
    v_lshl_add_u32 v10, v60, 3, v10
    v_and_b32 v60, 1, v0
    v_mul_u32_u24 v60, 192, v60
    v_add_u32 v10, v60, v10
    v_add_u32 v10, 160960, v10
    v_mov_b64 v[20:21], 0
    v_mov_b64 v[22:23], 0
    v_mov_b64 v[24:25], 0
    v_mov_b64 v[26:27], 0
    s_lshl_b32 s57, s54, 1
    s_lshl_b32 s58, s30, 9
    s_add_u32 s57, s57, s58
    v_and_b32 v11, 31, v0
    v_lshlrev_b32 v11, 4, v11
    v_lshrrev_b32 v60, 5, v0
    v_lshl_add_u32 v11, v60, 30, v11
    v_add_u32 v11, s57, v11
    s_mul_i32 s59, s53, 3072
    s_add_u32 s59, s59, s62
    s_add_u32 s59, s59, 46464
    s_lshl_b32 s60, s53, 6
    s_add_u32 s60, s60, s62
    s_add_u32 s60, s60, 25600
L_skip_175:
    s_cmp_lt_u32 s30, 6
    s_barrier
    s_cbranch_scc0 L_se_174
    ds_read_b128 v[12:15], v9
    ds_read_b64 v[16:17], v10
    s_waitcnt lgkmcnt(1)
    v_smfmac_f32_16x16x64_bf16 v[20:23], v[12:15], v[28:35], v1
    v_smfmac_f32_16x16x64_bf16 v[24:27], v[12:15], v[40:47], v1
    s_waitcnt lgkmcnt(0)
    v_smfmac_f32_16x16x32_bf16 v[20:23], v[16:17], v[36:39], v1
    v_smfmac_f32_16x16x32_bf16 v[24:27], v[16:17], v[48:51], v1
    s_cmp_eq_u32 s55, 0
    s_nop 5
    v_add_f32 v12, v20, v22
    s_nop 1
    v_add_f32_dpp v12, v24, v26 quad_perm:[0,1,2,3] row_mask:0x2 bank_mask:0xf
    v_cvt_pk_bf16_f32 v12, v12, v12
    v_min_u32 v12, -2, v12
    s_cbranch_scc1 L_gs_176
    buffer_store_short v12, v11, s[40:43], s59 offen
L_gb_177:
L_se_174:
    s_sub_u32 s57, s30, 1
    s_cmp_lt_u32 s57, 3
    s_cbranch_scc0 L_qo_191
    buffer_load_dwordx4 v[48:51], v7, s[40:43], s59 offen sc1
    v_mov_b64 v[24:25], 0
    v_mov_b64 v[26:27], 0
    v_mov_b64 v[28:29], 0
    v_mov_b64 v[30:31], 0
    v_mov_b64 v[32:33], 0
    v_mov_b64 v[34:35], 0
    v_mov_b64 v[36:37], 0
    v_mov_b64 v[38:39], 0
    v_mov_b64 v[40:41], 0
    v_mov_b64 v[42:43], 0
    v_mov_b64 v[44:45], 0
    v_mov_b64 v[46:47], 0
    v_lshrrev_b32 v5, 4, v0
    v_lshlrev_b32 v5, 5, v5
    v_bfe_u32 v60, v0, 1, 1
    v_lshl_add_u32 v5, v60, 4, v5
    v_add_u32 v5, 124928, v5
    v_add_u32 v9, 4294933376, v58
    v_mov_b32 v10, 0x3f803f80
L_qw_193:
    buffer_load_dwordx4 v[48:51], v7, s[40:43], s59 offen sc1
    s_sub_u32 s56, s56, 1
    s_cbranch_scc1 L_done
    s_and_b32 s57, s56, 31
    s_waitcnt vmcnt(1)
    v_dot2_f32_bf16 v60, v48, v10, 0
    v_dot2_f32_bf16 v61, v49, v10, 0
    v_dot2_f32_bf16 v60, v50, v10, v60
L_pad8:
    s_cbranch_execz L_pad12
    v_dot2_f32_bf16 v61, v51, v10, v61
    s_nop 2
    v_add_f32 v60, v60, v61
    v_cmp_u_f32 vcc, v60, v60
    v_cvt_pk_bf16_f32 v60, v60, v60
    s_cbranch_vccnz L_qr_194
L_qk_195:
    ds_write_b16 v9, v60
L_qb_192:
    s_waitcnt lgkmcnt(0)
    s_barrier
    ds_read_b128 v[12:15], v5 offset:0
    ds_read_b128 v[16:19], v5 offset:128
    ds_read_b128 v[20:23], v5 offset:256
    ds_read_b64 v[8:9], v8
    s_waitcnt lgkmcnt(1)
    v_smfmac_f32_16x16x64_bf16 v[24:27], v[12:15], v[64:71], v1
    v_smfmac_f32_16x16x64_bf16 v[24:27], v[16:19], v[72:79], v1
    v_smfmac_f32_16x16x64_bf16 v[24:27], v[20:23], v[80:87], v1
    v_smfmac_f32_16x16x64_bf16 v[28:31], v[12:15], v[88:95], v1
    v_smfmac_f32_16x16x64_bf16 v[28:31], v[16:19], v[96:103], v1
    v_smfmac_f32_16x16x64_bf16 v[28:31], v[20:23], v[104:111], v1
    v_smfmac_f32_16x16x64_bf16 v[32:35], v[12:15], v[112:119], v1
    v_smfmac_f32_16x16x64_bf16 v[32:35], v[16:19], v[120:127], v1
    v_smfmac_f32_16x16x64_bf16 v[32:35], v[20:23], v[128:135], v1
    v_smfmac_f32_16x16x64_bf16 v[36:39], v[12:15], v[136:143], v1
    v_smfmac_f32_16x16x64_bf16 v[36:39], v[16:19], v[144:151], v1
    v_smfmac_f32_16x16x64_bf16 v[36:39], v[20:23], v[152:159], v1
    v_add_f32_dpp v61, v24, v26 quad_perm:[0,1,2,3] row_mask:0x1 bank_mask:0xf
    s_waitcnt vmcnt(0) lgkmcnt(0)
    v_mul_f32 v8, v8, v6
    v_add_f32_dpp v61, v28, v30 quad_perm:[0,1,2,3] row_mask:0x2 bank_mask:0xf
    s_nop 1
    v_add_f32_dpp v61, v32, v34 quad_perm:[0,1,2,3] row_mask:0x4 bank_mask:0xf
    s_nop 1
    v_add_f32_dpp v61, v36, v38 quad_perm:[0,1,2,3] row_mask:0x8 bank_mask:0xf
    v_fma_f32 v36, v61, v9, v8
    s_nop 1
    v_max_f32_dpp v37, v36, v36 row_ror:8 row_mask:0xf bank_mask:0xf
    s_nop 1
    v_max_f32_dpp v37, v37, v37 row_ror:4 row_mask:0xf bank_mask:0xf
    s_nop 1
    v_max_f32_dpp v37, v37, v37 row_ror:2 row_mask:0xf bank_mask:0xf
    s_nop 1
    v_max_f32_dpp v37, v37, v37 row_ror:1 row_mask:0xf bank_mask:0xf
    s_nop 1
    v_max_f32_dpp v37, v37, v37 row_bcast:15 row_mask:0xa bank_mask:0xf
    s_nop 1
    v_max_f32_dpp v37, v37, v37 row_bcast:31 row_mask:0xc bank_mask:0xf
    s_nop 0
    v_readlane_b32 s64, v37, 63
    ds_write_b32 v59, v37
    s_nop 0
    v_subrev_f32 v36, s64, v36
    v_exp_f32 v36, v36
    s_nop 0
    v_cvt_pk_bf16_f32 v39, v36, v36
    ds_write_b16 v58, v39
    ds_read_b128 v[12:15], v52
    ds_read_b128 v[16:19], v53
    ds_read_b128 v[20:23], v54
    ds_read_b128 v[24:27], v55
    ds_read_b128 v[28:31], v56
    ds_read_b128 v[32:35], v57
    v_add_f32_dpp v38, v36, v36 row_ror:8 row_mask:0xf bank_mask:0xf
    s_nop 1
    v_add_f32_dpp v38, v38, v38 row_ror:4 row_mask:0xf bank_mask:0xf
    s_nop 1
    v_add_f32_dpp v38, v38, v38 row_ror:2 row_mask:0xf bank_mask:0xf
    s_nop 1
    v_add_f32_dpp v38, v38, v38 row_ror:1 row_mask:0xf bank_mask:0xf
    s_waitcnt lgkmcnt(5)
    v_smfmac_f32_16x16x64_bf16 v[40:43], v[12:15], v[160:167], v1
    v_add_f32_dpp v38, v38, v38 row_bcast:15 row_mask:0xa bank_mask:0xf
    v_smfmac_f32_16x16x64_bf16 v[44:47], v[12:15], v[208:215], v1
    s_waitcnt lgkmcnt(4)
    v_smfmac_f32_16x16x64_bf16 v[40:43], v[16:19], v[168:175], v1
    v_add_f32_dpp v38, v38, v38 row_bcast:31 row_mask:0xc bank_mask:0xf
    v_smfmac_f32_16x16x64_bf16 v[44:47], v[16:19], v[216:223], v1
L_pad9:
    s_cbranch_execz L_pad13
    ds_read_b32 v36, v62
    s_waitcnt lgkmcnt(4)
    v_smfmac_f32_16x16x64_bf16 v[40:43], v[20:23], v[176:183], v1
    v_smfmac_f32_16x16x64_bf16 v[44:47], v[20:23], v[224:231], v1
    s_waitcnt lgkmcnt(0)
    v_max_f32_dpp v37, v36, v36 row_ror:4 row_mask:0xf bank_mask:0xf
    v_smfmac_f32_16x16x64_bf16 v[40:43], v[24:27], v[184:191], v1
    v_smfmac_f32_16x16x64_bf16 v[44:47], v[24:27], v[232:239], v1
    v_max_f32_dpp v37, v37, v37 row_ror:2 row_mask:0xf bank_mask:0xf
    v_smfmac_f32_16x16x64_bf16 v[40:43], v[28:31], v[192:199], v1
    v_cmp_eq_u32 vcc, -1, v36
    v_smfmac_f32_16x16x64_bf16 v[44:47], v[28:31], v[240:247], v1
    v_max_f32_dpp v37, v37, v37 row_ror:1 row_mask:0xf bank_mask:0xf
    v_smfmac_f32_16x16x64_bf16 v[40:43], v[32:35], v[200:207], v1
    v_sub_f32 v39, s64, v37
    v_smfmac_f32_16x16x64_bf16 v[44:47], v[32:35], v[248:255], v1
    v_exp_f32 v39, v39
    s_cbranch_vccnz L_mr_198
L_mk_199:
    v_mul_f32 v38, v38, v39
    ds_write_b32 v63, v38 offset:1024
    s_cmp_lt_u32 s30, 2
    s_nop 0
    v_pk_add_f32 v[40:41], v[40:41], v[42:43]
    s_nop 0
    v_pk_add_f32 v[42:43], v[44:45], v[46:47]
    v_pk_mul_f32 v[40:41], v[40:41], v[38:39] op_sel:[0,1] op_sel_hi:[1,1]
    v_pk_mul_f32 v[42:43], v[42:43], v[38:39] op_sel:[0,1] op_sel_hi:[1,1]
    ds_write_b128 v63, v[40:43]
    s_cbranch_scc1 L_comb_1
    s_waitcnt lgkmcnt(0)
    s_barrier
L_comb_1b:
    s_cmp_lt_u32 s3, 20
    s_cbranch_scc0 L_typeB_1
    s_mul_i32 s60, s30, 1664
    s_add_u32 s60, s60, s62
    s_add_u32 s60, s60, 27008
    v_and_b32 v5, 7, v0
    v_lshlrev_b32 v5, 2, v5
    v_lshrrev_b32 v22, 4, v0
    v_lshlrev_b32 v22, 3, v22
    buffer_load_dword v18, v5, s[40:43], s60 offen offset:1536 sc1
    buffer_load_dwordx2 v[20:21], v22, s[40:43], s60 offen offset:1536 sc1
    v_lshlrev_b32 v9, 4, v0
    v_lshlrev_b32 v10, 3, v0
    s_mul_i32 s57, s30, 6144
    v_lshrrev_b32 v7, 2, v0
    v_lshlrev_b32 v7, 6, v7
    v_bfe_u32 v60, v0, 4, 1
    v_lshl_add_u32 v7, v60, 5, v7
    v_and_b32 v60, 3, v0
    v_lshl_add_u32 v7, v60, 3, v7
    v_add_u32 v7, s57, v7
    v_add_u32 v7, 30720, v7
    v_xor_b32 v8, 32, v7
    ds_read_b64_tr_b16 v[36:37], v7 offset:0
    ds_read_b64_tr_b16 v[38:39], v7 offset:1024
    ds_read_b64_tr_b16 v[40:41], v7 offset:2048
    ds_read_b64_tr_b16 v[42:43], v7 offset:3072
    ds_read_b64_tr_b16 v[44:45], v7 offset:4096
    ds_read_b64_tr_b16 v[46:47], v7 offset:5120
    ds_read_b64_tr_b16 v[48:49], v8 offset:0
    ds_read_b64_tr_b16 v[50:51], v8 offset:1024
    ds_read_b64_tr_b16 v[52:53], v8 offset:2048
    ds_read_b64_tr_b16 v[54:55], v8 offset:3072
    ds_read_b64_tr_b16 v[56:57], v8 offset:4096
    ds_read_b64_tr_b16 v[58:59], v8 offset:5120
    v_mov_b64 v[24:25], 0
    v_mov_b64 v[26:27], 0
    v_mov_b64 v[28:29], 0
    v_mov_b64 v[30:31], 0
    s_lshl_b32 s57, s30, 8
    v_lshlrev_b32 v11, 2, v0
    v_add_u32 v11, s57, v11
    v_add_u32 v11, 157696, v11
    v_lshlrev_b32 v32, 2, v0
    v_add_u32 v32, 157696, v32
    s_add_u32 s58, s6, 262144
    s_add_u32 s57, s58, 16384
    v_and_b32 v33, 15, v0
    v_lshlrev_b32 v33, 2, v33
    v_lshrrev_b32 v60, 5, v0
    v_lshl_add_u32 v33, v60, 6, v33
L_pad10:
    s_cbranch_execz L_pad14
    v_bfe_u32 v60, v0, 4, 1
    v_lshl_add_u32 v33, v60, 13, v33
    s_lshl_b32 s74, s3, 2
    s_add_u32 s74, s74, s62
    s_add_u32 s74, s74, 26240
    s_xor_b32 s75, s30, 2
    v_add_u32 v34, s75, v0
    v_lshlrev_b32 v34, 24, v34
    s_branch L_pw_206
L_pr_207:
    buffer_load_dword v18, v5, s[40:43], s60 offen offset:1536 sc1
    buffer_load_dwordx2 v[20:21], v22, s[40:43], s60 offen offset:1536 sc1
    s_sub_u32 s56, s56, 1
    s_cbranch_scc1 L_done
L_pw_206:
    s_waitcnt vmcnt(0)
    v_max3_u32 v19, v18, v20, v21
    v_cmp_eq_u32 vcc, -1, v19
    s_cbranch_vccnz L_pr_207
    buffer_load_dwordx4 v[12:15], v9, s[40:43], s60 offen sc1
    buffer_load_dwordx2 v[16:17], v10, s[40:43], s60 offen offset:1024 sc1
    buffer_load_dword v23, v5, s[40:43], s60 offen offset:1568 sc1
    v_max_f32_dpp v19, v18, v18 row_ror:4 row_mask:0xf bank_mask:0xf
    s_nop 1
    v_max_f32_dpp v19, v19, v19 row_ror:2 row_mask:0xf bank_mask:0xf
    s_nop 1
    v_max_f32_dpp v19, v19, v19 row_ror:1 row_mask:0xf bank_mask:0xf
    v_sub_f32 v18, v18, v19
    v_sub_f32 v20, v20, v19
    v_sub_f32 v21, v21, v19
    v_exp_f32 v18, v18
    v_exp_f32 v20, v20
    v_exp_f32 v21, v21
    s_waitcnt lgkmcnt(0)
    s_branch L_pw_208
L_pr_209:
    buffer_load_dwordx4 v[12:15], v9, s[40:43], s60 offen sc1
    buffer_load_dwordx2 v[16:17], v10, s[40:43], s60 offen offset:1024 sc1
    buffer_load_dword v23, v5, s[40:43], s60 offen offset:1568 sc1
    s_sub_u32 s56, s56, 1
    s_cbranch_scc1 L_done
L_pw_208:
    s_waitcnt vmcnt(0)
    v_max3_u32 v19, v12, v13, v14
    v_max3_u32 v19, v19, v15, v16
    v_max3_u32 v19, v19, v17, v23
    v_cmp_eq_u32 vcc, -1, v19
    s_cbranch_vccnz L_pr_209
    v_smfmac_f32_16x16x64_bf16 v[24:27], v[12:15], v[36:43], v1
    v_mul_f32 v18, v18, v23
    v_smfmac_f32_16x16x64_bf16 v[28:31], v[12:15], v[48:55], v1
    v_smfmac_f32_16x16x32_bf16 v[24:27], v[16:17], v[44:47], v1
    v_add_f32_dpp v18, v18, v18 row_ror:4 row_mask:0xf bank_mask:0xf
    v_smfmac_f32_16x16x32_bf16 v[28:31], v[16:17], v[56:59], v1
    s_nop 0
    v_add_f32_dpp v18, v18, v18 row_ror:2 row_mask:0xf bank_mask:0xf
    s_nop 1
    v_add_f32_dpp v18, v18, v18 row_ror:1 row_mask:0xf bank_mask:0xf
    v_rcp_f32 v18, v18
    v_pk_add_f32 v[24:25], v[24:25], v[26:27]
    s_nop 0
    v_pk_add_f32 v[28:29], v[28:29], v[30:31]
    v_pk_mul_f32 v[20:21], v[20:21], v[18:19] op_sel:[0,0] op_sel_hi:[1,0]
    v_mul_f32 v24, v24, v20
    v_mul_f32 v28, v28, v20
    v_fmac_f32 v24, v25, v21
    v_fmac_f32 v28, v29, v21
    s_nop 1
    v_permlane32_swap_b32 v24, v28
    v_add_f32 v24, v24, v28
    ds_write_b32 v11, v24
    s_cmp_eq_u32 s30, 2
    s_cbranch_scc1 L_fin_210
    s_cmp_eq_u32 s55, 0
    s_waitcnt vmcnt(0) lgkmcnt(0)
    s_barrier
L_finb_211:
    s_sub_u32 s57, s30, 4
    s_cmp_lt_u32 s57, 3
    s_cbranch_scc0 L_skip_214
    s_sub_u32 s60, s30, 4
    s_lshl_b32 s59, s60, 12
    s_add_u32 s59, s59, 79872
    s_lshl_b32 s57, s60, 11
    v_lshlrev_b32 v11, 4, v0
    v_add_u32 v11, s57, v11
    s_add_u32 s58, s62, 19456
    buffer_load_dwordx4 v[12:15], v11, s[40:43], s58 offen offset:0 sc1
    buffer_load_dwordx4 v[16:19], v11, s[40:43], s58 offen offset:1024 sc1
    v_lshrrev_b32 v35, 4, v0
    v_lshlrev_b32 v35, 9, v35
    v_bfe_u32 v60, v0, 2, 2
    v_lshl_add_u32 v35, v60, 6, v35
    v_and_b32 v60, 3, v0
    v_lshl_add_u32 v35, v60, 3, v35
    v_add_u32 v35, s59, v35
L_pad11:
    s_cbranch_execz L_pad15
    s_waitcnt vmcnt(0)
L_sw_215:
    v_max3_u32 v60, v12, v13, v14
    v_max3_u32 v60, v60, v15, v16
    v_max3_u32 v60, v60, v17, v18
    v_max_u32 v60, v60, v19
    v_cmp_eq_u32 vcc, -1, v60
    s_cbranch_vccnz L_sr_216
    v_pk_add_f32 v[20:21], v[12:13], v[14:15]
    v_pk_add_f32 v[22:23], v[16:17], v[18:19]
    v_pk_add_f32 v[20:21], v[20:21], v[22:23]
    v_add_f32 v8, v20, v21
    v_mov_b64 v[52:53], 0
    v_mov_b64 v[54:55], 0
    v_mov_b64 v[56:57], 0
    v_mov_b64 v[58:59], 0
    v_mov_b32 v9, 0xbdd2d3e8
    v_mov_b32 v10, 0xc0135761
    s_lshl_b32 s57, s60, 7
    s_add_u32 s57, s57, 160256
    v_lshlrev_b32 v32, 3, v0
    v_add_u32 v32, s57, v32
    v_lshlrev_b32 v33, 3, v0
    v_add_u32 v33, 129024, v33
    v_cmp_gt_u32 vcc, 16, v0
    s_nop 1
    v_cndmask_b32 v32, v33, v32, vcc
    v_and_b32 v33, 15, v0
    v_lshlrev_b32 v33, 3, v33
    v_lshrrev_b32 v60, 5, v0
    v_lshl_add_u32 v33, v60, 2, v33
    v_add_u32 v33, 160256, v33
    v_and_b32 v34, 15, v0
    v_lshlrev_b32 v34, 2, v34
    v_lshrrev_b32 v60, 5, v0
    v_lshl_add_u32 v34, v60, 6, v34
    v_bfe_u32 v60, v0, 4, 1
    v_lshl_add_u32 v34, v60, 13, v34
    s_add_u32 s60, s6, 393216
    s_add_u32 s59, s60, 16384
    s_lshl_b32 s74, s3, 2
    s_add_u32 s74, s74, s62
    s_add_u32 s74, s74, 26368
    s_xor_b32 s75, s30, 4
    v_add_u32 v5, s75, v0
    v_lshlrev_b32 v5, 24, v5
    s_add_u32 s58, s62, 40320
    s_add_u32 s57, s62, 25984
    v_and_b32 v7, 7, v0
    v_lshlrev_b32 v7, 3, v7
    buffer_load_dwordx2 v[24:25], v7, s[40:43], s57 offen sc1
    buffer_load_dwordx4 v[12:15], v11, s[40:43], s58 offen offset:0 sc1
    buffer_load_dwordx4 v[16:19], v11, s[40:43], s58 offen offset:1024 sc1
    ds_read_b64_tr_b16 v[36:37], v35 offset:0
    ds_read_b64_tr_b16 v[38:39], v35 offset:256
    ds_read_b64_tr_b16 v[40:41], v35 offset:2048
    ds_read_b64_tr_b16 v[42:43], v35 offset:2304
    ds_read_b64_tr_b16 v[44:45], v35 offset:32
    ds_read_b64_tr_b16 v[46:47], v35 offset:288
    ds_read_b64_tr_b16 v[48:49], v35 offset:2080
    ds_read_b64_tr_b16 v[50:51], v35 offset:2336
    s_waitcnt lgkmcnt(0)
L_pr_218:
    buffer_load_dwordx2 v[24:25], v7, s[40:43], s57 offen sc1
    buffer_load_dwordx4 v[12:15], v11, s[40:43], s58 offen offset:0 sc1
    buffer_load_dwordx4 v[16:19], v11, s[40:43], s58 offen offset:1024 sc1
    s_sub_u32 s56, s56, 1
    s_cbranch_scc1 L_done
L_pw_217:
    s_waitcnt vmcnt(5)
    v_max_u32 v26, v24, v25
    v_cmp_eq_u32 vcc, -1, v26
    s_cbranch_vccnz L_pr_218
    buffer_load_dwordx4 v[12:15], v11, s[40:43], s58 offen offset:0 sc1
    buffer_load_dwordx4 v[16:19], v11, s[40:43], s58 offen offset:1024 sc1
    v_add_f32_dpp v2, v24, v24 row_ror:4 row_mask:0xf bank_mask:0xf
    v_add_f32_dpp v3, v25, v25 row_ror:4 row_mask:0xf bank_mask:0xf
    s_nop 0
    v_add_f32_dpp v2, v2, v2 row_ror:2 row_mask:0xf bank_mask:0xf
    v_add_f32_dpp v3, v3, v3 row_ror:2 row_mask:0xf bank_mask:0xf
    s_nop 0
    v_add_f32_dpp v2, v2, v2 row_ror:1 row_mask:0xf bank_mask:0xf
    v_add_f32_dpp v3, v3, v3 row_ror:1 row_mask:0xf bank_mask:0xf
    v_mul_f32 v2, 0x3acccccd, v2
    v_mul_f32 v3, 0x3acccccd, v3
    v_fma_f32 v3, -v2, v2, v3
L_pad12:
    s_cbranch_execz L_pad16
    v_max_f32 v3, 0, v3
    v_add_f32 v3, 0x3727c5ac, v3
    v_rsq_f32 v3, v3
    s_nop 0
    v_mul_f32 v2, v2, v3
    v_fma_f32 v8, -v2, v8, v4
    s_waitcnt vmcnt(5)
L_hw_219:
    v_pk_add_f32 v[20:21], v[12:13], v[14:15]
    v_pk_add_f32 v[22:23], v[16:17], v[18:19]
    v_pk_add_f32 v[20:21], v[20:21], v[22:23]
    v_add_f32 v20, v20, v21
    v_cmp_u_f32 vcc, v20, v20
    v_fma_f32 v20, v20, v3, v8
    s_cbranch_vccnz L_hr_220
L_hk_221:
    v_mul_f32 v21, v20, v20
    v_fma_f32 v21, v21, v9, v10
    v_mul_f32 v21, v21, v20
    v_exp_f32 v21, v21
    s_cmp_eq_u32 s55, 0
    v_add_f32 v21, 1.0, v21
    v_rcp_f32 v21, v21
    s_nop 0
    v_mul_f32 v20, v20, v21
    s_nop 1
    v_mov_b32_dpp v21, v20 row_shl:1 row_mask:0xf bank_mask:0xf bound_ctrl:0
    v_cvt_pk_bf16_f32 v28, v20, v21
    s_nop 1
    v_mov_b32_dpp v29, v28 row_shl:4 row_mask:0xf bank_mask:0xf bound_ctrl:0
    v_mov_b32_dpp v30, v28 row_shl:8 row_mask:0xf bank_mask:0xf bound_ctrl:0
    v_mov_b32_dpp v31, v28 row_shl:12 row_mask:0xf bank_mask:0xf bound_ctrl:0
    s_nop 1
    v_smfmac_f32_16x16x64_bf16 v[52:55], v[28:31], v[36:43], v1
    v_smfmac_f32_16x16x64_bf16 v[56:59], v[28:31], v[44:51], v1
    s_nop 6
    v_add_f32 v22, v52, v54
    v_add_f32 v23, v56, v58
    ds_write_b64 v32, v[22:23]
    s_cmp_eq_u32 s30, 4
    s_cbranch_scc0 L_skip_223
L_xw_224:
    ds_read2_b32 v[20:21], v33 offset0:0 offset1:32
    ds_read_b32 v22, v33 offset:256
    s_cmp_eq_u32 s55, 0
    s_waitcnt lgkmcnt(0)
    v_max3_u32 v23, v20, v21, v22
    v_add_f32 v20, v20, v21
    v_cmp_eq_u32 vcc, -1, v23
    v_add_f32 v20, v20, v22
    s_cbranch_vccnz L_xr_225
    v_min_u32 v20, -2, v20
    buffer_store_dword v20, v34, s[40:43], s60 offen sc1
    s_cbranch_scc1 L_gs_226
    buffer_store_dword v0, v5, s[40:43], s74 offen
L_gb_227:
L_skip_223:
L_skip_214:
    s_branch L_done
L_typeB_1:
    s_cmp_eq_u32 s53, 3
    s_cbranch_scc0 L_done
    s_cmp_eq_u32 s30, 7
    s_cbranch_scc1 L_w7_228
    s_cmp_lt_u32 s30, 6
    s_cbranch_scc0 L_skip_230
    s_lshr_b32 s57, s30, 1
    s_mul_i32 s57, s57, 128
    s_and_b32 s58, s30, 1
    s_lshl_b32 s58, s58, 6
    s_add_u32 s57, s57, s58
    v_lshrrev_b32 v18, 5, v0
    v_lshlrev_b32 v18, 13, v18
    v_bfe_u32 v60, v0, 3, 1
    v_lshl_add_u32 v18, v60, 12, v18
    v_bfe_u32 v60, v0, 4, 1
    v_lshl_add_u32 v18, v60, 11, v18
    v_bfe_u32 v60, v0, 2, 1
    v_mul_u32_u24 v60, 384, v60
    v_add_u32 v18, v60, v18
    v_and_b32 v60, 3, v0
    v_lshl_add_u32 v18, v60, 3, v18
    v_add_u32 v18, s57, v18
    v_add_u32 v18, 30720, v18
    v_bfe_u32 v19, v0, 4, 1
    v_lshlrev_b32 v19, 12, v19
    v_bfe_u32 v60, v0, 3, 1
    v_lshl_add_u32 v19, v60, 11, v19
    v_bfe_u32 v60, v0, 2, 1
    v_mul_u32_u24 v60, 384, v60
    v_add_u32 v19, v60, v19
    v_and_b32 v60, 3, v0
    v_lshl_add_u32 v19, v60, 3, v19
    v_add_u32 v19, s57, v19
    v_add_u32 v19, 63488, v19
    ds_read_b64_tr_b16 v[28:29], v18 offset:0
L_pad13:
    s_cbranch_execz L_pad17
    ds_read_b64_tr_b16 v[30:31], v18 offset:1024
    ds_read_b64_tr_b16 v[32:33], v18 offset:16384
    ds_read_b64_tr_b16 v[34:35], v18 offset:17408
    ds_read_b64_tr_b16 v[36:37], v19 offset:0
    ds_read_b64_tr_b16 v[38:39], v19 offset:1024
    ds_read_b64_tr_b16 v[40:41], v18 offset:32
    ds_read_b64_tr_b16 v[42:43], v18 offset:1056
    ds_read_b64_tr_b16 v[44:45], v18 offset:16416
    ds_read_b64_tr_b16 v[46:47], v18 offset:17440
    ds_read_b64_tr_b16 v[48:49], v19 offset:32
    ds_read_b64_tr_b16 v[50:51], v19 offset:1056
    v_lshrrev_b32 v9, 4, v0
    v_lshlrev_b32 v9, 5, v9
    v_bfe_u32 v60, v0, 1, 1
    v_lshl_add_u32 v9, v60, 4, v9
    v_and_b32 v60, 1, v0
    v_mul_u32_u24 v60, 192, v60
    v_add_u32 v9, v60, v9
    v_add_u32 v9, 160832, v9
    v_lshrrev_b32 v10, 4, v0
    v_lshlrev_b32 v10, 4, v10
    v_bfe_u32 v60, v0, 1, 1
    v_lshl_add_u32 v10, v60, 3, v10
    v_and_b32 v60, 1, v0
    v_mul_u32_u24 v60, 192, v60
    v_add_u32 v10, v60, v10
    v_add_u32 v10, 160960, v10
    v_mov_b64 v[20:21], 0
    v_mov_b64 v[22:23], 0
    v_mov_b64 v[24:25], 0
    v_mov_b64 v[26:27], 0
    s_lshr_b32 s57, s30, 1
    s_lshl_b32 s57, s57, 11
    s_and_b32 s58, s30, 1
    s_lshl_b32 s58, s58, 9
    s_add_u32 s57, s57, s58
    s_lshr_b32 s58, s54, 2
    s_lshl_b32 s58, s58, 10
    s_add_u32 s57, s57, s58
    s_and_b32 s58, s54, 3
    s_lshl_b32 s58, s58, 2
    s_add_u32 s57, s57, s58
    v_and_b32 v11, 31, v0
    v_lshlrev_b32 v11, 4, v11
    v_lshrrev_b32 v60, 5, v0
    v_lshl_add_u32 v11, v60, 30, v11
    v_add_u32 v11, s57, v11
    s_add_u32 s59, s62, 40320
    s_add_u32 s60, s62, 25984
L_skip_230:
    s_cmp_lt_u32 s30, 6
    s_barrier
    s_cbranch_scc0 L_se_229
    ds_read_b128 v[12:15], v9
    ds_read_b64 v[16:17], v10
    s_waitcnt lgkmcnt(1)
    v_smfmac_f32_16x16x64_bf16 v[20:23], v[12:15], v[28:35], v1
    v_smfmac_f32_16x16x64_bf16 v[24:27], v[12:15], v[40:47], v1
    s_waitcnt lgkmcnt(0)
    v_smfmac_f32_16x16x32_bf16 v[20:23], v[16:17], v[36:39], v1
    v_smfmac_f32_16x16x32_bf16 v[24:27], v[16:17], v[48:51], v1
    s_cmp_eq_u32 s55, 0
    s_nop 5
    v_add_f32 v12, v20, v22
    s_nop 1
    v_add_f32_dpp v12, v24, v26 quad_perm:[0,1,2,3] row_mask:0x2 bank_mask:0xf
    v_min_u32 v12, -2, v12
    s_cbranch_scc1 L_gs_231
    buffer_store_dword v12, v11, s[40:43], s59 offen
L_gb_232:
L_se_229:
    s_cmp_eq_u32 s30, 7
    s_cbranch_scc0 L_done
    s_cmp_eq_u32 s31, 0
    s_cbranch_scc0 L_done
    v_lshlrev_b32 v60, 16, v4
    v_add_f32 v2, v2, v60
    v_and_b32 v60, 0xffff0000, v4
    v_add_f32 v3, v3, v60
    v_and_b32 v60, 31, v0
    v_min_u32 v60, 19, v60
    s_mul_i32 s57, s54, 160
    v_lshrrev_b32 v7, 5, v0
    v_lshlrev_b32 v7, 2, v7
    v_add_u32 v7, s57, v7
    v_lshl_add_u32 v7, v60, 3, v7
    s_add_u32 s57, s7, 393216
    s_add_u32 s58, s7, 425984
    s_add_u32 s59, s7, 458752
    s_add_u32 s60, s7, 491520
    s_add_u32 s75, s62, 26368
    v_min_u32 v9, 19, v0
L_pad14:
    s_cbranch_execz L_pad18
    v_lshlrev_b32 v9, 2, v9
    buffer_load_dword v12, v9, s[40:43], s75 offen sc1
    s_sleep 2
L_pr_244:
    buffer_load_dword v12, v9, s[40:43], s75 offen sc1
    s_sub_u32 s56, s56, 1
    s_cbranch_scc1 L_done
L_pw_243:
    s_waitcnt vmcnt(1)
    v_cmp_eq_u32 vcc, -1, v12
    s_cbranch_vccnz L_pr_244
    buffer_load_dwordx4 v[12:15], v5, s[40:43], s57 offen sc1
    buffer_load_dwordx4 v[16:19], v5, s[40:43], s58 offen sc1
    buffer_load_dwordx4 v[20:23], v5, s[40:43], s59 offen sc1
    buffer_load_dwordx4 v[24:27], v5, s[40:43], s60 offen sc1
    s_sleep 2
L_gw_240:
    buffer_load_dwordx4 v[12:15], v5, s[40:43], s57 offen sc1
    buffer_load_dwordx4 v[16:19], v5, s[40:43], s58 offen sc1
    buffer_load_dwordx4 v[20:23], v5, s[40:43], s59 offen sc1
    buffer_load_dwordx4 v[24:27], v5, s[40:43], s60 offen sc1
    s_sub_u32 s56, s56, 1
    s_cbranch_scc1 L_done
    s_and_b32 s74, s56, 31
    s_waitcnt vmcnt(6)
    v_pk_add_f32 v[28:29], v[12:13], v[16:17]
    v_pk_add_f32 v[30:31], v[14:15], v[18:19]
    s_waitcnt vmcnt(5)
    v_pk_add_f32 v[28:29], v[28:29], v[20:21]
    v_pk_add_f32 v[30:31], v[30:31], v[22:23]
    s_waitcnt vmcnt(4)
    v_pk_add_f32 v[28:29], v[28:29], v[24:25]
    v_pk_add_f32 v[30:31], v[30:31], v[26:27]
    v_pk_add_f32 v[32:33], v[28:29], v[30:31]
    v_cmp_u_f32 vcc, v32, v33
    v_permlane32_swap_b32 v28, v30
    v_permlane32_swap_b32 v29, v31
    s_cbranch_vccnz L_gr_241
L_gk_242:
    v_pk_add_f32 v[28:29], v[28:29], v[30:31]
    v_pk_add_f32 v[28:29], v[28:29], v[2:3]
    v_cvt_pk_bf16_f32 v28, v28, v29
    global_store_dword v7, v28, s[24:25]
    s_branch L_done
L_gs_38:
    buffer_store_dword v33, v34, s[40:43], s67 offen sc1
    s_branch L_gb_39
L_gs_41:
    buffer_store_short v12, v54, s[40:43], s59 offen sc1
    s_branch L_gb_42
L_cr_56:
    s_sub_u32 s56, s56, 1
    s_cbranch_scc1 L_done
    global_load_dword v2, v3, s[26:27] sc1
    s_waitcnt vmcnt(0)
    s_branch L_cw_55
L_far_57:
    s_lshl_b32 s57, s52, 2
    s_add_u32 s57, s57, s72
    s_mov_b64 exec, 1
    buffer_store_dword v25, v0, s[40:43], s57 offen offset:128 sc1
    s_mov_b64 exec, -1
    s_branch L_fb_58
L_cr_74:
    s_sub_u32 s56, s56, 1
    s_cbranch_scc1 L_done
    buffer_load_dword v2, v24, s[40:43], s72 offen sc1
    s_branch L_cw_73
L_gs_82:
    buffer_store_dword v33, v34, s[40:43], s67 offen sc1
    s_branch L_gb_83
L_gs_85:
    buffer_store_short v12, v54, s[40:43], s59 offen sc1
    s_branch L_gb_86
L_gs_110:
    buffer_store_dword v37, v4, s[40:43], s58 offen sc1
    s_branch L_gb_111
L_cr_121:
    s_sub_u32 s56, s56, 1
    s_cbranch_scc1 L_done
    global_load_dword v2, v3, s[26:27] offset:4 sc1
    s_branch L_cw_120
L_gs_131:
    buffer_store_dword v42, v3, s[40:43], s57 offen sc1
    s_branch L_gb_132
L_gs_133:
    buffer_store_dword v40, v4, s[40:43], s57 offen offset:32 sc1
    s_branch L_gb_134
L_comb_0:
    s_mov_b32 s57, 0
    s_cmp_eq_u32 s55, 0
    s_waitcnt lgkmcnt(0)
    s_barrier
    ds_read2st64_b64 v[40:43], v2 offset0:0 offset1:4
    ds_read2st64_b64 v[44:47], v2 offset0:8 offset1:12
    ds_read2st64_b64 v[48:51], v2 offset0:16 offset1:20
    ds_read2st64_b64 v[52:55], v2 offset0:24 offset1:28
    s_waitcnt lgkmcnt(2)
    v_pk_add_f32 v[40:41], v[40:41], v[42:43]
    v_pk_add_f32 v[44:45], v[44:45], v[46:47]
    v_pk_add_f32 v[40:41], v[40:41], v[44:45]
    s_waitcnt lgkmcnt(0)
    v_pk_add_f32 v[48:49], v[48:49], v[50:51]
L_pad15:
    s_cbranch_execz L_pad19
    v_pk_add_f32 v[52:53], v[52:53], v[54:55]
    v_pk_add_f32 v[40:41], v[40:41], v[48:49]
    v_pk_add_f32 v[40:41], v[40:41], v[52:53]
    v_cvt_pk_bf16_f32 v42, v40, v41
    v_min_u32 v40, -2, v40
    v_min_u32 v42, -2, v42
    s_cbranch_scc1 L_gs_131
    buffer_store_dword v42, v3, s[40:43], s57 offen
L_gb_132:
    s_cbranch_scc1 L_gs_133
    buffer_store_dword v40, v4, s[40:43], s57 offen offset:32
L_gb_134:
    s_branch L_comb_0b
L_gs_142:
    buffer_store_dword v0, v34, s[40:43], s74 offen sc1
    s_branch L_gb_143
L_fin_140:
    s_cmp_eq_u32 s55, 0
    s_waitcnt vmcnt(0) lgkmcnt(0)
    s_barrier
    ds_read2st64_b32 v[12:13], v32 offset0:0 offset1:1
    ds_read2st64_b32 v[14:15], v32 offset0:2 offset1:3
    ds_read2st64_b32 v[16:17], v32 offset0:4 offset1:5
    ds_read2st64_b32 v[18:19], v32 offset0:6 offset1:7
    s_waitcnt lgkmcnt(2)
    v_pk_add_f32 v[12:13], v[12:13], v[14:15]
    s_waitcnt lgkmcnt(0)
    v_pk_add_f32 v[16:17], v[16:17], v[18:19]
    v_pk_add_f32 v[12:13], v[12:13], v[16:17]
    v_add_f32 v14, v12, v13
    v_add_f32 v15, v12, v13
    s_nop 1
    v_permlane16_swap_b32 v14, v15
    v_add_f32 v12, v14, v15
    v_min_u32 v12, -2, v12
    buffer_store_dword v12, v33, s[40:43], s58 offen sc1
    s_branch L_finb_141
L_sr_146:
    buffer_load_dwordx4 v[12:15], v11, s[40:43], s58 offen offset:0 sc1
    buffer_load_dwordx4 v[16:19], v11, s[40:43], s58 offen offset:1024 sc1
    s_sub_u32 s56, s56, 1
    s_cbranch_scc1 L_done
    s_waitcnt vmcnt(0)
    s_branch L_sw_145
L_hr_150:
    s_sub_u32 s56, s56, 1
    s_cbranch_scc1 L_done
    s_and_b32 s64, s56, 15
    s_cbranch_scc1 L_ha_152
    s_waitcnt vmcnt(0)
    v_max3_u32 v21, v12, v13, v14
    v_max3_u32 v21, v21, v15, v16
    v_max3_u32 v21, v21, v17, v18
    v_max_u32 v21, v21, v19
    v_cmp_eq_u32 vcc, -1, v21
    s_cbranch_vccnz L_ha_152
    v_pk_add_f32 v[20:21], v[12:13], v[14:15]
    v_pk_add_f32 v[22:23], v[16:17], v[18:19]
    v_pk_add_f32 v[20:21], v[20:21], v[22:23]
    v_add_f32 v20, v20, v21
    v_fma_f32 v20, v20, v3, v8
    s_branch L_hk_151
L_ha_152:
    buffer_load_dwordx4 v[12:15], v11, s[40:43], s58 offen offset:0 sc1
    buffer_load_dwordx4 v[16:19], v11, s[40:43], s58 offen offset:1024 sc1
    s_waitcnt vmcnt(2)
    s_branch L_hw_149
L_xr_155:
    s_sub_u32 s56, s56, 1
    s_cbranch_scc1 L_done
    s_branch L_xw_154
L_gs_156:
    buffer_store_dword v0, v5, s[40:43], s74 offen sc1
    s_branch L_gb_157
L_gs_162:
    buffer_store_dword v12, v11, s[40:43], s60 offen sc1
    s_branch L_gb_163
L_gs_164:
    buffer_store_dword v12, v11, s[40:43], s59 offen sc1
    s_branch L_gb_165
L_gr_167:
    s_cbranch_scc1 L_gw_166
    s_waitcnt vmcnt(0)
    v_max3_u32 v32, v12, v13, v14
    v_max3_u32 v32, v32, v15, v16
    v_max3_u32 v32, v32, v17, v18
    v_max3_u32 v32, v32, v19, v20
    v_max3_u32 v32, v32, v21, v22
    v_max3_u32 v32, v32, v23, v24
    v_max3_u32 v32, v32, v25, v26
    v_max_u32 v32, v32, v27
    v_cmp_eq_u32 vcc, -1, v32
    s_cbranch_vccnz L_gw_166
    v_pk_add_f32 v[28:29], v[12:13], v[16:17]
    v_pk_add_f32 v[30:31], v[14:15], v[18:19]
    v_pk_add_f32 v[28:29], v[28:29], v[20:21]
    v_pk_add_f32 v[30:31], v[30:31], v[22:23]
    v_pk_add_f32 v[28:29], v[28:29], v[24:25]
L_pad16:
    s_cbranch_execz L_pad20
    v_pk_add_f32 v[30:31], v[30:31], v[26:27]
    s_nop 1
    v_permlane32_swap_b32 v28, v30
    v_permlane32_swap_b32 v29, v31
    s_branch L_gk_168
L_gs_171:
    buffer_store_dword v33, v34, s[40:43], s67 offen sc1
    s_branch L_gb_172
L_w7_159:
    v_and_b32 v60, 31, v0
    v_min_u32 v60, 19, v60
    s_mul_i32 s57, s54, 320
    v_lshrrev_b32 v5, 5, v0
    v_mul_u32_u24 v5, 2560, v5
    v_add_u32 v5, s57, v5
    v_lshl_add_u32 v5, v60, 4, v5
    v_and_b32 v60, 31, v0
    v_cmp_gt_u32 s[64:65], 20, v60
    v_min_u32 v60, 19, v60
    v_lshrrev_b32 v35, 5, v0
    v_lshlrev_b32 v35, 2, v35
    v_add_u32 v35, 160832, v35
    v_lshl_add_u32 v35, v60, 3, v35
    s_add_u32 s66, s62, 13312
    s_add_u32 s67, s62, 25856
    s_lshl_b32 s57, s54, 3
    v_lshrrev_b32 v34, 5, v0
    v_lshlrev_b32 v34, 2, v34
    v_add_u32 v34, s57, v34
    v_and_b32 v60, 31, v0
    v_mov_b32 v61, 0x7f000000
    v_cmp_ne_u32 vcc, 31, v60
    s_nop 1
    v_cndmask_b32 v34, v34, v61, vcc
    v_mov_b32 v61, 0x3f803f80
    s_add_u32 s57, s7, 0
    s_add_u32 s58, s7, 32768
    s_add_u32 s59, s7, 65536
    s_add_u32 s60, s7, 98304
    s_add_u32 s75, s62, 26112
    v_min_u32 v9, 19, v0
    v_lshlrev_b32 v9, 2, v9
    buffer_load_dword v12, v9, s[40:43], s75 offen sc1
    s_sleep 2
L_pr_170:
    buffer_load_dword v12, v9, s[40:43], s75 offen sc1
    s_sub_u32 s56, s56, 1
    s_cbranch_scc1 L_done
L_pw_169:
    s_waitcnt vmcnt(1)
    v_cmp_eq_u32 vcc, -1, v12
    s_cbranch_vccnz L_pr_170
    buffer_load_dwordx4 v[12:15], v5, s[40:43], s57 offen sc1
    buffer_load_dwordx4 v[16:19], v5, s[40:43], s58 offen sc1
    buffer_load_dwordx4 v[20:23], v5, s[40:43], s59 offen sc1
    buffer_load_dwordx4 v[24:27], v5, s[40:43], s60 offen sc1
    s_sleep 2
L_gw_166:
    buffer_load_dwordx4 v[12:15], v5, s[40:43], s57 offen sc1
    buffer_load_dwordx4 v[16:19], v5, s[40:43], s58 offen sc1
    buffer_load_dwordx4 v[20:23], v5, s[40:43], s59 offen sc1
    buffer_load_dwordx4 v[24:27], v5, s[40:43], s60 offen sc1
    s_sub_u32 s56, s56, 1
    s_cbranch_scc1 L_done
    s_and_b32 s74, s56, 31
    s_waitcnt vmcnt(6)
    v_pk_add_f32 v[28:29], v[12:13], v[16:17]
    v_pk_add_f32 v[30:31], v[14:15], v[18:19]
    s_waitcnt vmcnt(5)
    v_pk_add_f32 v[28:29], v[28:29], v[20:21]
    v_pk_add_f32 v[30:31], v[30:31], v[22:23]
    s_waitcnt vmcnt(4)
    v_pk_add_f32 v[28:29], v[28:29], v[24:25]
    v_pk_add_f32 v[30:31], v[30:31], v[26:27]
    v_pk_add_f32 v[32:33], v[28:29], v[30:31]
    v_cmp_u_f32 vcc, v32, v33
    v_permlane32_swap_b32 v28, v30
    v_permlane32_swap_b32 v29, v31
    s_cbranch_vccnz L_gr_167
L_gk_168:
    v_pk_add_f32 v[28:29], v[28:29], v[30:31]
    v_pk_add_f32 v[28:29], v[28:29], v[2:3]
    v_cvt_pk_bf16_f32 v28, v28, v29
    ds_write_b32 v35, v28
    s_waitcnt lgkmcnt(0)
    s_barrier
    v_cndmask_b32 v29, 0, v28, s[64:65]
    v_dot2_f32_bf16 v33, v29, v61, 0
    v_dot2_f32_bf16 v32, v29, v29, 0
    v_lshlrev_b32 v2, 16, v28
    v_and_b32 v3, 0xffff0000, v28
    s_cmp_eq_u32 s55, 0
L_pad17:
    s_cbranch_execz L_pad21
    v_permlane32_swap_b32 v33, v32
    v_add_f32 v33, v33, v32
    s_nop 1
    v_add_f32_dpp v33, v33, v33 row_ror:8 row_mask:0xf bank_mask:0xf
    s_nop 1
    v_add_f32_dpp v33, v33, v33 row_ror:4 row_mask:0xf bank_mask:0xf
    s_nop 1
    v_add_f32_dpp v33, v33, v33 row_ror:2 row_mask:0xf bank_mask:0xf
    s_nop 1
    v_add_f32_dpp v33, v33, v33 row_ror:1 row_mask:0xf bank_mask:0xf
    s_nop 1
    v_add_f32_dpp v33, v33, v33 row_bcast:15 row_mask:0xa bank_mask:0xf
    v_min_u32 v33, -2, v33
    s_cbranch_scc1 L_gs_171
    buffer_store_dword v33, v34, s[40:43], s67 offen
L_gb_172:
    s_waitcnt vmcnt(1)
    s_branch L_se_160
L_gs_176:
    buffer_store_short v12, v11, s[40:43], s59 offen sc1
    s_branch L_gb_177
L_gr_182:
    s_cbranch_scc1 L_gw_181
    s_waitcnt vmcnt(0)
    v_max3_u32 v32, v12, v13, v14
    v_max3_u32 v32, v32, v15, v16
    v_max3_u32 v32, v32, v17, v18
    v_max3_u32 v32, v32, v19, v20
    v_max3_u32 v32, v32, v21, v22
    v_max3_u32 v32, v32, v23, v24
    v_max3_u32 v32, v32, v25, v26
    v_max_u32 v32, v32, v27
    v_cmp_eq_u32 vcc, -1, v32
    s_cbranch_vccnz L_gw_181
    v_pk_add_f32 v[28:29], v[12:13], v[16:17]
    v_pk_add_f32 v[30:31], v[14:15], v[18:19]
    v_pk_add_f32 v[28:29], v[28:29], v[20:21]
    v_pk_add_f32 v[30:31], v[30:31], v[22:23]
    v_pk_add_f32 v[28:29], v[28:29], v[24:25]
    v_pk_add_f32 v[30:31], v[30:31], v[26:27]
    s_nop 1
    v_permlane32_swap_b32 v28, v30
    v_permlane32_swap_b32 v29, v31
    s_branch L_gk_183
L_gr_185:
    s_cbranch_scc1 L_gw_184
    s_waitcnt vmcnt(0)
    v_max3_u32 v32, v12, v13, v14
    v_max3_u32 v32, v32, v15, v16
    v_max3_u32 v32, v32, v17, v18
    v_max3_u32 v32, v32, v19, v20
    v_max3_u32 v32, v32, v21, v22
    v_max3_u32 v32, v32, v23, v24
    v_max3_u32 v32, v32, v25, v26
    v_max_u32 v32, v32, v27
    v_cmp_eq_u32 vcc, -1, v32
    s_cbranch_vccnz L_gw_184
    v_pk_add_f32 v[28:29], v[12:13], v[16:17]
    v_pk_add_f32 v[30:31], v[14:15], v[18:19]
    v_pk_add_f32 v[28:29], v[28:29], v[20:21]
    v_pk_add_f32 v[30:31], v[30:31], v[22:23]
    v_pk_add_f32 v[28:29], v[28:29], v[24:25]
    v_pk_add_f32 v[30:31], v[30:31], v[26:27]
    s_nop 1
    v_permlane32_swap_b32 v28, v30
    v_permlane32_swap_b32 v29, v31
    s_branch L_gk_186
L_gs_189:
    buffer_store_dword v33, v34, s[40:43], s67 offen sc1
    s_branch L_gb_190
L_w7_173:
    v_and_b32 v60, 31, v0
    v_min_u32 v60, 19, v60
    s_mul_i32 s57, s54, 320
    v_lshrrev_b32 v5, 5, v0
    v_mul_u32_u24 v5, 2560, v5
    v_add_u32 v5, s57, v5
    v_lshl_add_u32 v5, v60, 4, v5
    v_and_b32 v60, 31, v0
    v_cmp_gt_u32 s[64:65], 20, v60
    v_min_u32 v60, 19, v60
    v_lshrrev_b32 v35, 5, v0
    v_lshlrev_b32 v35, 2, v35
    v_add_u32 v35, 160832, v35
    v_lshl_add_u32 v35, v60, 3, v35
    s_mul_i32 s66, s53, 3072
    s_add_u32 s66, s66, s62
    s_add_u32 s66, s66, 46464
    s_lshl_b32 s67, s53, 6
    s_add_u32 s67, s67, s62
    s_add_u32 s67, s67, 25600
L_pad18:
    s_cbranch_execz L_pad22
    s_lshl_b32 s57, s54, 3
    v_lshrrev_b32 v34, 5, v0
    v_lshlrev_b32 v34, 2, v34
    v_add_u32 v34, s57, v34
    v_and_b32 v60, 31, v0
    v_mov_b32 v61, 0x7f000000
    v_cmp_ne_u32 vcc, 31, v60
    s_nop 1
    v_cndmask_b32 v34, v34, v61, vcc
    v_mov_b32 v61, 0x3f803f80
    s_cmp_lg_u32 s53, 3
    s_cbranch_scc0 L_skip_178
    s_add_u32 s57, s62, 25856
    v_mov_b32 v9, 0
L_pr_180:
    buffer_load_dword v12, v9, s[40:43], s57 offen sc1
    s_sub_u32 s56, s56, 1
    s_cbranch_scc1 L_done
L_pw_179:
    s_waitcnt vmcnt(0)
    v_cmp_eq_u32 vcc, -1, v12
    s_cbranch_vccnz L_pr_180
    s_add_u32 s57, s7, 0
    s_add_u32 s58, s7, 32768
    s_add_u32 s59, s7, 65536
    s_add_u32 s60, s7, 98304
L_gw_181:
    buffer_load_dwordx4 v[12:15], v5, s[40:43], s57 offen sc1
    buffer_load_dwordx4 v[16:19], v5, s[40:43], s58 offen sc1
    buffer_load_dwordx4 v[20:23], v5, s[40:43], s59 offen sc1
    buffer_load_dwordx4 v[24:27], v5, s[40:43], s60 offen sc1
    s_sub_u32 s56, s56, 1
    s_cbranch_scc1 L_done
    s_and_b32 s74, s56, 31
    s_waitcnt vmcnt(2)
    v_pk_add_f32 v[28:29], v[12:13], v[16:17]
    v_pk_add_f32 v[30:31], v[14:15], v[18:19]
    s_waitcnt vmcnt(1)
    v_pk_add_f32 v[28:29], v[28:29], v[20:21]
    v_pk_add_f32 v[30:31], v[30:31], v[22:23]
    s_waitcnt vmcnt(0)
    v_pk_add_f32 v[28:29], v[28:29], v[24:25]
    v_pk_add_f32 v[30:31], v[30:31], v[26:27]
    v_pk_add_f32 v[32:33], v[28:29], v[30:31]
    v_cmp_u_f32 vcc, v32, v33
    v_permlane32_swap_b32 v28, v30
    v_permlane32_swap_b32 v29, v31
    s_cbranch_vccnz L_gr_182
L_gk_183:
    v_pk_add_f32 v[28:29], v[28:29], v[30:31]
    v_pk_add_f32 v[28:29], v[28:29], v[2:3]
    v_cvt_pk_bf16_f32 v28, v28, v29
    v_lshlrev_b32 v2, 16, v28
    v_and_b32 v3, 0xffff0000, v28
L_skip_178:
    v_lshlrev_b32 v60, 16, v4
    v_add_f32 v2, v2, v60
    v_and_b32 v60, 0xffff0000, v4
    v_add_f32 v3, v3, v60
    s_add_u32 s57, s7, 131072
    s_add_u32 s58, s7, 163840
    s_add_u32 s59, s7, 196608
    s_add_u32 s60, s7, 229376
    s_add_u32 s75, s62, 26496
    s_lshl_b32 s74, s53, 7
    s_add_u32 s75, s75, s74
    v_min_u32 v9, 19, v0
    v_lshlrev_b32 v9, 2, v9
    buffer_load_dword v12, v9, s[40:43], s75 offen sc1
    s_sleep 2
L_pr_188:
    buffer_load_dword v12, v9, s[40:43], s75 offen sc1
    s_sub_u32 s56, s56, 1
    s_cbranch_scc1 L_done
L_pw_187:
    s_waitcnt vmcnt(1)
    v_cmp_eq_u32 vcc, -1, v12
    s_cbranch_vccnz L_pr_188
    buffer_load_dwordx4 v[12:15], v5, s[40:43], s57 offen sc1
    buffer_load_dwordx4 v[16:19], v5, s[40:43], s58 offen sc1
    buffer_load_dwordx4 v[20:23], v5, s[40:43], s59 offen sc1
    buffer_load_dwordx4 v[24:27], v5, s[40:43], s60 offen sc1
    s_sleep 2
L_gw_184:
    buffer_load_dwordx4 v[12:15], v5, s[40:43], s57 offen sc1
    buffer_load_dwordx4 v[16:19], v5, s[40:43], s58 offen sc1
    buffer_load_dwordx4 v[20:23], v5, s[40:43], s59 offen sc1
    buffer_load_dwordx4 v[24:27], v5, s[40:43], s60 offen sc1
    s_sub_u32 s56, s56, 1
    s_cbranch_scc1 L_done
    s_and_b32 s74, s56, 31
    s_waitcnt vmcnt(6)
    v_pk_add_f32 v[28:29], v[12:13], v[16:17]
    v_pk_add_f32 v[30:31], v[14:15], v[18:19]
L_pad19:
    s_cbranch_execz L_pad23
    s_waitcnt vmcnt(5)
    v_pk_add_f32 v[28:29], v[28:29], v[20:21]
    v_pk_add_f32 v[30:31], v[30:31], v[22:23]
    s_waitcnt vmcnt(4)
    v_pk_add_f32 v[28:29], v[28:29], v[24:25]
    v_pk_add_f32 v[30:31], v[30:31], v[26:27]
    v_pk_add_f32 v[32:33], v[28:29], v[30:31]
    v_cmp_u_f32 vcc, v32, v33
    v_permlane32_swap_b32 v28, v30
    v_permlane32_swap_b32 v29, v31
    s_cbranch_vccnz L_gr_185
L_gk_186:
    v_pk_add_f32 v[28:29], v[28:29], v[30:31]
    v_pk_add_f32 v[28:29], v[28:29], v[2:3]
    v_cvt_pk_bf16_f32 v28, v28, v29
    ds_write_b32 v35, v28
    s_waitcnt lgkmcnt(0)
    s_barrier
    v_cndmask_b32 v29, 0, v28, s[64:65]
    v_dot2_f32_bf16 v33, v29, v61, 0
    v_dot2_f32_bf16 v32, v29, v29, 0
    v_lshlrev_b32 v2, 16, v28
    v_and_b32 v3, 0xffff0000, v28
    s_cmp_eq_u32 s55, 0
    v_permlane32_swap_b32 v33, v32
    v_add_f32 v33, v33, v32
    s_nop 1
    v_add_f32_dpp v33, v33, v33 row_ror:8 row_mask:0xf bank_mask:0xf
    s_nop 1
    v_add_f32_dpp v33, v33, v33 row_ror:4 row_mask:0xf bank_mask:0xf
    s_nop 1
    v_add_f32_dpp v33, v33, v33 row_ror:2 row_mask:0xf bank_mask:0xf
    s_nop 1
    v_add_f32_dpp v33, v33, v33 row_ror:1 row_mask:0xf bank_mask:0xf
    s_nop 1
    v_add_f32_dpp v33, v33, v33 row_bcast:15 row_mask:0xa bank_mask:0xf
    v_min_u32 v33, -2, v33
    s_cbranch_scc1 L_gs_189
    buffer_store_dword v33, v34, s[40:43], s67 offen
L_gb_190:
    s_waitcnt vmcnt(1)
    s_branch L_se_174
L_qr_194:
    s_cbranch_scc1 L_qw_193
    s_waitcnt vmcnt(0)
    v_pk_max_u16 v60, v48, v49
    v_pk_max_u16 v61, v50, v51
    v_pk_max_u16 v60, v60, v61
    v_lshlrev_b32 v61, 16, v60
    v_max_u32 v60, v60, v61
    v_cmp_le_u32 vcc, 0xffff0000, v60
    s_cbranch_vccnz L_qw_193
    v_dot2_f32_bf16 v60, v48, v10, 0
    v_dot2_f32_bf16 v61, v49, v10, 0
    v_dot2_f32_bf16 v60, v50, v10, v60
    v_dot2_f32_bf16 v61, v51, v10, v61
    s_nop 2
    v_add_f32 v60, v60, v61
    v_cvt_pk_bf16_f32 v60, v60, v60
    s_branch L_qk_195
L_qo_191:
    v_mov_b64 v[24:25], 0
    v_mov_b64 v[26:27], 0
    v_mov_b64 v[28:29], 0
    v_mov_b64 v[30:31], 0
    v_mov_b64 v[32:33], 0
    v_mov_b64 v[34:35], 0
    v_mov_b64 v[36:37], 0
    v_mov_b64 v[38:39], 0
    v_mov_b64 v[40:41], 0
    v_mov_b64 v[42:43], 0
    v_mov_b64 v[44:45], 0
    v_mov_b64 v[46:47], 0
    v_lshrrev_b32 v5, 4, v0
    v_lshlrev_b32 v5, 5, v5
    v_bfe_u32 v60, v0, 1, 1
    v_lshl_add_u32 v5, v60, 4, v5
    v_add_u32 v5, 124928, v5
    s_cmp_eq_u32 s30, 6
    s_cbranch_scc0 L_qb_192
    s_mul_i32 s59, s53, 3072
    s_add_u32 s59, s59, s62
    s_add_u32 s59, s59, 46464
    s_lshl_b32 s60, s53, 6
    s_add_u32 s60, s60, s62
    s_add_u32 s60, s60, 25600
    v_and_b32 v16, 7, v0
    v_lshlrev_b32 v16, 3, v16
L_pr_197:
    buffer_load_dwordx2 v[10:11], v16, s[40:43], s60 offen sc1
    s_sub_u32 s56, s56, 1
    s_cbranch_scc1 L_done
L_pw_196:
    s_waitcnt vmcnt(0)
    v_max_u32 v18, v10, v11
    v_cmp_eq_u32 vcc, -1, v18
    s_cbranch_vccnz L_pr_197
    v_add_f32_dpp v10, v10, v10 row_ror:4 row_mask:0xf bank_mask:0xf
L_pad20:
    s_cbranch_execz L_padback
    v_add_f32_dpp v11, v11, v11 row_ror:4 row_mask:0xf bank_mask:0xf
    s_nop 0
    v_add_f32_dpp v10, v10, v10 row_ror:2 row_mask:0xf bank_mask:0xf
    v_add_f32_dpp v11, v11, v11 row_ror:2 row_mask:0xf bank_mask:0xf
    s_nop 0
    v_add_f32_dpp v10, v10, v10 row_ror:1 row_mask:0xf bank_mask:0xf
    v_add_f32_dpp v11, v11, v11 row_ror:1 row_mask:0xf bank_mask:0xf
    v_mul_f32 v10, 0x3acccccd, v10
    v_mul_f32 v11, 0x3acccccd, v11
    v_fma_f32 v11, -v10, v10, v11
    v_max_f32 v11, 0, v11
    v_add_f32 v11, 0x3727c5ac, v11
    v_rsq_f32 v11, v11
    s_nop 0
    v_mul_f32 v11, 0x3dd53b95, v11
    v_mul_f32 v10, -v10, v11
    ds_write_b64 v8, v[10:11]
    s_branch L_qb_192
L_mr_198:
    ds_read_b32 v36, v62
    s_sub_u32 s56, s56, 1
    s_cbranch_scc1 L_done
    s_waitcnt lgkmcnt(0)
    v_cmp_eq_u32 vcc, -1, v36
    s_cbranch_vccnz L_mr_198
    v_max_f32_dpp v37, v36, v36 row_ror:4 row_mask:0xf bank_mask:0xf
    s_nop 1
    v_max_f32_dpp v37, v37, v37 row_ror:2 row_mask:0xf bank_mask:0xf
    s_nop 1
    v_max_f32_dpp v37, v37, v37 row_ror:1 row_mask:0xf bank_mask:0xf
    v_sub_f32 v39, s64, v37
    v_exp_f32 v39, v39
    s_branch L_mk_199
L_gs_200:
    buffer_store_dword v37, v4, s[40:43], s58 offen sc1
    s_branch L_gb_201
L_gs_202:
    buffer_store_dword v42, v3, s[40:43], s57 offen sc1
    s_branch L_gb_203
L_gs_204:
    buffer_store_dword v40, v4, s[40:43], s57 offen offset:32 sc1
    s_branch L_gb_205
L_comb_1:
    s_mov_b32 s58, 27008
    v_min_u32 v37, -2, v37
    s_cmp_eq_u32 s55, 0
    s_cbranch_scc1 L_gs_200
    buffer_store_dword v37, v4, s[40:43], s58 offen
L_gb_201:
    s_mov_b32 s57, 27008
    s_cmp_eq_u32 s55, 0
    s_waitcnt lgkmcnt(0)
    s_barrier
    ds_read2st64_b64 v[40:43], v2 offset0:0 offset1:4
    ds_read2st64_b64 v[44:47], v2 offset0:8 offset1:12
    ds_read2st64_b64 v[48:51], v2 offset0:16 offset1:20
    ds_read2st64_b64 v[52:55], v2 offset0:24 offset1:28
    s_waitcnt lgkmcnt(2)
    v_pk_add_f32 v[40:41], v[40:41], v[42:43]
    v_pk_add_f32 v[44:45], v[44:45], v[46:47]
    v_pk_add_f32 v[40:41], v[40:41], v[44:45]
    s_waitcnt lgkmcnt(0)
    v_pk_add_f32 v[48:49], v[48:49], v[50:51]
    v_pk_add_f32 v[52:53], v[52:53], v[54:55]
    v_pk_add_f32 v[40:41], v[40:41], v[48:49]
    v_pk_add_f32 v[40:41], v[40:41], v[52:53]
    v_cvt_pk_bf16_f32 v42, v40, v41
    v_min_u32 v40, -2, v40
    v_min_u32 v42, -2, v42
    s_cbranch_scc1 L_gs_202
    buffer_store_dword v42, v3, s[40:43], s57 offen
L_gb_203:
    s_cbranch_scc1 L_gs_204
    buffer_store_dword v40, v4, s[40:43], s57 offen offset:32
L_gb_205:
    s_branch L_comb_1b
L_gs_212:
    buffer_store_dword v0, v34, s[40:43], s74 offen sc1
    s_branch L_gb_213
L_fin_210:
    s_cmp_eq_u32 s55, 0
    s_waitcnt vmcnt(0) lgkmcnt(0)
    s_barrier
    ds_read2st64_b32 v[12:13], v32 offset0:0 offset1:1
    ds_read2st64_b32 v[14:15], v32 offset0:2 offset1:3
    ds_read2st64_b32 v[16:17], v32 offset0:4 offset1:5
    ds_read2st64_b32 v[18:19], v32 offset0:6 offset1:7
    s_waitcnt lgkmcnt(2)
    v_pk_add_f32 v[12:13], v[12:13], v[14:15]
    s_waitcnt lgkmcnt(0)
    v_pk_add_f32 v[16:17], v[16:17], v[18:19]
    v_pk_add_f32 v[12:13], v[12:13], v[16:17]
L_pad21:
    s_cbranch_execz L_padback
    v_add_f32 v14, v12, v13
    v_add_f32 v15, v12, v13
    s_nop 1
    v_permlane16_swap_b32 v14, v15
    v_add_f32 v12, v14, v15
    v_min_u32 v12, -2, v12
    buffer_store_dword v12, v33, s[40:43], s58 offen sc1
    s_cbranch_scc1 L_gs_212
    buffer_store_dword v0, v34, s[40:43], s74 offen
L_gb_213:
    s_branch L_finb_211
L_sr_216:
    buffer_load_dwordx4 v[12:15], v11, s[40:43], s58 offen offset:0 sc1
    buffer_load_dwordx4 v[16:19], v11, s[40:43], s58 offen offset:1024 sc1
    s_sub_u32 s56, s56, 1
    s_cbranch_scc1 L_done
    s_waitcnt vmcnt(0)
    s_branch L_sw_215
L_hr_220:
    s_sub_u32 s56, s56, 1
    s_cbranch_scc1 L_done
    s_and_b32 s64, s56, 15
    s_cbranch_scc1 L_ha_222
    s_waitcnt vmcnt(0)
    v_max3_u32 v21, v12, v13, v14
    v_max3_u32 v21, v21, v15, v16
    v_max3_u32 v21, v21, v17, v18
    v_max_u32 v21, v21, v19
    v_cmp_eq_u32 vcc, -1, v21
    s_cbranch_vccnz L_ha_222
    v_pk_add_f32 v[20:21], v[12:13], v[14:15]
    v_pk_add_f32 v[22:23], v[16:17], v[18:19]
    v_pk_add_f32 v[20:21], v[20:21], v[22:23]
    v_add_f32 v20, v20, v21
    v_fma_f32 v20, v20, v3, v8
    s_branch L_hk_221
L_ha_222:
    buffer_load_dwordx4 v[12:15], v11, s[40:43], s58 offen offset:0 sc1
    buffer_load_dwordx4 v[16:19], v11, s[40:43], s58 offen offset:1024 sc1
    s_waitcnt vmcnt(2)
    s_branch L_hw_219
L_xr_225:
    s_sub_u32 s56, s56, 1
    s_cbranch_scc1 L_done
    s_branch L_xw_224
L_gs_226:
    buffer_store_dword v0, v5, s[40:43], s74 offen sc1
    s_branch L_gb_227
L_gs_231:
    buffer_store_dword v12, v11, s[40:43], s59 offen sc1
    s_branch L_gb_232
L_gr_234:
    s_cbranch_scc1 L_gw_233
    s_waitcnt vmcnt(0)
    v_max3_u32 v32, v12, v13, v14
    v_max3_u32 v32, v32, v15, v16
    v_max3_u32 v32, v32, v17, v18
    v_max3_u32 v32, v32, v19, v20
    v_max3_u32 v32, v32, v21, v22
    v_max3_u32 v32, v32, v23, v24
    v_max3_u32 v32, v32, v25, v26
    v_max_u32 v32, v32, v27
    v_cmp_eq_u32 vcc, -1, v32
    s_cbranch_vccnz L_gw_233
    v_pk_add_f32 v[28:29], v[12:13], v[16:17]
    v_pk_add_f32 v[30:31], v[14:15], v[18:19]
    v_pk_add_f32 v[28:29], v[28:29], v[20:21]
    v_pk_add_f32 v[30:31], v[30:31], v[22:23]
    v_pk_add_f32 v[28:29], v[28:29], v[24:25]
    v_pk_add_f32 v[30:31], v[30:31], v[26:27]
    s_nop 1
    v_permlane32_swap_b32 v28, v30
    v_permlane32_swap_b32 v29, v31
    s_branch L_gk_235
L_gs_238:
    buffer_store_dword v33, v34, s[40:43], s67 offen sc1
    s_branch L_gb_239
L_w7_228:
    v_and_b32 v60, 31, v0
    v_min_u32 v60, 19, v60
    s_mul_i32 s57, s54, 320
    v_lshrrev_b32 v5, 5, v0
    v_mul_u32_u24 v5, 2560, v5
    v_add_u32 v5, s57, v5
    v_lshl_add_u32 v5, v60, 4, v5
    v_and_b32 v60, 31, v0
    v_cmp_gt_u32 s[64:65], 20, v60
    v_min_u32 v60, 19, v60
    v_lshrrev_b32 v35, 5, v0
    v_lshlrev_b32 v35, 2, v35
    v_add_u32 v35, 160832, v35
    v_lshl_add_u32 v35, v60, 3, v35
    s_add_u32 s66, s62, 40320
    s_add_u32 s67, s62, 25984
    s_lshl_b32 s57, s54, 3
    v_lshrrev_b32 v34, 5, v0
    v_lshlrev_b32 v34, 2, v34
    v_add_u32 v34, s57, v34
    v_and_b32 v60, 31, v0
    v_mov_b32 v61, 0x7f000000
L_pad22:
    s_cbranch_execz L_padback
    v_cmp_ne_u32 vcc, 31, v60
    s_nop 1
    v_cndmask_b32 v34, v34, v61, vcc
    v_mov_b32 v61, 0x3f803f80
    s_add_u32 s57, s7, 262144
    s_add_u32 s58, s7, 294912
    s_add_u32 s59, s7, 327680
    s_add_u32 s60, s7, 360448
    s_add_u32 s75, s62, 26240
    v_min_u32 v9, 19, v0
    v_lshlrev_b32 v9, 2, v9
    buffer_load_dword v12, v9, s[40:43], s75 offen sc1
    s_sleep 2
L_pr_237:
    buffer_load_dword v12, v9, s[40:43], s75 offen sc1
    s_sub_u32 s56, s56, 1
    s_cbranch_scc1 L_done
L_pw_236:
    s_waitcnt vmcnt(1)
    v_cmp_eq_u32 vcc, -1, v12
    s_cbranch_vccnz L_pr_237
    buffer_load_dwordx4 v[12:15], v5, s[40:43], s57 offen sc1
    buffer_load_dwordx4 v[16:19], v5, s[40:43], s58 offen sc1
    buffer_load_dwordx4 v[20:23], v5, s[40:43], s59 offen sc1
    buffer_load_dwordx4 v[24:27], v5, s[40:43], s60 offen sc1
    s_sleep 2
L_gw_233:
    buffer_load_dwordx4 v[12:15], v5, s[40:43], s57 offen sc1
    buffer_load_dwordx4 v[16:19], v5, s[40:43], s58 offen sc1
    buffer_load_dwordx4 v[20:23], v5, s[40:43], s59 offen sc1
    buffer_load_dwordx4 v[24:27], v5, s[40:43], s60 offen sc1
    s_sub_u32 s56, s56, 1
    s_cbranch_scc1 L_done
    s_and_b32 s74, s56, 31
    s_waitcnt vmcnt(6)
    v_pk_add_f32 v[28:29], v[12:13], v[16:17]
    v_pk_add_f32 v[30:31], v[14:15], v[18:19]
    s_waitcnt vmcnt(5)
    v_pk_add_f32 v[28:29], v[28:29], v[20:21]
    v_pk_add_f32 v[30:31], v[30:31], v[22:23]
    s_waitcnt vmcnt(4)
    v_pk_add_f32 v[28:29], v[28:29], v[24:25]
    v_pk_add_f32 v[30:31], v[30:31], v[26:27]
    v_pk_add_f32 v[32:33], v[28:29], v[30:31]
    v_cmp_u_f32 vcc, v32, v33
    v_permlane32_swap_b32 v28, v30
    v_permlane32_swap_b32 v29, v31
    s_cbranch_vccnz L_gr_234
L_gk_235:
    v_pk_add_f32 v[28:29], v[28:29], v[30:31]
    v_pk_add_f32 v[28:29], v[28:29], v[2:3]
    v_cvt_pk_bf16_f32 v28, v28, v29
    ds_write_b32 v35, v28
    s_waitcnt lgkmcnt(0)
    s_barrier
    v_cndmask_b32 v29, 0, v28, s[64:65]
    v_dot2_f32_bf16 v33, v29, v61, 0
    v_dot2_f32_bf16 v32, v29, v29, 0
    v_lshlrev_b32 v2, 16, v28
    v_and_b32 v3, 0xffff0000, v28
    s_cmp_eq_u32 s55, 0
    v_permlane32_swap_b32 v33, v32
    v_add_f32 v33, v33, v32
    s_nop 1
    v_add_f32_dpp v33, v33, v33 row_ror:8 row_mask:0xf bank_mask:0xf
    s_nop 1
    v_add_f32_dpp v33, v33, v33 row_ror:4 row_mask:0xf bank_mask:0xf
    s_nop 1
    v_add_f32_dpp v33, v33, v33 row_ror:2 row_mask:0xf bank_mask:0xf
    s_nop 1
    v_add_f32_dpp v33, v33, v33 row_ror:1 row_mask:0xf bank_mask:0xf
    s_nop 1
    v_add_f32_dpp v33, v33, v33 row_bcast:15 row_mask:0xa bank_mask:0xf
    v_min_u32 v33, -2, v33
    s_cbranch_scc1 L_gs_238
    buffer_store_dword v33, v34, s[40:43], s67 offen
L_gb_239:
    s_waitcnt vmcnt(1)
    s_branch L_se_229
L_gr_241:
    s_cbranch_scc1 L_gw_240
    s_waitcnt vmcnt(0)
    v_max3_u32 v32, v12, v13, v14
    v_max3_u32 v32, v32, v15, v16
    v_max3_u32 v32, v32, v17, v18
    v_max3_u32 v32, v32, v19, v20
    v_max3_u32 v32, v32, v21, v22
    v_max3_u32 v32, v32, v23, v24
    v_max3_u32 v32, v32, v25, v26
L_pad23:
    s_cbranch_execz L_padback
    v_max_u32 v32, v32, v27
    v_cmp_eq_u32 vcc, -1, v32
    s_cbranch_vccnz L_gw_240
    v_pk_add_f32 v[28:29], v[12:13], v[16:17]
    v_pk_add_f32 v[30:31], v[14:15], v[18:19]
    v_pk_add_f32 v[28:29], v[28:29], v[20:21]
    v_pk_add_f32 v[30:31], v[30:31], v[22:23]
    v_pk_add_f32 v[28:29], v[28:29], v[24:25]
    v_pk_add_f32 v[30:31], v[30:31], v[26:27]
    s_nop 1
    v_permlane32_swap_b32 v28, v30
    v_permlane32_swap_b32 v29, v31
    s_branch L_gk_242
L_tail_end:
L_spread:
    s_add_u32 s62, s62, 688128
    s_cmp_eq_u32 s30, 5
    s_cbranch_scc0 L_skip_79
    v_mov_b64 v[12:13], -1
    v_mov_b64 v[14:15], -1
    v_lshlrev_b32 v16, 4, v0
    s_mul_i32 s57, s52, 1840
    s_add_u32 s57, s57, s62
    s_mov_b32 exec_lo, 0xffffffff
    s_mov_b32 exec_hi, 0x7ffff
    buffer_store_dwordx4 v[12:15], v16, s[40:43], s57 offen offset:1024 sc1
    s_mov_b64 exec, -1
    buffer_store_dwordx4 v[12:15], v16, s[40:43], s57 offen sc1
L_skip_79:
    s_cmp_eq_u32 s30, 7
    s_cbranch_scc0 L_skip_80
    v_and_b32 v60, 31, v0
    v_cmp_gt_u32 s[64:65], 20, v60
    v_min_u32 v60, 19, v60
    v_lshrrev_b32 v35, 5, v0
    v_lshlrev_b32 v35, 2, v35
    v_add_u32 v35, 160832, v35
    v_lshl_add_u32 v35, v60, 3, v35
    s_mul_i32 s66, s53, 6400
    s_add_u32 s66, s66, s62
    s_add_u32 s66, s66, 58880
    s_add_u32 s67, s66, 6144
    s_lshl_b32 s57, s54, 3
    v_lshrrev_b32 v34, 5, v0
    v_lshlrev_b32 v34, 2, v34
    v_add_u32 v34, s57, v34
    v_and_b32 v60, 31, v0
    v_mov_b32 v61, 0x7f000000
    v_cmp_ne_u32 vcc, 31, v60
    s_nop 1
    v_cndmask_b32 v34, v34, v61, vcc
    v_mov_b32 v61, 0x3f803f80
    v_cvt_pk_bf16_f32 v28, v2, v3
L_skip_80:
    s_cmp_eq_u32 s30, 7
    s_cbranch_scc0 L_skip_81
    v_cndmask_b32 v29, 0, v28, s[64:65]
    v_dot2_f32_bf16 v33, v29, v61, 0
    v_dot2_f32_bf16 v32, v29, v29, 0
    v_lshlrev_b32 v2, 16, v28
    v_and_b32 v3, 0xffff0000, v28
    s_cmp_eq_u32 s55, 0
    v_permlane32_swap_b32 v33, v32
    v_add_f32 v33, v33, v32
    s_nop 1
    v_add_f32_dpp v33, v33, v33 row_ror:8 row_mask:0xf bank_mask:0xf
    s_nop 1
    v_add_f32_dpp v33, v33, v33 row_ror:4 row_mask:0xf bank_mask:0xf
    s_nop 1
    v_add_f32_dpp v33, v33, v33 row_ror:2 row_mask:0xf bank_mask:0xf
    s_nop 1
    v_add_f32_dpp v33, v33, v33 row_ror:1 row_mask:0xf bank_mask:0xf
    s_nop 1
    v_add_f32_dpp v33, v33, v33 row_bcast:15 row_mask:0xa bank_mask:0xf
    v_min_u32 v33, -2, v33
    s_cbranch_scc1 L_gs_82
    buffer_store_dword v33, v34, s[40:43], s67 offen
L_gb_83:
    s_waitcnt vmcnt(1)
L_skip_81:
    s_cmp_lt_u32 s30, 6
    s_cbranch_scc0 L_skip_84
    s_lshr_b32 s57, s30, 1
    s_mul_i32 s57, s57, 1024
    s_and_b32 s58, s30, 1
    s_lshl_b32 s58, s58, 6
    s_add_u32 s57, s57, s58
    v_lshrrev_b32 v18, 5, v0
    v_mul_u32_u24 v18, 6144, v18
    v_bfe_u32 v60, v0, 3, 1
    v_mul_u32_u24 v60, 3072, v60
    v_add_u32 v18, v60, v18
    v_bfe_u32 v60, v0, 4, 1
    v_lshl_add_u32 v18, v60, 9, v18
    v_bfe_u32 v60, v0, 2, 1
    v_lshl_add_u32 v18, v60, 7, v18
    v_and_b32 v60, 3, v0
    v_lshl_add_u32 v18, v60, 3, v18
    v_add_u32 v18, s57, v18
    v_bfe_u32 v19, v0, 4, 1
    v_mul_u32_u24 v19, 3072, v19
    v_bfe_u32 v60, v0, 3, 1
    v_lshl_add_u32 v19, v60, 9, v19
    v_bfe_u32 v60, v0, 2, 1
    v_lshl_add_u32 v19, v60, 7, v19
    v_and_b32 v60, 3, v0
    v_lshl_add_u32 v19, v60, 3, v19
    v_add_u32 v19, s57, v19
    v_add_u32 v19, 24576, v19
    ds_read_b64_tr_b16 v[28:29], v18 offset:0
    ds_read_b64_tr_b16 v[30:31], v18 offset:256
    ds_read_b64_tr_b16 v[32:33], v18 offset:12288
    ds_read_b64_tr_b16 v[34:35], v18 offset:12544
    ds_read_b64_tr_b16 v[36:37], v19 offset:0
    ds_read_b64_tr_b16 v[38:39], v19 offset:256
    ds_read_b64_tr_b16 v[40:41], v18 offset:32
    ds_read_b64_tr_b16 v[42:43], v18 offset:288
    ds_read_b64_tr_b16 v[44:45], v18 offset:12320
    ds_read_b64_tr_b16 v[46:47], v18 offset:12576
    ds_read_b64_tr_b16 v[48:49], v19 offset:32
    ds_read_b64_tr_b16 v[50:51], v19 offset:288
    v_lshrrev_b32 v52, 4, v0
    v_lshlrev_b32 v52, 5, v52
    v_bfe_u32 v60, v0, 1, 1
    v_lshl_add_u32 v52, v60, 4, v52
    v_and_b32 v60, 1, v0
    v_mul_u32_u24 v60, 192, v60
    v_add_u32 v52, v60, v52
    v_add_u32 v52, 160832, v52
    v_lshrrev_b32 v53, 4, v0
    v_lshlrev_b32 v53, 4, v53
    v_bfe_u32 v60, v0, 1, 1
    v_lshl_add_u32 v53, v60, 3, v53
    v_and_b32 v60, 1, v0
    v_mul_u32_u24 v60, 192, v60
    v_add_u32 v53, v60, v53
    v_add_u32 v53, 160960, v53
    v_mov_b64 v[20:21], 0
    v_mov_b64 v[22:23], 0
    v_mov_b64 v[24:25], 0
    v_mov_b64 v[26:27], 0
    s_lshl_b32 s57, s54, 1
    s_lshl_b32 s58, s30, 9
    s_add_u32 s57, s57, s58
    v_and_b32 v54, 31, v0
    v_lshlrev_b32 v54, 4, v54
    v_lshrrev_b32 v60, 5, v0
    v_mul_u32_u24 v60, 3072, v60
    v_add_u32 v54, v60, v54
    v_add_u32 v54, s57, v54
    s_mul_i32 s59, s53, 6400
    s_add_u32 s59, s59, s62
    s_add_u32 s59, s59, 58880
    s_add_u32 s60, s59, 6144
    ds_read_b128 v[12:15], v52
    ds_read_b64 v[16:17], v53
    s_waitcnt lgkmcnt(1)
    v_smfmac_f32_16x16x64_bf16 v[20:23], v[12:15], v[28:35], v1
    v_smfmac_f32_16x16x64_bf16 v[24:27], v[12:15], v[40:47], v1
    s_waitcnt lgkmcnt(0)
    v_smfmac_f32_16x16x32_bf16 v[20:23], v[16:17], v[36:39], v1
    v_smfmac_f32_16x16x32_bf16 v[24:27], v[16:17], v[48:51], v1
    s_cmp_eq_u32 s55, 0
    s_nop 5
    v_add_f32 v12, v20, v22
    s_nop 1
    v_add_f32_dpp v12, v24, v26 quad_perm:[0,1,2,3] row_mask:0x2 bank_mask:0xf
    s_nop 1
    v_add_f32_dpp v12, v21, v23 quad_perm:[0,1,2,3] row_mask:0x4 bank_mask:0xf
    s_nop 1
    v_add_f32_dpp v12, v25, v27 quad_perm:[0,1,2,3] row_mask:0x8 bank_mask:0xf
    v_cvt_pk_bf16_f32 v12, v12, v12
    v_min_u32 v12, -2, v12
    s_cbranch_scc1 L_gs_85
    buffer_store_short v12, v54, s[40:43], s59 offen
L_gb_86:
L_skip_84:
    s_waitcnt vmcnt(0)
    s_barrier
    s_cmp_eq_u32 s30, 5
    s_cbranch_scc0 L_skip_87
    v_mov_b32 v25, 0
    s_lshl_b32 s57, s52, 2
    s_add_u32 s57, s57, s72
    s_mov_b64 exec, 1
    buffer_store_dword v25, v0, s[40:43], s57 offen offset:256 sc1
    s_mov_b64 exec, -1
    v_and_b32 v16, 31, v0
    v_lshlrev_b32 v16, 2, v16
L_pr_89:
    buffer_load_dword v17, v16, s[40:43], s72 offen offset:256 sc1
    s_sub_u32 s56, s56, 1
    s_cbranch_scc1 L_done
L_pw_88:
    s_waitcnt vmcnt(0)
    v_cmp_eq_u32 vcc, -1, v17
    s_cbranch_vccnz L_pr_89
L_skip_87:
    s_barrier
    s_branch L_spread_back
L_done:
L_exit:
    s_endpgm
.section .rodata,"a"
.p2align 6
.amdhsa_kernel interleave_layers__sliding_block_cached__dense_activation_gelu__decode_kernel
  .amdhsa_next_free_vgpr 256
  .amdhsa_next_free_sgpr 102
  .amdhsa_accum_offset 256
  .amdhsa_group_segment_fixed_size 0
  .amdhsa_kernarg_size 104
  .amdhsa_user_sgpr_count 2
  .amdhsa_user_sgpr_kernarg_segment_ptr 1
  .amdhsa_system_sgpr_workgroup_id_x 1
  .amdhsa_float_denorm_mode_32 3
.end_amdhsa_kernel
```

```asm
; @launch grid=(256,1,1) block=(512,1,1) lds=161216
.amdgcn_target "amdgcn-amd-amdhsa--gfx950"
.text
.fill 64, 4, 0xbf800000
.globl interleave_layers__sliding_block_cached__dense_activation_gelu__decode_kernel
.p2align 8
.type interleave_layers__sliding_block_cached__dense_activation_gelu__decode_kernel,@function
interleave_layers__sliding_block_cached__dense_activation_gelu__decode_kernel:
    s_load_dwordx16 s[4:19], s[0:1], 0
    s_load_dwordx8 s[20:27], s[0:1], 64
    s_load_dwordx2 s[28:29], s[0:1], 96
    s_cmp_ge_u32 s2, 256
    s_cbranch_scc1 L_exit
    s_getpc_b64 s[74:75]
L_pc:
    v_lshlrev_b32 v5, 6, v0
    v_min_u32 v5, L_exit-L_pc, v5
    global_load_dword v63, v5, s[74:75]
    v_lshrrev_b32 v5, 6, v0
    v_and_b32 v0, 63, v0
    v_readfirstlane_b32 s30, v5
    s_and_b32 s31, s2, 7
    s_lshr_b32 s52, s2, 3
    s_and_b32 s53, s52, 3
    s_lshr_b32 s54, s52, 2
    s_lshl_b32 s73, s31, 2
    s_add_u32 s73, s73, s53
    s_mul_i32 s3, s54, 3
    s_add_u32 s3, s3, s53
    s_cmp_eq_u32 s53, 3
    s_cselect_b32 s3, 31, s3
    s_cselect_b32 s70, 0, 0
    s_cmp_lt_u32 s3, 20
    s_cselect_b32 s70, 1, s70
    v_lshrrev_b32 v8, 5, v0
    v_lshlrev_b32 v8, 2, v8
    v_bfe_u32 v60, v0, 4, 1
    v_lshl_add_u32 v8, v60, 0, v8
    v_and_b32 v9, 7, v0
    v_xor_b32 v8, v8, v9
    v_lshrrev_b32 v10, 3, v0
    v_mul_u32_u24 v10, 384, v10
    v_lshl_add_u32 v5, v8, 4, v10
    v_xor_b32 v6, 32, v5
    v_lshrrev_b32 v8, 4, v0
    v_lshlrev_b32 v8, 1, v8
    v_xor_b32 v8, v8, v9
    v_lshl_add_u32 v7, v8, 4, v10
    v_lshrrev_b32 v2, 3, v0
    v_mul_u32_u24 v2, 12288, v2
    v_and_b32 v60, 7, v0
    v_lshl_add_u32 v2, v60, 4, v2
    s_mul_i32 s57, s73, 12582912
    s_mul_i32 s58, s54, 3072
    s_add_u32 s57, s57, s58
    s_add_u32 s57, s57, 11009024
    s_sub_u32 s58, 1573888, s58
    s_and_b32 s71, s73, 7
    s_mul_i32 s59, s73, 384
    s_mul_i32 s60, s54, 983040
    s_add_u32 s59, s59, s60
    s_sub_u32 s60, 7866368, s59
    s_lshl_b32 s61, s30, 11
    s_add_u32 s61, s61, 92160
    s_mul_i32 s62, s31, 86016
    s_lshl_b32 s72, s31, 9
    s_add_u32 s72, s72, 1933312
    s_mov_b32 s56, 65536
    s_mov_b32 s55, 1
    s_getreg_b32 s63, hwreg(20, 0, 3)
    s_andn2_b32 s64, 1, s63
    s_mul_i32 s64, s64, 1
    s_add_u32 s70, s70, s64
    v_mov_b32 v3, 0
    v_mov_b32 v4, 0
    v_mov_b32 v11, 0
    v_mov_b32 v24, 0
    v_mov_b32 v34, 0
    v_mov_b64 v[12:13], -1
    v_mov_b64 v[14:15], -1
    v_lshlrev_b32 v10, 4, v0
    s_waitcnt lgkmcnt(0)
    s_add_u32 s32, s6, s57
    s_addc_u32 s33, s7, 0
    s_mov_b32 s34, s58
    s_mov_b32 s35, 0x20000
    s_add_u32 s36, s8, s57
    s_addc_u32 s37, s9, 0
    s_mov_b32 s38, s58
    s_mov_b32 s39, 0x20000
    s_mov_b32 s40, s28
    s_mov_b32 s41, s29
    s_mov_b32 s42, 1937408
    s_mov_b32 s43, 0x20000
    s_add_u32 s44, s10, s59
    s_addc_u32 s45, s11, 0
    s_mov_b32 s46, s60
    s_mov_b32 s47, 0x20000
    s_sub_u32 s44, s44, 2048
    s_subb_u32 s45, s45, 0
    s_cmp_eq_u32 s30, 6
    s_cbranch_scc0 L_skip_1
    s_setprio 3
    s_xor_b32 s57, s71, 0
    s_mul_i32 s57, s57, 196608
    s_add_u32 s57, s57, 1024
    s_xor_b32 s58, s71, 1
    s_mul_i32 s58, s58, 196608
    s_add_u32 s58, s58, 0
    s_mov_b32 m0, 92160
L_dma_2:
    s_nop 0
    buffer_load_dwordx4 v5, s[32:35], s57 offen offset:0 nt lds
    buffer_load_dwordx4 v6, s[32:35], s58 offen offset:1024 nt lds
    s_add_u32 s57, s57, 24576
    s_add_u32 s58, s58, 24576
    s_add_u32 m0, m0, 2048
    s_cmp_lg_u32 m0, 108544
    s_cbranch_scc1 L_dma_2
    s_xor_b32 s57, s71, 0
    s_mul_i32 s57, s57, 196608
    s_add_u32 s57, s57, 1152
    s_xor_b32 s58, s71, 1
    s_mul_i32 s58, s58, 196608
    s_add_u32 s58, s58, 128
    s_mov_b32 m0, 108544
L_dma_3:
    s_waitcnt vmcnt(23)
    s_cmp_ge_u32 s70, 2
    s_cbranch_scc1 L_go_4
    s_waitcnt vmcnt(22)
    s_cmp_ge_u32 s70, 1
    s_cbranch_scc1 L_go_4
    s_waitcnt vmcnt(21)
L_go_4:
    buffer_load_dwordx4 v5, s[32:35], s57 offen offset:0 nt lds
    buffer_load_dwordx4 v6, s[32:35], s58 offen offset:1024 nt lds
    s_add_u32 s57, s57, 24576
    s_add_u32 s58, s58, 24576
    s_add_u32 m0, m0, 2048
    s_cmp_lg_u32 m0, 124928
    s_cbranch_scc1 L_dma_3
    s_mov_b32 s57, 2048
    s_mov_b32 s58, 1152
    s_mov_b32 s59, 256
    s_mov_b32 m0, 0
L_dma_5:
    s_waitcnt vmcnt(23)
    s_cmp_ge_u32 s70, 2
    s_cbranch_scc1 L_go_6
    s_waitcnt vmcnt(22)
    s_cmp_ge_u32 s70, 1
    s_cbranch_scc1 L_go_6
    s_waitcnt vmcnt(21)
L_go_6:
    buffer_load_dwordx4 v2, s[44:47], s57 offen offset:0 nt lds
    buffer_load_dwordx4 v2, s[44:47], s58 offen offset:1024 nt lds
    buffer_load_dwordx4 v2, s[44:47], s59 offen offset:2048 nt lds
    s_add_u32 s57, s57, 98304
    s_add_u32 s58, s58, 98304
    s_add_u32 s59, s59, 98304
    s_add_u32 m0, m0, 3072
    s_cmp_lg_u32 m0, 15360
    s_cbranch_scc1 L_dma_5
L_skip_1:
    s_cmp_lt_u32 s3, 20
    s_cselect_b32 s57, 7864320, 0
    s_add_u32 s58, s54, 1
    s_mul_i32 s58, s58, 245760
    s_cmp_lg_u32 s53, 3
    s_cselect_b64 s[48:49], s[12:13], s[16:17]
    s_cselect_b32 s50, s57, s58
    s_mov_b32 s51, 0x20000
    s_add_u32 s57, s28, 1376256
    s_sub_u32 s57, 0, s57
    s_and_b32 s57, s57, 0x7fff
    s_add_u32 s57, s57, 1376256
    s_lshr_b32 s58, s31, 1
    s_lshl_b32 s58, s58, 15
    s_add_u32 s6, s57, s58
    s_and_b32 s58, s31, 1
    s_mul_i32 s58, s58, 2560
    s_add_u32 s6, s6, s58
    s_lshl_b32 s58, s3, 7
    s_add_u32 s6, s6, s58
    s_mov_b32 s8, s57
    s_lshr_b32 s58, s52, 4
    s_lshl_b32 s58, s58, 15
    s_and_b32 s59, s52, 15
    s_lshl_b32 s59, s59, 7
    s_add_u32 s59, s59, s58
    s_add_u32 s59, s59, s57
    s_add_u32 s59, s59, 5120
    s_lshl_b32 s58, s31, 16
    s_add_u32 s59, s59, s58
    s_add_u32 s10, s28, s59
    s_addc_u32 s11, s29, 0
    s_lshr_b32 s58, s63, 2
    s_xor_b32 s58, s58, 0
    s_mul_i32 s58, s58, 8192
    s_add_u32 s7, s57, s58
    s_cmp_eq_u32 s30, 5
    s_cbranch_scc0 L_skip_7
    s_cmp_eq_u32 s52, 31
    s_cbranch_scc0 L_skip_8
    s_mov_b64 exec, 0xffffff
    buffer_store_dwordx4 v[12:15], v10, s[40:43], s72 offen sc1
    s_mov_b64 exec, -1
L_skip_8:
    s_cmp_lt_u32 s3, 20
    s_cbranch_scc0 L_skip_9
    v_and_b32 v16, 7, v0
    v_lshlrev_b32 v16, 4, v16
    v_bfe_u32 v17, v0, 3, 1
    v_lshl_add_u32 v16, v17, 13, v16
    v_lshrrev_b32 v17, 4, v0
    v_lshl_add_u32 v16, v17, 17, v16
    s_add_u32 s57, s6, 0
    buffer_store_dwordx4 v[12:15], v16, s[40:43], s57 offen sc1
L_skip_9:
    s_cmp_eq_u32 s3, 20
    s_cbranch_scc0 L_skip_10
    s_lshl_b32 s58, s31, 15
    s_add_u32 s58, s58, s8
    s_add_u32 s58, s58, 7168
    v_and_b32 v16, 7, v0
    v_lshlrev_b32 v16, 4, v16
    v_bfe_u32 v60, v0, 3, 1
    v_lshl_add_u32 v16, v60, 13, v16
    v_lshrrev_b32 v60, 4, v0
    v_lshl_add_u32 v16, v60, 28, v16
    buffer_store_dwordx4 v[12:15], v16, s[40:43], s58 offen sc1
L_skip_10:
    s_sub_u32 s58, s3, 20
    s_cmp_lt_u32 s58, 4
    s_cselect_b32 s59, s59, 0x7f000000
    v_and_b32 v16, 7, v0
    v_lshlrev_b32 v16, 4, v16
    v_bfe_u32 v60, v0, 3, 1
    v_lshl_add_u32 v16, v60, 13, v16
    v_lshrrev_b32 v60, 4, v0
    v_lshl_add_u32 v16, v60, 28, v16
    buffer_store_dwordx4 v[12:15], v16, s[40:43], s59 offen sc1
    s_mul_i32 s57, s52, 1840
    s_add_u32 s57, s57, s62
    s_mov_b32 exec_lo, 0xffffffff
    s_mov_b32 exec_hi, 0x7ffff
    buffer_store_dwordx4 v[12:15], v10, s[40:43], s57 offen offset:1024
    s_mov_b64 exec, -1
    buffer_store_dwordx4 v[12:15], v10, s[40:43], s57 offen
    s_mov_b64 exec, -1
    v_lshlrev_b32 v16, 4, v0
    v_add_u32 v16, 159744, v16
    ds_write_b128 v16, v[12:15]
    v_subrev_u32 v16, 8, v0
    v_cmp_gt_u32 vcc, 40, v16
    v_mov_b32 v16, 0x3f803f80
    s_nop 0
    v_cndmask_b32 v18, 0, v16, vcc
    v_min_u32 v16, 55, v0
    v_lshlrev_b32 v16, 2, v16
    v_add_u32 v16, 160992, v16
    ds_write_b32 v16, v18
    v_and_b32 v3, 7, v0
    v_lshlrev_b32 v3, 5, v3
L_skip_7:
    s_cmp_eq_u32 s30, 7
    s_cbranch_scc0 L_skip_11
    v_and_b32 v60, 31, v0
    v_min_u32 v60, 19, v60
    s_mul_i32 s57, s54, 160
    v_lshrrev_b32 v16, 5, v0
    v_lshlrev_b32 v16, 2, v16
    v_add_u32 v16, s57, v16
    v_lshl_add_u32 v16, v60, 3, v16
    global_load_dword v28, v16, s[4:5]
    global_load_dword v4, v16, s[22:23]
L_skip_11:
    s_sub_u32 s58, s30, 4
    s_cmp_lt_u32 s58, 3
    s_cbranch_scc0 L_skip_12
    s_mul_i32 s57, s31, 3
    s_add_u32 s57, s57, s58
    s_lshl_b32 s57, s57, 7
    v_lshlrev_b32 v16, 1, v0
    v_add_u32 v16, s57, v16
    global_load_short_d16_hi v4, v16, s[18:19]
L_skip_12:
    v_bfe_u32 v8, v0, 1, 3
    v_lshrrev_b32 v9, 4, v0
    v_xor_b32 v9, v8, v9
    v_bfe_u32 v8, v0, 2, 1
    v_lshlrev_b32 v8, 10, v8
    v_bfe_u32 v60, v0, 3, 1
    v_lshl_add_u32 v8, v60, 9, v8
    v_and_b32 v60, 3, v0
    v_lshl_add_u32 v8, v60, 7, v8
    v_add_u32 v8, s61, v8
    v_lshl_add_u32 v8, v9, 4, v8
    v_xor_b32 v9, 64, v8
    v_bfe_u32 v1, v0, 1, 1
    v_mul_u32_u24 v1, 43690, v1
    v_add_u32 v1, 17476, v1
    s_waitcnt vmcnt(31)
    s_barrier
    ds_read_b128 v[64:67], v8 offset:0
    ds_read_b128 v[68:71], v9 offset:0
    s_cmp_eq_u32 s30, 6
    s_cbranch_scc0 L_skip_13
    s_xor_b32 s57, s71, 0
    s_mul_i32 s57, s57, 196608
    s_add_u32 s57, s57, 1280
    s_xor_b32 s58, s71, 1
    s_mul_i32 s58, s58, 196608
    s_add_u32 s58, s58, 256
    s_mov_b32 m0, 124928
L_dma_14:
    s_waitcnt vmcnt(23)
    s_cmp_ge_u32 s70, 2
    s_cbranch_scc1 L_go_15
    s_waitcnt vmcnt(22)
    s_cmp_ge_u32 s70, 1
    s_cbranch_scc1 L_go_15
    s_waitcnt vmcnt(21)
L_go_15:
    buffer_load_dwordx4 v5, s[32:35], s57 offen offset:0 nt lds
    buffer_load_dwordx4 v6, s[32:35], s58 offen offset:1024 nt lds
    s_add_u32 s57, s57, 24576
    s_add_u32 s58, s58, 24576
    s_add_u32 m0, m0, 2048
    s_cmp_lg_u32 m0, 141312
    s_cbranch_scc1 L_dma_14
L_skip_13:
    s_waitcnt lgkmcnt(0)
    s_cmp_eq_u32 s30, 5
    s_cbranch_scc0 L_skip_16
    s_cmp_eq_u32 s52, 31
    s_cbranch_scc0 L_skip_17
    s_lshl_b32 s57, s31, 5
    v_mov_b32 v16, s57
    s_add_u32 s57, s63, 1
    v_mov_b32 v12, s57
    s_waitcnt vmcnt(4)
    s_mov_b64 exec, 0x1
    global_store_dword v16, v12, s[26:27] sc1
    s_mov_b64 exec, -1
L_skip_17:
L_skip_16:
    s_waitcnt vmcnt(31)
    s_barrier
    ds_read_b128 v[72:75], v8 offset:16384
    ds_read_b128 v[76:79], v9 offset:16384
    s_cmp_eq_u32 s30, 6
    s_cbranch_scc0 L_skip_18
    s_mov_b32 s57, 493568
    s_mov_b32 s58, 492672
    s_mov_b32 s59, 491776
    s_mov_b32 m0, 15360
L_dma_19:
    s_waitcnt vmcnt(23)
    s_cmp_ge_u32 s70, 2
    s_cbranch_scc1 L_go_20
    s_waitcnt vmcnt(22)
    s_cmp_ge_u32 s70, 1
    s_cbranch_scc1 L_go_20
    s_waitcnt vmcnt(21)
L_go_20:
    buffer_load_dwordx4 v2, s[44:47], s57 offen offset:0 nt lds
    buffer_load_dwordx4 v2, s[44:47], s58 offen offset:1024 nt lds
    buffer_load_dwordx4 v2, s[44:47], s59 offen offset:2048 nt lds
    s_add_u32 s57, s57, 98304
    s_add_u32 s58, s58, 98304
    s_add_u32 s59, s59, 98304
    s_add_u32 m0, m0, 3072
    s_cmp_lg_u32 m0, 30720
    s_cbranch_scc1 L_dma_19
    s_xor_b32 s57, s71, 2
    s_mul_i32 s57, s57, 196608
    s_add_u32 s57, s57, 1024
    s_xor_b32 s58, s71, 3
    s_mul_i32 s58, s58, 196608
    s_add_u32 s58, s58, 0
    s_mov_b32 m0, 141312
L_dma_21:
    s_waitcnt vmcnt(23)
    s_cmp_ge_u32 s70, 2
    s_cbranch_scc1 L_go_22
    s_waitcnt vmcnt(22)
    s_cmp_ge_u32 s70, 1
    s_cbranch_scc1 L_go_22
    s_waitcnt vmcnt(21)
L_go_22:
    buffer_load_dwordx4 v5, s[32:35], s57 offen offset:0 nt lds
    buffer_load_dwordx4 v6, s[32:35], s58 offen offset:1024 nt lds
    s_add_u32 s57, s57, 24576
    s_add_u32 s58, s58, 24576
    s_add_u32 m0, m0, 2048
    s_cmp_lg_u32 m0, 157696
    s_cbranch_scc1 L_dma_21
L_skip_18:
    s_waitcnt lgkmcnt(0)
    s_cmp_lt_u32 s30, 4
    s_cbranch_scc0 L_skip_23
    s_mov_b64 exec, 0
    s_cmp_eq_u32 s30, 1
    s_cbranch_scc1 L_pad1
    s_cmp_eq_u32 s30, 2
    s_cbranch_scc1 L_pad2
    s_cmp_eq_u32 s30, 3
    s_cbranch_scc1 L_pad3
    s_branch L_pad0
L_padback:
    s_mov_b64 exec, -1
L_skip_23:
    s_waitcnt vmcnt(31)
    s_barrier
    ds_read_b128 v[80:83], v8 offset:32768
    ds_read_b128 v[84:87], v9 offset:32768
    s_cmp_eq_u32 s30, 6
    s_cbranch_scc0 L_skip_24
    s_cmp_lg_u32 s53, 3
    s_cbranch_scc0 L_wb_25
    s_mul_i32 s57, s31, 983040
    s_lshl_b32 s58, s3, 6
    s_add_u32 s57, s57, s58
    v_bfe_u32 v38, v0, 4, 1
    v_lshlrev_b32 v38, 1, v38
    v_xor_b32 v38, v38, v0
    v_and_b32 v38, 3, v38
    v_lshrrev_b32 v3, 5, v0
    v_mul_u32_u24 v3, 10240, v3
    v_bfe_u32 v39, v0, 4, 1
    v_mul_u32_u24 v39, 2560, v39
    v_add_u32 v3, v39, v3
    v_bfe_u32 v39, v0, 3, 1
    v_mul_u32_u24 v39, 5120, v39
    v_add_u32 v3, v39, v3
    v_bfe_u32 v39, v0, 2, 1
    v_mul_u32_u24 v39, 20480, v39
    v_add_u32 v3, v39, v3
    v_add_u32 v3, s57, v3
    v_lshl_add_u32 v3, v38, 4, v3
    s_mov_b32 s14, 40960
    s_mov_b32 s15, 256
    s_branch L_we_26
L_wb_25:
    s_mul_i32 s57, s31, 384
    s_mul_i32 s58, s54, 245760
    s_add_u32 s57, s57, s58
    v_lshlrev_b32 v3, 4, v0
    v_add_u32 v3, s57, v3
    v_mov_b32 v38, 2688
    v_cmp_lt_u32 vcc, 23, v0
    s_nop 1
    v_cndmask_b32 v38, 0, v38, vcc
    v_add_u32 v3, v38, v3
    v_mov_b32 v38, 0x7f000000
    v_cmp_lt_u32 vcc, 47, v0
    s_nop 1
    v_cndmask_b32 v3, v3, v38, vcc
    s_mov_b32 s14, 12288
    s_mov_b32 s15, 5120
L_we_26:
    s_mul_i32 s57, s14, 0
    s_mov_b32 m0, 30720
    s_nop 0
    buffer_load_dwordx4 v3, s[48:51], s57 offen offset:0 nt lds
    s_mul_i32 s57, s14, 0
    s_add_u32 s57, s57, s15
    s_mov_b32 m0, 30720
    s_nop 0
    buffer_load_dwordx4 v3, s[48:51], s57 offen offset:1024 nt lds
    s_xor_b32 s57, s71, 2
    s_mul_i32 s57, s57, 196608
    s_add_u32 s57, s57, 1152
    s_xor_b32 s58, s71, 3
    s_mul_i32 s58, s58, 196608
    s_add_u32 s58, s58, 128
    s_mov_b32 m0, 92160
L_dma_27:
    s_waitcnt vmcnt(23)
    s_cmp_ge_u32 s70, 2
    s_cbranch_scc1 L_go_28
    s_waitcnt vmcnt(22)
    s_cmp_ge_u32 s70, 1
    s_cbranch_scc1 L_go_28
    s_waitcnt vmcnt(21)
L_go_28:
    buffer_load_dwordx4 v5, s[32:35], s57 offen offset:0 nt lds
    buffer_load_dwordx4 v6, s[32:35], s58 offen offset:1024 nt lds
    s_add_u32 s57, s57, 24576
    s_add_u32 s58, s58, 24576
    s_add_u32 m0, m0, 2048
    s_cmp_lg_u32 m0, 108544
    s_cbranch_scc1 L_dma_27
    s_mul_i32 s57, s14, 1
    s_mov_b32 m0, 32768
    s_nop 0
    buffer_load_dwordx4 v3, s[48:51], s57 offen offset:0 nt lds
    s_mul_i32 s57, s14, 1
    s_add_u32 s57, s57, s15
    s_mov_b32 m0, 32768
    s_nop 0
    buffer_load_dwordx4 v3, s[48:51], s57 offen offset:1024 nt lds
    s_xor_b32 s57, s71, 2
    s_mul_i32 s57, s57, 196608
    s_add_u32 s57, s57, 1280
    s_xor_b32 s58, s71, 3
    s_mul_i32 s58, s58, 196608
    s_add_u32 s58, s58, 256
    s_mov_b32 m0, 108544
L_dma_29:
    s_waitcnt vmcnt(23)
    s_cmp_ge_u32 s70, 2
    s_cbranch_scc1 L_go_30
    s_waitcnt vmcnt(22)
    s_cmp_ge_u32 s70, 1
    s_cbranch_scc1 L_go_30
    s_waitcnt vmcnt(21)
L_go_30:
    buffer_load_dwordx4 v5, s[32:35], s57 offen offset:0 nt lds
    buffer_load_dwordx4 v6, s[32:35], s58 offen offset:1024 nt lds
    s_add_u32 s57, s57, 24576
    s_add_u32 s58, s58, 24576
    s_add_u32 m0, m0, 2048
    s_cmp_lg_u32 m0, 124928
    s_cbranch_scc1 L_dma_29
L_skip_24:
    s_waitcnt lgkmcnt(0)
    s_cmp_lt_u32 s30, 5
    s_cbranch_scc0 L_skip_31
    s_waitcnt vmcnt(0)
L_skip_31:
    s_cmp_eq_u32 s30, 7
    s_cbranch_scc0 L_skip_32
    v_and_b32 v60, 31, v0
    v_cmp_gt_u32 s[64:65], 20, v60
    v_min_u32 v60, 19, v60
    v_lshrrev_b32 v35, 5, v0
    v_lshlrev_b32 v35, 2, v35
    v_add_u32 v35, 160832, v35
    v_lshl_add_u32 v35, v60, 3, v35
    s_mul_i32 s66, s53, 6400
    s_add_u32 s66, s66, s62
    s_add_u32 s66, s66, 58880
    s_add_u32 s67, s66, 6144
    s_lshl_b32 s57, s54, 3
    v_lshrrev_b32 v34, 5, v0
    v_lshlrev_b32 v34, 2, v34
    v_add_u32 v34, s57, v34
    v_and_b32 v60, 31, v0
    v_mov_b32 v61, 0x7f000000
    v_cmp_ne_u32 vcc, 31, v60
    s_nop 1
    v_cndmask_b32 v34, v34, v61, vcc
    v_mov_b32 v61, 0x3f803f80
    s_waitcnt vmcnt(0)
    ds_write_b32 v35, v28
    s_waitcnt lgkmcnt(0)
L_skip_32:
    s_cmp_eq_u32 s30, 5
    s_cbranch_scc0 L_skip_33
    s_waitcnt vmcnt(0)
    s_lshr_b32 s65, s63, 2
    s_sub_u32 s58, s3, 20
    s_cmp_lt_u32 s58, 4
    s_cbranch_scc0 L_skip_34
    s_mov_b32 s67, 0
    s_load_dword s66, s[10:11], 0
    s_load_dword s67, s[10:11], 8192
    s_waitcnt lgkmcnt(1)
    s_sleep 1
    s_mov_b32 s65, s67
L_skip_34:
L_skip_33:
    s_waitcnt vmcnt(36)
    s_barrier
    ds_read_b128 v[88:91], v8 offset:49152
    ds_read_b128 v[92:95], v9 offset:49152
    s_cmp_eq_u32 s30, 6
    s_cbranch_scc0 L_skip_35
    s_mul_i32 s57, s14, 2
    s_mov_b32 m0, 34816
    s_nop 0
    buffer_load_dwordx4 v3, s[48:51], s57 offen offset:0 nt lds
    s_mul_i32 s57, s14, 2
    s_add_u32 s57, s57, s15
    s_mov_b32 m0, 34816
    s_nop 0
    buffer_load_dwordx4 v3, s[48:51], s57 offen offset:1024 nt lds
    s_xor_b32 s57, s71, 4
    s_mul_i32 s57, s57, 196608
    s_add_u32 s57, s57, 1024
    s_xor_b32 s58, s71, 5
    s_mul_i32 s58, s58, 196608
    s_add_u32 s58, s58, 0
    s_mov_b32 m0, 124928
L_dma_36:
    s_waitcnt vmcnt(23)
    s_cmp_ge_u32 s70, 2
    s_cbranch_scc1 L_go_37
    s_waitcnt vmcnt(22)
    s_cmp_ge_u32 s70, 1
    s_cbranch_scc1 L_go_37
    s_waitcnt vmcnt(21)
L_go_37:
    buffer_load_dwordx4 v5, s[32:35], s57 offen offset:0 nt lds
    buffer_load_dwordx4 v6, s[32:35], s58 offen offset:1024 nt lds
    s_add_u32 s57, s57, 24576
    s_add_u32 s58, s58, 24576
    s_add_u32 m0, m0, 2048
    s_cmp_lg_u32 m0, 141312
    s_cbranch_scc1 L_dma_36
L_skip_35:
    s_waitcnt lgkmcnt(0)
    s_cmp_eq_u32 s30, 7
    s_cbranch_scc0 L_skip_38
    v_cndmask_b32 v29, 0, v28, s[64:65]
    v_dot2_f32_bf16 v33, v29, v61, 0
    v_dot2_f32_bf16 v32, v29, v29, 0
    v_lshlrev_b32 v2, 16, v28
    v_and_b32 v3, 0xffff0000, v28
    s_cmp_eq_u32 s55, 0
    v_permlane32_swap_b32 v33, v32
    v_add_f32 v33, v33, v32
    s_nop 1
    v_add_f32_dpp v33, v33, v33 row_ror:8 row_mask:0xf bank_mask:0xf
    s_nop 1
    v_add_f32_dpp v33, v33, v33 row_ror:4 row_mask:0xf bank_mask:0xf
    s_nop 1
    v_add_f32_dpp v33, v33, v33 row_ror:2 row_mask:0xf bank_mask:0xf
    s_nop 1
    v_add_f32_dpp v33, v33, v33 row_ror:1 row_mask:0xf bank_mask:0xf
    s_nop 1
    v_add_f32_dpp v33, v33, v33 row_bcast:15 row_mask:0xa bank_mask:0xf
    v_min_u32 v33, -2, v33
    s_cbranch_scc1 L_gs_39
    buffer_store_dword v33, v34, s[40:43], s67 offen
L_gb_40:
    s_waitcnt vmcnt(1)
L_skip_38:
    s_cmp_lt_u32 s30, 6
    s_cbranch_scc0 L_skip_41
    s_lshr_b32 s57, s30, 1
    s_mul_i32 s57, s57, 1024
    s_and_b32 s58, s30, 1
    s_lshl_b32 s58, s58, 6
    s_add_u32 s57, s57, s58
    v_lshrrev_b32 v18, 5, v0
    v_mul_u32_u24 v18, 6144, v18
    v_bfe_u32 v60, v0, 3, 1
    v_mul_u32_u24 v60, 3072, v60
    v_add_u32 v18, v60, v18
    v_bfe_u32 v60, v0, 4, 1
    v_lshl_add_u32 v18, v60, 9, v18
    v_bfe_u32 v60, v0, 2, 1
    v_lshl_add_u32 v18, v60, 7, v18
    v_and_b32 v60, 3, v0
    v_lshl_add_u32 v18, v60, 3, v18
    v_add_u32 v18, s57, v18
    v_bfe_u32 v19, v0, 4, 1
    v_mul_u32_u24 v19, 3072, v19
    v_bfe_u32 v60, v0, 3, 1
    v_lshl_add_u32 v19, v60, 9, v19
    v_bfe_u32 v60, v0, 2, 1
    v_lshl_add_u32 v19, v60, 7, v19
    v_and_b32 v60, 3, v0
    v_lshl_add_u32 v19, v60, 3, v19
    v_add_u32 v19, s57, v19
    v_add_u32 v19, 24576, v19
    ds_read_b64_tr_b16 v[28:29], v18 offset:0
    ds_read_b64_tr_b16 v[30:31], v18 offset:256
    ds_read_b64_tr_b16 v[32:33], v18 offset:12288
    ds_read_b64_tr_b16 v[34:35], v18 offset:12544
    ds_read_b64_tr_b16 v[36:37], v19 offset:0
    ds_read_b64_tr_b16 v[38:39], v19 offset:256
    ds_read_b64_tr_b16 v[40:41], v18 offset:32
    ds_read_b64_tr_b16 v[42:43], v18 offset:288
    ds_read_b64_tr_b16 v[44:45], v18 offset:12320
    ds_read_b64_tr_b16 v[46:47], v18 offset:12576
    ds_read_b64_tr_b16 v[48:49], v19 offset:32
    ds_read_b64_tr_b16 v[50:51], v19 offset:288
    v_lshrrev_b32 v52, 4, v0
    v_lshlrev_b32 v52, 5, v52
    v_bfe_u32 v60, v0, 1, 1
    v_lshl_add_u32 v52, v60, 4, v52
    v_and_b32 v60, 1, v0
    v_mul_u32_u24 v60, 192, v60
    v_add_u32 v52, v60, v52
    v_add_u32 v52, 160832, v52
    v_lshrrev_b32 v53, 4, v0
    v_lshlrev_b32 v53, 4, v53
    v_bfe_u32 v60, v0, 1, 1
    v_lshl_add_u32 v53, v60, 3, v53
    v_and_b32 v60, 1, v0
    v_mul_u32_u24 v60, 192, v60
    v_add_u32 v53, v60, v53
    v_add_u32 v53, 160960, v53
    v_mov_b64 v[20:21], 0
    v_mov_b64 v[22:23], 0
    v_mov_b64 v[24:25], 0
    v_mov_b64 v[26:27], 0
    s_lshl_b32 s57, s54, 1
    s_lshl_b32 s58, s30, 9
    s_add_u32 s57, s57, s58
    v_and_b32 v54, 31, v0
    v_lshlrev_b32 v54, 4, v54
    v_lshrrev_b32 v60, 5, v0
    v_mul_u32_u24 v60, 3072, v60
    v_add_u32 v54, v60, v54
    v_add_u32 v54, s57, v54
    s_mul_i32 s59, s53, 6400
    s_add_u32 s59, s59, s62
    s_add_u32 s59, s59, 58880
    s_add_u32 s60, s59, 6144
    ds_read_b128 v[12:15], v52
    ds_read_b64 v[16:17], v53
    s_waitcnt lgkmcnt(1)
    v_smfmac_f32_16x16x64_bf16 v[20:23], v[12:15], v[28:35], v1
    v_smfmac_f32_16x16x64_bf16 v[24:27], v[12:15], v[40:47], v1
    s_waitcnt lgkmcnt(0)
    v_smfmac_f32_16x16x32_bf16 v[20:23], v[16:17], v[36:39], v1
    v_smfmac_f32_16x16x32_bf16 v[24:27], v[16:17], v[48:51], v1
    s_cmp_eq_u32 s55, 0
    s_nop 5
    v_add_f32 v12, v20, v22
    s_nop 1
    v_add_f32_dpp v12, v24, v26 quad_perm:[0,1,2,3] row_mask:0x2 bank_mask:0xf
    s_nop 1
    v_add_f32_dpp v12, v21, v23 quad_perm:[0,1,2,3] row_mask:0x4 bank_mask:0xf
    s_nop 1
    v_add_f32_dpp v12, v25, v27 quad_perm:[0,1,2,3] row_mask:0x8 bank_mask:0xf
    v_cvt_pk_bf16_f32 v12, v12, v12
    v_min_u32 v12, -2, v12
    s_cbranch_scc1 L_gs_42
    buffer_store_short v12, v54, s[40:43], s59 offen
L_gb_43:
L_skip_41:
    s_cmp_eq_u32 s30, 5
    s_cbranch_scc0 L_skip_44
    global_load_dword v2, v3, s[26:27] sc1
L_skip_44:
    s_waitcnt vmcnt(36)
    s_barrier
    ds_read_b128 v[96:99], v8 offset:0
    ds_read_b128 v[100:103], v9 offset:0
    s_cmp_eq_u32 s30, 6
    s_cbranch_scc0 L_skip_45
    s_mul_i32 s57, s14, 3
    s_mov_b32 m0, 36864
    s_nop 0
    buffer_load_dwordx4 v3, s[48:51], s57 offen offset:0 nt lds
    s_mul_i32 s57, s14, 3
    s_add_u32 s57, s57, s15
    s_mov_b32 m0, 36864
    s_nop 0
    buffer_load_dwordx4 v3, s[48:51], s57 offen offset:1024 nt lds
    s_xor_b32 s57, s71, 4
    s_mul_i32 s57, s57, 196608
    s_add_u32 s57, s57, 1152
    s_xor_b32 s58, s71, 5
    s_mul_i32 s58, s58, 196608
    s_add_u32 s58, s58, 128
    s_mov_b32 m0, 141312
L_dma_46:
    s_waitcnt vmcnt(23)
    s_cmp_ge_u32 s70, 2
    s_cbranch_scc1 L_go_47
    s_waitcnt vmcnt(22)
    s_cmp_ge_u32 s70, 1
    s_cbranch_scc1 L_go_47
    s_waitcnt vmcnt(21)
L_go_47:
    buffer_load_dwordx4 v5, s[32:35], s57 offen offset:0 nt lds
    buffer_load_dwordx4 v6, s[32:35], s58 offen offset:1024 nt lds
    s_add_u32 s57, s57, 24576
    s_add_u32 s58, s58, 24576
    s_add_u32 m0, m0, 2048
    s_cmp_lg_u32 m0, 157696
    s_cbranch_scc1 L_dma_46
L_skip_45:
    s_waitcnt lgkmcnt(0)
    s_waitcnt vmcnt(36)
    s_barrier
    ds_read_b128 v[104:107], v8 offset:16384
    ds_read_b128 v[108:111], v9 offset:16384
    s_cmp_eq_u32 s30, 6
    s_cbranch_scc0 L_skip_48
    s_mul_i32 s57, s14, 4
    s_mov_b32 m0, 38912
    s_nop 0
    buffer_load_dwordx4 v3, s[48:51], s57 offen offset:0 nt lds
    s_mul_i32 s57, s14, 4
    s_add_u32 s57, s57, s15
    s_mov_b32 m0, 38912
    s_nop 0
    buffer_load_dwordx4 v3, s[48:51], s57 offen offset:1024 nt lds
    s_xor_b32 s57, s71, 4
    s_mul_i32 s57, s57, 196608
    s_add_u32 s57, s57, 1280
    s_xor_b32 s58, s71, 5
    s_mul_i32 s58, s58, 196608
    s_add_u32 s58, s58, 256
    s_mov_b32 m0, 92160
L_dma_49:
    s_waitcnt vmcnt(23)
    s_cmp_ge_u32 s70, 2
    s_cbranch_scc1 L_go_50
    s_waitcnt vmcnt(22)
    s_cmp_ge_u32 s70, 1
    s_cbranch_scc1 L_go_50
    s_waitcnt vmcnt(21)
L_go_50:
    buffer_load_dwordx4 v5, s[32:35], s57 offen offset:0 nt lds
    buffer_load_dwordx4 v6, s[32:35], s58 offen offset:1024 nt lds
    s_add_u32 s57, s57, 24576
    s_add_u32 s58, s58, 24576
    s_add_u32 m0, m0, 2048
    s_cmp_lg_u32 m0, 108544
    s_cbranch_scc1 L_dma_49
L_skip_48:
    s_waitcnt lgkmcnt(0)
    s_cmp_lg_u32 s30, 6
    s_cbranch_scc0 L_skip_51
    s_waitcnt vmcnt(0)
L_skip_51:
    s_waitcnt vmcnt(36)
    s_barrier
    ds_read_b128 v[112:115], v8 offset:32768
    ds_read_b128 v[116:119], v9 offset:32768
    s_cmp_eq_u32 s30, 6
    s_cbranch_scc0 L_skip_52
    s_mul_i32 s57, s14, 5
    s_mov_b32 m0, 40960
    s_nop 0
    buffer_load_dwordx4 v3, s[48:51], s57 offen offset:0 nt lds
    s_mul_i32 s57, s14, 5
    s_add_u32 s57, s57, s15
    s_mov_b32 m0, 40960
    s_nop 0
    buffer_load_dwordx4 v3, s[48:51], s57 offen offset:1024 nt lds
    s_xor_b32 s57, s71, 6
    s_mul_i32 s57, s57, 196608
    s_add_u32 s57, s57, 1024
    s_xor_b32 s58, s71, 7
    s_mul_i32 s58, s58, 196608
    s_add_u32 s58, s58, 0
    s_mov_b32 m0, 108544
L_dma_53:
    s_waitcnt vmcnt(23)
    s_cmp_ge_u32 s70, 2
    s_cbranch_scc1 L_go_54
    s_waitcnt vmcnt(22)
    s_cmp_ge_u32 s70, 1
    s_cbranch_scc1 L_go_54
    s_waitcnt vmcnt(21)
L_go_54:
    buffer_load_dwordx4 v5, s[32:35], s57 offen offset:0 nt lds
    buffer_load_dwordx4 v6, s[32:35], s58 offen offset:1024 nt lds
    s_add_u32 s57, s57, 24576
    s_add_u32 s58, s58, 24576
    s_add_u32 m0, m0, 2048
    s_cmp_lg_u32 m0, 124928
    s_cbranch_scc1 L_dma_53
L_skip_52:
    s_waitcnt lgkmcnt(0)
    s_cmp_eq_u32 s30, 5
    s_cbranch_scc0 L_skip_55
L_cw_56:
    v_readlane_b32 s57, v2, s31
    s_cmp_eq_u32 s57, 0
    s_cbranch_scc1 L_cr_57
    s_lshr_b32 s58, s63, 2
    s_xor_b32 s58, s58, s65
    s_and_b32 s58, s58, 1
    v_mov_b32 v25, s58
    s_sub_u32 s57, s57, 1
    s_cmp_eq_u32 s57, s63
    s_cselect_b32 s64, 1, 0
    s_cbranch_scc0 L_far_58
    s_lshl_b32 s57, s52, 2
    s_add_u32 s57, s57, s72
    s_mov_b64 exec, 1
    buffer_store_dword v25, v0, s[40:43], s57 offen offset:0
    s_mov_b64 exec, -1
L_fb_59:
L_skip_55:
    s_waitcnt vmcnt(36)
    s_barrier
    ds_read_b128 v[120:123], v8 offset:49152
    ds_read_b128 v[124:127], v9 offset:49152
    s_cmp_eq_u32 s30, 6
    s_cbranch_scc0 L_skip_60
    s_mul_i32 s57, s14, 6
    s_mov_b32 m0, 43008
    s_nop 0
    buffer_load_dwordx4 v3, s[48:51], s57 offen offset:0 nt lds
    s_mul_i32 s57, s14, 6
    s_add_u32 s57, s57, s15
    s_mov_b32 m0, 43008
    s_nop 0
    buffer_load_dwordx4 v3, s[48:51], s57 offen offset:1024 nt lds
    s_xor_b32 s57, s71, 6
    s_mul_i32 s57, s57, 196608
    s_add_u32 s57, s57, 1152
    s_xor_b32 s58, s71, 7
    s_mul_i32 s58, s58, 196608
    s_add_u32 s58, s58, 128
    s_mov_b32 m0, 124928
L_dma_61:
    s_waitcnt vmcnt(23)
    s_cmp_ge_u32 s70, 2
    s_cbranch_scc1 L_go_62
    s_waitcnt vmcnt(22)
    s_cmp_ge_u32 s70, 1
    s_cbranch_scc1 L_go_62
    s_waitcnt vmcnt(21)
L_go_62:
    buffer_load_dwordx4 v5, s[32:35], s57 offen offset:0 nt lds
    buffer_load_dwordx4 v6, s[32:35], s58 offen offset:1024 nt lds
    s_add_u32 s57, s57, 24576
    s_add_u32 s58, s58, 24576
    s_add_u32 m0, m0, 2048
    s_cmp_lg_u32 m0, 141312
    s_cbranch_scc1 L_dma_61
L_skip_60:
    s_waitcnt lgkmcnt(0)
    s_waitcnt vmcnt(36)
    s_barrier
    ds_read_b128 v[128:131], v8 offset:0
    ds_read_b128 v[132:135], v9 offset:0
    s_cmp_eq_u32 s30, 6
    s_cbranch_scc0 L_skip_63
    s_mul_i32 s57, s14, 7
    s_mov_b32 m0, 45056
    s_nop 0
    buffer_load_dwordx4 v3, s[48:51], s57 offen offset:0 nt lds
    s_mul_i32 s57, s14, 7
    s_add_u32 s57, s57, s15
    s_mov_b32 m0, 45056
    s_nop 0
    buffer_load_dwordx4 v3, s[48:51], s57 offen offset:1024 nt lds
    s_xor_b32 s57, s71, 6
    s_mul_i32 s57, s57, 196608
    s_add_u32 s57, s57, 1280
    s_xor_b32 s58, s71, 7
    s_mul_i32 s58, s58, 196608
    s_add_u32 s58, s58, 256
    s_mov_b32 m0, 141312
L_dma_64:
    s_waitcnt vmcnt(23)
    s_cmp_ge_u32 s70, 2
    s_cbranch_scc1 L_go_65
    s_waitcnt vmcnt(22)
    s_cmp_ge_u32 s70, 1
    s_cbranch_scc1 L_go_65
    s_waitcnt vmcnt(21)
L_go_65:
    buffer_load_dwordx4 v5, s[32:35], s57 offen offset:0 nt lds
    buffer_load_dwordx4 v6, s[32:35], s58 offen offset:1024 nt lds
    s_add_u32 s57, s57, 24576
    s_add_u32 s58, s58, 24576
    s_add_u32 m0, m0, 2048
    s_cmp_lg_u32 m0, 157696
    s_cbranch_scc1 L_dma_64
L_skip_63:
    s_waitcnt lgkmcnt(0)
    s_cmp_eq_u32 s30, 5
    s_cbranch_scc0 L_skip_66
    v_lshlrev_b32 v24, 2, v0
    buffer_load_dword v2, v24, s[40:43], s72 offen sc1
L_skip_66:
    s_waitcnt vmcnt(36)
    s_barrier
    ds_read_b128 v[136:139], v8 offset:16384
    ds_read_b128 v[140:143], v9 offset:16384
    s_cmp_eq_u32 s30, 6
    s_cbranch_scc0 L_skip_67
    s_mul_i32 s57, s14, 8
    s_mov_b32 m0, 47104
    s_nop 0
    buffer_load_dwordx4 v3, s[48:51], s57 offen offset:0 nt lds
    s_mul_i32 s57, s14, 8
    s_add_u32 s57, s57, s15
    s_mov_b32 m0, 47104
    s_nop 0
    buffer_load_dwordx4 v3, s[48:51], s57 offen offset:1024 nt lds
    s_xor_b32 s57, s71, 0
    s_mul_i32 s57, s57, 196608
    s_add_u32 s57, s57, 1024
    s_xor_b32 s58, s71, 2
    s_mul_i32 s58, s58, 196608
    s_add_u32 s58, s58, 0
    s_mov_b32 m0, 92160
L_dma_68:
    s_waitcnt vmcnt(23)
    s_cmp_ge_u32 s70, 2
    s_cbranch_scc1 L_go_69
    s_waitcnt vmcnt(22)
    s_cmp_ge_u32 s70, 1
    s_cbranch_scc1 L_go_69
    s_waitcnt vmcnt(21)
L_go_69:
    buffer_load_dwordx4 v7, s[36:39], s57 offen offset:0 nt lds
    buffer_load_dwordx4 v7, s[36:39], s58 offen offset:1024 nt lds
    s_add_u32 s57, s57, 24576
    s_add_u32 s58, s58, 24576
    s_add_u32 m0, m0, 2048
    s_cmp_lg_u32 m0, 108544
    s_cbranch_scc1 L_dma_68
L_skip_67:
    s_waitcnt lgkmcnt(0)
    s_waitcnt vmcnt(36)
    s_barrier
    ds_read_b128 v[144:147], v8 offset:32768
    ds_read_b128 v[148:151], v9 offset:32768
    s_cmp_eq_u32 s30, 6
    s_cbranch_scc0 L_skip_70
    s_mul_i32 s57, s14, 9
    s_mov_b32 m0, 49152
    s_nop 0
    buffer_load_dwordx4 v3, s[48:51], s57 offen offset:0 nt lds
    s_mul_i32 s57, s14, 9
    s_add_u32 s57, s57, s15
    s_mov_b32 m0, 49152
    s_nop 0
    buffer_load_dwordx4 v3, s[48:51], s57 offen offset:1024 nt lds
    s_xor_b32 s57, s71, 0
    s_mul_i32 s57, s57, 196608
    s_add_u32 s57, s57, 1152
    s_xor_b32 s58, s71, 2
    s_mul_i32 s58, s58, 196608
    s_add_u32 s58, s58, 128
    s_mov_b32 m0, 108544
L_dma_71:
    s_waitcnt vmcnt(23)
    s_cmp_ge_u32 s70, 2
    s_cbranch_scc1 L_go_72
    s_waitcnt vmcnt(22)
    s_cmp_ge_u32 s70, 1
    s_cbranch_scc1 L_go_72
    s_waitcnt vmcnt(21)
L_go_72:
    buffer_load_dwordx4 v7, s[36:39], s57 offen offset:0 nt lds
    buffer_load_dwordx4 v7, s[36:39], s58 offen offset:1024 nt lds
    s_add_u32 s57, s57, 24576
    s_add_u32 s58, s58, 24576
    s_add_u32 m0, m0, 2048
    s_cmp_lg_u32 m0, 124928
    s_cbranch_scc1 L_dma_71
L_skip_70:
    s_waitcnt lgkmcnt(0)
    s_cmp_eq_u32 s30, 5
    s_cbranch_scc0 L_skip_73
L_cw_74:
    s_waitcnt vmcnt(0)
    v_cmp_ne_u32 vcc, -1, v2
    s_mov_b32 s57, 0
    s_mov_b32 s68, 2
    s_cmp_eq_u32 s64, 0
    s_cbranch_scc1 L_cd_76
    s_cmp_lg_u32 vcc_hi, 0
    s_cbranch_scc1 L_cd_76
    s_cmp_lg_u32 vcc_lo, -1
    s_cbranch_scc1 L_cr_75
    v_cmp_eq_u32 vcc, 1, v2
    s_bcnt1_i32_b32 s68, vcc_lo
    s_mov_b32 s57, 1
L_cd_76:
    v_mov_b32 v37, 160768
    v_mov_b32 v38, s57
    ds_write_b32 v37, v38
    s_waitcnt lgkmcnt(0)
L_skip_73:
    s_waitcnt vmcnt(36)
    s_barrier
    ds_read_b128 v[152:155], v8 offset:49152
    ds_read_b128 v[156:159], v9 offset:49152
    s_cmp_eq_u32 s30, 6
    s_cbranch_scc0 L_skip_77
    s_mul_i32 s57, s14, 10
    s_mov_b32 m0, 51200
    s_nop 0
    buffer_load_dwordx4 v3, s[48:51], s57 offen offset:0 nt lds
    s_mul_i32 s57, s14, 10
    s_add_u32 s57, s57, s15
    s_mov_b32 m0, 51200
    s_nop 0
    buffer_load_dwordx4 v3, s[48:51], s57 offen offset:1024 nt lds
    s_xor_b32 s57, s71, 0
    s_mul_i32 s57, s57, 196608
    s_add_u32 s57, s57, 1280
    s_xor_b32 s58, s71, 2
    s_mul_i32 s58, s58, 196608
    s_add_u32 s58, s58, 256
    s_mov_b32 m0, 124928
L_dma_78:
    s_waitcnt vmcnt(23)
    s_cmp_ge_u32 s70, 2
    s_cbranch_scc1 L_go_79
    s_waitcnt vmcnt(22)
    s_cmp_ge_u32 s70, 1
    s_cbranch_scc1 L_go_79
    s_waitcnt vmcnt(21)
L_go_79:
    buffer_load_dwordx4 v7, s[36:39], s57 offen offset:0 nt lds
    buffer_load_dwordx4 v7, s[36:39], s58 offen offset:1024 nt lds
    s_add_u32 s57, s57, 24576
    s_add_u32 s58, s58, 24576
    s_add_u32 m0, m0, 2048
    s_cmp_lg_u32 m0, 141312
    s_cbranch_scc1 L_dma_78
L_skip_77:
    s_waitcnt lgkmcnt(0)
    v_lshrrev_b32 v8, 2, v0
    v_lshlrev_b32 v8, 7, v8
    v_bfe_u32 v60, v0, 3, 2
    v_lshl_add_u32 v8, v60, 5, v8
    v_and_b32 v60, 3, v0
    v_lshl_add_u32 v8, v60, 3, v8
    v_add_u32 v8, s61, v8
    v_xor_b32 v9, 32, v8
    v_xor_b32 v10, 64, v8
    v_xor_b32 v11, 96, v8
    v_mov_b32 v41, 160768
    ds_read_b32 v42, v41
    s_waitcnt lgkmcnt(0)
    v_readfirstlane_b32 s55, v42
    s_cmp_eq_u32 s55, 0
    s_cbranch_scc1 L_spread
L_spread_back:
    s_cmp_eq_u32 s30, 5
    s_cbranch_scc0 L_skip_91
    s_cmp_eq_u32 s52, 31
    s_cbranch_scc0 L_skip_92
    s_lshl_b32 s57, s31, 5
    v_mov_b32 v16, s57
    s_add_u32 s57, s68, 1
    v_mov_b32 v12, s57
    s_mov_b64 exec, 0x1
    global_store_dword v16, v12, s[26:27] offset:4 sc1
    s_mov_b64 exec, -1
L_skip_92:
L_skip_91:
    s_sub_u32 s58, s30, 1
    s_cmp_lt_u32 s58, 4
    s_cbranch_scc0 L_skip_93
    s_mul_i32 s59, s53, 6400
    s_add_u32 s59, s59, s62
    s_add_u32 s59, s59, 58880
    s_add_u32 s60, s59, 6144
    s_lshl_b32 s57, s58, 10
    v_lshlrev_b32 v16, 4, v0
    v_add_u32 v16, s57, v16
    v_and_b32 v17, 7, v0
    v_lshlrev_b32 v17, 3, v17
    s_cmp_eq_u32 s30, 4
    s_cbranch_scc0 L_skip_94
    buffer_load_dwordx2 v[12:13], v17, s[40:43], s60 offen sc1 nt
    s_branch L_skip_93
L_skip_94:
    buffer_load_dwordx4 v[12:15], v16, s[40:43], s59 offen sc1 nt
    buffer_load_dwordx4 v[20:23], v16, s[40:43], s59 offen offset:3072 sc1 nt
L_skip_93:
    s_waitcnt vmcnt(36)
    s_barrier
    ds_read_b64_tr_b16 v[160:161], v8 offset:0
    ds_read_b64_tr_b16 v[168:169], v9 offset:0
    ds_read_b64_tr_b16 v[176:177], v10 offset:0
    ds_read_b64_tr_b16 v[184:185], v11 offset:0
    s_cmp_eq_u32 s30, 6
    s_cbranch_scc0 L_skip_95
    s_mul_i32 s57, s14, 11
    s_mov_b32 m0, 53248
    s_nop 0
    buffer_load_dwordx4 v3, s[48:51], s57 offen offset:0 nt lds
    s_mul_i32 s57, s14, 11
    s_add_u32 s57, s57, s15
    s_mov_b32 m0, 53248
    s_nop 0
    buffer_load_dwordx4 v3, s[48:51], s57 offen offset:1024 nt lds
    s_xor_b32 s57, s71, 1
    s_mul_i32 s57, s57, 196608
    s_add_u32 s57, s57, 1024
    s_xor_b32 s58, s71, 3
    s_mul_i32 s58, s58, 196608
    s_add_u32 s58, s58, 0
    s_mov_b32 m0, 141312
L_dma_96:
    s_waitcnt vmcnt(23)
    s_cmp_ge_u32 s70, 2
    s_cbranch_scc1 L_go_97
    s_waitcnt vmcnt(22)
    s_cmp_ge_u32 s70, 1
    s_cbranch_scc1 L_go_97
    s_waitcnt vmcnt(21)
L_go_97:
    buffer_load_dwordx4 v7, s[36:39], s57 offen offset:0 nt lds
    buffer_load_dwordx4 v7, s[36:39], s58 offen offset:1024 nt lds
    s_add_u32 s57, s57, 24576
    s_add_u32 s58, s58, 24576
    s_add_u32 m0, m0, 2048
    s_cmp_lg_u32 m0, 157696
    s_cbranch_scc1 L_dma_96
L_skip_95:
    s_waitcnt lgkmcnt(0)
    s_waitcnt vmcnt(36)
    s_barrier
    ds_read_b64_tr_b16 v[192:193], v8 offset:16384
    ds_read_b64_tr_b16 v[200:201], v9 offset:16384
    ds_read_b64_tr_b16 v[208:209], v10 offset:16384
    ds_read_b64_tr_b16 v[216:217], v11 offset:16384
    s_cmp_eq_u32 s30, 6
    s_cbranch_scc0 L_skip_98
    s_mul_i32 s57, s14, 12
    s_mov_b32 m0, 55296
    s_nop 0
    buffer_load_dwordx4 v3, s[48:51], s57 offen offset:0 nt lds
    s_mul_i32 s57, s14, 12
    s_add_u32 s57, s57, s15
    s_mov_b32 m0, 55296
    s_nop 0
    buffer_load_dwordx4 v3, s[48:51], s57 offen offset:1024 nt lds
    s_xor_b32 s57, s71, 1
    s_mul_i32 s57, s57, 196608
    s_add_u32 s57, s57, 1152
    s_xor_b32 s58, s71, 3
    s_mul_i32 s58, s58, 196608
    s_add_u32 s58, s58, 128
    s_mov_b32 m0, 92160
L_dma_99:
    s_waitcnt vmcnt(23)
    s_cmp_ge_u32 s70, 2
    s_cbranch_scc1 L_go_100
    s_waitcnt vmcnt(22)
    s_cmp_ge_u32 s70, 1
    s_cbranch_scc1 L_go_100
    s_waitcnt vmcnt(21)
L_go_100:
    buffer_load_dwordx4 v7, s[36:39], s57 offen offset:0 nt lds
    buffer_load_dwordx4 v7, s[36:39], s58 offen offset:1024 nt lds
    s_add_u32 s57, s57, 24576
    s_add_u32 s58, s58, 24576
    s_add_u32 m0, m0, 2048
    s_cmp_lg_u32 m0, 108544
    s_cbranch_scc1 L_dma_99
L_skip_98:
    s_waitcnt lgkmcnt(0)
    s_sub_u32 s58, s30, 1
    s_cmp_lt_u32 s58, 4
    s_cbranch_scc0 L_skip_101
    s_waitcnt vmcnt(0)
    s_cmp_eq_u32 s30, 4
    s_cbranch_scc0 L_skip_102
    v_add_f32_dpp v12, v12, v12 row_ror:4 row_mask:0xf bank_mask:0xf
    v_add_f32_dpp v13, v13, v13 row_ror:4 row_mask:0xf bank_mask:0xf
    s_nop 0
    v_add_f32_dpp v12, v12, v12 row_ror:2 row_mask:0xf bank_mask:0xf
    v_add_f32_dpp v13, v13, v13 row_ror:2 row_mask:0xf bank_mask:0xf
    s_nop 0
    v_add_f32_dpp v12, v12, v12 row_ror:1 row_mask:0xf bank_mask:0xf
    v_add_f32_dpp v13, v13, v13 row_ror:1 row_mask:0xf bank_mask:0xf
    v_mul_f32 v12, 0x3acccccd, v12
    v_mul_f32 v13, 0x3acccccd, v13
    v_fma_f32 v13, -v12, v12, v13
    v_max_f32 v13, 0, v13
    v_add_f32 v13, 0x3727c5ac, v13
    v_rsq_f32 v13, v13
    s_nop 0
    v_mul_f32 v13, 0x3dd53b95, v13
    v_mul_f32 v12, -v12, v13
    v_mov_b32 v16, 160784
    ds_write_b64 v16, v[12:13]
    s_waitcnt lgkmcnt(0)
    s_branch L_skip_101
L_skip_102:
    s_lshl_b32 s57, s58, 7
    v_lshrrev_b32 v16, 4, v0
    v_lshlrev_b32 v16, 5, v16
    v_bfe_u32 v60, v0, 1, 1
    v_lshl_add_u32 v16, v60, 4, v16
    v_bfe_u32 v60, v0, 2, 2
    v_lshl_add_u32 v16, v60, 2, v16
    v_and_b32 v60, 1, v0
    v_lshl_add_u32 v16, v60, 1, v16
    v_add_u32 v16, s57, v16
    v_add_u32 v16, 157952, v16
    v_mov_b32 v17, 0x3f803f80
    v_dot2_f32_bf16 v24, v12, v17, 0
    v_dot2_f32_bf16 v25, v13, v17, 0
    v_dot2_f32_bf16 v24, v14, v17, v24
    v_dot2_f32_bf16 v25, v15, v17, v25
    s_nop 2
    v_add_f32 v24, v24, v25
    v_cvt_pk_bf16_f32 v24, v24, v24
    ds_write_b16 v16, v24 offset:0
    v_dot2_f32_bf16 v24, v20, v17, 0
    v_dot2_f32_bf16 v25, v21, v17, 0
    v_dot2_f32_bf16 v24, v22, v17, v24
    v_dot2_f32_bf16 v25, v23, v17, v25
    s_nop 2
    v_add_f32 v24, v24, v25
    v_cvt_pk_bf16_f32 v24, v24, v24
    ds_write_b16 v16, v24 offset:384
    s_waitcnt lgkmcnt(0)
L_skip_101:
    s_waitcnt vmcnt(36)
    s_barrier
    ds_read_b64_tr_b16 v[224:225], v8 offset:32768
    ds_read_b64_tr_b16 v[232:233], v9 offset:32768
    ds_read_b64_tr_b16 v[240:241], v10 offset:32768
    ds_read_b64_tr_b16 v[248:249], v11 offset:32768
    s_cmp_eq_u32 s30, 6
    s_cbranch_scc0 L_skip_103
    s_mul_i32 s57, s14, 13
    s_mov_b32 m0, 57344
    s_nop 0
    buffer_load_dwordx4 v3, s[48:51], s57 offen offset:0 nt lds
    s_mul_i32 s57, s14, 13
    s_add_u32 s57, s57, s15
    s_mov_b32 m0, 57344
    s_nop 0
    buffer_load_dwordx4 v3, s[48:51], s57 offen offset:1024 nt lds
    s_xor_b32 s57, s71, 1
    s_mul_i32 s57, s57, 196608
    s_add_u32 s57, s57, 1280
    s_xor_b32 s58, s71, 3
    s_mul_i32 s58, s58, 196608
    s_add_u32 s58, s58, 256
    s_mov_b32 m0, 108544
L_dma_104:
    s_nop 0
    buffer_load_dwordx4 v7, s[36:39], s57 offen offset:0 nt lds
    buffer_load_dwordx4 v7, s[36:39], s58 offen offset:1024 nt lds
    s_add_u32 s57, s57, 24576
    s_add_u32 s58, s58, 24576
    s_add_u32 m0, m0, 2048
    s_cmp_lg_u32 m0, 124928
    s_cbranch_scc1 L_dma_104
L_skip_103:
    s_waitcnt lgkmcnt(0)
    v_lshrrev_b32 v5, 4, v0
    v_lshlrev_b32 v5, 5, v5
    v_bfe_u32 v60, v0, 1, 1
    v_lshl_add_u32 v5, v60, 4, v5
    v_add_u32 v5, 157952, v5
    ds_read_b128 v[12:15], v5 offset:384
    ds_read_b128 v[16:19], v5 offset:512
    ds_read_b128 v[20:23], v5 offset:640
    s_lshl_b32 s57, s30, 7
    s_add_u32 s57, s57, 158720
    v_lshrrev_b32 v58, 4, v0
    v_lshlrev_b32 v58, 5, v58
    v_bfe_u32 v60, v0, 1, 1
    v_lshl_add_u32 v58, v60, 4, v58
    v_bfe_u32 v60, v0, 2, 2
    v_lshl_add_u32 v58, v60, 2, v58
    v_and_b32 v60, 1, v0
    v_lshl_add_u32 v58, v60, 1, v58
    v_add_u32 v58, s57, v58
    v_lshrrev_b32 v61, 4, v0
    v_lshlrev_b32 v61, 5, v61
    v_bfe_u32 v60, v0, 1, 1
    v_lshl_add_u32 v61, v60, 4, v61
    v_add_u32 v61, s57, v61
    v_bfe_u32 v62, v0, 2, 2
    v_lshlrev_b32 v62, 1, v62
    v_and_b32 v60, 1, v0
    v_lshl_add_u32 v62, v60, 0, v62
    v_mov_b32 v60, 160992
    v_cmp_eq_u32 vcc, 0, v62
    s_nop 1
    v_cndmask_b32 v52, v60, v61, vcc
    v_cmp_eq_u32 vcc, 1, v62
    s_nop 1
    v_cndmask_b32 v53, v60, v61, vcc
    v_cmp_eq_u32 vcc, 2, v62
    s_nop 1
    v_cndmask_b32 v54, v60, v61, vcc
    v_cmp_eq_u32 vcc, 3, v62
    s_nop 1
    v_cndmask_b32 v55, v60, v61, vcc
    v_cmp_eq_u32 vcc, 4, v62
    s_nop 1
    v_cndmask_b32 v56, v60, v61, vcc
    v_cmp_eq_u32 vcc, 5, v62
    s_nop 1
    v_cndmask_b32 v57, v60, v61, vcc
    s_lshl_b32 s58, s30, 2
    s_add_u32 s58, s58, 159744
    v_mov_b32 v60, s58
    v_lshlrev_b32 v59, 2, v0
    v_add_u32 v59, 157696, v59
    v_cmp_eq_u32 vcc, 63, v0
    s_nop 1
    v_cndmask_b32 v59, v59, v60, vcc
    v_and_b32 v62, 7, v0
    v_lshlrev_b32 v62, 2, v62
    v_add_u32 v62, 159744, v62
    s_lshl_b32 s57, s30, 11
    v_lshlrev_b32 v63, 4, v0
    v_add_u32 v63, s57, v63
    v_add_u32 v63, 92160, v63
    v_mov_b64 v[24:25], 0
    v_mov_b64 v[26:27], 0
    v_mov_b64 v[28:29], 0
    v_mov_b64 v[30:31], 0
    v_mov_b64 v[32:33], 0
    v_mov_b64 v[34:35], 0
    v_mov_b64 v[36:37], 0
    v_mov_b64 v[38:39], 0
    v_mov_b64 v[40:41], 0
    v_mov_b64 v[42:43], 0
    v_mov_b64 v[44:45], 0
    v_mov_b64 v[46:47], 0
    s_waitcnt lgkmcnt(0)
    v_smfmac_f32_16x16x64_bf16 v[24:27], v[12:15], v[64:71], v1
    v_smfmac_f32_16x16x64_bf16 v[24:27], v[16:19], v[72:79], v1
    v_smfmac_f32_16x16x64_bf16 v[24:27], v[20:23], v[80:87], v1
    v_smfmac_f32_16x16x64_bf16 v[28:31], v[12:15], v[88:95], v1
    v_smfmac_f32_16x16x64_bf16 v[28:31], v[16:19], v[96:103], v1
    v_smfmac_f32_16x16x64_bf16 v[28:31], v[20:23], v[104:111], v1
    v_smfmac_f32_16x16x64_bf16 v[32:35], v[12:15], v[112:119], v1
    v_smfmac_f32_16x16x64_bf16 v[32:35], v[16:19], v[120:127], v1
    v_smfmac_f32_16x16x64_bf16 v[32:35], v[20:23], v[128:135], v1
    v_smfmac_f32_16x16x64_bf16 v[36:39], v[12:15], v[136:143], v1
    v_smfmac_f32_16x16x64_bf16 v[36:39], v[16:19], v[144:151], v1
    v_smfmac_f32_16x16x64_bf16 v[36:39], v[20:23], v[152:159], v1
    v_add_f32_dpp v6, v24, v26 quad_perm:[0,1,2,3] row_mask:0x1 bank_mask:0xf
    s_nop 1
    v_add_f32_dpp v6, v28, v30 quad_perm:[0,1,2,3] row_mask:0x2 bank_mask:0xf
    s_nop 1
    v_add_f32_dpp v6, v32, v34 quad_perm:[0,1,2,3] row_mask:0x4 bank_mask:0xf
    s_nop 1
    v_add_f32_dpp v6, v36, v38 quad_perm:[0,1,2,3] row_mask:0x8 bank_mask:0xf
    s_waitcnt vmcnt(36)
    s_barrier
    ds_read_b64_tr_b16 v[162:163], v8 offset:49152
    ds_read_b64_tr_b16 v[170:171], v9 offset:49152
    ds_read_b64_tr_b16 v[178:179], v10 offset:49152
    ds_read_b64_tr_b16 v[186:187], v11 offset:49152
    s_cmp_eq_u32 s30, 6
    s_cbranch_scc0 L_skip_105
    s_mul_i32 s57, s14, 14
    s_mov_b32 m0, 59392
    s_nop 0
    buffer_load_dwordx4 v3, s[48:51], s57 offen offset:0 nt lds
    s_mul_i32 s57, s14, 14
    s_add_u32 s57, s57, s15
    s_mov_b32 m0, 59392
    s_nop 0
    buffer_load_dwordx4 v3, s[48:51], s57 offen offset:1024 nt lds
    s_xor_b32 s57, s71, 4
    s_mul_i32 s57, s57, 196608
    s_add_u32 s57, s57, 1024
    s_xor_b32 s58, s71, 6
    s_mul_i32 s58, s58, 196608
    s_add_u32 s58, s58, 0
    s_mov_b32 m0, 124928
L_dma_106:
    s_nop 0
    buffer_load_dwordx4 v7, s[36:39], s57 offen offset:0 nt lds
    buffer_load_dwordx4 v7, s[36:39], s58 offen offset:1024 nt lds
    s_add_u32 s57, s57, 24576
    s_add_u32 s58, s58, 24576
    s_add_u32 m0, m0, 2048
    s_cmp_lg_u32 m0, 141312
    s_cbranch_scc1 L_dma_106
L_skip_105:
    s_waitcnt lgkmcnt(0)
    v_mov_b32 v48, 160784
    ds_read_b128 v[12:15], v5 offset:0
    ds_read_b128 v[16:19], v5 offset:128
    ds_read_b128 v[20:23], v5 offset:256
    ds_read_b64 v[48:49], v48
    v_mov_b64 v[24:25], 0
    v_mov_b64 v[26:27], 0
    v_mov_b64 v[28:29], 0
    v_mov_b64 v[30:31], 0
    v_mov_b64 v[32:33], 0
    v_mov_b64 v[34:35], 0
    v_mov_b64 v[36:37], 0
    v_mov_b64 v[38:39], 0
    s_waitcnt lgkmcnt(0)
    v_smfmac_f32_16x16x64_bf16 v[24:27], v[12:15], v[64:71], v1
    v_smfmac_f32_16x16x64_bf16 v[24:27], v[16:19], v[72:79], v1
    v_smfmac_f32_16x16x64_bf16 v[24:27], v[20:23], v[80:87], v1
    v_smfmac_f32_16x16x64_bf16 v[28:31], v[12:15], v[88:95], v1
    v_smfmac_f32_16x16x64_bf16 v[28:31], v[16:19], v[96:103], v1
    v_smfmac_f32_16x16x64_bf16 v[28:31], v[20:23], v[104:111], v1
    v_smfmac_f32_16x16x64_bf16 v[32:35], v[12:15], v[112:119], v1
    v_smfmac_f32_16x16x64_bf16 v[32:35], v[16:19], v[120:127], v1
    v_smfmac_f32_16x16x64_bf16 v[32:35], v[20:23], v[128:135], v1
    v_smfmac_f32_16x16x64_bf16 v[36:39], v[12:15], v[136:143], v1
    v_smfmac_f32_16x16x64_bf16 v[36:39], v[16:19], v[144:151], v1
    v_smfmac_f32_16x16x64_bf16 v[36:39], v[20:23], v[152:159], v1
    v_add_f32_dpp v61, v24, v26 quad_perm:[0,1,2,3] row_mask:0x1 bank_mask:0xf
    v_mul_f32 v48, v48, v6
    s_nop 0
    v_add_f32_dpp v61, v28, v30 quad_perm:[0,1,2,3] row_mask:0x2 bank_mask:0xf
    s_nop 1
    v_add_f32_dpp v61, v32, v34 quad_perm:[0,1,2,3] row_mask:0x4 bank_mask:0xf
    s_nop 1
    v_add_f32_dpp v61, v36, v38 quad_perm:[0,1,2,3] row_mask:0x8 bank_mask:0xf
    v_fma_f32 v36, v61, v49, v48
    s_nop 1
    v_max_f32_dpp v37, v36, v36 row_ror:8 row_mask:0xf bank_mask:0xf
    s_nop 1
    v_max_f32_dpp v37, v37, v37 row_ror:4 row_mask:0xf bank_mask:0xf
    s_nop 1
    v_max_f32_dpp v37, v37, v37 row_ror:2 row_mask:0xf bank_mask:0xf
    s_nop 1
    v_max_f32_dpp v37, v37, v37 row_ror:1 row_mask:0xf bank_mask:0xf
    s_nop 1
    v_max_f32_dpp v37, v37, v37 row_bcast:15 row_mask:0xa bank_mask:0xf
    s_nop 1
    v_max_f32_dpp v37, v37, v37 row_bcast:31 row_mask:0xc bank_mask:0xf
    s_nop 0
    v_readlane_b32 s64, v37, 63
    ds_write_b32 v59, v37
    s_nop 0
    v_subrev_f32 v36, s64, v36
    v_exp_f32 v36, v36
    s_nop 0
    v_cvt_pk_bf16_f32 v39, v36, v36
    ds_write_b16 v58, v39
    ds_read_b128 v[12:15], v52
    ds_read_b128 v[16:19], v53
    ds_read_b128 v[20:23], v54
    ds_read_b128 v[24:27], v55
    ds_read_b128 v[28:31], v56
    ds_read_b128 v[32:35], v57
    v_add_f32_dpp v38, v36, v36 row_ror:8 row_mask:0xf bank_mask:0xf
    s_nop 1
    v_add_f32_dpp v38, v38, v38 row_ror:4 row_mask:0xf bank_mask:0xf
    s_nop 1
    v_add_f32_dpp v38, v38, v38 row_ror:2 row_mask:0xf bank_mask:0xf
    s_nop 1
    v_add_f32_dpp v38, v38, v38 row_ror:1 row_mask:0xf bank_mask:0xf
    s_nop 1
    v_add_f32_dpp v38, v38, v38 row_bcast:15 row_mask:0xa bank_mask:0xf
    s_nop 1
    v_add_f32_dpp v38, v38, v38 row_bcast:31 row_mask:0xc bank_mask:0xf
    s_waitcnt lgkmcnt(0)
    s_waitcnt vmcnt(36)
    s_barrier
    ds_read_b64_tr_b16 v[194:195], v8 offset:0
    ds_read_b64_tr_b16 v[202:203], v9 offset:0
    ds_read_b64_tr_b16 v[210:211], v10 offset:0
    ds_read_b64_tr_b16 v[218:219], v11 offset:0
    s_cmp_eq_u32 s30, 6
    s_cbranch_scc0 L_skip_107
    s_mul_i32 s57, s14, 15
    s_mov_b32 m0, 61440
    s_nop 0
    buffer_load_dwordx4 v3, s[48:51], s57 offen offset:0 nt lds
    s_mul_i32 s57, s14, 15
    s_add_u32 s57, s57, s15
    s_mov_b32 m0, 61440
    s_nop 0
    buffer_load_dwordx4 v3, s[48:51], s57 offen offset:1024 nt lds
    s_xor_b32 s57, s71, 4
    s_mul_i32 s57, s57, 196608
    s_add_u32 s57, s57, 1152
    s_xor_b32 s58, s71, 6
    s_mul_i32 s58, s58, 196608
    s_add_u32 s58, s58, 128
    s_mov_b32 m0, 141312
L_dma_108:
    s_waitcnt vmcnt(23)
    s_cmp_ge_u32 s70, 2
    s_cbranch_scc1 L_go_109
    s_waitcnt vmcnt(22)
    s_cmp_ge_u32 s70, 1
    s_cbranch_scc1 L_go_109
    s_waitcnt vmcnt(21)
L_go_109:
    buffer_load_dwordx4 v7, s[36:39], s57 offen offset:0 nt lds
    buffer_load_dwordx4 v7, s[36:39], s58 offen offset:1024 nt lds
    s_add_u32 s57, s57, 24576
    s_add_u32 s58, s58, 24576
    s_add_u32 m0, m0, 2048
    s_cmp_lg_u32 m0, 157696
    s_cbranch_scc1 L_dma_108
L_skip_107:
    s_waitcnt lgkmcnt(0)
    ds_read_b32 v36, v62
    s_waitcnt lgkmcnt(0)
    v_max_f32_dpp v37, v36, v36 row_ror:4 row_mask:0xf bank_mask:0xf
    s_nop 1
    v_max_f32_dpp v37, v37, v37 row_ror:2 row_mask:0xf bank_mask:0xf
    s_nop 1
    v_max_f32_dpp v37, v37, v37 row_ror:1 row_mask:0xf bank_mask:0xf
    v_sub_f32 v39, s64, v37
    v_exp_f32 v39, v39
    s_cmp_lt_u32 s30, 2
    s_cbranch_scc0 L_skip_110
    s_lshl_b32 s57, s30, 3
    v_lshlrev_b32 v2, 4, v0
    v_add_u32 v2, s57, v2
    v_add_u32 v2, 92160, v2
    v_mov_b32 v60, 94192
    v_cmp_le_u32 vcc, 48, v0
    s_nop 1
    v_cndmask_b32 v2, v2, v60, vcc
    s_lshr_b32 s57, s54, 1
    s_lshl_b32 s57, s57, 2
    s_and_b32 s58, s54, 1
    s_add_u32 s57, s57, s58
    s_lshl_b32 s58, s57, 4
    s_lshl_b32 s57, s57, 3
    v_bfe_u32 v3, v0, 3, 2
    v_lshlrev_b32 v3, 8, v3
    v_bfe_u32 v61, v0, 2, 1
    v_lshl_add_u32 v3, v61, 5, v3
    v_and_b32 v61, 3, v0
    v_lshl_add_u32 v3, v61, 2, v3
    v_add_u32 v3, s58, v3
    v_bfe_u32 v60, v0, 3, 1
    v_lshlrev_b32 v60, 8, v60
    v_bfe_u32 v61, v0, 1, 1
    v_lshl_add_u32 v60, v61, 7, v60
    v_bfe_u32 v61, v0, 2, 1
    v_lshl_add_u32 v60, v61, 4, v60
    v_and_b32 v61, 1, v0
    v_lshl_add_u32 v60, v61, 2, v60
    v_add_u32 v60, s57, v60
    v_add_u32 v60, 1024, v60
    v_cmp_gt_u32 vcc, 32, v0
    s_nop 1
    v_cndmask_b32 v3, v60, v3, vcc
    s_lshl_b32 s57, s53, 1
    s_add_u32 s57, s57, s30
    s_mul_i32 s57, s57, 1664
    s_add_u32 s57, s57, s62
    v_add_u32 v3, s57, v3
    v_mov_b32 v60, 0x7f000000
    v_cmp_le_u32 vcc, 48, v0
    s_nop 1
    v_cndmask_b32 v3, v3, v60, vcc
    s_lshl_b32 s58, s54, 2
    s_add_u32 s57, s57, s58
    s_add_u32 s57, s57, 1536
    v_mov_b32 v4, s57
    v_mov_b32 v60, 0x7f000000
    v_cmp_ne_u32 vcc, 48, v0
    s_nop 1
    v_cndmask_b32 v4, v4, v60, vcc
    s_mov_b32 s58, 0
    v_min_u32 v37, -2, v37
    s_cmp_eq_u32 s55, 0
    s_cbranch_scc1 L_gs_111
    buffer_store_dword v37, v4, s[40:43], s58 offen
L_gb_112:
L_skip_110:
    s_cmp_eq_u32 s30, 2
    s_cbranch_scc0 L_skip_113
    v_lshlrev_b32 v2, 2, v0
    v_add_u32 v2, 157696, v2
    v_and_b32 v3, 15, v0
    v_lshlrev_b32 v3, 2, v3
    v_lshrrev_b32 v60, 5, v0
    v_lshl_add_u32 v3, v60, 6, v3
    v_bfe_u32 v60, v0, 4, 1
    v_lshl_add_u32 v3, v60, 13, v3
L_skip_113:
    s_waitcnt vmcnt(36)
    s_barrier
    ds_read_b64_tr_b16 v[226:227], v8 offset:16384
    ds_read_b64_tr_b16 v[234:235], v9 offset:16384
    ds_read_b64_tr_b16 v[242:243], v10 offset:16384
    ds_read_b64_tr_b16 v[250:251], v11 offset:16384
    s_cmp_eq_u32 s30, 6
    s_cbranch_scc0 L_skip_114
    s_xor_b32 s57, s71, 4
    s_mul_i32 s57, s57, 196608
    s_add_u32 s57, s57, 1280
    s_xor_b32 s58, s71, 6
    s_mul_i32 s58, s58, 196608
    s_add_u32 s58, s58, 256
    s_mov_b32 m0, 92160
L_dma_115:
    s_nop 0
    buffer_load_dwordx4 v7, s[36:39], s57 offen offset:0 nt lds
    buffer_load_dwordx4 v7, s[36:39], s58 offen offset:1024 nt lds
    s_add_u32 s57, s57, 24576
    s_add_u32 s58, s58, 24576
    s_add_u32 m0, m0, 2048
    s_cmp_lg_u32 m0, 108544
    s_cbranch_scc1 L_dma_115
L_skip_114:
    s_waitcnt lgkmcnt(0)
    s_cmp_eq_u32 s30, 5
    s_cbranch_scc0 L_skip_116
    global_load_dword v2, v3, s[26:27] offset:4 sc1
L_skip_116:
    s_waitcnt vmcnt(34)
    s_barrier
    ds_read_b64_tr_b16 v[164:165], v8 offset:32768
    ds_read_b64_tr_b16 v[172:173], v9 offset:32768
    ds_read_b64_tr_b16 v[180:181], v10 offset:32768
    ds_read_b64_tr_b16 v[188:189], v11 offset:32768
    s_cmp_eq_u32 s30, 6
    s_cbranch_scc0 L_skip_117
    s_xor_b32 s57, s71, 5
    s_mul_i32 s57, s57, 196608
    s_add_u32 s57, s57, 1024
    s_xor_b32 s58, s71, 7
    s_mul_i32 s58, s58, 196608
    s_add_u32 s58, s58, 0
    s_mov_b32 m0, 108544
L_dma_118:
    s_nop 0
    buffer_load_dwordx4 v7, s[36:39], s57 offen offset:0 nt lds
    buffer_load_dwordx4 v7, s[36:39], s58 offen offset:1024 nt lds
    s_add_u32 s57, s57, 24576
    s_add_u32 s58, s58, 24576
    s_add_u32 m0, m0, 2048
    s_cmp_lg_u32 m0, 124928
    s_cbranch_scc1 L_dma_118
L_skip_117:
    s_waitcnt lgkmcnt(0)
    s_waitcnt vmcnt(32)
    s_barrier
    ds_read_b64_tr_b16 v[196:197], v8 offset:49152
    ds_read_b64_tr_b16 v[204:205], v9 offset:49152
    ds_read_b64_tr_b16 v[212:213], v10 offset:49152
    ds_read_b64_tr_b16 v[220:221], v11 offset:49152
    s_cmp_eq_u32 s30, 6
    s_cbranch_scc0 L_skip_119
    s_xor_b32 s57, s71, 5
    s_mul_i32 s57, s57, 196608
    s_add_u32 s57, s57, 1152
    s_xor_b32 s58, s71, 7
    s_mul_i32 s58, s58, 196608
    s_add_u32 s58, s58, 128
    s_mov_b32 m0, 124928
L_dma_120:
    s_nop 0
    buffer_load_dwordx4 v7, s[36:39], s57 offen offset:0 nt lds
    buffer_load_dwordx4 v7, s[36:39], s58 offen offset:1024 nt lds
    s_add_u32 s57, s57, 24576
    s_add_u32 s58, s58, 24576
    s_add_u32 m0, m0, 2048
    s_cmp_lg_u32 m0, 141312
    s_cbranch_scc1 L_dma_120
L_skip_119:
    s_waitcnt lgkmcnt(0)
    s_cmp_eq_u32 s30, 5
    s_cbranch_scc0 L_skip_121
L_cw_122:
    s_waitcnt vmcnt(0)
    v_cmp_eq_u32 vcc, 0, v2
    s_cbranch_vccnz L_cr_123
    v_add_u32_dpp v2, v2, v2 row_ror:4 row_mask:0xf bank_mask:0xf
    s_nop 1
    v_add_u32_dpp v2, v2, v2 row_ror:2 row_mask:0xf bank_mask:0xf
    s_nop 1
    v_add_u32_dpp v2, v2, v2 row_ror:1 row_mask:0xf bank_mask:0xf
    v_mov_b32 v60, 160772
    ds_write_b32 v60, v2
    s_waitcnt lgkmcnt(0)
L_skip_121:
    s_cmp_lt_u32 s3, 20
    s_cbranch_scc0 L_skip_124
    s_mul_i32 s74, s30, 1664
    s_add_u32 s74, s74, s62
    s_add_u32 s74, s74, 0
    v_and_b32 v56, 7, v0
    v_lshlrev_b32 v56, 2, v56
    v_lshrrev_b32 v62, 4, v0
    v_lshlrev_b32 v62, 3, v62
    s_cmp_lg_u32 s30, 6
    s_cbranch_scc0 L_skip_124
    buffer_load_dword v52, v56, s[40:43], s74 offen offset:1536 sc1
    buffer_load_dwordx2 v[54:55], v62, s[40:43], s74 offen offset:1536 sc1
L_skip_124:
    s_cmp_eq_u32 s30, 2
    s_cbranch_scc0 L_skip_125
    s_sub_u32 s57, s3, 20
    s_cmp_lt_u32 s57, 4
    s_cbranch_scc0 L_skip_126
    s_sub_u32 s57, s3, 20
    s_lshl_b32 s57, s57, 6
    v_add_u32 v50, s57, v0
    v_min_u32 v50, 210, v50
    v_lshlrev_b32 v50, 7, v50
    s_add_u32 s57, s62, 0
    buffer_load_dword v50, v50, s[40:43], s57 offen sc1 nt
    s_sub_u32 s57, s3, 20
    s_lshl_b32 s57, s57, 6
    v_add_u32 v51, s57, v0
    v_min_u32 v51, 247, v51
    v_lshlrev_b32 v51, 7, v51
    s_add_u32 s57, s62, 27008
    buffer_load_dword v51, v51, s[40:43], s57 offen sc1 nt
L_skip_126:
L_skip_125:
    s_waitcnt vmcnt(32)
    s_barrier
    ds_read_b64_tr_b16 v[228:229], v8 offset:0
    ds_read_b64_tr_b16 v[236:237], v9 offset:0
    ds_read_b64_tr_b16 v[244:245], v10 offset:0
    ds_read_b64_tr_b16 v[252:253], v11 offset:0
    s_cmp_eq_u32 s30, 6
    s_cbranch_scc0 L_skip_127
    s_xor_b32 s57, s71, 5
    s_mul_i32 s57, s57, 196608
    s_add_u32 s57, s57, 1280
    s_xor_b32 s58, s71, 7
    s_mul_i32 s58, s58, 196608
    s_add_u32 s58, s58, 256
    s_mov_b32 m0, 141312
L_dma_128:
    s_nop 0
    buffer_load_dwordx4 v7, s[36:39], s57 offen offset:0 nt lds
    buffer_load_dwordx4 v7, s[36:39], s58 offen offset:1024 nt lds
    s_add_u32 s57, s57, 24576
    s_add_u32 s58, s58, 24576
    s_add_u32 m0, m0, 2048
    s_cmp_lg_u32 m0, 157696
    s_cbranch_scc1 L_dma_128
L_skip_127:
    s_waitcnt lgkmcnt(0)
    s_cmp_eq_u32 s30, 7
    s_cbranch_scc0 L_skip_129
    v_mov_b32 v60, 160772
    ds_read_b32 v60, v60
    s_lshr_b32 s58, s63, 2
    s_waitcnt lgkmcnt(0)
    v_readfirstlane_b32 s57, v60
    s_cmp_gt_u32 s57, 24
    s_cselect_b32 s57, 1, 0
    s_xor_b32 s57, s57, s58
    s_lshl_b32 s57, s57, 13
    s_add_u32 s7, s8, s57
L_skip_129:
    s_branch L_tail
.p2align 10
L_tail:
L_pad0:
    s_cbranch_execz L_pad4
    s_waitcnt vmcnt(32)
    s_barrier
    ds_read_b64_tr_b16 v[166:167], v8 offset:16384
    ds_read_b64_tr_b16 v[174:175], v9 offset:16384
    ds_read_b64_tr_b16 v[182:183], v10 offset:16384
    ds_read_b64_tr_b16 v[190:191], v11 offset:16384
    s_waitcnt lgkmcnt(0)
    s_cmp_lt_u32 s30, 5
    s_cbranch_scc0 L_skip_130
    s_waitcnt vmcnt(0)
L_skip_130:
    s_cmp_lt_u32 s3, 20
    s_cbranch_scc0 L_skip_131
    v_lshlrev_b32 v57, 4, v0
    v_lshlrev_b32 v58, 3, v0
    s_mul_i32 s57, s30, 6144
    s_add_u32 s57, s57, 30720
    v_lshrrev_b32 v59, 2, v0
    v_lshlrev_b32 v59, 6, v59
    v_bfe_u32 v53, v0, 4, 1
    v_lshl_add_u32 v59, v53, 5, v59
    v_and_b32 v53, 3, v0
    v_lshl_add_u32 v59, v53, 3, v59
    v_add_u32 v59, s57, v59
    v_xor_b32 v60, 32, v59
    s_lshl_b32 s57, s30, 8
    s_add_u32 s57, s57, 157696
    v_lshl_add_u32 v61, v0, 2, s57
    s_cmp_lg_u32 s30, 6
    s_cbranch_scc0 L_skip_131
L_cw_132:
    s_waitcnt vmcnt(0)
    v_max3_u32 v53, v52, v54, v55
    v_cmp_eq_u32 vcc, -1, v53
    s_cbranch_vccnz L_cr_133
    v_max_f32_dpp v53, v52, v52 row_ror:4 row_mask:0xf bank_mask:0xf
    s_nop 1
    v_max_f32_dpp v53, v53, v53 row_ror:2 row_mask:0xf bank_mask:0xf
    s_nop 1
    v_max_f32_dpp v53, v53, v53 row_ror:1 row_mask:0xf bank_mask:0xf
    v_sub_f32 v52, v52, v53
    v_sub_f32 v54, v54, v53
    v_sub_f32 v55, v55, v53
    v_exp_f32 v52, v52
    v_exp_f32 v54, v54
    v_exp_f32 v55, v55
    s_cmp_eq_u32 s30, 7
    s_cbranch_scc0 L_skip_131
    v_add_u32 v62, 158720, v57
    ds_write_b128 v62, v[52:55]
    s_waitcnt lgkmcnt(0)
L_skip_131:
    v_smfmac_f32_16x16x64_bf16 v[40:43], v[12:15], v[160:167], v1
    v_smfmac_f32_16x16x64_bf16 v[40:43], v[16:19], v[168:175], v1
    v_smfmac_f32_16x16x64_bf16 v[40:43], v[20:23], v[176:183], v1
    v_smfmac_f32_16x16x64_bf16 v[40:43], v[24:27], v[184:191], v1
    s_cmp_eq_u32 s30, 6
    s_cbranch_scc0 L_skip_134
    s_mul_i32 s57, s14, 16
    s_add_u32 s58, s57, s15
    s_mov_b32 m0, 63488
L_dma_135:
    s_nop 0
    buffer_load_dwordx4 v3, s[48:51], s57 offen offset:0 nt lds
    buffer_load_dwordx4 v3, s[48:51], s58 offen offset:1024 nt lds
    s_add_u32 s57, s57, s14
    s_add_u32 s58, s58, s14
    s_add_u32 m0, m0, 2048
    s_cmp_lg_u32 m0, 71680
    s_cbranch_scc1 L_dma_135
    s_mul_i32 s57, s14, 20
    s_add_u32 s58, s57, s15
    s_mov_b32 m0, 71680
L_dma_136:
    s_nop 0
    buffer_load_dwordx4 v3, s[48:51], s57 offen offset:0 nt lds
    buffer_load_dwordx4 v3, s[48:51], s58 offen offset:1024 nt lds
    s_add_u32 s57, s57, s14
    s_add_u32 s58, s58, s14
    s_add_u32 m0, m0, 2048
    s_cmp_lg_u32 m0, 79872
    s_cbranch_scc1 L_dma_136
L_skip_134:
    s_waitcnt vmcnt(32)
    s_barrier
    ds_read_b64_tr_b16 v[198:199], v8 offset:32768
    ds_read_b64_tr_b16 v[206:207], v9 offset:32768
    ds_read_b64_tr_b16 v[214:215], v10 offset:32768
    ds_read_b64_tr_b16 v[222:223], v11 offset:32768
    s_waitcnt lgkmcnt(0)
    s_cmp_lt_u32 s3, 20
    s_cbranch_scc0 L_skip_137
    s_cmp_eq_u32 s30, 6
    s_cbranch_scc0 L_skip_137
    v_add_u32 v62, 158720, v57
    ds_read_b128 v[52:55], v62
L_skip_137:
L_pad1:
    s_cbranch_execz L_pad5
    v_smfmac_f32_16x16x64_bf16 v[40:43], v[28:31], v[192:199], v1
    v_smfmac_f32_16x16x64_bf16 v[40:43], v[32:35], v[200:207], v1
    v_smfmac_f32_16x16x64_bf16 v[44:47], v[12:15], v[208:215], v1
    v_smfmac_f32_16x16x64_bf16 v[44:47], v[16:19], v[216:223], v1
    v_mul_f32 v38, v38, v39
    ds_write_b32 v63, v38 offset:1024
    s_waitcnt vmcnt(16)
    s_barrier
    ds_read_b64_tr_b16 v[230:231], v8 offset:49152
    ds_read_b64_tr_b16 v[238:239], v9 offset:49152
    ds_read_b64_tr_b16 v[246:247], v10 offset:49152
    ds_read_b64_tr_b16 v[254:255], v11 offset:49152
    s_waitcnt lgkmcnt(0)
    v_smfmac_f32_16x16x64_bf16 v[44:47], v[20:23], v[224:231], v1
    v_smfmac_f32_16x16x64_bf16 v[44:47], v[24:27], v[232:239], v1
    v_smfmac_f32_16x16x64_bf16 v[44:47], v[28:31], v[240:247], v1
    v_smfmac_f32_16x16x64_bf16 v[44:47], v[32:35], v[248:255], v1
    s_setprio 0
    s_cmp_lt_u32 s30, 2
    v_pk_add_f32 v[40:41], v[40:41], v[42:43]
    s_nop 4
    v_pk_add_f32 v[42:43], v[44:45], v[46:47]
    v_pk_mul_f32 v[40:41], v[40:41], v[38:39] op_sel:[0,1] op_sel_hi:[1,1]
    v_pk_mul_f32 v[42:43], v[42:43], v[38:39] op_sel:[0,1] op_sel_hi:[1,1]
    ds_write_b128 v63, v[40:43]
    s_cbranch_scc1 L_comb_0
    s_waitcnt lgkmcnt(0)
    s_barrier
L_comb_0b:
    s_cmp_eq_u32 s30, 6
    s_cbranch_scc0 L_skip_142
    s_waitcnt vmcnt(0)
L_skip_142:
    s_barrier
    s_cmp_lt_u32 s3, 20
    s_cbranch_scc0 L_typeB_0
    buffer_load_dwordx4 v[12:15], v57, s[40:43], s74 offen sc1
    buffer_load_dwordx2 v[16:17], v58, s[40:43], s74 offen offset:1024 sc1
    buffer_load_dword v18, v56, s[40:43], s74 offen offset:1568 sc1
    ds_read_b64_tr_b16 v[28:29], v59 offset:0
    ds_read_b64_tr_b16 v[30:31], v59 offset:1024
    ds_read_b64_tr_b16 v[32:33], v59 offset:2048
    ds_read_b64_tr_b16 v[34:35], v59 offset:3072
    ds_read_b64_tr_b16 v[36:37], v59 offset:4096
    ds_read_b64_tr_b16 v[38:39], v59 offset:5120
    ds_read_b64_tr_b16 v[40:41], v60 offset:0
    ds_read_b64_tr_b16 v[42:43], v60 offset:1024
    ds_read_b64_tr_b16 v[44:45], v60 offset:2048
    ds_read_b64_tr_b16 v[46:47], v60 offset:3072
    ds_read_b64_tr_b16 v[48:49], v60 offset:4096
    ds_read_b64_tr_b16 v[50:51], v60 offset:5120
    v_mov_b64 v[20:21], 0
    v_mov_b64 v[22:23], 0
    v_mov_b64 v[24:25], 0
    v_mov_b64 v[26:27], 0
    s_add_u32 s58, s6, 0
    s_waitcnt lgkmcnt(0)
    s_branch L_pw_143
L_pr_144:
    buffer_load_dwordx4 v[12:15], v57, s[40:43], s74 offen sc1
    buffer_load_dwordx2 v[16:17], v58, s[40:43], s74 offen offset:1024 sc1
    buffer_load_dword v18, v56, s[40:43], s74 offen offset:1568 sc1
    s_sub_u32 s56, s56, 1
    s_cbranch_scc1 L_done
L_pw_143:
    s_waitcnt vmcnt(0)
    v_max3_u32 v19, v12, v13, v14
    v_max3_u32 v19, v19, v15, v16
    v_max3_u32 v19, v19, v17, v18
    v_cmp_eq_u32 vcc, -1, v19
    s_cbranch_vccnz L_pr_144
    v_smfmac_f32_16x16x64_bf16 v[20:23], v[12:15], v[28:35], v1
    v_mul_f32 v52, v52, v18
    v_smfmac_f32_16x16x64_bf16 v[24:27], v[12:15], v[40:47], v1
    v_smfmac_f32_16x16x32_bf16 v[20:23], v[16:17], v[36:39], v1
    v_add_f32_dpp v52, v52, v52 row_ror:4 row_mask:0xf bank_mask:0xf
    v_smfmac_f32_16x16x32_bf16 v[24:27], v[16:17], v[48:51], v1
    s_cmp_eq_u32 s30, 2
    v_add_f32_dpp v52, v52, v52 row_ror:2 row_mask:0xf bank_mask:0xf
    s_nop 1
    v_add_f32_dpp v52, v52, v52 row_ror:1 row_mask:0xf bank_mask:0xf
    v_rcp_f32 v52, v52
    v_pk_add_f32 v[20:21], v[20:21], v[22:23]
    s_nop 0
L_pad2:
    s_cbranch_execz L_pad6
    v_pk_add_f32 v[24:25], v[24:25], v[26:27]
    v_pk_mul_f32 v[54:55], v[54:55], v[52:53] op_sel:[0,0] op_sel_hi:[1,0]
    v_mul_f32 v20, v20, v54
    v_mul_f32 v24, v24, v54
    v_fmac_f32 v20, v21, v55
    v_fmac_f32 v24, v25, v55
    s_nop 1
    v_permlane32_swap_b32 v20, v24
    v_add_f32 v20, v20, v24
    ds_write_b32 v61, v20
    s_waitcnt lgkmcnt(0)
    s_barrier
    s_cbranch_scc0 L_finb_145
    ds_read2st64_b32 v[12:13], v2 offset0:0 offset1:1
    ds_read2st64_b32 v[14:15], v2 offset0:2 offset1:3
    ds_read2st64_b32 v[16:17], v2 offset0:4 offset1:5
    ds_read2st64_b32 v[18:19], v2 offset0:6 offset1:7
    s_waitcnt lgkmcnt(2)
    v_pk_add_f32 v[12:13], v[12:13], v[14:15]
    s_waitcnt lgkmcnt(0)
    v_pk_add_f32 v[16:17], v[16:17], v[18:19]
    v_pk_add_f32 v[12:13], v[12:13], v[16:17]
    v_add_f32 v14, v12, v13
    v_add_f32 v15, v12, v13
    s_nop 1
    v_permlane16_swap_b32 v14, v15
    v_add_f32 v12, v14, v15
    v_min_u32 v12, -2, v12
    buffer_store_dword v12, v3, s[40:43], s58 offen sc1
L_finb_145:
    s_sub_u32 s57, s30, 4
    s_cmp_lt_u32 s57, 3
    s_cbranch_scc0 L_skip_146
    s_sub_u32 s60, s30, 4
    s_lshl_b32 s59, s60, 12
    s_add_u32 s59, s59, 79872
    s_lshl_b32 s57, s60, 11
    v_lshlrev_b32 v11, 4, v0
    v_add_u32 v11, s57, v11
    s_add_u32 s58, s62, 19456
    buffer_load_dwordx4 v[12:15], v11, s[40:43], s58 offen offset:0 sc1
    buffer_load_dwordx4 v[16:19], v11, s[40:43], s58 offen offset:1024 sc1
    s_mov_b32 s44, s20
    s_mov_b32 s45, s21
    s_mov_b32 s46, 1966080
    s_mov_b32 s47, 0x20000
    s_mul_i32 s57, s31, 3
    s_add_u32 s57, s57, s60
    s_mul_i32 s57, s57, 81920
    s_lshl_b32 s64, s3, 6
    s_add_u32 s57, s57, s64
    v_lshrrev_b32 v5, 2, v0
    v_mul_u32_u24 v5, 1280, v5
    v_and_b32 v60, 3, v0
    v_lshl_add_u32 v5, v60, 4, v5
    v_add_u32 v5, s57, v5
    s_add_u32 m0, s59, 0
    s_mov_b32 s57, 0
    buffer_load_dwordx4 v5, s[44:47], s57 offen nt lds
    s_add_u32 m0, s59, 1024
    s_mov_b32 s57, 20480
    buffer_load_dwordx4 v5, s[44:47], s57 offen nt lds
    s_add_u32 m0, s59, 2048
    s_mov_b32 s57, 40960
    buffer_load_dwordx4 v5, s[44:47], s57 offen nt lds
    s_add_u32 m0, s59, 3072
    s_mov_b32 s57, 61440
    buffer_load_dwordx4 v5, s[44:47], s57 offen nt lds
    v_lshrrev_b32 v35, 4, v0
    v_lshlrev_b32 v35, 9, v35
    v_bfe_u32 v60, v0, 2, 2
    v_lshl_add_u32 v35, v60, 6, v35
    v_and_b32 v60, 3, v0
    v_lshl_add_u32 v35, v60, 3, v35
    v_add_u32 v35, s59, v35
    s_waitcnt vmcnt(4)
L_sw_147:
    v_max3_u32 v60, v12, v13, v14
    v_max3_u32 v60, v60, v15, v16
    v_max3_u32 v60, v60, v17, v18
    v_max_u32 v60, v60, v19
    v_cmp_eq_u32 vcc, -1, v60
    s_cbranch_vccnz L_sr_148
    v_pk_add_f32 v[20:21], v[12:13], v[14:15]
    v_pk_add_f32 v[22:23], v[16:17], v[18:19]
    v_pk_add_f32 v[20:21], v[20:21], v[22:23]
    v_add_f32 v8, v20, v21
    v_mov_b64 v[52:53], 0
    v_mov_b64 v[54:55], 0
    v_mov_b64 v[56:57], 0
L_pad3:
    s_cbranch_execz L_pad7
    v_mov_b64 v[58:59], 0
    v_mov_b32 v9, 0xbdd2d3e8
    v_mov_b32 v10, 0xc0135761
    s_lshl_b32 s57, s60, 7
    s_add_u32 s57, s57, 159872
    v_lshlrev_b32 v32, 3, v0
    v_add_u32 v32, s57, v32
    v_lshlrev_b32 v33, 3, v0
    v_add_u32 v33, 129024, v33
    v_cmp_gt_u32 vcc, 16, v0
    s_nop 1
    v_cndmask_b32 v32, v33, v32, vcc
    v_and_b32 v33, 15, v0
    v_lshlrev_b32 v33, 3, v33
    v_lshrrev_b32 v60, 5, v0
    v_lshl_add_u32 v33, v60, 2, v33
    v_add_u32 v33, 159872, v33
    v_and_b32 v34, 15, v0
    v_lshlrev_b32 v34, 2, v34
    v_lshrrev_b32 v60, 5, v0
    v_lshl_add_u32 v34, v60, 6, v34
    v_bfe_u32 v60, v0, 4, 1
    v_lshl_add_u32 v34, v60, 13, v34
    s_add_u32 s60, s6, 131072
    s_add_u32 s59, s60, 16384
    s_lshl_b32 s74, s3, 2
    s_add_u32 s74, s74, s62
    s_add_u32 s74, s74, 26496
    s_xor_b32 s75, s30, 4
    s_lshl_b32 s75, s75, 24
    v_and_b32 v5, 3, v0
    v_lshlrev_b32 v5, 7, v5
    v_lshrrev_b32 v60, 2, v0
    v_lshl_add_u32 v5, v60, 24, v5
    v_add_u32 v5, s75, v5
    s_add_u32 s58, s62, 13312
    s_add_u32 s57, s62, 25856
    v_and_b32 v7, 7, v0
    v_lshlrev_b32 v7, 3, v7
    buffer_load_dwordx2 v[24:25], v7, s[40:43], s57 offen sc1
    buffer_load_dwordx4 v[12:15], v11, s[40:43], s58 offen offset:0 sc1
    buffer_load_dwordx4 v[16:19], v11, s[40:43], s58 offen offset:1024 sc1
    s_waitcnt vmcnt(3)
    ds_read_b64_tr_b16 v[36:37], v35 offset:0
    ds_read_b64_tr_b16 v[38:39], v35 offset:256
    ds_read_b64_tr_b16 v[40:41], v35 offset:2048
    ds_read_b64_tr_b16 v[42:43], v35 offset:2304
    ds_read_b64_tr_b16 v[44:45], v35 offset:32
    ds_read_b64_tr_b16 v[46:47], v35 offset:288
    ds_read_b64_tr_b16 v[48:49], v35 offset:2080
    ds_read_b64_tr_b16 v[50:51], v35 offset:2336
    s_waitcnt lgkmcnt(0)
L_pr_150:
    buffer_load_dwordx2 v[24:25], v7, s[40:43], s57 offen sc1
    buffer_load_dwordx4 v[12:15], v11, s[40:43], s58 offen offset:0 sc1
    buffer_load_dwordx4 v[16:19], v11, s[40:43], s58 offen offset:1024 sc1
    s_sub_u32 s56, s56, 1
    s_cbranch_scc1 L_done
L_pw_149:
    s_waitcnt vmcnt(5)
    v_max_u32 v26, v24, v25
    v_cmp_eq_u32 vcc, -1, v26
    s_cbranch_vccnz L_pr_150
    buffer_load_dwordx4 v[12:15], v11, s[40:43], s58 offen offset:0 sc1
    buffer_load_dwordx4 v[16:19], v11, s[40:43], s58 offen offset:1024 sc1
    v_add_f32_dpp v2, v24, v24 row_ror:4 row_mask:0xf bank_mask:0xf
    v_add_f32_dpp v3, v25, v25 row_ror:4 row_mask:0xf bank_mask:0xf
    s_nop 0
    v_add_f32_dpp v2, v2, v2 row_ror:2 row_mask:0xf bank_mask:0xf
    v_add_f32_dpp v3, v3, v3 row_ror:2 row_mask:0xf bank_mask:0xf
    s_nop 0
    v_add_f32_dpp v2, v2, v2 row_ror:1 row_mask:0xf bank_mask:0xf
    v_add_f32_dpp v3, v3, v3 row_ror:1 row_mask:0xf bank_mask:0xf
    v_mul_f32 v2, 0x3acccccd, v2
    v_mul_f32 v3, 0x3acccccd, v3
    v_fma_f32 v3, -v2, v2, v3
    v_max_f32 v3, 0, v3
    v_add_f32 v3, 0x3727c5ac, v3
    v_rsq_f32 v3, v3
    s_nop 0
    v_mul_f32 v2, v2, v3
    v_fma_f32 v8, -v2, v8, v4
    s_waitcnt vmcnt(5)
L_hw_151:
    v_pk_add_f32 v[20:21], v[12:13], v[14:15]
    v_pk_add_f32 v[22:23], v[16:17], v[18:19]
L_pad4:
    s_cbranch_execz L_pad8
    v_pk_add_f32 v[20:21], v[20:21], v[22:23]
    v_add_f32 v20, v20, v21
    v_cmp_u_f32 vcc, v20, v20
    v_fma_f32 v20, v20, v3, v8
    s_cbranch_vccnz L_hr_152
L_hk_153:
    v_mul_f32 v21, v20, v20
    v_fma_f32 v21, v21, v9, v10
    v_mul_f32 v21, v21, v20
    v_exp_f32 v21, v21
    s_cmp_eq_u32 s55, 0
    v_add_f32 v21, 1.0, v21
    v_rcp_f32 v21, v21
    s_nop 0
    v_mul_f32 v20, v20, v21
    s_nop 1
    v_mov_b32_dpp v21, v20 row_shl:1 row_mask:0xf bank_mask:0xf bound_ctrl:0
    v_cvt_pk_bf16_f32 v28, v20, v21
    s_nop 1
    v_mov_b32_dpp v29, v28 row_shl:4 row_mask:0xf bank_mask:0xf bound_ctrl:0
    v_mov_b32_dpp v30, v28 row_shl:8 row_mask:0xf bank_mask:0xf bound_ctrl:0
    v_mov_b32_dpp v31, v28 row_shl:12 row_mask:0xf bank_mask:0xf bound_ctrl:0
    s_nop 1
    v_smfmac_f32_16x16x64_bf16 v[52:55], v[28:31], v[36:43], v1
    v_smfmac_f32_16x16x64_bf16 v[56:59], v[28:31], v[44:51], v1
    s_nop 6
    v_add_f32 v22, v52, v54
    v_add_f32 v23, v56, v58
    ds_write_b64 v32, v[22:23]
    s_cmp_eq_u32 s30, 4
    s_cbranch_scc0 L_skip_155
L_xw_156:
    ds_read2_b32 v[20:21], v33 offset0:0 offset1:32
    ds_read_b32 v22, v33 offset:256
    s_cmp_eq_u32 s55, 0
    s_waitcnt lgkmcnt(0)
    v_max3_u32 v23, v20, v21, v22
    v_add_f32 v20, v20, v21
    v_cmp_eq_u32 vcc, -1, v23
    v_add_f32 v20, v20, v22
    s_cbranch_vccnz L_xr_157
    v_min_u32 v20, -2, v20
    buffer_store_dword v20, v34, s[40:43], s60 offen sc1
    s_waitcnt vmcnt(1)
    s_branch L_pe_158
L_skip_155:
    s_waitcnt vmcnt(0)
L_pe_158:
L_skip_146:
    s_branch L_p1
L_typeB_0:
    s_cmp_eq_u32 s53, 3
    s_cbranch_scc0 L_typeC_159
    s_cmp_eq_u32 s30, 7
    s_cbranch_scc1 L_w7_164
    s_cmp_lt_u32 s30, 6
    s_cbranch_scc0 L_skip_166
    s_lshr_b32 s57, s30, 1
    s_mul_i32 s57, s57, 128
    s_and_b32 s58, s30, 1
    s_lshl_b32 s58, s58, 6
    s_add_u32 s57, s57, s58
    v_lshrrev_b32 v18, 5, v0
    v_lshlrev_b32 v18, 13, v18
    v_bfe_u32 v60, v0, 3, 1
    v_lshl_add_u32 v18, v60, 12, v18
    v_bfe_u32 v60, v0, 4, 1
    v_lshl_add_u32 v18, v60, 11, v18
    v_bfe_u32 v60, v0, 2, 1
    v_mul_u32_u24 v60, 384, v60
    v_add_u32 v18, v60, v18
    v_and_b32 v60, 3, v0
    v_lshl_add_u32 v18, v60, 3, v18
    v_add_u32 v18, s57, v18
    v_add_u32 v18, 30720, v18
    v_bfe_u32 v19, v0, 4, 1
    v_lshlrev_b32 v19, 12, v19
    v_bfe_u32 v60, v0, 3, 1
    v_lshl_add_u32 v19, v60, 11, v19
    v_bfe_u32 v60, v0, 2, 1
    v_mul_u32_u24 v60, 384, v60
    v_add_u32 v19, v60, v19
    v_and_b32 v60, 3, v0
    v_lshl_add_u32 v19, v60, 3, v19
    v_add_u32 v19, s57, v19
    v_add_u32 v19, 63488, v19
    ds_read_b64_tr_b16 v[28:29], v18 offset:0
    ds_read_b64_tr_b16 v[30:31], v18 offset:1024
    ds_read_b64_tr_b16 v[32:33], v18 offset:16384
    ds_read_b64_tr_b16 v[34:35], v18 offset:17408
    ds_read_b64_tr_b16 v[36:37], v19 offset:0
    ds_read_b64_tr_b16 v[38:39], v19 offset:1024
    ds_read_b64_tr_b16 v[40:41], v18 offset:32
    ds_read_b64_tr_b16 v[42:43], v18 offset:1056
L_pad5:
    s_cbranch_execz L_pad9
    ds_read_b64_tr_b16 v[44:45], v18 offset:16416
    ds_read_b64_tr_b16 v[46:47], v18 offset:17440
    ds_read_b64_tr_b16 v[48:49], v19 offset:32
    ds_read_b64_tr_b16 v[50:51], v19 offset:1056
    v_lshrrev_b32 v9, 4, v0
    v_lshlrev_b32 v9, 5, v9
    v_bfe_u32 v60, v0, 1, 1
    v_lshl_add_u32 v9, v60, 4, v9
    v_and_b32 v60, 1, v0
    v_mul_u32_u24 v60, 192, v60
    v_add_u32 v9, v60, v9
    v_add_u32 v9, 160832, v9
    v_lshrrev_b32 v10, 4, v0
    v_lshlrev_b32 v10, 4, v10
    v_bfe_u32 v60, v0, 1, 1
    v_lshl_add_u32 v10, v60, 3, v10
    v_and_b32 v60, 1, v0
    v_mul_u32_u24 v60, 192, v60
    v_add_u32 v10, v60, v10
    v_add_u32 v10, 160960, v10
    v_mov_b64 v[20:21], 0
    v_mov_b64 v[22:23], 0
    v_mov_b64 v[24:25], 0
    v_mov_b64 v[26:27], 0
    s_lshr_b32 s57, s30, 1
    s_lshl_b32 s57, s57, 11
    s_and_b32 s58, s30, 1
    s_lshl_b32 s58, s58, 9
    s_add_u32 s57, s57, s58
    s_lshr_b32 s58, s54, 2
    s_lshl_b32 s58, s58, 10
    s_add_u32 s57, s57, s58
    s_and_b32 s58, s54, 3
    s_lshl_b32 s58, s58, 2
    s_add_u32 s57, s57, s58
    v_and_b32 v11, 31, v0
    v_lshlrev_b32 v11, 4, v11
    v_lshrrev_b32 v60, 5, v0
    v_lshl_add_u32 v11, v60, 30, v11
    v_add_u32 v11, s57, v11
    s_add_u32 s59, s62, 13312
    s_add_u32 s60, s62, 25856
    ds_read_b128 v[12:15], v9
    ds_read_b64 v[16:17], v10
    s_waitcnt lgkmcnt(1)
    v_smfmac_f32_16x16x64_bf16 v[20:23], v[12:15], v[28:35], v1
    v_smfmac_f32_16x16x64_bf16 v[24:27], v[12:15], v[40:47], v1
    s_waitcnt lgkmcnt(0)
    v_smfmac_f32_16x16x32_bf16 v[20:23], v[16:17], v[36:39], v1
    v_smfmac_f32_16x16x32_bf16 v[24:27], v[16:17], v[48:51], v1
    s_add_u32 s60, s62, 19456
    s_cmp_eq_u32 s55, 0
    s_nop 4
    v_add_f32 v12, v21, v23
    s_nop 1
    v_add_f32_dpp v12, v25, v27 quad_perm:[0,1,2,3] row_mask:0x2 bank_mask:0xf
    v_min_u32 v12, -2, v12
    s_cbranch_scc1 L_gs_167
    buffer_store_dword v12, v11, s[40:43], s60 offen
L_gb_168:
    v_mov_b64 v[20:21], 0
    v_mov_b64 v[22:23], 0
    v_mov_b64 v[24:25], 0
    v_mov_b64 v[26:27], 0
L_skip_166:
    s_cmp_lt_u32 s30, 6
    s_barrier
    s_cbranch_scc0 L_se_165
    ds_read_b128 v[12:15], v9
    ds_read_b64 v[16:17], v10
    s_waitcnt lgkmcnt(1)
    v_smfmac_f32_16x16x64_bf16 v[20:23], v[12:15], v[28:35], v1
    v_smfmac_f32_16x16x64_bf16 v[24:27], v[12:15], v[40:47], v1
    s_waitcnt lgkmcnt(0)
    v_smfmac_f32_16x16x32_bf16 v[20:23], v[16:17], v[36:39], v1
    v_smfmac_f32_16x16x32_bf16 v[24:27], v[16:17], v[48:51], v1
    s_cmp_eq_u32 s55, 0
    s_nop 5
    v_add_f32 v12, v20, v22
    s_nop 1
    v_add_f32_dpp v12, v24, v26 quad_perm:[0,1,2,3] row_mask:0x2 bank_mask:0xf
    v_min_u32 v12, -2, v12
    s_cbranch_scc1 L_gs_169
    buffer_store_dword v12, v11, s[40:43], s59 offen
L_gb_170:
L_se_165:
L_p1:
    s_lshl_b32 s57, s30, 7
    s_add_u32 s57, s57, 158720
    v_lshrrev_b32 v58, 4, v0
    v_lshlrev_b32 v58, 5, v58
    v_bfe_u32 v60, v0, 1, 1
    v_lshl_add_u32 v58, v60, 4, v58
    v_bfe_u32 v60, v0, 2, 2
    v_lshl_add_u32 v58, v60, 2, v58
L_pad6:
    s_cbranch_execz L_pad10
    v_and_b32 v60, 1, v0
    v_lshl_add_u32 v58, v60, 1, v58
    v_add_u32 v58, s57, v58
    v_lshrrev_b32 v61, 4, v0
    v_lshlrev_b32 v61, 5, v61
    v_bfe_u32 v60, v0, 1, 1
    v_lshl_add_u32 v61, v60, 4, v61
    v_add_u32 v61, s57, v61
    v_bfe_u32 v62, v0, 2, 2
    v_lshlrev_b32 v62, 1, v62
    v_and_b32 v60, 1, v0
    v_lshl_add_u32 v62, v60, 0, v62
    v_mov_b32 v60, 160992
    v_cmp_eq_u32 vcc, 0, v62
    s_nop 1
    v_cndmask_b32 v52, v60, v61, vcc
    v_cmp_eq_u32 vcc, 1, v62
    s_nop 1
    v_cndmask_b32 v53, v60, v61, vcc
    v_cmp_eq_u32 vcc, 2, v62
    s_nop 1
    v_cndmask_b32 v54, v60, v61, vcc
    v_cmp_eq_u32 vcc, 3, v62
    s_nop 1
    v_cndmask_b32 v55, v60, v61, vcc
    v_cmp_eq_u32 vcc, 4, v62
    s_nop 1
    v_cndmask_b32 v56, v60, v61, vcc
    v_cmp_eq_u32 vcc, 5, v62
    s_nop 1
    v_cndmask_b32 v57, v60, v61, vcc
    s_lshl_b32 s58, s30, 2
    s_add_u32 s58, s58, 159808
    v_mov_b32 v60, s58
    v_lshlrev_b32 v59, 2, v0
    v_add_u32 v59, 157696, v59
    v_cmp_eq_u32 vcc, 63, v0
    s_nop 1
    v_cndmask_b32 v59, v59, v60, vcc
    v_and_b32 v62, 7, v0
    v_lshlrev_b32 v62, 2, v62
    v_add_u32 v62, 159808, v62
    s_lshl_b32 s57, s30, 11
    v_lshlrev_b32 v63, 4, v0
    v_add_u32 v63, s57, v63
    v_add_u32 v63, 92160, v63
    v_mov_b32 v8, 125440
    s_sub_u32 s57, s30, 1
    s_lshl_b32 s57, s57, 10
    v_lshlrev_b32 v7, 4, v0
    v_add_u32 v7, s57, v7
    s_cmp_eq_u32 s30, 7
    s_cbranch_scc1 L_w7_178
    s_cmp_lt_u32 s30, 6
    s_cbranch_scc0 L_skip_180
    s_lshr_b32 s57, s30, 1
    s_mul_i32 s57, s57, 1024
    s_and_b32 s58, s30, 1
    s_lshl_b32 s58, s58, 6
    s_add_u32 s57, s57, s58
    v_lshrrev_b32 v18, 5, v0
    v_mul_u32_u24 v18, 6144, v18
    v_bfe_u32 v60, v0, 3, 1
    v_mul_u32_u24 v60, 3072, v60
    v_add_u32 v18, v60, v18
    v_bfe_u32 v60, v0, 4, 1
    v_lshl_add_u32 v18, v60, 9, v18
    v_bfe_u32 v60, v0, 2, 1
    v_lshl_add_u32 v18, v60, 7, v18
    v_and_b32 v60, 3, v0
    v_lshl_add_u32 v18, v60, 3, v18
    v_add_u32 v18, s57, v18
    v_bfe_u32 v19, v0, 4, 1
    v_mul_u32_u24 v19, 3072, v19
    v_bfe_u32 v60, v0, 3, 1
    v_lshl_add_u32 v19, v60, 9, v19
    v_bfe_u32 v60, v0, 2, 1
    v_lshl_add_u32 v19, v60, 7, v19
    v_and_b32 v60, 3, v0
    v_lshl_add_u32 v19, v60, 3, v19
    v_add_u32 v19, s57, v19
    v_add_u32 v19, 24576, v19
    ds_read_b64_tr_b16 v[28:29], v18 offset:0
    ds_read_b64_tr_b16 v[30:31], v18 offset:256
    ds_read_b64_tr_b16 v[32:33], v18 offset:12288
    ds_read_b64_tr_b16 v[34:35], v18 offset:12544
    ds_read_b64_tr_b16 v[36:37], v19 offset:0
    ds_read_b64_tr_b16 v[38:39], v19 offset:256
    ds_read_b64_tr_b16 v[40:41], v18 offset:32
    ds_read_b64_tr_b16 v[42:43], v18 offset:288
    ds_read_b64_tr_b16 v[44:45], v18 offset:12320
L_pad7:
    s_cbranch_execz L_pad11
    ds_read_b64_tr_b16 v[46:47], v18 offset:12576
    ds_read_b64_tr_b16 v[48:49], v19 offset:32
    ds_read_b64_tr_b16 v[50:51], v19 offset:288
    v_lshrrev_b32 v9, 4, v0
    v_lshlrev_b32 v9, 5, v9
    v_bfe_u32 v60, v0, 1, 1
    v_lshl_add_u32 v9, v60, 4, v9
    v_and_b32 v60, 1, v0
    v_mul_u32_u24 v60, 192, v60
    v_add_u32 v9, v60, v9
    v_add_u32 v9, 160832, v9
    v_lshrrev_b32 v10, 4, v0
    v_lshlrev_b32 v10, 4, v10
    v_bfe_u32 v60, v0, 1, 1
    v_lshl_add_u32 v10, v60, 3, v10
    v_and_b32 v60, 1, v0
    v_mul_u32_u24 v60, 192, v60
    v_add_u32 v10, v60, v10
    v_add_u32 v10, 160960, v10
    v_mov_b64 v[20:21], 0
    v_mov_b64 v[22:23], 0
    v_mov_b64 v[24:25], 0
    v_mov_b64 v[26:27], 0
    s_lshl_b32 s57, s54, 1
    s_lshl_b32 s58, s30, 9
    s_add_u32 s57, s57, s58
    v_and_b32 v11, 31, v0
    v_lshlrev_b32 v11, 4, v11
    v_lshrrev_b32 v60, 5, v0
    v_lshl_add_u32 v11, v60, 30, v11
    v_add_u32 v11, s57, v11
    s_mul_i32 s59, s53, 3072
    s_add_u32 s59, s59, s62
    s_add_u32 s59, s59, 46464
    s_lshl_b32 s60, s53, 6
    s_add_u32 s60, s60, s62
    s_add_u32 s60, s60, 25600
L_skip_180:
    s_cmp_lt_u32 s30, 6
    s_barrier
    s_cbranch_scc0 L_se_179
    ds_read_b128 v[12:15], v9
    ds_read_b64 v[16:17], v10
    s_waitcnt lgkmcnt(1)
    v_smfmac_f32_16x16x64_bf16 v[20:23], v[12:15], v[28:35], v1
    v_smfmac_f32_16x16x64_bf16 v[24:27], v[12:15], v[40:47], v1
    s_waitcnt lgkmcnt(0)
    v_smfmac_f32_16x16x32_bf16 v[20:23], v[16:17], v[36:39], v1
    v_smfmac_f32_16x16x32_bf16 v[24:27], v[16:17], v[48:51], v1
    s_cmp_eq_u32 s55, 0
    s_nop 5
    v_add_f32 v12, v20, v22
    s_nop 1
    v_add_f32_dpp v12, v24, v26 quad_perm:[0,1,2,3] row_mask:0x2 bank_mask:0xf
    v_cvt_pk_bf16_f32 v12, v12, v12
    v_min_u32 v12, -2, v12
    s_cbranch_scc1 L_gs_181
    buffer_store_short v12, v11, s[40:43], s59 offen
L_gb_182:
L_se_179:
    s_sub_u32 s57, s30, 1
    s_cmp_lt_u32 s57, 3
    s_cbranch_scc0 L_qo_196
    buffer_load_dwordx4 v[48:51], v7, s[40:43], s59 offen sc1
    v_mov_b64 v[24:25], 0
    v_mov_b64 v[26:27], 0
    v_mov_b64 v[28:29], 0
    v_mov_b64 v[30:31], 0
    v_mov_b64 v[32:33], 0
    v_mov_b64 v[34:35], 0
    v_mov_b64 v[36:37], 0
    v_mov_b64 v[38:39], 0
    v_mov_b64 v[40:41], 0
    v_mov_b64 v[42:43], 0
    v_mov_b64 v[44:45], 0
    v_mov_b64 v[46:47], 0
    v_lshrrev_b32 v5, 4, v0
    v_lshlrev_b32 v5, 5, v5
    v_bfe_u32 v60, v0, 1, 1
    v_lshl_add_u32 v5, v60, 4, v5
    v_add_u32 v5, 124928, v5
    v_add_u32 v9, 4294933376, v58
    v_mov_b32 v10, 0x3f803f80
L_qw_198:
    buffer_load_dwordx4 v[48:51], v7, s[40:43], s59 offen sc1
    s_sub_u32 s56, s56, 1
    s_cbranch_scc1 L_done
    s_and_b32 s57, s56, 31
    s_waitcnt vmcnt(1)
    v_dot2_f32_bf16 v60, v48, v10, 0
    v_dot2_f32_bf16 v61, v49, v10, 0
    v_dot2_f32_bf16 v60, v50, v10, v60
    v_dot2_f32_bf16 v61, v51, v10, v61
    s_nop 2
    v_add_f32 v60, v60, v61
L_pad8:
    s_cbranch_execz L_pad12
    v_cmp_u_f32 vcc, v60, v60
    v_cvt_pk_bf16_f32 v60, v60, v60
    s_cbranch_vccnz L_qr_199
L_qk_200:
    ds_write_b16 v9, v60
L_qb_197:
    s_waitcnt lgkmcnt(0)
    s_barrier
    ds_read_b128 v[12:15], v5 offset:0
    ds_read_b128 v[16:19], v5 offset:128
    ds_read_b128 v[20:23], v5 offset:256
    ds_read_b64 v[8:9], v8
    s_waitcnt lgkmcnt(1)
    v_smfmac_f32_16x16x64_bf16 v[24:27], v[12:15], v[64:71], v1
    v_smfmac_f32_16x16x64_bf16 v[24:27], v[16:19], v[72:79], v1
    v_smfmac_f32_16x16x64_bf16 v[24:27], v[20:23], v[80:87], v1
    v_smfmac_f32_16x16x64_bf16 v[28:31], v[12:15], v[88:95], v1
    v_smfmac_f32_16x16x64_bf16 v[28:31], v[16:19], v[96:103], v1
    v_smfmac_f32_16x16x64_bf16 v[28:31], v[20:23], v[104:111], v1
    v_smfmac_f32_16x16x64_bf16 v[32:35], v[12:15], v[112:119], v1
    v_smfmac_f32_16x16x64_bf16 v[32:35], v[16:19], v[120:127], v1
    v_smfmac_f32_16x16x64_bf16 v[32:35], v[20:23], v[128:135], v1
    v_smfmac_f32_16x16x64_bf16 v[36:39], v[12:15], v[136:143], v1
    v_smfmac_f32_16x16x64_bf16 v[36:39], v[16:19], v[144:151], v1
    v_smfmac_f32_16x16x64_bf16 v[36:39], v[20:23], v[152:159], v1
    v_add_f32_dpp v61, v24, v26 quad_perm:[0,1,2,3] row_mask:0x1 bank_mask:0xf
    s_waitcnt vmcnt(0) lgkmcnt(0)
    v_mul_f32 v8, v8, v6
    v_add_f32_dpp v61, v28, v30 quad_perm:[0,1,2,3] row_mask:0x2 bank_mask:0xf
    s_nop 1
    v_add_f32_dpp v61, v32, v34 quad_perm:[0,1,2,3] row_mask:0x4 bank_mask:0xf
    s_nop 1
    v_add_f32_dpp v61, v36, v38 quad_perm:[0,1,2,3] row_mask:0x8 bank_mask:0xf
    v_fma_f32 v36, v61, v9, v8
    s_nop 1
    v_max_f32_dpp v37, v36, v36 row_ror:8 row_mask:0xf bank_mask:0xf
    s_nop 1
    v_max_f32_dpp v37, v37, v37 row_ror:4 row_mask:0xf bank_mask:0xf
    s_nop 1
    v_max_f32_dpp v37, v37, v37 row_ror:2 row_mask:0xf bank_mask:0xf
    s_nop 1
    v_max_f32_dpp v37, v37, v37 row_ror:1 row_mask:0xf bank_mask:0xf
    s_nop 1
    v_max_f32_dpp v37, v37, v37 row_bcast:15 row_mask:0xa bank_mask:0xf
    s_nop 1
    v_max_f32_dpp v37, v37, v37 row_bcast:31 row_mask:0xc bank_mask:0xf
    s_nop 0
    v_readlane_b32 s64, v37, 63
    ds_write_b32 v59, v37
    s_nop 0
    v_subrev_f32 v36, s64, v36
    v_exp_f32 v36, v36
    s_nop 0
    v_cvt_pk_bf16_f32 v39, v36, v36
    ds_write_b16 v58, v39
    ds_read_b128 v[12:15], v52
    ds_read_b128 v[16:19], v53
    ds_read_b128 v[20:23], v54
    ds_read_b128 v[24:27], v55
    ds_read_b128 v[28:31], v56
    ds_read_b128 v[32:35], v57
    v_add_f32_dpp v38, v36, v36 row_ror:8 row_mask:0xf bank_mask:0xf
    s_nop 1
    v_add_f32_dpp v38, v38, v38 row_ror:4 row_mask:0xf bank_mask:0xf
    s_nop 1
    v_add_f32_dpp v38, v38, v38 row_ror:2 row_mask:0xf bank_mask:0xf
    s_nop 1
    v_add_f32_dpp v38, v38, v38 row_ror:1 row_mask:0xf bank_mask:0xf
    s_waitcnt lgkmcnt(5)
    v_smfmac_f32_16x16x64_bf16 v[40:43], v[12:15], v[160:167], v1
    v_add_f32_dpp v38, v38, v38 row_bcast:15 row_mask:0xa bank_mask:0xf
    v_smfmac_f32_16x16x64_bf16 v[44:47], v[12:15], v[208:215], v1
    s_waitcnt lgkmcnt(4)
    v_smfmac_f32_16x16x64_bf16 v[40:43], v[16:19], v[168:175], v1
    v_add_f32_dpp v38, v38, v38 row_bcast:31 row_mask:0xc bank_mask:0xf
    v_smfmac_f32_16x16x64_bf16 v[44:47], v[16:19], v[216:223], v1
    ds_read_b32 v36, v62
    s_waitcnt lgkmcnt(4)
    v_smfmac_f32_16x16x64_bf16 v[40:43], v[20:23], v[176:183], v1
L_pad9:
    s_cbranch_execz L_pad13
    v_smfmac_f32_16x16x64_bf16 v[44:47], v[20:23], v[224:231], v1
    s_waitcnt lgkmcnt(0)
    v_max_f32_dpp v37, v36, v36 row_ror:4 row_mask:0xf bank_mask:0xf
    v_smfmac_f32_16x16x64_bf16 v[40:43], v[24:27], v[184:191], v1
    v_smfmac_f32_16x16x64_bf16 v[44:47], v[24:27], v[232:239], v1
    v_max_f32_dpp v37, v37, v37 row_ror:2 row_mask:0xf bank_mask:0xf
    v_smfmac_f32_16x16x64_bf16 v[40:43], v[28:31], v[192:199], v1
    v_cmp_eq_u32 vcc, -1, v36
    v_smfmac_f32_16x16x64_bf16 v[44:47], v[28:31], v[240:247], v1
    v_max_f32_dpp v37, v37, v37 row_ror:1 row_mask:0xf bank_mask:0xf
    v_smfmac_f32_16x16x64_bf16 v[40:43], v[32:35], v[200:207], v1
    v_sub_f32 v39, s64, v37
    v_smfmac_f32_16x16x64_bf16 v[44:47], v[32:35], v[248:255], v1
    v_exp_f32 v39, v39
    s_cbranch_vccnz L_mr_203
L_mk_204:
    v_mul_f32 v38, v38, v39
    ds_write_b32 v63, v38 offset:1024
    s_cmp_lt_u32 s30, 2
    s_nop 0
    v_pk_add_f32 v[40:41], v[40:41], v[42:43]
    s_nop 0
    v_pk_add_f32 v[42:43], v[44:45], v[46:47]
    v_pk_mul_f32 v[40:41], v[40:41], v[38:39] op_sel:[0,1] op_sel_hi:[1,1]
    v_pk_mul_f32 v[42:43], v[42:43], v[38:39] op_sel:[0,1] op_sel_hi:[1,1]
    ds_write_b128 v63, v[40:43]
    s_cbranch_scc1 L_comb_1
    s_waitcnt lgkmcnt(0)
    s_barrier
L_comb_1b:
    s_cmp_lt_u32 s3, 20
    s_cbranch_scc0 L_typeB_1
    s_mul_i32 s74, s30, 1664
    s_add_u32 s74, s74, s62
    s_add_u32 s74, s74, 27008
    v_and_b32 v56, 7, v0
    v_lshlrev_b32 v56, 2, v56
    v_lshrrev_b32 v62, 4, v0
    v_lshlrev_b32 v62, 3, v62
    buffer_load_dword v52, v56, s[40:43], s74 offen offset:1536 sc1
    buffer_load_dwordx2 v[54:55], v62, s[40:43], s74 offen offset:1536 sc1
    v_lshlrev_b32 v57, 4, v0
    v_lshlrev_b32 v58, 3, v0
    s_mul_i32 s57, s30, 6144
    s_add_u32 s57, s57, 30720
    v_lshrrev_b32 v59, 2, v0
    v_lshlrev_b32 v59, 6, v59
    v_bfe_u32 v53, v0, 4, 1
    v_lshl_add_u32 v59, v53, 5, v59
    v_and_b32 v53, 3, v0
    v_lshl_add_u32 v59, v53, 3, v59
    v_add_u32 v59, s57, v59
    v_xor_b32 v60, 32, v59
    s_lshl_b32 s57, s30, 8
    s_add_u32 s57, s57, 157696
    v_lshl_add_u32 v61, v0, 2, s57
    ds_read_b64_tr_b16 v[28:29], v59 offset:0
    ds_read_b64_tr_b16 v[30:31], v59 offset:1024
    ds_read_b64_tr_b16 v[32:33], v59 offset:2048
    ds_read_b64_tr_b16 v[34:35], v59 offset:3072
    ds_read_b64_tr_b16 v[36:37], v59 offset:4096
    ds_read_b64_tr_b16 v[38:39], v59 offset:5120
    ds_read_b64_tr_b16 v[40:41], v60 offset:0
    ds_read_b64_tr_b16 v[42:43], v60 offset:1024
    ds_read_b64_tr_b16 v[44:45], v60 offset:2048
    ds_read_b64_tr_b16 v[46:47], v60 offset:3072
    ds_read_b64_tr_b16 v[48:49], v60 offset:4096
    ds_read_b64_tr_b16 v[50:51], v60 offset:5120
    v_mov_b64 v[20:21], 0
    v_mov_b64 v[22:23], 0
    v_mov_b64 v[24:25], 0
    v_mov_b64 v[26:27], 0
    s_add_u32 s58, s6, 262144
    s_branch L_pw_211
L_pr_212:
    buffer_load_dword v52, v56, s[40:43], s74 offen offset:1536 sc1
    buffer_load_dwordx2 v[54:55], v62, s[40:43], s74 offen offset:1536 sc1
    s_sub_u32 s56, s56, 1
    s_cbranch_scc1 L_done
L_pw_211:
    s_waitcnt vmcnt(0)
    v_max3_u32 v53, v52, v54, v55
    v_cmp_eq_u32 vcc, -1, v53
    s_cbranch_vccnz L_pr_212
    buffer_load_dwordx4 v[12:15], v57, s[40:43], s74 offen sc1
    buffer_load_dwordx2 v[16:17], v58, s[40:43], s74 offen offset:1024 sc1
L_pad10:
    s_cbranch_execz L_pad14
    buffer_load_dword v18, v56, s[40:43], s74 offen offset:1568 sc1
    v_max_f32_dpp v53, v52, v52 row_ror:4 row_mask:0xf bank_mask:0xf
    s_nop 1
    v_max_f32_dpp v53, v53, v53 row_ror:2 row_mask:0xf bank_mask:0xf
    s_nop 1
    v_max_f32_dpp v53, v53, v53 row_ror:1 row_mask:0xf bank_mask:0xf
    v_sub_f32 v52, v52, v53
    v_sub_f32 v54, v54, v53
    v_sub_f32 v55, v55, v53
    v_exp_f32 v52, v52
    v_exp_f32 v54, v54
    v_exp_f32 v55, v55
    s_waitcnt lgkmcnt(0)
    s_branch L_pw_213
L_pr_214:
    buffer_load_dwordx4 v[12:15], v57, s[40:43], s74 offen sc1
    buffer_load_dwordx2 v[16:17], v58, s[40:43], s74 offen offset:1024 sc1
    buffer_load_dword v18, v56, s[40:43], s74 offen offset:1568 sc1
    s_sub_u32 s56, s56, 1
    s_cbranch_scc1 L_done
L_pw_213:
    s_waitcnt vmcnt(0)
    v_max3_u32 v19, v12, v13, v14
    v_max3_u32 v19, v19, v15, v16
    v_max3_u32 v19, v19, v17, v18
    v_cmp_eq_u32 vcc, -1, v19
    s_cbranch_vccnz L_pr_214
    v_smfmac_f32_16x16x64_bf16 v[20:23], v[12:15], v[28:35], v1
    v_mul_f32 v52, v52, v18
    v_smfmac_f32_16x16x64_bf16 v[24:27], v[12:15], v[40:47], v1
    v_smfmac_f32_16x16x32_bf16 v[20:23], v[16:17], v[36:39], v1
    v_add_f32_dpp v52, v52, v52 row_ror:4 row_mask:0xf bank_mask:0xf
    v_smfmac_f32_16x16x32_bf16 v[24:27], v[16:17], v[48:51], v1
    s_cmp_eq_u32 s30, 2
    v_add_f32_dpp v52, v52, v52 row_ror:2 row_mask:0xf bank_mask:0xf
    s_nop 1
    v_add_f32_dpp v52, v52, v52 row_ror:1 row_mask:0xf bank_mask:0xf
    v_rcp_f32 v52, v52
    v_pk_add_f32 v[20:21], v[20:21], v[22:23]
    s_nop 0
    v_pk_add_f32 v[24:25], v[24:25], v[26:27]
    v_pk_mul_f32 v[54:55], v[54:55], v[52:53] op_sel:[0,0] op_sel_hi:[1,0]
    v_mul_f32 v20, v20, v54
    v_mul_f32 v24, v24, v54
    v_fmac_f32 v20, v21, v55
    v_fmac_f32 v24, v25, v55
    s_nop 1
    v_permlane32_swap_b32 v20, v24
    v_add_f32 v20, v20, v24
    ds_write_b32 v61, v20
    s_waitcnt lgkmcnt(0)
    s_barrier
    s_cbranch_scc0 L_finb_215
    ds_read2st64_b32 v[12:13], v2 offset0:0 offset1:1
    ds_read2st64_b32 v[14:15], v2 offset0:2 offset1:3
    ds_read2st64_b32 v[16:17], v2 offset0:4 offset1:5
    ds_read2st64_b32 v[18:19], v2 offset0:6 offset1:7
    s_waitcnt lgkmcnt(2)
    v_pk_add_f32 v[12:13], v[12:13], v[14:15]
    s_waitcnt lgkmcnt(0)
    v_pk_add_f32 v[16:17], v[16:17], v[18:19]
    v_pk_add_f32 v[12:13], v[12:13], v[16:17]
    v_add_f32 v14, v12, v13
    v_add_f32 v15, v12, v13
    s_nop 1
    v_permlane16_swap_b32 v14, v15
    v_add_f32 v12, v14, v15
    v_min_u32 v12, -2, v12
    buffer_store_dword v12, v3, s[40:43], s58 offen sc1
L_finb_215:
    s_sub_u32 s57, s30, 4
    s_cmp_lt_u32 s57, 3
    s_cbranch_scc0 L_skip_216
    s_sub_u32 s60, s30, 4
    s_lshl_b32 s59, s60, 12
    s_add_u32 s59, s59, 79872
    s_lshl_b32 s57, s60, 11
    v_lshlrev_b32 v11, 4, v0
    v_add_u32 v11, s57, v11
    s_add_u32 s58, s62, 19456
    buffer_load_dwordx4 v[12:15], v11, s[40:43], s58 offen offset:0 sc1
    buffer_load_dwordx4 v[16:19], v11, s[40:43], s58 offen offset:1024 sc1
    v_lshrrev_b32 v35, 4, v0
    v_lshlrev_b32 v35, 9, v35
    v_bfe_u32 v60, v0, 2, 2
    v_lshl_add_u32 v35, v60, 6, v35
    v_and_b32 v60, 3, v0
    v_lshl_add_u32 v35, v60, 3, v35
    v_add_u32 v35, s59, v35
    s_waitcnt vmcnt(0)
L_sw_217:
    v_max3_u32 v60, v12, v13, v14
    v_max3_u32 v60, v60, v15, v16
L_pad11:
    s_cbranch_execz L_pad15
    v_max3_u32 v60, v60, v17, v18
    v_max_u32 v60, v60, v19
    v_cmp_eq_u32 vcc, -1, v60
    s_cbranch_vccnz L_sr_218
    v_pk_add_f32 v[20:21], v[12:13], v[14:15]
    v_pk_add_f32 v[22:23], v[16:17], v[18:19]
    v_pk_add_f32 v[20:21], v[20:21], v[22:23]
    v_add_f32 v8, v20, v21
    v_mov_b64 v[52:53], 0
    v_mov_b64 v[54:55], 0
    v_mov_b64 v[56:57], 0
    v_mov_b64 v[58:59], 0
    v_mov_b32 v9, 0xbdd2d3e8
    v_mov_b32 v10, 0xc0135761
    s_lshl_b32 s57, s60, 7
    s_add_u32 s57, s57, 160256
    v_lshlrev_b32 v32, 3, v0
    v_add_u32 v32, s57, v32
    v_lshlrev_b32 v33, 3, v0
    v_add_u32 v33, 129024, v33
    v_cmp_gt_u32 vcc, 16, v0
    s_nop 1
    v_cndmask_b32 v32, v33, v32, vcc
    v_and_b32 v33, 15, v0
    v_lshlrev_b32 v33, 3, v33
    v_lshrrev_b32 v60, 5, v0
    v_lshl_add_u32 v33, v60, 2, v33
    v_add_u32 v33, 160256, v33
    v_and_b32 v34, 15, v0
    v_lshlrev_b32 v34, 2, v34
    v_lshrrev_b32 v60, 5, v0
    v_lshl_add_u32 v34, v60, 6, v34
    v_bfe_u32 v60, v0, 4, 1
    v_lshl_add_u32 v34, v60, 13, v34
    s_add_u32 s60, s6, 393216
    s_add_u32 s59, s60, 16384
    s_lshl_b32 s74, s3, 2
    s_add_u32 s74, s74, s62
    s_add_u32 s74, s74, 26368
    s_xor_b32 s75, s30, 4
    v_add_u32 v5, s75, v0
    v_lshlrev_b32 v5, 24, v5
    s_add_u32 s58, s62, 40320
    s_add_u32 s57, s62, 25984
    v_and_b32 v7, 7, v0
    v_lshlrev_b32 v7, 3, v7
    buffer_load_dwordx2 v[24:25], v7, s[40:43], s57 offen sc1
    buffer_load_dwordx4 v[12:15], v11, s[40:43], s58 offen offset:0 sc1
    buffer_load_dwordx4 v[16:19], v11, s[40:43], s58 offen offset:1024 sc1
    ds_read_b64_tr_b16 v[36:37], v35 offset:0
    ds_read_b64_tr_b16 v[38:39], v35 offset:256
    ds_read_b64_tr_b16 v[40:41], v35 offset:2048
    ds_read_b64_tr_b16 v[42:43], v35 offset:2304
    ds_read_b64_tr_b16 v[44:45], v35 offset:32
    ds_read_b64_tr_b16 v[46:47], v35 offset:288
    ds_read_b64_tr_b16 v[48:49], v35 offset:2080
    ds_read_b64_tr_b16 v[50:51], v35 offset:2336
    s_waitcnt lgkmcnt(0)
L_pr_220:
    buffer_load_dwordx2 v[24:25], v7, s[40:43], s57 offen sc1
    buffer_load_dwordx4 v[12:15], v11, s[40:43], s58 offen offset:0 sc1
    buffer_load_dwordx4 v[16:19], v11, s[40:43], s58 offen offset:1024 sc1
    s_sub_u32 s56, s56, 1
    s_cbranch_scc1 L_done
L_pw_219:
    s_waitcnt vmcnt(5)
    v_max_u32 v26, v24, v25
    v_cmp_eq_u32 vcc, -1, v26
    s_cbranch_vccnz L_pr_220
    buffer_load_dwordx4 v[12:15], v11, s[40:43], s58 offen offset:0 sc1
    buffer_load_dwordx4 v[16:19], v11, s[40:43], s58 offen offset:1024 sc1
    v_add_f32_dpp v2, v24, v24 row_ror:4 row_mask:0xf bank_mask:0xf
    v_add_f32_dpp v3, v25, v25 row_ror:4 row_mask:0xf bank_mask:0xf
    s_nop 0
    v_add_f32_dpp v2, v2, v2 row_ror:2 row_mask:0xf bank_mask:0xf
    v_add_f32_dpp v3, v3, v3 row_ror:2 row_mask:0xf bank_mask:0xf
    s_nop 0
    v_add_f32_dpp v2, v2, v2 row_ror:1 row_mask:0xf bank_mask:0xf
    v_add_f32_dpp v3, v3, v3 row_ror:1 row_mask:0xf bank_mask:0xf
    v_mul_f32 v2, 0x3acccccd, v2
    v_mul_f32 v3, 0x3acccccd, v3
    v_fma_f32 v3, -v2, v2, v3
    v_max_f32 v3, 0, v3
    v_add_f32 v3, 0x3727c5ac, v3
L_pad12:
    s_cbranch_execz L_pad16
    v_rsq_f32 v3, v3
    s_nop 0
    v_mul_f32 v2, v2, v3
    v_fma_f32 v8, -v2, v8, v4
    s_waitcnt vmcnt(5)
L_hw_221:
    v_pk_add_f32 v[20:21], v[12:13], v[14:15]
    v_pk_add_f32 v[22:23], v[16:17], v[18:19]
    v_pk_add_f32 v[20:21], v[20:21], v[22:23]
    v_add_f32 v20, v20, v21
    v_cmp_u_f32 vcc, v20, v20
    v_fma_f32 v20, v20, v3, v8
    s_cbranch_vccnz L_hr_222
L_hk_223:
    v_mul_f32 v21, v20, v20
    v_fma_f32 v21, v21, v9, v10
    v_mul_f32 v21, v21, v20
    v_exp_f32 v21, v21
    s_cmp_eq_u32 s55, 0
    v_add_f32 v21, 1.0, v21
    v_rcp_f32 v21, v21
    s_nop 0
    v_mul_f32 v20, v20, v21
    s_nop 1
    v_mov_b32_dpp v21, v20 row_shl:1 row_mask:0xf bank_mask:0xf bound_ctrl:0
    v_cvt_pk_bf16_f32 v28, v20, v21
    s_nop 1
    v_mov_b32_dpp v29, v28 row_shl:4 row_mask:0xf bank_mask:0xf bound_ctrl:0
    v_mov_b32_dpp v30, v28 row_shl:8 row_mask:0xf bank_mask:0xf bound_ctrl:0
    v_mov_b32_dpp v31, v28 row_shl:12 row_mask:0xf bank_mask:0xf bound_ctrl:0
    s_nop 1
    v_smfmac_f32_16x16x64_bf16 v[52:55], v[28:31], v[36:43], v1
    v_smfmac_f32_16x16x64_bf16 v[56:59], v[28:31], v[44:51], v1
    s_nop 6
    v_add_f32 v22, v52, v54
    v_add_f32 v23, v56, v58
    ds_write_b64 v32, v[22:23]
    s_cmp_eq_u32 s30, 4
    s_cbranch_scc0 L_skip_225
L_xw_226:
    ds_read2_b32 v[20:21], v33 offset0:0 offset1:32
    ds_read_b32 v22, v33 offset:256
    s_cmp_eq_u32 s55, 0
    s_waitcnt lgkmcnt(0)
    v_max3_u32 v23, v20, v21, v22
    v_add_f32 v20, v20, v21
    v_cmp_eq_u32 vcc, -1, v23
    v_add_f32 v20, v20, v22
    s_cbranch_vccnz L_xr_227
    v_min_u32 v20, -2, v20
    buffer_store_dword v20, v34, s[40:43], s60 offen sc1
L_skip_225:
L_skip_216:
    s_branch L_done
L_typeB_1:
    s_cmp_eq_u32 s53, 3
    s_cbranch_scc0 L_typeC_228
    s_cmp_eq_u32 s30, 7
    s_cbranch_scc1 L_w7_233
    s_cmp_lt_u32 s30, 6
    s_cbranch_scc0 L_skip_235
    s_lshr_b32 s57, s30, 1
    s_mul_i32 s57, s57, 128
    s_and_b32 s58, s30, 1
    s_lshl_b32 s58, s58, 6
    s_add_u32 s57, s57, s58
    v_lshrrev_b32 v18, 5, v0
    v_lshlrev_b32 v18, 13, v18
    v_bfe_u32 v60, v0, 3, 1
    v_lshl_add_u32 v18, v60, 12, v18
    v_bfe_u32 v60, v0, 4, 1
    v_lshl_add_u32 v18, v60, 11, v18
    v_bfe_u32 v60, v0, 2, 1
    v_mul_u32_u24 v60, 384, v60
    v_add_u32 v18, v60, v18
    v_and_b32 v60, 3, v0
    v_lshl_add_u32 v18, v60, 3, v18
    v_add_u32 v18, s57, v18
    v_add_u32 v18, 30720, v18
    v_bfe_u32 v19, v0, 4, 1
    v_lshlrev_b32 v19, 12, v19
    v_bfe_u32 v60, v0, 3, 1
    v_lshl_add_u32 v19, v60, 11, v19
    v_bfe_u32 v60, v0, 2, 1
    v_mul_u32_u24 v60, 384, v60
    v_add_u32 v19, v60, v19
    v_and_b32 v60, 3, v0
    v_lshl_add_u32 v19, v60, 3, v19
    v_add_u32 v19, s57, v19
    v_add_u32 v19, 63488, v19
    ds_read_b64_tr_b16 v[28:29], v18 offset:0
    ds_read_b64_tr_b16 v[30:31], v18 offset:1024
    ds_read_b64_tr_b16 v[32:33], v18 offset:16384
    ds_read_b64_tr_b16 v[34:35], v18 offset:17408
    ds_read_b64_tr_b16 v[36:37], v19 offset:0
L_pad13:
    s_cbranch_execz L_pad17
    ds_read_b64_tr_b16 v[38:39], v19 offset:1024
    ds_read_b64_tr_b16 v[40:41], v18 offset:32
    ds_read_b64_tr_b16 v[42:43], v18 offset:1056
    ds_read_b64_tr_b16 v[44:45], v18 offset:16416
    ds_read_b64_tr_b16 v[46:47], v18 offset:17440
    ds_read_b64_tr_b16 v[48:49], v19 offset:32
    ds_read_b64_tr_b16 v[50:51], v19 offset:1056
    v_lshrrev_b32 v9, 4, v0
    v_lshlrev_b32 v9, 5, v9
    v_bfe_u32 v60, v0, 1, 1
    v_lshl_add_u32 v9, v60, 4, v9
    v_and_b32 v60, 1, v0
    v_mul_u32_u24 v60, 192, v60
    v_add_u32 v9, v60, v9
    v_add_u32 v9, 160832, v9
    v_lshrrev_b32 v10, 4, v0
    v_lshlrev_b32 v10, 4, v10
    v_bfe_u32 v60, v0, 1, 1
    v_lshl_add_u32 v10, v60, 3, v10
    v_and_b32 v60, 1, v0
    v_mul_u32_u24 v60, 192, v60
    v_add_u32 v10, v60, v10
    v_add_u32 v10, 160960, v10
    v_mov_b64 v[20:21], 0
    v_mov_b64 v[22:23], 0
    v_mov_b64 v[24:25], 0
    v_mov_b64 v[26:27], 0
    s_lshr_b32 s57, s30, 1
    s_lshl_b32 s57, s57, 11
    s_and_b32 s58, s30, 1
    s_lshl_b32 s58, s58, 9
    s_add_u32 s57, s57, s58
    s_lshr_b32 s58, s54, 2
    s_lshl_b32 s58, s58, 10
    s_add_u32 s57, s57, s58
    s_and_b32 s58, s54, 3
    s_lshl_b32 s58, s58, 2
    s_add_u32 s57, s57, s58
    v_and_b32 v11, 31, v0
    v_lshlrev_b32 v11, 4, v11
    v_lshrrev_b32 v60, 5, v0
    v_lshl_add_u32 v11, v60, 30, v11
    v_add_u32 v11, s57, v11
    s_add_u32 s59, s62, 40320
    s_add_u32 s60, s62, 25984
L_skip_235:
    s_cmp_lt_u32 s30, 6
    s_barrier
    s_cbranch_scc0 L_se_234
    ds_read_b128 v[12:15], v9
    ds_read_b64 v[16:17], v10
    s_waitcnt lgkmcnt(1)
    v_smfmac_f32_16x16x64_bf16 v[20:23], v[12:15], v[28:35], v1
    v_smfmac_f32_16x16x64_bf16 v[24:27], v[12:15], v[40:47], v1
    s_waitcnt lgkmcnt(0)
    v_smfmac_f32_16x16x32_bf16 v[20:23], v[16:17], v[36:39], v1
    v_smfmac_f32_16x16x32_bf16 v[24:27], v[16:17], v[48:51], v1
    s_cmp_eq_u32 s55, 0
    s_nop 5
    v_add_f32 v12, v20, v22
    s_nop 1
    v_add_f32_dpp v12, v24, v26 quad_perm:[0,1,2,3] row_mask:0x2 bank_mask:0xf
    v_min_u32 v12, -2, v12
    s_cbranch_scc1 L_gs_236
    buffer_store_dword v12, v11, s[40:43], s59 offen
L_gb_237:
L_se_234:
    s_cmp_eq_u32 s30, 7
    s_cbranch_scc0 L_done
    s_cmp_eq_u32 s31, 0
    s_cbranch_scc0 L_done
    v_lshlrev_b32 v60, 16, v4
    v_add_f32 v2, v2, v60
    v_and_b32 v60, 0xffff0000, v4
    v_add_f32 v3, v3, v60
    v_and_b32 v60, 31, v0
    v_min_u32 v60, 19, v60
    s_mul_i32 s57, s54, 160
    v_lshrrev_b32 v7, 5, v0
    v_lshlrev_b32 v7, 2, v7
    v_add_u32 v7, s57, v7
    v_lshl_add_u32 v7, v60, 3, v7
    s_add_u32 s57, s7, 393216
    s_add_u32 s58, s7, 425984
    s_add_u32 s59, s7, 458752
    s_add_u32 s60, s7, 491520
    s_add_u32 s75, s7, 7180
    v_and_b32 v9, 7, v0
    v_lshlrev_b32 v9, 15, v9
    buffer_load_dword v12, v9, s[40:43], s75 offen sc1
    s_sleep 2
L_pr_249:
    buffer_load_dword v12, v9, s[40:43], s75 offen sc1
    s_sub_u32 s56, s56, 1
L_pad14:
    s_cbranch_execz L_pad18
    s_cbranch_scc1 L_done
L_pw_248:
    s_waitcnt vmcnt(1)
    v_cmp_eq_u32 vcc, -1, v12
    s_cbranch_vccnz L_pr_249
    s_sleep 3
    buffer_load_dwordx4 v[12:15], v5, s[40:43], s57 offen sc1
    buffer_load_dwordx4 v[16:19], v5, s[40:43], s58 offen sc1
    buffer_load_dwordx4 v[20:23], v5, s[40:43], s59 offen sc1
    buffer_load_dwordx4 v[24:27], v5, s[40:43], s60 offen sc1
    s_sleep 2
L_gw_245:
    buffer_load_dwordx4 v[12:15], v5, s[40:43], s57 offen sc1
    buffer_load_dwordx4 v[16:19], v5, s[40:43], s58 offen sc1
    buffer_load_dwordx4 v[20:23], v5, s[40:43], s59 offen sc1
    buffer_load_dwordx4 v[24:27], v5, s[40:43], s60 offen sc1
    s_sub_u32 s56, s56, 1
    s_cbranch_scc1 L_done
    s_and_b32 s74, s56, 31
    s_waitcnt vmcnt(6)
    v_pk_add_f32 v[28:29], v[12:13], v[16:17]
    v_pk_add_f32 v[30:31], v[14:15], v[18:19]
    s_waitcnt vmcnt(5)
    v_pk_add_f32 v[28:29], v[28:29], v[20:21]
    v_pk_add_f32 v[30:31], v[30:31], v[22:23]
    s_waitcnt vmcnt(4)
    v_pk_add_f32 v[28:29], v[28:29], v[24:25]
    v_pk_add_f32 v[30:31], v[30:31], v[26:27]
    v_pk_add_f32 v[32:33], v[28:29], v[30:31]
    v_cmp_u_f32 vcc, v32, v33
    v_permlane32_swap_b32 v28, v30
    v_permlane32_swap_b32 v29, v31
    s_cbranch_vccnz L_gr_246
L_gk_247:
    v_pk_add_f32 v[28:29], v[28:29], v[30:31]
    v_pk_add_f32 v[28:29], v[28:29], v[2:3]
    v_cvt_pk_bf16_f32 v28, v28, v29
    global_store_dword v7, v28, s[24:25]
    s_branch L_done
L_gs_39:
    buffer_store_dword v33, v34, s[40:43], s67 offen sc1
    s_branch L_gb_40
L_gs_42:
    buffer_store_short v12, v54, s[40:43], s59 offen sc1
    s_branch L_gb_43
L_cr_57:
    s_sub_u32 s56, s56, 1
    s_cbranch_scc1 L_done
    global_load_dword v2, v3, s[26:27] sc1
    s_waitcnt vmcnt(0)
    s_branch L_cw_56
L_far_58:
    s_lshl_b32 s57, s52, 2
    s_add_u32 s57, s57, s72
    s_mov_b64 exec, 1
    buffer_store_dword v25, v0, s[40:43], s57 offen offset:128 sc1
    s_mov_b64 exec, -1
    s_branch L_fb_59
L_cr_75:
    s_sub_u32 s56, s56, 1
    s_cbranch_scc1 L_done
    buffer_load_dword v2, v24, s[40:43], s72 offen sc1
    s_branch L_cw_74
L_gs_83:
    buffer_store_dword v33, v34, s[40:43], s67 offen sc1
    s_branch L_gb_84
L_gs_86:
    buffer_store_short v12, v54, s[40:43], s59 offen sc1
    s_branch L_gb_87
L_gs_111:
    buffer_store_dword v37, v4, s[40:43], s58 offen sc1
    s_branch L_gb_112
L_cr_123:
    s_sub_u32 s56, s56, 1
    s_cbranch_scc1 L_done
    global_load_dword v2, v3, s[26:27] offset:4 sc1
    s_branch L_cw_122
L_cr_133:
    buffer_load_dword v52, v56, s[40:43], s74 offen offset:1536 sc1
    buffer_load_dwordx2 v[54:55], v62, s[40:43], s74 offen offset:1536 sc1
    s_sub_u32 s56, s56, 1
    s_cbranch_scc1 L_done
    s_branch L_cw_132
L_gs_138:
    buffer_store_dword v14, v3, s[40:43], s57 offen sc1
    s_branch L_gb_139
L_gs_140:
    buffer_store_dword v12, v4, s[40:43], s57 offen offset:32 sc1
    s_branch L_gb_141
L_comb_0:
    s_mov_b32 s57, 0
    s_cmp_eq_u32 s55, 0
    s_waitcnt lgkmcnt(0)
    s_barrier
    ds_read2st64_b64 v[12:15], v2 offset0:0 offset1:4
    ds_read2st64_b64 v[16:19], v2 offset0:8 offset1:12
    ds_read2st64_b64 v[20:23], v2 offset0:16 offset1:20
    ds_read2st64_b64 v[24:27], v2 offset0:24 offset1:28
    s_waitcnt lgkmcnt(2)
    v_pk_add_f32 v[12:13], v[12:13], v[14:15]
    v_pk_add_f32 v[16:17], v[16:17], v[18:19]
    v_pk_add_f32 v[12:13], v[12:13], v[16:17]
    s_waitcnt lgkmcnt(0)
    v_pk_add_f32 v[20:21], v[20:21], v[22:23]
L_pad15:
    s_cbranch_execz L_pad19
    v_pk_add_f32 v[24:25], v[24:25], v[26:27]
    v_pk_add_f32 v[12:13], v[12:13], v[20:21]
    v_pk_add_f32 v[12:13], v[12:13], v[24:25]
    v_cvt_pk_bf16_f32 v14, v12, v13
    v_min_u32 v12, -2, v12
    v_min_u32 v14, -2, v14
    s_cbranch_scc1 L_gs_138
    buffer_store_dword v14, v3, s[40:43], s57 offen
L_gb_139:
    s_cbranch_scc1 L_gs_140
    buffer_store_dword v12, v4, s[40:43], s57 offen offset:32
L_gb_141:
    s_branch L_comb_0b
L_sr_148:
    buffer_load_dwordx4 v[12:15], v11, s[40:43], s58 offen offset:0 sc1
    buffer_load_dwordx4 v[16:19], v11, s[40:43], s58 offen offset:1024 sc1
    s_sub_u32 s56, s56, 1
    s_cbranch_scc1 L_done
    s_waitcnt vmcnt(0)
    s_branch L_sw_147
L_hr_152:
    s_sub_u32 s56, s56, 1
    s_cbranch_scc1 L_done
    s_and_b32 s64, s56, 15
    s_cbranch_scc1 L_ha_154
    s_waitcnt vmcnt(0)
    v_max3_u32 v21, v12, v13, v14
    v_max3_u32 v21, v21, v15, v16
    v_max3_u32 v21, v21, v17, v18
    v_max_u32 v21, v21, v19
    v_cmp_eq_u32 vcc, -1, v21
    s_cbranch_vccnz L_ha_154
    v_pk_add_f32 v[20:21], v[12:13], v[14:15]
    v_pk_add_f32 v[22:23], v[16:17], v[18:19]
    v_pk_add_f32 v[20:21], v[20:21], v[22:23]
    v_add_f32 v20, v20, v21
    v_fma_f32 v20, v20, v3, v8
    s_branch L_hk_153
L_ha_154:
    buffer_load_dwordx4 v[12:15], v11, s[40:43], s58 offen offset:0 sc1
    buffer_load_dwordx4 v[16:19], v11, s[40:43], s58 offen offset:1024 sc1
    s_waitcnt vmcnt(2)
    s_branch L_hw_151
L_xr_157:
    s_sub_u32 s56, s56, 1
    s_cbranch_scc1 L_done
    s_branch L_xw_156
L_typeC_159:
    s_cmp_eq_u32 s30, 6
    s_cbranch_scc0 L_p1
    s_cmp_eq_u32 s3, 20
    s_cbranch_scc0 L_p1
    s_lshl_b32 s59, s31, 15
    s_add_u32 s59, s59, s8
    s_add_u32 s59, s59, 7168
    v_and_b32 v10, 1, v0
    v_lshlrev_b32 v10, 13, v10
    v_lshrrev_b32 v60, 1, v0
    v_lshl_add_u32 v10, v60, 24, v10
    s_add_u32 s58, s62, 1568
    v_lshrrev_b32 v9, 3, v0
    v_mul_u32_u24 v9, 1664, v9
    v_and_b32 v60, 7, v0
    v_lshl_add_u32 v9, v60, 2, v9
    buffer_load_dword v12, v9, s[40:43], s58 offen sc1
    s_sleep 2
L_pr_161:
    buffer_load_dword v12, v9, s[40:43], s58 offen sc1
    s_sub_u32 s56, s56, 1
    s_cbranch_scc1 L_done
L_pw_160:
    s_waitcnt vmcnt(1)
    v_cmp_eq_u32 vcc, -1, v12
    s_cbranch_vccnz L_pr_161
    buffer_store_dword v0, v10, s[40:43], s59 offen offset:0 sc1
    s_add_u32 s58, s62, 25856
    v_and_b32 v9, 15, v0
    v_lshlrev_b32 v9, 2, v9
    buffer_load_dword v13, v9, s[40:43], s58 offen sc1
    s_sleep 2
L_pr_163:
    buffer_load_dword v13, v9, s[40:43], s58 offen sc1
    s_sub_u32 s56, s56, 1
    s_cbranch_scc1 L_done
L_pw_162:
    s_waitcnt vmcnt(1)
    v_cmp_eq_u32 vcc, -1, v13
    s_cbranch_vccnz L_pr_163
    buffer_store_dword v0, v10, s[40:43], s59 offen offset:4 sc1
    s_waitcnt vmcnt(1)
    s_branch L_p1
L_gs_167:
    buffer_store_dword v12, v11, s[40:43], s60 offen sc1
    s_branch L_gb_168
L_gs_169:
    buffer_store_dword v12, v11, s[40:43], s59 offen sc1
    s_branch L_gb_170
L_gr_172:
    s_cbranch_scc1 L_gw_171
    s_waitcnt vmcnt(0)
    v_max3_u32 v32, v12, v13, v14
    v_max3_u32 v32, v32, v15, v16
    v_max3_u32 v32, v32, v17, v18
    v_max3_u32 v32, v32, v19, v20
    v_max3_u32 v32, v32, v21, v22
L_pad16:
    s_cbranch_execz L_pad20
    v_max3_u32 v32, v32, v23, v24
    v_max3_u32 v32, v32, v25, v26
    v_max_u32 v32, v32, v27
    v_cmp_eq_u32 vcc, -1, v32
    s_cbranch_vccnz L_gw_171
    v_pk_add_f32 v[28:29], v[12:13], v[16:17]
    v_pk_add_f32 v[30:31], v[14:15], v[18:19]
    v_pk_add_f32 v[28:29], v[28:29], v[20:21]
    v_pk_add_f32 v[30:31], v[30:31], v[22:23]
    v_pk_add_f32 v[28:29], v[28:29], v[24:25]
    v_pk_add_f32 v[30:31], v[30:31], v[26:27]
    s_nop 1
    v_permlane32_swap_b32 v28, v30
    v_permlane32_swap_b32 v29, v31
    s_branch L_gk_173
L_gs_176:
    buffer_store_dword v33, v34, s[40:43], s67 offen sc1
    s_branch L_gb_177
L_w7_164:
    v_and_b32 v60, 31, v0
    v_min_u32 v60, 19, v60
    s_mul_i32 s57, s54, 320
    v_lshrrev_b32 v5, 5, v0
    v_mul_u32_u24 v5, 2560, v5
    v_add_u32 v5, s57, v5
    v_lshl_add_u32 v5, v60, 4, v5
    v_and_b32 v60, 31, v0
    v_cmp_gt_u32 s[64:65], 20, v60
    v_min_u32 v60, 19, v60
    v_lshrrev_b32 v35, 5, v0
    v_lshlrev_b32 v35, 2, v35
    v_add_u32 v35, 160832, v35
    v_lshl_add_u32 v35, v60, 3, v35
    s_add_u32 s66, s62, 13312
    s_add_u32 s67, s62, 25856
    s_lshl_b32 s57, s54, 3
    v_lshrrev_b32 v34, 5, v0
    v_lshlrev_b32 v34, 2, v34
    v_add_u32 v34, s57, v34
    v_and_b32 v60, 31, v0
    v_mov_b32 v61, 0x7f000000
    v_cmp_ne_u32 vcc, 31, v60
    s_nop 1
    v_cndmask_b32 v34, v34, v61, vcc
    v_mov_b32 v61, 0x3f803f80
    s_add_u32 s57, s7, 0
    s_add_u32 s58, s7, 32768
    s_add_u32 s59, s7, 65536
    s_add_u32 s60, s7, 98304
    s_add_u32 s75, s7, 7168
    v_and_b32 v9, 7, v0
    v_lshlrev_b32 v9, 15, v9
    buffer_load_dword v12, v9, s[40:43], s75 offen sc1
    s_sleep 2
L_pr_175:
    buffer_load_dword v12, v9, s[40:43], s75 offen sc1
    s_sub_u32 s56, s56, 1
    s_cbranch_scc1 L_done
L_pw_174:
    s_waitcnt vmcnt(1)
    v_cmp_eq_u32 vcc, -1, v12
    s_cbranch_vccnz L_pr_175
    s_sleep 2
    buffer_load_dwordx4 v[12:15], v5, s[40:43], s57 offen sc1
    buffer_load_dwordx4 v[16:19], v5, s[40:43], s58 offen sc1
    buffer_load_dwordx4 v[20:23], v5, s[40:43], s59 offen sc1
    buffer_load_dwordx4 v[24:27], v5, s[40:43], s60 offen sc1
    s_sleep 2
L_gw_171:
    buffer_load_dwordx4 v[12:15], v5, s[40:43], s57 offen sc1
    buffer_load_dwordx4 v[16:19], v5, s[40:43], s58 offen sc1
    buffer_load_dwordx4 v[20:23], v5, s[40:43], s59 offen sc1
    buffer_load_dwordx4 v[24:27], v5, s[40:43], s60 offen sc1
    s_sub_u32 s56, s56, 1
    s_cbranch_scc1 L_done
    s_and_b32 s74, s56, 31
    s_waitcnt vmcnt(6)
    v_pk_add_f32 v[28:29], v[12:13], v[16:17]
    v_pk_add_f32 v[30:31], v[14:15], v[18:19]
    s_waitcnt vmcnt(5)
    v_pk_add_f32 v[28:29], v[28:29], v[20:21]
    v_pk_add_f32 v[30:31], v[30:31], v[22:23]
    s_waitcnt vmcnt(4)
    v_pk_add_f32 v[28:29], v[28:29], v[24:25]
    v_pk_add_f32 v[30:31], v[30:31], v[26:27]
    v_pk_add_f32 v[32:33], v[28:29], v[30:31]
    v_cmp_u_f32 vcc, v32, v33
    v_permlane32_swap_b32 v28, v30
    v_permlane32_swap_b32 v29, v31
    s_cbranch_vccnz L_gr_172
L_gk_173:
    v_pk_add_f32 v[28:29], v[28:29], v[30:31]
L_pad17:
    s_cbranch_execz L_pad21
    v_pk_add_f32 v[28:29], v[28:29], v[2:3]
    v_cvt_pk_bf16_f32 v28, v28, v29
    ds_write_b32 v35, v28
    s_waitcnt lgkmcnt(0)
    s_barrier
    v_cndmask_b32 v29, 0, v28, s[64:65]
    v_dot2_f32_bf16 v33, v29, v61, 0
    v_dot2_f32_bf16 v32, v29, v29, 0
    v_lshlrev_b32 v2, 16, v28
    v_and_b32 v3, 0xffff0000, v28
    s_cmp_eq_u32 s55, 0
    v_permlane32_swap_b32 v33, v32
    v_add_f32 v33, v33, v32
    s_nop 1
    v_add_f32_dpp v33, v33, v33 row_ror:8 row_mask:0xf bank_mask:0xf
    s_nop 1
    v_add_f32_dpp v33, v33, v33 row_ror:4 row_mask:0xf bank_mask:0xf
    s_nop 1
    v_add_f32_dpp v33, v33, v33 row_ror:2 row_mask:0xf bank_mask:0xf
    s_nop 1
    v_add_f32_dpp v33, v33, v33 row_ror:1 row_mask:0xf bank_mask:0xf
    s_nop 1
    v_add_f32_dpp v33, v33, v33 row_bcast:15 row_mask:0xa bank_mask:0xf
    v_min_u32 v33, -2, v33
    s_cbranch_scc1 L_gs_176
    buffer_store_dword v33, v34, s[40:43], s67 offen
L_gb_177:
    s_waitcnt vmcnt(1)
    s_branch L_se_165
L_gs_181:
    buffer_store_short v12, v11, s[40:43], s59 offen sc1
    s_branch L_gb_182
L_gr_187:
    s_cbranch_scc1 L_gw_186
    s_waitcnt vmcnt(0)
    v_max3_u32 v32, v12, v13, v14
    v_max3_u32 v32, v32, v15, v16
    v_max3_u32 v32, v32, v17, v18
    v_max3_u32 v32, v32, v19, v20
    v_max3_u32 v32, v32, v21, v22
    v_max3_u32 v32, v32, v23, v24
    v_max3_u32 v32, v32, v25, v26
    v_max_u32 v32, v32, v27
    v_cmp_eq_u32 vcc, -1, v32
    s_cbranch_vccnz L_gw_186
    v_pk_add_f32 v[28:29], v[12:13], v[16:17]
    v_pk_add_f32 v[30:31], v[14:15], v[18:19]
    v_pk_add_f32 v[28:29], v[28:29], v[20:21]
    v_pk_add_f32 v[30:31], v[30:31], v[22:23]
    v_pk_add_f32 v[28:29], v[28:29], v[24:25]
    v_pk_add_f32 v[30:31], v[30:31], v[26:27]
    s_nop 1
    v_permlane32_swap_b32 v28, v30
    v_permlane32_swap_b32 v29, v31
    s_branch L_gk_188
L_gr_190:
    s_cbranch_scc1 L_gw_189
    s_waitcnt vmcnt(0)
    v_max3_u32 v32, v12, v13, v14
    v_max3_u32 v32, v32, v15, v16
    v_max3_u32 v32, v32, v17, v18
    v_max3_u32 v32, v32, v19, v20
    v_max3_u32 v32, v32, v21, v22
    v_max3_u32 v32, v32, v23, v24
    v_max3_u32 v32, v32, v25, v26
    v_max_u32 v32, v32, v27
    v_cmp_eq_u32 vcc, -1, v32
    s_cbranch_vccnz L_gw_189
    v_pk_add_f32 v[28:29], v[12:13], v[16:17]
    v_pk_add_f32 v[30:31], v[14:15], v[18:19]
    v_pk_add_f32 v[28:29], v[28:29], v[20:21]
    v_pk_add_f32 v[30:31], v[30:31], v[22:23]
    v_pk_add_f32 v[28:29], v[28:29], v[24:25]
    v_pk_add_f32 v[30:31], v[30:31], v[26:27]
    s_nop 1
    v_permlane32_swap_b32 v28, v30
    v_permlane32_swap_b32 v29, v31
    s_branch L_gk_191
L_gs_194:
    buffer_store_dword v33, v34, s[40:43], s67 offen sc1
    s_branch L_gb_195
L_w7_178:
    v_and_b32 v60, 31, v0
    v_min_u32 v60, 19, v60
    s_mul_i32 s57, s54, 320
    v_lshrrev_b32 v5, 5, v0
    v_mul_u32_u24 v5, 2560, v5
    v_add_u32 v5, s57, v5
    v_lshl_add_u32 v5, v60, 4, v5
L_pad18:
    s_cbranch_execz L_pad22
    v_and_b32 v60, 31, v0
    v_cmp_gt_u32 s[64:65], 20, v60
    v_min_u32 v60, 19, v60
    v_lshrrev_b32 v35, 5, v0
    v_lshlrev_b32 v35, 2, v35
    v_add_u32 v35, 160832, v35
    v_lshl_add_u32 v35, v60, 3, v35
    s_mul_i32 s66, s53, 3072
    s_add_u32 s66, s66, s62
    s_add_u32 s66, s66, 46464
    s_lshl_b32 s67, s53, 6
    s_add_u32 s67, s67, s62
    s_add_u32 s67, s67, 25600
    s_lshl_b32 s57, s54, 3
    v_lshrrev_b32 v34, 5, v0
    v_lshlrev_b32 v34, 2, v34
    v_add_u32 v34, s57, v34
    v_and_b32 v60, 31, v0
    v_mov_b32 v61, 0x7f000000
    v_cmp_ne_u32 vcc, 31, v60
    s_nop 1
    v_cndmask_b32 v34, v34, v61, vcc
    v_mov_b32 v61, 0x3f803f80
    s_cmp_lg_u32 s53, 3
    s_cbranch_scc0 L_skip_183
    s_add_u32 s57, s62, 25856
    v_mov_b32 v9, 0
L_pr_185:
    buffer_load_dword v12, v9, s[40:43], s57 offen sc1
    s_sub_u32 s56, s56, 1
    s_cbranch_scc1 L_done
L_pw_184:
    s_waitcnt vmcnt(0)
    v_cmp_eq_u32 vcc, -1, v12
    s_cbranch_vccnz L_pr_185
    s_add_u32 s57, s7, 0
    s_add_u32 s58, s7, 32768
    s_add_u32 s59, s7, 65536
    s_add_u32 s60, s7, 98304
L_gw_186:
    buffer_load_dwordx4 v[12:15], v5, s[40:43], s57 offen sc1
    buffer_load_dwordx4 v[16:19], v5, s[40:43], s58 offen sc1
    buffer_load_dwordx4 v[20:23], v5, s[40:43], s59 offen sc1
    buffer_load_dwordx4 v[24:27], v5, s[40:43], s60 offen sc1
    s_sub_u32 s56, s56, 1
    s_cbranch_scc1 L_done
    s_and_b32 s74, s56, 31
    s_waitcnt vmcnt(2)
    v_pk_add_f32 v[28:29], v[12:13], v[16:17]
    v_pk_add_f32 v[30:31], v[14:15], v[18:19]
    s_waitcnt vmcnt(1)
    v_pk_add_f32 v[28:29], v[28:29], v[20:21]
    v_pk_add_f32 v[30:31], v[30:31], v[22:23]
    s_waitcnt vmcnt(0)
    v_pk_add_f32 v[28:29], v[28:29], v[24:25]
    v_pk_add_f32 v[30:31], v[30:31], v[26:27]
    v_pk_add_f32 v[32:33], v[28:29], v[30:31]
    v_cmp_u_f32 vcc, v32, v33
    v_permlane32_swap_b32 v28, v30
    v_permlane32_swap_b32 v29, v31
    s_cbranch_vccnz L_gr_187
L_gk_188:
    v_pk_add_f32 v[28:29], v[28:29], v[30:31]
    v_pk_add_f32 v[28:29], v[28:29], v[2:3]
    v_cvt_pk_bf16_f32 v28, v28, v29
    v_lshlrev_b32 v2, 16, v28
    v_and_b32 v3, 0xffff0000, v28
L_skip_183:
    v_lshlrev_b32 v60, 16, v4
    v_add_f32 v2, v2, v60
    v_and_b32 v60, 0xffff0000, v4
    v_add_f32 v3, v3, v60
    s_add_u32 s57, s7, 131072
    s_add_u32 s58, s7, 163840
    s_add_u32 s59, s7, 196608
    s_add_u32 s60, s7, 229376
    s_add_u32 s75, s7, 7172
    v_and_b32 v9, 7, v0
    v_lshlrev_b32 v9, 15, v9
    buffer_load_dword v12, v9, s[40:43], s75 offen sc1
    s_sleep 2
L_pr_193:
    buffer_load_dword v12, v9, s[40:43], s75 offen sc1
    s_sub_u32 s56, s56, 1
    s_cbranch_scc1 L_done
L_pw_192:
    s_waitcnt vmcnt(1)
    v_cmp_eq_u32 vcc, -1, v12
    s_cbranch_vccnz L_pr_193
    s_sleep 5
    buffer_load_dwordx4 v[12:15], v5, s[40:43], s57 offen sc1
    buffer_load_dwordx4 v[16:19], v5, s[40:43], s58 offen sc1
    buffer_load_dwordx4 v[20:23], v5, s[40:43], s59 offen sc1
    buffer_load_dwordx4 v[24:27], v5, s[40:43], s60 offen sc1
L_pad19:
    s_cbranch_execz L_pad23
    s_sleep 2
L_gw_189:
    buffer_load_dwordx4 v[12:15], v5, s[40:43], s57 offen sc1
    buffer_load_dwordx4 v[16:19], v5, s[40:43], s58 offen sc1
    buffer_load_dwordx4 v[20:23], v5, s[40:43], s59 offen sc1
    buffer_load_dwordx4 v[24:27], v5, s[40:43], s60 offen sc1
    s_sub_u32 s56, s56, 1
    s_cbranch_scc1 L_done
    s_and_b32 s74, s56, 31
    s_waitcnt vmcnt(6)
    v_pk_add_f32 v[28:29], v[12:13], v[16:17]
    v_pk_add_f32 v[30:31], v[14:15], v[18:19]
    s_waitcnt vmcnt(5)
    v_pk_add_f32 v[28:29], v[28:29], v[20:21]
    v_pk_add_f32 v[30:31], v[30:31], v[22:23]
    s_waitcnt vmcnt(4)
    v_pk_add_f32 v[28:29], v[28:29], v[24:25]
    v_pk_add_f32 v[30:31], v[30:31], v[26:27]
    v_pk_add_f32 v[32:33], v[28:29], v[30:31]
    v_cmp_u_f32 vcc, v32, v33
    v_permlane32_swap_b32 v28, v30
    v_permlane32_swap_b32 v29, v31
    s_cbranch_vccnz L_gr_190
L_gk_191:
    v_pk_add_f32 v[28:29], v[28:29], v[30:31]
    v_pk_add_f32 v[28:29], v[28:29], v[2:3]
    v_cvt_pk_bf16_f32 v28, v28, v29
    ds_write_b32 v35, v28
    s_waitcnt lgkmcnt(0)
    s_barrier
    v_cndmask_b32 v29, 0, v28, s[64:65]
    v_dot2_f32_bf16 v33, v29, v61, 0
    v_dot2_f32_bf16 v32, v29, v29, 0
    v_lshlrev_b32 v2, 16, v28
    v_and_b32 v3, 0xffff0000, v28
    s_cmp_eq_u32 s55, 0
    v_permlane32_swap_b32 v33, v32
    v_add_f32 v33, v33, v32
    s_nop 1
    v_add_f32_dpp v33, v33, v33 row_ror:8 row_mask:0xf bank_mask:0xf
    s_nop 1
    v_add_f32_dpp v33, v33, v33 row_ror:4 row_mask:0xf bank_mask:0xf
    s_nop 1
    v_add_f32_dpp v33, v33, v33 row_ror:2 row_mask:0xf bank_mask:0xf
    s_nop 1
    v_add_f32_dpp v33, v33, v33 row_ror:1 row_mask:0xf bank_mask:0xf
    s_nop 1
    v_add_f32_dpp v33, v33, v33 row_bcast:15 row_mask:0xa bank_mask:0xf
    v_min_u32 v33, -2, v33
    s_cbranch_scc1 L_gs_194
    buffer_store_dword v33, v34, s[40:43], s67 offen
L_gb_195:
    s_waitcnt vmcnt(1)
    s_branch L_se_179
L_qr_199:
    s_cbranch_scc1 L_qw_198
    s_waitcnt vmcnt(0)
    v_pk_max_u16 v60, v48, v49
    v_pk_max_u16 v61, v50, v51
    v_pk_max_u16 v60, v60, v61
    v_lshlrev_b32 v61, 16, v60
    v_max_u32 v60, v60, v61
    v_cmp_le_u32 vcc, 0xffff0000, v60
    s_cbranch_vccnz L_qw_198
    v_dot2_f32_bf16 v60, v48, v10, 0
    v_dot2_f32_bf16 v61, v49, v10, 0
    v_dot2_f32_bf16 v60, v50, v10, v60
    v_dot2_f32_bf16 v61, v51, v10, v61
    s_nop 2
    v_add_f32 v60, v60, v61
    v_cvt_pk_bf16_f32 v60, v60, v60
    s_branch L_qk_200
L_qo_196:
    v_mov_b64 v[24:25], 0
    v_mov_b64 v[26:27], 0
    v_mov_b64 v[28:29], 0
    v_mov_b64 v[30:31], 0
    v_mov_b64 v[32:33], 0
    v_mov_b64 v[34:35], 0
    v_mov_b64 v[36:37], 0
    v_mov_b64 v[38:39], 0
    v_mov_b64 v[40:41], 0
    v_mov_b64 v[42:43], 0
    v_mov_b64 v[44:45], 0
    v_mov_b64 v[46:47], 0
    v_lshrrev_b32 v5, 4, v0
    v_lshlrev_b32 v5, 5, v5
    v_bfe_u32 v60, v0, 1, 1
    v_lshl_add_u32 v5, v60, 4, v5
    v_add_u32 v5, 124928, v5
    s_cmp_eq_u32 s30, 6
    s_cbranch_scc0 L_qb_197
    s_mul_i32 s59, s53, 3072
L_pad20:
    s_cbranch_execz L_padback
    s_add_u32 s59, s59, s62
    s_add_u32 s59, s59, 46464
    s_lshl_b32 s60, s53, 6
    s_add_u32 s60, s60, s62
    s_add_u32 s60, s60, 25600
    v_and_b32 v16, 7, v0
    v_lshlrev_b32 v16, 3, v16
L_pr_202:
    buffer_load_dwordx2 v[10:11], v16, s[40:43], s60 offen sc1
    s_sub_u32 s56, s56, 1
    s_cbranch_scc1 L_done
L_pw_201:
    s_waitcnt vmcnt(0)
    v_max_u32 v18, v10, v11
    v_cmp_eq_u32 vcc, -1, v18
    s_cbranch_vccnz L_pr_202
    v_add_f32_dpp v10, v10, v10 row_ror:4 row_mask:0xf bank_mask:0xf
    v_add_f32_dpp v11, v11, v11 row_ror:4 row_mask:0xf bank_mask:0xf
    s_nop 0
    v_add_f32_dpp v10, v10, v10 row_ror:2 row_mask:0xf bank_mask:0xf
    v_add_f32_dpp v11, v11, v11 row_ror:2 row_mask:0xf bank_mask:0xf
    s_nop 0
    v_add_f32_dpp v10, v10, v10 row_ror:1 row_mask:0xf bank_mask:0xf
    v_add_f32_dpp v11, v11, v11 row_ror:1 row_mask:0xf bank_mask:0xf
    v_mul_f32 v10, 0x3acccccd, v10
    v_mul_f32 v11, 0x3acccccd, v11
    v_fma_f32 v11, -v10, v10, v11
    v_max_f32 v11, 0, v11
    v_add_f32 v11, 0x3727c5ac, v11
    v_rsq_f32 v11, v11
    s_nop 0
    v_mul_f32 v11, 0x3dd53b95, v11
    v_mul_f32 v10, -v10, v11
    ds_write_b64 v8, v[10:11]
    s_branch L_qb_197
L_mr_203:
    ds_read_b32 v36, v62
    s_sub_u32 s56, s56, 1
    s_cbranch_scc1 L_done
    s_waitcnt lgkmcnt(0)
    v_cmp_eq_u32 vcc, -1, v36
    s_cbranch_vccnz L_mr_203
    v_max_f32_dpp v37, v36, v36 row_ror:4 row_mask:0xf bank_mask:0xf
    s_nop 1
    v_max_f32_dpp v37, v37, v37 row_ror:2 row_mask:0xf bank_mask:0xf
    s_nop 1
    v_max_f32_dpp v37, v37, v37 row_ror:1 row_mask:0xf bank_mask:0xf
    v_sub_f32 v39, s64, v37
    v_exp_f32 v39, v39
    s_branch L_mk_204
L_gs_205:
    buffer_store_dword v37, v4, s[40:43], s58 offen sc1
    s_branch L_gb_206
L_gs_207:
    buffer_store_dword v14, v3, s[40:43], s57 offen sc1
    s_branch L_gb_208
L_gs_209:
    buffer_store_dword v12, v4, s[40:43], s57 offen offset:32 sc1
    s_branch L_gb_210
L_comb_1:
    s_mov_b32 s58, 27008
    v_min_u32 v37, -2, v37
    s_cmp_eq_u32 s55, 0
    s_cbranch_scc1 L_gs_205
    buffer_store_dword v37, v4, s[40:43], s58 offen
L_gb_206:
    s_mov_b32 s57, 27008
    s_cmp_eq_u32 s55, 0
    s_waitcnt lgkmcnt(0)
    s_barrier
    ds_read2st64_b64 v[12:15], v2 offset0:0 offset1:4
    ds_read2st64_b64 v[16:19], v2 offset0:8 offset1:12
    ds_read2st64_b64 v[20:23], v2 offset0:16 offset1:20
    ds_read2st64_b64 v[24:27], v2 offset0:24 offset1:28
    s_waitcnt lgkmcnt(2)
    v_pk_add_f32 v[12:13], v[12:13], v[14:15]
    v_pk_add_f32 v[16:17], v[16:17], v[18:19]
    v_pk_add_f32 v[12:13], v[12:13], v[16:17]
    s_waitcnt lgkmcnt(0)
    v_pk_add_f32 v[20:21], v[20:21], v[22:23]
    v_pk_add_f32 v[24:25], v[24:25], v[26:27]
    v_pk_add_f32 v[12:13], v[12:13], v[20:21]
    v_pk_add_f32 v[12:13], v[12:13], v[24:25]
    v_cvt_pk_bf16_f32 v14, v12, v13
    v_min_u32 v12, -2, v12
    v_min_u32 v14, -2, v14
    s_cbranch_scc1 L_gs_207
    buffer_store_dword v14, v3, s[40:43], s57 offen
L_gb_208:
    s_cbranch_scc1 L_gs_209
    buffer_store_dword v12, v4, s[40:43], s57 offen offset:32
L_gb_210:
    s_branch L_comb_1b
L_sr_218:
    buffer_load_dwordx4 v[12:15], v11, s[40:43], s58 offen offset:0 sc1
    buffer_load_dwordx4 v[16:19], v11, s[40:43], s58 offen offset:1024 sc1
L_pad21:
    s_cbranch_execz L_padback
    s_sub_u32 s56, s56, 1
    s_cbranch_scc1 L_done
    s_waitcnt vmcnt(0)
    s_branch L_sw_217
L_hr_222:
    s_sub_u32 s56, s56, 1
    s_cbranch_scc1 L_done
    s_and_b32 s64, s56, 15
    s_cbranch_scc1 L_ha_224
    s_waitcnt vmcnt(0)
    v_max3_u32 v21, v12, v13, v14
    v_max3_u32 v21, v21, v15, v16
    v_max3_u32 v21, v21, v17, v18
    v_max_u32 v21, v21, v19
    v_cmp_eq_u32 vcc, -1, v21
    s_cbranch_vccnz L_ha_224
    v_pk_add_f32 v[20:21], v[12:13], v[14:15]
    v_pk_add_f32 v[22:23], v[16:17], v[18:19]
    v_pk_add_f32 v[20:21], v[20:21], v[22:23]
    v_add_f32 v20, v20, v21
    v_fma_f32 v20, v20, v3, v8
    s_branch L_hk_223
L_ha_224:
    buffer_load_dwordx4 v[12:15], v11, s[40:43], s58 offen offset:0 sc1
    buffer_load_dwordx4 v[16:19], v11, s[40:43], s58 offen offset:1024 sc1
    s_waitcnt vmcnt(2)
    s_branch L_hw_221
L_xr_227:
    s_sub_u32 s56, s56, 1
    s_cbranch_scc1 L_done
    s_branch L_xw_226
L_typeC_228:
    s_cmp_eq_u32 s30, 6
    s_cbranch_scc0 L_done
    s_cmp_eq_u32 s3, 20
    s_cbranch_scc0 L_done
    s_lshl_b32 s59, s31, 15
    s_add_u32 s59, s59, s8
    s_add_u32 s59, s59, 7168
    v_and_b32 v10, 1, v0
    v_lshlrev_b32 v10, 13, v10
    v_lshrrev_b32 v60, 1, v0
    v_lshl_add_u32 v10, v60, 24, v10
    s_add_u32 s58, s62, 28576
    v_lshrrev_b32 v9, 3, v0
    v_mul_u32_u24 v9, 1664, v9
    v_and_b32 v60, 7, v0
    v_lshl_add_u32 v9, v60, 2, v9
    buffer_load_dword v12, v9, s[40:43], s58 offen sc1
    s_sleep 2
L_pr_230:
    buffer_load_dword v12, v9, s[40:43], s58 offen sc1
    s_sub_u32 s56, s56, 1
    s_cbranch_scc1 L_done
L_pw_229:
    s_waitcnt vmcnt(1)
    v_cmp_eq_u32 vcc, -1, v12
    s_cbranch_vccnz L_pr_230
    buffer_store_dword v0, v10, s[40:43], s59 offen offset:8 sc1
    s_add_u32 s58, s62, 25984
    v_and_b32 v9, 15, v0
    v_lshlrev_b32 v9, 2, v9
    buffer_load_dword v13, v9, s[40:43], s58 offen sc1
    s_sleep 2
L_pr_232:
    buffer_load_dword v13, v9, s[40:43], s58 offen sc1
    s_sub_u32 s56, s56, 1
    s_cbranch_scc1 L_done
L_pw_231:
    s_waitcnt vmcnt(1)
    v_cmp_eq_u32 vcc, -1, v13
    s_cbranch_vccnz L_pr_232
    buffer_store_dword v0, v10, s[40:43], s59 offen offset:12 sc1
    s_waitcnt vmcnt(1)
    s_branch L_done
L_gs_236:
    buffer_store_dword v12, v11, s[40:43], s59 offen sc1
    s_branch L_gb_237
L_gr_239:
    s_cbranch_scc1 L_gw_238
    s_waitcnt vmcnt(0)
    v_max3_u32 v32, v12, v13, v14
    v_max3_u32 v32, v32, v15, v16
    v_max3_u32 v32, v32, v17, v18
    v_max3_u32 v32, v32, v19, v20
    v_max3_u32 v32, v32, v21, v22
    v_max3_u32 v32, v32, v23, v24
    v_max3_u32 v32, v32, v25, v26
    v_max_u32 v32, v32, v27
    v_cmp_eq_u32 vcc, -1, v32
    s_cbranch_vccnz L_gw_238
    v_pk_add_f32 v[28:29], v[12:13], v[16:17]
    v_pk_add_f32 v[30:31], v[14:15], v[18:19]
    v_pk_add_f32 v[28:29], v[28:29], v[20:21]
    v_pk_add_f32 v[30:31], v[30:31], v[22:23]
    v_pk_add_f32 v[28:29], v[28:29], v[24:25]
    v_pk_add_f32 v[30:31], v[30:31], v[26:27]
    s_nop 1
    v_permlane32_swap_b32 v28, v30
    v_permlane32_swap_b32 v29, v31
    s_branch L_gk_240
L_gs_243:
    buffer_store_dword v33, v34, s[40:43], s67 offen sc1
L_pad22:
    s_cbranch_execz L_padback
    s_branch L_gb_244
L_w7_233:
    v_and_b32 v60, 31, v0
    v_min_u32 v60, 19, v60
    s_mul_i32 s57, s54, 320
    v_lshrrev_b32 v5, 5, v0
    v_mul_u32_u24 v5, 2560, v5
    v_add_u32 v5, s57, v5
    v_lshl_add_u32 v5, v60, 4, v5
    v_and_b32 v60, 31, v0
    v_cmp_gt_u32 s[64:65], 20, v60
    v_min_u32 v60, 19, v60
    v_lshrrev_b32 v35, 5, v0
    v_lshlrev_b32 v35, 2, v35
    v_add_u32 v35, 160832, v35
    v_lshl_add_u32 v35, v60, 3, v35
    s_add_u32 s66, s62, 40320
    s_add_u32 s67, s62, 25984
    s_lshl_b32 s57, s54, 3
    v_lshrrev_b32 v34, 5, v0
    v_lshlrev_b32 v34, 2, v34
    v_add_u32 v34, s57, v34
    v_and_b32 v60, 31, v0
    v_mov_b32 v61, 0x7f000000
    v_cmp_ne_u32 vcc, 31, v60
    s_nop 1
    v_cndmask_b32 v34, v34, v61, vcc
    v_mov_b32 v61, 0x3f803f80
    s_add_u32 s57, s7, 262144
    s_add_u32 s58, s7, 294912
    s_add_u32 s59, s7, 327680
    s_add_u32 s60, s7, 360448
    s_add_u32 s75, s7, 7176
    v_and_b32 v9, 7, v0
    v_lshlrev_b32 v9, 15, v9
    buffer_load_dword v12, v9, s[40:43], s75 offen sc1
    s_sleep 2
L_pr_242:
    buffer_load_dword v12, v9, s[40:43], s75 offen sc1
    s_sub_u32 s56, s56, 1
    s_cbranch_scc1 L_done
L_pw_241:
    s_waitcnt vmcnt(1)
    v_cmp_eq_u32 vcc, -1, v12
    s_cbranch_vccnz L_pr_242
    s_sleep 5
    buffer_load_dwordx4 v[12:15], v5, s[40:43], s57 offen sc1
    buffer_load_dwordx4 v[16:19], v5, s[40:43], s58 offen sc1
    buffer_load_dwordx4 v[20:23], v5, s[40:43], s59 offen sc1
    buffer_load_dwordx4 v[24:27], v5, s[40:43], s60 offen sc1
    s_sleep 2
L_gw_238:
    buffer_load_dwordx4 v[12:15], v5, s[40:43], s57 offen sc1
    buffer_load_dwordx4 v[16:19], v5, s[40:43], s58 offen sc1
    buffer_load_dwordx4 v[20:23], v5, s[40:43], s59 offen sc1
    buffer_load_dwordx4 v[24:27], v5, s[40:43], s60 offen sc1
    s_sub_u32 s56, s56, 1
    s_cbranch_scc1 L_done
    s_and_b32 s74, s56, 31
    s_waitcnt vmcnt(6)
    v_pk_add_f32 v[28:29], v[12:13], v[16:17]
    v_pk_add_f32 v[30:31], v[14:15], v[18:19]
    s_waitcnt vmcnt(5)
    v_pk_add_f32 v[28:29], v[28:29], v[20:21]
    v_pk_add_f32 v[30:31], v[30:31], v[22:23]
    s_waitcnt vmcnt(4)
    v_pk_add_f32 v[28:29], v[28:29], v[24:25]
    v_pk_add_f32 v[30:31], v[30:31], v[26:27]
    v_pk_add_f32 v[32:33], v[28:29], v[30:31]
    v_cmp_u_f32 vcc, v32, v33
    v_permlane32_swap_b32 v28, v30
    v_permlane32_swap_b32 v29, v31
    s_cbranch_vccnz L_gr_239
L_gk_240:
    v_pk_add_f32 v[28:29], v[28:29], v[30:31]
    v_pk_add_f32 v[28:29], v[28:29], v[2:3]
    v_cvt_pk_bf16_f32 v28, v28, v29
    ds_write_b32 v35, v28
    s_waitcnt lgkmcnt(0)
    s_barrier
    v_cndmask_b32 v29, 0, v28, s[64:65]
    v_dot2_f32_bf16 v33, v29, v61, 0
    v_dot2_f32_bf16 v32, v29, v29, 0
    v_lshlrev_b32 v2, 16, v28
    v_and_b32 v3, 0xffff0000, v28
    s_cmp_eq_u32 s55, 0
    v_permlane32_swap_b32 v33, v32
    v_add_f32 v33, v33, v32
    s_nop 1
    v_add_f32_dpp v33, v33, v33 row_ror:8 row_mask:0xf bank_mask:0xf
L_pad23:
    s_cbranch_execz L_padback
    s_nop 1
    v_add_f32_dpp v33, v33, v33 row_ror:4 row_mask:0xf bank_mask:0xf
    s_nop 1
    v_add_f32_dpp v33, v33, v33 row_ror:2 row_mask:0xf bank_mask:0xf
    s_nop 1
    v_add_f32_dpp v33, v33, v33 row_ror:1 row_mask:0xf bank_mask:0xf
    s_nop 1
    v_add_f32_dpp v33, v33, v33 row_bcast:15 row_mask:0xa bank_mask:0xf
    v_min_u32 v33, -2, v33
    s_cbranch_scc1 L_gs_243
    buffer_store_dword v33, v34, s[40:43], s67 offen
L_gb_244:
    s_waitcnt vmcnt(1)
    s_branch L_se_234
L_gr_246:
    s_cbranch_scc1 L_gw_245
    s_waitcnt vmcnt(0)
    v_max3_u32 v32, v12, v13, v14
    v_max3_u32 v32, v32, v15, v16
    v_max3_u32 v32, v32, v17, v18
    v_max3_u32 v32, v32, v19, v20
    v_max3_u32 v32, v32, v21, v22
    v_max3_u32 v32, v32, v23, v24
    v_max3_u32 v32, v32, v25, v26
    v_max_u32 v32, v32, v27
    v_cmp_eq_u32 vcc, -1, v32
    s_cbranch_vccnz L_gw_245
    v_pk_add_f32 v[28:29], v[12:13], v[16:17]
    v_pk_add_f32 v[30:31], v[14:15], v[18:19]
    v_pk_add_f32 v[28:29], v[28:29], v[20:21]
    v_pk_add_f32 v[30:31], v[30:31], v[22:23]
    v_pk_add_f32 v[28:29], v[28:29], v[24:25]
    v_pk_add_f32 v[30:31], v[30:31], v[26:27]
    s_nop 1
    v_permlane32_swap_b32 v28, v30
    v_permlane32_swap_b32 v29, v31
    s_branch L_gk_247
L_tail_end:
L_spread:
    s_add_u32 s62, s62, 688128
    s_cmp_eq_u32 s30, 5
    s_cbranch_scc0 L_skip_80
    v_mov_b64 v[12:13], -1
    v_mov_b64 v[14:15], -1
    v_lshlrev_b32 v16, 4, v0
    s_mul_i32 s57, s52, 1840
    s_add_u32 s57, s57, s62
    s_mov_b32 exec_lo, 0xffffffff
    s_mov_b32 exec_hi, 0x7ffff
    buffer_store_dwordx4 v[12:15], v16, s[40:43], s57 offen offset:1024 sc1
    s_mov_b64 exec, -1
    buffer_store_dwordx4 v[12:15], v16, s[40:43], s57 offen sc1
L_skip_80:
    s_cmp_eq_u32 s30, 7
    s_cbranch_scc0 L_skip_81
    v_and_b32 v60, 31, v0
    v_cmp_gt_u32 s[64:65], 20, v60
    v_min_u32 v60, 19, v60
    v_lshrrev_b32 v35, 5, v0
    v_lshlrev_b32 v35, 2, v35
    v_add_u32 v35, 160832, v35
    v_lshl_add_u32 v35, v60, 3, v35
    s_mul_i32 s66, s53, 6400
    s_add_u32 s66, s66, s62
    s_add_u32 s66, s66, 58880
    s_add_u32 s67, s66, 6144
    s_lshl_b32 s57, s54, 3
    v_lshrrev_b32 v34, 5, v0
    v_lshlrev_b32 v34, 2, v34
    v_add_u32 v34, s57, v34
    v_and_b32 v60, 31, v0
    v_mov_b32 v61, 0x7f000000
    v_cmp_ne_u32 vcc, 31, v60
    s_nop 1
    v_cndmask_b32 v34, v34, v61, vcc
    v_mov_b32 v61, 0x3f803f80
    v_cvt_pk_bf16_f32 v28, v2, v3
L_skip_81:
    s_cmp_eq_u32 s30, 7
    s_cbranch_scc0 L_skip_82
    v_cndmask_b32 v29, 0, v28, s[64:65]
    v_dot2_f32_bf16 v33, v29, v61, 0
    v_dot2_f32_bf16 v32, v29, v29, 0
    v_lshlrev_b32 v2, 16, v28
    v_and_b32 v3, 0xffff0000, v28
    s_cmp_eq_u32 s55, 0
    v_permlane32_swap_b32 v33, v32
    v_add_f32 v33, v33, v32
    s_nop 1
    v_add_f32_dpp v33, v33, v33 row_ror:8 row_mask:0xf bank_mask:0xf
    s_nop 1
    v_add_f32_dpp v33, v33, v33 row_ror:4 row_mask:0xf bank_mask:0xf
    s_nop 1
    v_add_f32_dpp v33, v33, v33 row_ror:2 row_mask:0xf bank_mask:0xf
    s_nop 1
    v_add_f32_dpp v33, v33, v33 row_ror:1 row_mask:0xf bank_mask:0xf
    s_nop 1
    v_add_f32_dpp v33, v33, v33 row_bcast:15 row_mask:0xa bank_mask:0xf
    v_min_u32 v33, -2, v33
    s_cbranch_scc1 L_gs_83
    buffer_store_dword v33, v34, s[40:43], s67 offen
L_gb_84:
    s_waitcnt vmcnt(1)
L_skip_82:
    s_cmp_lt_u32 s30, 6
    s_cbranch_scc0 L_skip_85
    s_lshr_b32 s57, s30, 1
    s_mul_i32 s57, s57, 1024
    s_and_b32 s58, s30, 1
    s_lshl_b32 s58, s58, 6
    s_add_u32 s57, s57, s58
    v_lshrrev_b32 v18, 5, v0
    v_mul_u32_u24 v18, 6144, v18
    v_bfe_u32 v60, v0, 3, 1
    v_mul_u32_u24 v60, 3072, v60
    v_add_u32 v18, v60, v18
    v_bfe_u32 v60, v0, 4, 1
    v_lshl_add_u32 v18, v60, 9, v18
    v_bfe_u32 v60, v0, 2, 1
    v_lshl_add_u32 v18, v60, 7, v18
    v_and_b32 v60, 3, v0
    v_lshl_add_u32 v18, v60, 3, v18
    v_add_u32 v18, s57, v18
    v_bfe_u32 v19, v0, 4, 1
    v_mul_u32_u24 v19, 3072, v19
    v_bfe_u32 v60, v0, 3, 1
    v_lshl_add_u32 v19, v60, 9, v19
    v_bfe_u32 v60, v0, 2, 1
    v_lshl_add_u32 v19, v60, 7, v19
    v_and_b32 v60, 3, v0
    v_lshl_add_u32 v19, v60, 3, v19
    v_add_u32 v19, s57, v19
    v_add_u32 v19, 24576, v19
    ds_read_b64_tr_b16 v[28:29], v18 offset:0
    ds_read_b64_tr_b16 v[30:31], v18 offset:256
    ds_read_b64_tr_b16 v[32:33], v18 offset:12288
    ds_read_b64_tr_b16 v[34:35], v18 offset:12544
    ds_read_b64_tr_b16 v[36:37], v19 offset:0
    ds_read_b64_tr_b16 v[38:39], v19 offset:256
    ds_read_b64_tr_b16 v[40:41], v18 offset:32
    ds_read_b64_tr_b16 v[42:43], v18 offset:288
    ds_read_b64_tr_b16 v[44:45], v18 offset:12320
    ds_read_b64_tr_b16 v[46:47], v18 offset:12576
    ds_read_b64_tr_b16 v[48:49], v19 offset:32
    ds_read_b64_tr_b16 v[50:51], v19 offset:288
    v_lshrrev_b32 v52, 4, v0
    v_lshlrev_b32 v52, 5, v52
    v_bfe_u32 v60, v0, 1, 1
    v_lshl_add_u32 v52, v60, 4, v52
    v_and_b32 v60, 1, v0
    v_mul_u32_u24 v60, 192, v60
    v_add_u32 v52, v60, v52
    v_add_u32 v52, 160832, v52
    v_lshrrev_b32 v53, 4, v0
    v_lshlrev_b32 v53, 4, v53
    v_bfe_u32 v60, v0, 1, 1
    v_lshl_add_u32 v53, v60, 3, v53
    v_and_b32 v60, 1, v0
    v_mul_u32_u24 v60, 192, v60
    v_add_u32 v53, v60, v53
    v_add_u32 v53, 160960, v53
    v_mov_b64 v[20:21], 0
    v_mov_b64 v[22:23], 0
    v_mov_b64 v[24:25], 0
    v_mov_b64 v[26:27], 0
    s_lshl_b32 s57, s54, 1
    s_lshl_b32 s58, s30, 9
    s_add_u32 s57, s57, s58
    v_and_b32 v54, 31, v0
    v_lshlrev_b32 v54, 4, v54
    v_lshrrev_b32 v60, 5, v0
    v_mul_u32_u24 v60, 3072, v60
    v_add_u32 v54, v60, v54
    v_add_u32 v54, s57, v54
    s_mul_i32 s59, s53, 6400
    s_add_u32 s59, s59, s62
    s_add_u32 s59, s59, 58880
    s_add_u32 s60, s59, 6144
    ds_read_b128 v[12:15], v52
    ds_read_b64 v[16:17], v53
    s_waitcnt lgkmcnt(1)
    v_smfmac_f32_16x16x64_bf16 v[20:23], v[12:15], v[28:35], v1
    v_smfmac_f32_16x16x64_bf16 v[24:27], v[12:15], v[40:47], v1
    s_waitcnt lgkmcnt(0)
    v_smfmac_f32_16x16x32_bf16 v[20:23], v[16:17], v[36:39], v1
    v_smfmac_f32_16x16x32_bf16 v[24:27], v[16:17], v[48:51], v1
    s_cmp_eq_u32 s55, 0
    s_nop 5
    v_add_f32 v12, v20, v22
    s_nop 1
    v_add_f32_dpp v12, v24, v26 quad_perm:[0,1,2,3] row_mask:0x2 bank_mask:0xf
    s_nop 1
    v_add_f32_dpp v12, v21, v23 quad_perm:[0,1,2,3] row_mask:0x4 bank_mask:0xf
    s_nop 1
    v_add_f32_dpp v12, v25, v27 quad_perm:[0,1,2,3] row_mask:0x8 bank_mask:0xf
    v_cvt_pk_bf16_f32 v12, v12, v12
    v_min_u32 v12, -2, v12
    s_cbranch_scc1 L_gs_86
    buffer_store_short v12, v54, s[40:43], s59 offen
L_gb_87:
L_skip_85:
    s_waitcnt vmcnt(0)
    s_barrier
    s_cmp_eq_u32 s30, 5
    s_cbranch_scc0 L_skip_88
    v_mov_b32 v25, 0
    s_lshl_b32 s57, s52, 2
    s_add_u32 s57, s57, s72
    s_mov_b64 exec, 1
    buffer_store_dword v25, v0, s[40:43], s57 offen offset:256 sc1
    s_mov_b64 exec, -1
    v_and_b32 v16, 31, v0
    v_lshlrev_b32 v16, 2, v16
L_pr_90:
    buffer_load_dword v17, v16, s[40:43], s72 offen offset:256 sc1
    s_sub_u32 s56, s56, 1
    s_cbranch_scc1 L_done
L_pw_89:
    s_waitcnt vmcnt(0)
    v_cmp_eq_u32 vcc, -1, v17
    s_cbranch_vccnz L_pr_90
L_skip_88:
    s_barrier
    s_branch L_spread_back
L_done:
L_exit:
    s_endpgm
.section .rodata,"a"
.p2align 6
.amdhsa_kernel interleave_layers__sliding_block_cached__dense_activation_gelu__decode_kernel
  .amdhsa_next_free_vgpr 256
  .amdhsa_next_free_sgpr 102
  .amdhsa_accum_offset 256
  .amdhsa_group_segment_fixed_size 0
  .amdhsa_kernarg_size 104
  .amdhsa_user_sgpr_count 2
  .amdhsa_user_sgpr_kernarg_segment_ptr 1
  .amdhsa_system_sgpr_workgroup_id_x 1
  .amdhsa_float_denorm_mode_32 3
.end_amdhsa_kernel
```

```asm
; @launch grid=(256,1,1) block=(512,1,1) lds=161216
.amdgcn_target "amdgcn-amd-amdhsa--gfx950"
.text
.fill 64, 4, 0xbf800000
.globl interleave_layers__sliding_block_cached__dense_activation_gelu__decode_kernel
.p2align 8
.type interleave_layers__sliding_block_cached__dense_activation_gelu__decode_kernel,@function
interleave_layers__sliding_block_cached__dense_activation_gelu__decode_kernel:
    s_load_dwordx16 s[4:19], s[0:1], 0
    s_load_dwordx8 s[20:27], s[0:1], 64
    s_load_dwordx2 s[28:29], s[0:1], 96
    s_cmp_ge_u32 s2, 256
    s_cbranch_scc1 L_exit
    s_getpc_b64 s[74:75]
L_pc:
    v_lshlrev_b32 v5, 6, v0
    v_min_u32 v5, L_exit-L_pc, v5
    global_load_dword v63, v5, s[74:75]
    v_lshrrev_b32 v5, 6, v0
    v_and_b32 v0, 63, v0
    v_readfirstlane_b32 s30, v5
    s_and_b32 s31, s2, 7
    s_lshr_b32 s52, s2, 3
    s_and_b32 s53, s52, 3
    s_lshr_b32 s54, s52, 2
    s_lshl_b32 s73, s31, 2
    s_add_u32 s73, s73, s53
    s_mul_i32 s3, s54, 3
    s_add_u32 s3, s3, s53
    s_cmp_eq_u32 s53, 3
    s_cselect_b32 s3, 31, s3
    s_cselect_b32 s70, 0, 0
    s_cmp_lt_u32 s3, 20
    s_cselect_b32 s70, 1, s70
    v_lshrrev_b32 v8, 5, v0
    v_lshlrev_b32 v8, 2, v8
    v_bfe_u32 v60, v0, 4, 1
    v_lshl_add_u32 v8, v60, 0, v8
    v_and_b32 v9, 7, v0
    v_xor_b32 v8, v8, v9
    v_lshrrev_b32 v10, 3, v0
    v_mul_u32_u24 v10, 384, v10
    v_lshl_add_u32 v5, v8, 4, v10
    v_xor_b32 v6, 32, v5
    v_lshrrev_b32 v8, 4, v0
    v_lshlrev_b32 v8, 1, v8
    v_xor_b32 v8, v8, v9
    v_lshl_add_u32 v7, v8, 4, v10
    v_lshrrev_b32 v2, 3, v0
    v_mul_u32_u24 v2, 12288, v2
    v_and_b32 v60, 7, v0
    v_lshl_add_u32 v2, v60, 4, v2
    s_mul_i32 s57, s73, 12582912
    s_mul_i32 s58, s54, 3072
    s_add_u32 s57, s57, s58
    s_add_u32 s57, s57, 11009024
    s_sub_u32 s58, 1573888, s58
    s_and_b32 s71, s73, 7
    s_mul_i32 s59, s73, 384
    s_mul_i32 s60, s54, 983040
    s_add_u32 s59, s59, s60
    s_sub_u32 s60, 7866368, s59
    s_lshl_b32 s61, s30, 11
    s_add_u32 s61, s61, 92160
    s_mul_i32 s62, s31, 86016
    s_lshl_b32 s72, s31, 9
    s_add_u32 s72, s72, 1933312
    s_mov_b32 s56, 65536
    s_mov_b32 s55, 1
    s_getreg_b32 s63, hwreg(20, 0, 3)
    s_andn2_b32 s64, 1, s63
    s_mul_i32 s64, s64, 1
    s_add_u32 s70, s70, s64
    v_mov_b32 v3, 0
    v_mov_b32 v4, 0
    v_mov_b32 v11, 0
    v_mov_b32 v24, 0
    v_mov_b32 v34, 0
    v_mov_b64 v[12:13], -1
    v_mov_b64 v[14:15], -1
    v_lshlrev_b32 v10, 4, v0
    s_waitcnt lgkmcnt(0)
    s_add_u32 s32, s6, s57
    s_addc_u32 s33, s7, 0
    s_mov_b32 s34, s58
    s_mov_b32 s35, 0x20000
    s_add_u32 s36, s8, s57
    s_addc_u32 s37, s9, 0
    s_mov_b32 s38, s58
    s_mov_b32 s39, 0x20000
    s_mov_b32 s40, s28
    s_mov_b32 s41, s29
    s_mov_b32 s42, 1937408
    s_mov_b32 s43, 0x20000
    s_add_u32 s44, s10, s59
    s_addc_u32 s45, s11, 0
    s_mov_b32 s46, s60
    s_mov_b32 s47, 0x20000
    s_sub_u32 s44, s44, 2048
    s_subb_u32 s45, s45, 0
    s_cmp_eq_u32 s30, 6
    s_cbranch_scc0 L_skip_1
    s_setprio 3
    s_xor_b32 s57, s71, 0
    s_mul_i32 s57, s57, 196608
    s_add_u32 s57, s57, 1024
    s_xor_b32 s58, s71, 1
    s_mul_i32 s58, s58, 196608
    s_add_u32 s58, s58, 0
    s_mov_b32 m0, 92160
L_dma_2:
    s_nop 0
    buffer_load_dwordx4 v5, s[32:35], s57 offen offset:0 nt lds
    buffer_load_dwordx4 v6, s[32:35], s58 offen offset:1024 nt lds
    s_add_u32 s57, s57, 24576
    s_add_u32 s58, s58, 24576
    s_add_u32 m0, m0, 2048
    s_cmp_lg_u32 m0, 108544
    s_cbranch_scc1 L_dma_2
    s_xor_b32 s57, s71, 0
    s_mul_i32 s57, s57, 196608
    s_add_u32 s57, s57, 1152
    s_xor_b32 s58, s71, 1
    s_mul_i32 s58, s58, 196608
    s_add_u32 s58, s58, 128
    s_mov_b32 m0, 108544
L_dma_3:
    s_waitcnt vmcnt(23)
    s_cmp_ge_u32 s70, 2
    s_cbranch_scc1 L_go_4
    s_waitcnt vmcnt(22)
    s_cmp_ge_u32 s70, 1
    s_cbranch_scc1 L_go_4
    s_waitcnt vmcnt(21)
L_go_4:
    buffer_load_dwordx4 v5, s[32:35], s57 offen offset:0 nt lds
    buffer_load_dwordx4 v6, s[32:35], s58 offen offset:1024 nt lds
    s_add_u32 s57, s57, 24576
    s_add_u32 s58, s58, 24576
    s_add_u32 m0, m0, 2048
    s_cmp_lg_u32 m0, 124928
    s_cbranch_scc1 L_dma_3
    s_mov_b32 s57, 2048
    s_mov_b32 s58, 1152
    s_mov_b32 s59, 256
    s_mov_b32 m0, 0
L_dma_5:
    s_waitcnt vmcnt(23)
    s_cmp_ge_u32 s70, 2
    s_cbranch_scc1 L_go_6
    s_waitcnt vmcnt(22)
    s_cmp_ge_u32 s70, 1
    s_cbranch_scc1 L_go_6
    s_waitcnt vmcnt(21)
L_go_6:
    buffer_load_dwordx4 v2, s[44:47], s57 offen offset:0 nt lds
    buffer_load_dwordx4 v2, s[44:47], s58 offen offset:1024 nt lds
    buffer_load_dwordx4 v2, s[44:47], s59 offen offset:2048 nt lds
    s_add_u32 s57, s57, 98304
    s_add_u32 s58, s58, 98304
    s_add_u32 s59, s59, 98304
    s_add_u32 m0, m0, 3072
    s_cmp_lg_u32 m0, 15360
    s_cbranch_scc1 L_dma_5
L_skip_1:
    s_cmp_lt_u32 s3, 20
    s_cselect_b32 s57, 7864320, 0
    s_add_u32 s58, s54, 1
    s_mul_i32 s58, s58, 245760
    s_cmp_lg_u32 s53, 3
    s_cselect_b64 s[48:49], s[12:13], s[16:17]
    s_cselect_b32 s50, s57, s58
    s_mov_b32 s51, 0x20000
    s_add_u32 s57, s28, 1376256
    s_sub_u32 s57, 0, s57
    s_and_b32 s57, s57, 0x7fff
    s_add_u32 s57, s57, 1376256
    s_lshr_b32 s58, s31, 1
    s_lshl_b32 s58, s58, 15
    s_add_u32 s6, s57, s58
    s_and_b32 s58, s31, 1
    s_mul_i32 s58, s58, 2560
    s_add_u32 s6, s6, s58
    s_lshl_b32 s58, s3, 7
    s_add_u32 s6, s6, s58
    s_mov_b32 s8, s57
    s_lshr_b32 s58, s52, 4
    s_lshl_b32 s58, s58, 15
    s_and_b32 s59, s52, 15
    s_lshl_b32 s59, s59, 7
    s_add_u32 s59, s59, s58
    s_add_u32 s59, s59, s57
    s_add_u32 s59, s59, 5120
    s_lshl_b32 s58, s31, 16
    s_add_u32 s59, s59, s58
    s_add_u32 s10, s28, s59
    s_addc_u32 s11, s29, 0
    s_lshr_b32 s58, s63, 2
    s_xor_b32 s58, s58, 0
    s_mul_i32 s58, s58, 8192
    s_add_u32 s7, s57, s58
    s_cmp_eq_u32 s30, 5
    s_cbranch_scc0 L_skip_7
    s_cmp_eq_u32 s52, 31
    s_cbranch_scc0 L_skip_8
    s_mov_b64 exec, 0xffffff
    buffer_store_dwordx4 v[12:15], v10, s[40:43], s72 offen sc1
    s_mov_b64 exec, -1
L_skip_8:
    s_cmp_lt_u32 s3, 20
    s_cbranch_scc0 L_skip_9
    v_and_b32 v16, 7, v0
    v_lshlrev_b32 v16, 4, v16
    v_bfe_u32 v17, v0, 3, 1
    v_lshl_add_u32 v16, v17, 13, v16
    v_lshrrev_b32 v17, 4, v0
    v_lshl_add_u32 v16, v17, 17, v16
    s_add_u32 s57, s6, 0
    buffer_store_dwordx4 v[12:15], v16, s[40:43], s57 offen sc1
L_skip_9:
    s_cmp_eq_u32 s3, 20
    s_cbranch_scc0 L_skip_10
    s_lshl_b32 s58, s31, 15
    s_add_u32 s58, s58, s8
    s_add_u32 s58, s58, 7168
    v_and_b32 v16, 7, v0
    v_lshlrev_b32 v16, 4, v16
    v_bfe_u32 v60, v0, 3, 1
    v_lshl_add_u32 v16, v60, 13, v16
    v_lshrrev_b32 v60, 4, v0
    v_lshl_add_u32 v16, v60, 28, v16
    buffer_store_dwordx4 v[12:15], v16, s[40:43], s58 offen sc1
L_skip_10:
    s_sub_u32 s58, s3, 20
    s_cmp_lt_u32 s58, 4
    s_cselect_b32 s59, s59, 0x7f000000
    v_and_b32 v16, 7, v0
    v_lshlrev_b32 v16, 4, v16
    v_bfe_u32 v60, v0, 3, 1
    v_lshl_add_u32 v16, v60, 13, v16
    v_lshrrev_b32 v60, 4, v0
    v_lshl_add_u32 v16, v60, 28, v16
    buffer_store_dwordx4 v[12:15], v16, s[40:43], s59 offen sc1
    s_mul_i32 s57, s52, 1840
    s_add_u32 s57, s57, s62
    s_mov_b32 exec_lo, 0xffffffff
    s_mov_b32 exec_hi, 0x7ffff
    buffer_store_dwordx4 v[12:15], v10, s[40:43], s57 offen offset:1024
    s_mov_b64 exec, -1
    buffer_store_dwordx4 v[12:15], v10, s[40:43], s57 offen
    s_mov_b64 exec, -1
    v_lshlrev_b32 v16, 4, v0
    v_add_u32 v16, 159744, v16
    ds_write_b128 v16, v[12:15]
    v_subrev_u32 v16, 8, v0
    v_cmp_gt_u32 vcc, 40, v16
    v_mov_b32 v16, 0x3f803f80
    s_nop 0
    v_cndmask_b32 v18, 0, v16, vcc
    v_min_u32 v16, 55, v0
    v_lshlrev_b32 v16, 2, v16
    v_add_u32 v16, 160992, v16
    ds_write_b32 v16, v18
    v_and_b32 v3, 7, v0
    v_lshlrev_b32 v3, 5, v3
L_skip_7:
    s_cmp_eq_u32 s30, 7
    s_cbranch_scc0 L_skip_11
    v_and_b32 v60, 31, v0
    v_min_u32 v60, 19, v60
    s_mul_i32 s57, s54, 160
    v_lshrrev_b32 v16, 5, v0
    v_lshlrev_b32 v16, 2, v16
    v_add_u32 v16, s57, v16
    v_lshl_add_u32 v16, v60, 3, v16
    global_load_dword v28, v16, s[4:5]
    global_load_dword v4, v16, s[22:23]
L_skip_11:
    s_sub_u32 s58, s30, 4
    s_cmp_lt_u32 s58, 3
    s_cbranch_scc0 L_skip_12
    s_mul_i32 s57, s31, 3
    s_add_u32 s57, s57, s58
    s_lshl_b32 s57, s57, 7
    v_lshlrev_b32 v16, 1, v0
    v_add_u32 v16, s57, v16
    global_load_short_d16_hi v4, v16, s[18:19]
L_skip_12:
    v_bfe_u32 v8, v0, 1, 3
    v_lshrrev_b32 v9, 4, v0
    v_xor_b32 v9, v8, v9
    v_bfe_u32 v8, v0, 2, 1
    v_lshlrev_b32 v8, 10, v8
    v_bfe_u32 v60, v0, 3, 1
    v_lshl_add_u32 v8, v60, 9, v8
    v_and_b32 v60, 3, v0
    v_lshl_add_u32 v8, v60, 7, v8
    v_add_u32 v8, s61, v8
    v_lshl_add_u32 v8, v9, 4, v8
    v_xor_b32 v9, 64, v8
    v_bfe_u32 v1, v0, 1, 1
    v_mul_u32_u24 v1, 43690, v1
    v_add_u32 v1, 17476, v1
    s_waitcnt vmcnt(31)
    s_barrier
    ds_read_b128 v[64:67], v8 offset:0
    ds_read_b128 v[68:71], v9 offset:0
    s_cmp_eq_u32 s30, 6
    s_cbranch_scc0 L_skip_13
    s_xor_b32 s57, s71, 0
    s_mul_i32 s57, s57, 196608
    s_add_u32 s57, s57, 1280
    s_xor_b32 s58, s71, 1
    s_mul_i32 s58, s58, 196608
    s_add_u32 s58, s58, 256
    s_mov_b32 m0, 124928
L_dma_14:
    s_waitcnt vmcnt(23)
    s_cmp_ge_u32 s70, 2
    s_cbranch_scc1 L_go_15
    s_waitcnt vmcnt(22)
    s_cmp_ge_u32 s70, 1
    s_cbranch_scc1 L_go_15
    s_waitcnt vmcnt(21)
L_go_15:
    buffer_load_dwordx4 v5, s[32:35], s57 offen offset:0 nt lds
    buffer_load_dwordx4 v6, s[32:35], s58 offen offset:1024 nt lds
    s_add_u32 s57, s57, 24576
    s_add_u32 s58, s58, 24576
    s_add_u32 m0, m0, 2048
    s_cmp_lg_u32 m0, 141312
    s_cbranch_scc1 L_dma_14
L_skip_13:
    s_waitcnt lgkmcnt(0)
    s_cmp_eq_u32 s30, 5
    s_cbranch_scc0 L_skip_16
    s_cmp_eq_u32 s52, 31
    s_cbranch_scc0 L_skip_17
    s_lshl_b32 s57, s31, 5
    v_mov_b32 v16, s57
    s_add_u32 s57, s63, 1
    v_mov_b32 v12, s57
    s_waitcnt vmcnt(4)
    s_mov_b64 exec, 0x1
    global_store_dword v16, v12, s[26:27] sc1
    s_mov_b64 exec, -1
L_skip_17:
L_skip_16:
    s_waitcnt vmcnt(31)
    s_barrier
    ds_read_b128 v[72:75], v8 offset:16384
    ds_read_b128 v[76:79], v9 offset:16384
    s_cmp_eq_u32 s30, 6
    s_cbranch_scc0 L_skip_18
    s_mov_b32 s57, 493568
    s_mov_b32 s58, 492672
    s_mov_b32 s59, 491776
    s_mov_b32 m0, 15360
L_dma_19:
    s_waitcnt vmcnt(23)
    s_cmp_ge_u32 s70, 2
    s_cbranch_scc1 L_go_20
    s_waitcnt vmcnt(22)
    s_cmp_ge_u32 s70, 1
    s_cbranch_scc1 L_go_20
    s_waitcnt vmcnt(21)
L_go_20:
    buffer_load_dwordx4 v2, s[44:47], s57 offen offset:0 nt lds
    buffer_load_dwordx4 v2, s[44:47], s58 offen offset:1024 nt lds
    buffer_load_dwordx4 v2, s[44:47], s59 offen offset:2048 nt lds
    s_add_u32 s57, s57, 98304
    s_add_u32 s58, s58, 98304
    s_add_u32 s59, s59, 98304
    s_add_u32 m0, m0, 3072
    s_cmp_lg_u32 m0, 30720
    s_cbranch_scc1 L_dma_19
    s_xor_b32 s57, s71, 2
    s_mul_i32 s57, s57, 196608
    s_add_u32 s57, s57, 1024
    s_xor_b32 s58, s71, 3
    s_mul_i32 s58, s58, 196608
    s_add_u32 s58, s58, 0
    s_mov_b32 m0, 141312
L_dma_21:
    s_waitcnt vmcnt(23)
    s_cmp_ge_u32 s70, 2
    s_cbranch_scc1 L_go_22
    s_waitcnt vmcnt(22)
    s_cmp_ge_u32 s70, 1
    s_cbranch_scc1 L_go_22
    s_waitcnt vmcnt(21)
L_go_22:
    buffer_load_dwordx4 v5, s[32:35], s57 offen offset:0 nt lds
    buffer_load_dwordx4 v6, s[32:35], s58 offen offset:1024 nt lds
    s_add_u32 s57, s57, 24576
    s_add_u32 s58, s58, 24576
    s_add_u32 m0, m0, 2048
    s_cmp_lg_u32 m0, 157696
    s_cbranch_scc1 L_dma_21
L_skip_18:
    s_waitcnt lgkmcnt(0)
    s_cmp_lt_u32 s30, 4
    s_cbranch_scc0 L_skip_23
    s_mov_b64 exec, 0
    s_cmp_eq_u32 s30, 1
    s_cbranch_scc1 L_pad1
    s_cmp_eq_u32 s30, 2
    s_cbranch_scc1 L_pad2
    s_cmp_eq_u32 s30, 3
    s_cbranch_scc1 L_pad3
    s_branch L_pad0
L_padback:
    s_mov_b64 exec, -1
L_skip_23:
    s_waitcnt vmcnt(31)
    s_barrier
    ds_read_b128 v[80:83], v8 offset:32768
    ds_read_b128 v[84:87], v9 offset:32768
    s_cmp_eq_u32 s30, 6
    s_cbranch_scc0 L_skip_24
    s_cmp_lg_u32 s53, 3
    s_cbranch_scc0 L_wb_25
    s_mul_i32 s57, s31, 983040
    s_lshl_b32 s58, s3, 6
    s_add_u32 s57, s57, s58
    v_bfe_u32 v38, v0, 4, 1
    v_lshlrev_b32 v38, 1, v38
    v_xor_b32 v38, v38, v0
    v_and_b32 v38, 3, v38
    v_lshrrev_b32 v3, 5, v0
    v_mul_u32_u24 v3, 10240, v3
    v_bfe_u32 v39, v0, 4, 1
    v_mul_u32_u24 v39, 2560, v39
    v_add_u32 v3, v39, v3
    v_bfe_u32 v39, v0, 3, 1
    v_mul_u32_u24 v39, 5120, v39
    v_add_u32 v3, v39, v3
    v_bfe_u32 v39, v0, 2, 1
    v_mul_u32_u24 v39, 20480, v39
    v_add_u32 v3, v39, v3
    v_add_u32 v3, s57, v3
    v_lshl_add_u32 v3, v38, 4, v3
    s_mov_b32 s14, 40960
    s_mov_b32 s15, 256
    s_branch L_we_26
L_wb_25:
    s_mul_i32 s57, s31, 384
    s_mul_i32 s58, s54, 245760
    s_add_u32 s57, s57, s58
    v_lshlrev_b32 v3, 4, v0
    v_add_u32 v3, s57, v3
    v_mov_b32 v38, 2688
    v_cmp_lt_u32 vcc, 23, v0
    s_nop 1
    v_cndmask_b32 v38, 0, v38, vcc
    v_add_u32 v3, v38, v3
    v_mov_b32 v38, 0x7f000000
    v_cmp_lt_u32 vcc, 47, v0
    s_nop 1
    v_cndmask_b32 v3, v3, v38, vcc
    s_mov_b32 s14, 12288
    s_mov_b32 s15, 5120
L_we_26:
    s_mul_i32 s57, s14, 0
    s_mov_b32 m0, 30720
    s_nop 0
    buffer_load_dwordx4 v3, s[48:51], s57 offen offset:0 nt lds
    s_mul_i32 s57, s14, 0
    s_add_u32 s57, s57, s15
    s_mov_b32 m0, 30720
    s_nop 0
    buffer_load_dwordx4 v3, s[48:51], s57 offen offset:1024 nt lds
    s_xor_b32 s57, s71, 2
    s_mul_i32 s57, s57, 196608
    s_add_u32 s57, s57, 1152
    s_xor_b32 s58, s71, 3
    s_mul_i32 s58, s58, 196608
    s_add_u32 s58, s58, 128
    s_mov_b32 m0, 92160
L_dma_27:
    s_waitcnt vmcnt(23)
    s_cmp_ge_u32 s70, 2
    s_cbranch_scc1 L_go_28
    s_waitcnt vmcnt(22)
    s_cmp_ge_u32 s70, 1
    s_cbranch_scc1 L_go_28
    s_waitcnt vmcnt(21)
L_go_28:
    buffer_load_dwordx4 v5, s[32:35], s57 offen offset:0 nt lds
    buffer_load_dwordx4 v6, s[32:35], s58 offen offset:1024 nt lds
    s_add_u32 s57, s57, 24576
    s_add_u32 s58, s58, 24576
    s_add_u32 m0, m0, 2048
    s_cmp_lg_u32 m0, 108544
    s_cbranch_scc1 L_dma_27
    s_mul_i32 s57, s14, 1
    s_mov_b32 m0, 32768
    s_nop 0
    buffer_load_dwordx4 v3, s[48:51], s57 offen offset:0 nt lds
    s_mul_i32 s57, s14, 1
    s_add_u32 s57, s57, s15
    s_mov_b32 m0, 32768
    s_nop 0
    buffer_load_dwordx4 v3, s[48:51], s57 offen offset:1024 nt lds
    s_xor_b32 s57, s71, 2
    s_mul_i32 s57, s57, 196608
    s_add_u32 s57, s57, 1280
    s_xor_b32 s58, s71, 3
    s_mul_i32 s58, s58, 196608
    s_add_u32 s58, s58, 256
    s_mov_b32 m0, 108544
L_dma_29:
    s_waitcnt vmcnt(23)
    s_cmp_ge_u32 s70, 2
    s_cbranch_scc1 L_go_30
    s_waitcnt vmcnt(22)
    s_cmp_ge_u32 s70, 1
    s_cbranch_scc1 L_go_30
    s_waitcnt vmcnt(21)
L_go_30:
    buffer_load_dwordx4 v5, s[32:35], s57 offen offset:0 nt lds
    buffer_load_dwordx4 v6, s[32:35], s58 offen offset:1024 nt lds
    s_add_u32 s57, s57, 24576
    s_add_u32 s58, s58, 24576
    s_add_u32 m0, m0, 2048
    s_cmp_lg_u32 m0, 124928
    s_cbranch_scc1 L_dma_29
L_skip_24:
    s_waitcnt lgkmcnt(0)
    s_cmp_lt_u32 s30, 5
    s_cbranch_scc0 L_skip_31
    s_waitcnt vmcnt(0)
L_skip_31:
    s_cmp_eq_u32 s30, 7
    s_cbranch_scc0 L_skip_32
    v_and_b32 v60, 31, v0
    v_cmp_gt_u32 s[64:65], 20, v60
    v_min_u32 v60, 19, v60
    v_lshrrev_b32 v35, 5, v0
    v_lshlrev_b32 v35, 2, v35
    v_add_u32 v35, 160832, v35
    v_lshl_add_u32 v35, v60, 3, v35
    s_mul_i32 s66, s53, 6400
    s_add_u32 s66, s66, s62
    s_add_u32 s66, s66, 58880
    s_add_u32 s67, s66, 6144
    s_lshl_b32 s57, s54, 3
    v_lshrrev_b32 v34, 5, v0
    v_lshlrev_b32 v34, 2, v34
    v_add_u32 v34, s57, v34
    v_and_b32 v60, 31, v0
    v_mov_b32 v61, 0x7f000000
    v_cmp_ne_u32 vcc, 31, v60
    s_nop 1
    v_cndmask_b32 v34, v34, v61, vcc
    v_mov_b32 v61, 0x3f803f80
    s_waitcnt vmcnt(0)
    ds_write_b32 v35, v28
    s_waitcnt lgkmcnt(0)
L_skip_32:
    s_cmp_eq_u32 s30, 5
    s_cbranch_scc0 L_skip_33
    s_waitcnt vmcnt(0)
    s_lshr_b32 s65, s63, 2
    s_sub_u32 s58, s3, 20
    s_cmp_lt_u32 s58, 4
    s_cbranch_scc0 L_skip_34
    s_mov_b32 s67, 0
    s_load_dword s66, s[10:11], 0
    s_load_dword s67, s[10:11], 8192
    s_waitcnt lgkmcnt(1)
    s_sleep 1
    s_mov_b32 s65, s67
L_skip_34:
L_skip_33:
    s_waitcnt vmcnt(36)
    s_barrier
    ds_read_b128 v[88:91], v8 offset:49152
    ds_read_b128 v[92:95], v9 offset:49152
    s_cmp_eq_u32 s30, 6
    s_cbranch_scc0 L_skip_35
    s_mul_i32 s57, s14, 2
    s_mov_b32 m0, 34816
    s_nop 0
    buffer_load_dwordx4 v3, s[48:51], s57 offen offset:0 nt lds
    s_mul_i32 s57, s14, 2
    s_add_u32 s57, s57, s15
    s_mov_b32 m0, 34816
    s_nop 0
    buffer_load_dwordx4 v3, s[48:51], s57 offen offset:1024 nt lds
    s_xor_b32 s57, s71, 4
    s_mul_i32 s57, s57, 196608
    s_add_u32 s57, s57, 1024
    s_xor_b32 s58, s71, 5
    s_mul_i32 s58, s58, 196608
    s_add_u32 s58, s58, 0
    s_mov_b32 m0, 124928
L_dma_36:
    s_waitcnt vmcnt(23)
    s_cmp_ge_u32 s70, 2
    s_cbranch_scc1 L_go_37
    s_waitcnt vmcnt(22)
    s_cmp_ge_u32 s70, 1
    s_cbranch_scc1 L_go_37
    s_waitcnt vmcnt(21)
L_go_37:
    buffer_load_dwordx4 v5, s[32:35], s57 offen offset:0 nt lds
    buffer_load_dwordx4 v6, s[32:35], s58 offen offset:1024 nt lds
    s_add_u32 s57, s57, 24576
    s_add_u32 s58, s58, 24576
    s_add_u32 m0, m0, 2048
    s_cmp_lg_u32 m0, 141312
    s_cbranch_scc1 L_dma_36
L_skip_35:
    s_waitcnt lgkmcnt(0)
    s_cmp_eq_u32 s30, 7
    s_cbranch_scc0 L_skip_38
    v_cndmask_b32 v29, 0, v28, s[64:65]
    v_dot2_f32_bf16 v33, v29, v61, 0
    v_dot2_f32_bf16 v32, v29, v29, 0
    v_lshlrev_b32 v2, 16, v28
    v_and_b32 v3, 0xffff0000, v28
    s_cmp_eq_u32 s55, 0
    v_permlane32_swap_b32 v33, v32
    v_add_f32 v33, v33, v32
    s_nop 1
    v_add_f32_dpp v33, v33, v33 row_ror:8 row_mask:0xf bank_mask:0xf
    s_nop 1
    v_add_f32_dpp v33, v33, v33 row_ror:4 row_mask:0xf bank_mask:0xf
    s_nop 1
    v_add_f32_dpp v33, v33, v33 row_ror:2 row_mask:0xf bank_mask:0xf
    s_nop 1
    v_add_f32_dpp v33, v33, v33 row_ror:1 row_mask:0xf bank_mask:0xf
    s_nop 1
    v_add_f32_dpp v33, v33, v33 row_bcast:15 row_mask:0xa bank_mask:0xf
    v_min_u32 v33, -2, v33
    s_cbranch_scc1 L_gs_39
    buffer_store_dword v33, v34, s[40:43], s67 offen
L_gb_40:
    s_waitcnt vmcnt(1)
L_skip_38:
    s_cmp_lt_u32 s30, 6
    s_cbranch_scc0 L_skip_41
    s_lshr_b32 s57, s30, 1
    s_mul_i32 s57, s57, 1024
    s_and_b32 s58, s30, 1
    s_lshl_b32 s58, s58, 6
    s_add_u32 s57, s57, s58
    v_lshrrev_b32 v18, 5, v0
    v_mul_u32_u24 v18, 6144, v18
    v_bfe_u32 v60, v0, 3, 1
    v_mul_u32_u24 v60, 3072, v60
    v_add_u32 v18, v60, v18
    v_bfe_u32 v60, v0, 4, 1
    v_lshl_add_u32 v18, v60, 9, v18
    v_bfe_u32 v60, v0, 2, 1
    v_lshl_add_u32 v18, v60, 7, v18
    v_and_b32 v60, 3, v0
    v_lshl_add_u32 v18, v60, 3, v18
    v_add_u32 v18, s57, v18
    v_bfe_u32 v19, v0, 4, 1
    v_mul_u32_u24 v19, 3072, v19
    v_bfe_u32 v60, v0, 3, 1
    v_lshl_add_u32 v19, v60, 9, v19
    v_bfe_u32 v60, v0, 2, 1
    v_lshl_add_u32 v19, v60, 7, v19
    v_and_b32 v60, 3, v0
    v_lshl_add_u32 v19, v60, 3, v19
    v_add_u32 v19, s57, v19
    v_add_u32 v19, 24576, v19
    ds_read_b64_tr_b16 v[28:29], v18 offset:0
    ds_read_b64_tr_b16 v[30:31], v18 offset:256
    ds_read_b64_tr_b16 v[32:33], v18 offset:12288
    ds_read_b64_tr_b16 v[34:35], v18 offset:12544
    ds_read_b64_tr_b16 v[36:37], v19 offset:0
    ds_read_b64_tr_b16 v[38:39], v19 offset:256
    ds_read_b64_tr_b16 v[40:41], v18 offset:32
    ds_read_b64_tr_b16 v[42:43], v18 offset:288
    ds_read_b64_tr_b16 v[44:45], v18 offset:12320
    ds_read_b64_tr_b16 v[46:47], v18 offset:12576
    ds_read_b64_tr_b16 v[48:49], v19 offset:32
    ds_read_b64_tr_b16 v[50:51], v19 offset:288
    v_lshrrev_b32 v52, 4, v0
    v_lshlrev_b32 v52, 5, v52
    v_bfe_u32 v60, v0, 1, 1
    v_lshl_add_u32 v52, v60, 4, v52
    v_and_b32 v60, 1, v0
    v_mul_u32_u24 v60, 192, v60
    v_add_u32 v52, v60, v52
    v_add_u32 v52, 160832, v52
    v_lshrrev_b32 v53, 4, v0
    v_lshlrev_b32 v53, 4, v53
    v_bfe_u32 v60, v0, 1, 1
    v_lshl_add_u32 v53, v60, 3, v53
    v_and_b32 v60, 1, v0
    v_mul_u32_u24 v60, 192, v60
    v_add_u32 v53, v60, v53
    v_add_u32 v53, 160960, v53
    v_mov_b64 v[20:21], 0
    v_mov_b64 v[22:23], 0
    v_mov_b64 v[24:25], 0
    v_mov_b64 v[26:27], 0
    s_lshl_b32 s57, s54, 1
    s_lshl_b32 s58, s30, 9
    s_add_u32 s57, s57, s58
    v_and_b32 v54, 31, v0
    v_lshlrev_b32 v54, 4, v54
    v_lshrrev_b32 v60, 5, v0
    v_mul_u32_u24 v60, 3072, v60
    v_add_u32 v54, v60, v54
    v_add_u32 v54, s57, v54
    s_mul_i32 s59, s53, 6400
    s_add_u32 s59, s59, s62
    s_add_u32 s59, s59, 58880
    s_add_u32 s60, s59, 6144
    ds_read_b128 v[12:15], v52
    ds_read_b64 v[16:17], v53
    s_waitcnt lgkmcnt(1)
    v_smfmac_f32_16x16x64_bf16 v[20:23], v[12:15], v[28:35], v1
    v_smfmac_f32_16x16x64_bf16 v[24:27], v[12:15], v[40:47], v1
    s_waitcnt lgkmcnt(0)
    v_smfmac_f32_16x16x32_bf16 v[20:23], v[16:17], v[36:39], v1
    v_smfmac_f32_16x16x32_bf16 v[24:27], v[16:17], v[48:51], v1
    s_cmp_eq_u32 s55, 0
    s_nop 5
    v_add_f32 v12, v20, v22
    s_nop 1
    v_add_f32_dpp v12, v24, v26 quad_perm:[0,1,2,3] row_mask:0x2 bank_mask:0xf
    s_nop 1
    v_add_f32_dpp v12, v21, v23 quad_perm:[0,1,2,3] row_mask:0x4 bank_mask:0xf
    s_nop 1
    v_add_f32_dpp v12, v25, v27 quad_perm:[0,1,2,3] row_mask:0x8 bank_mask:0xf
    v_cvt_pk_bf16_f32 v12, v12, v12
    v_min_u32 v12, -2, v12
    s_cbranch_scc1 L_gs_42
    buffer_store_short v12, v54, s[40:43], s59 offen
L_gb_43:
L_skip_41:
    s_cmp_eq_u32 s30, 5
    s_cbranch_scc0 L_skip_44
    global_load_dword v2, v3, s[26:27] sc1
L_skip_44:
    s_waitcnt vmcnt(36)
    s_barrier
    ds_read_b128 v[96:99], v8 offset:0
    ds_read_b128 v[100:103], v9 offset:0
    s_cmp_eq_u32 s30, 6
    s_cbranch_scc0 L_skip_45
    s_mul_i32 s57, s14, 3
    s_mov_b32 m0, 36864
    s_nop 0
    buffer_load_dwordx4 v3, s[48:51], s57 offen offset:0 nt lds
    s_mul_i32 s57, s14, 3
    s_add_u32 s57, s57, s15
    s_mov_b32 m0, 36864
    s_nop 0
    buffer_load_dwordx4 v3, s[48:51], s57 offen offset:1024 nt lds
    s_xor_b32 s57, s71, 4
    s_mul_i32 s57, s57, 196608
    s_add_u32 s57, s57, 1152
    s_xor_b32 s58, s71, 5
    s_mul_i32 s58, s58, 196608
    s_add_u32 s58, s58, 128
    s_mov_b32 m0, 141312
L_dma_46:
    s_waitcnt vmcnt(23)
    s_cmp_ge_u32 s70, 2
    s_cbranch_scc1 L_go_47
    s_waitcnt vmcnt(22)
    s_cmp_ge_u32 s70, 1
    s_cbranch_scc1 L_go_47
    s_waitcnt vmcnt(21)
L_go_47:
    buffer_load_dwordx4 v5, s[32:35], s57 offen offset:0 nt lds
    buffer_load_dwordx4 v6, s[32:35], s58 offen offset:1024 nt lds
    s_add_u32 s57, s57, 24576
    s_add_u32 s58, s58, 24576
    s_add_u32 m0, m0, 2048
    s_cmp_lg_u32 m0, 157696
    s_cbranch_scc1 L_dma_46
L_skip_45:
    s_waitcnt lgkmcnt(0)
    s_waitcnt vmcnt(36)
    s_barrier
    ds_read_b128 v[104:107], v8 offset:16384
    ds_read_b128 v[108:111], v9 offset:16384
    s_cmp_eq_u32 s30, 6
    s_cbranch_scc0 L_skip_48
    s_mul_i32 s57, s14, 4
    s_mov_b32 m0, 38912
    s_nop 0
    buffer_load_dwordx4 v3, s[48:51], s57 offen offset:0 nt lds
    s_mul_i32 s57, s14, 4
    s_add_u32 s57, s57, s15
    s_mov_b32 m0, 38912
    s_nop 0
    buffer_load_dwordx4 v3, s[48:51], s57 offen offset:1024 nt lds
    s_xor_b32 s57, s71, 4
    s_mul_i32 s57, s57, 196608
    s_add_u32 s57, s57, 1280
    s_xor_b32 s58, s71, 5
    s_mul_i32 s58, s58, 196608
    s_add_u32 s58, s58, 256
    s_mov_b32 m0, 92160
L_dma_49:
    s_waitcnt vmcnt(23)
    s_cmp_ge_u32 s70, 2
    s_cbranch_scc1 L_go_50
    s_waitcnt vmcnt(22)
    s_cmp_ge_u32 s70, 1
    s_cbranch_scc1 L_go_50
    s_waitcnt vmcnt(21)
L_go_50:
    buffer_load_dwordx4 v5, s[32:35], s57 offen offset:0 nt lds
    buffer_load_dwordx4 v6, s[32:35], s58 offen offset:1024 nt lds
    s_add_u32 s57, s57, 24576
    s_add_u32 s58, s58, 24576
    s_add_u32 m0, m0, 2048
    s_cmp_lg_u32 m0, 108544
    s_cbranch_scc1 L_dma_49
L_skip_48:
    s_waitcnt lgkmcnt(0)
    s_cmp_lg_u32 s30, 6
    s_cbranch_scc0 L_skip_51
    s_waitcnt vmcnt(0)
L_skip_51:
    s_waitcnt vmcnt(36)
    s_barrier
    ds_read_b128 v[112:115], v8 offset:32768
    ds_read_b128 v[116:119], v9 offset:32768
    s_cmp_eq_u32 s30, 6
    s_cbranch_scc0 L_skip_52
    s_mul_i32 s57, s14, 5
    s_mov_b32 m0, 40960
    s_nop 0
    buffer_load_dwordx4 v3, s[48:51], s57 offen offset:0 nt lds
    s_mul_i32 s57, s14, 5
    s_add_u32 s57, s57, s15
    s_mov_b32 m0, 40960
    s_nop 0
    buffer_load_dwordx4 v3, s[48:51], s57 offen offset:1024 nt lds
    s_xor_b32 s57, s71, 6
    s_mul_i32 s57, s57, 196608
    s_add_u32 s57, s57, 1024
    s_xor_b32 s58, s71, 7
    s_mul_i32 s58, s58, 196608
    s_add_u32 s58, s58, 0
    s_mov_b32 m0, 108544
L_dma_53:
    s_waitcnt vmcnt(23)
    s_cmp_ge_u32 s70, 2
    s_cbranch_scc1 L_go_54
    s_waitcnt vmcnt(22)
    s_cmp_ge_u32 s70, 1
    s_cbranch_scc1 L_go_54
    s_waitcnt vmcnt(21)
L_go_54:
    buffer_load_dwordx4 v5, s[32:35], s57 offen offset:0 nt lds
    buffer_load_dwordx4 v6, s[32:35], s58 offen offset:1024 nt lds
    s_add_u32 s57, s57, 24576
    s_add_u32 s58, s58, 24576
    s_add_u32 m0, m0, 2048
    s_cmp_lg_u32 m0, 124928
    s_cbranch_scc1 L_dma_53
L_skip_52:
    s_waitcnt lgkmcnt(0)
    s_cmp_eq_u32 s30, 5
    s_cbranch_scc0 L_skip_55
L_cw_56:
    v_readlane_b32 s57, v2, s31
    s_cmp_eq_u32 s57, 0
    s_cbranch_scc1 L_cr_57
    s_lshr_b32 s58, s63, 2
    s_xor_b32 s58, s58, s65
    s_and_b32 s58, s58, 1
    v_mov_b32 v25, s58
    s_sub_u32 s57, s57, 1
    s_cmp_eq_u32 s57, s63
    s_cselect_b32 s64, 1, 0
    s_cbranch_scc0 L_far_58
    s_lshl_b32 s57, s52, 2
    s_add_u32 s57, s57, s72
    s_mov_b64 exec, 1
    buffer_store_dword v25, v0, s[40:43], s57 offen offset:0
    s_mov_b64 exec, -1
L_fb_59:
L_skip_55:
    s_waitcnt vmcnt(36)
    s_barrier
    ds_read_b128 v[120:123], v8 offset:49152
    ds_read_b128 v[124:127], v9 offset:49152
    s_cmp_eq_u32 s30, 6
    s_cbranch_scc0 L_skip_60
    s_mul_i32 s57, s14, 6
    s_mov_b32 m0, 43008
    s_nop 0
    buffer_load_dwordx4 v3, s[48:51], s57 offen offset:0 nt lds
    s_mul_i32 s57, s14, 6
    s_add_u32 s57, s57, s15
    s_mov_b32 m0, 43008
    s_nop 0
    buffer_load_dwordx4 v3, s[48:51], s57 offen offset:1024 nt lds
    s_xor_b32 s57, s71, 6
    s_mul_i32 s57, s57, 196608
    s_add_u32 s57, s57, 1152
    s_xor_b32 s58, s71, 7
    s_mul_i32 s58, s58, 196608
    s_add_u32 s58, s58, 128
    s_mov_b32 m0, 124928
L_dma_61:
    s_waitcnt vmcnt(23)
    s_cmp_ge_u32 s70, 2
    s_cbranch_scc1 L_go_62
    s_waitcnt vmcnt(22)
    s_cmp_ge_u32 s70, 1
    s_cbranch_scc1 L_go_62
    s_waitcnt vmcnt(21)
L_go_62:
    buffer_load_dwordx4 v5, s[32:35], s57 offen offset:0 nt lds
    buffer_load_dwordx4 v6, s[32:35], s58 offen offset:1024 nt lds
    s_add_u32 s57, s57, 24576
    s_add_u32 s58, s58, 24576
    s_add_u32 m0, m0, 2048
    s_cmp_lg_u32 m0, 141312
    s_cbranch_scc1 L_dma_61
L_skip_60:
    s_waitcnt lgkmcnt(0)
    s_waitcnt vmcnt(36)
    s_barrier
    ds_read_b128 v[128:131], v8 offset:0
    ds_read_b128 v[132:135], v9 offset:0
    s_cmp_eq_u32 s30, 6
    s_cbranch_scc0 L_skip_63
    s_mul_i32 s57, s14, 7
    s_mov_b32 m0, 45056
    s_nop 0
    buffer_load_dwordx4 v3, s[48:51], s57 offen offset:0 nt lds
    s_mul_i32 s57, s14, 7
    s_add_u32 s57, s57, s15
    s_mov_b32 m0, 45056
    s_nop 0
    buffer_load_dwordx4 v3, s[48:51], s57 offen offset:1024 nt lds
    s_xor_b32 s57, s71, 6
    s_mul_i32 s57, s57, 196608
    s_add_u32 s57, s57, 1280
    s_xor_b32 s58, s71, 7
    s_mul_i32 s58, s58, 196608
    s_add_u32 s58, s58, 256
    s_mov_b32 m0, 141312
L_dma_64:
    s_waitcnt vmcnt(23)
    s_cmp_ge_u32 s70, 2
    s_cbranch_scc1 L_go_65
    s_waitcnt vmcnt(22)
    s_cmp_ge_u32 s70, 1
    s_cbranch_scc1 L_go_65
    s_waitcnt vmcnt(21)
L_go_65:
    buffer_load_dwordx4 v5, s[32:35], s57 offen offset:0 nt lds
    buffer_load_dwordx4 v6, s[32:35], s58 offen offset:1024 nt lds
    s_add_u32 s57, s57, 24576
    s_add_u32 s58, s58, 24576
    s_add_u32 m0, m0, 2048
    s_cmp_lg_u32 m0, 157696
    s_cbranch_scc1 L_dma_64
L_skip_63:
    s_waitcnt lgkmcnt(0)
    s_cmp_eq_u32 s30, 5
    s_cbranch_scc0 L_skip_66
    v_lshlrev_b32 v24, 2, v0
    buffer_load_dword v2, v24, s[40:43], s72 offen sc1
L_skip_66:
    s_waitcnt vmcnt(36)
    s_barrier
    ds_read_b128 v[136:139], v8 offset:16384
    ds_read_b128 v[140:143], v9 offset:16384
    s_cmp_eq_u32 s30, 6
    s_cbranch_scc0 L_skip_67
    s_mul_i32 s57, s14, 8
    s_mov_b32 m0, 47104
    s_nop 0
    buffer_load_dwordx4 v3, s[48:51], s57 offen offset:0 nt lds
    s_mul_i32 s57, s14, 8
    s_add_u32 s57, s57, s15
    s_mov_b32 m0, 47104
    s_nop 0
    buffer_load_dwordx4 v3, s[48:51], s57 offen offset:1024 nt lds
    s_xor_b32 s57, s71, 0
    s_mul_i32 s57, s57, 196608
    s_add_u32 s57, s57, 1024
    s_xor_b32 s58, s71, 2
    s_mul_i32 s58, s58, 196608
    s_add_u32 s58, s58, 0
    s_mov_b32 m0, 92160
L_dma_68:
    s_waitcnt vmcnt(23)
    s_cmp_ge_u32 s70, 2
    s_cbranch_scc1 L_go_69
    s_waitcnt vmcnt(22)
    s_cmp_ge_u32 s70, 1
    s_cbranch_scc1 L_go_69
    s_waitcnt vmcnt(21)
L_go_69:
    buffer_load_dwordx4 v7, s[36:39], s57 offen offset:0 nt lds
    buffer_load_dwordx4 v7, s[36:39], s58 offen offset:1024 nt lds
    s_add_u32 s57, s57, 24576
    s_add_u32 s58, s58, 24576
    s_add_u32 m0, m0, 2048
    s_cmp_lg_u32 m0, 108544
    s_cbranch_scc1 L_dma_68
L_skip_67:
    s_waitcnt lgkmcnt(0)
    s_waitcnt vmcnt(36)
    s_barrier
    ds_read_b128 v[144:147], v8 offset:32768
    ds_read_b128 v[148:151], v9 offset:32768
    s_cmp_eq_u32 s30, 6
    s_cbranch_scc0 L_skip_70
    s_mul_i32 s57, s14, 9
    s_mov_b32 m0, 49152
    s_nop 0
    buffer_load_dwordx4 v3, s[48:51], s57 offen offset:0 nt lds
    s_mul_i32 s57, s14, 9
    s_add_u32 s57, s57, s15
    s_mov_b32 m0, 49152
    s_nop 0
    buffer_load_dwordx4 v3, s[48:51], s57 offen offset:1024 nt lds
    s_xor_b32 s57, s71, 0
    s_mul_i32 s57, s57, 196608
    s_add_u32 s57, s57, 1152
    s_xor_b32 s58, s71, 2
    s_mul_i32 s58, s58, 196608
    s_add_u32 s58, s58, 128
    s_mov_b32 m0, 108544
L_dma_71:
    s_waitcnt vmcnt(23)
    s_cmp_ge_u32 s70, 2
    s_cbranch_scc1 L_go_72
    s_waitcnt vmcnt(22)
    s_cmp_ge_u32 s70, 1
    s_cbranch_scc1 L_go_72
    s_waitcnt vmcnt(21)
L_go_72:
    buffer_load_dwordx4 v7, s[36:39], s57 offen offset:0 nt lds
    buffer_load_dwordx4 v7, s[36:39], s58 offen offset:1024 nt lds
    s_add_u32 s57, s57, 24576
    s_add_u32 s58, s58, 24576
    s_add_u32 m0, m0, 2048
    s_cmp_lg_u32 m0, 124928
    s_cbranch_scc1 L_dma_71
L_skip_70:
    s_waitcnt lgkmcnt(0)
    s_cmp_eq_u32 s30, 5
    s_cbranch_scc0 L_skip_73
L_cw_74:
    s_waitcnt vmcnt(0)
    v_cmp_ne_u32 vcc, -1, v2
    s_mov_b32 s57, 0
    s_mov_b32 s68, 2
    s_cmp_eq_u32 s64, 0
    s_cbranch_scc1 L_cd_76
    s_cmp_lg_u32 vcc_hi, 0
    s_cbranch_scc1 L_cd_76
    s_cmp_lg_u32 vcc_lo, -1
    s_cbranch_scc1 L_cr_75
    v_cmp_eq_u32 vcc, 1, v2
    s_bcnt1_i32_b32 s68, vcc_lo
    s_mov_b32 s57, 1
L_cd_76:
    v_mov_b32 v37, 160768
    v_mov_b32 v38, s57
    ds_write_b32 v37, v38
    s_waitcnt lgkmcnt(0)
L_skip_73:
    s_waitcnt vmcnt(36)
    s_barrier
    ds_read_b128 v[152:155], v8 offset:49152
    ds_read_b128 v[156:159], v9 offset:49152
    s_cmp_eq_u32 s30, 6
    s_cbranch_scc0 L_skip_77
    s_mul_i32 s57, s14, 10
    s_mov_b32 m0, 51200
    s_nop 0
    buffer_load_dwordx4 v3, s[48:51], s57 offen offset:0 nt lds
    s_mul_i32 s57, s14, 10
    s_add_u32 s57, s57, s15
    s_mov_b32 m0, 51200
    s_nop 0
    buffer_load_dwordx4 v3, s[48:51], s57 offen offset:1024 nt lds
    s_xor_b32 s57, s71, 0
    s_mul_i32 s57, s57, 196608
    s_add_u32 s57, s57, 1280
    s_xor_b32 s58, s71, 2
    s_mul_i32 s58, s58, 196608
    s_add_u32 s58, s58, 256
    s_mov_b32 m0, 124928
L_dma_78:
    s_waitcnt vmcnt(23)
    s_cmp_ge_u32 s70, 2
    s_cbranch_scc1 L_go_79
    s_waitcnt vmcnt(22)
    s_cmp_ge_u32 s70, 1
    s_cbranch_scc1 L_go_79
    s_waitcnt vmcnt(21)
L_go_79:
    buffer_load_dwordx4 v7, s[36:39], s57 offen offset:0 nt lds
    buffer_load_dwordx4 v7, s[36:39], s58 offen offset:1024 nt lds
    s_add_u32 s57, s57, 24576
    s_add_u32 s58, s58, 24576
    s_add_u32 m0, m0, 2048
    s_cmp_lg_u32 m0, 141312
    s_cbranch_scc1 L_dma_78
L_skip_77:
    s_waitcnt lgkmcnt(0)
    v_lshrrev_b32 v8, 2, v0
    v_lshlrev_b32 v8, 7, v8
    v_bfe_u32 v60, v0, 3, 2
    v_lshl_add_u32 v8, v60, 5, v8
    v_and_b32 v60, 3, v0
    v_lshl_add_u32 v8, v60, 3, v8
    v_add_u32 v8, s61, v8
    v_xor_b32 v9, 32, v8
    v_xor_b32 v10, 64, v8
    v_xor_b32 v11, 96, v8
    v_mov_b32 v41, 160768
    ds_read_b32 v42, v41
    s_waitcnt lgkmcnt(0)
    v_readfirstlane_b32 s55, v42
    s_cmp_eq_u32 s55, 0
    s_cbranch_scc1 L_spread
L_spread_back:
    s_cmp_eq_u32 s30, 5
    s_cbranch_scc0 L_skip_91
    s_cmp_eq_u32 s52, 31
    s_cbranch_scc0 L_skip_92
    s_lshl_b32 s57, s31, 5
    v_mov_b32 v16, s57
    s_add_u32 s57, s68, 1
    v_mov_b32 v12, s57
    s_mov_b64 exec, 0x1
    global_store_dword v16, v12, s[26:27] offset:4 sc1
    s_mov_b64 exec, -1
L_skip_92:
L_skip_91:
    s_sub_u32 s58, s30, 1
    s_cmp_lt_u32 s58, 4
    s_cbranch_scc0 L_skip_93
    s_mul_i32 s59, s53, 6400
    s_add_u32 s59, s59, s62
    s_add_u32 s59, s59, 58880
    s_add_u32 s60, s59, 6144
    s_lshl_b32 s57, s58, 10
    v_lshlrev_b32 v16, 4, v0
    v_add_u32 v16, s57, v16
    v_and_b32 v17, 7, v0
    v_lshlrev_b32 v17, 3, v17
    s_cmp_eq_u32 s30, 4
    s_cbranch_scc0 L_skip_94
    buffer_load_dwordx2 v[12:13], v17, s[40:43], s60 offen sc1 nt
    s_branch L_skip_93
L_skip_94:
    buffer_load_dwordx4 v[12:15], v16, s[40:43], s59 offen sc1 nt
    buffer_load_dwordx4 v[20:23], v16, s[40:43], s59 offen offset:3072 sc1 nt
L_skip_93:
    s_waitcnt vmcnt(36)
    s_barrier
    ds_read_b64_tr_b16 v[160:161], v8 offset:0
    ds_read_b64_tr_b16 v[168:169], v9 offset:0
    ds_read_b64_tr_b16 v[176:177], v10 offset:0
    ds_read_b64_tr_b16 v[184:185], v11 offset:0
    s_cmp_eq_u32 s30, 6
    s_cbranch_scc0 L_skip_95
    s_mul_i32 s57, s14, 11
    s_mov_b32 m0, 53248
    s_nop 0
    buffer_load_dwordx4 v3, s[48:51], s57 offen offset:0 nt lds
    s_mul_i32 s57, s14, 11
    s_add_u32 s57, s57, s15
    s_mov_b32 m0, 53248
    s_nop 0
    buffer_load_dwordx4 v3, s[48:51], s57 offen offset:1024 nt lds
    s_xor_b32 s57, s71, 1
    s_mul_i32 s57, s57, 196608
    s_add_u32 s57, s57, 1024
    s_xor_b32 s58, s71, 3
    s_mul_i32 s58, s58, 196608
    s_add_u32 s58, s58, 0
    s_mov_b32 m0, 141312
L_dma_96:
    s_waitcnt vmcnt(23)
    s_cmp_ge_u32 s70, 2
    s_cbranch_scc1 L_go_97
    s_waitcnt vmcnt(22)
    s_cmp_ge_u32 s70, 1
    s_cbranch_scc1 L_go_97
    s_waitcnt vmcnt(21)
L_go_97:
    buffer_load_dwordx4 v7, s[36:39], s57 offen offset:0 nt lds
    buffer_load_dwordx4 v7, s[36:39], s58 offen offset:1024 nt lds
    s_add_u32 s57, s57, 24576
    s_add_u32 s58, s58, 24576
    s_add_u32 m0, m0, 2048
    s_cmp_lg_u32 m0, 157696
    s_cbranch_scc1 L_dma_96
L_skip_95:
    s_waitcnt lgkmcnt(0)
    s_waitcnt vmcnt(36)
    s_barrier
    ds_read_b64_tr_b16 v[192:193], v8 offset:16384
    ds_read_b64_tr_b16 v[200:201], v9 offset:16384
    ds_read_b64_tr_b16 v[208:209], v10 offset:16384
    ds_read_b64_tr_b16 v[216:217], v11 offset:16384
    s_cmp_eq_u32 s30, 6
    s_cbranch_scc0 L_skip_98
    s_mul_i32 s57, s14, 12
    s_mov_b32 m0, 55296
    s_nop 0
    buffer_load_dwordx4 v3, s[48:51], s57 offen offset:0 nt lds
    s_mul_i32 s57, s14, 12
    s_add_u32 s57, s57, s15
    s_mov_b32 m0, 55296
    s_nop 0
    buffer_load_dwordx4 v3, s[48:51], s57 offen offset:1024 nt lds
    s_xor_b32 s57, s71, 1
    s_mul_i32 s57, s57, 196608
    s_add_u32 s57, s57, 1152
    s_xor_b32 s58, s71, 3
    s_mul_i32 s58, s58, 196608
    s_add_u32 s58, s58, 128
    s_mov_b32 m0, 92160
L_dma_99:
    s_waitcnt vmcnt(23)
    s_cmp_ge_u32 s70, 2
    s_cbranch_scc1 L_go_100
    s_waitcnt vmcnt(22)
    s_cmp_ge_u32 s70, 1
    s_cbranch_scc1 L_go_100
    s_waitcnt vmcnt(21)
L_go_100:
    buffer_load_dwordx4 v7, s[36:39], s57 offen offset:0 nt lds
    buffer_load_dwordx4 v7, s[36:39], s58 offen offset:1024 nt lds
    s_add_u32 s57, s57, 24576
    s_add_u32 s58, s58, 24576
    s_add_u32 m0, m0, 2048
    s_cmp_lg_u32 m0, 108544
    s_cbranch_scc1 L_dma_99
L_skip_98:
    s_waitcnt lgkmcnt(0)
    s_sub_u32 s58, s30, 1
    s_cmp_lt_u32 s58, 4
    s_cbranch_scc0 L_skip_101
    s_waitcnt vmcnt(0)
    s_cmp_eq_u32 s30, 4
    s_cbranch_scc0 L_skip_102
    v_add_f32_dpp v12, v12, v12 row_ror:4 row_mask:0xf bank_mask:0xf
    v_add_f32_dpp v13, v13, v13 row_ror:4 row_mask:0xf bank_mask:0xf
    s_nop 0
    v_add_f32_dpp v12, v12, v12 row_ror:2 row_mask:0xf bank_mask:0xf
    v_add_f32_dpp v13, v13, v13 row_ror:2 row_mask:0xf bank_mask:0xf
    s_nop 0
    v_add_f32_dpp v12, v12, v12 row_ror:1 row_mask:0xf bank_mask:0xf
    v_add_f32_dpp v13, v13, v13 row_ror:1 row_mask:0xf bank_mask:0xf
    v_mul_f32 v12, 0x3acccccd, v12
    v_mul_f32 v13, 0x3acccccd, v13
    v_fma_f32 v13, -v12, v12, v13
    v_max_f32 v13, 0, v13
    v_add_f32 v13, 0x3727c5ac, v13
    v_rsq_f32 v13, v13
    s_nop 0
    v_mul_f32 v13, 0x3dd53b95, v13
    v_mul_f32 v12, -v12, v13
    v_mov_b32 v16, 160784
    ds_write_b64 v16, v[12:13]
    s_waitcnt lgkmcnt(0)
    s_branch L_skip_101
L_skip_102:
    s_lshl_b32 s57, s58, 7
    v_lshrrev_b32 v16, 4, v0
    v_lshlrev_b32 v16, 5, v16
    v_bfe_u32 v60, v0, 1, 1
    v_lshl_add_u32 v16, v60, 4, v16
    v_bfe_u32 v60, v0, 2, 2
    v_lshl_add_u32 v16, v60, 2, v16
    v_and_b32 v60, 1, v0
    v_lshl_add_u32 v16, v60, 1, v16
    v_add_u32 v16, s57, v16
    v_add_u32 v16, 157952, v16
    v_mov_b32 v17, 0x3f803f80
    v_dot2_f32_bf16 v24, v12, v17, 0
    v_dot2_f32_bf16 v25, v13, v17, 0
    v_dot2_f32_bf16 v24, v14, v17, v24
    v_dot2_f32_bf16 v25, v15, v17, v25
    s_nop 2
    v_add_f32 v24, v24, v25
    v_cvt_pk_bf16_f32 v24, v24, v24
    ds_write_b16 v16, v24 offset:0
    v_dot2_f32_bf16 v24, v20, v17, 0
    v_dot2_f32_bf16 v25, v21, v17, 0
    v_dot2_f32_bf16 v24, v22, v17, v24
    v_dot2_f32_bf16 v25, v23, v17, v25
    s_nop 2
    v_add_f32 v24, v24, v25
    v_cvt_pk_bf16_f32 v24, v24, v24
    ds_write_b16 v16, v24 offset:384
    s_waitcnt lgkmcnt(0)
L_skip_101:
    s_waitcnt vmcnt(36)
    s_barrier
    ds_read_b64_tr_b16 v[224:225], v8 offset:32768
    ds_read_b64_tr_b16 v[232:233], v9 offset:32768
    ds_read_b64_tr_b16 v[240:241], v10 offset:32768
    ds_read_b64_tr_b16 v[248:249], v11 offset:32768
    s_cmp_eq_u32 s30, 6
    s_cbranch_scc0 L_skip_103
    s_mul_i32 s57, s14, 13
    s_mov_b32 m0, 57344
    s_nop 0
    buffer_load_dwordx4 v3, s[48:51], s57 offen offset:0 nt lds
    s_mul_i32 s57, s14, 13
    s_add_u32 s57, s57, s15
    s_mov_b32 m0, 57344
    s_nop 0
    buffer_load_dwordx4 v3, s[48:51], s57 offen offset:1024 nt lds
    s_xor_b32 s57, s71, 1
    s_mul_i32 s57, s57, 196608
    s_add_u32 s57, s57, 1280
    s_xor_b32 s58, s71, 3
    s_mul_i32 s58, s58, 196608
    s_add_u32 s58, s58, 256
    s_mov_b32 m0, 108544
L_dma_104:
    s_nop 0
    buffer_load_dwordx4 v7, s[36:39], s57 offen offset:0 nt lds
    buffer_load_dwordx4 v7, s[36:39], s58 offen offset:1024 nt lds
    s_add_u32 s57, s57, 24576
    s_add_u32 s58, s58, 24576
    s_add_u32 m0, m0, 2048
    s_cmp_lg_u32 m0, 124928
    s_cbranch_scc1 L_dma_104
L_skip_103:
    s_waitcnt lgkmcnt(0)
    v_lshrrev_b32 v5, 4, v0
    v_lshlrev_b32 v5, 5, v5
    v_bfe_u32 v60, v0, 1, 1
    v_lshl_add_u32 v5, v60, 4, v5
    v_add_u32 v5, 157952, v5
    ds_read_b128 v[12:15], v5 offset:384
    ds_read_b128 v[16:19], v5 offset:512
    ds_read_b128 v[20:23], v5 offset:640
    s_lshl_b32 s57, s30, 7
    s_add_u32 s57, s57, 158720
    v_lshrrev_b32 v58, 4, v0
    v_lshlrev_b32 v58, 5, v58
    v_bfe_u32 v60, v0, 1, 1
    v_lshl_add_u32 v58, v60, 4, v58
    v_bfe_u32 v60, v0, 2, 2
    v_lshl_add_u32 v58, v60, 2, v58
    v_and_b32 v60, 1, v0
    v_lshl_add_u32 v58, v60, 1, v58
    v_add_u32 v58, s57, v58
    v_lshrrev_b32 v61, 4, v0
    v_lshlrev_b32 v61, 5, v61
    v_bfe_u32 v60, v0, 1, 1
    v_lshl_add_u32 v61, v60, 4, v61
    v_add_u32 v61, s57, v61
    v_bfe_u32 v62, v0, 2, 2
    v_lshlrev_b32 v62, 1, v62
    v_and_b32 v60, 1, v0
    v_lshl_add_u32 v62, v60, 0, v62
    v_mov_b32 v60, 160992
    v_cmp_eq_u32 vcc, 0, v62
    s_nop 1
    v_cndmask_b32 v52, v60, v61, vcc
    v_cmp_eq_u32 vcc, 1, v62
    s_nop 1
    v_cndmask_b32 v53, v60, v61, vcc
    v_cmp_eq_u32 vcc, 2, v62
    s_nop 1
    v_cndmask_b32 v54, v60, v61, vcc
    v_cmp_eq_u32 vcc, 3, v62
    s_nop 1
    v_cndmask_b32 v55, v60, v61, vcc
    v_cmp_eq_u32 vcc, 4, v62
    s_nop 1
    v_cndmask_b32 v56, v60, v61, vcc
    v_cmp_eq_u32 vcc, 5, v62
    s_nop 1
    v_cndmask_b32 v57, v60, v61, vcc
    s_lshl_b32 s58, s30, 2
    s_add_u32 s58, s58, 159744
    v_mov_b32 v60, s58
    v_lshlrev_b32 v59, 2, v0
    v_add_u32 v59, 157696, v59
    v_cmp_eq_u32 vcc, 63, v0
    s_nop 1
    v_cndmask_b32 v59, v59, v60, vcc
    v_and_b32 v62, 7, v0
    v_lshlrev_b32 v62, 2, v62
    v_add_u32 v62, 159744, v62
    s_lshl_b32 s57, s30, 11
    v_lshlrev_b32 v63, 4, v0
    v_add_u32 v63, s57, v63
    v_add_u32 v63, 92160, v63
    v_mov_b64 v[24:25], 0
    v_mov_b64 v[26:27], 0
    v_mov_b64 v[28:29], 0
    v_mov_b64 v[30:31], 0
    v_mov_b64 v[32:33], 0
    v_mov_b64 v[34:35], 0
    v_mov_b64 v[36:37], 0
    v_mov_b64 v[38:39], 0
    v_mov_b64 v[40:41], 0
    v_mov_b64 v[42:43], 0
    v_mov_b64 v[44:45], 0
    v_mov_b64 v[46:47], 0
    s_waitcnt lgkmcnt(0)
    v_smfmac_f32_16x16x64_bf16 v[24:27], v[12:15], v[64:71], v1
    v_smfmac_f32_16x16x64_bf16 v[24:27], v[16:19], v[72:79], v1
    v_smfmac_f32_16x16x64_bf16 v[24:27], v[20:23], v[80:87], v1
    v_smfmac_f32_16x16x64_bf16 v[28:31], v[12:15], v[88:95], v1
    v_smfmac_f32_16x16x64_bf16 v[28:31], v[16:19], v[96:103], v1
    v_smfmac_f32_16x16x64_bf16 v[28:31], v[20:23], v[104:111], v1
    v_smfmac_f32_16x16x64_bf16 v[32:35], v[12:15], v[112:119], v1
    v_smfmac_f32_16x16x64_bf16 v[32:35], v[16:19], v[120:127], v1
    v_smfmac_f32_16x16x64_bf16 v[32:35], v[20:23], v[128:135], v1
    v_smfmac_f32_16x16x64_bf16 v[36:39], v[12:15], v[136:143], v1
    v_smfmac_f32_16x16x64_bf16 v[36:39], v[16:19], v[144:151], v1
    v_smfmac_f32_16x16x64_bf16 v[36:39], v[20:23], v[152:159], v1
    v_add_f32_dpp v6, v24, v26 quad_perm:[0,1,2,3] row_mask:0x1 bank_mask:0xf
    s_nop 1
    v_add_f32_dpp v6, v28, v30 quad_perm:[0,1,2,3] row_mask:0x2 bank_mask:0xf
    s_nop 1
    v_add_f32_dpp v6, v32, v34 quad_perm:[0,1,2,3] row_mask:0x4 bank_mask:0xf
    s_nop 1
    v_add_f32_dpp v6, v36, v38 quad_perm:[0,1,2,3] row_mask:0x8 bank_mask:0xf
    s_waitcnt vmcnt(36)
    s_barrier
    ds_read_b64_tr_b16 v[162:163], v8 offset:49152
    ds_read_b64_tr_b16 v[170:171], v9 offset:49152
    ds_read_b64_tr_b16 v[178:179], v10 offset:49152
    ds_read_b64_tr_b16 v[186:187], v11 offset:49152
    s_cmp_eq_u32 s30, 6
    s_cbranch_scc0 L_skip_105
    s_mul_i32 s57, s14, 14
    s_mov_b32 m0, 59392
    s_nop 0
    buffer_load_dwordx4 v3, s[48:51], s57 offen offset:0 nt lds
    s_mul_i32 s57, s14, 14
    s_add_u32 s57, s57, s15
    s_mov_b32 m0, 59392
    s_nop 0
    buffer_load_dwordx4 v3, s[48:51], s57 offen offset:1024 nt lds
    s_xor_b32 s57, s71, 4
    s_mul_i32 s57, s57, 196608
    s_add_u32 s57, s57, 1024
    s_xor_b32 s58, s71, 6
    s_mul_i32 s58, s58, 196608
    s_add_u32 s58, s58, 0
    s_mov_b32 m0, 124928
L_dma_106:
    s_nop 0
    buffer_load_dwordx4 v7, s[36:39], s57 offen offset:0 nt lds
    buffer_load_dwordx4 v7, s[36:39], s58 offen offset:1024 nt lds
    s_add_u32 s57, s57, 24576
    s_add_u32 s58, s58, 24576
    s_add_u32 m0, m0, 2048
    s_cmp_lg_u32 m0, 141312
    s_cbranch_scc1 L_dma_106
L_skip_105:
    s_waitcnt lgkmcnt(0)
    v_mov_b32 v48, 160784
    ds_read_b128 v[12:15], v5 offset:0
    ds_read_b128 v[16:19], v5 offset:128
    ds_read_b128 v[20:23], v5 offset:256
    ds_read_b64 v[48:49], v48
    v_mov_b64 v[24:25], 0
    v_mov_b64 v[26:27], 0
    v_mov_b64 v[28:29], 0
    v_mov_b64 v[30:31], 0
    v_mov_b64 v[32:33], 0
    v_mov_b64 v[34:35], 0
    v_mov_b64 v[36:37], 0
    v_mov_b64 v[38:39], 0
    s_waitcnt lgkmcnt(0)
    v_smfmac_f32_16x16x64_bf16 v[24:27], v[12:15], v[64:71], v1
    v_smfmac_f32_16x16x64_bf16 v[24:27], v[16:19], v[72:79], v1
    v_smfmac_f32_16x16x64_bf16 v[24:27], v[20:23], v[80:87], v1
    v_smfmac_f32_16x16x64_bf16 v[28:31], v[12:15], v[88:95], v1
    v_smfmac_f32_16x16x64_bf16 v[28:31], v[16:19], v[96:103], v1
    v_smfmac_f32_16x16x64_bf16 v[28:31], v[20:23], v[104:111], v1
    v_smfmac_f32_16x16x64_bf16 v[32:35], v[12:15], v[112:119], v1
    v_smfmac_f32_16x16x64_bf16 v[32:35], v[16:19], v[120:127], v1
    v_smfmac_f32_16x16x64_bf16 v[32:35], v[20:23], v[128:135], v1
    v_smfmac_f32_16x16x64_bf16 v[36:39], v[12:15], v[136:143], v1
    v_smfmac_f32_16x16x64_bf16 v[36:39], v[16:19], v[144:151], v1
    v_smfmac_f32_16x16x64_bf16 v[36:39], v[20:23], v[152:159], v1
    v_add_f32_dpp v61, v24, v26 quad_perm:[0,1,2,3] row_mask:0x1 bank_mask:0xf
    v_mul_f32 v48, v48, v6
    s_nop 0
    v_add_f32_dpp v61, v28, v30 quad_perm:[0,1,2,3] row_mask:0x2 bank_mask:0xf
    s_nop 1
    v_add_f32_dpp v61, v32, v34 quad_perm:[0,1,2,3] row_mask:0x4 bank_mask:0xf
    s_nop 1
    v_add_f32_dpp v61, v36, v38 quad_perm:[0,1,2,3] row_mask:0x8 bank_mask:0xf
    v_fma_f32 v36, v61, v49, v48
    s_nop 1
    v_max_f32_dpp v37, v36, v36 row_ror:8 row_mask:0xf bank_mask:0xf
    s_nop 1
    v_max_f32_dpp v37, v37, v37 row_ror:4 row_mask:0xf bank_mask:0xf
    s_nop 1
    v_max_f32_dpp v37, v37, v37 row_ror:2 row_mask:0xf bank_mask:0xf
    s_nop 1
    v_max_f32_dpp v37, v37, v37 row_ror:1 row_mask:0xf bank_mask:0xf
    s_nop 1
    v_max_f32_dpp v37, v37, v37 row_bcast:15 row_mask:0xa bank_mask:0xf
    s_nop 1
    v_max_f32_dpp v37, v37, v37 row_bcast:31 row_mask:0xc bank_mask:0xf
    s_nop 0
    v_readlane_b32 s64, v37, 63
    ds_write_b32 v59, v37
    s_nop 0
    v_subrev_f32 v36, s64, v36
    v_exp_f32 v36, v36
    s_nop 0
    v_cvt_pk_bf16_f32 v39, v36, v36
    ds_write_b16 v58, v39
    ds_read_b128 v[12:15], v52
    ds_read_b128 v[16:19], v53
    ds_read_b128 v[20:23], v54
    ds_read_b128 v[24:27], v55
    ds_read_b128 v[28:31], v56
    ds_read_b128 v[32:35], v57
    v_add_f32_dpp v38, v36, v36 row_ror:8 row_mask:0xf bank_mask:0xf
    s_nop 1
    v_add_f32_dpp v38, v38, v38 row_ror:4 row_mask:0xf bank_mask:0xf
    s_nop 1
    v_add_f32_dpp v38, v38, v38 row_ror:2 row_mask:0xf bank_mask:0xf
    s_nop 1
    v_add_f32_dpp v38, v38, v38 row_ror:1 row_mask:0xf bank_mask:0xf
    s_nop 1
    v_add_f32_dpp v38, v38, v38 row_bcast:15 row_mask:0xa bank_mask:0xf
    s_nop 1
    v_add_f32_dpp v38, v38, v38 row_bcast:31 row_mask:0xc bank_mask:0xf
    s_waitcnt lgkmcnt(0)
    s_waitcnt vmcnt(36)
    s_barrier
    ds_read_b64_tr_b16 v[194:195], v8 offset:0
    ds_read_b64_tr_b16 v[202:203], v9 offset:0
    ds_read_b64_tr_b16 v[210:211], v10 offset:0
    ds_read_b64_tr_b16 v[218:219], v11 offset:0
    s_cmp_eq_u32 s30, 6
    s_cbranch_scc0 L_skip_107
    s_mul_i32 s57, s14, 15
    s_mov_b32 m0, 61440
    s_nop 0
    buffer_load_dwordx4 v3, s[48:51], s57 offen offset:0 nt lds
    s_mul_i32 s57, s14, 15
    s_add_u32 s57, s57, s15
    s_mov_b32 m0, 61440
    s_nop 0
    buffer_load_dwordx4 v3, s[48:51], s57 offen offset:1024 nt lds
    s_xor_b32 s57, s71, 4
    s_mul_i32 s57, s57, 196608
    s_add_u32 s57, s57, 1152
    s_xor_b32 s58, s71, 6
    s_mul_i32 s58, s58, 196608
    s_add_u32 s58, s58, 128
    s_mov_b32 m0, 141312
L_dma_108:
    s_waitcnt vmcnt(23)
    s_cmp_ge_u32 s70, 2
    s_cbranch_scc1 L_go_109
    s_waitcnt vmcnt(22)
    s_cmp_ge_u32 s70, 1
    s_cbranch_scc1 L_go_109
    s_waitcnt vmcnt(21)
L_go_109:
    buffer_load_dwordx4 v7, s[36:39], s57 offen offset:0 nt lds
    buffer_load_dwordx4 v7, s[36:39], s58 offen offset:1024 nt lds
    s_add_u32 s57, s57, 24576
    s_add_u32 s58, s58, 24576
    s_add_u32 m0, m0, 2048
    s_cmp_lg_u32 m0, 157696
    s_cbranch_scc1 L_dma_108
L_skip_107:
    s_waitcnt lgkmcnt(0)
    ds_read_b32 v36, v62
    s_waitcnt lgkmcnt(0)
    v_max_f32_dpp v37, v36, v36 row_ror:4 row_mask:0xf bank_mask:0xf
    s_nop 1
    v_max_f32_dpp v37, v37, v37 row_ror:2 row_mask:0xf bank_mask:0xf
    s_nop 1
    v_max_f32_dpp v37, v37, v37 row_ror:1 row_mask:0xf bank_mask:0xf
    v_sub_f32 v39, s64, v37
    v_exp_f32 v39, v39
    s_cmp_lt_u32 s30, 2
    s_cbranch_scc0 L_skip_110
    s_lshl_b32 s57, s30, 3
    v_lshlrev_b32 v2, 4, v0
    v_add_u32 v2, s57, v2
    v_add_u32 v2, 92160, v2
    v_mov_b32 v60, 94192
    v_cmp_le_u32 vcc, 48, v0
    s_nop 1
    v_cndmask_b32 v2, v2, v60, vcc
    s_lshr_b32 s57, s54, 1
    s_lshl_b32 s57, s57, 2
    s_and_b32 s58, s54, 1
    s_add_u32 s57, s57, s58
    s_lshl_b32 s58, s57, 4
    s_lshl_b32 s57, s57, 3
    v_bfe_u32 v3, v0, 3, 2
    v_lshlrev_b32 v3, 8, v3
    v_bfe_u32 v61, v0, 2, 1
    v_lshl_add_u32 v3, v61, 5, v3
    v_and_b32 v61, 3, v0
    v_lshl_add_u32 v3, v61, 2, v3
    v_add_u32 v3, s58, v3
    v_bfe_u32 v60, v0, 3, 1
    v_lshlrev_b32 v60, 8, v60
    v_bfe_u32 v61, v0, 1, 1
    v_lshl_add_u32 v60, v61, 7, v60
    v_bfe_u32 v61, v0, 2, 1
    v_lshl_add_u32 v60, v61, 4, v60
    v_and_b32 v61, 1, v0
    v_lshl_add_u32 v60, v61, 2, v60
    v_add_u32 v60, s57, v60
    v_add_u32 v60, 1024, v60
    v_cmp_gt_u32 vcc, 32, v0
    s_nop 1
    v_cndmask_b32 v3, v60, v3, vcc
    s_lshl_b32 s57, s53, 1
    s_add_u32 s57, s57, s30
    s_mul_i32 s57, s57, 1664
    s_add_u32 s57, s57, s62
    v_add_u32 v3, s57, v3
    v_mov_b32 v60, 0x7f000000
    v_cmp_le_u32 vcc, 48, v0
    s_nop 1
    v_cndmask_b32 v3, v3, v60, vcc
    s_lshl_b32 s58, s54, 2
    s_add_u32 s57, s57, s58
    s_add_u32 s57, s57, 1536
    v_mov_b32 v4, s57
    v_mov_b32 v60, 0x7f000000
    v_cmp_ne_u32 vcc, 48, v0
    s_nop 1
    v_cndmask_b32 v4, v4, v60, vcc
    s_mov_b32 s58, 0
    v_min_u32 v37, -2, v37
    s_cmp_eq_u32 s55, 0
    s_cbranch_scc1 L_gs_111
    buffer_store_dword v37, v4, s[40:43], s58 offen
L_gb_112:
L_skip_110:
    s_cmp_eq_u32 s30, 2
    s_cbranch_scc0 L_skip_113
    v_lshlrev_b32 v2, 2, v0
    v_add_u32 v2, 157696, v2
    v_and_b32 v3, 15, v0
    v_lshlrev_b32 v3, 2, v3
    v_lshrrev_b32 v60, 5, v0
    v_lshl_add_u32 v3, v60, 6, v3
    v_bfe_u32 v60, v0, 4, 1
    v_lshl_add_u32 v3, v60, 13, v3
L_skip_113:
    s_waitcnt vmcnt(36)
    s_barrier
    ds_read_b64_tr_b16 v[226:227], v8 offset:16384
    ds_read_b64_tr_b16 v[234:235], v9 offset:16384
    ds_read_b64_tr_b16 v[242:243], v10 offset:16384
    ds_read_b64_tr_b16 v[250:251], v11 offset:16384
    s_cmp_eq_u32 s30, 6
    s_cbranch_scc0 L_skip_114
    s_xor_b32 s57, s71, 4
    s_mul_i32 s57, s57, 196608
    s_add_u32 s57, s57, 1280
    s_xor_b32 s58, s71, 6
    s_mul_i32 s58, s58, 196608
    s_add_u32 s58, s58, 256
    s_mov_b32 m0, 92160
L_dma_115:
    s_nop 0
    buffer_load_dwordx4 v7, s[36:39], s57 offen offset:0 nt lds
    buffer_load_dwordx4 v7, s[36:39], s58 offen offset:1024 nt lds
    s_add_u32 s57, s57, 24576
    s_add_u32 s58, s58, 24576
    s_add_u32 m0, m0, 2048
    s_cmp_lg_u32 m0, 108544
    s_cbranch_scc1 L_dma_115
L_skip_114:
    s_waitcnt lgkmcnt(0)
    s_cmp_eq_u32 s30, 5
    s_cbranch_scc0 L_skip_116
    global_load_dword v2, v3, s[26:27] offset:4 sc1
L_skip_116:
    s_waitcnt vmcnt(34)
    s_barrier
    ds_read_b64_tr_b16 v[164:165], v8 offset:32768
    ds_read_b64_tr_b16 v[172:173], v9 offset:32768
    ds_read_b64_tr_b16 v[180:181], v10 offset:32768
    ds_read_b64_tr_b16 v[188:189], v11 offset:32768
    s_cmp_eq_u32 s30, 6
    s_cbranch_scc0 L_skip_117
    s_xor_b32 s57, s71, 5
    s_mul_i32 s57, s57, 196608
    s_add_u32 s57, s57, 1024
    s_xor_b32 s58, s71, 7
    s_mul_i32 s58, s58, 196608
    s_add_u32 s58, s58, 0
    s_mov_b32 m0, 108544
L_dma_118:
    s_nop 0
    buffer_load_dwordx4 v7, s[36:39], s57 offen offset:0 nt lds
    buffer_load_dwordx4 v7, s[36:39], s58 offen offset:1024 nt lds
    s_add_u32 s57, s57, 24576
    s_add_u32 s58, s58, 24576
    s_add_u32 m0, m0, 2048
    s_cmp_lg_u32 m0, 124928
    s_cbranch_scc1 L_dma_118
L_skip_117:
    s_waitcnt lgkmcnt(0)
    s_waitcnt vmcnt(32)
    s_barrier
    ds_read_b64_tr_b16 v[196:197], v8 offset:49152
    ds_read_b64_tr_b16 v[204:205], v9 offset:49152
    ds_read_b64_tr_b16 v[212:213], v10 offset:49152
    ds_read_b64_tr_b16 v[220:221], v11 offset:49152
    s_cmp_eq_u32 s30, 6
    s_cbranch_scc0 L_skip_119
    s_xor_b32 s57, s71, 5
    s_mul_i32 s57, s57, 196608
    s_add_u32 s57, s57, 1152
    s_xor_b32 s58, s71, 7
    s_mul_i32 s58, s58, 196608
    s_add_u32 s58, s58, 128
    s_mov_b32 m0, 124928
L_dma_120:
    s_nop 0
    buffer_load_dwordx4 v7, s[36:39], s57 offen offset:0 nt lds
    buffer_load_dwordx4 v7, s[36:39], s58 offen offset:1024 nt lds
    s_add_u32 s57, s57, 24576
    s_add_u32 s58, s58, 24576
    s_add_u32 m0, m0, 2048
    s_cmp_lg_u32 m0, 141312
    s_cbranch_scc1 L_dma_120
L_skip_119:
    s_waitcnt lgkmcnt(0)
    s_cmp_eq_u32 s30, 5
    s_cbranch_scc0 L_skip_121
L_cw_122:
    s_waitcnt vmcnt(0)
    v_cmp_eq_u32 vcc, 0, v2
    s_cbranch_vccnz L_cr_123
    v_add_u32_dpp v2, v2, v2 row_ror:4 row_mask:0xf bank_mask:0xf
    s_nop 1
    v_add_u32_dpp v2, v2, v2 row_ror:2 row_mask:0xf bank_mask:0xf
    s_nop 1
    v_add_u32_dpp v2, v2, v2 row_ror:1 row_mask:0xf bank_mask:0xf
    v_mov_b32 v60, 160772
    ds_write_b32 v60, v2
    s_waitcnt lgkmcnt(0)
L_skip_121:
    s_cmp_lt_u32 s3, 20
    s_cbranch_scc0 L_skip_124
    s_mul_i32 s74, s30, 1664
    s_add_u32 s74, s74, s62
    s_add_u32 s74, s74, 0
    v_and_b32 v56, 7, v0
    v_lshlrev_b32 v56, 2, v56
    v_lshrrev_b32 v62, 4, v0
    v_lshlrev_b32 v62, 3, v62
    s_cmp_lg_u32 s30, 6
    s_cbranch_scc0 L_skip_124
    buffer_load_dword v52, v56, s[40:43], s74 offen offset:1536 sc1
    buffer_load_dwordx2 v[54:55], v62, s[40:43], s74 offen offset:1536 sc1
L_skip_124:
    s_cmp_eq_u32 s30, 2
    s_cbranch_scc0 L_skip_125
    s_sub_u32 s57, s3, 20
    s_cmp_lt_u32 s57, 4
    s_cbranch_scc0 L_skip_126
    s_sub_u32 s57, s3, 20
    s_lshl_b32 s57, s57, 6
    v_add_u32 v50, s57, v0
    v_min_u32 v50, 210, v50
    v_lshlrev_b32 v50, 7, v50
    s_add_u32 s57, s62, 0
    buffer_load_dword v50, v50, s[40:43], s57 offen sc1 nt
    s_sub_u32 s57, s3, 20
    s_lshl_b32 s57, s57, 6
    v_add_u32 v51, s57, v0
    v_min_u32 v51, 247, v51
    v_lshlrev_b32 v51, 7, v51
    s_add_u32 s57, s62, 27008
    buffer_load_dword v51, v51, s[40:43], s57 offen sc1 nt
L_skip_126:
L_skip_125:
    s_waitcnt vmcnt(32)
    s_barrier
    ds_read_b64_tr_b16 v[228:229], v8 offset:0
    ds_read_b64_tr_b16 v[236:237], v9 offset:0
    ds_read_b64_tr_b16 v[244:245], v10 offset:0
    ds_read_b64_tr_b16 v[252:253], v11 offset:0
    s_cmp_eq_u32 s30, 6
    s_cbranch_scc0 L_skip_127
    s_xor_b32 s57, s71, 5
    s_mul_i32 s57, s57, 196608
    s_add_u32 s57, s57, 1280
    s_xor_b32 s58, s71, 7
    s_mul_i32 s58, s58, 196608
    s_add_u32 s58, s58, 256
    s_mov_b32 m0, 141312
L_dma_128:
    s_nop 0
    buffer_load_dwordx4 v7, s[36:39], s57 offen offset:0 nt lds
    buffer_load_dwordx4 v7, s[36:39], s58 offen offset:1024 nt lds
    s_add_u32 s57, s57, 24576
    s_add_u32 s58, s58, 24576
    s_add_u32 m0, m0, 2048
    s_cmp_lg_u32 m0, 157696
    s_cbranch_scc1 L_dma_128
L_skip_127:
    s_waitcnt lgkmcnt(0)
    s_cmp_ge_u32 s30, 6
    s_cbranch_scc0 L_skip_129
    v_mov_b32 v60, 160772
    ds_read_b32 v60, v60
    s_lshr_b32 s58, s63, 2
    s_waitcnt lgkmcnt(0)
    v_readfirstlane_b32 s57, v60
    s_cmp_gt_u32 s57, 24
    s_cselect_b32 s57, 1, 0
    s_xor_b32 s57, s57, s58
    s_lshl_b32 s57, s57, 13
    s_add_u32 s7, s8, s57
L_skip_129:
    s_branch L_tail
.p2align 10
L_tail:
L_pad0:
    s_cbranch_execz L_pad4
    s_waitcnt vmcnt(32)
    s_barrier
    ds_read_b64_tr_b16 v[166:167], v8 offset:16384
    ds_read_b64_tr_b16 v[174:175], v9 offset:16384
    ds_read_b64_tr_b16 v[182:183], v10 offset:16384
    ds_read_b64_tr_b16 v[190:191], v11 offset:16384
    s_waitcnt lgkmcnt(0)
    s_cmp_lt_u32 s30, 5
    s_cbranch_scc0 L_skip_130
    s_waitcnt vmcnt(0)
L_skip_130:
    s_cmp_lt_u32 s3, 20
    s_cbranch_scc0 L_skip_131
    v_lshlrev_b32 v57, 4, v0
    v_lshlrev_b32 v58, 3, v0
    s_mul_i32 s57, s30, 6144
    s_add_u32 s57, s57, 30720
    v_lshrrev_b32 v59, 2, v0
    v_lshlrev_b32 v59, 6, v59
    v_bfe_u32 v53, v0, 4, 1
    v_lshl_add_u32 v59, v53, 5, v59
    v_and_b32 v53, 3, v0
    v_lshl_add_u32 v59, v53, 3, v59
    v_add_u32 v59, s57, v59
    v_xor_b32 v60, 32, v59
    s_lshl_b32 s57, s30, 8
    s_add_u32 s57, s57, 157696
    v_lshl_add_u32 v61, v0, 2, s57
    s_cmp_lg_u32 s30, 6
    s_cbranch_scc0 L_skip_131
L_cw_132:
    s_waitcnt vmcnt(0)
    v_max3_u32 v53, v52, v54, v55
    v_cmp_eq_u32 vcc, -1, v53
    s_cbranch_vccnz L_cr_133
    v_max_f32_dpp v53, v52, v52 row_ror:4 row_mask:0xf bank_mask:0xf
    s_nop 1
    v_max_f32_dpp v53, v53, v53 row_ror:2 row_mask:0xf bank_mask:0xf
    s_nop 1
    v_max_f32_dpp v53, v53, v53 row_ror:1 row_mask:0xf bank_mask:0xf
    v_sub_f32 v52, v52, v53
    v_sub_f32 v54, v54, v53
    v_sub_f32 v55, v55, v53
    v_exp_f32 v52, v52
    v_exp_f32 v54, v54
    v_exp_f32 v55, v55
    s_cmp_eq_u32 s30, 7
    s_cbranch_scc0 L_skip_131
    v_add_u32 v62, 158720, v57
    ds_write_b128 v62, v[52:55]
    s_waitcnt lgkmcnt(0)
L_skip_131:
    v_smfmac_f32_16x16x64_bf16 v[40:43], v[12:15], v[160:167], v1
    v_smfmac_f32_16x16x64_bf16 v[40:43], v[16:19], v[168:175], v1
    v_smfmac_f32_16x16x64_bf16 v[40:43], v[20:23], v[176:183], v1
    v_smfmac_f32_16x16x64_bf16 v[40:43], v[24:27], v[184:191], v1
    s_cmp_eq_u32 s30, 6
    s_cbranch_scc0 L_skip_134
    s_mul_i32 s57, s14, 16
    s_add_u32 s58, s57, s15
    s_mov_b32 m0, 63488
L_dma_135:
    s_nop 0
    buffer_load_dwordx4 v3, s[48:51], s57 offen offset:0 nt lds
    buffer_load_dwordx4 v3, s[48:51], s58 offen offset:1024 nt lds
    s_add_u32 s57, s57, s14
    s_add_u32 s58, s58, s14
    s_add_u32 m0, m0, 2048
    s_cmp_lg_u32 m0, 71680
    s_cbranch_scc1 L_dma_135
    s_mul_i32 s57, s14, 20
    s_add_u32 s58, s57, s15
    s_mov_b32 m0, 71680
L_dma_136:
    s_nop 0
    buffer_load_dwordx4 v3, s[48:51], s57 offen offset:0 nt lds
    buffer_load_dwordx4 v3, s[48:51], s58 offen offset:1024 nt lds
    s_add_u32 s57, s57, s14
    s_add_u32 s58, s58, s14
    s_add_u32 m0, m0, 2048
    s_cmp_lg_u32 m0, 79872
    s_cbranch_scc1 L_dma_136
L_skip_134:
    s_waitcnt vmcnt(32)
    s_barrier
    ds_read_b64_tr_b16 v[198:199], v8 offset:32768
    ds_read_b64_tr_b16 v[206:207], v9 offset:32768
    ds_read_b64_tr_b16 v[214:215], v10 offset:32768
    ds_read_b64_tr_b16 v[222:223], v11 offset:32768
    s_waitcnt lgkmcnt(0)
    s_cmp_lt_u32 s3, 20
    s_cbranch_scc0 L_skip_137
    s_cmp_eq_u32 s30, 6
    s_cbranch_scc0 L_skip_137
    v_add_u32 v62, 158720, v57
    ds_read_b128 v[52:55], v62
L_skip_137:
L_pad1:
    s_cbranch_execz L_pad5
    v_smfmac_f32_16x16x64_bf16 v[40:43], v[28:31], v[192:199], v1
    v_smfmac_f32_16x16x64_bf16 v[40:43], v[32:35], v[200:207], v1
    v_smfmac_f32_16x16x64_bf16 v[44:47], v[12:15], v[208:215], v1
    v_smfmac_f32_16x16x64_bf16 v[44:47], v[16:19], v[216:223], v1
    v_mul_f32 v38, v38, v39
    ds_write_b32 v63, v38 offset:1024
    s_waitcnt vmcnt(16)
    s_barrier
    ds_read_b64_tr_b16 v[230:231], v8 offset:49152
    ds_read_b64_tr_b16 v[238:239], v9 offset:49152
    ds_read_b64_tr_b16 v[246:247], v10 offset:49152
    ds_read_b64_tr_b16 v[254:255], v11 offset:49152
    s_waitcnt lgkmcnt(0)
    v_smfmac_f32_16x16x64_bf16 v[44:47], v[20:23], v[224:231], v1
    v_smfmac_f32_16x16x64_bf16 v[44:47], v[24:27], v[232:239], v1
    v_smfmac_f32_16x16x64_bf16 v[44:47], v[28:31], v[240:247], v1
    v_smfmac_f32_16x16x64_bf16 v[44:47], v[32:35], v[248:255], v1
    s_setprio 0
    s_cmp_lt_u32 s30, 2
    v_pk_add_f32 v[40:41], v[40:41], v[42:43]
    s_nop 4
    v_pk_add_f32 v[42:43], v[44:45], v[46:47]
    v_pk_mul_f32 v[40:41], v[40:41], v[38:39] op_sel:[0,1] op_sel_hi:[1,1]
    v_pk_mul_f32 v[42:43], v[42:43], v[38:39] op_sel:[0,1] op_sel_hi:[1,1]
    ds_write_b128 v63, v[40:43]
    s_cbranch_scc1 L_comb_0
    s_waitcnt lgkmcnt(0)
    s_barrier
L_comb_0b:
    s_cmp_eq_u32 s30, 6
    s_cbranch_scc0 L_skip_142
    s_waitcnt vmcnt(0)
L_skip_142:
    s_barrier
    s_cmp_lt_u32 s3, 20
    s_cbranch_scc0 L_typeB_0
    buffer_load_dwordx4 v[12:15], v57, s[40:43], s74 offen sc1
    buffer_load_dwordx2 v[16:17], v58, s[40:43], s74 offen offset:1024 sc1
    buffer_load_dword v18, v56, s[40:43], s74 offen offset:1568 sc1
    ds_read_b64_tr_b16 v[28:29], v59 offset:0
    ds_read_b64_tr_b16 v[30:31], v59 offset:1024
    ds_read_b64_tr_b16 v[32:33], v59 offset:2048
    ds_read_b64_tr_b16 v[34:35], v59 offset:3072
    ds_read_b64_tr_b16 v[36:37], v59 offset:4096
    ds_read_b64_tr_b16 v[38:39], v59 offset:5120
    ds_read_b64_tr_b16 v[40:41], v60 offset:0
    ds_read_b64_tr_b16 v[42:43], v60 offset:1024
    ds_read_b64_tr_b16 v[44:45], v60 offset:2048
    ds_read_b64_tr_b16 v[46:47], v60 offset:3072
    ds_read_b64_tr_b16 v[48:49], v60 offset:4096
    ds_read_b64_tr_b16 v[50:51], v60 offset:5120
    v_mov_b64 v[20:21], 0
    v_mov_b64 v[22:23], 0
    v_mov_b64 v[24:25], 0
    v_mov_b64 v[26:27], 0
    s_add_u32 s58, s6, 0
    s_waitcnt lgkmcnt(0)
    s_branch L_pw_143
L_pr_144:
    buffer_load_dwordx4 v[12:15], v57, s[40:43], s74 offen sc1
    buffer_load_dwordx2 v[16:17], v58, s[40:43], s74 offen offset:1024 sc1
    buffer_load_dword v18, v56, s[40:43], s74 offen offset:1568 sc1
    s_sub_u32 s56, s56, 1
    s_cbranch_scc1 L_done
L_pw_143:
    s_waitcnt vmcnt(0)
    v_max3_u32 v19, v12, v13, v14
    v_max3_u32 v19, v19, v15, v16
    v_max3_u32 v19, v19, v17, v18
    v_cmp_eq_u32 vcc, -1, v19
    s_cbranch_vccnz L_pr_144
    v_smfmac_f32_16x16x64_bf16 v[20:23], v[12:15], v[28:35], v1
    v_mul_f32 v52, v52, v18
    v_smfmac_f32_16x16x64_bf16 v[24:27], v[12:15], v[40:47], v1
    v_smfmac_f32_16x16x32_bf16 v[20:23], v[16:17], v[36:39], v1
    v_add_f32_dpp v52, v52, v52 row_ror:4 row_mask:0xf bank_mask:0xf
    v_smfmac_f32_16x16x32_bf16 v[24:27], v[16:17], v[48:51], v1
    s_cmp_eq_u32 s30, 2
    v_add_f32_dpp v52, v52, v52 row_ror:2 row_mask:0xf bank_mask:0xf
    s_nop 1
    v_add_f32_dpp v52, v52, v52 row_ror:1 row_mask:0xf bank_mask:0xf
    v_rcp_f32 v52, v52
    v_pk_add_f32 v[20:21], v[20:21], v[22:23]
    s_nop 0
L_pad2:
    s_cbranch_execz L_pad6
    v_pk_add_f32 v[24:25], v[24:25], v[26:27]
    v_pk_mul_f32 v[54:55], v[54:55], v[52:53] op_sel:[0,0] op_sel_hi:[1,0]
    v_mul_f32 v20, v20, v54
    v_mul_f32 v24, v24, v54
    v_fmac_f32 v20, v21, v55
    v_fmac_f32 v24, v25, v55
    s_nop 1
    v_permlane32_swap_b32 v20, v24
    v_add_f32 v20, v20, v24
    ds_write_b32 v61, v20
    s_waitcnt lgkmcnt(0)
    s_barrier
    s_cbranch_scc0 L_finb_145
    ds_read2st64_b32 v[12:13], v2 offset0:0 offset1:1
    ds_read2st64_b32 v[14:15], v2 offset0:2 offset1:3
    ds_read2st64_b32 v[16:17], v2 offset0:4 offset1:5
    ds_read2st64_b32 v[18:19], v2 offset0:6 offset1:7
    s_waitcnt lgkmcnt(2)
    v_pk_add_f32 v[12:13], v[12:13], v[14:15]
    s_waitcnt lgkmcnt(0)
    v_pk_add_f32 v[16:17], v[16:17], v[18:19]
    v_pk_add_f32 v[12:13], v[12:13], v[16:17]
    v_add_f32 v14, v12, v13
    v_add_f32 v15, v12, v13
    s_nop 1
    v_permlane16_swap_b32 v14, v15
    v_add_f32 v12, v14, v15
    v_min_u32 v12, -2, v12
    buffer_store_dword v12, v3, s[40:43], s58 offen sc1
L_finb_145:
    s_sub_u32 s57, s30, 4
    s_cmp_lt_u32 s57, 3
    s_cbranch_scc0 L_skip_146
    s_sub_u32 s60, s30, 4
    s_lshl_b32 s59, s60, 12
    s_add_u32 s59, s59, 79872
    s_lshl_b32 s57, s60, 11
    v_lshlrev_b32 v11, 4, v0
    v_add_u32 v11, s57, v11
    s_add_u32 s58, s62, 19456
    buffer_load_dwordx4 v[12:15], v11, s[40:43], s58 offen offset:0 sc1
    buffer_load_dwordx4 v[16:19], v11, s[40:43], s58 offen offset:1024 sc1
    s_mov_b32 s44, s20
    s_mov_b32 s45, s21
    s_mov_b32 s46, 1966080
    s_mov_b32 s47, 0x20000
    s_mul_i32 s57, s31, 3
    s_add_u32 s57, s57, s60
    s_mul_i32 s57, s57, 81920
    s_lshl_b32 s64, s3, 6
    s_add_u32 s57, s57, s64
    v_lshrrev_b32 v5, 2, v0
    v_mul_u32_u24 v5, 1280, v5
    v_and_b32 v60, 3, v0
    v_lshl_add_u32 v5, v60, 4, v5
    v_add_u32 v5, s57, v5
    s_add_u32 m0, s59, 0
    s_mov_b32 s57, 0
    buffer_load_dwordx4 v5, s[44:47], s57 offen nt lds
    s_add_u32 m0, s59, 1024
    s_mov_b32 s57, 20480
    buffer_load_dwordx4 v5, s[44:47], s57 offen nt lds
    s_add_u32 m0, s59, 2048
    s_mov_b32 s57, 40960
    buffer_load_dwordx4 v5, s[44:47], s57 offen nt lds
    s_add_u32 m0, s59, 3072
    s_mov_b32 s57, 61440
    buffer_load_dwordx4 v5, s[44:47], s57 offen nt lds
    v_lshrrev_b32 v35, 4, v0
    v_lshlrev_b32 v35, 9, v35
    v_bfe_u32 v60, v0, 2, 2
    v_lshl_add_u32 v35, v60, 6, v35
    v_and_b32 v60, 3, v0
    v_lshl_add_u32 v35, v60, 3, v35
    v_add_u32 v35, s59, v35
    s_waitcnt vmcnt(4)
L_sw_147:
    v_max3_u32 v60, v12, v13, v14
    v_max3_u32 v60, v60, v15, v16
    v_max3_u32 v60, v60, v17, v18
    v_max_u32 v60, v60, v19
    v_cmp_eq_u32 vcc, -1, v60
    s_cbranch_vccnz L_sr_148
    v_pk_add_f32 v[20:21], v[12:13], v[14:15]
    v_pk_add_f32 v[22:23], v[16:17], v[18:19]
    v_pk_add_f32 v[20:21], v[20:21], v[22:23]
    v_add_f32 v8, v20, v21
    v_mov_b64 v[52:53], 0
    v_mov_b64 v[54:55], 0
    v_mov_b64 v[56:57], 0
L_pad3:
    s_cbranch_execz L_pad7
    v_mov_b64 v[58:59], 0
    v_mov_b32 v9, 0xbdd2d3e8
    v_mov_b32 v10, 0xc0135761
    s_lshl_b32 s57, s60, 7
    s_add_u32 s57, s57, 159872
    v_lshlrev_b32 v32, 3, v0
    v_add_u32 v32, s57, v32
    v_lshlrev_b32 v33, 3, v0
    v_add_u32 v33, 129024, v33
    v_cmp_gt_u32 vcc, 16, v0
    s_nop 1
    v_cndmask_b32 v32, v33, v32, vcc
    v_and_b32 v33, 15, v0
    v_lshlrev_b32 v33, 3, v33
    v_lshrrev_b32 v60, 5, v0
    v_lshl_add_u32 v33, v60, 2, v33
    v_add_u32 v33, 159872, v33
    v_and_b32 v34, 15, v0
    v_lshlrev_b32 v34, 2, v34
    v_lshrrev_b32 v60, 5, v0
    v_lshl_add_u32 v34, v60, 6, v34
    v_bfe_u32 v60, v0, 4, 1
    v_lshl_add_u32 v34, v60, 13, v34
    s_add_u32 s60, s6, 131072
    s_add_u32 s59, s60, 16384
    s_lshl_b32 s74, s3, 2
    s_add_u32 s74, s74, s62
    s_add_u32 s74, s74, 26496
    s_xor_b32 s75, s30, 4
    s_lshl_b32 s75, s75, 24
    v_and_b32 v5, 3, v0
    v_lshlrev_b32 v5, 7, v5
    v_lshrrev_b32 v60, 2, v0
    v_lshl_add_u32 v5, v60, 24, v5
    v_add_u32 v5, s75, v5
    s_add_u32 s58, s62, 13312
    s_add_u32 s57, s62, 25856
    v_and_b32 v7, 7, v0
    v_lshlrev_b32 v7, 3, v7
    buffer_load_dwordx2 v[24:25], v7, s[40:43], s57 offen sc1
    buffer_load_dwordx4 v[12:15], v11, s[40:43], s58 offen offset:0 sc1
    buffer_load_dwordx4 v[16:19], v11, s[40:43], s58 offen offset:1024 sc1
    s_waitcnt vmcnt(3)
    ds_read_b64_tr_b16 v[36:37], v35 offset:0
    ds_read_b64_tr_b16 v[38:39], v35 offset:256
    ds_read_b64_tr_b16 v[40:41], v35 offset:2048
    ds_read_b64_tr_b16 v[42:43], v35 offset:2304
    ds_read_b64_tr_b16 v[44:45], v35 offset:32
    ds_read_b64_tr_b16 v[46:47], v35 offset:288
    ds_read_b64_tr_b16 v[48:49], v35 offset:2080
    ds_read_b64_tr_b16 v[50:51], v35 offset:2336
    s_waitcnt lgkmcnt(0)
L_pr_150:
    buffer_load_dwordx2 v[24:25], v7, s[40:43], s57 offen sc1
    buffer_load_dwordx4 v[12:15], v11, s[40:43], s58 offen offset:0 sc1
    buffer_load_dwordx4 v[16:19], v11, s[40:43], s58 offen offset:1024 sc1
    s_sub_u32 s56, s56, 1
    s_cbranch_scc1 L_done
L_pw_149:
    s_waitcnt vmcnt(5)
    v_max_u32 v26, v24, v25
    v_cmp_eq_u32 vcc, -1, v26
    s_cbranch_vccnz L_pr_150
    buffer_load_dwordx4 v[12:15], v11, s[40:43], s58 offen offset:0 sc1
    buffer_load_dwordx4 v[16:19], v11, s[40:43], s58 offen offset:1024 sc1
    v_add_f32_dpp v2, v24, v24 row_ror:4 row_mask:0xf bank_mask:0xf
    v_add_f32_dpp v3, v25, v25 row_ror:4 row_mask:0xf bank_mask:0xf
    s_nop 0
    v_add_f32_dpp v2, v2, v2 row_ror:2 row_mask:0xf bank_mask:0xf
    v_add_f32_dpp v3, v3, v3 row_ror:2 row_mask:0xf bank_mask:0xf
    s_nop 0
    v_add_f32_dpp v2, v2, v2 row_ror:1 row_mask:0xf bank_mask:0xf
    v_add_f32_dpp v3, v3, v3 row_ror:1 row_mask:0xf bank_mask:0xf
    v_mul_f32 v2, 0x3acccccd, v2
    v_mul_f32 v3, 0x3acccccd, v3
    v_fma_f32 v3, -v2, v2, v3
    v_max_f32 v3, 0, v3
    v_add_f32 v3, 0x3727c5ac, v3
    v_rsq_f32 v3, v3
    s_nop 0
    v_mul_f32 v2, v2, v3
    v_fma_f32 v8, -v2, v8, v4
    s_waitcnt vmcnt(5)
L_hw_151:
    v_pk_add_f32 v[20:21], v[12:13], v[14:15]
    v_pk_add_f32 v[22:23], v[16:17], v[18:19]
L_pad4:
    s_cbranch_execz L_pad8
    v_pk_add_f32 v[20:21], v[20:21], v[22:23]
    v_add_f32 v20, v20, v21
    v_cmp_u_f32 vcc, v20, v20
    v_fma_f32 v20, v20, v3, v8
    s_cbranch_vccnz L_hr_152
L_hk_153:
    v_mul_f32 v21, v20, v20
    v_fma_f32 v21, v21, v9, v10
    v_mul_f32 v21, v21, v20
    v_exp_f32 v21, v21
    s_cmp_eq_u32 s55, 0
    v_add_f32 v21, 1.0, v21
    v_rcp_f32 v21, v21
    s_nop 0
    v_mul_f32 v20, v20, v21
    s_nop 1
    v_mov_b32_dpp v21, v20 row_shl:1 row_mask:0xf bank_mask:0xf bound_ctrl:0
    v_cvt_pk_bf16_f32 v28, v20, v21
    s_nop 1
    v_mov_b32_dpp v29, v28 row_shl:4 row_mask:0xf bank_mask:0xf bound_ctrl:0
    v_mov_b32_dpp v30, v28 row_shl:8 row_mask:0xf bank_mask:0xf bound_ctrl:0
    v_mov_b32_dpp v31, v28 row_shl:12 row_mask:0xf bank_mask:0xf bound_ctrl:0
    s_nop 1
    v_smfmac_f32_16x16x64_bf16 v[52:55], v[28:31], v[36:43], v1
    v_smfmac_f32_16x16x64_bf16 v[56:59], v[28:31], v[44:51], v1
    s_nop 6
    v_add_f32 v22, v52, v54
    v_add_f32 v23, v56, v58
    ds_write_b64 v32, v[22:23]
    s_cmp_eq_u32 s30, 4
    s_cbranch_scc0 L_skip_155
L_xw_156:
    ds_read2_b32 v[20:21], v33 offset0:0 offset1:32
    ds_read_b32 v22, v33 offset:256
    s_cmp_eq_u32 s55, 0
    s_waitcnt lgkmcnt(0)
    v_max3_u32 v23, v20, v21, v22
    v_add_f32 v20, v20, v21
    v_cmp_eq_u32 vcc, -1, v23
    v_add_f32 v20, v20, v22
    s_cbranch_vccnz L_xr_157
    v_min_u32 v20, -2, v20
    buffer_store_dword v20, v34, s[40:43], s60 offen sc1
    s_waitcnt vmcnt(1)
    s_branch L_pe_158
L_skip_155:
    s_waitcnt vmcnt(0)
L_pe_158:
L_skip_146:
    s_branch L_p1
L_typeB_0:
    s_cmp_eq_u32 s53, 3
    s_cbranch_scc0 L_typeC_159
    s_cmp_eq_u32 s30, 7
    s_cbranch_scc1 L_w7_169
    s_cmp_lt_u32 s30, 6
    s_cbranch_scc0 L_skip_171
    s_lshr_b32 s57, s30, 1
    s_mul_i32 s57, s57, 128
    s_and_b32 s58, s30, 1
    s_lshl_b32 s58, s58, 6
    s_add_u32 s57, s57, s58
    v_lshrrev_b32 v18, 5, v0
    v_lshlrev_b32 v18, 13, v18
    v_bfe_u32 v60, v0, 3, 1
    v_lshl_add_u32 v18, v60, 12, v18
    v_bfe_u32 v60, v0, 4, 1
    v_lshl_add_u32 v18, v60, 11, v18
    v_bfe_u32 v60, v0, 2, 1
    v_mul_u32_u24 v60, 384, v60
    v_add_u32 v18, v60, v18
    v_and_b32 v60, 3, v0
    v_lshl_add_u32 v18, v60, 3, v18
    v_add_u32 v18, s57, v18
    v_add_u32 v18, 30720, v18
    v_bfe_u32 v19, v0, 4, 1
    v_lshlrev_b32 v19, 12, v19
    v_bfe_u32 v60, v0, 3, 1
    v_lshl_add_u32 v19, v60, 11, v19
    v_bfe_u32 v60, v0, 2, 1
    v_mul_u32_u24 v60, 384, v60
    v_add_u32 v19, v60, v19
    v_and_b32 v60, 3, v0
    v_lshl_add_u32 v19, v60, 3, v19
    v_add_u32 v19, s57, v19
    v_add_u32 v19, 63488, v19
    ds_read_b64_tr_b16 v[28:29], v18 offset:0
    ds_read_b64_tr_b16 v[30:31], v18 offset:1024
    ds_read_b64_tr_b16 v[32:33], v18 offset:16384
    ds_read_b64_tr_b16 v[34:35], v18 offset:17408
    ds_read_b64_tr_b16 v[36:37], v19 offset:0
    ds_read_b64_tr_b16 v[38:39], v19 offset:1024
    ds_read_b64_tr_b16 v[40:41], v18 offset:32
    ds_read_b64_tr_b16 v[42:43], v18 offset:1056
L_pad5:
    s_cbranch_execz L_pad9
    ds_read_b64_tr_b16 v[44:45], v18 offset:16416
    ds_read_b64_tr_b16 v[46:47], v18 offset:17440
    ds_read_b64_tr_b16 v[48:49], v19 offset:32
    ds_read_b64_tr_b16 v[50:51], v19 offset:1056
    v_lshrrev_b32 v9, 4, v0
    v_lshlrev_b32 v9, 5, v9
    v_bfe_u32 v60, v0, 1, 1
    v_lshl_add_u32 v9, v60, 4, v9
    v_and_b32 v60, 1, v0
    v_mul_u32_u24 v60, 192, v60
    v_add_u32 v9, v60, v9
    v_add_u32 v9, 160832, v9
    v_lshrrev_b32 v10, 4, v0
    v_lshlrev_b32 v10, 4, v10
    v_bfe_u32 v60, v0, 1, 1
    v_lshl_add_u32 v10, v60, 3, v10
    v_and_b32 v60, 1, v0
    v_mul_u32_u24 v60, 192, v60
    v_add_u32 v10, v60, v10
    v_add_u32 v10, 160960, v10
    v_mov_b64 v[20:21], 0
    v_mov_b64 v[22:23], 0
    v_mov_b64 v[24:25], 0
    v_mov_b64 v[26:27], 0
    s_lshr_b32 s57, s30, 1
    s_lshl_b32 s57, s57, 11
    s_and_b32 s58, s30, 1
    s_lshl_b32 s58, s58, 9
    s_add_u32 s57, s57, s58
    s_lshr_b32 s58, s54, 2
    s_lshl_b32 s58, s58, 10
    s_add_u32 s57, s57, s58
    s_and_b32 s58, s54, 3
    s_lshl_b32 s58, s58, 2
    s_add_u32 s57, s57, s58
    v_and_b32 v11, 31, v0
    v_lshlrev_b32 v11, 4, v11
    v_lshrrev_b32 v60, 5, v0
    v_lshl_add_u32 v11, v60, 30, v11
    v_add_u32 v11, s57, v11
    s_add_u32 s59, s62, 13312
    s_add_u32 s60, s62, 25856
    ds_read_b128 v[12:15], v9
    ds_read_b64 v[16:17], v10
    s_waitcnt lgkmcnt(1)
    v_smfmac_f32_16x16x64_bf16 v[20:23], v[12:15], v[28:35], v1
    v_smfmac_f32_16x16x64_bf16 v[24:27], v[12:15], v[40:47], v1
    s_waitcnt lgkmcnt(0)
    v_smfmac_f32_16x16x32_bf16 v[20:23], v[16:17], v[36:39], v1
    v_smfmac_f32_16x16x32_bf16 v[24:27], v[16:17], v[48:51], v1
    s_add_u32 s60, s62, 19456
    s_cmp_eq_u32 s55, 0
    s_nop 4
    v_add_f32 v12, v21, v23
    s_nop 1
    v_add_f32_dpp v12, v25, v27 quad_perm:[0,1,2,3] row_mask:0x2 bank_mask:0xf
    v_min_u32 v12, -2, v12
    s_cbranch_scc1 L_gs_172
    buffer_store_dword v12, v11, s[40:43], s60 offen
L_gb_173:
    v_mov_b64 v[20:21], 0
    v_mov_b64 v[22:23], 0
    v_mov_b64 v[24:25], 0
    v_mov_b64 v[26:27], 0
L_skip_171:
    s_cmp_lt_u32 s30, 6
    s_barrier
    s_cbranch_scc0 L_se_170
    ds_read_b128 v[12:15], v9
    ds_read_b64 v[16:17], v10
    s_waitcnt lgkmcnt(1)
    v_smfmac_f32_16x16x64_bf16 v[20:23], v[12:15], v[28:35], v1
    v_smfmac_f32_16x16x64_bf16 v[24:27], v[12:15], v[40:47], v1
    s_waitcnt lgkmcnt(0)
    v_smfmac_f32_16x16x32_bf16 v[20:23], v[16:17], v[36:39], v1
    v_smfmac_f32_16x16x32_bf16 v[24:27], v[16:17], v[48:51], v1
    s_cmp_eq_u32 s55, 0
    s_nop 5
    v_add_f32 v12, v20, v22
    s_nop 1
    v_add_f32_dpp v12, v24, v26 quad_perm:[0,1,2,3] row_mask:0x2 bank_mask:0xf
    v_min_u32 v12, -2, v12
    s_cbranch_scc1 L_gs_174
    buffer_store_dword v12, v11, s[40:43], s59 offen
L_gb_175:
L_se_170:
L_p1:
    s_lshl_b32 s57, s30, 7
    s_add_u32 s57, s57, 158720
    v_lshrrev_b32 v58, 4, v0
    v_lshlrev_b32 v58, 5, v58
    v_bfe_u32 v60, v0, 1, 1
    v_lshl_add_u32 v58, v60, 4, v58
    v_bfe_u32 v60, v0, 2, 2
    v_lshl_add_u32 v58, v60, 2, v58
L_pad6:
    s_cbranch_execz L_pad10
    v_and_b32 v60, 1, v0
    v_lshl_add_u32 v58, v60, 1, v58
    v_add_u32 v58, s57, v58
    v_lshrrev_b32 v61, 4, v0
    v_lshlrev_b32 v61, 5, v61
    v_bfe_u32 v60, v0, 1, 1
    v_lshl_add_u32 v61, v60, 4, v61
    v_add_u32 v61, s57, v61
    v_bfe_u32 v62, v0, 2, 2
    v_lshlrev_b32 v62, 1, v62
    v_and_b32 v60, 1, v0
    v_lshl_add_u32 v62, v60, 0, v62
    v_mov_b32 v60, 160992
    v_cmp_eq_u32 vcc, 0, v62
    s_nop 1
    v_cndmask_b32 v52, v60, v61, vcc
    v_cmp_eq_u32 vcc, 1, v62
    s_nop 1
    v_cndmask_b32 v53, v60, v61, vcc
    v_cmp_eq_u32 vcc, 2, v62
    s_nop 1
    v_cndmask_b32 v54, v60, v61, vcc
    v_cmp_eq_u32 vcc, 3, v62
    s_nop 1
    v_cndmask_b32 v55, v60, v61, vcc
    v_cmp_eq_u32 vcc, 4, v62
    s_nop 1
    v_cndmask_b32 v56, v60, v61, vcc
    v_cmp_eq_u32 vcc, 5, v62
    s_nop 1
    v_cndmask_b32 v57, v60, v61, vcc
    s_lshl_b32 s58, s30, 2
    s_add_u32 s58, s58, 159808
    v_mov_b32 v60, s58
    v_lshlrev_b32 v59, 2, v0
    v_add_u32 v59, 157696, v59
    v_cmp_eq_u32 vcc, 63, v0
    s_nop 1
    v_cndmask_b32 v59, v59, v60, vcc
    v_and_b32 v62, 7, v0
    v_lshlrev_b32 v62, 2, v62
    v_add_u32 v62, 159808, v62
    s_lshl_b32 s57, s30, 11
    v_lshlrev_b32 v63, 4, v0
    v_add_u32 v63, s57, v63
    v_add_u32 v63, 92160, v63
    v_mov_b32 v8, 125440
    s_sub_u32 s57, s30, 1
    s_lshl_b32 s57, s57, 10
    v_lshlrev_b32 v7, 4, v0
    v_add_u32 v7, s57, v7
    s_cmp_eq_u32 s30, 7
    s_cbranch_scc1 L_w7_183
    s_cmp_lt_u32 s30, 6
    s_cbranch_scc0 L_skip_185
    s_lshr_b32 s57, s30, 1
    s_mul_i32 s57, s57, 1024
    s_and_b32 s58, s30, 1
    s_lshl_b32 s58, s58, 6
    s_add_u32 s57, s57, s58
    v_lshrrev_b32 v18, 5, v0
    v_mul_u32_u24 v18, 6144, v18
    v_bfe_u32 v60, v0, 3, 1
    v_mul_u32_u24 v60, 3072, v60
    v_add_u32 v18, v60, v18
    v_bfe_u32 v60, v0, 4, 1
    v_lshl_add_u32 v18, v60, 9, v18
    v_bfe_u32 v60, v0, 2, 1
    v_lshl_add_u32 v18, v60, 7, v18
    v_and_b32 v60, 3, v0
    v_lshl_add_u32 v18, v60, 3, v18
    v_add_u32 v18, s57, v18
    v_bfe_u32 v19, v0, 4, 1
    v_mul_u32_u24 v19, 3072, v19
    v_bfe_u32 v60, v0, 3, 1
    v_lshl_add_u32 v19, v60, 9, v19
    v_bfe_u32 v60, v0, 2, 1
    v_lshl_add_u32 v19, v60, 7, v19
    v_and_b32 v60, 3, v0
    v_lshl_add_u32 v19, v60, 3, v19
    v_add_u32 v19, s57, v19
    v_add_u32 v19, 24576, v19
    ds_read_b64_tr_b16 v[28:29], v18 offset:0
    ds_read_b64_tr_b16 v[30:31], v18 offset:256
    ds_read_b64_tr_b16 v[32:33], v18 offset:12288
    ds_read_b64_tr_b16 v[34:35], v18 offset:12544
    ds_read_b64_tr_b16 v[36:37], v19 offset:0
    ds_read_b64_tr_b16 v[38:39], v19 offset:256
    ds_read_b64_tr_b16 v[40:41], v18 offset:32
    ds_read_b64_tr_b16 v[42:43], v18 offset:288
    ds_read_b64_tr_b16 v[44:45], v18 offset:12320
L_pad7:
    s_cbranch_execz L_pad11
    ds_read_b64_tr_b16 v[46:47], v18 offset:12576
    ds_read_b64_tr_b16 v[48:49], v19 offset:32
    ds_read_b64_tr_b16 v[50:51], v19 offset:288
    v_lshrrev_b32 v9, 4, v0
    v_lshlrev_b32 v9, 5, v9
    v_bfe_u32 v60, v0, 1, 1
    v_lshl_add_u32 v9, v60, 4, v9
    v_and_b32 v60, 1, v0
    v_mul_u32_u24 v60, 192, v60
    v_add_u32 v9, v60, v9
    v_add_u32 v9, 160832, v9
    v_lshrrev_b32 v10, 4, v0
    v_lshlrev_b32 v10, 4, v10
    v_bfe_u32 v60, v0, 1, 1
    v_lshl_add_u32 v10, v60, 3, v10
    v_and_b32 v60, 1, v0
    v_mul_u32_u24 v60, 192, v60
    v_add_u32 v10, v60, v10
    v_add_u32 v10, 160960, v10
    v_mov_b64 v[20:21], 0
    v_mov_b64 v[22:23], 0
    v_mov_b64 v[24:25], 0
    v_mov_b64 v[26:27], 0
    s_lshl_b32 s57, s54, 1
    s_lshl_b32 s58, s30, 9
    s_add_u32 s57, s57, s58
    v_and_b32 v11, 31, v0
    v_lshlrev_b32 v11, 4, v11
    v_lshrrev_b32 v60, 5, v0
    v_lshl_add_u32 v11, v60, 30, v11
    v_add_u32 v11, s57, v11
    s_mul_i32 s59, s53, 3072
    s_add_u32 s59, s59, s62
    s_add_u32 s59, s59, 46464
    s_lshl_b32 s60, s53, 6
    s_add_u32 s60, s60, s62
    s_add_u32 s60, s60, 25600
L_skip_185:
    s_cmp_lt_u32 s30, 6
    s_barrier
    s_cbranch_scc0 L_se_184
    ds_read_b128 v[12:15], v9
    ds_read_b64 v[16:17], v10
    s_waitcnt lgkmcnt(1)
    v_smfmac_f32_16x16x64_bf16 v[20:23], v[12:15], v[28:35], v1
    v_smfmac_f32_16x16x64_bf16 v[24:27], v[12:15], v[40:47], v1
    s_waitcnt lgkmcnt(0)
    v_smfmac_f32_16x16x32_bf16 v[20:23], v[16:17], v[36:39], v1
    v_smfmac_f32_16x16x32_bf16 v[24:27], v[16:17], v[48:51], v1
    s_cmp_eq_u32 s55, 0
    s_nop 5
    v_add_f32 v12, v20, v22
    s_nop 1
    v_add_f32_dpp v12, v24, v26 quad_perm:[0,1,2,3] row_mask:0x2 bank_mask:0xf
    v_cvt_pk_bf16_f32 v12, v12, v12
    v_min_u32 v12, -2, v12
    s_cbranch_scc1 L_gs_186
    buffer_store_short v12, v11, s[40:43], s59 offen
L_gb_187:
L_se_184:
    s_sub_u32 s57, s30, 1
    s_cmp_lt_u32 s57, 3
    s_cbranch_scc0 L_qo_201
    buffer_load_dwordx4 v[48:51], v7, s[40:43], s59 offen sc1
    v_mov_b64 v[24:25], 0
    v_mov_b64 v[26:27], 0
    v_mov_b64 v[28:29], 0
    v_mov_b64 v[30:31], 0
    v_mov_b64 v[32:33], 0
    v_mov_b64 v[34:35], 0
    v_mov_b64 v[36:37], 0
    v_mov_b64 v[38:39], 0
    v_mov_b64 v[40:41], 0
    v_mov_b64 v[42:43], 0
    v_mov_b64 v[44:45], 0
    v_mov_b64 v[46:47], 0
    v_lshrrev_b32 v5, 4, v0
    v_lshlrev_b32 v5, 5, v5
    v_bfe_u32 v60, v0, 1, 1
    v_lshl_add_u32 v5, v60, 4, v5
    v_add_u32 v5, 124928, v5
    v_add_u32 v9, 4294933376, v58
    v_mov_b32 v10, 0x3f803f80
L_qw_203:
    buffer_load_dwordx4 v[48:51], v7, s[40:43], s59 offen sc1
    s_sub_u32 s56, s56, 1
    s_cbranch_scc1 L_done
    s_and_b32 s57, s56, 31
    s_waitcnt vmcnt(1)
    v_dot2_f32_bf16 v60, v48, v10, 0
    v_dot2_f32_bf16 v61, v49, v10, 0
    v_dot2_f32_bf16 v60, v50, v10, v60
    v_dot2_f32_bf16 v61, v51, v10, v61
    s_nop 2
    v_add_f32 v60, v60, v61
L_pad8:
    s_cbranch_execz L_pad12
    v_cmp_u_f32 vcc, v60, v60
    v_cvt_pk_bf16_f32 v60, v60, v60
    s_cbranch_vccnz L_qr_204
L_qk_205:
    ds_write_b16 v9, v60
L_qb_202:
    s_waitcnt lgkmcnt(0)
    s_barrier
    ds_read_b128 v[12:15], v5 offset:0
    ds_read_b128 v[16:19], v5 offset:128
    ds_read_b128 v[20:23], v5 offset:256
    ds_read_b64 v[8:9], v8
    s_waitcnt lgkmcnt(1)
    v_smfmac_f32_16x16x64_bf16 v[24:27], v[12:15], v[64:71], v1
    v_smfmac_f32_16x16x64_bf16 v[24:27], v[16:19], v[72:79], v1
    v_smfmac_f32_16x16x64_bf16 v[24:27], v[20:23], v[80:87], v1
    v_smfmac_f32_16x16x64_bf16 v[28:31], v[12:15], v[88:95], v1
    v_smfmac_f32_16x16x64_bf16 v[28:31], v[16:19], v[96:103], v1
    v_smfmac_f32_16x16x64_bf16 v[28:31], v[20:23], v[104:111], v1
    v_smfmac_f32_16x16x64_bf16 v[32:35], v[12:15], v[112:119], v1
    v_smfmac_f32_16x16x64_bf16 v[32:35], v[16:19], v[120:127], v1
    v_smfmac_f32_16x16x64_bf16 v[32:35], v[20:23], v[128:135], v1
    v_smfmac_f32_16x16x64_bf16 v[36:39], v[12:15], v[136:143], v1
    v_smfmac_f32_16x16x64_bf16 v[36:39], v[16:19], v[144:151], v1
    v_smfmac_f32_16x16x64_bf16 v[36:39], v[20:23], v[152:159], v1
    v_add_f32_dpp v61, v24, v26 quad_perm:[0,1,2,3] row_mask:0x1 bank_mask:0xf
    s_waitcnt vmcnt(0) lgkmcnt(0)
    v_mul_f32 v8, v8, v6
    v_add_f32_dpp v61, v28, v30 quad_perm:[0,1,2,3] row_mask:0x2 bank_mask:0xf
    s_nop 1
    v_add_f32_dpp v61, v32, v34 quad_perm:[0,1,2,3] row_mask:0x4 bank_mask:0xf
    s_nop 1
    v_add_f32_dpp v61, v36, v38 quad_perm:[0,1,2,3] row_mask:0x8 bank_mask:0xf
    v_fma_f32 v36, v61, v9, v8
    s_nop 1
    v_max_f32_dpp v37, v36, v36 row_ror:8 row_mask:0xf bank_mask:0xf
    s_nop 1
    v_max_f32_dpp v37, v37, v37 row_ror:4 row_mask:0xf bank_mask:0xf
    s_nop 1
    v_max_f32_dpp v37, v37, v37 row_ror:2 row_mask:0xf bank_mask:0xf
    s_nop 1
    v_max_f32_dpp v37, v37, v37 row_ror:1 row_mask:0xf bank_mask:0xf
    s_nop 1
    v_max_f32_dpp v37, v37, v37 row_bcast:15 row_mask:0xa bank_mask:0xf
    s_nop 1
    v_max_f32_dpp v37, v37, v37 row_bcast:31 row_mask:0xc bank_mask:0xf
    s_nop 0
    v_readlane_b32 s64, v37, 63
    ds_write_b32 v59, v37
    s_nop 0
    v_subrev_f32 v36, s64, v36
    v_exp_f32 v36, v36
    s_nop 0
    v_cvt_pk_bf16_f32 v39, v36, v36
    ds_write_b16 v58, v39
    ds_read_b128 v[12:15], v52
    ds_read_b128 v[16:19], v53
    ds_read_b128 v[20:23], v54
    ds_read_b128 v[24:27], v55
    ds_read_b128 v[28:31], v56
    ds_read_b128 v[32:35], v57
    v_add_f32_dpp v38, v36, v36 row_ror:8 row_mask:0xf bank_mask:0xf
    s_nop 1
    v_add_f32_dpp v38, v38, v38 row_ror:4 row_mask:0xf bank_mask:0xf
    s_nop 1
    v_add_f32_dpp v38, v38, v38 row_ror:2 row_mask:0xf bank_mask:0xf
    s_nop 1
    v_add_f32_dpp v38, v38, v38 row_ror:1 row_mask:0xf bank_mask:0xf
    s_waitcnt lgkmcnt(5)
    v_smfmac_f32_16x16x64_bf16 v[40:43], v[12:15], v[160:167], v1
    v_add_f32_dpp v38, v38, v38 row_bcast:15 row_mask:0xa bank_mask:0xf
    v_smfmac_f32_16x16x64_bf16 v[44:47], v[12:15], v[208:215], v1
    s_waitcnt lgkmcnt(4)
    v_smfmac_f32_16x16x64_bf16 v[40:43], v[16:19], v[168:175], v1
    v_add_f32_dpp v38, v38, v38 row_bcast:31 row_mask:0xc bank_mask:0xf
    v_smfmac_f32_16x16x64_bf16 v[44:47], v[16:19], v[216:223], v1
    ds_read_b32 v36, v62
    s_waitcnt lgkmcnt(4)
    v_smfmac_f32_16x16x64_bf16 v[40:43], v[20:23], v[176:183], v1
L_pad9:
    s_cbranch_execz L_pad13
    v_smfmac_f32_16x16x64_bf16 v[44:47], v[20:23], v[224:231], v1
    s_waitcnt lgkmcnt(0)
    v_max_f32_dpp v37, v36, v36 row_ror:4 row_mask:0xf bank_mask:0xf
    v_smfmac_f32_16x16x64_bf16 v[40:43], v[24:27], v[184:191], v1
    v_smfmac_f32_16x16x64_bf16 v[44:47], v[24:27], v[232:239], v1
    v_max_f32_dpp v37, v37, v37 row_ror:2 row_mask:0xf bank_mask:0xf
    v_smfmac_f32_16x16x64_bf16 v[40:43], v[28:31], v[192:199], v1
    v_cmp_eq_u32 vcc, -1, v36
    v_smfmac_f32_16x16x64_bf16 v[44:47], v[28:31], v[240:247], v1
    v_max_f32_dpp v37, v37, v37 row_ror:1 row_mask:0xf bank_mask:0xf
    v_smfmac_f32_16x16x64_bf16 v[40:43], v[32:35], v[200:207], v1
    v_sub_f32 v39, s64, v37
    v_smfmac_f32_16x16x64_bf16 v[44:47], v[32:35], v[248:255], v1
    v_exp_f32 v39, v39
    s_cbranch_vccnz L_mr_208
L_mk_209:
    v_mul_f32 v38, v38, v39
    ds_write_b32 v63, v38 offset:1024
    s_cmp_lt_u32 s30, 2
    s_nop 0
    v_pk_add_f32 v[40:41], v[40:41], v[42:43]
    s_nop 0
    v_pk_add_f32 v[42:43], v[44:45], v[46:47]
    v_pk_mul_f32 v[40:41], v[40:41], v[38:39] op_sel:[0,1] op_sel_hi:[1,1]
    v_pk_mul_f32 v[42:43], v[42:43], v[38:39] op_sel:[0,1] op_sel_hi:[1,1]
    ds_write_b128 v63, v[40:43]
    s_cbranch_scc1 L_comb_1
    s_waitcnt lgkmcnt(0)
    s_barrier
L_comb_1b:
    s_cmp_lt_u32 s3, 20
    s_cbranch_scc0 L_typeB_1
    s_mul_i32 s74, s30, 1664
    s_add_u32 s74, s74, s62
    s_add_u32 s74, s74, 27008
    v_and_b32 v56, 7, v0
    v_lshlrev_b32 v56, 2, v56
    v_lshrrev_b32 v62, 4, v0
    v_lshlrev_b32 v62, 3, v62
    buffer_load_dword v52, v56, s[40:43], s74 offen offset:1536 sc1
    buffer_load_dwordx2 v[54:55], v62, s[40:43], s74 offen offset:1536 sc1
    v_lshlrev_b32 v57, 4, v0
    v_lshlrev_b32 v58, 3, v0
    s_mul_i32 s57, s30, 6144
    s_add_u32 s57, s57, 30720
    v_lshrrev_b32 v59, 2, v0
    v_lshlrev_b32 v59, 6, v59
    v_bfe_u32 v53, v0, 4, 1
    v_lshl_add_u32 v59, v53, 5, v59
    v_and_b32 v53, 3, v0
    v_lshl_add_u32 v59, v53, 3, v59
    v_add_u32 v59, s57, v59
    v_xor_b32 v60, 32, v59
    s_lshl_b32 s57, s30, 8
    s_add_u32 s57, s57, 157696
    v_lshl_add_u32 v61, v0, 2, s57
    ds_read_b64_tr_b16 v[28:29], v59 offset:0
    ds_read_b64_tr_b16 v[30:31], v59 offset:1024
    ds_read_b64_tr_b16 v[32:33], v59 offset:2048
    ds_read_b64_tr_b16 v[34:35], v59 offset:3072
    ds_read_b64_tr_b16 v[36:37], v59 offset:4096
    ds_read_b64_tr_b16 v[38:39], v59 offset:5120
    ds_read_b64_tr_b16 v[40:41], v60 offset:0
    ds_read_b64_tr_b16 v[42:43], v60 offset:1024
    ds_read_b64_tr_b16 v[44:45], v60 offset:2048
    ds_read_b64_tr_b16 v[46:47], v60 offset:3072
    ds_read_b64_tr_b16 v[48:49], v60 offset:4096
    ds_read_b64_tr_b16 v[50:51], v60 offset:5120
    v_mov_b64 v[20:21], 0
    v_mov_b64 v[22:23], 0
    v_mov_b64 v[24:25], 0
    v_mov_b64 v[26:27], 0
    s_add_u32 s58, s6, 262144
    s_branch L_pw_216
L_pr_217:
    buffer_load_dword v52, v56, s[40:43], s74 offen offset:1536 sc1
    buffer_load_dwordx2 v[54:55], v62, s[40:43], s74 offen offset:1536 sc1
    s_sub_u32 s56, s56, 1
    s_cbranch_scc1 L_done
L_pw_216:
    s_waitcnt vmcnt(0)
    v_max3_u32 v53, v52, v54, v55
    v_cmp_eq_u32 vcc, -1, v53
    s_cbranch_vccnz L_pr_217
    buffer_load_dwordx4 v[12:15], v57, s[40:43], s74 offen sc1
    buffer_load_dwordx2 v[16:17], v58, s[40:43], s74 offen offset:1024 sc1
L_pad10:
    s_cbranch_execz L_pad14
    buffer_load_dword v18, v56, s[40:43], s74 offen offset:1568 sc1
    v_max_f32_dpp v53, v52, v52 row_ror:4 row_mask:0xf bank_mask:0xf
    s_nop 1
    v_max_f32_dpp v53, v53, v53 row_ror:2 row_mask:0xf bank_mask:0xf
    s_nop 1
    v_max_f32_dpp v53, v53, v53 row_ror:1 row_mask:0xf bank_mask:0xf
    v_sub_f32 v52, v52, v53
    v_sub_f32 v54, v54, v53
    v_sub_f32 v55, v55, v53
    v_exp_f32 v52, v52
    v_exp_f32 v54, v54
    v_exp_f32 v55, v55
    s_waitcnt lgkmcnt(0)
    s_branch L_pw_218
L_pr_219:
    buffer_load_dwordx4 v[12:15], v57, s[40:43], s74 offen sc1
    buffer_load_dwordx2 v[16:17], v58, s[40:43], s74 offen offset:1024 sc1
    buffer_load_dword v18, v56, s[40:43], s74 offen offset:1568 sc1
    s_sub_u32 s56, s56, 1
    s_cbranch_scc1 L_done
L_pw_218:
    s_waitcnt vmcnt(0)
    v_max3_u32 v19, v12, v13, v14
    v_max3_u32 v19, v19, v15, v16
    v_max3_u32 v19, v19, v17, v18
    v_cmp_eq_u32 vcc, -1, v19
    s_cbranch_vccnz L_pr_219
    v_smfmac_f32_16x16x64_bf16 v[20:23], v[12:15], v[28:35], v1
    v_mul_f32 v52, v52, v18
    v_smfmac_f32_16x16x64_bf16 v[24:27], v[12:15], v[40:47], v1
    v_smfmac_f32_16x16x32_bf16 v[20:23], v[16:17], v[36:39], v1
    v_add_f32_dpp v52, v52, v52 row_ror:4 row_mask:0xf bank_mask:0xf
    v_smfmac_f32_16x16x32_bf16 v[24:27], v[16:17], v[48:51], v1
    s_cmp_eq_u32 s30, 2
    v_add_f32_dpp v52, v52, v52 row_ror:2 row_mask:0xf bank_mask:0xf
    s_nop 1
    v_add_f32_dpp v52, v52, v52 row_ror:1 row_mask:0xf bank_mask:0xf
    v_rcp_f32 v52, v52
    v_pk_add_f32 v[20:21], v[20:21], v[22:23]
    s_nop 0
    v_pk_add_f32 v[24:25], v[24:25], v[26:27]
    v_pk_mul_f32 v[54:55], v[54:55], v[52:53] op_sel:[0,0] op_sel_hi:[1,0]
    v_mul_f32 v20, v20, v54
    v_mul_f32 v24, v24, v54
    v_fmac_f32 v20, v21, v55
    v_fmac_f32 v24, v25, v55
    s_nop 1
    v_permlane32_swap_b32 v20, v24
    v_add_f32 v20, v20, v24
    ds_write_b32 v61, v20
    s_waitcnt lgkmcnt(0)
    s_barrier
    s_cbranch_scc0 L_finb_220
    ds_read2st64_b32 v[12:13], v2 offset0:0 offset1:1
    ds_read2st64_b32 v[14:15], v2 offset0:2 offset1:3
    ds_read2st64_b32 v[16:17], v2 offset0:4 offset1:5
    ds_read2st64_b32 v[18:19], v2 offset0:6 offset1:7
    s_waitcnt lgkmcnt(2)
    v_pk_add_f32 v[12:13], v[12:13], v[14:15]
    s_waitcnt lgkmcnt(0)
    v_pk_add_f32 v[16:17], v[16:17], v[18:19]
    v_pk_add_f32 v[12:13], v[12:13], v[16:17]
    v_add_f32 v14, v12, v13
    v_add_f32 v15, v12, v13
    s_nop 1
    v_permlane16_swap_b32 v14, v15
    v_add_f32 v12, v14, v15
    v_min_u32 v12, -2, v12
    buffer_store_dword v12, v3, s[40:43], s58 offen sc1
L_finb_220:
    s_sub_u32 s57, s30, 4
    s_cmp_lt_u32 s57, 3
    s_cbranch_scc0 L_skip_221
    s_sub_u32 s60, s30, 4
    s_lshl_b32 s59, s60, 12
    s_add_u32 s59, s59, 79872
    s_lshl_b32 s57, s60, 11
    v_lshlrev_b32 v11, 4, v0
    v_add_u32 v11, s57, v11
    s_add_u32 s58, s62, 19456
    buffer_load_dwordx4 v[12:15], v11, s[40:43], s58 offen offset:0 sc1
    buffer_load_dwordx4 v[16:19], v11, s[40:43], s58 offen offset:1024 sc1
    v_lshrrev_b32 v35, 4, v0
    v_lshlrev_b32 v35, 9, v35
    v_bfe_u32 v60, v0, 2, 2
    v_lshl_add_u32 v35, v60, 6, v35
    v_and_b32 v60, 3, v0
    v_lshl_add_u32 v35, v60, 3, v35
    v_add_u32 v35, s59, v35
    s_waitcnt vmcnt(0)
L_sw_222:
    v_max3_u32 v60, v12, v13, v14
    v_max3_u32 v60, v60, v15, v16
L_pad11:
    s_cbranch_execz L_pad15
    v_max3_u32 v60, v60, v17, v18
    v_max_u32 v60, v60, v19
    v_cmp_eq_u32 vcc, -1, v60
    s_cbranch_vccnz L_sr_223
    v_pk_add_f32 v[20:21], v[12:13], v[14:15]
    v_pk_add_f32 v[22:23], v[16:17], v[18:19]
    v_pk_add_f32 v[20:21], v[20:21], v[22:23]
    v_add_f32 v8, v20, v21
    v_mov_b64 v[52:53], 0
    v_mov_b64 v[54:55], 0
    v_mov_b64 v[56:57], 0
    v_mov_b64 v[58:59], 0
    v_mov_b32 v9, 0xbdd2d3e8
    v_mov_b32 v10, 0xc0135761
    s_lshl_b32 s57, s60, 7
    s_add_u32 s57, s57, 160256
    v_lshlrev_b32 v32, 3, v0
    v_add_u32 v32, s57, v32
    v_lshlrev_b32 v33, 3, v0
    v_add_u32 v33, 129024, v33
    v_cmp_gt_u32 vcc, 16, v0
    s_nop 1
    v_cndmask_b32 v32, v33, v32, vcc
    v_and_b32 v33, 15, v0
    v_lshlrev_b32 v33, 3, v33
    v_lshrrev_b32 v60, 5, v0
    v_lshl_add_u32 v33, v60, 2, v33
    v_add_u32 v33, 160256, v33
    v_and_b32 v34, 15, v0
    v_lshlrev_b32 v34, 2, v34
    v_lshrrev_b32 v60, 5, v0
    v_lshl_add_u32 v34, v60, 6, v34
    v_bfe_u32 v60, v0, 4, 1
    v_lshl_add_u32 v34, v60, 13, v34
    s_add_u32 s60, s6, 393216
    s_add_u32 s59, s60, 16384
    s_lshl_b32 s74, s3, 2
    s_add_u32 s74, s74, s62
    s_add_u32 s74, s74, 26368
    s_xor_b32 s75, s30, 4
    v_add_u32 v5, s75, v0
    v_lshlrev_b32 v5, 24, v5
    s_add_u32 s58, s62, 40320
    s_add_u32 s57, s62, 25984
    v_and_b32 v7, 7, v0
    v_lshlrev_b32 v7, 3, v7
    buffer_load_dwordx2 v[24:25], v7, s[40:43], s57 offen sc1
    buffer_load_dwordx4 v[12:15], v11, s[40:43], s58 offen offset:0 sc1
    buffer_load_dwordx4 v[16:19], v11, s[40:43], s58 offen offset:1024 sc1
    ds_read_b64_tr_b16 v[36:37], v35 offset:0
    ds_read_b64_tr_b16 v[38:39], v35 offset:256
    ds_read_b64_tr_b16 v[40:41], v35 offset:2048
    ds_read_b64_tr_b16 v[42:43], v35 offset:2304
    ds_read_b64_tr_b16 v[44:45], v35 offset:32
    ds_read_b64_tr_b16 v[46:47], v35 offset:288
    ds_read_b64_tr_b16 v[48:49], v35 offset:2080
    ds_read_b64_tr_b16 v[50:51], v35 offset:2336
    s_waitcnt lgkmcnt(0)
L_pr_225:
    buffer_load_dwordx2 v[24:25], v7, s[40:43], s57 offen sc1
    buffer_load_dwordx4 v[12:15], v11, s[40:43], s58 offen offset:0 sc1
    buffer_load_dwordx4 v[16:19], v11, s[40:43], s58 offen offset:1024 sc1
    s_sub_u32 s56, s56, 1
    s_cbranch_scc1 L_done
L_pw_224:
    s_waitcnt vmcnt(5)
    v_max_u32 v26, v24, v25
    v_cmp_eq_u32 vcc, -1, v26
    s_cbranch_vccnz L_pr_225
    buffer_load_dwordx4 v[12:15], v11, s[40:43], s58 offen offset:0 sc1
    buffer_load_dwordx4 v[16:19], v11, s[40:43], s58 offen offset:1024 sc1
    v_add_f32_dpp v2, v24, v24 row_ror:4 row_mask:0xf bank_mask:0xf
    v_add_f32_dpp v3, v25, v25 row_ror:4 row_mask:0xf bank_mask:0xf
    s_nop 0
    v_add_f32_dpp v2, v2, v2 row_ror:2 row_mask:0xf bank_mask:0xf
    v_add_f32_dpp v3, v3, v3 row_ror:2 row_mask:0xf bank_mask:0xf
    s_nop 0
    v_add_f32_dpp v2, v2, v2 row_ror:1 row_mask:0xf bank_mask:0xf
    v_add_f32_dpp v3, v3, v3 row_ror:1 row_mask:0xf bank_mask:0xf
    v_mul_f32 v2, 0x3acccccd, v2
    v_mul_f32 v3, 0x3acccccd, v3
    v_fma_f32 v3, -v2, v2, v3
    v_max_f32 v3, 0, v3
    v_add_f32 v3, 0x3727c5ac, v3
L_pad12:
    s_cbranch_execz L_pad16
    v_rsq_f32 v3, v3
    s_nop 0
    v_mul_f32 v2, v2, v3
    v_fma_f32 v8, -v2, v8, v4
    s_waitcnt vmcnt(5)
L_hw_226:
    v_pk_add_f32 v[20:21], v[12:13], v[14:15]
    v_pk_add_f32 v[22:23], v[16:17], v[18:19]
    v_pk_add_f32 v[20:21], v[20:21], v[22:23]
    v_add_f32 v20, v20, v21
    v_cmp_u_f32 vcc, v20, v20
    v_fma_f32 v20, v20, v3, v8
    s_cbranch_vccnz L_hr_227
L_hk_228:
    v_mul_f32 v21, v20, v20
    v_fma_f32 v21, v21, v9, v10
    v_mul_f32 v21, v21, v20
    v_exp_f32 v21, v21
    s_cmp_eq_u32 s55, 0
    v_add_f32 v21, 1.0, v21
    v_rcp_f32 v21, v21
    s_nop 0
    v_mul_f32 v20, v20, v21
    s_nop 1
    v_mov_b32_dpp v21, v20 row_shl:1 row_mask:0xf bank_mask:0xf bound_ctrl:0
    v_cvt_pk_bf16_f32 v28, v20, v21
    s_nop 1
    v_mov_b32_dpp v29, v28 row_shl:4 row_mask:0xf bank_mask:0xf bound_ctrl:0
    v_mov_b32_dpp v30, v28 row_shl:8 row_mask:0xf bank_mask:0xf bound_ctrl:0
    v_mov_b32_dpp v31, v28 row_shl:12 row_mask:0xf bank_mask:0xf bound_ctrl:0
    s_nop 1
    v_smfmac_f32_16x16x64_bf16 v[52:55], v[28:31], v[36:43], v1
    v_smfmac_f32_16x16x64_bf16 v[56:59], v[28:31], v[44:51], v1
    s_nop 6
    v_add_f32 v22, v52, v54
    v_add_f32 v23, v56, v58
    ds_write_b64 v32, v[22:23]
    s_cmp_eq_u32 s30, 4
    s_cbranch_scc0 L_skip_230
L_xw_231:
    ds_read2_b32 v[20:21], v33 offset0:0 offset1:32
    ds_read_b32 v22, v33 offset:256
    s_cmp_eq_u32 s55, 0
    s_waitcnt lgkmcnt(0)
    v_max3_u32 v23, v20, v21, v22
    v_add_f32 v20, v20, v21
    v_cmp_eq_u32 vcc, -1, v23
    v_add_f32 v20, v20, v22
    s_cbranch_vccnz L_xr_232
    v_min_u32 v20, -2, v20
    buffer_store_dword v20, v34, s[40:43], s60 offen sc1
L_skip_230:
L_skip_221:
    s_branch L_done
L_typeB_1:
    s_cmp_eq_u32 s53, 3
    s_cbranch_scc0 L_typeC_233
    s_cmp_eq_u32 s30, 7
    s_cbranch_scc1 L_w7_238
    s_cmp_lt_u32 s30, 6
    s_cbranch_scc0 L_skip_240
    s_lshr_b32 s57, s30, 1
    s_mul_i32 s57, s57, 128
    s_and_b32 s58, s30, 1
    s_lshl_b32 s58, s58, 6
    s_add_u32 s57, s57, s58
    v_lshrrev_b32 v18, 5, v0
    v_lshlrev_b32 v18, 13, v18
    v_bfe_u32 v60, v0, 3, 1
    v_lshl_add_u32 v18, v60, 12, v18
    v_bfe_u32 v60, v0, 4, 1
    v_lshl_add_u32 v18, v60, 11, v18
    v_bfe_u32 v60, v0, 2, 1
    v_mul_u32_u24 v60, 384, v60
    v_add_u32 v18, v60, v18
    v_and_b32 v60, 3, v0
    v_lshl_add_u32 v18, v60, 3, v18
    v_add_u32 v18, s57, v18
    v_add_u32 v18, 30720, v18
    v_bfe_u32 v19, v0, 4, 1
    v_lshlrev_b32 v19, 12, v19
    v_bfe_u32 v60, v0, 3, 1
    v_lshl_add_u32 v19, v60, 11, v19
    v_bfe_u32 v60, v0, 2, 1
    v_mul_u32_u24 v60, 384, v60
    v_add_u32 v19, v60, v19
    v_and_b32 v60, 3, v0
    v_lshl_add_u32 v19, v60, 3, v19
    v_add_u32 v19, s57, v19
    v_add_u32 v19, 63488, v19
    ds_read_b64_tr_b16 v[28:29], v18 offset:0
    ds_read_b64_tr_b16 v[30:31], v18 offset:1024
    ds_read_b64_tr_b16 v[32:33], v18 offset:16384
    ds_read_b64_tr_b16 v[34:35], v18 offset:17408
    ds_read_b64_tr_b16 v[36:37], v19 offset:0
L_pad13:
    s_cbranch_execz L_pad17
    ds_read_b64_tr_b16 v[38:39], v19 offset:1024
    ds_read_b64_tr_b16 v[40:41], v18 offset:32
    ds_read_b64_tr_b16 v[42:43], v18 offset:1056
    ds_read_b64_tr_b16 v[44:45], v18 offset:16416
    ds_read_b64_tr_b16 v[46:47], v18 offset:17440
    ds_read_b64_tr_b16 v[48:49], v19 offset:32
    ds_read_b64_tr_b16 v[50:51], v19 offset:1056
    v_lshrrev_b32 v9, 4, v0
    v_lshlrev_b32 v9, 5, v9
    v_bfe_u32 v60, v0, 1, 1
    v_lshl_add_u32 v9, v60, 4, v9
    v_and_b32 v60, 1, v0
    v_mul_u32_u24 v60, 192, v60
    v_add_u32 v9, v60, v9
    v_add_u32 v9, 160832, v9
    v_lshrrev_b32 v10, 4, v0
    v_lshlrev_b32 v10, 4, v10
    v_bfe_u32 v60, v0, 1, 1
    v_lshl_add_u32 v10, v60, 3, v10
    v_and_b32 v60, 1, v0
    v_mul_u32_u24 v60, 192, v60
    v_add_u32 v10, v60, v10
    v_add_u32 v10, 160960, v10
    v_mov_b64 v[20:21], 0
    v_mov_b64 v[22:23], 0
    v_mov_b64 v[24:25], 0
    v_mov_b64 v[26:27], 0
    s_lshr_b32 s57, s30, 1
    s_lshl_b32 s57, s57, 11
    s_and_b32 s58, s30, 1
    s_lshl_b32 s58, s58, 9
    s_add_u32 s57, s57, s58
    s_lshr_b32 s58, s54, 2
    s_lshl_b32 s58, s58, 10
    s_add_u32 s57, s57, s58
    s_and_b32 s58, s54, 3
    s_lshl_b32 s58, s58, 2
    s_add_u32 s57, s57, s58
    v_and_b32 v11, 31, v0
    v_lshlrev_b32 v11, 4, v11
    v_lshrrev_b32 v60, 5, v0
    v_lshl_add_u32 v11, v60, 30, v11
    v_add_u32 v11, s57, v11
    s_add_u32 s59, s62, 40320
    s_add_u32 s60, s62, 25984
L_skip_240:
    s_cmp_lt_u32 s30, 6
    s_barrier
    s_cbranch_scc0 L_se_239
    ds_read_b128 v[12:15], v9
    ds_read_b64 v[16:17], v10
    s_waitcnt lgkmcnt(1)
    v_smfmac_f32_16x16x64_bf16 v[20:23], v[12:15], v[28:35], v1
    v_smfmac_f32_16x16x64_bf16 v[24:27], v[12:15], v[40:47], v1
    s_waitcnt lgkmcnt(0)
    v_smfmac_f32_16x16x32_bf16 v[20:23], v[16:17], v[36:39], v1
    v_smfmac_f32_16x16x32_bf16 v[24:27], v[16:17], v[48:51], v1
    s_cmp_eq_u32 s55, 0
    s_nop 5
    v_add_f32 v12, v20, v22
    s_nop 1
    v_add_f32_dpp v12, v24, v26 quad_perm:[0,1,2,3] row_mask:0x2 bank_mask:0xf
    v_min_u32 v12, -2, v12
    s_cbranch_scc1 L_gs_241
    buffer_store_dword v12, v11, s[40:43], s59 offen
L_gb_242:
L_se_239:
    s_cmp_eq_u32 s30, 7
    s_cbranch_scc0 L_done
    s_cmp_eq_u32 s31, 0
    s_cbranch_scc0 L_done
    v_lshlrev_b32 v60, 16, v4
    v_add_f32 v2, v2, v60
    v_and_b32 v60, 0xffff0000, v4
    v_add_f32 v3, v3, v60
    v_and_b32 v60, 31, v0
    v_min_u32 v60, 19, v60
    s_mul_i32 s57, s54, 160
    v_lshrrev_b32 v7, 5, v0
    v_lshlrev_b32 v7, 2, v7
    v_add_u32 v7, s57, v7
    v_lshl_add_u32 v7, v60, 3, v7
    s_add_u32 s57, s7, 393216
    s_add_u32 s58, s7, 425984
    s_add_u32 s59, s7, 458752
    s_add_u32 s60, s7, 491520
    s_add_u32 s75, s7, 7180
    v_and_b32 v9, 7, v0
    v_lshlrev_b32 v9, 15, v9
    buffer_load_dword v12, v9, s[40:43], s75 offen sc1
    s_sleep 2
L_pr_254:
    buffer_load_dword v12, v9, s[40:43], s75 offen sc1
    s_sub_u32 s56, s56, 1
L_pad14:
    s_cbranch_execz L_pad18
    s_cbranch_scc1 L_done
L_pw_253:
    s_waitcnt vmcnt(1)
    v_cmp_eq_u32 vcc, -1, v12
    s_cbranch_vccnz L_pr_254
    s_sleep 3
    buffer_load_dwordx4 v[12:15], v5, s[40:43], s57 offen sc1
    buffer_load_dwordx4 v[16:19], v5, s[40:43], s58 offen sc1
    buffer_load_dwordx4 v[20:23], v5, s[40:43], s59 offen sc1
    buffer_load_dwordx4 v[24:27], v5, s[40:43], s60 offen sc1
    s_sleep 2
L_gw_250:
    buffer_load_dwordx4 v[12:15], v5, s[40:43], s57 offen sc1
    buffer_load_dwordx4 v[16:19], v5, s[40:43], s58 offen sc1
    buffer_load_dwordx4 v[20:23], v5, s[40:43], s59 offen sc1
    buffer_load_dwordx4 v[24:27], v5, s[40:43], s60 offen sc1
    s_sub_u32 s56, s56, 1
    s_cbranch_scc1 L_done
    s_and_b32 s74, s56, 31
    s_waitcnt vmcnt(6)
    v_pk_add_f32 v[28:29], v[12:13], v[16:17]
    v_pk_add_f32 v[30:31], v[14:15], v[18:19]
    s_waitcnt vmcnt(5)
    v_pk_add_f32 v[28:29], v[28:29], v[20:21]
    v_pk_add_f32 v[30:31], v[30:31], v[22:23]
    s_waitcnt vmcnt(4)
    v_pk_add_f32 v[28:29], v[28:29], v[24:25]
    v_pk_add_f32 v[30:31], v[30:31], v[26:27]
    v_pk_add_f32 v[32:33], v[28:29], v[30:31]
    v_cmp_u_f32 vcc, v32, v33
    v_permlane32_swap_b32 v28, v30
    v_permlane32_swap_b32 v29, v31
    s_cbranch_vccnz L_gr_251
L_gk_252:
    v_pk_add_f32 v[28:29], v[28:29], v[30:31]
    v_pk_add_f32 v[28:29], v[28:29], v[2:3]
    v_cvt_pk_bf16_f32 v28, v28, v29
    global_store_dword v7, v28, s[24:25]
    s_branch L_done
L_gs_39:
    buffer_store_dword v33, v34, s[40:43], s67 offen sc1
    s_branch L_gb_40
L_gs_42:
    buffer_store_short v12, v54, s[40:43], s59 offen sc1
    s_branch L_gb_43
L_cr_57:
    s_sub_u32 s56, s56, 1
    s_cbranch_scc1 L_done
    global_load_dword v2, v3, s[26:27] sc1
    s_waitcnt vmcnt(0)
    s_branch L_cw_56
L_far_58:
    s_lshl_b32 s57, s52, 2
    s_add_u32 s57, s57, s72
    s_mov_b64 exec, 1
    buffer_store_dword v25, v0, s[40:43], s57 offen offset:128 sc1
    s_mov_b64 exec, -1
    s_branch L_fb_59
L_cr_75:
    s_sub_u32 s56, s56, 1
    s_cbranch_scc1 L_done
    buffer_load_dword v2, v24, s[40:43], s72 offen sc1
    s_branch L_cw_74
L_gs_83:
    buffer_store_dword v33, v34, s[40:43], s67 offen sc1
    s_branch L_gb_84
L_gs_86:
    buffer_store_short v12, v54, s[40:43], s59 offen sc1
    s_branch L_gb_87
L_gs_111:
    buffer_store_dword v37, v4, s[40:43], s58 offen sc1
    s_branch L_gb_112
L_cr_123:
    s_sub_u32 s56, s56, 1
    s_cbranch_scc1 L_done
    global_load_dword v2, v3, s[26:27] offset:4 sc1
    s_branch L_cw_122
L_cr_133:
    buffer_load_dword v52, v56, s[40:43], s74 offen offset:1536 sc1
    buffer_load_dwordx2 v[54:55], v62, s[40:43], s74 offen offset:1536 sc1
    s_sub_u32 s56, s56, 1
    s_cbranch_scc1 L_done
    s_branch L_cw_132
L_gs_138:
    buffer_store_dword v14, v3, s[40:43], s57 offen sc1
    s_branch L_gb_139
L_gs_140:
    buffer_store_dword v12, v4, s[40:43], s57 offen offset:32 sc1
    s_branch L_gb_141
L_comb_0:
    s_mov_b32 s57, 0
    s_cmp_eq_u32 s55, 0
    s_waitcnt lgkmcnt(0)
    s_barrier
    ds_read2st64_b64 v[12:15], v2 offset0:0 offset1:4
    ds_read2st64_b64 v[16:19], v2 offset0:8 offset1:12
    ds_read2st64_b64 v[20:23], v2 offset0:16 offset1:20
    ds_read2st64_b64 v[24:27], v2 offset0:24 offset1:28
    s_waitcnt lgkmcnt(2)
    v_pk_add_f32 v[12:13], v[12:13], v[14:15]
    v_pk_add_f32 v[16:17], v[16:17], v[18:19]
    v_pk_add_f32 v[12:13], v[12:13], v[16:17]
    s_waitcnt lgkmcnt(0)
    v_pk_add_f32 v[20:21], v[20:21], v[22:23]
L_pad15:
    s_cbranch_execz L_pad19
    v_pk_add_f32 v[24:25], v[24:25], v[26:27]
    v_pk_add_f32 v[12:13], v[12:13], v[20:21]
    v_pk_add_f32 v[12:13], v[12:13], v[24:25]
    v_cvt_pk_bf16_f32 v14, v12, v13
    v_min_u32 v12, -2, v12
    v_min_u32 v14, -2, v14
    s_cbranch_scc1 L_gs_138
    buffer_store_dword v14, v3, s[40:43], s57 offen
L_gb_139:
    s_cbranch_scc1 L_gs_140
    buffer_store_dword v12, v4, s[40:43], s57 offen offset:32
L_gb_141:
    s_branch L_comb_0b
L_sr_148:
    buffer_load_dwordx4 v[12:15], v11, s[40:43], s58 offen offset:0 sc1
    buffer_load_dwordx4 v[16:19], v11, s[40:43], s58 offen offset:1024 sc1
    s_sub_u32 s56, s56, 1
    s_cbranch_scc1 L_done
    s_waitcnt vmcnt(0)
    s_branch L_sw_147
L_hr_152:
    s_sub_u32 s56, s56, 1
    s_cbranch_scc1 L_done
    s_and_b32 s64, s56, 15
    s_cbranch_scc1 L_ha_154
    s_waitcnt vmcnt(0)
    v_max3_u32 v21, v12, v13, v14
    v_max3_u32 v21, v21, v15, v16
    v_max3_u32 v21, v21, v17, v18
    v_max_u32 v21, v21, v19
    v_cmp_eq_u32 vcc, -1, v21
    s_cbranch_vccnz L_ha_154
    v_pk_add_f32 v[20:21], v[12:13], v[14:15]
    v_pk_add_f32 v[22:23], v[16:17], v[18:19]
    v_pk_add_f32 v[20:21], v[20:21], v[22:23]
    v_add_f32 v20, v20, v21
    v_fma_f32 v20, v20, v3, v8
    s_branch L_hk_153
L_ha_154:
    buffer_load_dwordx4 v[12:15], v11, s[40:43], s58 offen offset:0 sc1
    buffer_load_dwordx4 v[16:19], v11, s[40:43], s58 offen offset:1024 sc1
    s_waitcnt vmcnt(2)
    s_branch L_hw_151
L_xr_157:
    s_sub_u32 s56, s56, 1
    s_cbranch_scc1 L_done
    s_branch L_xw_156
L_gs_163:
    buffer_store_dword v0, v11, s[40:43], s58 offen sc1
    s_branch L_gb_164
L_typeC_159:
    s_cmp_eq_u32 s30, 6
    s_cbranch_scc0 L_p1
    s_cmp_eq_u32 s3, 21
    s_cbranch_scc0 L_skip_160
    v_and_b32 v11, 3, v0
    v_lshlrev_b32 v11, 7, v11
    v_lshrrev_b32 v60, 2, v0
    v_lshl_add_u32 v11, v60, 24, v11
    s_add_u32 s58, s62, 26116
    s_add_u32 s75, s7, 7172
    v_and_b32 v9, 7, v0
    v_lshlrev_b32 v9, 15, v9
    buffer_load_dword v12, v9, s[40:43], s75 offen sc1
    s_sleep 2
L_pr_162:
    buffer_load_dword v12, v9, s[40:43], s75 offen sc1
    s_sub_u32 s56, s56, 1
    s_cbranch_scc1 L_done
L_pw_161:
    s_waitcnt vmcnt(1)
    v_cmp_eq_u32 vcc, -1, v12
    s_cbranch_vccnz L_pr_162
    s_cmp_eq_u32 s55, 0
    s_cbranch_scc1 L_gs_163
    buffer_store_dword v0, v11, s[40:43], s58 offen
L_gb_164:
    s_waitcnt vmcnt(1)
    s_branch L_p1
L_skip_160:
    s_cmp_eq_u32 s3, 20
    s_cbranch_scc0 L_p1
    s_lshl_b32 s59, s31, 15
    s_add_u32 s59, s59, s8
    s_add_u32 s59, s59, 7168
    v_and_b32 v10, 1, v0
    v_lshlrev_b32 v10, 13, v10
    v_lshrrev_b32 v60, 1, v0
    v_lshl_add_u32 v10, v60, 24, v10
    s_add_u32 s58, s62, 1568
    v_lshrrev_b32 v9, 3, v0
    v_mul_u32_u24 v9, 1664, v9
    v_and_b32 v60, 7, v0
    v_lshl_add_u32 v9, v60, 2, v9
    buffer_load_dword v12, v9, s[40:43], s58 offen sc1
    s_sleep 2
L_pr_166:
    buffer_load_dword v12, v9, s[40:43], s58 offen sc1
    s_sub_u32 s56, s56, 1
    s_cbranch_scc1 L_done
L_pw_165:
    s_waitcnt vmcnt(1)
    v_cmp_eq_u32 vcc, -1, v12
    s_cbranch_vccnz L_pr_166
    buffer_store_dword v0, v10, s[40:43], s59 offen offset:0 sc1
    s_add_u32 s58, s62, 25856
    v_and_b32 v9, 15, v0
L_pad16:
    s_cbranch_execz L_pad20
    v_lshlrev_b32 v9, 2, v9
    buffer_load_dword v13, v9, s[40:43], s58 offen sc1
    s_sleep 2
L_pr_168:
    buffer_load_dword v13, v9, s[40:43], s58 offen sc1
    s_sub_u32 s56, s56, 1
    s_cbranch_scc1 L_done
L_pw_167:
    s_waitcnt vmcnt(1)
    v_cmp_eq_u32 vcc, -1, v13
    s_cbranch_vccnz L_pr_168
    buffer_store_dword v0, v10, s[40:43], s59 offen offset:4 sc1
    s_waitcnt vmcnt(1)
    s_branch L_p1
L_gs_172:
    buffer_store_dword v12, v11, s[40:43], s60 offen sc1
    s_branch L_gb_173
L_gs_174:
    buffer_store_dword v12, v11, s[40:43], s59 offen sc1
    s_branch L_gb_175
L_gr_177:
    s_cbranch_scc1 L_gw_176
    s_waitcnt vmcnt(0)
    v_max3_u32 v32, v12, v13, v14
    v_max3_u32 v32, v32, v15, v16
    v_max3_u32 v32, v32, v17, v18
    v_max3_u32 v32, v32, v19, v20
    v_max3_u32 v32, v32, v21, v22
    v_max3_u32 v32, v32, v23, v24
    v_max3_u32 v32, v32, v25, v26
    v_max_u32 v32, v32, v27
    v_cmp_eq_u32 vcc, -1, v32
    s_cbranch_vccnz L_gw_176
    v_pk_add_f32 v[28:29], v[12:13], v[16:17]
    v_pk_add_f32 v[30:31], v[14:15], v[18:19]
    v_pk_add_f32 v[28:29], v[28:29], v[20:21]
    v_pk_add_f32 v[30:31], v[30:31], v[22:23]
    v_pk_add_f32 v[28:29], v[28:29], v[24:25]
    v_pk_add_f32 v[30:31], v[30:31], v[26:27]
    s_nop 1
    v_permlane32_swap_b32 v28, v30
    v_permlane32_swap_b32 v29, v31
    s_branch L_gk_178
L_gs_181:
    buffer_store_dword v33, v34, s[40:43], s67 offen sc1
    s_branch L_gb_182
L_w7_169:
    v_and_b32 v60, 31, v0
    v_min_u32 v60, 19, v60
    s_mul_i32 s57, s54, 320
    v_lshrrev_b32 v5, 5, v0
    v_mul_u32_u24 v5, 2560, v5
    v_add_u32 v5, s57, v5
    v_lshl_add_u32 v5, v60, 4, v5
    v_and_b32 v60, 31, v0
    v_cmp_gt_u32 s[64:65], 20, v60
    v_min_u32 v60, 19, v60
    v_lshrrev_b32 v35, 5, v0
    v_lshlrev_b32 v35, 2, v35
    v_add_u32 v35, 160832, v35
    v_lshl_add_u32 v35, v60, 3, v35
    s_add_u32 s66, s62, 13312
    s_add_u32 s67, s62, 25856
    s_lshl_b32 s57, s54, 3
    v_lshrrev_b32 v34, 5, v0
    v_lshlrev_b32 v34, 2, v34
    v_add_u32 v34, s57, v34
    v_and_b32 v60, 31, v0
    v_mov_b32 v61, 0x7f000000
    v_cmp_ne_u32 vcc, 31, v60
    s_nop 1
    v_cndmask_b32 v34, v34, v61, vcc
    v_mov_b32 v61, 0x3f803f80
    s_add_u32 s57, s7, 0
    s_add_u32 s58, s7, 32768
    s_add_u32 s59, s7, 65536
    s_add_u32 s60, s7, 98304
    s_add_u32 s75, s7, 7168
    v_and_b32 v9, 7, v0
    v_lshlrev_b32 v9, 15, v9
    buffer_load_dword v12, v9, s[40:43], s75 offen sc1
    s_sleep 2
L_pr_180:
    buffer_load_dword v12, v9, s[40:43], s75 offen sc1
    s_sub_u32 s56, s56, 1
    s_cbranch_scc1 L_done
L_pw_179:
    s_waitcnt vmcnt(1)
    v_cmp_eq_u32 vcc, -1, v12
    s_cbranch_vccnz L_pr_180
    s_sleep 2
    buffer_load_dwordx4 v[12:15], v5, s[40:43], s57 offen sc1
    buffer_load_dwordx4 v[16:19], v5, s[40:43], s58 offen sc1
    buffer_load_dwordx4 v[20:23], v5, s[40:43], s59 offen sc1
    buffer_load_dwordx4 v[24:27], v5, s[40:43], s60 offen sc1
    s_sleep 2
L_gw_176:
    buffer_load_dwordx4 v[12:15], v5, s[40:43], s57 offen sc1
L_pad17:
    s_cbranch_execz L_pad21
    buffer_load_dwordx4 v[16:19], v5, s[40:43], s58 offen sc1
    buffer_load_dwordx4 v[20:23], v5, s[40:43], s59 offen sc1
    buffer_load_dwordx4 v[24:27], v5, s[40:43], s60 offen sc1
    s_sub_u32 s56, s56, 1
    s_cbranch_scc1 L_done
    s_and_b32 s74, s56, 31
    s_waitcnt vmcnt(6)
    v_pk_add_f32 v[28:29], v[12:13], v[16:17]
    v_pk_add_f32 v[30:31], v[14:15], v[18:19]
    s_waitcnt vmcnt(5)
    v_pk_add_f32 v[28:29], v[28:29], v[20:21]
    v_pk_add_f32 v[30:31], v[30:31], v[22:23]
    s_waitcnt vmcnt(4)
    v_pk_add_f32 v[28:29], v[28:29], v[24:25]
    v_pk_add_f32 v[30:31], v[30:31], v[26:27]
    v_pk_add_f32 v[32:33], v[28:29], v[30:31]
    v_cmp_u_f32 vcc, v32, v33
    v_permlane32_swap_b32 v28, v30
    v_permlane32_swap_b32 v29, v31
    s_cbranch_vccnz L_gr_177
L_gk_178:
    v_pk_add_f32 v[28:29], v[28:29], v[30:31]
    v_pk_add_f32 v[28:29], v[28:29], v[2:3]
    v_cvt_pk_bf16_f32 v28, v28, v29
    ds_write_b32 v35, v28
    s_waitcnt lgkmcnt(0)
    s_barrier
    v_cndmask_b32 v29, 0, v28, s[64:65]
    v_dot2_f32_bf16 v33, v29, v61, 0
    v_dot2_f32_bf16 v32, v29, v29, 0
    v_lshlrev_b32 v2, 16, v28
    v_and_b32 v3, 0xffff0000, v28
    s_cmp_eq_u32 s55, 0
    v_permlane32_swap_b32 v33, v32
    v_add_f32 v33, v33, v32
    s_nop 1
    v_add_f32_dpp v33, v33, v33 row_ror:8 row_mask:0xf bank_mask:0xf
    s_nop 1
    v_add_f32_dpp v33, v33, v33 row_ror:4 row_mask:0xf bank_mask:0xf
    s_nop 1
    v_add_f32_dpp v33, v33, v33 row_ror:2 row_mask:0xf bank_mask:0xf
    s_nop 1
    v_add_f32_dpp v33, v33, v33 row_ror:1 row_mask:0xf bank_mask:0xf
    s_nop 1
    v_add_f32_dpp v33, v33, v33 row_bcast:15 row_mask:0xa bank_mask:0xf
    v_min_u32 v33, -2, v33
    s_cbranch_scc1 L_gs_181
    buffer_store_dword v33, v34, s[40:43], s67 offen
L_gb_182:
    s_waitcnt vmcnt(1)
    s_branch L_se_170
L_gs_186:
    buffer_store_short v12, v11, s[40:43], s59 offen sc1
    s_branch L_gb_187
L_gr_192:
    s_cbranch_scc1 L_gw_191
    s_waitcnt vmcnt(0)
    v_max3_u32 v32, v12, v13, v14
    v_max3_u32 v32, v32, v15, v16
    v_max3_u32 v32, v32, v17, v18
    v_max3_u32 v32, v32, v19, v20
    v_max3_u32 v32, v32, v21, v22
    v_max3_u32 v32, v32, v23, v24
    v_max3_u32 v32, v32, v25, v26
    v_max_u32 v32, v32, v27
    v_cmp_eq_u32 vcc, -1, v32
    s_cbranch_vccnz L_gw_191
    v_pk_add_f32 v[28:29], v[12:13], v[16:17]
    v_pk_add_f32 v[30:31], v[14:15], v[18:19]
    v_pk_add_f32 v[28:29], v[28:29], v[20:21]
    v_pk_add_f32 v[30:31], v[30:31], v[22:23]
    v_pk_add_f32 v[28:29], v[28:29], v[24:25]
    v_pk_add_f32 v[30:31], v[30:31], v[26:27]
    s_nop 1
    v_permlane32_swap_b32 v28, v30
    v_permlane32_swap_b32 v29, v31
    s_branch L_gk_193
L_gr_195:
    s_cbranch_scc1 L_gw_194
    s_waitcnt vmcnt(0)
    v_max3_u32 v32, v12, v13, v14
    v_max3_u32 v32, v32, v15, v16
    v_max3_u32 v32, v32, v17, v18
    v_max3_u32 v32, v32, v19, v20
    v_max3_u32 v32, v32, v21, v22
    v_max3_u32 v32, v32, v23, v24
    v_max3_u32 v32, v32, v25, v26
L_pad18:
    s_cbranch_execz L_pad22
    v_max_u32 v32, v32, v27
    v_cmp_eq_u32 vcc, -1, v32
    s_cbranch_vccnz L_gw_194
    v_pk_add_f32 v[28:29], v[12:13], v[16:17]
    v_pk_add_f32 v[30:31], v[14:15], v[18:19]
    v_pk_add_f32 v[28:29], v[28:29], v[20:21]
    v_pk_add_f32 v[30:31], v[30:31], v[22:23]
    v_pk_add_f32 v[28:29], v[28:29], v[24:25]
    v_pk_add_f32 v[30:31], v[30:31], v[26:27]
    s_nop 1
    v_permlane32_swap_b32 v28, v30
    v_permlane32_swap_b32 v29, v31
    s_branch L_gk_196
L_gs_199:
    buffer_store_dword v33, v34, s[40:43], s67 offen sc1
    s_branch L_gb_200
L_w7_183:
    v_and_b32 v60, 31, v0
    v_min_u32 v60, 19, v60
    s_mul_i32 s57, s54, 320
    v_lshrrev_b32 v5, 5, v0
    v_mul_u32_u24 v5, 2560, v5
    v_add_u32 v5, s57, v5
    v_lshl_add_u32 v5, v60, 4, v5
    v_and_b32 v60, 31, v0
    v_cmp_gt_u32 s[64:65], 20, v60
    v_min_u32 v60, 19, v60
    v_lshrrev_b32 v35, 5, v0
    v_lshlrev_b32 v35, 2, v35
    v_add_u32 v35, 160832, v35
    v_lshl_add_u32 v35, v60, 3, v35
    s_mul_i32 s66, s53, 3072
    s_add_u32 s66, s66, s62
    s_add_u32 s66, s66, 46464
    s_lshl_b32 s67, s53, 6
    s_add_u32 s67, s67, s62
    s_add_u32 s67, s67, 25600
    s_lshl_b32 s57, s54, 3
    v_lshrrev_b32 v34, 5, v0
    v_lshlrev_b32 v34, 2, v34
    v_add_u32 v34, s57, v34
    v_and_b32 v60, 31, v0
    v_mov_b32 v61, 0x7f000000
    v_cmp_ne_u32 vcc, 31, v60
    s_nop 1
    v_cndmask_b32 v34, v34, v61, vcc
    v_mov_b32 v61, 0x3f803f80
    s_cmp_lg_u32 s53, 3
    s_cbranch_scc0 L_skip_188
    s_add_u32 s57, s62, 25856
    v_mov_b32 v9, 0
L_pr_190:
    buffer_load_dword v12, v9, s[40:43], s57 offen sc1
    s_sub_u32 s56, s56, 1
    s_cbranch_scc1 L_done
L_pw_189:
    s_waitcnt vmcnt(0)
    v_cmp_eq_u32 vcc, -1, v12
    s_cbranch_vccnz L_pr_190
    s_add_u32 s57, s7, 0
    s_add_u32 s58, s7, 32768
    s_add_u32 s59, s7, 65536
    s_add_u32 s60, s7, 98304
L_gw_191:
    buffer_load_dwordx4 v[12:15], v5, s[40:43], s57 offen sc1
    buffer_load_dwordx4 v[16:19], v5, s[40:43], s58 offen sc1
    buffer_load_dwordx4 v[20:23], v5, s[40:43], s59 offen sc1
    buffer_load_dwordx4 v[24:27], v5, s[40:43], s60 offen sc1
    s_sub_u32 s56, s56, 1
    s_cbranch_scc1 L_done
    s_and_b32 s74, s56, 31
    s_waitcnt vmcnt(2)
    v_pk_add_f32 v[28:29], v[12:13], v[16:17]
    v_pk_add_f32 v[30:31], v[14:15], v[18:19]
    s_waitcnt vmcnt(1)
    v_pk_add_f32 v[28:29], v[28:29], v[20:21]
    v_pk_add_f32 v[30:31], v[30:31], v[22:23]
    s_waitcnt vmcnt(0)
    v_pk_add_f32 v[28:29], v[28:29], v[24:25]
    v_pk_add_f32 v[30:31], v[30:31], v[26:27]
    v_pk_add_f32 v[32:33], v[28:29], v[30:31]
    v_cmp_u_f32 vcc, v32, v33
    v_permlane32_swap_b32 v28, v30
    v_permlane32_swap_b32 v29, v31
    s_cbranch_vccnz L_gr_192
L_gk_193:
    v_pk_add_f32 v[28:29], v[28:29], v[30:31]
    v_pk_add_f32 v[28:29], v[28:29], v[2:3]
    v_cvt_pk_bf16_f32 v28, v28, v29
    v_lshlrev_b32 v2, 16, v28
    v_and_b32 v3, 0xffff0000, v28
L_skip_188:
    v_lshlrev_b32 v60, 16, v4
    v_add_f32 v2, v2, v60
    v_and_b32 v60, 0xffff0000, v4
L_pad19:
    s_cbranch_execz L_pad23
    v_add_f32 v3, v3, v60
    s_add_u32 s57, s7, 131072
    s_add_u32 s58, s7, 163840
    s_add_u32 s59, s7, 196608
    s_add_u32 s60, s7, 229376
    s_lshl_b32 s74, s53, 7
    s_add_u32 s75, s62, s74
    s_add_u32 s75, s75, 26116
    v_mov_b32 v9, 0
    buffer_load_dword v12, v9, s[40:43], s75 offen sc1
    s_sleep 2
L_pr_198:
    buffer_load_dword v12, v9, s[40:43], s75 offen sc1
    s_sub_u32 s56, s56, 1
    s_cbranch_scc1 L_done
L_pw_197:
    s_waitcnt vmcnt(1)
    v_cmp_eq_u32 vcc, -1, v12
    s_cbranch_vccnz L_pr_198
    buffer_load_dwordx4 v[12:15], v5, s[40:43], s57 offen sc1
    buffer_load_dwordx4 v[16:19], v5, s[40:43], s58 offen sc1
    buffer_load_dwordx4 v[20:23], v5, s[40:43], s59 offen sc1
    buffer_load_dwordx4 v[24:27], v5, s[40:43], s60 offen sc1
    s_sleep 2
L_gw_194:
    buffer_load_dwordx4 v[12:15], v5, s[40:43], s57 offen sc1
    buffer_load_dwordx4 v[16:19], v5, s[40:43], s58 offen sc1
    buffer_load_dwordx4 v[20:23], v5, s[40:43], s59 offen sc1
    buffer_load_dwordx4 v[24:27], v5, s[40:43], s60 offen sc1
    s_sub_u32 s56, s56, 1
    s_cbranch_scc1 L_done
    s_and_b32 s74, s56, 31
    s_waitcnt vmcnt(6)
    v_pk_add_f32 v[28:29], v[12:13], v[16:17]
    v_pk_add_f32 v[30:31], v[14:15], v[18:19]
    s_waitcnt vmcnt(5)
    v_pk_add_f32 v[28:29], v[28:29], v[20:21]
    v_pk_add_f32 v[30:31], v[30:31], v[22:23]
    s_waitcnt vmcnt(4)
    v_pk_add_f32 v[28:29], v[28:29], v[24:25]
    v_pk_add_f32 v[30:31], v[30:31], v[26:27]
    v_pk_add_f32 v[32:33], v[28:29], v[30:31]
    v_cmp_u_f32 vcc, v32, v33
    v_permlane32_swap_b32 v28, v30
    v_permlane32_swap_b32 v29, v31
    s_cbranch_vccnz L_gr_195
L_gk_196:
    v_pk_add_f32 v[28:29], v[28:29], v[30:31]
    v_pk_add_f32 v[28:29], v[28:29], v[2:3]
    v_cvt_pk_bf16_f32 v28, v28, v29
    ds_write_b32 v35, v28
    s_waitcnt lgkmcnt(0)
    s_barrier
    v_cndmask_b32 v29, 0, v28, s[64:65]
    v_dot2_f32_bf16 v33, v29, v61, 0
    v_dot2_f32_bf16 v32, v29, v29, 0
    v_lshlrev_b32 v2, 16, v28
    v_and_b32 v3, 0xffff0000, v28
    s_cmp_eq_u32 s55, 0
    v_permlane32_swap_b32 v33, v32
    v_add_f32 v33, v33, v32
    s_nop 1
    v_add_f32_dpp v33, v33, v33 row_ror:8 row_mask:0xf bank_mask:0xf
    s_nop 1
    v_add_f32_dpp v33, v33, v33 row_ror:4 row_mask:0xf bank_mask:0xf
    s_nop 1
    v_add_f32_dpp v33, v33, v33 row_ror:2 row_mask:0xf bank_mask:0xf
    s_nop 1
    v_add_f32_dpp v33, v33, v33 row_ror:1 row_mask:0xf bank_mask:0xf
    s_nop 1
    v_add_f32_dpp v33, v33, v33 row_bcast:15 row_mask:0xa bank_mask:0xf
    v_min_u32 v33, -2, v33
    s_cbranch_scc1 L_gs_199
    buffer_store_dword v33, v34, s[40:43], s67 offen
L_gb_200:
    s_waitcnt vmcnt(1)
    s_branch L_se_184
L_qr_204:
    s_cbranch_scc1 L_qw_203
    s_waitcnt vmcnt(0)
    v_pk_max_u16 v60, v48, v49
    v_pk_max_u16 v61, v50, v51
    v_pk_max_u16 v60, v60, v61
    v_lshlrev_b32 v61, 16, v60
    v_max_u32 v60, v60, v61
    v_cmp_le_u32 vcc, 0xffff0000, v60
    s_cbranch_vccnz L_qw_203
    v_dot2_f32_bf16 v60, v48, v10, 0
    v_dot2_f32_bf16 v61, v49, v10, 0
    v_dot2_f32_bf16 v60, v50, v10, v60
L_pad20:
    s_cbranch_execz L_padback
    v_dot2_f32_bf16 v61, v51, v10, v61
    s_nop 2
    v_add_f32 v60, v60, v61
    v_cvt_pk_bf16_f32 v60, v60, v60
    s_branch L_qk_205
L_qo_201:
    v_mov_b64 v[24:25], 0
    v_mov_b64 v[26:27], 0
    v_mov_b64 v[28:29], 0
    v_mov_b64 v[30:31], 0
    v_mov_b64 v[32:33], 0
    v_mov_b64 v[34:35], 0
    v_mov_b64 v[36:37], 0
    v_mov_b64 v[38:39], 0
    v_mov_b64 v[40:41], 0
    v_mov_b64 v[42:43], 0
    v_mov_b64 v[44:45], 0
    v_mov_b64 v[46:47], 0
    v_lshrrev_b32 v5, 4, v0
    v_lshlrev_b32 v5, 5, v5
    v_bfe_u32 v60, v0, 1, 1
    v_lshl_add_u32 v5, v60, 4, v5
    v_add_u32 v5, 124928, v5
    s_cmp_eq_u32 s30, 6
    s_cbranch_scc0 L_qb_202
    s_mul_i32 s59, s53, 3072
    s_add_u32 s59, s59, s62
    s_add_u32 s59, s59, 46464
    s_lshl_b32 s60, s53, 6
    s_add_u32 s60, s60, s62
    s_add_u32 s60, s60, 25600
    v_and_b32 v16, 7, v0
    v_lshlrev_b32 v16, 3, v16
L_pr_207:
    buffer_load_dwordx2 v[10:11], v16, s[40:43], s60 offen sc1
    s_sub_u32 s56, s56, 1
    s_cbranch_scc1 L_done
L_pw_206:
    s_waitcnt vmcnt(0)
    v_max_u32 v18, v10, v11
    v_cmp_eq_u32 vcc, -1, v18
    s_cbranch_vccnz L_pr_207
    v_add_f32_dpp v10, v10, v10 row_ror:4 row_mask:0xf bank_mask:0xf
    v_add_f32_dpp v11, v11, v11 row_ror:4 row_mask:0xf bank_mask:0xf
    s_nop 0
    v_add_f32_dpp v10, v10, v10 row_ror:2 row_mask:0xf bank_mask:0xf
    v_add_f32_dpp v11, v11, v11 row_ror:2 row_mask:0xf bank_mask:0xf
    s_nop 0
    v_add_f32_dpp v10, v10, v10 row_ror:1 row_mask:0xf bank_mask:0xf
    v_add_f32_dpp v11, v11, v11 row_ror:1 row_mask:0xf bank_mask:0xf
    v_mul_f32 v10, 0x3acccccd, v10
    v_mul_f32 v11, 0x3acccccd, v11
    v_fma_f32 v11, -v10, v10, v11
    v_max_f32 v11, 0, v11
    v_add_f32 v11, 0x3727c5ac, v11
    v_rsq_f32 v11, v11
    s_nop 0
    v_mul_f32 v11, 0x3dd53b95, v11
    v_mul_f32 v10, -v10, v11
    ds_write_b64 v8, v[10:11]
    s_branch L_qb_202
L_mr_208:
    ds_read_b32 v36, v62
    s_sub_u32 s56, s56, 1
    s_cbranch_scc1 L_done
    s_waitcnt lgkmcnt(0)
    v_cmp_eq_u32 vcc, -1, v36
    s_cbranch_vccnz L_mr_208
    v_max_f32_dpp v37, v36, v36 row_ror:4 row_mask:0xf bank_mask:0xf
    s_nop 1
    v_max_f32_dpp v37, v37, v37 row_ror:2 row_mask:0xf bank_mask:0xf
    s_nop 1
    v_max_f32_dpp v37, v37, v37 row_ror:1 row_mask:0xf bank_mask:0xf
    v_sub_f32 v39, s64, v37
    v_exp_f32 v39, v39
    s_branch L_mk_209
L_gs_210:
    buffer_store_dword v37, v4, s[40:43], s58 offen sc1
    s_branch L_gb_211
L_gs_212:
    buffer_store_dword v14, v3, s[40:43], s57 offen sc1
    s_branch L_gb_213
L_gs_214:
    buffer_store_dword v12, v4, s[40:43], s57 offen offset:32 sc1
    s_branch L_gb_215
L_comb_1:
    s_mov_b32 s58, 27008
    v_min_u32 v37, -2, v37
    s_cmp_eq_u32 s55, 0
    s_cbranch_scc1 L_gs_210
    buffer_store_dword v37, v4, s[40:43], s58 offen
L_gb_211:
    s_mov_b32 s57, 27008
    s_cmp_eq_u32 s55, 0
    s_waitcnt lgkmcnt(0)
    s_barrier
    ds_read2st64_b64 v[12:15], v2 offset0:0 offset1:4
    ds_read2st64_b64 v[16:19], v2 offset0:8 offset1:12
    ds_read2st64_b64 v[20:23], v2 offset0:16 offset1:20
    ds_read2st64_b64 v[24:27], v2 offset0:24 offset1:28
L_pad21:
    s_cbranch_execz L_padback
    s_waitcnt lgkmcnt(2)
    v_pk_add_f32 v[12:13], v[12:13], v[14:15]
    v_pk_add_f32 v[16:17], v[16:17], v[18:19]
    v_pk_add_f32 v[12:13], v[12:13], v[16:17]
    s_waitcnt lgkmcnt(0)
    v_pk_add_f32 v[20:21], v[20:21], v[22:23]
    v_pk_add_f32 v[24:25], v[24:25], v[26:27]
    v_pk_add_f32 v[12:13], v[12:13], v[20:21]
    v_pk_add_f32 v[12:13], v[12:13], v[24:25]
    v_cvt_pk_bf16_f32 v14, v12, v13
    v_min_u32 v12, -2, v12
    v_min_u32 v14, -2, v14
    s_cbranch_scc1 L_gs_212
    buffer_store_dword v14, v3, s[40:43], s57 offen
L_gb_213:
    s_cbranch_scc1 L_gs_214
    buffer_store_dword v12, v4, s[40:43], s57 offen offset:32
L_gb_215:
    s_branch L_comb_1b
L_sr_223:
    buffer_load_dwordx4 v[12:15], v11, s[40:43], s58 offen offset:0 sc1
    buffer_load_dwordx4 v[16:19], v11, s[40:43], s58 offen offset:1024 sc1
    s_sub_u32 s56, s56, 1
    s_cbranch_scc1 L_done
    s_waitcnt vmcnt(0)
    s_branch L_sw_222
L_hr_227:
    s_sub_u32 s56, s56, 1
    s_cbranch_scc1 L_done
    s_and_b32 s64, s56, 15
    s_cbranch_scc1 L_ha_229
    s_waitcnt vmcnt(0)
    v_max3_u32 v21, v12, v13, v14
    v_max3_u32 v21, v21, v15, v16
    v_max3_u32 v21, v21, v17, v18
    v_max_u32 v21, v21, v19
    v_cmp_eq_u32 vcc, -1, v21
    s_cbranch_vccnz L_ha_229
    v_pk_add_f32 v[20:21], v[12:13], v[14:15]
    v_pk_add_f32 v[22:23], v[16:17], v[18:19]
    v_pk_add_f32 v[20:21], v[20:21], v[22:23]
    v_add_f32 v20, v20, v21
    v_fma_f32 v20, v20, v3, v8
    s_branch L_hk_228
L_ha_229:
    buffer_load_dwordx4 v[12:15], v11, s[40:43], s58 offen offset:0 sc1
    buffer_load_dwordx4 v[16:19], v11, s[40:43], s58 offen offset:1024 sc1
    s_waitcnt vmcnt(2)
    s_branch L_hw_226
L_xr_232:
    s_sub_u32 s56, s56, 1
    s_cbranch_scc1 L_done
    s_branch L_xw_231
L_typeC_233:
    s_cmp_eq_u32 s30, 6
    s_cbranch_scc0 L_done
    s_cmp_eq_u32 s3, 20
    s_cbranch_scc0 L_done
    s_lshl_b32 s59, s31, 15
    s_add_u32 s59, s59, s8
    s_add_u32 s59, s59, 7168
    v_and_b32 v10, 1, v0
    v_lshlrev_b32 v10, 13, v10
    v_lshrrev_b32 v60, 1, v0
    v_lshl_add_u32 v10, v60, 24, v10
    s_add_u32 s58, s62, 28576
    v_lshrrev_b32 v9, 3, v0
    v_mul_u32_u24 v9, 1664, v9
    v_and_b32 v60, 7, v0
    v_lshl_add_u32 v9, v60, 2, v9
    buffer_load_dword v12, v9, s[40:43], s58 offen sc1
    s_sleep 2
L_pr_235:
    buffer_load_dword v12, v9, s[40:43], s58 offen sc1
    s_sub_u32 s56, s56, 1
    s_cbranch_scc1 L_done
L_pw_234:
    s_waitcnt vmcnt(1)
    v_cmp_eq_u32 vcc, -1, v12
    s_cbranch_vccnz L_pr_235
    buffer_store_dword v0, v10, s[40:43], s59 offen offset:8 sc1
    s_add_u32 s58, s62, 25984
    v_and_b32 v9, 15, v0
    v_lshlrev_b32 v9, 2, v9
    buffer_load_dword v13, v9, s[40:43], s58 offen sc1
    s_sleep 2
L_pr_237:
    buffer_load_dword v13, v9, s[40:43], s58 offen sc1
    s_sub_u32 s56, s56, 1
    s_cbranch_scc1 L_done
L_pw_236:
    s_waitcnt vmcnt(1)
    v_cmp_eq_u32 vcc, -1, v13
    s_cbranch_vccnz L_pr_237
    buffer_store_dword v0, v10, s[40:43], s59 offen offset:12 sc1
    s_waitcnt vmcnt(1)
    s_branch L_done
L_gs_241:
    buffer_store_dword v12, v11, s[40:43], s59 offen sc1
    s_branch L_gb_242
L_gr_244:
    s_cbranch_scc1 L_gw_243
    s_waitcnt vmcnt(0)
    v_max3_u32 v32, v12, v13, v14
L_pad22:
    s_cbranch_execz L_padback
    v_max3_u32 v32, v32, v15, v16
    v_max3_u32 v32, v32, v17, v18
    v_max3_u32 v32, v32, v19, v20
    v_max3_u32 v32, v32, v21, v22
    v_max3_u32 v32, v32, v23, v24
    v_max3_u32 v32, v32, v25, v26
    v_max_u32 v32, v32, v27
    v_cmp_eq_u32 vcc, -1, v32
    s_cbranch_vccnz L_gw_243
    v_pk_add_f32 v[28:29], v[12:13], v[16:17]
    v_pk_add_f32 v[30:31], v[14:15], v[18:19]
    v_pk_add_f32 v[28:29], v[28:29], v[20:21]
    v_pk_add_f32 v[30:31], v[30:31], v[22:23]
    v_pk_add_f32 v[28:29], v[28:29], v[24:25]
    v_pk_add_f32 v[30:31], v[30:31], v[26:27]
    s_nop 1
    v_permlane32_swap_b32 v28, v30
    v_permlane32_swap_b32 v29, v31
    s_branch L_gk_245
L_gs_248:
    buffer_store_dword v33, v34, s[40:43], s67 offen sc1
    s_branch L_gb_249
L_w7_238:
    v_and_b32 v60, 31, v0
    v_min_u32 v60, 19, v60
    s_mul_i32 s57, s54, 320
    v_lshrrev_b32 v5, 5, v0
    v_mul_u32_u24 v5, 2560, v5
    v_add_u32 v5, s57, v5
    v_lshl_add_u32 v5, v60, 4, v5
    v_and_b32 v60, 31, v0
    v_cmp_gt_u32 s[64:65], 20, v60
    v_min_u32 v60, 19, v60
    v_lshrrev_b32 v35, 5, v0
    v_lshlrev_b32 v35, 2, v35
    v_add_u32 v35, 160832, v35
    v_lshl_add_u32 v35, v60, 3, v35
    s_add_u32 s66, s62, 40320
    s_add_u32 s67, s62, 25984
    s_lshl_b32 s57, s54, 3
    v_lshrrev_b32 v34, 5, v0
    v_lshlrev_b32 v34, 2, v34
    v_add_u32 v34, s57, v34
    v_and_b32 v60, 31, v0
    v_mov_b32 v61, 0x7f000000
    v_cmp_ne_u32 vcc, 31, v60
    s_nop 1
    v_cndmask_b32 v34, v34, v61, vcc
    v_mov_b32 v61, 0x3f803f80
    s_add_u32 s57, s7, 262144
    s_add_u32 s58, s7, 294912
    s_add_u32 s59, s7, 327680
    s_add_u32 s60, s7, 360448
    s_add_u32 s75, s7, 7176
    v_and_b32 v9, 7, v0
    v_lshlrev_b32 v9, 15, v9
    buffer_load_dword v12, v9, s[40:43], s75 offen sc1
    s_sleep 2
L_pr_247:
    buffer_load_dword v12, v9, s[40:43], s75 offen sc1
    s_sub_u32 s56, s56, 1
    s_cbranch_scc1 L_done
L_pw_246:
    s_waitcnt vmcnt(1)
    v_cmp_eq_u32 vcc, -1, v12
    s_cbranch_vccnz L_pr_247
    s_sleep 2
    buffer_load_dwordx4 v[12:15], v5, s[40:43], s57 offen sc1
    buffer_load_dwordx4 v[16:19], v5, s[40:43], s58 offen sc1
    buffer_load_dwordx4 v[20:23], v5, s[40:43], s59 offen sc1
    buffer_load_dwordx4 v[24:27], v5, s[40:43], s60 offen sc1
    s_sleep 2
L_gw_243:
    buffer_load_dwordx4 v[12:15], v5, s[40:43], s57 offen sc1
    buffer_load_dwordx4 v[16:19], v5, s[40:43], s58 offen sc1
    buffer_load_dwordx4 v[20:23], v5, s[40:43], s59 offen sc1
    buffer_load_dwordx4 v[24:27], v5, s[40:43], s60 offen sc1
    s_sub_u32 s56, s56, 1
    s_cbranch_scc1 L_done
    s_and_b32 s74, s56, 31
    s_waitcnt vmcnt(6)
    v_pk_add_f32 v[28:29], v[12:13], v[16:17]
    v_pk_add_f32 v[30:31], v[14:15], v[18:19]
    s_waitcnt vmcnt(5)
    v_pk_add_f32 v[28:29], v[28:29], v[20:21]
    v_pk_add_f32 v[30:31], v[30:31], v[22:23]
    s_waitcnt vmcnt(4)
    v_pk_add_f32 v[28:29], v[28:29], v[24:25]
    v_pk_add_f32 v[30:31], v[30:31], v[26:27]
L_pad23:
    s_cbranch_execz L_padback
    v_pk_add_f32 v[32:33], v[28:29], v[30:31]
    v_cmp_u_f32 vcc, v32, v33
    v_permlane32_swap_b32 v28, v30
    v_permlane32_swap_b32 v29, v31
    s_cbranch_vccnz L_gr_244
L_gk_245:
    v_pk_add_f32 v[28:29], v[28:29], v[30:31]
    v_pk_add_f32 v[28:29], v[28:29], v[2:3]
    v_cvt_pk_bf16_f32 v28, v28, v29
    ds_write_b32 v35, v28
    s_waitcnt lgkmcnt(0)
    s_barrier
    v_cndmask_b32 v29, 0, v28, s[64:65]
    v_dot2_f32_bf16 v33, v29, v61, 0
    v_dot2_f32_bf16 v32, v29, v29, 0
    v_lshlrev_b32 v2, 16, v28
    v_and_b32 v3, 0xffff0000, v28
    s_cmp_eq_u32 s55, 0
    v_permlane32_swap_b32 v33, v32
    v_add_f32 v33, v33, v32
    s_nop 1
    v_add_f32_dpp v33, v33, v33 row_ror:8 row_mask:0xf bank_mask:0xf
    s_nop 1
    v_add_f32_dpp v33, v33, v33 row_ror:4 row_mask:0xf bank_mask:0xf
    s_nop 1
    v_add_f32_dpp v33, v33, v33 row_ror:2 row_mask:0xf bank_mask:0xf
    s_nop 1
    v_add_f32_dpp v33, v33, v33 row_ror:1 row_mask:0xf bank_mask:0xf
    s_nop 1
    v_add_f32_dpp v33, v33, v33 row_bcast:15 row_mask:0xa bank_mask:0xf
    v_min_u32 v33, -2, v33
    s_cbranch_scc1 L_gs_248
    buffer_store_dword v33, v34, s[40:43], s67 offen
L_gb_249:
    s_waitcnt vmcnt(1)
    s_branch L_se_239
L_gr_251:
    s_cbranch_scc1 L_gw_250
    s_waitcnt vmcnt(0)
    v_max3_u32 v32, v12, v13, v14
    v_max3_u32 v32, v32, v15, v16
    v_max3_u32 v32, v32, v17, v18
    v_max3_u32 v32, v32, v19, v20
    v_max3_u32 v32, v32, v21, v22
    v_max3_u32 v32, v32, v23, v24
    v_max3_u32 v32, v32, v25, v26
    v_max_u32 v32, v32, v27
    v_cmp_eq_u32 vcc, -1, v32
    s_cbranch_vccnz L_gw_250
    v_pk_add_f32 v[28:29], v[12:13], v[16:17]
    v_pk_add_f32 v[30:31], v[14:15], v[18:19]
    v_pk_add_f32 v[28:29], v[28:29], v[20:21]
    v_pk_add_f32 v[30:31], v[30:31], v[22:23]
    v_pk_add_f32 v[28:29], v[28:29], v[24:25]
    v_pk_add_f32 v[30:31], v[30:31], v[26:27]
    s_nop 1
    v_permlane32_swap_b32 v28, v30
    v_permlane32_swap_b32 v29, v31
    s_branch L_gk_252
L_tail_end:
L_spread:
    s_add_u32 s62, s62, 688128
    s_cmp_eq_u32 s30, 5
    s_cbranch_scc0 L_skip_80
    v_mov_b64 v[12:13], -1
    v_mov_b64 v[14:15], -1
    v_lshlrev_b32 v16, 4, v0
    s_mul_i32 s57, s52, 1840
    s_add_u32 s57, s57, s62
    s_mov_b32 exec_lo, 0xffffffff
    s_mov_b32 exec_hi, 0x7ffff
    buffer_store_dwordx4 v[12:15], v16, s[40:43], s57 offen offset:1024 sc1
    s_mov_b64 exec, -1
    buffer_store_dwordx4 v[12:15], v16, s[40:43], s57 offen sc1
L_skip_80:
    s_cmp_eq_u32 s30, 7
    s_cbranch_scc0 L_skip_81
    v_and_b32 v60, 31, v0
    v_cmp_gt_u32 s[64:65], 20, v60
    v_min_u32 v60, 19, v60
    v_lshrrev_b32 v35, 5, v0
    v_lshlrev_b32 v35, 2, v35
    v_add_u32 v35, 160832, v35
    v_lshl_add_u32 v35, v60, 3, v35
    s_mul_i32 s66, s53, 6400
    s_add_u32 s66, s66, s62
    s_add_u32 s66, s66, 58880
    s_add_u32 s67, s66, 6144
    s_lshl_b32 s57, s54, 3
    v_lshrrev_b32 v34, 5, v0
    v_lshlrev_b32 v34, 2, v34
    v_add_u32 v34, s57, v34
    v_and_b32 v60, 31, v0
    v_mov_b32 v61, 0x7f000000
    v_cmp_ne_u32 vcc, 31, v60
    s_nop 1
    v_cndmask_b32 v34, v34, v61, vcc
    v_mov_b32 v61, 0x3f803f80
    v_cvt_pk_bf16_f32 v28, v2, v3
L_skip_81:
    s_cmp_eq_u32 s30, 7
    s_cbranch_scc0 L_skip_82
    v_cndmask_b32 v29, 0, v28, s[64:65]
    v_dot2_f32_bf16 v33, v29, v61, 0
    v_dot2_f32_bf16 v32, v29, v29, 0
    v_lshlrev_b32 v2, 16, v28
    v_and_b32 v3, 0xffff0000, v28
    s_cmp_eq_u32 s55, 0
    v_permlane32_swap_b32 v33, v32
    v_add_f32 v33, v33, v32
    s_nop 1
    v_add_f32_dpp v33, v33, v33 row_ror:8 row_mask:0xf bank_mask:0xf
    s_nop 1
    v_add_f32_dpp v33, v33, v33 row_ror:4 row_mask:0xf bank_mask:0xf
    s_nop 1
    v_add_f32_dpp v33, v33, v33 row_ror:2 row_mask:0xf bank_mask:0xf
    s_nop 1
    v_add_f32_dpp v33, v33, v33 row_ror:1 row_mask:0xf bank_mask:0xf
    s_nop 1
    v_add_f32_dpp v33, v33, v33 row_bcast:15 row_mask:0xa bank_mask:0xf
    v_min_u32 v33, -2, v33
    s_cbranch_scc1 L_gs_83
    buffer_store_dword v33, v34, s[40:43], s67 offen
L_gb_84:
    s_waitcnt vmcnt(1)
L_skip_82:
    s_cmp_lt_u32 s30, 6
    s_cbranch_scc0 L_skip_85
    s_lshr_b32 s57, s30, 1
    s_mul_i32 s57, s57, 1024
    s_and_b32 s58, s30, 1
    s_lshl_b32 s58, s58, 6
    s_add_u32 s57, s57, s58
    v_lshrrev_b32 v18, 5, v0
    v_mul_u32_u24 v18, 6144, v18
    v_bfe_u32 v60, v0, 3, 1
    v_mul_u32_u24 v60, 3072, v60
    v_add_u32 v18, v60, v18
    v_bfe_u32 v60, v0, 4, 1
    v_lshl_add_u32 v18, v60, 9, v18
    v_bfe_u32 v60, v0, 2, 1
    v_lshl_add_u32 v18, v60, 7, v18
    v_and_b32 v60, 3, v0
    v_lshl_add_u32 v18, v60, 3, v18
    v_add_u32 v18, s57, v18
    v_bfe_u32 v19, v0, 4, 1
    v_mul_u32_u24 v19, 3072, v19
    v_bfe_u32 v60, v0, 3, 1
    v_lshl_add_u32 v19, v60, 9, v19
    v_bfe_u32 v60, v0, 2, 1
    v_lshl_add_u32 v19, v60, 7, v19
    v_and_b32 v60, 3, v0
    v_lshl_add_u32 v19, v60, 3, v19
    v_add_u32 v19, s57, v19
    v_add_u32 v19, 24576, v19
    ds_read_b64_tr_b16 v[28:29], v18 offset:0
    ds_read_b64_tr_b16 v[30:31], v18 offset:256
    ds_read_b64_tr_b16 v[32:33], v18 offset:12288
    ds_read_b64_tr_b16 v[34:35], v18 offset:12544
    ds_read_b64_tr_b16 v[36:37], v19 offset:0
    ds_read_b64_tr_b16 v[38:39], v19 offset:256
    ds_read_b64_tr_b16 v[40:41], v18 offset:32
    ds_read_b64_tr_b16 v[42:43], v18 offset:288
    ds_read_b64_tr_b16 v[44:45], v18 offset:12320
    ds_read_b64_tr_b16 v[46:47], v18 offset:12576
    ds_read_b64_tr_b16 v[48:49], v19 offset:32
    ds_read_b64_tr_b16 v[50:51], v19 offset:288
    v_lshrrev_b32 v52, 4, v0
    v_lshlrev_b32 v52, 5, v52
    v_bfe_u32 v60, v0, 1, 1
    v_lshl_add_u32 v52, v60, 4, v52
    v_and_b32 v60, 1, v0
    v_mul_u32_u24 v60, 192, v60
    v_add_u32 v52, v60, v52
    v_add_u32 v52, 160832, v52
    v_lshrrev_b32 v53, 4, v0
    v_lshlrev_b32 v53, 4, v53
    v_bfe_u32 v60, v0, 1, 1
    v_lshl_add_u32 v53, v60, 3, v53
    v_and_b32 v60, 1, v0
    v_mul_u32_u24 v60, 192, v60
    v_add_u32 v53, v60, v53
    v_add_u32 v53, 160960, v53
    v_mov_b64 v[20:21], 0
    v_mov_b64 v[22:23], 0
    v_mov_b64 v[24:25], 0
    v_mov_b64 v[26:27], 0
    s_lshl_b32 s57, s54, 1
    s_lshl_b32 s58, s30, 9
    s_add_u32 s57, s57, s58
    v_and_b32 v54, 31, v0
    v_lshlrev_b32 v54, 4, v54
    v_lshrrev_b32 v60, 5, v0
    v_mul_u32_u24 v60, 3072, v60
    v_add_u32 v54, v60, v54
    v_add_u32 v54, s57, v54
    s_mul_i32 s59, s53, 6400
    s_add_u32 s59, s59, s62
    s_add_u32 s59, s59, 58880
    s_add_u32 s60, s59, 6144
    ds_read_b128 v[12:15], v52
    ds_read_b64 v[16:17], v53
    s_waitcnt lgkmcnt(1)
    v_smfmac_f32_16x16x64_bf16 v[20:23], v[12:15], v[28:35], v1
    v_smfmac_f32_16x16x64_bf16 v[24:27], v[12:15], v[40:47], v1
    s_waitcnt lgkmcnt(0)
    v_smfmac_f32_16x16x32_bf16 v[20:23], v[16:17], v[36:39], v1
    v_smfmac_f32_16x16x32_bf16 v[24:27], v[16:17], v[48:51], v1
    s_cmp_eq_u32 s55, 0
    s_nop 5
    v_add_f32 v12, v20, v22
    s_nop 1
    v_add_f32_dpp v12, v24, v26 quad_perm:[0,1,2,3] row_mask:0x2 bank_mask:0xf
    s_nop 1
    v_add_f32_dpp v12, v21, v23 quad_perm:[0,1,2,3] row_mask:0x4 bank_mask:0xf
    s_nop 1
    v_add_f32_dpp v12, v25, v27 quad_perm:[0,1,2,3] row_mask:0x8 bank_mask:0xf
    v_cvt_pk_bf16_f32 v12, v12, v12
    v_min_u32 v12, -2, v12
    s_cbranch_scc1 L_gs_86
    buffer_store_short v12, v54, s[40:43], s59 offen
L_gb_87:
L_skip_85:
    s_waitcnt vmcnt(0)
    s_barrier
    s_cmp_eq_u32 s30, 5
    s_cbranch_scc0 L_skip_88
    v_mov_b32 v25, 0
    s_lshl_b32 s57, s52, 2
    s_add_u32 s57, s57, s72
    s_mov_b64 exec, 1
    buffer_store_dword v25, v0, s[40:43], s57 offen offset:256 sc1
    s_mov_b64 exec, -1
    v_and_b32 v16, 31, v0
    v_lshlrev_b32 v16, 2, v16
L_pr_90:
    buffer_load_dword v17, v16, s[40:43], s72 offen offset:256 sc1
    s_sub_u32 s56, s56, 1
    s_cbranch_scc1 L_done
L_pw_89:
    s_waitcnt vmcnt(0)
    v_cmp_eq_u32 vcc, -1, v17
    s_cbranch_vccnz L_pr_90
L_skip_88:
    s_barrier
    s_branch L_spread_back
L_done:
L_exit:
    s_endpgm
.section .rodata,"a"
.p2align 6
.amdhsa_kernel interleave_layers__sliding_block_cached__dense_activation_gelu__decode_kernel
  .amdhsa_next_free_vgpr 256
  .amdhsa_next_free_sgpr 102
  .amdhsa_accum_offset 256
  .amdhsa_group_segment_fixed_size 0
  .amdhsa_kernarg_size 104
  .amdhsa_user_sgpr_count 2
  .amdhsa_user_sgpr_kernarg_segment_ptr 1
  .amdhsa_system_sgpr_workgroup_id_x 1
  .amdhsa_float_denorm_mode_32 3
.end_amdhsa_kernel
```

```asm
; @launch grid=(256,1,1) block=(512,1,1) lds=161216
.amdgcn_target "amdgcn-amd-amdhsa--gfx950"
.text
.fill 64, 4, 0xbf800000
.globl interleave_layers__sliding_block_cached__dense_activation_gelu__decode_kernel
.p2align 8
.type interleave_layers__sliding_block_cached__dense_activation_gelu__decode_kernel,@function
interleave_layers__sliding_block_cached__dense_activation_gelu__decode_kernel:
    s_load_dwordx16 s[4:19], s[0:1], 0
    s_load_dwordx8 s[20:27], s[0:1], 64
    s_load_dwordx2 s[28:29], s[0:1], 96
    s_cmp_ge_u32 s2, 256
    s_cbranch_scc1 L_exit
    s_getpc_b64 s[74:75]
L_pc:
    v_lshlrev_b32 v5, 6, v0
    v_min_u32 v5, L_exit-L_pc, v5
    global_load_dword v63, v5, s[74:75]
    v_lshrrev_b32 v5, 6, v0
    v_and_b32 v0, 63, v0
    v_readfirstlane_b32 s30, v5
    s_and_b32 s31, s2, 7
    s_lshr_b32 s52, s2, 3
    s_and_b32 s53, s52, 3
    s_lshr_b32 s54, s52, 2
    s_lshl_b32 s73, s31, 2
    s_add_u32 s73, s73, s53
    s_mul_i32 s3, s54, 3
    s_add_u32 s3, s3, s53
    s_cmp_eq_u32 s53, 3
    s_cselect_b32 s3, 31, s3
    s_cselect_b32 s70, 0, 0
    s_cmp_lt_u32 s3, 20
    s_cselect_b32 s70, 1, s70
    v_lshrrev_b32 v8, 5, v0
    v_lshlrev_b32 v8, 2, v8
    v_bfe_u32 v60, v0, 4, 1
    v_lshl_add_u32 v8, v60, 0, v8
    v_and_b32 v9, 7, v0
    v_xor_b32 v8, v8, v9
    v_lshrrev_b32 v10, 3, v0
    v_mul_u32_u24 v10, 384, v10
    v_lshl_add_u32 v5, v8, 4, v10
    v_xor_b32 v6, 32, v5
    v_lshrrev_b32 v8, 4, v0
    v_lshlrev_b32 v8, 1, v8
    v_xor_b32 v8, v8, v9
    v_lshl_add_u32 v7, v8, 4, v10
    v_lshrrev_b32 v2, 3, v0
    v_mul_u32_u24 v2, 12288, v2
    v_and_b32 v60, 7, v0
    v_lshl_add_u32 v2, v60, 4, v2
    s_mul_i32 s57, s73, 12582912
    s_mul_i32 s58, s54, 3072
    s_add_u32 s57, s57, s58
    s_add_u32 s57, s57, 11009024
    s_sub_u32 s58, 1573888, s58
    s_and_b32 s71, s73, 7
    s_mul_i32 s59, s73, 384
    s_mul_i32 s60, s54, 983040
    s_add_u32 s59, s59, s60
    s_sub_u32 s60, 7866368, s59
    s_lshl_b32 s61, s30, 11
    s_add_u32 s61, s61, 92160
    s_mul_i32 s62, s31, 75776
    s_lshl_b32 s72, s31, 9
    s_add_u32 s72, s72, 1769472
    s_mov_b32 s56, 65536
    s_mov_b32 s55, 1
    s_getreg_b32 s63, hwreg(20, 0, 3)
    s_andn2_b32 s64, 1, s63
    s_mul_i32 s64, s64, 1
    s_add_u32 s70, s70, s64
    v_mov_b32 v3, 0
    v_mov_b32 v4, 0
    v_mov_b32 v11, 0
    v_mov_b32 v24, 0
    v_mov_b32 v34, 0
    v_mov_b64 v[12:13], -1
    v_mov_b64 v[14:15], -1
    v_lshlrev_b32 v10, 4, v0
    s_waitcnt lgkmcnt(0)
    s_add_u32 s32, s6, s57
    s_addc_u32 s33, s7, 0
    s_mov_b32 s34, s58
    s_mov_b32 s35, 0x20000
    s_add_u32 s36, s8, s57
    s_addc_u32 s37, s9, 0
    s_mov_b32 s38, s58
    s_mov_b32 s39, 0x20000
    s_mov_b32 s40, s28
    s_mov_b32 s41, s29
    s_mov_b32 s42, 1773568
    s_mov_b32 s43, 0x20000
    s_add_u32 s44, s10, s59
    s_addc_u32 s45, s11, 0
    s_mov_b32 s46, s60
    s_mov_b32 s47, 0x20000
    s_sub_u32 s44, s44, 2048
    s_subb_u32 s45, s45, 0
    s_cmp_eq_u32 s30, 6
    s_cbranch_scc0 L_skip_1
    s_setprio 3
    s_xor_b32 s57, s71, 0
    s_mul_i32 s57, s57, 196608
    s_add_u32 s57, s57, 1024
    s_xor_b32 s58, s71, 1
    s_mul_i32 s58, s58, 196608
    s_add_u32 s58, s58, 0
    s_mov_b32 m0, 92160
L_dma_2:
    s_nop 0
    buffer_load_dwordx4 v5, s[32:35], s57 offen offset:0 nt lds
    buffer_load_dwordx4 v6, s[32:35], s58 offen offset:1024 nt lds
    s_add_u32 s57, s57, 24576
    s_add_u32 s58, s58, 24576
    s_add_u32 m0, m0, 2048
    s_cmp_lg_u32 m0, 108544
    s_cbranch_scc1 L_dma_2
    s_xor_b32 s57, s71, 0
    s_mul_i32 s57, s57, 196608
    s_add_u32 s57, s57, 1152
    s_xor_b32 s58, s71, 1
    s_mul_i32 s58, s58, 196608
    s_add_u32 s58, s58, 128
    s_mov_b32 m0, 108544
L_dma_3:
    s_waitcnt vmcnt(23)
    s_cmp_ge_u32 s70, 2
    s_cbranch_scc1 L_go_4
    s_waitcnt vmcnt(22)
    s_cmp_ge_u32 s70, 1
    s_cbranch_scc1 L_go_4
    s_waitcnt vmcnt(21)
L_go_4:
    buffer_load_dwordx4 v5, s[32:35], s57 offen offset:0 nt lds
    buffer_load_dwordx4 v6, s[32:35], s58 offen offset:1024 nt lds
    s_add_u32 s57, s57, 24576
    s_add_u32 s58, s58, 24576
    s_add_u32 m0, m0, 2048
    s_cmp_lg_u32 m0, 124928
    s_cbranch_scc1 L_dma_3
    s_mov_b32 s57, 2048
    s_mov_b32 s58, 1152
    s_mov_b32 s59, 256
    s_mov_b32 m0, 0
L_dma_5:
    s_waitcnt vmcnt(23)
    s_cmp_ge_u32 s70, 2
    s_cbranch_scc1 L_go_6
    s_waitcnt vmcnt(22)
    s_cmp_ge_u32 s70, 1
    s_cbranch_scc1 L_go_6
    s_waitcnt vmcnt(21)
L_go_6:
    buffer_load_dwordx4 v2, s[44:47], s57 offen offset:0 nt lds
    buffer_load_dwordx4 v2, s[44:47], s58 offen offset:1024 nt lds
    buffer_load_dwordx4 v2, s[44:47], s59 offen offset:2048 nt lds
    s_add_u32 s57, s57, 98304
    s_add_u32 s58, s58, 98304
    s_add_u32 s59, s59, 98304
    s_add_u32 m0, m0, 3072
    s_cmp_lg_u32 m0, 15360
    s_cbranch_scc1 L_dma_5
L_skip_1:
    s_cmp_lt_u32 s3, 20
    s_cselect_b32 s57, 7864320, 0
    s_add_u32 s58, s54, 1
    s_mul_i32 s58, s58, 245760
    s_cmp_lg_u32 s53, 3
    s_cselect_b64 s[48:49], s[12:13], s[16:17]
    s_cselect_b32 s50, s57, s58
    s_mov_b32 s51, 0x20000
    s_add_u32 s57, s28, 1212416
    s_sub_u32 s57, 0, s57
    s_and_b32 s57, s57, 0x7fff
    s_add_u32 s57, s57, 1212416
    s_lshr_b32 s58, s31, 1
    s_lshl_b32 s58, s58, 15
    s_add_u32 s6, s57, s58
    s_and_b32 s58, s31, 1
    s_mul_i32 s58, s58, 2560
    s_add_u32 s6, s6, s58
    s_lshl_b32 s58, s3, 7
    s_add_u32 s6, s6, s58
    s_mov_b32 s8, s57
    s_lshr_b32 s58, s52, 4
    s_lshl_b32 s58, s58, 15
    s_and_b32 s59, s52, 15
    s_lshl_b32 s59, s59, 7
    s_add_u32 s59, s59, s58
    s_add_u32 s59, s59, s57
    s_add_u32 s59, s59, 5120
    s_lshl_b32 s58, s31, 16
    s_add_u32 s59, s59, s58
    s_add_u32 s10, s28, s59
    s_addc_u32 s11, s29, 0
    s_lshr_b32 s58, s63, 2
    s_xor_b32 s58, s58, 0
    s_mul_i32 s58, s58, 8192
    s_add_u32 s7, s57, s58
    s_cmp_eq_u32 s30, 5
    s_cbranch_scc0 L_skip_7
    s_cmp_eq_u32 s52, 31
    s_cbranch_scc0 L_skip_8
    s_mov_b64 exec, 0xffffff
    buffer_store_dwordx4 v[12:15], v10, s[40:43], s72 offen sc1
    s_mov_b64 exec, -1
L_skip_8:
    s_cmp_lt_u32 s3, 20
    s_cbranch_scc0 L_skip_9
    v_and_b32 v16, 7, v0
    v_lshlrev_b32 v16, 4, v16
    v_bfe_u32 v17, v0, 3, 1
    v_lshl_add_u32 v16, v17, 13, v16
    v_lshrrev_b32 v17, 4, v0
    v_lshl_add_u32 v16, v17, 17, v16
    s_add_u32 s57, s6, 0
    buffer_store_dwordx4 v[12:15], v16, s[40:43], s57 offen sc1
L_skip_9:
    s_cmp_eq_u32 s3, 20
    s_cbranch_scc0 L_skip_10
    s_lshl_b32 s58, s31, 15
    s_add_u32 s58, s58, s8
    s_add_u32 s58, s58, 7168
    v_and_b32 v16, 7, v0
    v_lshlrev_b32 v16, 4, v16
    v_bfe_u32 v60, v0, 3, 1
    v_lshl_add_u32 v16, v60, 13, v16
    v_lshrrev_b32 v60, 4, v0
    v_lshl_add_u32 v16, v60, 28, v16
    buffer_store_dwordx4 v[12:15], v16, s[40:43], s58 offen sc1
L_skip_10:
    s_sub_u32 s58, s3, 20
    s_cmp_lt_u32 s58, 4
    s_cselect_b32 s59, s59, 0x7f000000
    v_and_b32 v16, 7, v0
    v_lshlrev_b32 v16, 4, v16
    v_bfe_u32 v60, v0, 3, 1
    v_lshl_add_u32 v16, v60, 13, v16
    v_lshrrev_b32 v60, 4, v0
    v_lshl_add_u32 v16, v60, 28, v16
    buffer_store_dwordx4 v[12:15], v16, s[40:43], s59 offen sc1
    s_mul_i32 s57, s52, 1536
    s_add_u32 s57, s57, s62
    s_mov_b32 exec_lo, 0xffffffff
    s_mov_b32 exec_hi, 0x0
    buffer_store_dwordx4 v[12:15], v10, s[40:43], s57 offen offset:1024
    s_mov_b64 exec, -1
    buffer_store_dwordx4 v[12:15], v10, s[40:43], s57 offen
    s_mov_b64 exec, -1
    v_lshlrev_b32 v16, 4, v0
    v_add_u32 v16, 159744, v16
    ds_write_b128 v16, v[12:15]
    v_subrev_u32 v16, 8, v0
    v_cmp_gt_u32 vcc, 40, v16
    v_mov_b32 v16, 0x3f803f80
    s_nop 0
    v_cndmask_b32 v18, 0, v16, vcc
    v_min_u32 v16, 55, v0
    v_lshlrev_b32 v16, 2, v16
    v_add_u32 v16, 160992, v16
    ds_write_b32 v16, v18
    v_and_b32 v3, 7, v0
    v_lshlrev_b32 v3, 5, v3
L_skip_7:
    s_cmp_eq_u32 s30, 7
    s_cbranch_scc0 L_skip_11
    v_and_b32 v60, 31, v0
    v_min_u32 v60, 19, v60
    s_mul_i32 s57, s54, 160
    v_lshrrev_b32 v16, 5, v0
    v_lshlrev_b32 v16, 2, v16
    v_add_u32 v16, s57, v16
    v_lshl_add_u32 v16, v60, 3, v16
    global_load_dword v28, v16, s[4:5]
    global_load_dword v4, v16, s[22:23]
L_skip_11:
    s_sub_u32 s58, s30, 4
    s_cmp_lt_u32 s58, 3
    s_cbranch_scc0 L_skip_12
    s_mul_i32 s57, s31, 3
    s_add_u32 s57, s57, s58
    s_lshl_b32 s57, s57, 7
    v_lshlrev_b32 v16, 1, v0
    v_add_u32 v16, s57, v16
    global_load_short_d16_hi v4, v16, s[18:19]
L_skip_12:
    v_bfe_u32 v8, v0, 1, 3
    v_lshrrev_b32 v9, 4, v0
    v_xor_b32 v9, v8, v9
    v_bfe_u32 v8, v0, 2, 1
    v_lshlrev_b32 v8, 10, v8
    v_bfe_u32 v60, v0, 3, 1
    v_lshl_add_u32 v8, v60, 9, v8
    v_and_b32 v60, 3, v0
    v_lshl_add_u32 v8, v60, 7, v8
    v_add_u32 v8, s61, v8
    v_lshl_add_u32 v8, v9, 4, v8
    v_xor_b32 v9, 64, v8
    v_bfe_u32 v1, v0, 1, 1
    v_mul_u32_u24 v1, 43690, v1
    v_add_u32 v1, 17476, v1
    s_waitcnt vmcnt(31)
    s_barrier
    ds_read_b128 v[64:67], v8 offset:0
    ds_read_b128 v[68:71], v9 offset:0
    s_cmp_eq_u32 s30, 6
    s_cbranch_scc0 L_skip_13
    s_xor_b32 s57, s71, 0
    s_mul_i32 s57, s57, 196608
    s_add_u32 s57, s57, 1280
    s_xor_b32 s58, s71, 1
    s_mul_i32 s58, s58, 196608
    s_add_u32 s58, s58, 256
    s_mov_b32 m0, 124928
L_dma_14:
    s_waitcnt vmcnt(23)
    s_cmp_ge_u32 s70, 2
    s_cbranch_scc1 L_go_15
    s_waitcnt vmcnt(22)
    s_cmp_ge_u32 s70, 1
    s_cbranch_scc1 L_go_15
    s_waitcnt vmcnt(21)
L_go_15:
    buffer_load_dwordx4 v5, s[32:35], s57 offen offset:0 nt lds
    buffer_load_dwordx4 v6, s[32:35], s58 offen offset:1024 nt lds
    s_add_u32 s57, s57, 24576
    s_add_u32 s58, s58, 24576
    s_add_u32 m0, m0, 2048
    s_cmp_lg_u32 m0, 141312
    s_cbranch_scc1 L_dma_14
L_skip_13:
    s_waitcnt lgkmcnt(0)
    s_cmp_eq_u32 s30, 5
    s_cbranch_scc0 L_skip_16
    s_cmp_eq_u32 s52, 31
    s_cbranch_scc0 L_skip_17
    s_lshl_b32 s57, s31, 5
    v_mov_b32 v16, s57
    s_add_u32 s57, s63, 1
    v_mov_b32 v12, s57
    s_waitcnt vmcnt(4)
    s_mov_b64 exec, 0x1
    global_store_dword v16, v12, s[26:27] sc1
    s_mov_b64 exec, -1
L_skip_17:
L_skip_16:
    s_waitcnt vmcnt(31)
    s_barrier
    ds_read_b128 v[72:75], v8 offset:16384
    ds_read_b128 v[76:79], v9 offset:16384
    s_cmp_eq_u32 s30, 6
    s_cbranch_scc0 L_skip_18
    s_mov_b32 s57, 493568
    s_mov_b32 s58, 492672
    s_mov_b32 s59, 491776
    s_mov_b32 m0, 15360
L_dma_19:
    s_waitcnt vmcnt(23)
    s_cmp_ge_u32 s70, 2
    s_cbranch_scc1 L_go_20
    s_waitcnt vmcnt(22)
    s_cmp_ge_u32 s70, 1
    s_cbranch_scc1 L_go_20
    s_waitcnt vmcnt(21)
L_go_20:
    buffer_load_dwordx4 v2, s[44:47], s57 offen offset:0 nt lds
    buffer_load_dwordx4 v2, s[44:47], s58 offen offset:1024 nt lds
    buffer_load_dwordx4 v2, s[44:47], s59 offen offset:2048 nt lds
    s_add_u32 s57, s57, 98304
    s_add_u32 s58, s58, 98304
    s_add_u32 s59, s59, 98304
    s_add_u32 m0, m0, 3072
    s_cmp_lg_u32 m0, 30720
    s_cbranch_scc1 L_dma_19
    s_xor_b32 s57, s71, 2
    s_mul_i32 s57, s57, 196608
    s_add_u32 s57, s57, 1024
    s_xor_b32 s58, s71, 3
    s_mul_i32 s58, s58, 196608
    s_add_u32 s58, s58, 0
    s_mov_b32 m0, 141312
L_dma_21:
    s_waitcnt vmcnt(23)
    s_cmp_ge_u32 s70, 2
    s_cbranch_scc1 L_go_22
    s_waitcnt vmcnt(22)
    s_cmp_ge_u32 s70, 1
    s_cbranch_scc1 L_go_22
    s_waitcnt vmcnt(21)
L_go_22:
    buffer_load_dwordx4 v5, s[32:35], s57 offen offset:0 nt lds
    buffer_load_dwordx4 v6, s[32:35], s58 offen offset:1024 nt lds
    s_add_u32 s57, s57, 24576
    s_add_u32 s58, s58, 24576
    s_add_u32 m0, m0, 2048
    s_cmp_lg_u32 m0, 157696
    s_cbranch_scc1 L_dma_21
L_skip_18:
    s_waitcnt lgkmcnt(0)
    s_cmp_lt_u32 s30, 4
    s_cbranch_scc0 L_skip_23
    s_mov_b64 exec, 0
    s_cmp_eq_u32 s30, 1
    s_cbranch_scc1 L_pad1
    s_cmp_eq_u32 s30, 2
    s_cbranch_scc1 L_pad2
    s_cmp_eq_u32 s30, 3
    s_cbranch_scc1 L_pad3
    s_branch L_pad0
L_padback:
    s_mov_b64 exec, -1
L_skip_23:
    s_waitcnt vmcnt(31)
    s_barrier
    ds_read_b128 v[80:83], v8 offset:32768
    ds_read_b128 v[84:87], v9 offset:32768
    s_cmp_eq_u32 s30, 6
    s_cbranch_scc0 L_skip_24
    s_cmp_lg_u32 s53, 3
    s_cbranch_scc0 L_wb_25
    s_mul_i32 s57, s31, 983040
    s_lshl_b32 s58, s3, 6
    s_add_u32 s57, s57, s58
    v_bfe_u32 v38, v0, 4, 1
    v_lshlrev_b32 v38, 1, v38
    v_xor_b32 v38, v38, v0
    v_and_b32 v38, 3, v38
    v_lshrrev_b32 v3, 5, v0
    v_mul_u32_u24 v3, 10240, v3
    v_bfe_u32 v39, v0, 4, 1
    v_mul_u32_u24 v39, 2560, v39
    v_add_u32 v3, v39, v3
    v_bfe_u32 v39, v0, 3, 1
    v_mul_u32_u24 v39, 5120, v39
    v_add_u32 v3, v39, v3
    v_bfe_u32 v39, v0, 2, 1
    v_mul_u32_u24 v39, 20480, v39
    v_add_u32 v3, v39, v3
    v_add_u32 v3, s57, v3
    v_lshl_add_u32 v3, v38, 4, v3
    s_mov_b32 s14, 40960
    s_mov_b32 s15, 256
    s_branch L_we_26
L_wb_25:
    s_mul_i32 s57, s31, 384
    s_mul_i32 s58, s54, 245760
    s_add_u32 s57, s57, s58
    v_lshlrev_b32 v3, 4, v0
    v_add_u32 v3, s57, v3
    v_mov_b32 v38, 2688
    v_cmp_lt_u32 vcc, 23, v0
    s_nop 1
    v_cndmask_b32 v38, 0, v38, vcc
    v_add_u32 v3, v38, v3
    v_mov_b32 v38, 0x7f000000
    v_cmp_lt_u32 vcc, 47, v0
    s_nop 1
    v_cndmask_b32 v3, v3, v38, vcc
    s_mov_b32 s14, 12288
    s_mov_b32 s15, 5120
L_we_26:
    s_mul_i32 s57, s14, 0
    s_mov_b32 m0, 30720
    s_nop 0
    buffer_load_dwordx4 v3, s[48:51], s57 offen offset:0 nt lds
    s_mul_i32 s57, s14, 0
    s_add_u32 s57, s57, s15
    s_mov_b32 m0, 30720
    s_nop 0
    buffer_load_dwordx4 v3, s[48:51], s57 offen offset:1024 nt lds
    s_xor_b32 s57, s71, 2
    s_mul_i32 s57, s57, 196608
    s_add_u32 s57, s57, 1152
    s_xor_b32 s58, s71, 3
    s_mul_i32 s58, s58, 196608
    s_add_u32 s58, s58, 128
    s_mov_b32 m0, 92160
L_dma_27:
    s_waitcnt vmcnt(23)
    s_cmp_ge_u32 s70, 2
    s_cbranch_scc1 L_go_28
    s_waitcnt vmcnt(22)
    s_cmp_ge_u32 s70, 1
    s_cbranch_scc1 L_go_28
    s_waitcnt vmcnt(21)
L_go_28:
    buffer_load_dwordx4 v5, s[32:35], s57 offen offset:0 nt lds
    buffer_load_dwordx4 v6, s[32:35], s58 offen offset:1024 nt lds
    s_add_u32 s57, s57, 24576
    s_add_u32 s58, s58, 24576
    s_add_u32 m0, m0, 2048
    s_cmp_lg_u32 m0, 108544
    s_cbranch_scc1 L_dma_27
    s_mul_i32 s57, s14, 1
    s_mov_b32 m0, 32768
    s_nop 0
    buffer_load_dwordx4 v3, s[48:51], s57 offen offset:0 nt lds
    s_mul_i32 s57, s14, 1
    s_add_u32 s57, s57, s15
    s_mov_b32 m0, 32768
    s_nop 0
    buffer_load_dwordx4 v3, s[48:51], s57 offen offset:1024 nt lds
    s_xor_b32 s57, s71, 2
    s_mul_i32 s57, s57, 196608
    s_add_u32 s57, s57, 1280
    s_xor_b32 s58, s71, 3
    s_mul_i32 s58, s58, 196608
    s_add_u32 s58, s58, 256
    s_mov_b32 m0, 108544
L_dma_29:
    s_waitcnt vmcnt(23)
    s_cmp_ge_u32 s70, 2
    s_cbranch_scc1 L_go_30
    s_waitcnt vmcnt(22)
    s_cmp_ge_u32 s70, 1
    s_cbranch_scc1 L_go_30
    s_waitcnt vmcnt(21)
L_go_30:
    buffer_load_dwordx4 v5, s[32:35], s57 offen offset:0 nt lds
    buffer_load_dwordx4 v6, s[32:35], s58 offen offset:1024 nt lds
    s_add_u32 s57, s57, 24576
    s_add_u32 s58, s58, 24576
    s_add_u32 m0, m0, 2048
    s_cmp_lg_u32 m0, 124928
    s_cbranch_scc1 L_dma_29
L_skip_24:
    s_waitcnt lgkmcnt(0)
    s_cmp_lt_u32 s30, 5
    s_cbranch_scc0 L_skip_31
    s_waitcnt vmcnt(0)
L_skip_31:
    s_cmp_eq_u32 s30, 7
    s_cbranch_scc0 L_skip_32
    v_and_b32 v60, 31, v0
    v_cmp_gt_u32 s[64:65], 20, v60
    v_min_u32 v60, 19, v60
    v_lshrrev_b32 v35, 5, v0
    v_lshlrev_b32 v35, 2, v35
    v_add_u32 v35, 160832, v35
    v_lshl_add_u32 v35, v60, 3, v35
    s_mul_i32 s66, s53, 6400
    s_add_u32 s66, s66, s62
    s_add_u32 s66, s66, 49152
    s_add_u32 s67, s66, 6144
    s_lshl_b32 s57, s54, 3
    v_lshrrev_b32 v34, 5, v0
    v_lshlrev_b32 v34, 2, v34
    v_add_u32 v34, s57, v34
    v_and_b32 v60, 31, v0
    v_mov_b32 v61, 0x7f000000
    v_cmp_ne_u32 vcc, 31, v60
    s_nop 1
    v_cndmask_b32 v34, v34, v61, vcc
    v_mov_b32 v61, 0x3f803f80
    s_waitcnt vmcnt(0)
    ds_write_b32 v35, v28
    s_waitcnt lgkmcnt(0)
L_skip_32:
    s_cmp_eq_u32 s30, 5
    s_cbranch_scc0 L_skip_33
    s_waitcnt vmcnt(0)
    s_lshr_b32 s65, s63, 2
    s_sub_u32 s58, s3, 20
    s_cmp_lt_u32 s58, 4
    s_cbranch_scc0 L_skip_34
    s_mov_b32 s67, 0
    s_load_dword s66, s[10:11], 0
    s_load_dword s67, s[10:11], 8192
    s_waitcnt lgkmcnt(1)
    s_sleep 1
    s_mov_b32 s65, s67
L_skip_34:
L_skip_33:
    s_waitcnt vmcnt(36)
    s_barrier
    ds_read_b128 v[88:91], v8 offset:49152
    ds_read_b128 v[92:95], v9 offset:49152
    s_cmp_eq_u32 s30, 6
    s_cbranch_scc0 L_skip_35
    s_mul_i32 s57, s14, 2
    s_mov_b32 m0, 34816
    s_nop 0
    buffer_load_dwordx4 v3, s[48:51], s57 offen offset:0 nt lds
    s_mul_i32 s57, s14, 2
    s_add_u32 s57, s57, s15
    s_mov_b32 m0, 34816
    s_nop 0
    buffer_load_dwordx4 v3, s[48:51], s57 offen offset:1024 nt lds
    s_xor_b32 s57, s71, 4
    s_mul_i32 s57, s57, 196608
    s_add_u32 s57, s57, 1024
    s_xor_b32 s58, s71, 5
    s_mul_i32 s58, s58, 196608
    s_add_u32 s58, s58, 0
    s_mov_b32 m0, 124928
L_dma_36:
    s_waitcnt vmcnt(23)
    s_cmp_ge_u32 s70, 2
    s_cbranch_scc1 L_go_37
    s_waitcnt vmcnt(22)
    s_cmp_ge_u32 s70, 1
    s_cbranch_scc1 L_go_37
    s_waitcnt vmcnt(21)
L_go_37:
    buffer_load_dwordx4 v5, s[32:35], s57 offen offset:0 nt lds
    buffer_load_dwordx4 v6, s[32:35], s58 offen offset:1024 nt lds
    s_add_u32 s57, s57, 24576
    s_add_u32 s58, s58, 24576
    s_add_u32 m0, m0, 2048
    s_cmp_lg_u32 m0, 141312
    s_cbranch_scc1 L_dma_36
L_skip_35:
    s_waitcnt lgkmcnt(0)
    s_cmp_eq_u32 s30, 7
    s_cbranch_scc0 L_skip_38
    v_cndmask_b32 v29, 0, v28, s[64:65]
    v_dot2_f32_bf16 v33, v29, v61, 0
    v_dot2_f32_bf16 v32, v29, v29, 0
    v_lshlrev_b32 v2, 16, v28
    v_and_b32 v3, 0xffff0000, v28
    s_cmp_eq_u32 s55, 0
    v_permlane32_swap_b32 v33, v32
    v_add_f32 v33, v33, v32
    s_nop 1
    v_add_f32_dpp v33, v33, v33 row_ror:8 row_mask:0xf bank_mask:0xf
    s_nop 1
    v_add_f32_dpp v33, v33, v33 row_ror:4 row_mask:0xf bank_mask:0xf
    s_nop 1
    v_add_f32_dpp v33, v33, v33 row_ror:2 row_mask:0xf bank_mask:0xf
    s_nop 1
    v_add_f32_dpp v33, v33, v33 row_ror:1 row_mask:0xf bank_mask:0xf
    s_nop 1
    v_add_f32_dpp v33, v33, v33 row_bcast:15 row_mask:0xa bank_mask:0xf
    v_min_u32 v33, -2, v33
    s_cbranch_scc1 L_gs_39
    buffer_store_dword v33, v34, s[40:43], s67 offen
L_gb_40:
    s_waitcnt vmcnt(1)
L_skip_38:
    s_cmp_lt_u32 s30, 6
    s_cbranch_scc0 L_skip_41
    s_lshr_b32 s57, s30, 1
    s_mul_i32 s57, s57, 1024
    s_and_b32 s58, s30, 1
    s_lshl_b32 s58, s58, 6
    s_add_u32 s57, s57, s58
    v_lshrrev_b32 v18, 5, v0
    v_mul_u32_u24 v18, 6144, v18
    v_bfe_u32 v60, v0, 3, 1
    v_mul_u32_u24 v60, 3072, v60
    v_add_u32 v18, v60, v18
    v_bfe_u32 v60, v0, 4, 1
    v_lshl_add_u32 v18, v60, 9, v18
    v_bfe_u32 v60, v0, 2, 1
    v_lshl_add_u32 v18, v60, 7, v18
    v_and_b32 v60, 3, v0
    v_lshl_add_u32 v18, v60, 3, v18
    v_add_u32 v18, s57, v18
    v_bfe_u32 v19, v0, 4, 1
    v_mul_u32_u24 v19, 3072, v19
    v_bfe_u32 v60, v0, 3, 1
    v_lshl_add_u32 v19, v60, 9, v19
    v_bfe_u32 v60, v0, 2, 1
    v_lshl_add_u32 v19, v60, 7, v19
    v_and_b32 v60, 3, v0
    v_lshl_add_u32 v19, v60, 3, v19
    v_add_u32 v19, s57, v19
    v_add_u32 v19, 24576, v19
    ds_read_b64_tr_b16 v[28:29], v18 offset:0
    ds_read_b64_tr_b16 v[30:31], v18 offset:256
    ds_read_b64_tr_b16 v[32:33], v18 offset:12288
    ds_read_b64_tr_b16 v[34:35], v18 offset:12544
    ds_read_b64_tr_b16 v[36:37], v19 offset:0
    ds_read_b64_tr_b16 v[38:39], v19 offset:256
    ds_read_b64_tr_b16 v[40:41], v18 offset:32
    ds_read_b64_tr_b16 v[42:43], v18 offset:288
    ds_read_b64_tr_b16 v[44:45], v18 offset:12320
    ds_read_b64_tr_b16 v[46:47], v18 offset:12576
    ds_read_b64_tr_b16 v[48:49], v19 offset:32
    ds_read_b64_tr_b16 v[50:51], v19 offset:288
    v_lshrrev_b32 v52, 4, v0
    v_lshlrev_b32 v52, 5, v52
    v_bfe_u32 v60, v0, 1, 1
    v_lshl_add_u32 v52, v60, 4, v52
    v_and_b32 v60, 1, v0
    v_mul_u32_u24 v60, 192, v60
    v_add_u32 v52, v60, v52
    v_add_u32 v52, 160832, v52
    v_lshrrev_b32 v53, 4, v0
    v_lshlrev_b32 v53, 4, v53
    v_bfe_u32 v60, v0, 1, 1
    v_lshl_add_u32 v53, v60, 3, v53
    v_and_b32 v60, 1, v0
    v_mul_u32_u24 v60, 192, v60
    v_add_u32 v53, v60, v53
    v_add_u32 v53, 160960, v53
    v_mov_b64 v[20:21], 0
    v_mov_b64 v[22:23], 0
    v_mov_b64 v[24:25], 0
    v_mov_b64 v[26:27], 0
    s_lshl_b32 s57, s54, 1
    s_lshl_b32 s58, s30, 9
    s_add_u32 s57, s57, s58
    v_and_b32 v54, 31, v0
    v_lshlrev_b32 v54, 4, v54
    v_lshrrev_b32 v60, 5, v0
    v_mul_u32_u24 v60, 3072, v60
    v_add_u32 v54, v60, v54
    v_add_u32 v54, s57, v54
    s_mul_i32 s59, s53, 6400
    s_add_u32 s59, s59, s62
    s_add_u32 s59, s59, 49152
    s_add_u32 s60, s59, 6144
    ds_read_b128 v[12:15], v52
    ds_read_b64 v[16:17], v53
    s_waitcnt lgkmcnt(1)
    v_smfmac_f32_16x16x64_bf16 v[20:23], v[12:15], v[28:35], v1
    v_smfmac_f32_16x16x64_bf16 v[24:27], v[12:15], v[40:47], v1
    s_waitcnt lgkmcnt(0)
    v_smfmac_f32_16x16x32_bf16 v[20:23], v[16:17], v[36:39], v1
    v_smfmac_f32_16x16x32_bf16 v[24:27], v[16:17], v[48:51], v1
    s_cmp_eq_u32 s55, 0
    s_nop 5
    v_add_f32 v12, v20, v22
    s_nop 1
    v_add_f32_dpp v12, v24, v26 quad_perm:[0,1,2,3] row_mask:0x2 bank_mask:0xf
    s_nop 1
    v_add_f32_dpp v12, v21, v23 quad_perm:[0,1,2,3] row_mask:0x4 bank_mask:0xf
    s_nop 1
    v_add_f32_dpp v12, v25, v27 quad_perm:[0,1,2,3] row_mask:0x8 bank_mask:0xf
    v_cvt_pk_bf16_f32 v12, v12, v12
    v_min_u32 v12, -2, v12
    s_cbranch_scc1 L_gs_42
    buffer_store_short v12, v54, s[40:43], s59 offen
L_gb_43:
L_skip_41:
    s_cmp_eq_u32 s30, 5
    s_cbranch_scc0 L_skip_44
    global_load_dword v2, v3, s[26:27] sc1
L_skip_44:
    s_waitcnt vmcnt(36)
    s_barrier
    ds_read_b128 v[96:99], v8 offset:0
    ds_read_b128 v[100:103], v9 offset:0
    s_cmp_eq_u32 s30, 6
    s_cbranch_scc0 L_skip_45
    s_mul_i32 s57, s14, 3
    s_mov_b32 m0, 36864
    s_nop 0
    buffer_load_dwordx4 v3, s[48:51], s57 offen offset:0 nt lds
    s_mul_i32 s57, s14, 3
    s_add_u32 s57, s57, s15
    s_mov_b32 m0, 36864
    s_nop 0
    buffer_load_dwordx4 v3, s[48:51], s57 offen offset:1024 nt lds
    s_xor_b32 s57, s71, 4
    s_mul_i32 s57, s57, 196608
    s_add_u32 s57, s57, 1152
    s_xor_b32 s58, s71, 5
    s_mul_i32 s58, s58, 196608
    s_add_u32 s58, s58, 128
    s_mov_b32 m0, 141312
L_dma_46:
    s_waitcnt vmcnt(23)
    s_cmp_ge_u32 s70, 2
    s_cbranch_scc1 L_go_47
    s_waitcnt vmcnt(22)
    s_cmp_ge_u32 s70, 1
    s_cbranch_scc1 L_go_47
    s_waitcnt vmcnt(21)
L_go_47:
    buffer_load_dwordx4 v5, s[32:35], s57 offen offset:0 nt lds
    buffer_load_dwordx4 v6, s[32:35], s58 offen offset:1024 nt lds
    s_add_u32 s57, s57, 24576
    s_add_u32 s58, s58, 24576
    s_add_u32 m0, m0, 2048
    s_cmp_lg_u32 m0, 157696
    s_cbranch_scc1 L_dma_46
L_skip_45:
    s_waitcnt lgkmcnt(0)
    s_waitcnt vmcnt(36)
    s_barrier
    ds_read_b128 v[104:107], v8 offset:16384
    ds_read_b128 v[108:111], v9 offset:16384
    s_cmp_eq_u32 s30, 6
    s_cbranch_scc0 L_skip_48
    s_mul_i32 s57, s14, 4
    s_mov_b32 m0, 38912
    s_nop 0
    buffer_load_dwordx4 v3, s[48:51], s57 offen offset:0 nt lds
    s_mul_i32 s57, s14, 4
    s_add_u32 s57, s57, s15
    s_mov_b32 m0, 38912
    s_nop 0
    buffer_load_dwordx4 v3, s[48:51], s57 offen offset:1024 nt lds
    s_xor_b32 s57, s71, 4
    s_mul_i32 s57, s57, 196608
    s_add_u32 s57, s57, 1280
    s_xor_b32 s58, s71, 5
    s_mul_i32 s58, s58, 196608
    s_add_u32 s58, s58, 256
    s_mov_b32 m0, 92160
L_dma_49:
    s_waitcnt vmcnt(23)
    s_cmp_ge_u32 s70, 2
    s_cbranch_scc1 L_go_50
    s_waitcnt vmcnt(22)
    s_cmp_ge_u32 s70, 1
    s_cbranch_scc1 L_go_50
    s_waitcnt vmcnt(21)
L_go_50:
    buffer_load_dwordx4 v5, s[32:35], s57 offen offset:0 nt lds
    buffer_load_dwordx4 v6, s[32:35], s58 offen offset:1024 nt lds
    s_add_u32 s57, s57, 24576
    s_add_u32 s58, s58, 24576
    s_add_u32 m0, m0, 2048
    s_cmp_lg_u32 m0, 108544
    s_cbranch_scc1 L_dma_49
L_skip_48:
    s_waitcnt lgkmcnt(0)
    s_cmp_lg_u32 s30, 6
    s_cbranch_scc0 L_skip_51
    s_waitcnt vmcnt(0)
L_skip_51:
    s_waitcnt vmcnt(36)
    s_barrier
    ds_read_b128 v[112:115], v8 offset:32768
    ds_read_b128 v[116:119], v9 offset:32768
    s_cmp_eq_u32 s30, 6
    s_cbranch_scc0 L_skip_52
    s_mul_i32 s57, s14, 5
    s_mov_b32 m0, 40960
    s_nop 0
    buffer_load_dwordx4 v3, s[48:51], s57 offen offset:0 nt lds
    s_mul_i32 s57, s14, 5
    s_add_u32 s57, s57, s15
    s_mov_b32 m0, 40960
    s_nop 0
    buffer_load_dwordx4 v3, s[48:51], s57 offen offset:1024 nt lds
    s_xor_b32 s57, s71, 6
    s_mul_i32 s57, s57, 196608
    s_add_u32 s57, s57, 1024
    s_xor_b32 s58, s71, 7
    s_mul_i32 s58, s58, 196608
    s_add_u32 s58, s58, 0
    s_mov_b32 m0, 108544
L_dma_53:
    s_waitcnt vmcnt(23)
    s_cmp_ge_u32 s70, 2
    s_cbranch_scc1 L_go_54
    s_waitcnt vmcnt(22)
    s_cmp_ge_u32 s70, 1
    s_cbranch_scc1 L_go_54
    s_waitcnt vmcnt(21)
L_go_54:
    buffer_load_dwordx4 v5, s[32:35], s57 offen offset:0 nt lds
    buffer_load_dwordx4 v6, s[32:35], s58 offen offset:1024 nt lds
    s_add_u32 s57, s57, 24576
    s_add_u32 s58, s58, 24576
    s_add_u32 m0, m0, 2048
    s_cmp_lg_u32 m0, 124928
    s_cbranch_scc1 L_dma_53
L_skip_52:
    s_waitcnt lgkmcnt(0)
    s_cmp_eq_u32 s30, 5
    s_cbranch_scc0 L_skip_55
L_cw_56:
    v_readlane_b32 s57, v2, s31
    s_cmp_eq_u32 s57, 0
    s_cbranch_scc1 L_cr_57
    s_lshr_b32 s58, s63, 2
    s_xor_b32 s58, s58, s65
    s_and_b32 s58, s58, 1
    v_mov_b32 v25, s58
    s_sub_u32 s57, s57, 1
    s_cmp_eq_u32 s57, s63
    s_cselect_b32 s64, 1, 0
    s_cbranch_scc0 L_far_58
    s_lshl_b32 s57, s52, 2
    s_add_u32 s57, s57, s72
    s_mov_b64 exec, 1
    buffer_store_dword v25, v0, s[40:43], s57 offen offset:0
    s_mov_b64 exec, -1
L_fb_59:
L_skip_55:
    s_waitcnt vmcnt(36)
    s_barrier
    ds_read_b128 v[120:123], v8 offset:49152
    ds_read_b128 v[124:127], v9 offset:49152
    s_cmp_eq_u32 s30, 6
    s_cbranch_scc0 L_skip_60
    s_mul_i32 s57, s14, 6
    s_mov_b32 m0, 43008
    s_nop 0
    buffer_load_dwordx4 v3, s[48:51], s57 offen offset:0 nt lds
    s_mul_i32 s57, s14, 6
    s_add_u32 s57, s57, s15
    s_mov_b32 m0, 43008
    s_nop 0
    buffer_load_dwordx4 v3, s[48:51], s57 offen offset:1024 nt lds
    s_xor_b32 s57, s71, 6
    s_mul_i32 s57, s57, 196608
    s_add_u32 s57, s57, 1152
    s_xor_b32 s58, s71, 7
    s_mul_i32 s58, s58, 196608
    s_add_u32 s58, s58, 128
    s_mov_b32 m0, 124928
L_dma_61:
    s_waitcnt vmcnt(23)
    s_cmp_ge_u32 s70, 2
    s_cbranch_scc1 L_go_62
    s_waitcnt vmcnt(22)
    s_cmp_ge_u32 s70, 1
    s_cbranch_scc1 L_go_62
    s_waitcnt vmcnt(21)
L_go_62:
    buffer_load_dwordx4 v5, s[32:35], s57 offen offset:0 nt lds
    buffer_load_dwordx4 v6, s[32:35], s58 offen offset:1024 nt lds
    s_add_u32 s57, s57, 24576
    s_add_u32 s58, s58, 24576
    s_add_u32 m0, m0, 2048
    s_cmp_lg_u32 m0, 141312
    s_cbranch_scc1 L_dma_61
L_skip_60:
    s_waitcnt lgkmcnt(0)
    s_waitcnt vmcnt(36)
    s_barrier
    ds_read_b128 v[128:131], v8 offset:0
    ds_read_b128 v[132:135], v9 offset:0
    s_cmp_eq_u32 s30, 6
    s_cbranch_scc0 L_skip_63
    s_mul_i32 s57, s14, 7
    s_mov_b32 m0, 45056
    s_nop 0
    buffer_load_dwordx4 v3, s[48:51], s57 offen offset:0 nt lds
    s_mul_i32 s57, s14, 7
    s_add_u32 s57, s57, s15
    s_mov_b32 m0, 45056
    s_nop 0
    buffer_load_dwordx4 v3, s[48:51], s57 offen offset:1024 nt lds
    s_xor_b32 s57, s71, 6
    s_mul_i32 s57, s57, 196608
    s_add_u32 s57, s57, 1280
    s_xor_b32 s58, s71, 7
    s_mul_i32 s58, s58, 196608
    s_add_u32 s58, s58, 256
    s_mov_b32 m0, 141312
L_dma_64:
    s_waitcnt vmcnt(23)
    s_cmp_ge_u32 s70, 2
    s_cbranch_scc1 L_go_65
    s_waitcnt vmcnt(22)
    s_cmp_ge_u32 s70, 1
    s_cbranch_scc1 L_go_65
    s_waitcnt vmcnt(21)
L_go_65:
    buffer_load_dwordx4 v5, s[32:35], s57 offen offset:0 nt lds
    buffer_load_dwordx4 v6, s[32:35], s58 offen offset:1024 nt lds
    s_add_u32 s57, s57, 24576
    s_add_u32 s58, s58, 24576
    s_add_u32 m0, m0, 2048
    s_cmp_lg_u32 m0, 157696
    s_cbranch_scc1 L_dma_64
L_skip_63:
    s_waitcnt lgkmcnt(0)
    s_cmp_eq_u32 s30, 5
    s_cbranch_scc0 L_skip_66
    v_lshlrev_b32 v24, 2, v0
    buffer_load_dword v2, v24, s[40:43], s72 offen sc1
L_skip_66:
    s_waitcnt vmcnt(36)
    s_barrier
    ds_read_b128 v[136:139], v8 offset:16384
    ds_read_b128 v[140:143], v9 offset:16384
    s_cmp_eq_u32 s30, 6
    s_cbranch_scc0 L_skip_67
    s_mul_i32 s57, s14, 8
    s_mov_b32 m0, 47104
    s_nop 0
    buffer_load_dwordx4 v3, s[48:51], s57 offen offset:0 nt lds
    s_mul_i32 s57, s14, 8
    s_add_u32 s57, s57, s15
    s_mov_b32 m0, 47104
    s_nop 0
    buffer_load_dwordx4 v3, s[48:51], s57 offen offset:1024 nt lds
    s_xor_b32 s57, s71, 0
    s_mul_i32 s57, s57, 196608
    s_add_u32 s57, s57, 1024
    s_xor_b32 s58, s71, 2
    s_mul_i32 s58, s58, 196608
    s_add_u32 s58, s58, 0
    s_mov_b32 m0, 92160
L_dma_68:
    s_waitcnt vmcnt(23)
    s_cmp_ge_u32 s70, 2
    s_cbranch_scc1 L_go_69
    s_waitcnt vmcnt(22)
    s_cmp_ge_u32 s70, 1
    s_cbranch_scc1 L_go_69
    s_waitcnt vmcnt(21)
L_go_69:
    buffer_load_dwordx4 v7, s[36:39], s57 offen offset:0 nt lds
    buffer_load_dwordx4 v7, s[36:39], s58 offen offset:1024 nt lds
    s_add_u32 s57, s57, 24576
    s_add_u32 s58, s58, 24576
    s_add_u32 m0, m0, 2048
    s_cmp_lg_u32 m0, 108544
    s_cbranch_scc1 L_dma_68
L_skip_67:
    s_waitcnt lgkmcnt(0)
    s_waitcnt vmcnt(36)
    s_barrier
    ds_read_b128 v[144:147], v8 offset:32768
    ds_read_b128 v[148:151], v9 offset:32768
    s_cmp_eq_u32 s30, 6
    s_cbranch_scc0 L_skip_70
    s_mul_i32 s57, s14, 9
    s_mov_b32 m0, 49152
    s_nop 0
    buffer_load_dwordx4 v3, s[48:51], s57 offen offset:0 nt lds
    s_mul_i32 s57, s14, 9
    s_add_u32 s57, s57, s15
    s_mov_b32 m0, 49152
    s_nop 0
    buffer_load_dwordx4 v3, s[48:51], s57 offen offset:1024 nt lds
    s_xor_b32 s57, s71, 0
    s_mul_i32 s57, s57, 196608
    s_add_u32 s57, s57, 1152
    s_xor_b32 s58, s71, 2
    s_mul_i32 s58, s58, 196608
    s_add_u32 s58, s58, 128
    s_mov_b32 m0, 108544
L_dma_71:
    s_waitcnt vmcnt(23)
    s_cmp_ge_u32 s70, 2
    s_cbranch_scc1 L_go_72
    s_waitcnt vmcnt(22)
    s_cmp_ge_u32 s70, 1
    s_cbranch_scc1 L_go_72
    s_waitcnt vmcnt(21)
L_go_72:
    buffer_load_dwordx4 v7, s[36:39], s57 offen offset:0 nt lds
    buffer_load_dwordx4 v7, s[36:39], s58 offen offset:1024 nt lds
    s_add_u32 s57, s57, 24576
    s_add_u32 s58, s58, 24576
    s_add_u32 m0, m0, 2048
    s_cmp_lg_u32 m0, 124928
    s_cbranch_scc1 L_dma_71
L_skip_70:
    s_waitcnt lgkmcnt(0)
    s_cmp_eq_u32 s30, 5
    s_cbranch_scc0 L_skip_73
L_cw_74:
    s_waitcnt vmcnt(0)
    v_cmp_ne_u32 vcc, -1, v2
    s_mov_b32 s57, 0
    s_mov_b32 s68, 2
    s_cmp_eq_u32 s64, 0
    s_cbranch_scc1 L_cd_76
    s_cmp_lg_u32 vcc_hi, 0
    s_cbranch_scc1 L_cd_76
    s_cmp_lg_u32 vcc_lo, -1
    s_cbranch_scc1 L_cr_75
    v_cmp_eq_u32 vcc, 1, v2
    s_bcnt1_i32_b32 s68, vcc_lo
    s_mov_b32 s57, 1
L_cd_76:
    v_mov_b32 v37, 160768
    v_mov_b32 v38, s57
    ds_write_b32 v37, v38
    s_waitcnt lgkmcnt(0)
L_skip_73:
    s_waitcnt vmcnt(36)
    s_barrier
    ds_read_b128 v[152:155], v8 offset:49152
    ds_read_b128 v[156:159], v9 offset:49152
    s_cmp_eq_u32 s30, 6
    s_cbranch_scc0 L_skip_77
    s_mul_i32 s57, s14, 10
    s_mov_b32 m0, 51200
    s_nop 0
    buffer_load_dwordx4 v3, s[48:51], s57 offen offset:0 nt lds
    s_mul_i32 s57, s14, 10
    s_add_u32 s57, s57, s15
    s_mov_b32 m0, 51200
    s_nop 0
    buffer_load_dwordx4 v3, s[48:51], s57 offen offset:1024 nt lds
    s_xor_b32 s57, s71, 0
    s_mul_i32 s57, s57, 196608
    s_add_u32 s57, s57, 1280
    s_xor_b32 s58, s71, 2
    s_mul_i32 s58, s58, 196608
    s_add_u32 s58, s58, 256
    s_mov_b32 m0, 124928
L_dma_78:
    s_waitcnt vmcnt(23)
    s_cmp_ge_u32 s70, 2
    s_cbranch_scc1 L_go_79
    s_waitcnt vmcnt(22)
    s_cmp_ge_u32 s70, 1
    s_cbranch_scc1 L_go_79
    s_waitcnt vmcnt(21)
L_go_79:
    buffer_load_dwordx4 v7, s[36:39], s57 offen offset:0 nt lds
    buffer_load_dwordx4 v7, s[36:39], s58 offen offset:1024 nt lds
    s_add_u32 s57, s57, 24576
    s_add_u32 s58, s58, 24576
    s_add_u32 m0, m0, 2048
    s_cmp_lg_u32 m0, 141312
    s_cbranch_scc1 L_dma_78
L_skip_77:
    s_waitcnt lgkmcnt(0)
    v_lshrrev_b32 v8, 2, v0
    v_lshlrev_b32 v8, 7, v8
    v_bfe_u32 v60, v0, 3, 2
    v_lshl_add_u32 v8, v60, 5, v8
    v_and_b32 v60, 3, v0
    v_lshl_add_u32 v8, v60, 3, v8
    v_add_u32 v8, s61, v8
    v_xor_b32 v9, 32, v8
    v_xor_b32 v10, 64, v8
    v_xor_b32 v11, 96, v8
    v_mov_b32 v41, 160768
    ds_read_b32 v42, v41
    s_waitcnt lgkmcnt(0)
    v_readfirstlane_b32 s55, v42
    s_cmp_eq_u32 s55, 0
    s_cbranch_scc1 L_spread
L_spread_back:
    s_cmp_eq_u32 s30, 5
    s_cbranch_scc0 L_skip_91
    s_cmp_eq_u32 s52, 31
    s_cbranch_scc0 L_skip_92
    s_lshl_b32 s57, s31, 5
    v_mov_b32 v16, s57
    s_add_u32 s57, s68, 1
    v_mov_b32 v12, s57
    s_mov_b64 exec, 0x1
    global_store_dword v16, v12, s[26:27] offset:4 sc1
    s_mov_b64 exec, -1
L_skip_92:
L_skip_91:
    s_sub_u32 s58, s30, 1
    s_cmp_lt_u32 s58, 4
    s_cbranch_scc0 L_skip_93
    s_mul_i32 s59, s53, 6400
    s_add_u32 s59, s59, s62
    s_add_u32 s59, s59, 49152
    s_add_u32 s60, s59, 6144
    s_lshl_b32 s57, s58, 10
    v_lshlrev_b32 v16, 4, v0
    v_add_u32 v16, s57, v16
    v_and_b32 v17, 7, v0
    v_lshlrev_b32 v17, 3, v17
    s_cmp_eq_u32 s30, 4
    s_cbranch_scc0 L_skip_94
    buffer_load_dwordx2 v[12:13], v17, s[40:43], s60 offen sc1 nt
    s_branch L_skip_93
L_skip_94:
    buffer_load_dwordx4 v[12:15], v16, s[40:43], s59 offen sc1 nt
    buffer_load_dwordx4 v[20:23], v16, s[40:43], s59 offen offset:3072 sc1 nt
L_skip_93:
    s_waitcnt vmcnt(36)
    s_barrier
    ds_read_b64_tr_b16 v[160:161], v8 offset:0
    ds_read_b64_tr_b16 v[168:169], v9 offset:0
    ds_read_b64_tr_b16 v[176:177], v10 offset:0
    ds_read_b64_tr_b16 v[184:185], v11 offset:0
    s_cmp_eq_u32 s30, 6
    s_cbranch_scc0 L_skip_95
    s_mul_i32 s57, s14, 11
    s_mov_b32 m0, 53248
    s_nop 0
    buffer_load_dwordx4 v3, s[48:51], s57 offen offset:0 nt lds
    s_mul_i32 s57, s14, 11
    s_add_u32 s57, s57, s15
    s_mov_b32 m0, 53248
    s_nop 0
    buffer_load_dwordx4 v3, s[48:51], s57 offen offset:1024 nt lds
    s_xor_b32 s57, s71, 1
    s_mul_i32 s57, s57, 196608
    s_add_u32 s57, s57, 1024
    s_xor_b32 s58, s71, 3
    s_mul_i32 s58, s58, 196608
    s_add_u32 s58, s58, 0
    s_mov_b32 m0, 141312
L_dma_96:
    s_waitcnt vmcnt(23)
    s_cmp_ge_u32 s70, 2
    s_cbranch_scc1 L_go_97
    s_waitcnt vmcnt(22)
    s_cmp_ge_u32 s70, 1
    s_cbranch_scc1 L_go_97
    s_waitcnt vmcnt(21)
L_go_97:
    buffer_load_dwordx4 v7, s[36:39], s57 offen offset:0 nt lds
    buffer_load_dwordx4 v7, s[36:39], s58 offen offset:1024 nt lds
    s_add_u32 s57, s57, 24576
    s_add_u32 s58, s58, 24576
    s_add_u32 m0, m0, 2048
    s_cmp_lg_u32 m0, 157696
    s_cbranch_scc1 L_dma_96
L_skip_95:
    s_waitcnt lgkmcnt(0)
    s_waitcnt vmcnt(36)
    s_barrier
    ds_read_b64_tr_b16 v[192:193], v8 offset:16384
    ds_read_b64_tr_b16 v[200:201], v9 offset:16384
    ds_read_b64_tr_b16 v[208:209], v10 offset:16384
    ds_read_b64_tr_b16 v[216:217], v11 offset:16384
    s_cmp_eq_u32 s30, 6
    s_cbranch_scc0 L_skip_98
    s_mul_i32 s57, s14, 12
    s_mov_b32 m0, 55296
    s_nop 0
    buffer_load_dwordx4 v3, s[48:51], s57 offen offset:0 nt lds
    s_mul_i32 s57, s14, 12
    s_add_u32 s57, s57, s15
    s_mov_b32 m0, 55296
    s_nop 0
    buffer_load_dwordx4 v3, s[48:51], s57 offen offset:1024 nt lds
    s_xor_b32 s57, s71, 1
    s_mul_i32 s57, s57, 196608
    s_add_u32 s57, s57, 1152
    s_xor_b32 s58, s71, 3
    s_mul_i32 s58, s58, 196608
    s_add_u32 s58, s58, 128
    s_mov_b32 m0, 92160
L_dma_99:
    s_waitcnt vmcnt(23)
    s_cmp_ge_u32 s70, 2
    s_cbranch_scc1 L_go_100
    s_waitcnt vmcnt(22)
    s_cmp_ge_u32 s70, 1
    s_cbranch_scc1 L_go_100
    s_waitcnt vmcnt(21)
L_go_100:
    buffer_load_dwordx4 v7, s[36:39], s57 offen offset:0 nt lds
    buffer_load_dwordx4 v7, s[36:39], s58 offen offset:1024 nt lds
    s_add_u32 s57, s57, 24576
    s_add_u32 s58, s58, 24576
    s_add_u32 m0, m0, 2048
    s_cmp_lg_u32 m0, 108544
    s_cbranch_scc1 L_dma_99
L_skip_98:
    s_waitcnt lgkmcnt(0)
    s_sub_u32 s58, s30, 1
    s_cmp_lt_u32 s58, 4
    s_cbranch_scc0 L_skip_101
    s_waitcnt vmcnt(0)
    s_cmp_eq_u32 s30, 4
    s_cbranch_scc0 L_skip_102
    v_add_f32_dpp v12, v12, v12 row_ror:4 row_mask:0xf bank_mask:0xf
    v_add_f32_dpp v13, v13, v13 row_ror:4 row_mask:0xf bank_mask:0xf
    s_nop 0
    v_add_f32_dpp v12, v12, v12 row_ror:2 row_mask:0xf bank_mask:0xf
    v_add_f32_dpp v13, v13, v13 row_ror:2 row_mask:0xf bank_mask:0xf
    s_nop 0
    v_add_f32_dpp v12, v12, v12 row_ror:1 row_mask:0xf bank_mask:0xf
    v_add_f32_dpp v13, v13, v13 row_ror:1 row_mask:0xf bank_mask:0xf
    v_mul_f32 v13, 0x3acccccd, v13
    v_mul_f32 v12, 0x3acccccd, v12
    v_add_f32 v13, 0x3727c5ac, v13
    v_fma_f32 v13, -v12, v12, v13
    v_max_f32 v13, 0x3727c5ac, v13
    v_rsq_f32 v13, v13
    s_nop 0
    v_mul_f32 v13, 0x3dd53b95, v13
    v_mul_f32 v12, -v12, v13
    v_mov_b32 v16, 160784
    ds_write_b64 v16, v[12:13]
    s_waitcnt lgkmcnt(0)
    s_branch L_skip_101
L_skip_102:
    s_lshl_b32 s57, s58, 7
    v_lshrrev_b32 v16, 4, v0
    v_lshlrev_b32 v16, 5, v16
    v_bfe_u32 v60, v0, 1, 1
    v_lshl_add_u32 v16, v60, 4, v16
    v_bfe_u32 v60, v0, 2, 2
    v_lshl_add_u32 v16, v60, 2, v16
    v_and_b32 v60, 1, v0
    v_lshl_add_u32 v16, v60, 1, v16
    v_add_u32 v16, s57, v16
    v_add_u32 v16, 157952, v16
    v_mov_b32 v17, 0x3f803f80
    v_dot2_f32_bf16 v24, v12, v17, 0
    v_dot2_f32_bf16 v25, v13, v17, 0
    v_dot2_f32_bf16 v24, v14, v17, v24
    v_dot2_f32_bf16 v25, v15, v17, v25
    s_nop 2
    v_add_f32 v24, v24, v25
    v_cvt_pk_bf16_f32 v24, v24, v24
    ds_write_b16 v16, v24 offset:0
    v_dot2_f32_bf16 v24, v20, v17, 0
    v_dot2_f32_bf16 v25, v21, v17, 0
    v_dot2_f32_bf16 v24, v22, v17, v24
    v_dot2_f32_bf16 v25, v23, v17, v25
    s_nop 2
    v_add_f32 v24, v24, v25
    v_cvt_pk_bf16_f32 v24, v24, v24
    ds_write_b16 v16, v24 offset:384
    s_waitcnt lgkmcnt(0)
L_skip_101:
    s_waitcnt vmcnt(36)
    s_barrier
    ds_read_b64_tr_b16 v[224:225], v8 offset:32768
    ds_read_b64_tr_b16 v[232:233], v9 offset:32768
    ds_read_b64_tr_b16 v[240:241], v10 offset:32768
    ds_read_b64_tr_b16 v[248:249], v11 offset:32768
    s_cmp_eq_u32 s30, 6
    s_cbranch_scc0 L_skip_103
    s_mul_i32 s57, s14, 13
    s_mov_b32 m0, 57344
    s_nop 0
    buffer_load_dwordx4 v3, s[48:51], s57 offen offset:0 nt lds
    s_mul_i32 s57, s14, 13
    s_add_u32 s57, s57, s15
    s_mov_b32 m0, 57344
    s_nop 0
    buffer_load_dwordx4 v3, s[48:51], s57 offen offset:1024 nt lds
    s_xor_b32 s57, s71, 1
    s_mul_i32 s57, s57, 196608
    s_add_u32 s57, s57, 1280
    s_xor_b32 s58, s71, 3
    s_mul_i32 s58, s58, 196608
    s_add_u32 s58, s58, 256
    s_mov_b32 m0, 108544
L_dma_104:
    s_nop 0
    buffer_load_dwordx4 v7, s[36:39], s57 offen offset:0 nt lds
    buffer_load_dwordx4 v7, s[36:39], s58 offen offset:1024 nt lds
    s_add_u32 s57, s57, 24576
    s_add_u32 s58, s58, 24576
    s_add_u32 m0, m0, 2048
    s_cmp_lg_u32 m0, 124928
    s_cbranch_scc1 L_dma_104
L_skip_103:
    s_waitcnt lgkmcnt(0)
    v_lshrrev_b32 v5, 4, v0
    v_lshlrev_b32 v5, 5, v5
    v_bfe_u32 v60, v0, 1, 1
    v_lshl_add_u32 v5, v60, 4, v5
    v_add_u32 v5, 157952, v5
    ds_read_b128 v[12:15], v5 offset:384
    ds_read_b128 v[16:19], v5 offset:512
    ds_read_b128 v[20:23], v5 offset:640
    s_lshl_b32 s57, s30, 7
    s_add_u32 s57, s57, 158720
    v_lshrrev_b32 v58, 4, v0
    v_lshlrev_b32 v58, 5, v58
    v_bfe_u32 v60, v0, 1, 1
    v_lshl_add_u32 v58, v60, 4, v58
    v_bfe_u32 v60, v0, 2, 2
    v_lshl_add_u32 v58, v60, 2, v58
    v_and_b32 v60, 1, v0
    v_lshl_add_u32 v58, v60, 1, v58
    v_add_u32 v58, s57, v58
    v_lshrrev_b32 v61, 4, v0
    v_lshlrev_b32 v61, 5, v61
    v_bfe_u32 v60, v0, 1, 1
    v_lshl_add_u32 v61, v60, 4, v61
    v_add_u32 v61, s57, v61
    v_bfe_u32 v62, v0, 2, 2
    v_lshlrev_b32 v62, 1, v62
    v_and_b32 v60, 1, v0
    v_lshl_add_u32 v62, v60, 0, v62
    v_mov_b32 v60, 160992
    v_cmp_eq_u32 vcc, 0, v62
    s_nop 1
    v_cndmask_b32 v52, v60, v61, vcc
    v_cmp_eq_u32 vcc, 1, v62
    s_nop 1
    v_cndmask_b32 v53, v60, v61, vcc
    v_cmp_eq_u32 vcc, 2, v62
    s_nop 1
    v_cndmask_b32 v54, v60, v61, vcc
    v_cmp_eq_u32 vcc, 3, v62
    s_nop 1
    v_cndmask_b32 v55, v60, v61, vcc
    v_cmp_eq_u32 vcc, 4, v62
    s_nop 1
    v_cndmask_b32 v56, v60, v61, vcc
    v_cmp_eq_u32 vcc, 5, v62
    s_nop 1
    v_cndmask_b32 v57, v60, v61, vcc
    s_lshl_b32 s58, s30, 2
    s_add_u32 s58, s58, 159744
    v_mov_b32 v60, s58
    v_lshlrev_b32 v59, 2, v0
    v_add_u32 v59, 157696, v59
    v_cmp_eq_u32 vcc, 63, v0
    s_nop 1
    v_cndmask_b32 v59, v59, v60, vcc
    v_and_b32 v62, 7, v0
    v_lshlrev_b32 v62, 2, v62
    v_add_u32 v62, 159744, v62
    s_lshl_b32 s57, s30, 11
    v_lshlrev_b32 v63, 4, v0
    v_add_u32 v63, s57, v63
    v_add_u32 v63, 92160, v63
    v_mov_b64 v[24:25], 0
    v_mov_b64 v[26:27], 0
    v_mov_b64 v[28:29], 0
    v_mov_b64 v[30:31], 0
    v_mov_b64 v[32:33], 0
    v_mov_b64 v[34:35], 0
    v_mov_b64 v[36:37], 0
    v_mov_b64 v[38:39], 0
    v_mov_b64 v[40:41], 0
    v_mov_b64 v[42:43], 0
    v_mov_b64 v[44:45], 0
    v_mov_b64 v[46:47], 0
    s_waitcnt lgkmcnt(0)
    v_smfmac_f32_16x16x64_bf16 v[24:27], v[12:15], v[64:71], v1
    v_smfmac_f32_16x16x64_bf16 v[24:27], v[16:19], v[72:79], v1
    v_smfmac_f32_16x16x64_bf16 v[24:27], v[20:23], v[80:87], v1
    v_smfmac_f32_16x16x64_bf16 v[28:31], v[12:15], v[88:95], v1
    v_smfmac_f32_16x16x64_bf16 v[28:31], v[16:19], v[96:103], v1
    v_smfmac_f32_16x16x64_bf16 v[28:31], v[20:23], v[104:111], v1
    v_smfmac_f32_16x16x64_bf16 v[32:35], v[12:15], v[112:119], v1
    v_smfmac_f32_16x16x64_bf16 v[32:35], v[16:19], v[120:127], v1
    v_smfmac_f32_16x16x64_bf16 v[32:35], v[20:23], v[128:135], v1
    v_smfmac_f32_16x16x64_bf16 v[36:39], v[12:15], v[136:143], v1
    v_smfmac_f32_16x16x64_bf16 v[36:39], v[16:19], v[144:151], v1
    v_smfmac_f32_16x16x64_bf16 v[36:39], v[20:23], v[152:159], v1
    v_add_f32_dpp v6, v24, v26 quad_perm:[0,1,2,3] row_mask:0x1 bank_mask:0xf
    s_nop 1
    v_add_f32_dpp v6, v28, v30 quad_perm:[0,1,2,3] row_mask:0x2 bank_mask:0xf
    s_nop 1
    v_add_f32_dpp v6, v32, v34 quad_perm:[0,1,2,3] row_mask:0x4 bank_mask:0xf
    s_nop 1
    v_add_f32_dpp v6, v36, v38 quad_perm:[0,1,2,3] row_mask:0x8 bank_mask:0xf
    s_waitcnt vmcnt(36)
    s_barrier
    ds_read_b64_tr_b16 v[162:163], v8 offset:49152
    ds_read_b64_tr_b16 v[170:171], v9 offset:49152
    ds_read_b64_tr_b16 v[178:179], v10 offset:49152
    ds_read_b64_tr_b16 v[186:187], v11 offset:49152
    s_cmp_eq_u32 s30, 6
    s_cbranch_scc0 L_skip_105
    s_mul_i32 s57, s14, 14
    s_mov_b32 m0, 59392
    s_nop 0
    buffer_load_dwordx4 v3, s[48:51], s57 offen offset:0 nt lds
    s_mul_i32 s57, s14, 14
    s_add_u32 s57, s57, s15
    s_mov_b32 m0, 59392
    s_nop 0
    buffer_load_dwordx4 v3, s[48:51], s57 offen offset:1024 nt lds
    s_xor_b32 s57, s71, 4
    s_mul_i32 s57, s57, 196608
    s_add_u32 s57, s57, 1024
    s_xor_b32 s58, s71, 6
    s_mul_i32 s58, s58, 196608
    s_add_u32 s58, s58, 0
    s_mov_b32 m0, 124928
L_dma_106:
    s_nop 0
    buffer_load_dwordx4 v7, s[36:39], s57 offen offset:0 nt lds
    buffer_load_dwordx4 v7, s[36:39], s58 offen offset:1024 nt lds
    s_add_u32 s57, s57, 24576
    s_add_u32 s58, s58, 24576
    s_add_u32 m0, m0, 2048
    s_cmp_lg_u32 m0, 141312
    s_cbranch_scc1 L_dma_106
L_skip_105:
    s_waitcnt lgkmcnt(0)
    v_mov_b32 v48, 160784
    ds_read_b128 v[12:15], v5 offset:0
    ds_read_b128 v[16:19], v5 offset:128
    ds_read_b128 v[20:23], v5 offset:256
    ds_read_b64 v[48:49], v48
    v_mov_b64 v[24:25], 0
    v_mov_b64 v[26:27], 0
    v_mov_b64 v[28:29], 0
    v_mov_b64 v[30:31], 0
    v_mov_b64 v[32:33], 0
    v_mov_b64 v[34:35], 0
    v_mov_b64 v[36:37], 0
    v_mov_b64 v[38:39], 0
    s_waitcnt lgkmcnt(0)
    v_smfmac_f32_16x16x64_bf16 v[24:27], v[12:15], v[64:71], v1
    v_smfmac_f32_16x16x64_bf16 v[24:27], v[16:19], v[72:79], v1
    v_smfmac_f32_16x16x64_bf16 v[24:27], v[20:23], v[80:87], v1
    v_smfmac_f32_16x16x64_bf16 v[28:31], v[12:15], v[88:95], v1
    v_smfmac_f32_16x16x64_bf16 v[28:31], v[16:19], v[96:103], v1
    v_smfmac_f32_16x16x64_bf16 v[28:31], v[20:23], v[104:111], v1
    v_smfmac_f32_16x16x64_bf16 v[32:35], v[12:15], v[112:119], v1
    v_smfmac_f32_16x16x64_bf16 v[32:35], v[16:19], v[120:127], v1
    v_smfmac_f32_16x16x64_bf16 v[32:35], v[20:23], v[128:135], v1
    v_smfmac_f32_16x16x64_bf16 v[36:39], v[12:15], v[136:143], v1
    v_smfmac_f32_16x16x64_bf16 v[36:39], v[16:19], v[144:151], v1
    v_smfmac_f32_16x16x64_bf16 v[36:39], v[20:23], v[152:159], v1
    v_add_f32_dpp v61, v24, v26 quad_perm:[0,1,2,3] row_mask:0x1 bank_mask:0xf
    v_mul_f32 v48, v48, v6
    s_nop 0
    v_add_f32_dpp v61, v28, v30 quad_perm:[0,1,2,3] row_mask:0x2 bank_mask:0xf
    s_nop 1
    v_add_f32_dpp v61, v32, v34 quad_perm:[0,1,2,3] row_mask:0x4 bank_mask:0xf
    s_nop 1
    v_add_f32_dpp v61, v36, v38 quad_perm:[0,1,2,3] row_mask:0x8 bank_mask:0xf
    v_fma_f32 v36, v61, v49, v48
    s_nop 1
    v_max_f32_dpp v37, v36, v36 row_ror:8 row_mask:0xf bank_mask:0xf
    s_nop 1
    v_max_f32_dpp v37, v37, v37 row_ror:4 row_mask:0xf bank_mask:0xf
    s_nop 1
    v_max_f32_dpp v37, v37, v37 row_ror:2 row_mask:0xf bank_mask:0xf
    s_nop 1
    v_max_f32_dpp v37, v37, v37 row_ror:1 row_mask:0xf bank_mask:0xf
    s_nop 1
    v_max_f32_dpp v37, v37, v37 row_bcast:15 row_mask:0xa bank_mask:0xf
    s_nop 1
    v_max_f32_dpp v37, v37, v37 row_bcast:31 row_mask:0xc bank_mask:0xf
    s_nop 0
    v_readlane_b32 s64, v37, 63
    ds_write_b32 v59, v37
    s_nop 0
    v_subrev_f32 v36, s64, v36
    v_exp_f32 v36, v36
    s_nop 0
    v_cvt_pk_bf16_f32 v39, v36, v36
    ds_write_b16 v58, v39
    ds_read_b128 v[12:15], v52
    ds_read_b128 v[16:19], v53
    ds_read_b128 v[20:23], v54
    ds_read_b128 v[24:27], v55
    ds_read_b128 v[28:31], v56
    ds_read_b128 v[32:35], v57
    v_add_f32_dpp v38, v36, v36 row_ror:8 row_mask:0xf bank_mask:0xf
    s_nop 1
    v_add_f32_dpp v38, v38, v38 row_ror:4 row_mask:0xf bank_mask:0xf
    s_nop 1
    v_add_f32_dpp v38, v38, v38 row_ror:2 row_mask:0xf bank_mask:0xf
    s_nop 1
    v_add_f32_dpp v38, v38, v38 row_ror:1 row_mask:0xf bank_mask:0xf
    s_nop 1
    v_add_f32_dpp v38, v38, v38 row_bcast:15 row_mask:0xa bank_mask:0xf
    s_nop 1
    v_add_f32_dpp v38, v38, v38 row_bcast:31 row_mask:0xc bank_mask:0xf
    s_waitcnt lgkmcnt(0)
    s_waitcnt vmcnt(36)
    s_barrier
    ds_read_b64_tr_b16 v[194:195], v8 offset:0
    ds_read_b64_tr_b16 v[202:203], v9 offset:0
    ds_read_b64_tr_b16 v[210:211], v10 offset:0
    ds_read_b64_tr_b16 v[218:219], v11 offset:0
    s_cmp_eq_u32 s30, 6
    s_cbranch_scc0 L_skip_107
    s_mul_i32 s57, s14, 15
    s_mov_b32 m0, 61440
    s_nop 0
    buffer_load_dwordx4 v3, s[48:51], s57 offen offset:0 nt lds
    s_mul_i32 s57, s14, 15
    s_add_u32 s57, s57, s15
    s_mov_b32 m0, 61440
    s_nop 0
    buffer_load_dwordx4 v3, s[48:51], s57 offen offset:1024 nt lds
    s_xor_b32 s57, s71, 4
    s_mul_i32 s57, s57, 196608
    s_add_u32 s57, s57, 1152
    s_xor_b32 s58, s71, 6
    s_mul_i32 s58, s58, 196608
    s_add_u32 s58, s58, 128
    s_mov_b32 m0, 141312
L_dma_108:
    s_waitcnt vmcnt(23)
    s_cmp_ge_u32 s70, 2
    s_cbranch_scc1 L_go_109
    s_waitcnt vmcnt(22)
    s_cmp_ge_u32 s70, 1
    s_cbranch_scc1 L_go_109
    s_waitcnt vmcnt(21)
L_go_109:
    buffer_load_dwordx4 v7, s[36:39], s57 offen offset:0 nt lds
    buffer_load_dwordx4 v7, s[36:39], s58 offen offset:1024 nt lds
    s_add_u32 s57, s57, 24576
    s_add_u32 s58, s58, 24576
    s_add_u32 m0, m0, 2048
    s_cmp_lg_u32 m0, 157696
    s_cbranch_scc1 L_dma_108
L_skip_107:
    s_waitcnt lgkmcnt(0)
    ds_read_b32 v36, v62
    s_waitcnt lgkmcnt(0)
    v_max_f32_dpp v37, v36, v36 row_ror:4 row_mask:0xf bank_mask:0xf
    s_nop 1
    v_max_f32_dpp v37, v37, v37 row_ror:2 row_mask:0xf bank_mask:0xf
    s_nop 1
    v_max_f32_dpp v37, v37, v37 row_ror:1 row_mask:0xf bank_mask:0xf
    v_sub_f32 v39, s64, v37
    v_exp_f32 v39, v39
    s_cmp_lt_u32 s30, 2
    s_cbranch_scc0 L_skip_110
    s_lshl_b32 s57, s30, 3
    v_lshlrev_b32 v2, 4, v0
    v_add_u32 v2, s57, v2
    v_add_u32 v2, 92160, v2
    v_mov_b32 v60, 94192
    v_cmp_le_u32 vcc, 48, v0
    s_nop 1
    v_cndmask_b32 v2, v2, v60, vcc
    s_lshr_b32 s57, s54, 1
    s_lshl_b32 s57, s57, 2
    s_and_b32 s58, s54, 1
    s_add_u32 s57, s57, s58
    s_lshl_b32 s58, s57, 4
    s_lshl_b32 s57, s57, 3
    v_bfe_u32 v3, v0, 3, 2
    v_lshlrev_b32 v3, 8, v3
    v_bfe_u32 v61, v0, 2, 1
    v_lshl_add_u32 v3, v61, 5, v3
    v_and_b32 v61, 3, v0
    v_lshl_add_u32 v3, v61, 2, v3
    v_add_u32 v3, s58, v3
    v_bfe_u32 v60, v0, 3, 1
    v_lshlrev_b32 v60, 8, v60
    v_bfe_u32 v61, v0, 1, 1
    v_lshl_add_u32 v60, v61, 7, v60
    v_bfe_u32 v61, v0, 2, 1
    v_lshl_add_u32 v60, v61, 4, v60
    v_and_b32 v61, 1, v0
    v_lshl_add_u32 v60, v61, 2, v60
    v_add_u32 v60, s57, v60
    v_add_u32 v60, 1024, v60
    v_cmp_gt_u32 vcc, 32, v0
    s_nop 1
    v_cndmask_b32 v3, v60, v3, vcc
    s_lshl_b32 s57, s53, 1
    s_add_u32 s57, s57, s30
    s_mul_i32 s57, s57, 1664
    s_add_u32 s57, s57, s62
    v_add_u32 v3, s57, v3
    v_mov_b32 v60, 0x7f000000
    v_cmp_le_u32 vcc, 48, v0
    s_nop 1
    v_cndmask_b32 v3, v3, v60, vcc
    s_lshl_b32 s58, s54, 2
    s_add_u32 s57, s57, s58
    s_add_u32 s57, s57, 1536
    v_mov_b32 v4, s57
    v_mov_b32 v60, 0x7f000000
    v_cmp_ne_u32 vcc, 48, v0
    s_nop 1
    v_cndmask_b32 v4, v4, v60, vcc
    s_mov_b32 s58, 0
    v_min_u32 v37, -2, v37
    s_cmp_eq_u32 s55, 0
    s_cbranch_scc1 L_gs_111
    buffer_store_dword v37, v4, s[40:43], s58 offen
L_gb_112:
L_skip_110:
    s_cmp_eq_u32 s30, 2
    s_cbranch_scc0 L_skip_113
    v_lshlrev_b32 v2, 2, v0
    v_add_u32 v2, 157696, v2
    v_and_b32 v3, 15, v0
    v_lshlrev_b32 v3, 2, v3
    v_lshrrev_b32 v60, 5, v0
    v_lshl_add_u32 v3, v60, 6, v3
    v_bfe_u32 v60, v0, 4, 1
    v_lshl_add_u32 v3, v60, 13, v3
L_skip_113:
    s_waitcnt vmcnt(36)
    s_barrier
    ds_read_b64_tr_b16 v[226:227], v8 offset:16384
    ds_read_b64_tr_b16 v[234:235], v9 offset:16384
    ds_read_b64_tr_b16 v[242:243], v10 offset:16384
    ds_read_b64_tr_b16 v[250:251], v11 offset:16384
    s_cmp_eq_u32 s30, 6
    s_cbranch_scc0 L_skip_114
    s_xor_b32 s57, s71, 4
    s_mul_i32 s57, s57, 196608
    s_add_u32 s57, s57, 1280
    s_xor_b32 s58, s71, 6
    s_mul_i32 s58, s58, 196608
    s_add_u32 s58, s58, 256
    s_mov_b32 m0, 92160
L_dma_115:
    s_nop 0
    buffer_load_dwordx4 v7, s[36:39], s57 offen offset:0 nt lds
    buffer_load_dwordx4 v7, s[36:39], s58 offen offset:1024 nt lds
    s_add_u32 s57, s57, 24576
    s_add_u32 s58, s58, 24576
    s_add_u32 m0, m0, 2048
    s_cmp_lg_u32 m0, 108544
    s_cbranch_scc1 L_dma_115
L_skip_114:
    s_waitcnt lgkmcnt(0)
    s_cmp_eq_u32 s30, 5
    s_cbranch_scc0 L_skip_116
    global_load_dword v2, v3, s[26:27] offset:4 sc1
L_skip_116:
    s_waitcnt vmcnt(34)
    s_barrier
    ds_read_b64_tr_b16 v[164:165], v8 offset:32768
    ds_read_b64_tr_b16 v[172:173], v9 offset:32768
    ds_read_b64_tr_b16 v[180:181], v10 offset:32768
    ds_read_b64_tr_b16 v[188:189], v11 offset:32768
    s_cmp_eq_u32 s30, 6
    s_cbranch_scc0 L_skip_117
    s_xor_b32 s57, s71, 5
    s_mul_i32 s57, s57, 196608
    s_add_u32 s57, s57, 1024
    s_xor_b32 s58, s71, 7
    s_mul_i32 s58, s58, 196608
    s_add_u32 s58, s58, 0
    s_mov_b32 m0, 108544
L_dma_118:
    s_nop 0
    buffer_load_dwordx4 v7, s[36:39], s57 offen offset:0 nt lds
    buffer_load_dwordx4 v7, s[36:39], s58 offen offset:1024 nt lds
    s_add_u32 s57, s57, 24576
    s_add_u32 s58, s58, 24576
    s_add_u32 m0, m0, 2048
    s_cmp_lg_u32 m0, 124928
    s_cbranch_scc1 L_dma_118
L_skip_117:
    s_waitcnt lgkmcnt(0)
    s_waitcnt vmcnt(32)
    s_barrier
    ds_read_b64_tr_b16 v[196:197], v8 offset:49152
    ds_read_b64_tr_b16 v[204:205], v9 offset:49152
    ds_read_b64_tr_b16 v[212:213], v10 offset:49152
    ds_read_b64_tr_b16 v[220:221], v11 offset:49152
    s_cmp_eq_u32 s30, 6
    s_cbranch_scc0 L_skip_119
    s_xor_b32 s57, s71, 5
    s_mul_i32 s57, s57, 196608
    s_add_u32 s57, s57, 1152
    s_xor_b32 s58, s71, 7
    s_mul_i32 s58, s58, 196608
    s_add_u32 s58, s58, 128
    s_mov_b32 m0, 124928
L_dma_120:
    s_nop 0
    buffer_load_dwordx4 v7, s[36:39], s57 offen offset:0 nt lds
    buffer_load_dwordx4 v7, s[36:39], s58 offen offset:1024 nt lds
    s_add_u32 s57, s57, 24576
    s_add_u32 s58, s58, 24576
    s_add_u32 m0, m0, 2048
    s_cmp_lg_u32 m0, 141312
    s_cbranch_scc1 L_dma_120
L_skip_119:
    s_waitcnt lgkmcnt(0)
    s_cmp_eq_u32 s30, 5
    s_cbranch_scc0 L_skip_121
L_cw_122:
    s_waitcnt vmcnt(0)
    v_cmp_eq_u32 vcc, 0, v2
    s_cbranch_vccnz L_cr_123
    v_add_u32_dpp v2, v2, v2 row_ror:4 row_mask:0xf bank_mask:0xf
    s_nop 1
    v_add_u32_dpp v2, v2, v2 row_ror:2 row_mask:0xf bank_mask:0xf
    s_nop 1
    v_add_u32_dpp v2, v2, v2 row_ror:1 row_mask:0xf bank_mask:0xf
    v_mov_b32 v60, 160772
    ds_write_b32 v60, v2
    s_waitcnt lgkmcnt(0)
L_skip_121:
    s_cmp_lt_u32 s3, 20
    s_cbranch_scc0 L_skip_124
    s_mul_i32 s74, s30, 1664
    s_add_u32 s74, s74, s62
    s_add_u32 s74, s74, 0
    v_and_b32 v56, 7, v0
    v_lshlrev_b32 v56, 2, v56
    v_lshrrev_b32 v62, 4, v0
    v_lshlrev_b32 v62, 3, v62
    s_cmp_lg_u32 s30, 6
    s_cbranch_scc0 L_skip_124
    buffer_load_dword v52, v56, s[40:43], s74 offen offset:1536 sc1
    buffer_load_dwordx2 v[54:55], v62, s[40:43], s74 offen offset:1536 sc1
L_skip_124:
    s_cmp_eq_u32 s30, 2
    s_cbranch_scc0 L_skip_125
    s_sub_u32 s57, s3, 20
    s_cmp_lt_u32 s57, 4
    s_cbranch_scc0 L_skip_126
    s_sub_u32 s57, s3, 20
    s_lshl_b32 s57, s57, 6
    v_add_u32 v50, s57, v0
    v_min_u32 v50, 159, v50
    v_lshlrev_b32 v50, 7, v50
    s_add_u32 s57, s62, 0
    buffer_load_dword v50, v50, s[40:43], s57 offen sc1 nt
    s_sub_u32 s57, s3, 20
    s_lshl_b32 s57, s57, 6
    v_add_u32 v51, s57, v0
    v_min_u32 v51, 223, v51
    v_lshlrev_b32 v51, 7, v51
    s_add_u32 s57, s62, 20480
    buffer_load_dword v51, v51, s[40:43], s57 offen sc1 nt
L_skip_126:
L_skip_125:
    s_waitcnt vmcnt(32)
    s_barrier
    ds_read_b64_tr_b16 v[228:229], v8 offset:0
    ds_read_b64_tr_b16 v[236:237], v9 offset:0
    ds_read_b64_tr_b16 v[244:245], v10 offset:0
    ds_read_b64_tr_b16 v[252:253], v11 offset:0
    s_cmp_eq_u32 s30, 6
    s_cbranch_scc0 L_skip_127
    s_xor_b32 s57, s71, 5
    s_mul_i32 s57, s57, 196608
    s_add_u32 s57, s57, 1280
    s_xor_b32 s58, s71, 7
    s_mul_i32 s58, s58, 196608
    s_add_u32 s58, s58, 256
    s_mov_b32 m0, 141312
L_dma_128:
    s_nop 0
    buffer_load_dwordx4 v7, s[36:39], s57 offen offset:0 nt lds
    buffer_load_dwordx4 v7, s[36:39], s58 offen offset:1024 nt lds
    s_add_u32 s57, s57, 24576
    s_add_u32 s58, s58, 24576
    s_add_u32 m0, m0, 2048
    s_cmp_lg_u32 m0, 157696
    s_cbranch_scc1 L_dma_128
L_skip_127:
    s_waitcnt lgkmcnt(0)
    s_cmp_ge_u32 s30, 6
    s_cbranch_scc0 L_skip_129
    v_mov_b32 v60, 160772
    ds_read_b32 v60, v60
    s_lshr_b32 s58, s63, 2
    s_waitcnt lgkmcnt(0)
    v_readfirstlane_b32 s57, v60
    s_cmp_gt_u32 s57, 24
    s_cselect_b32 s57, 1, 0
    s_xor_b32 s57, s57, s58
    s_lshl_b32 s57, s57, 13
    s_add_u32 s7, s8, s57
L_skip_129:
    s_branch L_tail
.p2align 10
L_tail:
L_pad0:
    s_cbranch_execz L_pad4
    s_waitcnt vmcnt(32)
    s_barrier
    ds_read_b64_tr_b16 v[166:167], v8 offset:16384
    ds_read_b64_tr_b16 v[174:175], v9 offset:16384
    ds_read_b64_tr_b16 v[182:183], v10 offset:16384
    ds_read_b64_tr_b16 v[190:191], v11 offset:16384
    s_waitcnt lgkmcnt(0)
    s_cmp_lt_u32 s30, 5
    s_cbranch_scc0 L_skip_130
    s_waitcnt vmcnt(0)
L_skip_130:
    s_cmp_lt_u32 s3, 20
    s_cbranch_scc0 L_skip_131
    v_lshlrev_b32 v57, 4, v0
    v_lshlrev_b32 v58, 3, v0
    s_mul_i32 s57, s30, 6144
    s_add_u32 s57, s57, 30720
    v_lshrrev_b32 v59, 2, v0
    v_lshlrev_b32 v59, 6, v59
    v_bfe_u32 v53, v0, 4, 1
    v_lshl_add_u32 v59, v53, 5, v59
    v_and_b32 v53, 3, v0
    v_lshl_add_u32 v59, v53, 3, v59
    v_add_u32 v59, s57, v59
    v_xor_b32 v60, 32, v59
    s_lshl_b32 s57, s30, 8
    s_add_u32 s57, s57, 157696
    v_lshl_add_u32 v61, v0, 2, s57
    s_cmp_lg_u32 s30, 6
    s_cbranch_scc0 L_skip_131
L_cw_132:
    s_waitcnt vmcnt(0)
    v_max3_u32 v53, v52, v54, v55
    v_cmp_eq_u32 vcc, -1, v53
    s_cbranch_vccnz L_cr_133
    v_max_f32_dpp v53, v52, v52 row_ror:4 row_mask:0xf bank_mask:0xf
    s_nop 1
    v_max_f32_dpp v53, v53, v53 row_ror:2 row_mask:0xf bank_mask:0xf
    s_nop 1
    v_max_f32_dpp v53, v53, v53 row_ror:1 row_mask:0xf bank_mask:0xf
    v_sub_f32 v52, v52, v53
    v_sub_f32 v54, v54, v53
    v_sub_f32 v55, v55, v53
    v_exp_f32 v52, v52
    v_exp_f32 v54, v54
    v_exp_f32 v55, v55
    s_cmp_eq_u32 s30, 7
    s_cbranch_scc0 L_skip_131
    v_add_u32 v62, 158720, v57
    ds_write_b128 v62, v[52:55]
    s_waitcnt lgkmcnt(0)
L_skip_131:
    v_smfmac_f32_16x16x64_bf16 v[40:43], v[12:15], v[160:167], v1
    v_smfmac_f32_16x16x64_bf16 v[40:43], v[16:19], v[168:175], v1
    v_smfmac_f32_16x16x64_bf16 v[40:43], v[20:23], v[176:183], v1
    v_smfmac_f32_16x16x64_bf16 v[40:43], v[24:27], v[184:191], v1
    s_cmp_eq_u32 s30, 6
    s_cbranch_scc0 L_skip_134
    s_mul_i32 s57, s14, 16
    s_add_u32 s58, s57, s15
    s_mov_b32 m0, 63488
L_dma_135:
    s_nop 0
    buffer_load_dwordx4 v3, s[48:51], s57 offen offset:0 nt lds
    buffer_load_dwordx4 v3, s[48:51], s58 offen offset:1024 nt lds
    s_add_u32 s57, s57, s14
    s_add_u32 s58, s58, s14
    s_add_u32 m0, m0, 2048
    s_cmp_lg_u32 m0, 71680
    s_cbranch_scc1 L_dma_135
    s_mul_i32 s57, s14, 20
    s_add_u32 s58, s57, s15
    s_mov_b32 m0, 71680
L_dma_136:
    s_nop 0
    buffer_load_dwordx4 v3, s[48:51], s57 offen offset:0 nt lds
    buffer_load_dwordx4 v3, s[48:51], s58 offen offset:1024 nt lds
    s_add_u32 s57, s57, s14
    s_add_u32 s58, s58, s14
    s_add_u32 m0, m0, 2048
    s_cmp_lg_u32 m0, 79872
    s_cbranch_scc1 L_dma_136
L_skip_134:
    s_waitcnt vmcnt(32)
    s_barrier
    ds_read_b64_tr_b16 v[198:199], v8 offset:32768
    ds_read_b64_tr_b16 v[206:207], v9 offset:32768
    ds_read_b64_tr_b16 v[214:215], v10 offset:32768
    ds_read_b64_tr_b16 v[222:223], v11 offset:32768
    s_waitcnt lgkmcnt(0)
    s_cmp_lt_u32 s3, 20
    s_cbranch_scc0 L_skip_137
    s_cmp_eq_u32 s30, 6
    s_cbranch_scc0 L_skip_137
    v_add_u32 v62, 158720, v57
    ds_read_b128 v[52:55], v62
L_skip_137:
L_pad1:
    s_cbranch_execz L_pad5
    v_smfmac_f32_16x16x64_bf16 v[40:43], v[28:31], v[192:199], v1
    v_smfmac_f32_16x16x64_bf16 v[40:43], v[32:35], v[200:207], v1
    v_smfmac_f32_16x16x64_bf16 v[44:47], v[12:15], v[208:215], v1
    v_smfmac_f32_16x16x64_bf16 v[44:47], v[16:19], v[216:223], v1
    v_mul_f32 v38, v38, v39
    ds_write_b32 v63, v38 offset:1024
    s_waitcnt vmcnt(16)
    s_barrier
    ds_read_b64_tr_b16 v[230:231], v8 offset:49152
    ds_read_b64_tr_b16 v[238:239], v9 offset:49152
    ds_read_b64_tr_b16 v[246:247], v10 offset:49152
    ds_read_b64_tr_b16 v[254:255], v11 offset:49152
    s_waitcnt lgkmcnt(0)
    v_smfmac_f32_16x16x64_bf16 v[44:47], v[20:23], v[224:231], v1
    v_smfmac_f32_16x16x64_bf16 v[44:47], v[24:27], v[232:239], v1
    v_smfmac_f32_16x16x64_bf16 v[44:47], v[28:31], v[240:247], v1
    v_smfmac_f32_16x16x64_bf16 v[44:47], v[32:35], v[248:255], v1
    s_setprio 0
    s_cmp_lt_u32 s30, 2
    v_pk_add_f32 v[40:41], v[40:41], v[42:43]
    s_nop 4
    v_pk_add_f32 v[42:43], v[44:45], v[46:47]
    v_pk_mul_f32 v[40:41], v[40:41], v[38:39] op_sel:[0,1] op_sel_hi:[1,1]
    v_pk_mul_f32 v[42:43], v[42:43], v[38:39] op_sel:[0,1] op_sel_hi:[1,1]
    ds_write_b128 v63, v[40:43]
    s_cbranch_scc1 L_comb_0
    s_waitcnt lgkmcnt(0)
    s_barrier
L_comb_0b:
    s_cmp_eq_u32 s30, 6
    s_cbranch_scc0 L_skip_142
    s_waitcnt vmcnt(0)
L_skip_142:
    s_barrier
    s_cmp_lt_u32 s3, 20
    s_cbranch_scc0 L_typeB_0
    buffer_load_dwordx4 v[12:15], v57, s[40:43], s74 offen sc1
    buffer_load_dwordx2 v[16:17], v58, s[40:43], s74 offen offset:1024 sc1
    buffer_load_dword v18, v56, s[40:43], s74 offen offset:1568 sc1
    ds_read_b64_tr_b16 v[28:29], v59 offset:0
    ds_read_b64_tr_b16 v[30:31], v59 offset:1024
    ds_read_b64_tr_b16 v[32:33], v59 offset:2048
    ds_read_b64_tr_b16 v[34:35], v59 offset:3072
    ds_read_b64_tr_b16 v[36:37], v59 offset:4096
    ds_read_b64_tr_b16 v[38:39], v59 offset:5120
    ds_read_b64_tr_b16 v[40:41], v60 offset:0
    ds_read_b64_tr_b16 v[42:43], v60 offset:1024
    ds_read_b64_tr_b16 v[44:45], v60 offset:2048
    ds_read_b64_tr_b16 v[46:47], v60 offset:3072
    ds_read_b64_tr_b16 v[48:49], v60 offset:4096
    ds_read_b64_tr_b16 v[50:51], v60 offset:5120
    v_mov_b64 v[20:21], 0
    v_mov_b64 v[22:23], 0
    v_mov_b64 v[24:25], 0
    v_mov_b64 v[26:27], 0
    s_add_u32 s58, s6, 0
    s_waitcnt lgkmcnt(0)
    s_branch L_pw_143
L_pr_144:
    buffer_load_dwordx4 v[12:15], v57, s[40:43], s74 offen sc1
    buffer_load_dwordx2 v[16:17], v58, s[40:43], s74 offen offset:1024 sc1
    buffer_load_dword v18, v56, s[40:43], s74 offen offset:1568 sc1
    s_sub_u32 s56, s56, 1
    s_cbranch_scc1 L_done
L_pw_143:
    s_waitcnt vmcnt(0)
    v_max3_u32 v19, v12, v13, v14
    v_max3_u32 v19, v19, v15, v16
    v_max3_u32 v19, v19, v17, v18
    v_cmp_eq_u32 vcc, -1, v19
    s_cbranch_vccnz L_pr_144
    v_smfmac_f32_16x16x64_bf16 v[20:23], v[12:15], v[28:35], v1
    v_mul_f32 v52, v52, v18
    v_smfmac_f32_16x16x64_bf16 v[24:27], v[12:15], v[40:47], v1
    v_smfmac_f32_16x16x32_bf16 v[20:23], v[16:17], v[36:39], v1
    v_add_f32_dpp v52, v52, v52 row_ror:4 row_mask:0xf bank_mask:0xf
    v_smfmac_f32_16x16x32_bf16 v[24:27], v[16:17], v[48:51], v1
    s_cmp_eq_u32 s30, 2
    v_add_f32_dpp v52, v52, v52 row_ror:2 row_mask:0xf bank_mask:0xf
    s_nop 1
    v_add_f32_dpp v52, v52, v52 row_ror:1 row_mask:0xf bank_mask:0xf
    v_rcp_f32 v52, v52
    v_pk_add_f32 v[20:21], v[20:21], v[22:23]
    s_nop 0
L_pad2:
    s_cbranch_execz L_pad6
    v_pk_add_f32 v[24:25], v[24:25], v[26:27]
    v_pk_mul_f32 v[54:55], v[54:55], v[52:53] op_sel:[0,0] op_sel_hi:[1,0]
    v_mul_f32 v20, v20, v54
    v_mul_f32 v24, v24, v54
    v_fmac_f32 v20, v21, v55
    v_fmac_f32 v24, v25, v55
    s_nop 1
    v_permlane32_swap_b32 v20, v24
    v_add_f32 v20, v20, v24
    ds_write_b32 v61, v20
    s_waitcnt lgkmcnt(0)
    s_barrier
    s_cbranch_scc0 L_finb_145
    ds_read2st64_b32 v[12:13], v2 offset0:0 offset1:1
    ds_read2st64_b32 v[14:15], v2 offset0:2 offset1:3
    ds_read2st64_b32 v[16:17], v2 offset0:4 offset1:5
    ds_read2st64_b32 v[18:19], v2 offset0:6 offset1:7
    s_waitcnt lgkmcnt(2)
    v_pk_add_f32 v[12:13], v[12:13], v[14:15]
    s_waitcnt lgkmcnt(0)
    v_pk_add_f32 v[16:17], v[16:17], v[18:19]
    v_pk_add_f32 v[12:13], v[12:13], v[16:17]
    v_add_f32 v14, v12, v13
    v_add_f32 v15, v12, v13
    s_nop 1
    v_permlane16_swap_b32 v14, v15
    v_add_f32 v12, v14, v15
    v_min_u32 v12, -2, v12
    buffer_store_dword v12, v3, s[40:43], s58 offen sc1
L_finb_145:
    s_sub_u32 s57, s30, 4
    s_cmp_lt_u32 s57, 3
    s_cbranch_scc0 L_skip_146
    s_sub_u32 s60, s30, 4
    s_lshl_b32 s57, s60, 10
    v_lshlrev_b32 v11, 4, v0
    v_add_u32 v11, s57, v11
    s_add_u32 s65, s62, 16384
    buffer_load_dwordx4 v[16:19], v11, s[40:43], s65 offen sc1
    s_lshl_b32 s59, s60, 12
    s_add_u32 s59, s59, 79872
    s_mov_b32 s44, s20
    s_mov_b32 s45, s21
    s_mov_b32 s46, 1966080
    s_mov_b32 s47, 0x20000
    s_mul_i32 s57, s31, 3
    s_add_u32 s57, s57, s60
    s_mul_i32 s57, s57, 81920
    s_lshl_b32 s64, s3, 6
    s_add_u32 s57, s57, s64
    v_lshrrev_b32 v5, 2, v0
    v_mul_u32_u24 v5, 1280, v5
    v_and_b32 v60, 3, v0
    v_lshl_add_u32 v5, v60, 4, v5
    v_add_u32 v5, s57, v5
    s_add_u32 m0, s59, 0
    s_mov_b32 s57, 0
    buffer_load_dwordx4 v5, s[44:47], s57 offen nt lds
    s_add_u32 m0, s59, 1024
    s_mov_b32 s57, 20480
    buffer_load_dwordx4 v5, s[44:47], s57 offen nt lds
    s_add_u32 m0, s59, 2048
    s_mov_b32 s57, 40960
    buffer_load_dwordx4 v5, s[44:47], s57 offen nt lds
    s_add_u32 m0, s59, 3072
    s_mov_b32 s57, 61440
    buffer_load_dwordx4 v5, s[44:47], s57 offen nt lds
    v_lshrrev_b32 v35, 4, v0
    v_lshlrev_b32 v35, 9, v35
    v_bfe_u32 v60, v0, 2, 2
    v_lshl_add_u32 v35, v60, 6, v35
    v_and_b32 v60, 3, v0
    v_lshl_add_u32 v35, v60, 3, v35
    v_add_u32 v35, s59, v35
    v_mov_b64 v[52:53], 0
    v_mov_b64 v[54:55], 0
    v_mov_b64 v[56:57], 0
    v_mov_b64 v[58:59], 0
    v_mov_b32 v9, 0xbdd2d3e8
    v_mov_b32 v10, 0xc0135761
    v_mov_b32 v5, 0x3f803f80
    v_mov_b32 v61, 0x3acccccd
    v_mov_b32 v62, 0x3727c5ac
    s_lshl_b32 s57, s60, 7
    s_add_u32 s57, s57, 159872
    v_lshlrev_b32 v32, 3, v0
    v_add_u32 v32, s57, v32
    v_lshlrev_b32 v33, 3, v0
    v_add_u32 v33, 129024, v33
L_pad3:
    s_cbranch_execz L_pad7
    v_cmp_gt_u32 vcc, 16, v0
    s_nop 1
    v_cndmask_b32 v32, v33, v32, vcc
    v_and_b32 v33, 15, v0
    v_lshlrev_b32 v33, 3, v33
    v_lshrrev_b32 v60, 5, v0
    v_lshl_add_u32 v33, v60, 2, v33
    v_add_u32 v33, 159872, v33
    v_and_b32 v34, 15, v0
    v_lshlrev_b32 v34, 2, v34
    v_lshrrev_b32 v60, 5, v0
    v_lshl_add_u32 v34, v60, 6, v34
    v_bfe_u32 v60, v0, 4, 1
    v_lshl_add_u32 v34, v60, 13, v34
    s_add_u32 s60, s6, 131072
    s_add_u32 s58, s62, 13312
    s_add_u32 s57, s62, 19712
    v_and_b32 v7, 7, v0
    v_lshlrev_b32 v7, 3, v7
    s_waitcnt vmcnt(0)
    buffer_load_dwordx2 v[24:25], v7, s[40:43], s57 offen sc1
    buffer_load_dwordx4 v[12:15], v11, s[40:43], s58 offen sc1
    ds_read_b64_tr_b16 v[36:37], v35 offset:0
    ds_read_b64_tr_b16 v[38:39], v35 offset:256
    ds_read_b64_tr_b16 v[40:41], v35 offset:2048
    ds_read_b64_tr_b16 v[42:43], v35 offset:2304
    ds_read_b64_tr_b16 v[44:45], v35 offset:32
    ds_read_b64_tr_b16 v[46:47], v35 offset:288
    ds_read_b64_tr_b16 v[48:49], v35 offset:2080
    ds_read_b64_tr_b16 v[50:51], v35 offset:2336
L_sw_149:
    v_pk_max_u16 v20, v16, v17
    v_pk_max_u16 v21, v18, v19
    v_pk_max_u16 v20, v20, v21
    v_lshlrev_b32 v21, 16, v20
    v_max_u32 v20, v20, v21
    v_cmp_le_u32 vcc, 0xffff0000, v20
    s_cbranch_vccnz L_sr_150
    v_dot2_f32_bf16 v26, v16, v5, 0
    v_dot2_f32_bf16 v27, v17, v5, 0
    v_dot2_f32_bf16 v26, v18, v5, v26
    v_dot2_f32_bf16 v27, v19, v5, v27
    s_nop 2
    v_add_f32 v26, v26, v27
    s_waitcnt lgkmcnt(0)
L_pr_148:
    buffer_load_dwordx2 v[24:25], v7, s[40:43], s57 offen sc1
    buffer_load_dwordx4 v[12:15], v11, s[40:43], s58 offen sc1
    s_sub_u32 s56, s56, 1
    s_cbranch_scc1 L_done
L_pw_147:
    s_waitcnt vmcnt(2)
    v_max_u32 v20, v24, v25
    v_cmp_eq_u32 vcc, -1, v20
    s_cbranch_vccnz L_pr_148
    buffer_load_dwordx4 v[12:15], v11, s[40:43], s58 offen sc1
    v_add_f32_dpp v2, v24, v24 row_ror:4 row_mask:0xf bank_mask:0xf
    v_add_f32_dpp v3, v25, v25 row_ror:4 row_mask:0xf bank_mask:0xf
    v_dot2_f32_bf16 v20, v12, v5, 0
    v_dot2_f32_bf16 v21, v13, v5, 0
    v_add_f32_dpp v2, v2, v2 row_ror:2 row_mask:0xf bank_mask:0xf
    v_add_f32_dpp v3, v3, v3 row_ror:2 row_mask:0xf bank_mask:0xf
    v_dot2_f32_bf16 v20, v14, v5, v20
    v_dot2_f32_bf16 v21, v15, v5, v21
    v_add_f32_dpp v2, v2, v2 row_ror:1 row_mask:0xf bank_mask:0xf
    v_add_f32_dpp v3, v3, v3 row_ror:1 row_mask:0xf bank_mask:0xf
    v_mul_f32 v2, v2, v61
    v_fma_f32 v3, v3, v61, v62
    v_add_f32 v20, v20, v21
    v_fma_f32 v3, -v2, v2, v3
    v_mul_f32 v26, v26, v2
    v_max_f32 v3, v3, v62
    v_cmp_u_f32 vcc, v20, v20
    v_rsq_f32 v3, v3
    v_sub_f32 v20, v20, v26
    s_cbranch_vccnz L_hr_152
L_hk_153:
    v_fma_f32 v20, v20, v3, v4
    v_mul_f32 v21, v20, v20
    v_fma_f32 v21, v21, v9, v10
    v_mul_f32 v21, v21, v20
    v_exp_f32 v21, v21
    s_nop 0
    v_add_f32 v21, 1.0, v21
    v_rcp_f32 v21, v21
    s_nop 0
    v_mul_f32 v20, v20, v21
    s_nop 1
L_pad4:
    s_cbranch_execz L_pad8
    v_mov_b32_dpp v21, v20 row_shl:1 row_mask:0xf bank_mask:0xf bound_ctrl:0
    v_cvt_pk_bf16_f32 v28, v20, v21
    s_nop 1
    v_mov_b32_dpp v29, v28 row_shl:4 row_mask:0xf bank_mask:0xf bound_ctrl:0
    v_mov_b32_dpp v30, v28 row_shl:8 row_mask:0xf bank_mask:0xf bound_ctrl:0
    v_mov_b32_dpp v31, v28 row_shl:12 row_mask:0xf bank_mask:0xf bound_ctrl:0
    s_nop 1
    v_smfmac_f32_16x16x64_bf16 v[52:55], v[28:31], v[36:43], v1
    v_smfmac_f32_16x16x64_bf16 v[56:59], v[28:31], v[44:51], v1
    s_cmp_eq_u32 s30, 4
    s_nop 5
    v_add_f32 v22, v52, v54
    v_add_f32 v23, v56, v58
    ds_write_b64 v32, v[22:23]
    s_cbranch_scc0 L_skip_155
L_xw_156:
    ds_read2_b32 v[20:21], v33 offset0:0 offset1:32
    ds_read_b32 v22, v33 offset:256
    s_sub_u32 s56, s56, 1
    s_cbranch_scc1 L_done
    s_waitcnt lgkmcnt(0)
    v_max3_u32 v23, v20, v21, v22
    v_add_f32 v20, v20, v21
    v_cmp_eq_u32 vcc, -1, v23
    v_add_f32 v20, v20, v22
    s_cbranch_vccnz L_xw_156
    v_min_u32 v20, -2, v20
    buffer_store_dword v20, v34, s[40:43], s60 offen sc1
    s_waitcnt vmcnt(1)
    s_branch L_pe_157
L_skip_155:
    s_waitcnt vmcnt(0)
L_pe_157:
L_skip_146:
    s_branch L_p1
L_typeB_0:
    s_cmp_eq_u32 s53, 3
    s_cbranch_scc0 L_typeC_158
    s_cmp_eq_u32 s30, 7
    s_cbranch_scc1 L_w7_168
    s_cmp_lt_u32 s30, 6
    s_cbranch_scc0 L_skip_170
    s_lshr_b32 s57, s30, 1
    s_mul_i32 s57, s57, 128
    s_and_b32 s58, s30, 1
    s_lshl_b32 s58, s58, 6
    s_add_u32 s57, s57, s58
    v_lshrrev_b32 v18, 5, v0
    v_lshlrev_b32 v18, 13, v18
    v_bfe_u32 v60, v0, 3, 1
    v_lshl_add_u32 v18, v60, 12, v18
    v_bfe_u32 v60, v0, 4, 1
    v_lshl_add_u32 v18, v60, 11, v18
    v_bfe_u32 v60, v0, 2, 1
    v_mul_u32_u24 v60, 384, v60
    v_add_u32 v18, v60, v18
    v_and_b32 v60, 3, v0
    v_lshl_add_u32 v18, v60, 3, v18
    v_add_u32 v18, s57, v18
    v_add_u32 v18, 30720, v18
    v_bfe_u32 v19, v0, 4, 1
    v_lshlrev_b32 v19, 12, v19
    v_bfe_u32 v60, v0, 3, 1
    v_lshl_add_u32 v19, v60, 11, v19
    v_bfe_u32 v60, v0, 2, 1
    v_mul_u32_u24 v60, 384, v60
    v_add_u32 v19, v60, v19
    v_and_b32 v60, 3, v0
    v_lshl_add_u32 v19, v60, 3, v19
    v_add_u32 v19, s57, v19
    v_add_u32 v19, 63488, v19
    ds_read_b64_tr_b16 v[28:29], v18 offset:0
    ds_read_b64_tr_b16 v[30:31], v18 offset:1024
    ds_read_b64_tr_b16 v[32:33], v18 offset:16384
    ds_read_b64_tr_b16 v[34:35], v18 offset:17408
    ds_read_b64_tr_b16 v[36:37], v19 offset:0
    ds_read_b64_tr_b16 v[38:39], v19 offset:1024
    ds_read_b64_tr_b16 v[40:41], v18 offset:32
    ds_read_b64_tr_b16 v[42:43], v18 offset:1056
    ds_read_b64_tr_b16 v[44:45], v18 offset:16416
    ds_read_b64_tr_b16 v[46:47], v18 offset:17440
    ds_read_b64_tr_b16 v[48:49], v19 offset:32
    ds_read_b64_tr_b16 v[50:51], v19 offset:1056
    v_lshrrev_b32 v9, 4, v0
    v_lshlrev_b32 v9, 5, v9
    v_bfe_u32 v60, v0, 1, 1
    v_lshl_add_u32 v9, v60, 4, v9
    v_and_b32 v60, 1, v0
    v_mul_u32_u24 v60, 192, v60
L_pad5:
    s_cbranch_execz L_pad9
    v_add_u32 v9, v60, v9
    v_add_u32 v9, 160832, v9
    v_lshrrev_b32 v10, 4, v0
    v_lshlrev_b32 v10, 4, v10
    v_bfe_u32 v60, v0, 1, 1
    v_lshl_add_u32 v10, v60, 3, v10
    v_and_b32 v60, 1, v0
    v_mul_u32_u24 v60, 192, v60
    v_add_u32 v10, v60, v10
    v_add_u32 v10, 160960, v10
    v_mov_b64 v[20:21], 0
    v_mov_b64 v[22:23], 0
    v_mov_b64 v[24:25], 0
    v_mov_b64 v[26:27], 0
    s_lshl_b32 s57, s54, 1
    s_lshl_b32 s58, s30, 9
    s_add_u32 s57, s57, s58
    v_and_b32 v11, 31, v0
    v_lshlrev_b32 v11, 4, v11
    v_lshrrev_b32 v60, 5, v0
    v_lshl_add_u32 v11, v60, 30, v11
    v_add_u32 v11, s57, v11
    s_add_u32 s59, s62, 13312
    s_add_u32 s60, s62, 19712
    ds_read_b128 v[12:15], v9
    ds_read_b64 v[16:17], v10
    s_waitcnt lgkmcnt(1)
    v_smfmac_f32_16x16x64_bf16 v[20:23], v[12:15], v[28:35], v1
    v_smfmac_f32_16x16x64_bf16 v[24:27], v[12:15], v[40:47], v1
    s_waitcnt lgkmcnt(0)
    v_smfmac_f32_16x16x32_bf16 v[20:23], v[16:17], v[36:39], v1
    v_smfmac_f32_16x16x32_bf16 v[24:27], v[16:17], v[48:51], v1
    s_add_u32 s60, s62, 16384
    s_cmp_eq_u32 s55, 0
    s_nop 4
    v_add_f32 v12, v21, v23
    s_nop 1
    v_add_f32_dpp v12, v25, v27 quad_perm:[0,1,2,3] row_mask:0x2 bank_mask:0xf
    v_cvt_pk_bf16_f32 v12, v12, v12
    v_min_u32 v12, -2, v12
    s_cbranch_scc1 L_gs_171
    buffer_store_short v12, v11, s[40:43], s60 offen
L_gb_172:
    v_mov_b64 v[20:21], 0
    v_mov_b64 v[22:23], 0
    v_mov_b64 v[24:25], 0
    v_mov_b64 v[26:27], 0
L_skip_170:
    s_cmp_lt_u32 s30, 6
    s_barrier
    s_cbranch_scc0 L_se_169
    ds_read_b128 v[12:15], v9
    ds_read_b64 v[16:17], v10
    s_waitcnt lgkmcnt(1)
    v_smfmac_f32_16x16x64_bf16 v[20:23], v[12:15], v[28:35], v1
    v_smfmac_f32_16x16x64_bf16 v[24:27], v[12:15], v[40:47], v1
    s_waitcnt lgkmcnt(0)
    v_smfmac_f32_16x16x32_bf16 v[20:23], v[16:17], v[36:39], v1
    v_smfmac_f32_16x16x32_bf16 v[24:27], v[16:17], v[48:51], v1
    s_cmp_eq_u32 s55, 0
    s_nop 5
    v_add_f32 v12, v20, v22
    s_nop 1
    v_add_f32_dpp v12, v24, v26 quad_perm:[0,1,2,3] row_mask:0x2 bank_mask:0xf
    v_cvt_pk_bf16_f32 v12, v12, v12
    v_min_u32 v12, -2, v12
    s_cbranch_scc1 L_gs_173
    buffer_store_short v12, v11, s[40:43], s59 offen
L_gb_174:
L_se_169:
L_p1:
    s_lshl_b32 s57, s30, 7
    s_add_u32 s57, s57, 158720
    v_lshrrev_b32 v58, 4, v0
    v_lshlrev_b32 v58, 5, v58
    v_bfe_u32 v60, v0, 1, 1
    v_lshl_add_u32 v58, v60, 4, v58
    v_bfe_u32 v60, v0, 2, 2
    v_lshl_add_u32 v58, v60, 2, v58
    v_and_b32 v60, 1, v0
    v_lshl_add_u32 v58, v60, 1, v58
    v_add_u32 v58, s57, v58
    v_lshrrev_b32 v61, 4, v0
    v_lshlrev_b32 v61, 5, v61
    v_bfe_u32 v60, v0, 1, 1
    v_lshl_add_u32 v61, v60, 4, v61
    v_add_u32 v61, s57, v61
    v_bfe_u32 v62, v0, 2, 2
    v_lshlrev_b32 v62, 1, v62
    v_and_b32 v60, 1, v0
    v_lshl_add_u32 v62, v60, 0, v62
    v_mov_b32 v60, 160992
    v_cmp_eq_u32 vcc, 0, v62
    s_nop 1
L_pad6:
    s_cbranch_execz L_pad10
    v_cndmask_b32 v52, v60, v61, vcc
    v_cmp_eq_u32 vcc, 1, v62
    s_nop 1
    v_cndmask_b32 v53, v60, v61, vcc
    v_cmp_eq_u32 vcc, 2, v62
    s_nop 1
    v_cndmask_b32 v54, v60, v61, vcc
    v_cmp_eq_u32 vcc, 3, v62
    s_nop 1
    v_cndmask_b32 v55, v60, v61, vcc
    v_cmp_eq_u32 vcc, 4, v62
    s_nop 1
    v_cndmask_b32 v56, v60, v61, vcc
    v_cmp_eq_u32 vcc, 5, v62
    s_nop 1
    v_cndmask_b32 v57, v60, v61, vcc
    s_lshl_b32 s58, s30, 2
    s_add_u32 s58, s58, 159808
    v_mov_b32 v60, s58
    v_lshlrev_b32 v59, 2, v0
    v_add_u32 v59, 157696, v59
    v_cmp_eq_u32 vcc, 63, v0
    s_nop 1
    v_cndmask_b32 v59, v59, v60, vcc
    v_and_b32 v62, 7, v0
    v_lshlrev_b32 v62, 2, v62
    v_add_u32 v62, 159808, v62
    s_lshl_b32 s57, s30, 11
    v_lshlrev_b32 v63, 4, v0
    v_add_u32 v63, s57, v63
    v_add_u32 v63, 92160, v63
    v_mov_b32 v8, 125440
    s_sub_u32 s57, s30, 1
    s_lshl_b32 s57, s57, 10
    v_lshlrev_b32 v7, 4, v0
    v_add_u32 v7, s57, v7
    s_cmp_eq_u32 s30, 7
    s_cbranch_scc1 L_w7_182
    s_cmp_lt_u32 s30, 6
    s_cbranch_scc0 L_skip_184
    s_lshr_b32 s57, s30, 1
    s_mul_i32 s57, s57, 1024
    s_and_b32 s58, s30, 1
    s_lshl_b32 s58, s58, 6
    s_add_u32 s57, s57, s58
    v_lshrrev_b32 v18, 5, v0
    v_mul_u32_u24 v18, 6144, v18
    v_bfe_u32 v60, v0, 3, 1
    v_mul_u32_u24 v60, 3072, v60
    v_add_u32 v18, v60, v18
    v_bfe_u32 v60, v0, 4, 1
    v_lshl_add_u32 v18, v60, 9, v18
    v_bfe_u32 v60, v0, 2, 1
    v_lshl_add_u32 v18, v60, 7, v18
    v_and_b32 v60, 3, v0
    v_lshl_add_u32 v18, v60, 3, v18
    v_add_u32 v18, s57, v18
    v_bfe_u32 v19, v0, 4, 1
    v_mul_u32_u24 v19, 3072, v19
    v_bfe_u32 v60, v0, 3, 1
    v_lshl_add_u32 v19, v60, 9, v19
    v_bfe_u32 v60, v0, 2, 1
    v_lshl_add_u32 v19, v60, 7, v19
    v_and_b32 v60, 3, v0
    v_lshl_add_u32 v19, v60, 3, v19
    v_add_u32 v19, s57, v19
    v_add_u32 v19, 24576, v19
    ds_read_b64_tr_b16 v[28:29], v18 offset:0
    ds_read_b64_tr_b16 v[30:31], v18 offset:256
    ds_read_b64_tr_b16 v[32:33], v18 offset:12288
    ds_read_b64_tr_b16 v[34:35], v18 offset:12544
    ds_read_b64_tr_b16 v[36:37], v19 offset:0
    ds_read_b64_tr_b16 v[38:39], v19 offset:256
    ds_read_b64_tr_b16 v[40:41], v18 offset:32
    ds_read_b64_tr_b16 v[42:43], v18 offset:288
    ds_read_b64_tr_b16 v[44:45], v18 offset:12320
    ds_read_b64_tr_b16 v[46:47], v18 offset:12576
    ds_read_b64_tr_b16 v[48:49], v19 offset:32
    ds_read_b64_tr_b16 v[50:51], v19 offset:288
    v_lshrrev_b32 v9, 4, v0
    v_lshlrev_b32 v9, 5, v9
    v_bfe_u32 v60, v0, 1, 1
    v_lshl_add_u32 v9, v60, 4, v9
    v_and_b32 v60, 1, v0
    v_mul_u32_u24 v60, 192, v60
    v_add_u32 v9, v60, v9
    v_add_u32 v9, 160832, v9
    v_lshrrev_b32 v10, 4, v0
    v_lshlrev_b32 v10, 4, v10
L_pad7:
    s_cbranch_execz L_pad11
    v_bfe_u32 v60, v0, 1, 1
    v_lshl_add_u32 v10, v60, 3, v10
    v_and_b32 v60, 1, v0
    v_mul_u32_u24 v60, 192, v60
    v_add_u32 v10, v60, v10
    v_add_u32 v10, 160960, v10
    v_mov_b64 v[20:21], 0
    v_mov_b64 v[22:23], 0
    v_mov_b64 v[24:25], 0
    v_mov_b64 v[26:27], 0
    s_lshl_b32 s57, s54, 1
    s_lshl_b32 s58, s30, 9
    s_add_u32 s57, s57, s58
    v_and_b32 v11, 31, v0
    v_lshlrev_b32 v11, 4, v11
    v_lshrrev_b32 v60, 5, v0
    v_lshl_add_u32 v11, v60, 30, v11
    v_add_u32 v11, s57, v11
    s_mul_i32 s59, s53, 3072
    s_add_u32 s59, s59, s62
    s_add_u32 s59, s59, 36864
    s_lshl_b32 s60, s53, 6
    s_add_u32 s60, s60, s62
    s_add_u32 s60, s60, 19456
L_skip_184:
    s_cmp_lt_u32 s30, 6
    s_barrier
    s_cbranch_scc0 L_se_183
    ds_read_b128 v[12:15], v9
    ds_read_b64 v[16:17], v10
    s_waitcnt lgkmcnt(1)
    v_smfmac_f32_16x16x64_bf16 v[20:23], v[12:15], v[28:35], v1
    v_smfmac_f32_16x16x64_bf16 v[24:27], v[12:15], v[40:47], v1
    s_waitcnt lgkmcnt(0)
    v_smfmac_f32_16x16x32_bf16 v[20:23], v[16:17], v[36:39], v1
    v_smfmac_f32_16x16x32_bf16 v[24:27], v[16:17], v[48:51], v1
    s_cmp_eq_u32 s55, 0
    s_nop 5
    v_add_f32 v12, v20, v22
    s_nop 1
    v_add_f32_dpp v12, v24, v26 quad_perm:[0,1,2,3] row_mask:0x2 bank_mask:0xf
    v_cvt_pk_bf16_f32 v12, v12, v12
    v_min_u32 v12, -2, v12
    s_cbranch_scc1 L_gs_185
    buffer_store_short v12, v11, s[40:43], s59 offen
L_gb_186:
L_se_183:
    s_sub_u32 s57, s30, 1
    s_cmp_lt_u32 s57, 3
    s_cbranch_scc0 L_qo_200
    buffer_load_dwordx4 v[48:51], v7, s[40:43], s59 offen sc1
    v_mov_b64 v[24:25], 0
    v_mov_b64 v[26:27], 0
    v_mov_b64 v[28:29], 0
    v_mov_b64 v[30:31], 0
    v_mov_b64 v[32:33], 0
    v_mov_b64 v[34:35], 0
    v_mov_b64 v[36:37], 0
    v_mov_b64 v[38:39], 0
    v_mov_b64 v[40:41], 0
    v_mov_b64 v[42:43], 0
    v_mov_b64 v[44:45], 0
    v_mov_b64 v[46:47], 0
    v_lshrrev_b32 v5, 4, v0
    v_lshlrev_b32 v5, 5, v5
    v_bfe_u32 v60, v0, 1, 1
    v_lshl_add_u32 v5, v60, 4, v5
    v_add_u32 v5, 124928, v5
    v_add_u32 v9, 4294933376, v58
    v_mov_b32 v10, 0x3f803f80
L_qw_202:
    buffer_load_dwordx4 v[48:51], v7, s[40:43], s59 offen sc1
    s_sub_u32 s56, s56, 1
    s_cbranch_scc1 L_done
    s_and_b32 s57, s56, 31
    s_waitcnt vmcnt(1)
    v_dot2_f32_bf16 v60, v48, v10, 0
    v_dot2_f32_bf16 v61, v49, v10, 0
    v_dot2_f32_bf16 v60, v50, v10, v60
    v_dot2_f32_bf16 v61, v51, v10, v61
    s_nop 2
    v_add_f32 v60, v60, v61
    v_cmp_u_f32 vcc, v60, v60
    v_cvt_pk_bf16_f32 v60, v60, v60
    s_cbranch_vccnz L_qr_203
L_qk_204:
    ds_write_b16 v9, v60
L_qb_201:
    s_waitcnt lgkmcnt(0)
    s_barrier
    ds_read_b128 v[12:15], v5 offset:0
    ds_read_b128 v[16:19], v5 offset:128
    ds_read_b128 v[20:23], v5 offset:256
    ds_read_b64 v[8:9], v8
    s_waitcnt lgkmcnt(1)
    v_smfmac_f32_16x16x64_bf16 v[24:27], v[12:15], v[64:71], v1
    v_smfmac_f32_16x16x64_bf16 v[24:27], v[16:19], v[72:79], v1
L_pad8:
    s_cbranch_execz L_pad12
    v_smfmac_f32_16x16x64_bf16 v[24:27], v[20:23], v[80:87], v1
    v_smfmac_f32_16x16x64_bf16 v[28:31], v[12:15], v[88:95], v1
    v_smfmac_f32_16x16x64_bf16 v[28:31], v[16:19], v[96:103], v1
    v_smfmac_f32_16x16x64_bf16 v[28:31], v[20:23], v[104:111], v1
    v_smfmac_f32_16x16x64_bf16 v[32:35], v[12:15], v[112:119], v1
    v_smfmac_f32_16x16x64_bf16 v[32:35], v[16:19], v[120:127], v1
    v_smfmac_f32_16x16x64_bf16 v[32:35], v[20:23], v[128:135], v1
    v_smfmac_f32_16x16x64_bf16 v[36:39], v[12:15], v[136:143], v1
    v_smfmac_f32_16x16x64_bf16 v[36:39], v[16:19], v[144:151], v1
    v_smfmac_f32_16x16x64_bf16 v[36:39], v[20:23], v[152:159], v1
    v_add_f32_dpp v61, v24, v26 quad_perm:[0,1,2,3] row_mask:0x1 bank_mask:0xf
    s_waitcnt vmcnt(0) lgkmcnt(0)
    v_mul_f32 v8, v8, v6
    v_add_f32_dpp v61, v28, v30 quad_perm:[0,1,2,3] row_mask:0x2 bank_mask:0xf
    s_nop 1
    v_add_f32_dpp v61, v32, v34 quad_perm:[0,1,2,3] row_mask:0x4 bank_mask:0xf
    s_nop 1
    v_add_f32_dpp v61, v36, v38 quad_perm:[0,1,2,3] row_mask:0x8 bank_mask:0xf
    v_fma_f32 v36, v61, v9, v8
    s_nop 1
    v_max_f32_dpp v37, v36, v36 row_ror:8 row_mask:0xf bank_mask:0xf
    s_nop 1
    v_max_f32_dpp v37, v37, v37 row_ror:4 row_mask:0xf bank_mask:0xf
    s_nop 1
    v_max_f32_dpp v37, v37, v37 row_ror:2 row_mask:0xf bank_mask:0xf
    s_nop 1
    v_max_f32_dpp v37, v37, v37 row_ror:1 row_mask:0xf bank_mask:0xf
    s_nop 1
    v_max_f32_dpp v37, v37, v37 row_bcast:15 row_mask:0xa bank_mask:0xf
    s_nop 1
    v_max_f32_dpp v37, v37, v37 row_bcast:31 row_mask:0xc bank_mask:0xf
    s_nop 0
    v_readlane_b32 s64, v37, 63
    ds_write_b32 v59, v37
    s_nop 0
    v_subrev_f32 v36, s64, v36
    v_exp_f32 v36, v36
    s_nop 0
    v_cvt_pk_bf16_f32 v39, v36, v36
    ds_write_b16 v58, v39
    ds_read_b128 v[12:15], v52
    ds_read_b128 v[16:19], v53
    ds_read_b128 v[20:23], v54
    ds_read_b128 v[24:27], v55
    ds_read_b128 v[28:31], v56
    ds_read_b128 v[32:35], v57
    v_add_f32_dpp v38, v36, v36 row_ror:8 row_mask:0xf bank_mask:0xf
    s_nop 1
    v_add_f32_dpp v38, v38, v38 row_ror:4 row_mask:0xf bank_mask:0xf
    s_nop 1
    v_add_f32_dpp v38, v38, v38 row_ror:2 row_mask:0xf bank_mask:0xf
    s_nop 1
    v_add_f32_dpp v38, v38, v38 row_ror:1 row_mask:0xf bank_mask:0xf
    s_waitcnt lgkmcnt(5)
    v_smfmac_f32_16x16x64_bf16 v[40:43], v[12:15], v[160:167], v1
    v_add_f32_dpp v38, v38, v38 row_bcast:15 row_mask:0xa bank_mask:0xf
    v_smfmac_f32_16x16x64_bf16 v[44:47], v[12:15], v[208:215], v1
    s_waitcnt lgkmcnt(4)
    v_smfmac_f32_16x16x64_bf16 v[40:43], v[16:19], v[168:175], v1
    v_add_f32_dpp v38, v38, v38 row_bcast:31 row_mask:0xc bank_mask:0xf
    v_smfmac_f32_16x16x64_bf16 v[44:47], v[16:19], v[216:223], v1
    ds_read_b32 v36, v62
    s_waitcnt lgkmcnt(4)
    v_smfmac_f32_16x16x64_bf16 v[40:43], v[20:23], v[176:183], v1
    v_smfmac_f32_16x16x64_bf16 v[44:47], v[20:23], v[224:231], v1
    s_waitcnt lgkmcnt(0)
    v_max_f32_dpp v37, v36, v36 row_ror:4 row_mask:0xf bank_mask:0xf
    v_smfmac_f32_16x16x64_bf16 v[40:43], v[24:27], v[184:191], v1
    v_smfmac_f32_16x16x64_bf16 v[44:47], v[24:27], v[232:239], v1
    v_max_f32_dpp v37, v37, v37 row_ror:2 row_mask:0xf bank_mask:0xf
    v_smfmac_f32_16x16x64_bf16 v[40:43], v[28:31], v[192:199], v1
    v_cmp_eq_u32 vcc, -1, v36
    v_smfmac_f32_16x16x64_bf16 v[44:47], v[28:31], v[240:247], v1
    v_max_f32_dpp v37, v37, v37 row_ror:1 row_mask:0xf bank_mask:0xf
    v_smfmac_f32_16x16x64_bf16 v[40:43], v[32:35], v[200:207], v1
L_pad9:
    s_cbranch_execz L_pad13
    v_sub_f32 v39, s64, v37
    v_smfmac_f32_16x16x64_bf16 v[44:47], v[32:35], v[248:255], v1
    v_exp_f32 v39, v39
    s_cbranch_vccnz L_mr_207
L_mk_208:
    v_mul_f32 v38, v38, v39
    ds_write_b32 v63, v38 offset:1024
    s_cmp_lt_u32 s30, 2
    s_nop 0
    v_pk_add_f32 v[40:41], v[40:41], v[42:43]
    s_nop 0
    v_pk_add_f32 v[42:43], v[44:45], v[46:47]
    v_pk_mul_f32 v[40:41], v[40:41], v[38:39] op_sel:[0,1] op_sel_hi:[1,1]
    v_pk_mul_f32 v[42:43], v[42:43], v[38:39] op_sel:[0,1] op_sel_hi:[1,1]
    ds_write_b128 v63, v[40:43]
    s_cbranch_scc1 L_comb_1
    s_waitcnt lgkmcnt(0)
    s_barrier
L_comb_1b:
    s_cmp_lt_u32 s3, 20
    s_cbranch_scc0 L_typeB_1
    s_mul_i32 s74, s30, 1664
    s_add_u32 s74, s74, s62
    s_add_u32 s74, s74, 20480
    v_and_b32 v56, 7, v0
    v_lshlrev_b32 v56, 2, v56
    v_lshrrev_b32 v62, 4, v0
    v_lshlrev_b32 v62, 3, v62
    buffer_load_dword v52, v56, s[40:43], s74 offen offset:1536 sc1
    buffer_load_dwordx2 v[54:55], v62, s[40:43], s74 offen offset:1536 sc1
    v_lshlrev_b32 v57, 4, v0
    v_lshlrev_b32 v58, 3, v0
    s_mul_i32 s57, s30, 6144
    s_add_u32 s57, s57, 30720
    v_lshrrev_b32 v59, 2, v0
    v_lshlrev_b32 v59, 6, v59
    v_bfe_u32 v53, v0, 4, 1
    v_lshl_add_u32 v59, v53, 5, v59
    v_and_b32 v53, 3, v0
    v_lshl_add_u32 v59, v53, 3, v59
    v_add_u32 v59, s57, v59
    v_xor_b32 v60, 32, v59
    s_lshl_b32 s57, s30, 8
    s_add_u32 s57, s57, 157696
    v_lshl_add_u32 v61, v0, 2, s57
    ds_read_b64_tr_b16 v[28:29], v59 offset:0
    ds_read_b64_tr_b16 v[30:31], v59 offset:1024
    ds_read_b64_tr_b16 v[32:33], v59 offset:2048
    ds_read_b64_tr_b16 v[34:35], v59 offset:3072
    ds_read_b64_tr_b16 v[36:37], v59 offset:4096
    ds_read_b64_tr_b16 v[38:39], v59 offset:5120
    ds_read_b64_tr_b16 v[40:41], v60 offset:0
    ds_read_b64_tr_b16 v[42:43], v60 offset:1024
    ds_read_b64_tr_b16 v[44:45], v60 offset:2048
    ds_read_b64_tr_b16 v[46:47], v60 offset:3072
    ds_read_b64_tr_b16 v[48:49], v60 offset:4096
    ds_read_b64_tr_b16 v[50:51], v60 offset:5120
    v_mov_b64 v[20:21], 0
    v_mov_b64 v[22:23], 0
    v_mov_b64 v[24:25], 0
    v_mov_b64 v[26:27], 0
    s_add_u32 s58, s6, 262144
    s_branch L_pw_215
L_pr_216:
    buffer_load_dword v52, v56, s[40:43], s74 offen offset:1536 sc1
    buffer_load_dwordx2 v[54:55], v62, s[40:43], s74 offen offset:1536 sc1
    s_sub_u32 s56, s56, 1
    s_cbranch_scc1 L_done
L_pw_215:
    s_waitcnt vmcnt(0)
    v_max3_u32 v53, v52, v54, v55
    v_cmp_eq_u32 vcc, -1, v53
    s_cbranch_vccnz L_pr_216
    buffer_load_dwordx4 v[12:15], v57, s[40:43], s74 offen sc1
    buffer_load_dwordx2 v[16:17], v58, s[40:43], s74 offen offset:1024 sc1
    buffer_load_dword v18, v56, s[40:43], s74 offen offset:1568 sc1
    v_max_f32_dpp v53, v52, v52 row_ror:4 row_mask:0xf bank_mask:0xf
    s_nop 1
    v_max_f32_dpp v53, v53, v53 row_ror:2 row_mask:0xf bank_mask:0xf
    s_nop 1
    v_max_f32_dpp v53, v53, v53 row_ror:1 row_mask:0xf bank_mask:0xf
    v_sub_f32 v52, v52, v53
    v_sub_f32 v54, v54, v53
    v_sub_f32 v55, v55, v53
    v_exp_f32 v52, v52
    v_exp_f32 v54, v54
    v_exp_f32 v55, v55
    s_waitcnt lgkmcnt(0)
    s_branch L_pw_217
L_pr_218:
    buffer_load_dwordx4 v[12:15], v57, s[40:43], s74 offen sc1
L_pad10:
    s_cbranch_execz L_pad14
    buffer_load_dwordx2 v[16:17], v58, s[40:43], s74 offen offset:1024 sc1
    buffer_load_dword v18, v56, s[40:43], s74 offen offset:1568 sc1
    s_sub_u32 s56, s56, 1
    s_cbranch_scc1 L_done
L_pw_217:
    s_waitcnt vmcnt(0)
    v_max3_u32 v19, v12, v13, v14
    v_max3_u32 v19, v19, v15, v16
    v_max3_u32 v19, v19, v17, v18
    v_cmp_eq_u32 vcc, -1, v19
    s_cbranch_vccnz L_pr_218
    v_smfmac_f32_16x16x64_bf16 v[20:23], v[12:15], v[28:35], v1
    v_mul_f32 v52, v52, v18
    v_smfmac_f32_16x16x64_bf16 v[24:27], v[12:15], v[40:47], v1
    v_smfmac_f32_16x16x32_bf16 v[20:23], v[16:17], v[36:39], v1
    v_add_f32_dpp v52, v52, v52 row_ror:4 row_mask:0xf bank_mask:0xf
    v_smfmac_f32_16x16x32_bf16 v[24:27], v[16:17], v[48:51], v1
    s_cmp_eq_u32 s30, 2
    v_add_f32_dpp v52, v52, v52 row_ror:2 row_mask:0xf bank_mask:0xf
    s_nop 1
    v_add_f32_dpp v52, v52, v52 row_ror:1 row_mask:0xf bank_mask:0xf
    v_rcp_f32 v52, v52
    v_pk_add_f32 v[20:21], v[20:21], v[22:23]
    s_nop 0
    v_pk_add_f32 v[24:25], v[24:25], v[26:27]
    v_pk_mul_f32 v[54:55], v[54:55], v[52:53] op_sel:[0,0] op_sel_hi:[1,0]
    v_mul_f32 v20, v20, v54
    v_mul_f32 v24, v24, v54
    v_fmac_f32 v20, v21, v55
    v_fmac_f32 v24, v25, v55
    s_nop 1
    v_permlane32_swap_b32 v20, v24
    v_add_f32 v20, v20, v24
    ds_write_b32 v61, v20
    s_waitcnt lgkmcnt(0)
    s_barrier
    s_cbranch_scc0 L_finb_219
    ds_read2st64_b32 v[12:13], v2 offset0:0 offset1:1
    ds_read2st64_b32 v[14:15], v2 offset0:2 offset1:3
    ds_read2st64_b32 v[16:17], v2 offset0:4 offset1:5
    ds_read2st64_b32 v[18:19], v2 offset0:6 offset1:7
    s_waitcnt lgkmcnt(2)
    v_pk_add_f32 v[12:13], v[12:13], v[14:15]
    s_waitcnt lgkmcnt(0)
    v_pk_add_f32 v[16:17], v[16:17], v[18:19]
    v_pk_add_f32 v[12:13], v[12:13], v[16:17]
    v_add_f32 v14, v12, v13
    v_add_f32 v15, v12, v13
    s_nop 1
    v_permlane16_swap_b32 v14, v15
    v_add_f32 v12, v14, v15
    v_min_u32 v12, -2, v12
    buffer_store_dword v12, v3, s[40:43], s58 offen sc1
L_finb_219:
    s_sub_u32 s57, s30, 4
    s_cmp_lt_u32 s57, 3
    s_cbranch_scc0 L_skip_220
    s_sub_u32 s60, s30, 4
    s_lshl_b32 s57, s60, 10
    v_lshlrev_b32 v11, 4, v0
    v_add_u32 v11, s57, v11
    s_add_u32 s65, s62, 16384
    buffer_load_dwordx4 v[16:19], v11, s[40:43], s65 offen sc1
    s_lshl_b32 s59, s60, 12
    s_add_u32 s59, s59, 79872
    v_lshrrev_b32 v35, 4, v0
    v_lshlrev_b32 v35, 9, v35
    v_bfe_u32 v60, v0, 2, 2
    v_lshl_add_u32 v35, v60, 6, v35
    v_and_b32 v60, 3, v0
    v_lshl_add_u32 v35, v60, 3, v35
    v_add_u32 v35, s59, v35
    v_mov_b64 v[52:53], 0
    v_mov_b64 v[54:55], 0
    v_mov_b64 v[56:57], 0
    v_mov_b64 v[58:59], 0
    v_mov_b32 v9, 0xbdd2d3e8
    v_mov_b32 v10, 0xc0135761
    v_mov_b32 v5, 0x3f803f80
    v_mov_b32 v61, 0x3acccccd
    v_mov_b32 v62, 0x3727c5ac
    s_lshl_b32 s57, s60, 7
    s_add_u32 s57, s57, 160256
    v_lshlrev_b32 v32, 3, v0
    v_add_u32 v32, s57, v32
    v_lshlrev_b32 v33, 3, v0
    v_add_u32 v33, 129024, v33
    v_cmp_gt_u32 vcc, 16, v0
    s_nop 1
    v_cndmask_b32 v32, v33, v32, vcc
    v_and_b32 v33, 15, v0
    v_lshlrev_b32 v33, 3, v33
L_pad11:
    s_cbranch_execz L_pad15
    v_lshrrev_b32 v60, 5, v0
    v_lshl_add_u32 v33, v60, 2, v33
    v_add_u32 v33, 160256, v33
    v_and_b32 v34, 15, v0
    v_lshlrev_b32 v34, 2, v34
    v_lshrrev_b32 v60, 5, v0
    v_lshl_add_u32 v34, v60, 6, v34
    v_bfe_u32 v60, v0, 4, 1
    v_lshl_add_u32 v34, v60, 13, v34
    s_add_u32 s60, s6, 393216
    s_add_u32 s58, s62, 33792
    s_add_u32 s57, s62, 19840
    v_and_b32 v7, 7, v0
    v_lshlrev_b32 v7, 3, v7
    s_waitcnt vmcnt(0)
    buffer_load_dwordx2 v[24:25], v7, s[40:43], s57 offen sc1
    buffer_load_dwordx4 v[12:15], v11, s[40:43], s58 offen sc1
    ds_read_b64_tr_b16 v[36:37], v35 offset:0
    ds_read_b64_tr_b16 v[38:39], v35 offset:256
    ds_read_b64_tr_b16 v[40:41], v35 offset:2048
    ds_read_b64_tr_b16 v[42:43], v35 offset:2304
    ds_read_b64_tr_b16 v[44:45], v35 offset:32
    ds_read_b64_tr_b16 v[46:47], v35 offset:288
    ds_read_b64_tr_b16 v[48:49], v35 offset:2080
    ds_read_b64_tr_b16 v[50:51], v35 offset:2336
L_sw_223:
    v_pk_max_u16 v20, v16, v17
    v_pk_max_u16 v21, v18, v19
    v_pk_max_u16 v20, v20, v21
    v_lshlrev_b32 v21, 16, v20
    v_max_u32 v20, v20, v21
    v_cmp_le_u32 vcc, 0xffff0000, v20
    s_cbranch_vccnz L_sr_224
    v_dot2_f32_bf16 v26, v16, v5, 0
    v_dot2_f32_bf16 v27, v17, v5, 0
    v_dot2_f32_bf16 v26, v18, v5, v26
    v_dot2_f32_bf16 v27, v19, v5, v27
    s_nop 2
    v_add_f32 v26, v26, v27
    s_waitcnt lgkmcnt(0)
L_pr_222:
    buffer_load_dwordx2 v[24:25], v7, s[40:43], s57 offen sc1
    buffer_load_dwordx4 v[12:15], v11, s[40:43], s58 offen sc1
    s_sub_u32 s56, s56, 1
    s_cbranch_scc1 L_done
L_pw_221:
    s_waitcnt vmcnt(2)
    v_max_u32 v20, v24, v25
    v_cmp_eq_u32 vcc, -1, v20
    s_cbranch_vccnz L_pr_222
    buffer_load_dwordx4 v[12:15], v11, s[40:43], s58 offen sc1
    v_add_f32_dpp v2, v24, v24 row_ror:4 row_mask:0xf bank_mask:0xf
    v_add_f32_dpp v3, v25, v25 row_ror:4 row_mask:0xf bank_mask:0xf
    v_dot2_f32_bf16 v20, v12, v5, 0
    v_dot2_f32_bf16 v21, v13, v5, 0
    v_add_f32_dpp v2, v2, v2 row_ror:2 row_mask:0xf bank_mask:0xf
    v_add_f32_dpp v3, v3, v3 row_ror:2 row_mask:0xf bank_mask:0xf
    v_dot2_f32_bf16 v20, v14, v5, v20
    v_dot2_f32_bf16 v21, v15, v5, v21
    v_add_f32_dpp v2, v2, v2 row_ror:1 row_mask:0xf bank_mask:0xf
    v_add_f32_dpp v3, v3, v3 row_ror:1 row_mask:0xf bank_mask:0xf
    v_mul_f32 v2, v2, v61
    v_fma_f32 v3, v3, v61, v62
    v_add_f32 v20, v20, v21
    v_fma_f32 v3, -v2, v2, v3
    v_mul_f32 v26, v26, v2
    v_max_f32 v3, v3, v62
    v_cmp_u_f32 vcc, v20, v20
    v_rsq_f32 v3, v3
    v_sub_f32 v20, v20, v26
    s_cbranch_vccnz L_hr_226
L_hk_227:
    v_fma_f32 v20, v20, v3, v4
    v_mul_f32 v21, v20, v20
    v_fma_f32 v21, v21, v9, v10
    v_mul_f32 v21, v21, v20
    v_exp_f32 v21, v21
    s_nop 0
    v_add_f32 v21, 1.0, v21
    v_rcp_f32 v21, v21
    s_nop 0
    v_mul_f32 v20, v20, v21
    s_nop 1
    v_mov_b32_dpp v21, v20 row_shl:1 row_mask:0xf bank_mask:0xf bound_ctrl:0
    v_cvt_pk_bf16_f32 v28, v20, v21
    s_nop 1
L_pad12:
    s_cbranch_execz L_pad16
    v_mov_b32_dpp v29, v28 row_shl:4 row_mask:0xf bank_mask:0xf bound_ctrl:0
    v_mov_b32_dpp v30, v28 row_shl:8 row_mask:0xf bank_mask:0xf bound_ctrl:0
    v_mov_b32_dpp v31, v28 row_shl:12 row_mask:0xf bank_mask:0xf bound_ctrl:0
    s_nop 1
    v_smfmac_f32_16x16x64_bf16 v[52:55], v[28:31], v[36:43], v1
    v_smfmac_f32_16x16x64_bf16 v[56:59], v[28:31], v[44:51], v1
    s_cmp_eq_u32 s30, 4
    s_nop 5
    v_add_f32 v22, v52, v54
    v_add_f32 v23, v56, v58
    ds_write_b64 v32, v[22:23]
    s_cbranch_scc0 L_skip_229
L_xw_230:
    ds_read2_b32 v[20:21], v33 offset0:0 offset1:32
    ds_read_b32 v22, v33 offset:256
    s_sub_u32 s56, s56, 1
    s_cbranch_scc1 L_done
    s_waitcnt lgkmcnt(0)
    v_max3_u32 v23, v20, v21, v22
    v_add_f32 v20, v20, v21
    v_cmp_eq_u32 vcc, -1, v23
    v_add_f32 v20, v20, v22
    s_cbranch_vccnz L_xw_230
    v_min_u32 v20, -2, v20
    buffer_store_dword v20, v34, s[40:43], s60 offen sc1
L_skip_229:
L_skip_220:
    s_branch L_done
L_typeB_1:
    s_cmp_eq_u32 s53, 3
    s_cbranch_scc0 L_typeC_231
    s_cmp_eq_u32 s30, 7
    s_cbranch_scc1 L_w7_236
    s_cmp_lt_u32 s30, 6
    s_cbranch_scc0 L_skip_238
    s_lshr_b32 s57, s30, 1
    s_mul_i32 s57, s57, 128
    s_and_b32 s58, s30, 1
    s_lshl_b32 s58, s58, 6
    s_add_u32 s57, s57, s58
    v_lshrrev_b32 v18, 5, v0
    v_lshlrev_b32 v18, 13, v18
    v_bfe_u32 v60, v0, 3, 1
    v_lshl_add_u32 v18, v60, 12, v18
    v_bfe_u32 v60, v0, 4, 1
    v_lshl_add_u32 v18, v60, 11, v18
    v_bfe_u32 v60, v0, 2, 1
    v_mul_u32_u24 v60, 384, v60
    v_add_u32 v18, v60, v18
    v_and_b32 v60, 3, v0
    v_lshl_add_u32 v18, v60, 3, v18
    v_add_u32 v18, s57, v18
    v_add_u32 v18, 30720, v18
    v_bfe_u32 v19, v0, 4, 1
    v_lshlrev_b32 v19, 12, v19
    v_bfe_u32 v60, v0, 3, 1
    v_lshl_add_u32 v19, v60, 11, v19
    v_bfe_u32 v60, v0, 2, 1
    v_mul_u32_u24 v60, 384, v60
    v_add_u32 v19, v60, v19
    v_and_b32 v60, 3, v0
    v_lshl_add_u32 v19, v60, 3, v19
    v_add_u32 v19, s57, v19
    v_add_u32 v19, 63488, v19
    ds_read_b64_tr_b16 v[28:29], v18 offset:0
    ds_read_b64_tr_b16 v[30:31], v18 offset:1024
    ds_read_b64_tr_b16 v[32:33], v18 offset:16384
    ds_read_b64_tr_b16 v[34:35], v18 offset:17408
    ds_read_b64_tr_b16 v[36:37], v19 offset:0
    ds_read_b64_tr_b16 v[38:39], v19 offset:1024
    ds_read_b64_tr_b16 v[40:41], v18 offset:32
    ds_read_b64_tr_b16 v[42:43], v18 offset:1056
    ds_read_b64_tr_b16 v[44:45], v18 offset:16416
    ds_read_b64_tr_b16 v[46:47], v18 offset:17440
    ds_read_b64_tr_b16 v[48:49], v19 offset:32
    ds_read_b64_tr_b16 v[50:51], v19 offset:1056
    v_lshrrev_b32 v9, 4, v0
    v_lshlrev_b32 v9, 5, v9
    v_bfe_u32 v60, v0, 1, 1
    v_lshl_add_u32 v9, v60, 4, v9
    v_and_b32 v60, 1, v0
    v_mul_u32_u24 v60, 192, v60
    v_add_u32 v9, v60, v9
    v_add_u32 v9, 160832, v9
    v_lshrrev_b32 v10, 4, v0
    v_lshlrev_b32 v10, 4, v10
    v_bfe_u32 v60, v0, 1, 1
    v_lshl_add_u32 v10, v60, 3, v10
L_pad13:
    s_cbranch_execz L_pad17
    v_and_b32 v60, 1, v0
    v_mul_u32_u24 v60, 192, v60
    v_add_u32 v10, v60, v10
    v_add_u32 v10, 160960, v10
    v_mov_b64 v[20:21], 0
    v_mov_b64 v[22:23], 0
    v_mov_b64 v[24:25], 0
    v_mov_b64 v[26:27], 0
    s_lshl_b32 s57, s54, 1
    s_lshl_b32 s58, s30, 9
    s_add_u32 s57, s57, s58
    v_and_b32 v11, 31, v0
    v_lshlrev_b32 v11, 4, v11
    v_lshrrev_b32 v60, 5, v0
    v_lshl_add_u32 v11, v60, 30, v11
    v_add_u32 v11, s57, v11
    s_add_u32 s59, s62, 33792
    s_add_u32 s60, s62, 19840
L_skip_238:
    s_cmp_lt_u32 s30, 6
    s_barrier
    s_cbranch_scc0 L_se_237
    ds_read_b128 v[12:15], v9
    ds_read_b64 v[16:17], v10
    s_waitcnt lgkmcnt(1)
    v_smfmac_f32_16x16x64_bf16 v[20:23], v[12:15], v[28:35], v1
    v_smfmac_f32_16x16x64_bf16 v[24:27], v[12:15], v[40:47], v1
    s_waitcnt lgkmcnt(0)
    v_smfmac_f32_16x16x32_bf16 v[20:23], v[16:17], v[36:39], v1
    v_smfmac_f32_16x16x32_bf16 v[24:27], v[16:17], v[48:51], v1
    s_cmp_eq_u32 s55, 0
    s_nop 5
    v_add_f32 v12, v20, v22
    s_nop 1
    v_add_f32_dpp v12, v24, v26 quad_perm:[0,1,2,3] row_mask:0x2 bank_mask:0xf
    v_cvt_pk_bf16_f32 v12, v12, v12
    v_min_u32 v12, -2, v12
    s_cbranch_scc1 L_gs_239
    buffer_store_short v12, v11, s[40:43], s59 offen
L_gb_240:
L_se_237:
    s_cmp_eq_u32 s30, 7
    s_cbranch_scc0 L_done
    s_cmp_eq_u32 s31, 0
    s_cbranch_scc0 L_done
    v_lshlrev_b32 v60, 16, v4
    v_add_f32 v2, v2, v60
    v_and_b32 v60, 0xffff0000, v4
    v_add_f32 v3, v3, v60
    v_and_b32 v60, 31, v0
    v_min_u32 v60, 19, v60
    s_mul_i32 s57, s54, 160
    v_lshrrev_b32 v7, 5, v0
    v_lshlrev_b32 v7, 2, v7
    v_add_u32 v7, s57, v7
    v_lshl_add_u32 v7, v60, 3, v7
    s_add_u32 s57, s7, 393216
    s_add_u32 s58, s7, 425984
    s_add_u32 s59, s7, 458752
    s_add_u32 s60, s7, 491520
    s_add_u32 s75, s7, 7180
    v_and_b32 v9, 7, v0
    v_lshlrev_b32 v9, 15, v9
    buffer_load_dword v12, v9, s[40:43], s75 offen sc1
    s_sleep 2
L_pr_252:
    buffer_load_dword v12, v9, s[40:43], s75 offen sc1
    s_sub_u32 s56, s56, 1
    s_cbranch_scc1 L_done
L_pw_251:
    s_waitcnt vmcnt(1)
    v_cmp_eq_u32 vcc, -1, v12
    s_cbranch_vccnz L_pr_252
    s_sleep 3
    buffer_load_dwordx4 v[12:15], v5, s[40:43], s57 offen sc1
    buffer_load_dwordx4 v[16:19], v5, s[40:43], s58 offen sc1
    buffer_load_dwordx4 v[20:23], v5, s[40:43], s59 offen sc1
    buffer_load_dwordx4 v[24:27], v5, s[40:43], s60 offen sc1
    s_sleep 2
L_gw_248:
    buffer_load_dwordx4 v[12:15], v5, s[40:43], s57 offen sc1
    buffer_load_dwordx4 v[16:19], v5, s[40:43], s58 offen sc1
    buffer_load_dwordx4 v[20:23], v5, s[40:43], s59 offen sc1
    buffer_load_dwordx4 v[24:27], v5, s[40:43], s60 offen sc1
    s_sub_u32 s56, s56, 1
    s_cbranch_scc1 L_done
    s_and_b32 s74, s56, 31
    s_waitcnt vmcnt(6)
    v_pk_add_f32 v[28:29], v[12:13], v[16:17]
    v_pk_add_f32 v[30:31], v[14:15], v[18:19]
    s_waitcnt vmcnt(5)
    v_pk_add_f32 v[28:29], v[28:29], v[20:21]
    v_pk_add_f32 v[30:31], v[30:31], v[22:23]
    s_waitcnt vmcnt(4)
    v_pk_add_f32 v[28:29], v[28:29], v[24:25]
L_pad14:
    s_cbranch_execz L_pad18
    v_pk_add_f32 v[30:31], v[30:31], v[26:27]
    v_pk_add_f32 v[32:33], v[28:29], v[30:31]
    v_cmp_u_f32 vcc, v32, v33
    v_permlane32_swap_b32 v28, v30
    v_permlane32_swap_b32 v29, v31
    s_cbranch_vccnz L_gr_249
L_gk_250:
    v_pk_add_f32 v[28:29], v[28:29], v[30:31]
    v_pk_add_f32 v[28:29], v[28:29], v[2:3]
    v_cvt_pk_bf16_f32 v28, v28, v29
    global_store_dword v7, v28, s[24:25]
    s_branch L_done
L_gs_39:
    buffer_store_dword v33, v34, s[40:43], s67 offen sc1
    s_branch L_gb_40
L_gs_42:
    buffer_store_short v12, v54, s[40:43], s59 offen sc1
    s_branch L_gb_43
L_cr_57:
    s_sub_u32 s56, s56, 1
    s_cbranch_scc1 L_done
    global_load_dword v2, v3, s[26:27] sc1
    s_waitcnt vmcnt(0)
    s_branch L_cw_56
L_far_58:
    s_lshl_b32 s57, s52, 2
    s_add_u32 s57, s57, s72
    s_mov_b64 exec, 1
    buffer_store_dword v25, v0, s[40:43], s57 offen offset:128 sc1
    s_mov_b64 exec, -1
    s_branch L_fb_59
L_cr_75:
    s_sub_u32 s56, s56, 1
    s_cbranch_scc1 L_done
    buffer_load_dword v2, v24, s[40:43], s72 offen sc1
    s_branch L_cw_74
L_gs_83:
    buffer_store_dword v33, v34, s[40:43], s67 offen sc1
    s_branch L_gb_84
L_gs_86:
    buffer_store_short v12, v54, s[40:43], s59 offen sc1
    s_branch L_gb_87
L_gs_111:
    buffer_store_dword v37, v4, s[40:43], s58 offen sc1
    s_branch L_gb_112
L_cr_123:
    s_sub_u32 s56, s56, 1
    s_cbranch_scc1 L_done
    global_load_dword v2, v3, s[26:27] offset:4 sc1
    s_branch L_cw_122
L_cr_133:
    buffer_load_dword v52, v56, s[40:43], s74 offen offset:1536 sc1
    buffer_load_dwordx2 v[54:55], v62, s[40:43], s74 offen offset:1536 sc1
    s_sub_u32 s56, s56, 1
    s_cbranch_scc1 L_done
    s_branch L_cw_132
L_gs_138:
    buffer_store_dword v14, v3, s[40:43], s57 offen sc1
    s_branch L_gb_139
L_gs_140:
    buffer_store_dword v12, v4, s[40:43], s57 offen offset:32 sc1
    s_branch L_gb_141
L_comb_0:
    s_mov_b32 s57, 0
    s_cmp_eq_u32 s55, 0
    s_waitcnt lgkmcnt(0)
    s_barrier
    ds_read2st64_b64 v[12:15], v2 offset0:0 offset1:4
    ds_read2st64_b64 v[16:19], v2 offset0:8 offset1:12
    ds_read2st64_b64 v[20:23], v2 offset0:16 offset1:20
    ds_read2st64_b64 v[24:27], v2 offset0:24 offset1:28
    s_waitcnt lgkmcnt(2)
    v_pk_add_f32 v[12:13], v[12:13], v[14:15]
    v_pk_add_f32 v[16:17], v[16:17], v[18:19]
    v_pk_add_f32 v[12:13], v[12:13], v[16:17]
    s_waitcnt lgkmcnt(0)
    v_pk_add_f32 v[20:21], v[20:21], v[22:23]
    v_pk_add_f32 v[24:25], v[24:25], v[26:27]
    v_pk_add_f32 v[12:13], v[12:13], v[20:21]
    v_pk_add_f32 v[12:13], v[12:13], v[24:25]
    v_cvt_pk_bf16_f32 v14, v12, v13
    v_min_u32 v12, -2, v12
    v_min_u32 v14, -2, v14
    s_cbranch_scc1 L_gs_138
    buffer_store_dword v14, v3, s[40:43], s57 offen
L_gb_139:
    s_cbranch_scc1 L_gs_140
    buffer_store_dword v12, v4, s[40:43], s57 offen offset:32
L_gb_141:
    s_branch L_comb_0b
L_sr_150:
    buffer_load_dwordx4 v[16:19], v11, s[40:43], s65 offen sc1
    s_sub_u32 s56, s56, 1
    s_cbranch_scc1 L_done
    s_waitcnt vmcnt(0)
    s_branch L_sw_149
L_hr_152:
    buffer_load_dwordx4 v[12:15], v11, s[40:43], s58 offen sc1
    s_sub_u32 s56, s56, 1
    s_cbranch_scc1 L_done
    s_and_b32 s64, s56, 31
    s_cbranch_scc0 L_hx_154
    s_waitcnt vmcnt(1)
    v_dot2_f32_bf16 v20, v12, v5, 0
    v_dot2_f32_bf16 v21, v13, v5, 0
    v_dot2_f32_bf16 v20, v14, v5, v20
    v_dot2_f32_bf16 v21, v15, v5, v21
L_pad15:
    s_cbranch_execz L_pad19
    s_nop 2
    v_add_f32 v20, v20, v21
    v_cmp_u_f32 vcc, v20, v20
    v_sub_f32 v20, v20, v26
    s_cbranch_vccnz L_hr_152
    s_branch L_hk_153
L_hx_154:
    s_waitcnt vmcnt(0)
    v_pk_max_u16 v20, v12, v13
    v_pk_max_u16 v21, v14, v15
    v_pk_max_u16 v20, v20, v21
    v_lshlrev_b32 v21, 16, v20
    v_max_u32 v20, v20, v21
    v_cmp_le_u32 vcc, 0xffff0000, v20
    s_cbranch_vccnz L_hr_152
    v_dot2_f32_bf16 v20, v12, v5, 0
    v_dot2_f32_bf16 v21, v13, v5, 0
    v_dot2_f32_bf16 v20, v14, v5, v20
    v_dot2_f32_bf16 v21, v15, v5, v21
    s_nop 2
    v_add_f32 v20, v20, v21
    v_sub_f32 v20, v20, v26
    s_branch L_hk_153
L_gs_162:
    buffer_store_dword v0, v11, s[40:43], s58 offen sc1
    s_branch L_gb_163
L_typeC_158:
    s_cmp_eq_u32 s30, 6
    s_cbranch_scc0 L_p1
    s_cmp_eq_u32 s3, 21
    s_cbranch_scc0 L_skip_159
    v_and_b32 v11, 3, v0
    v_lshlrev_b32 v11, 7, v11
    v_lshrrev_b32 v60, 2, v0
    v_lshl_add_u32 v11, v60, 24, v11
    s_add_u32 s58, s62, 19972
    s_add_u32 s75, s7, 7172
    v_and_b32 v9, 7, v0
    v_lshlrev_b32 v9, 15, v9
    buffer_load_dword v12, v9, s[40:43], s75 offen sc1
    s_sleep 2
L_pr_161:
    buffer_load_dword v12, v9, s[40:43], s75 offen sc1
    s_sub_u32 s56, s56, 1
    s_cbranch_scc1 L_done
L_pw_160:
    s_waitcnt vmcnt(1)
    v_cmp_eq_u32 vcc, -1, v12
    s_cbranch_vccnz L_pr_161
    s_cmp_eq_u32 s55, 0
    s_cbranch_scc1 L_gs_162
    buffer_store_dword v0, v11, s[40:43], s58 offen
L_gb_163:
    s_waitcnt vmcnt(1)
    s_branch L_p1
L_skip_159:
    s_cmp_eq_u32 s3, 20
    s_cbranch_scc0 L_p1
    s_lshl_b32 s59, s31, 15
    s_add_u32 s59, s59, s8
    s_add_u32 s59, s59, 7168
    v_and_b32 v10, 1, v0
    v_lshlrev_b32 v10, 13, v10
    v_lshrrev_b32 v60, 1, v0
    v_lshl_add_u32 v10, v60, 24, v10
    s_add_u32 s58, s62, 1568
    v_lshrrev_b32 v9, 3, v0
    v_mul_u32_u24 v9, 1664, v9
    v_and_b32 v60, 7, v0
    v_lshl_add_u32 v9, v60, 2, v9
    buffer_load_dword v12, v9, s[40:43], s58 offen sc1
    s_sleep 2
L_pr_165:
    buffer_load_dword v12, v9, s[40:43], s58 offen sc1
    s_sub_u32 s56, s56, 1
    s_cbranch_scc1 L_done
L_pw_164:
    s_waitcnt vmcnt(1)
    v_cmp_eq_u32 vcc, -1, v12
    s_cbranch_vccnz L_pr_165
    buffer_store_dword v0, v10, s[40:43], s59 offen offset:0 sc1
    s_add_u32 s58, s62, 19712
    v_and_b32 v9, 15, v0
    v_lshlrev_b32 v9, 2, v9
    buffer_load_dword v13, v9, s[40:43], s58 offen sc1
    s_sleep 2
L_pr_167:
    buffer_load_dword v13, v9, s[40:43], s58 offen sc1
    s_sub_u32 s56, s56, 1
    s_cbranch_scc1 L_done
L_pw_166:
    s_waitcnt vmcnt(1)
    v_cmp_eq_u32 vcc, -1, v13
    s_cbranch_vccnz L_pr_167
    buffer_store_dword v0, v10, s[40:43], s59 offen offset:4 sc1
    s_waitcnt vmcnt(1)
    s_branch L_p1
L_gs_171:
    buffer_store_short v12, v11, s[40:43], s60 offen sc1
    s_branch L_gb_172
L_gs_173:
    buffer_store_short v12, v11, s[40:43], s59 offen sc1
    s_branch L_gb_174
L_gr_176:
    s_cbranch_scc1 L_gw_175
    s_waitcnt vmcnt(0)
    v_max3_u32 v32, v12, v13, v14
    v_max3_u32 v32, v32, v15, v16
    v_max3_u32 v32, v32, v17, v18
L_pad16:
    s_cbranch_execz L_pad20
    v_max3_u32 v32, v32, v19, v20
    v_max3_u32 v32, v32, v21, v22
    v_max3_u32 v32, v32, v23, v24
    v_max3_u32 v32, v32, v25, v26
    v_max_u32 v32, v32, v27
    v_cmp_eq_u32 vcc, -1, v32
    s_cbranch_vccnz L_gw_175
    v_pk_add_f32 v[28:29], v[12:13], v[16:17]
    v_pk_add_f32 v[30:31], v[14:15], v[18:19]
    v_pk_add_f32 v[28:29], v[28:29], v[20:21]
    v_pk_add_f32 v[30:31], v[30:31], v[22:23]
    v_pk_add_f32 v[28:29], v[28:29], v[24:25]
    v_pk_add_f32 v[30:31], v[30:31], v[26:27]
    s_nop 1
    v_permlane32_swap_b32 v28, v30
    v_permlane32_swap_b32 v29, v31
    s_branch L_gk_177
L_gs_180:
    buffer_store_dword v33, v34, s[40:43], s67 offen sc1
    s_branch L_gb_181
L_w7_168:
    v_and_b32 v60, 31, v0
    v_min_u32 v60, 19, v60
    s_mul_i32 s57, s54, 320
    v_lshrrev_b32 v5, 5, v0
    v_mul_u32_u24 v5, 2560, v5
    v_add_u32 v5, s57, v5
    v_lshl_add_u32 v5, v60, 4, v5
    v_and_b32 v60, 31, v0
    v_cmp_gt_u32 s[64:65], 20, v60
    v_min_u32 v60, 19, v60
    v_lshrrev_b32 v35, 5, v0
    v_lshlrev_b32 v35, 2, v35
    v_add_u32 v35, 160832, v35
    v_lshl_add_u32 v35, v60, 3, v35
    s_add_u32 s66, s62, 13312
    s_add_u32 s67, s62, 19712
    s_lshl_b32 s57, s54, 3
    v_lshrrev_b32 v34, 5, v0
    v_lshlrev_b32 v34, 2, v34
    v_add_u32 v34, s57, v34
    v_and_b32 v60, 31, v0
    v_mov_b32 v61, 0x7f000000
    v_cmp_ne_u32 vcc, 31, v60
    s_nop 1
    v_cndmask_b32 v34, v34, v61, vcc
    v_mov_b32 v61, 0x3f803f80
    s_add_u32 s57, s7, 0
    s_add_u32 s58, s7, 32768
    s_add_u32 s59, s7, 65536
    s_add_u32 s60, s7, 98304
    s_add_u32 s75, s7, 7168
    v_and_b32 v9, 7, v0
    v_lshlrev_b32 v9, 15, v9
    buffer_load_dword v12, v9, s[40:43], s75 offen sc1
    s_sleep 2
L_pr_179:
    buffer_load_dword v12, v9, s[40:43], s75 offen sc1
    s_sub_u32 s56, s56, 1
    s_cbranch_scc1 L_done
L_pw_178:
    s_waitcnt vmcnt(1)
    v_cmp_eq_u32 vcc, -1, v12
    s_cbranch_vccnz L_pr_179
    s_sleep 2
    buffer_load_dwordx4 v[12:15], v5, s[40:43], s57 offen sc1
    buffer_load_dwordx4 v[16:19], v5, s[40:43], s58 offen sc1
    buffer_load_dwordx4 v[20:23], v5, s[40:43], s59 offen sc1
    buffer_load_dwordx4 v[24:27], v5, s[40:43], s60 offen sc1
    s_sleep 2
L_gw_175:
    buffer_load_dwordx4 v[12:15], v5, s[40:43], s57 offen sc1
    buffer_load_dwordx4 v[16:19], v5, s[40:43], s58 offen sc1
    buffer_load_dwordx4 v[20:23], v5, s[40:43], s59 offen sc1
    buffer_load_dwordx4 v[24:27], v5, s[40:43], s60 offen sc1
    s_sub_u32 s56, s56, 1
    s_cbranch_scc1 L_done
    s_and_b32 s74, s56, 31
    s_waitcnt vmcnt(6)
    v_pk_add_f32 v[28:29], v[12:13], v[16:17]
    v_pk_add_f32 v[30:31], v[14:15], v[18:19]
    s_waitcnt vmcnt(5)
    v_pk_add_f32 v[28:29], v[28:29], v[20:21]
    v_pk_add_f32 v[30:31], v[30:31], v[22:23]
    s_waitcnt vmcnt(4)
    v_pk_add_f32 v[28:29], v[28:29], v[24:25]
    v_pk_add_f32 v[30:31], v[30:31], v[26:27]
    v_pk_add_f32 v[32:33], v[28:29], v[30:31]
    v_cmp_u_f32 vcc, v32, v33
L_pad17:
    s_cbranch_execz L_pad21
    v_permlane32_swap_b32 v28, v30
    v_permlane32_swap_b32 v29, v31
    s_cbranch_vccnz L_gr_176
L_gk_177:
    v_pk_add_f32 v[28:29], v[28:29], v[30:31]
    v_pk_add_f32 v[28:29], v[28:29], v[2:3]
    v_cvt_pk_bf16_f32 v28, v28, v29
    ds_write_b32 v35, v28
    s_waitcnt lgkmcnt(0)
    s_barrier
    v_cndmask_b32 v29, 0, v28, s[64:65]
    v_dot2_f32_bf16 v33, v29, v61, 0
    v_dot2_f32_bf16 v32, v29, v29, 0
    v_lshlrev_b32 v2, 16, v28
    v_and_b32 v3, 0xffff0000, v28
    s_cmp_eq_u32 s55, 0
    v_permlane32_swap_b32 v33, v32
    v_add_f32 v33, v33, v32
    s_nop 1
    v_add_f32_dpp v33, v33, v33 row_ror:8 row_mask:0xf bank_mask:0xf
    s_nop 1
    v_add_f32_dpp v33, v33, v33 row_ror:4 row_mask:0xf bank_mask:0xf
    s_nop 1
    v_add_f32_dpp v33, v33, v33 row_ror:2 row_mask:0xf bank_mask:0xf
    s_nop 1
    v_add_f32_dpp v33, v33, v33 row_ror:1 row_mask:0xf bank_mask:0xf
    s_nop 1
    v_add_f32_dpp v33, v33, v33 row_bcast:15 row_mask:0xa bank_mask:0xf
    v_min_u32 v33, -2, v33
    s_cbranch_scc1 L_gs_180
    buffer_store_dword v33, v34, s[40:43], s67 offen
L_gb_181:
    s_waitcnt vmcnt(1)
    s_branch L_se_169
L_gs_185:
    buffer_store_short v12, v11, s[40:43], s59 offen sc1
    s_branch L_gb_186
L_gr_191:
    s_cbranch_scc1 L_gw_190
    s_waitcnt vmcnt(0)
    v_max3_u32 v32, v12, v13, v14
    v_max3_u32 v32, v32, v15, v16
    v_max3_u32 v32, v32, v17, v18
    v_max3_u32 v32, v32, v19, v20
    v_max3_u32 v32, v32, v21, v22
    v_max3_u32 v32, v32, v23, v24
    v_max3_u32 v32, v32, v25, v26
    v_max_u32 v32, v32, v27
    v_cmp_eq_u32 vcc, -1, v32
    s_cbranch_vccnz L_gw_190
    v_pk_add_f32 v[28:29], v[12:13], v[16:17]
    v_pk_add_f32 v[30:31], v[14:15], v[18:19]
    v_pk_add_f32 v[28:29], v[28:29], v[20:21]
    v_pk_add_f32 v[30:31], v[30:31], v[22:23]
    v_pk_add_f32 v[28:29], v[28:29], v[24:25]
    v_pk_add_f32 v[30:31], v[30:31], v[26:27]
    s_nop 1
    v_permlane32_swap_b32 v28, v30
    v_permlane32_swap_b32 v29, v31
    s_branch L_gk_192
L_gr_194:
    s_cbranch_scc1 L_gw_193
    s_waitcnt vmcnt(0)
    v_max3_u32 v32, v12, v13, v14
    v_max3_u32 v32, v32, v15, v16
    v_max3_u32 v32, v32, v17, v18
    v_max3_u32 v32, v32, v19, v20
    v_max3_u32 v32, v32, v21, v22
    v_max3_u32 v32, v32, v23, v24
    v_max3_u32 v32, v32, v25, v26
    v_max_u32 v32, v32, v27
    v_cmp_eq_u32 vcc, -1, v32
    s_cbranch_vccnz L_gw_193
    v_pk_add_f32 v[28:29], v[12:13], v[16:17]
    v_pk_add_f32 v[30:31], v[14:15], v[18:19]
    v_pk_add_f32 v[28:29], v[28:29], v[20:21]
    v_pk_add_f32 v[30:31], v[30:31], v[22:23]
    v_pk_add_f32 v[28:29], v[28:29], v[24:25]
    v_pk_add_f32 v[30:31], v[30:31], v[26:27]
    s_nop 1
    v_permlane32_swap_b32 v28, v30
    v_permlane32_swap_b32 v29, v31
    s_branch L_gk_195
L_gs_198:
    buffer_store_dword v33, v34, s[40:43], s67 offen sc1
    s_branch L_gb_199
L_w7_182:
    v_and_b32 v60, 31, v0
    v_min_u32 v60, 19, v60
    s_mul_i32 s57, s54, 320
    v_lshrrev_b32 v5, 5, v0
L_pad18:
    s_cbranch_execz L_pad22
    v_mul_u32_u24 v5, 2560, v5
    v_add_u32 v5, s57, v5
    v_lshl_add_u32 v5, v60, 4, v5
    v_and_b32 v60, 31, v0
    v_cmp_gt_u32 s[64:65], 20, v60
    v_min_u32 v60, 19, v60
    v_lshrrev_b32 v35, 5, v0
    v_lshlrev_b32 v35, 2, v35
    v_add_u32 v35, 160832, v35
    v_lshl_add_u32 v35, v60, 3, v35
    s_mul_i32 s66, s53, 3072
    s_add_u32 s66, s66, s62
    s_add_u32 s66, s66, 36864
    s_lshl_b32 s67, s53, 6
    s_add_u32 s67, s67, s62
    s_add_u32 s67, s67, 19456
    s_lshl_b32 s57, s54, 3
    v_lshrrev_b32 v34, 5, v0
    v_lshlrev_b32 v34, 2, v34
    v_add_u32 v34, s57, v34
    v_and_b32 v60, 31, v0
    v_mov_b32 v61, 0x7f000000
    v_cmp_ne_u32 vcc, 31, v60
    s_nop 1
    v_cndmask_b32 v34, v34, v61, vcc
    v_mov_b32 v61, 0x3f803f80
    s_cmp_lg_u32 s53, 3
    s_cbranch_scc0 L_skip_187
    s_add_u32 s57, s62, 19712
    v_mov_b32 v9, 0
L_pr_189:
    buffer_load_dword v12, v9, s[40:43], s57 offen sc1
    s_sub_u32 s56, s56, 1
    s_cbranch_scc1 L_done
L_pw_188:
    s_waitcnt vmcnt(0)
    v_cmp_eq_u32 vcc, -1, v12
    s_cbranch_vccnz L_pr_189
    s_add_u32 s57, s7, 0
    s_add_u32 s58, s7, 32768
    s_add_u32 s59, s7, 65536
    s_add_u32 s60, s7, 98304
L_gw_190:
    buffer_load_dwordx4 v[12:15], v5, s[40:43], s57 offen sc1
    buffer_load_dwordx4 v[16:19], v5, s[40:43], s58 offen sc1
    buffer_load_dwordx4 v[20:23], v5, s[40:43], s59 offen sc1
    buffer_load_dwordx4 v[24:27], v5, s[40:43], s60 offen sc1
    s_sub_u32 s56, s56, 1
    s_cbranch_scc1 L_done
    s_and_b32 s74, s56, 31
    s_waitcnt vmcnt(2)
    v_pk_add_f32 v[28:29], v[12:13], v[16:17]
    v_pk_add_f32 v[30:31], v[14:15], v[18:19]
    s_waitcnt vmcnt(1)
    v_pk_add_f32 v[28:29], v[28:29], v[20:21]
    v_pk_add_f32 v[30:31], v[30:31], v[22:23]
    s_waitcnt vmcnt(0)
    v_pk_add_f32 v[28:29], v[28:29], v[24:25]
    v_pk_add_f32 v[30:31], v[30:31], v[26:27]
    v_pk_add_f32 v[32:33], v[28:29], v[30:31]
    v_cmp_u_f32 vcc, v32, v33
    v_permlane32_swap_b32 v28, v30
    v_permlane32_swap_b32 v29, v31
    s_cbranch_vccnz L_gr_191
L_gk_192:
    v_pk_add_f32 v[28:29], v[28:29], v[30:31]
    v_pk_add_f32 v[28:29], v[28:29], v[2:3]
    v_cvt_pk_bf16_f32 v28, v28, v29
    v_lshlrev_b32 v2, 16, v28
    v_and_b32 v3, 0xffff0000, v28
L_skip_187:
    v_lshlrev_b32 v60, 16, v4
    v_add_f32 v2, v2, v60
    v_and_b32 v60, 0xffff0000, v4
    v_add_f32 v3, v3, v60
    s_add_u32 s57, s7, 131072
    s_add_u32 s58, s7, 163840
    s_add_u32 s59, s7, 196608
    s_add_u32 s60, s7, 229376
    s_lshl_b32 s74, s53, 7
    s_add_u32 s75, s62, s74
    s_add_u32 s75, s75, 19972
    v_mov_b32 v9, 0
    buffer_load_dword v12, v9, s[40:43], s75 offen sc1
    s_sleep 2
L_pr_197:
    buffer_load_dword v12, v9, s[40:43], s75 offen sc1
    s_sub_u32 s56, s56, 1
    s_cbranch_scc1 L_done
L_pw_196:
    s_waitcnt vmcnt(1)
    v_cmp_eq_u32 vcc, -1, v12
    s_cbranch_vccnz L_pr_197
    buffer_load_dwordx4 v[12:15], v5, s[40:43], s57 offen sc1
    buffer_load_dwordx4 v[16:19], v5, s[40:43], s58 offen sc1
L_pad19:
    s_cbranch_execz L_pad23
    buffer_load_dwordx4 v[20:23], v5, s[40:43], s59 offen sc1
    buffer_load_dwordx4 v[24:27], v5, s[40:43], s60 offen sc1
    s_sleep 2
L_gw_193:
    buffer_load_dwordx4 v[12:15], v5, s[40:43], s57 offen sc1
    buffer_load_dwordx4 v[16:19], v5, s[40:43], s58 offen sc1
    buffer_load_dwordx4 v[20:23], v5, s[40:43], s59 offen sc1
    buffer_load_dwordx4 v[24:27], v5, s[40:43], s60 offen sc1
    s_sub_u32 s56, s56, 1
    s_cbranch_scc1 L_done
    s_and_b32 s74, s56, 31
    s_waitcnt vmcnt(6)
    v_pk_add_f32 v[28:29], v[12:13], v[16:17]
    v_pk_add_f32 v[30:31], v[14:15], v[18:19]
    s_waitcnt vmcnt(5)
    v_pk_add_f32 v[28:29], v[28:29], v[20:21]
    v_pk_add_f32 v[30:31], v[30:31], v[22:23]
    s_waitcnt vmcnt(4)
    v_pk_add_f32 v[28:29], v[28:29], v[24:25]
    v_pk_add_f32 v[30:31], v[30:31], v[26:27]
    v_pk_add_f32 v[32:33], v[28:29], v[30:31]
    v_cmp_u_f32 vcc, v32, v33
    v_permlane32_swap_b32 v28, v30
    v_permlane32_swap_b32 v29, v31
    s_cbranch_vccnz L_gr_194
L_gk_195:
    v_pk_add_f32 v[28:29], v[28:29], v[30:31]
    v_pk_add_f32 v[28:29], v[28:29], v[2:3]
    v_cvt_pk_bf16_f32 v28, v28, v29
    ds_write_b32 v35, v28
    s_waitcnt lgkmcnt(0)
    s_barrier
    v_cndmask_b32 v29, 0, v28, s[64:65]
    v_dot2_f32_bf16 v33, v29, v61, 0
    v_dot2_f32_bf16 v32, v29, v29, 0
    v_lshlrev_b32 v2, 16, v28
    v_and_b32 v3, 0xffff0000, v28
    s_cmp_eq_u32 s55, 0
    v_permlane32_swap_b32 v33, v32
    v_add_f32 v33, v33, v32
    s_nop 1
    v_add_f32_dpp v33, v33, v33 row_ror:8 row_mask:0xf bank_mask:0xf
    s_nop 1
    v_add_f32_dpp v33, v33, v33 row_ror:4 row_mask:0xf bank_mask:0xf
    s_nop 1
    v_add_f32_dpp v33, v33, v33 row_ror:2 row_mask:0xf bank_mask:0xf
    s_nop 1
    v_add_f32_dpp v33, v33, v33 row_ror:1 row_mask:0xf bank_mask:0xf
    s_nop 1
    v_add_f32_dpp v33, v33, v33 row_bcast:15 row_mask:0xa bank_mask:0xf
    v_min_u32 v33, -2, v33
    s_cbranch_scc1 L_gs_198
    buffer_store_dword v33, v34, s[40:43], s67 offen
L_gb_199:
    s_waitcnt vmcnt(1)
    s_branch L_se_183
L_qr_203:
    s_cbranch_scc1 L_qw_202
    s_waitcnt vmcnt(0)
    v_pk_max_u16 v60, v48, v49
    v_pk_max_u16 v61, v50, v51
    v_pk_max_u16 v60, v60, v61
    v_lshlrev_b32 v61, 16, v60
    v_max_u32 v60, v60, v61
    v_cmp_le_u32 vcc, 0xffff0000, v60
    s_cbranch_vccnz L_qw_202
    v_dot2_f32_bf16 v60, v48, v10, 0
    v_dot2_f32_bf16 v61, v49, v10, 0
    v_dot2_f32_bf16 v60, v50, v10, v60
    v_dot2_f32_bf16 v61, v51, v10, v61
    s_nop 2
    v_add_f32 v60, v60, v61
    v_cvt_pk_bf16_f32 v60, v60, v60
    s_branch L_qk_204
L_qo_200:
    v_mov_b64 v[24:25], 0
    v_mov_b64 v[26:27], 0
    v_mov_b64 v[28:29], 0
    v_mov_b64 v[30:31], 0
    v_mov_b64 v[32:33], 0
    v_mov_b64 v[34:35], 0
    v_mov_b64 v[36:37], 0
    v_mov_b64 v[38:39], 0
    v_mov_b64 v[40:41], 0
    v_mov_b64 v[42:43], 0
    v_mov_b64 v[44:45], 0
    v_mov_b64 v[46:47], 0
    v_lshrrev_b32 v5, 4, v0
    v_lshlrev_b32 v5, 5, v5
    v_bfe_u32 v60, v0, 1, 1
    v_lshl_add_u32 v5, v60, 4, v5
    v_add_u32 v5, 124928, v5
L_pad20:
    s_cbranch_execz L_padback
    s_cmp_eq_u32 s30, 6
    s_cbranch_scc0 L_qb_201
    s_mul_i32 s59, s53, 3072
    s_add_u32 s59, s59, s62
    s_add_u32 s59, s59, 36864
    s_lshl_b32 s60, s53, 6
    s_add_u32 s60, s60, s62
    s_add_u32 s60, s60, 19456
    v_and_b32 v16, 7, v0
    v_lshlrev_b32 v16, 3, v16
L_pr_206:
    buffer_load_dwordx2 v[10:11], v16, s[40:43], s60 offen sc1
    s_sub_u32 s56, s56, 1
    s_cbranch_scc1 L_done
L_pw_205:
    s_waitcnt vmcnt(0)
    v_max_u32 v18, v10, v11
    v_cmp_eq_u32 vcc, -1, v18
    s_cbranch_vccnz L_pr_206
    v_add_f32_dpp v10, v10, v10 row_ror:4 row_mask:0xf bank_mask:0xf
    v_add_f32_dpp v11, v11, v11 row_ror:4 row_mask:0xf bank_mask:0xf
    s_nop 0
    v_add_f32_dpp v10, v10, v10 row_ror:2 row_mask:0xf bank_mask:0xf
    v_add_f32_dpp v11, v11, v11 row_ror:2 row_mask:0xf bank_mask:0xf
    s_nop 0
    v_add_f32_dpp v10, v10, v10 row_ror:1 row_mask:0xf bank_mask:0xf
    v_add_f32_dpp v11, v11, v11 row_ror:1 row_mask:0xf bank_mask:0xf
    v_mul_f32 v11, 0x3acccccd, v11
    v_mul_f32 v10, 0x3acccccd, v10
    v_add_f32 v11, 0x3727c5ac, v11
    v_fma_f32 v11, -v10, v10, v11
    v_max_f32 v11, 0x3727c5ac, v11
    v_rsq_f32 v11, v11
    s_nop 0
    v_mul_f32 v11, 0x3dd53b95, v11
    v_mul_f32 v10, -v10, v11
    ds_write_b64 v8, v[10:11]
    s_branch L_qb_201
L_mr_207:
    ds_read_b32 v36, v62
    s_sub_u32 s56, s56, 1
    s_cbranch_scc1 L_done
    s_waitcnt lgkmcnt(0)
    v_cmp_eq_u32 vcc, -1, v36
    s_cbranch_vccnz L_mr_207
    v_max_f32_dpp v37, v36, v36 row_ror:4 row_mask:0xf bank_mask:0xf
    s_nop 1
    v_max_f32_dpp v37, v37, v37 row_ror:2 row_mask:0xf bank_mask:0xf
    s_nop 1
    v_max_f32_dpp v37, v37, v37 row_ror:1 row_mask:0xf bank_mask:0xf
    v_sub_f32 v39, s64, v37
    v_exp_f32 v39, v39
    s_branch L_mk_208
L_gs_209:
    buffer_store_dword v37, v4, s[40:43], s58 offen sc1
    s_branch L_gb_210
L_gs_211:
    buffer_store_dword v14, v3, s[40:43], s57 offen sc1
    s_branch L_gb_212
L_gs_213:
    buffer_store_dword v12, v4, s[40:43], s57 offen offset:32 sc1
    s_branch L_gb_214
L_comb_1:
    s_mov_b32 s58, 20480
    v_min_u32 v37, -2, v37
    s_cmp_eq_u32 s55, 0
    s_cbranch_scc1 L_gs_209
    buffer_store_dword v37, v4, s[40:43], s58 offen
L_gb_210:
    s_mov_b32 s57, 20480
    s_cmp_eq_u32 s55, 0
    s_waitcnt lgkmcnt(0)
    s_barrier
    ds_read2st64_b64 v[12:15], v2 offset0:0 offset1:4
    ds_read2st64_b64 v[16:19], v2 offset0:8 offset1:12
    ds_read2st64_b64 v[20:23], v2 offset0:16 offset1:20
    ds_read2st64_b64 v[24:27], v2 offset0:24 offset1:28
    s_waitcnt lgkmcnt(2)
    v_pk_add_f32 v[12:13], v[12:13], v[14:15]
    v_pk_add_f32 v[16:17], v[16:17], v[18:19]
    v_pk_add_f32 v[12:13], v[12:13], v[16:17]
    s_waitcnt lgkmcnt(0)
    v_pk_add_f32 v[20:21], v[20:21], v[22:23]
    v_pk_add_f32 v[24:25], v[24:25], v[26:27]
    v_pk_add_f32 v[12:13], v[12:13], v[20:21]
    v_pk_add_f32 v[12:13], v[12:13], v[24:25]
    v_cvt_pk_bf16_f32 v14, v12, v13
    v_min_u32 v12, -2, v12
    v_min_u32 v14, -2, v14
    s_cbranch_scc1 L_gs_211
    buffer_store_dword v14, v3, s[40:43], s57 offen
L_gb_212:
    s_cbranch_scc1 L_gs_213
    buffer_store_dword v12, v4, s[40:43], s57 offen offset:32
L_gb_214:
L_pad21:
    s_cbranch_execz L_padback
    s_branch L_comb_1b
L_sr_224:
    buffer_load_dwordx4 v[16:19], v11, s[40:43], s65 offen sc1
    s_sub_u32 s56, s56, 1
    s_cbranch_scc1 L_done
    s_waitcnt vmcnt(0)
    s_branch L_sw_223
L_hr_226:
    buffer_load_dwordx4 v[12:15], v11, s[40:43], s58 offen sc1
    s_sub_u32 s56, s56, 1
    s_cbranch_scc1 L_done
    s_and_b32 s64, s56, 31
    s_cbranch_scc0 L_hx_228
    s_waitcnt vmcnt(1)
    v_dot2_f32_bf16 v20, v12, v5, 0
    v_dot2_f32_bf16 v21, v13, v5, 0
    v_dot2_f32_bf16 v20, v14, v5, v20
    v_dot2_f32_bf16 v21, v15, v5, v21
    s_nop 2
    v_add_f32 v20, v20, v21
    v_cmp_u_f32 vcc, v20, v20
    v_sub_f32 v20, v20, v26
    s_cbranch_vccnz L_hr_226
    s_branch L_hk_227
L_hx_228:
    s_waitcnt vmcnt(0)
    v_pk_max_u16 v20, v12, v13
    v_pk_max_u16 v21, v14, v15
    v_pk_max_u16 v20, v20, v21
    v_lshlrev_b32 v21, 16, v20
    v_max_u32 v20, v20, v21
    v_cmp_le_u32 vcc, 0xffff0000, v20
    s_cbranch_vccnz L_hr_226
    v_dot2_f32_bf16 v20, v12, v5, 0
    v_dot2_f32_bf16 v21, v13, v5, 0
    v_dot2_f32_bf16 v20, v14, v5, v20
    v_dot2_f32_bf16 v21, v15, v5, v21
    s_nop 2
    v_add_f32 v20, v20, v21
    v_sub_f32 v20, v20, v26
    s_branch L_hk_227
L_typeC_231:
    s_cmp_eq_u32 s30, 6
    s_cbranch_scc0 L_done
    s_cmp_eq_u32 s3, 20
    s_cbranch_scc0 L_done
    s_lshl_b32 s59, s31, 15
    s_add_u32 s59, s59, s8
    s_add_u32 s59, s59, 7168
    v_and_b32 v10, 1, v0
    v_lshlrev_b32 v10, 13, v10
    v_lshrrev_b32 v60, 1, v0
    v_lshl_add_u32 v10, v60, 24, v10
    s_add_u32 s58, s62, 22048
    v_lshrrev_b32 v9, 3, v0
    v_mul_u32_u24 v9, 1664, v9
    v_and_b32 v60, 7, v0
    v_lshl_add_u32 v9, v60, 2, v9
    buffer_load_dword v12, v9, s[40:43], s58 offen sc1
    s_sleep 2
L_pr_233:
    buffer_load_dword v12, v9, s[40:43], s58 offen sc1
    s_sub_u32 s56, s56, 1
    s_cbranch_scc1 L_done
L_pw_232:
    s_waitcnt vmcnt(1)
    v_cmp_eq_u32 vcc, -1, v12
    s_cbranch_vccnz L_pr_233
    buffer_store_dword v0, v10, s[40:43], s59 offen offset:8 sc1
    s_add_u32 s58, s62, 19840
    v_and_b32 v9, 15, v0
    v_lshlrev_b32 v9, 2, v9
    buffer_load_dword v13, v9, s[40:43], s58 offen sc1
    s_sleep 2
L_pr_235:
    buffer_load_dword v13, v9, s[40:43], s58 offen sc1
    s_sub_u32 s56, s56, 1
    s_cbranch_scc1 L_done
L_pw_234:
    s_waitcnt vmcnt(1)
    v_cmp_eq_u32 vcc, -1, v13
    s_cbranch_vccnz L_pr_235
    buffer_store_dword v0, v10, s[40:43], s59 offen offset:12 sc1
    s_waitcnt vmcnt(1)
    s_branch L_done
L_gs_239:
    buffer_store_short v12, v11, s[40:43], s59 offen sc1
    s_branch L_gb_240
L_gr_242:
    s_cbranch_scc1 L_gw_241
    s_waitcnt vmcnt(0)
    v_max3_u32 v32, v12, v13, v14
    v_max3_u32 v32, v32, v15, v16
    v_max3_u32 v32, v32, v17, v18
    v_max3_u32 v32, v32, v19, v20
    v_max3_u32 v32, v32, v21, v22
    v_max3_u32 v32, v32, v23, v24
    v_max3_u32 v32, v32, v25, v26
    v_max_u32 v32, v32, v27
    v_cmp_eq_u32 vcc, -1, v32
    s_cbranch_vccnz L_gw_241
    v_pk_add_f32 v[28:29], v[12:13], v[16:17]
L_pad22:
    s_cbranch_execz L_padback
    v_pk_add_f32 v[30:31], v[14:15], v[18:19]
    v_pk_add_f32 v[28:29], v[28:29], v[20:21]
    v_pk_add_f32 v[30:31], v[30:31], v[22:23]
    v_pk_add_f32 v[28:29], v[28:29], v[24:25]
    v_pk_add_f32 v[30:31], v[30:31], v[26:27]
    s_nop 1
    v_permlane32_swap_b32 v28, v30
    v_permlane32_swap_b32 v29, v31
    s_branch L_gk_243
L_gs_246:
    buffer_store_dword v33, v34, s[40:43], s67 offen sc1
    s_branch L_gb_247
L_w7_236:
    v_and_b32 v60, 31, v0
    v_min_u32 v60, 19, v60
    s_mul_i32 s57, s54, 320
    v_lshrrev_b32 v5, 5, v0
    v_mul_u32_u24 v5, 2560, v5
    v_add_u32 v5, s57, v5
    v_lshl_add_u32 v5, v60, 4, v5
    v_and_b32 v60, 31, v0
    v_cmp_gt_u32 s[64:65], 20, v60
    v_min_u32 v60, 19, v60
    v_lshrrev_b32 v35, 5, v0
    v_lshlrev_b32 v35, 2, v35
    v_add_u32 v35, 160832, v35
    v_lshl_add_u32 v35, v60, 3, v35
    s_add_u32 s66, s62, 33792
    s_add_u32 s67, s62, 19840
    s_lshl_b32 s57, s54, 3
    v_lshrrev_b32 v34, 5, v0
    v_lshlrev_b32 v34, 2, v34
    v_add_u32 v34, s57, v34
    v_and_b32 v60, 31, v0
    v_mov_b32 v61, 0x7f000000
    v_cmp_ne_u32 vcc, 31, v60
    s_nop 1
    v_cndmask_b32 v34, v34, v61, vcc
    v_mov_b32 v61, 0x3f803f80
    s_add_u32 s57, s7, 262144
    s_add_u32 s58, s7, 294912
    s_add_u32 s59, s7, 327680
    s_add_u32 s60, s7, 360448
    s_add_u32 s75, s7, 7176
    v_and_b32 v9, 7, v0
    v_lshlrev_b32 v9, 15, v9
    buffer_load_dword v12, v9, s[40:43], s75 offen sc1
    s_sleep 2
L_pr_245:
    buffer_load_dword v12, v9, s[40:43], s75 offen sc1
    s_sub_u32 s56, s56, 1
    s_cbranch_scc1 L_done
L_pw_244:
    s_waitcnt vmcnt(1)
    v_cmp_eq_u32 vcc, -1, v12
    s_cbranch_vccnz L_pr_245
    s_sleep 2
    buffer_load_dwordx4 v[12:15], v5, s[40:43], s57 offen sc1
    buffer_load_dwordx4 v[16:19], v5, s[40:43], s58 offen sc1
    buffer_load_dwordx4 v[20:23], v5, s[40:43], s59 offen sc1
    buffer_load_dwordx4 v[24:27], v5, s[40:43], s60 offen sc1
    s_sleep 2
L_gw_241:
    buffer_load_dwordx4 v[12:15], v5, s[40:43], s57 offen sc1
    buffer_load_dwordx4 v[16:19], v5, s[40:43], s58 offen sc1
    buffer_load_dwordx4 v[20:23], v5, s[40:43], s59 offen sc1
    buffer_load_dwordx4 v[24:27], v5, s[40:43], s60 offen sc1
    s_sub_u32 s56, s56, 1
    s_cbranch_scc1 L_done
    s_and_b32 s74, s56, 31
    s_waitcnt vmcnt(6)
    v_pk_add_f32 v[28:29], v[12:13], v[16:17]
    v_pk_add_f32 v[30:31], v[14:15], v[18:19]
    s_waitcnt vmcnt(5)
    v_pk_add_f32 v[28:29], v[28:29], v[20:21]
    v_pk_add_f32 v[30:31], v[30:31], v[22:23]
    s_waitcnt vmcnt(4)
    v_pk_add_f32 v[28:29], v[28:29], v[24:25]
    v_pk_add_f32 v[30:31], v[30:31], v[26:27]
    v_pk_add_f32 v[32:33], v[28:29], v[30:31]
    v_cmp_u_f32 vcc, v32, v33
    v_permlane32_swap_b32 v28, v30
    v_permlane32_swap_b32 v29, v31
    s_cbranch_vccnz L_gr_242
L_gk_243:
    v_pk_add_f32 v[28:29], v[28:29], v[30:31]
    v_pk_add_f32 v[28:29], v[28:29], v[2:3]
    v_cvt_pk_bf16_f32 v28, v28, v29
    ds_write_b32 v35, v28
    s_waitcnt lgkmcnt(0)
    s_barrier
L_pad23:
    s_cbranch_execz L_padback
    v_cndmask_b32 v29, 0, v28, s[64:65]
    v_dot2_f32_bf16 v33, v29, v61, 0
    v_dot2_f32_bf16 v32, v29, v29, 0
    v_lshlrev_b32 v2, 16, v28
    v_and_b32 v3, 0xffff0000, v28
    s_cmp_eq_u32 s55, 0
    v_permlane32_swap_b32 v33, v32
    v_add_f32 v33, v33, v32
    s_nop 1
    v_add_f32_dpp v33, v33, v33 row_ror:8 row_mask:0xf bank_mask:0xf
    s_nop 1
    v_add_f32_dpp v33, v33, v33 row_ror:4 row_mask:0xf bank_mask:0xf
    s_nop 1
    v_add_f32_dpp v33, v33, v33 row_ror:2 row_mask:0xf bank_mask:0xf
    s_nop 1
    v_add_f32_dpp v33, v33, v33 row_ror:1 row_mask:0xf bank_mask:0xf
    s_nop 1
    v_add_f32_dpp v33, v33, v33 row_bcast:15 row_mask:0xa bank_mask:0xf
    v_min_u32 v33, -2, v33
    s_cbranch_scc1 L_gs_246
    buffer_store_dword v33, v34, s[40:43], s67 offen
L_gb_247:
    s_waitcnt vmcnt(1)
    s_branch L_se_237
L_gr_249:
    s_cbranch_scc1 L_gw_248
    s_waitcnt vmcnt(0)
    v_max3_u32 v32, v12, v13, v14
    v_max3_u32 v32, v32, v15, v16
    v_max3_u32 v32, v32, v17, v18
    v_max3_u32 v32, v32, v19, v20
    v_max3_u32 v32, v32, v21, v22
    v_max3_u32 v32, v32, v23, v24
    v_max3_u32 v32, v32, v25, v26
    v_max_u32 v32, v32, v27
    v_cmp_eq_u32 vcc, -1, v32
    s_cbranch_vccnz L_gw_248
    v_pk_add_f32 v[28:29], v[12:13], v[16:17]
    v_pk_add_f32 v[30:31], v[14:15], v[18:19]
    v_pk_add_f32 v[28:29], v[28:29], v[20:21]
    v_pk_add_f32 v[30:31], v[30:31], v[22:23]
    v_pk_add_f32 v[28:29], v[28:29], v[24:25]
    v_pk_add_f32 v[30:31], v[30:31], v[26:27]
    s_nop 1
    v_permlane32_swap_b32 v28, v30
    v_permlane32_swap_b32 v29, v31
    s_branch L_gk_250
L_tail_end:
L_spread:
    s_add_u32 s62, s62, 606208
    s_cmp_eq_u32 s30, 5
    s_cbranch_scc0 L_skip_80
    v_mov_b64 v[12:13], -1
    v_mov_b64 v[14:15], -1
    v_lshlrev_b32 v16, 4, v0
    s_mul_i32 s57, s52, 1536
    s_add_u32 s57, s57, s62
    s_mov_b32 exec_lo, 0xffffffff
    s_mov_b32 exec_hi, 0x0
    buffer_store_dwordx4 v[12:15], v16, s[40:43], s57 offen offset:1024 sc1
    s_mov_b64 exec, -1
    buffer_store_dwordx4 v[12:15], v16, s[40:43], s57 offen sc1
L_skip_80:
    s_cmp_eq_u32 s30, 7
    s_cbranch_scc0 L_skip_81
    v_and_b32 v60, 31, v0
    v_cmp_gt_u32 s[64:65], 20, v60
    v_min_u32 v60, 19, v60
    v_lshrrev_b32 v35, 5, v0
    v_lshlrev_b32 v35, 2, v35
    v_add_u32 v35, 160832, v35
    v_lshl_add_u32 v35, v60, 3, v35
    s_mul_i32 s66, s53, 6400
    s_add_u32 s66, s66, s62
    s_add_u32 s66, s66, 49152
    s_add_u32 s67, s66, 6144
    s_lshl_b32 s57, s54, 3
    v_lshrrev_b32 v34, 5, v0
    v_lshlrev_b32 v34, 2, v34
    v_add_u32 v34, s57, v34
    v_and_b32 v60, 31, v0
    v_mov_b32 v61, 0x7f000000
    v_cmp_ne_u32 vcc, 31, v60
    s_nop 1
    v_cndmask_b32 v34, v34, v61, vcc
    v_mov_b32 v61, 0x3f803f80
    v_cvt_pk_bf16_f32 v28, v2, v3
L_skip_81:
    s_cmp_eq_u32 s30, 7
    s_cbranch_scc0 L_skip_82
    v_cndmask_b32 v29, 0, v28, s[64:65]
    v_dot2_f32_bf16 v33, v29, v61, 0
    v_dot2_f32_bf16 v32, v29, v29, 0
    v_lshlrev_b32 v2, 16, v28
    v_and_b32 v3, 0xffff0000, v28
    s_cmp_eq_u32 s55, 0
    v_permlane32_swap_b32 v33, v32
    v_add_f32 v33, v33, v32
    s_nop 1
    v_add_f32_dpp v33, v33, v33 row_ror:8 row_mask:0xf bank_mask:0xf
    s_nop 1
    v_add_f32_dpp v33, v33, v33 row_ror:4 row_mask:0xf bank_mask:0xf
    s_nop 1
    v_add_f32_dpp v33, v33, v33 row_ror:2 row_mask:0xf bank_mask:0xf
    s_nop 1
    v_add_f32_dpp v33, v33, v33 row_ror:1 row_mask:0xf bank_mask:0xf
    s_nop 1
    v_add_f32_dpp v33, v33, v33 row_bcast:15 row_mask:0xa bank_mask:0xf
    v_min_u32 v33, -2, v33
    s_cbranch_scc1 L_gs_83
    buffer_store_dword v33, v34, s[40:43], s67 offen
L_gb_84:
    s_waitcnt vmcnt(1)
L_skip_82:
    s_cmp_lt_u32 s30, 6
    s_cbranch_scc0 L_skip_85
    s_lshr_b32 s57, s30, 1
    s_mul_i32 s57, s57, 1024
    s_and_b32 s58, s30, 1
    s_lshl_b32 s58, s58, 6
    s_add_u32 s57, s57, s58
    v_lshrrev_b32 v18, 5, v0
    v_mul_u32_u24 v18, 6144, v18
    v_bfe_u32 v60, v0, 3, 1
    v_mul_u32_u24 v60, 3072, v60
    v_add_u32 v18, v60, v18
    v_bfe_u32 v60, v0, 4, 1
    v_lshl_add_u32 v18, v60, 9, v18
    v_bfe_u32 v60, v0, 2, 1
    v_lshl_add_u32 v18, v60, 7, v18
    v_and_b32 v60, 3, v0
    v_lshl_add_u32 v18, v60, 3, v18
    v_add_u32 v18, s57, v18
    v_bfe_u32 v19, v0, 4, 1
    v_mul_u32_u24 v19, 3072, v19
    v_bfe_u32 v60, v0, 3, 1
    v_lshl_add_u32 v19, v60, 9, v19
    v_bfe_u32 v60, v0, 2, 1
    v_lshl_add_u32 v19, v60, 7, v19
    v_and_b32 v60, 3, v0
    v_lshl_add_u32 v19, v60, 3, v19
    v_add_u32 v19, s57, v19
    v_add_u32 v19, 24576, v19
    ds_read_b64_tr_b16 v[28:29], v18 offset:0
    ds_read_b64_tr_b16 v[30:31], v18 offset:256
    ds_read_b64_tr_b16 v[32:33], v18 offset:12288
    ds_read_b64_tr_b16 v[34:35], v18 offset:12544
    ds_read_b64_tr_b16 v[36:37], v19 offset:0
    ds_read_b64_tr_b16 v[38:39], v19 offset:256
    ds_read_b64_tr_b16 v[40:41], v18 offset:32
    ds_read_b64_tr_b16 v[42:43], v18 offset:288
    ds_read_b64_tr_b16 v[44:45], v18 offset:12320
    ds_read_b64_tr_b16 v[46:47], v18 offset:12576
    ds_read_b64_tr_b16 v[48:49], v19 offset:32
    ds_read_b64_tr_b16 v[50:51], v19 offset:288
    v_lshrrev_b32 v52, 4, v0
    v_lshlrev_b32 v52, 5, v52
    v_bfe_u32 v60, v0, 1, 1
    v_lshl_add_u32 v52, v60, 4, v52
    v_and_b32 v60, 1, v0
    v_mul_u32_u24 v60, 192, v60
    v_add_u32 v52, v60, v52
    v_add_u32 v52, 160832, v52
    v_lshrrev_b32 v53, 4, v0
    v_lshlrev_b32 v53, 4, v53
    v_bfe_u32 v60, v0, 1, 1
    v_lshl_add_u32 v53, v60, 3, v53
    v_and_b32 v60, 1, v0
    v_mul_u32_u24 v60, 192, v60
    v_add_u32 v53, v60, v53
    v_add_u32 v53, 160960, v53
    v_mov_b64 v[20:21], 0
    v_mov_b64 v[22:23], 0
    v_mov_b64 v[24:25], 0
    v_mov_b64 v[26:27], 0
    s_lshl_b32 s57, s54, 1
    s_lshl_b32 s58, s30, 9
    s_add_u32 s57, s57, s58
    v_and_b32 v54, 31, v0
    v_lshlrev_b32 v54, 4, v54
    v_lshrrev_b32 v60, 5, v0
    v_mul_u32_u24 v60, 3072, v60
    v_add_u32 v54, v60, v54
    v_add_u32 v54, s57, v54
    s_mul_i32 s59, s53, 6400
    s_add_u32 s59, s59, s62
    s_add_u32 s59, s59, 49152
    s_add_u32 s60, s59, 6144
    ds_read_b128 v[12:15], v52
    ds_read_b64 v[16:17], v53
    s_waitcnt lgkmcnt(1)
    v_smfmac_f32_16x16x64_bf16 v[20:23], v[12:15], v[28:35], v1
    v_smfmac_f32_16x16x64_bf16 v[24:27], v[12:15], v[40:47], v1
    s_waitcnt lgkmcnt(0)
    v_smfmac_f32_16x16x32_bf16 v[20:23], v[16:17], v[36:39], v1
    v_smfmac_f32_16x16x32_bf16 v[24:27], v[16:17], v[48:51], v1
    s_cmp_eq_u32 s55, 0
    s_nop 5
    v_add_f32 v12, v20, v22
    s_nop 1
    v_add_f32_dpp v12, v24, v26 quad_perm:[0,1,2,3] row_mask:0x2 bank_mask:0xf
    s_nop 1
    v_add_f32_dpp v12, v21, v23 quad_perm:[0,1,2,3] row_mask:0x4 bank_mask:0xf
    s_nop 1
    v_add_f32_dpp v12, v25, v27 quad_perm:[0,1,2,3] row_mask:0x8 bank_mask:0xf
    v_cvt_pk_bf16_f32 v12, v12, v12
    v_min_u32 v12, -2, v12
    s_cbranch_scc1 L_gs_86
    buffer_store_short v12, v54, s[40:43], s59 offen
L_gb_87:
L_skip_85:
    s_waitcnt vmcnt(0)
    s_barrier
    s_cmp_eq_u32 s30, 5
    s_cbranch_scc0 L_skip_88
    v_mov_b32 v25, 0
    s_lshl_b32 s57, s52, 2
    s_add_u32 s57, s57, s72
    s_mov_b64 exec, 1
    buffer_store_dword v25, v0, s[40:43], s57 offen offset:256 sc1
    s_mov_b64 exec, -1
    v_and_b32 v16, 31, v0
    v_lshlrev_b32 v16, 2, v16
L_pr_90:
    buffer_load_dword v17, v16, s[40:43], s72 offen offset:256 sc1
    s_sub_u32 s56, s56, 1
    s_cbranch_scc1 L_done
L_pw_89:
    s_waitcnt vmcnt(0)
    v_cmp_eq_u32 vcc, -1, v17
    s_cbranch_vccnz L_pr_90
L_skip_88:
    s_barrier
    s_branch L_spread_back
L_done:
L_exit:
    s_endpgm
.section .rodata,"a"
.p2align 6
.amdhsa_kernel interleave_layers__sliding_block_cached__dense_activation_gelu__decode_kernel
  .amdhsa_next_free_vgpr 256
  .amdhsa_next_free_sgpr 102
  .amdhsa_accum_offset 256
  .amdhsa_group_segment_fixed_size 0
  .amdhsa_kernarg_size 104
  .amdhsa_user_sgpr_count 2
  .amdhsa_user_sgpr_kernarg_segment_ptr 1
  .amdhsa_system_sgpr_workgroup_id_x 1
  .amdhsa_float_denorm_mode_32 3
.end_amdhsa_kernel
```

```asm
; @launch grid=(256,1,1) block=(512,1,1) lds=161216
.amdgcn_target "amdgcn-amd-amdhsa--gfx950"
.text
.fill 64, 4, 0xbf800000
.globl interleave_layers__sliding_block_cached__dense_activation_gelu__decode_kernel
.p2align 8
.type interleave_layers__sliding_block_cached__dense_activation_gelu__decode_kernel,@function
interleave_layers__sliding_block_cached__dense_activation_gelu__decode_kernel:
    s_load_dwordx16 s[4:19], s[0:1], 0
    s_load_dwordx8 s[20:27], s[0:1], 64
    s_load_dwordx2 s[28:29], s[0:1], 96
    s_cmp_ge_u32 s2, 256
    s_cbranch_scc1 L_exit
    s_getpc_b64 s[74:75]
L_pc:
    v_lshlrev_b32 v5, 6, v0
    v_min_u32 v5, L_exit-L_pc, v5
    global_load_dword v63, v5, s[74:75]
    v_lshrrev_b32 v5, 6, v0
    v_and_b32 v0, 63, v0
    v_readfirstlane_b32 s30, v5
    s_and_b32 s31, s2, 7
    s_lshr_b32 s52, s2, 3
    s_and_b32 s53, s52, 3
    s_lshr_b32 s54, s52, 2
    s_lshl_b32 s73, s31, 2
    s_add_u32 s73, s73, s53
    s_mul_i32 s3, s54, 3
    s_add_u32 s3, s3, s53
    s_cmp_eq_u32 s53, 3
    s_cselect_b32 s3, 31, s3
    s_cselect_b32 s70, 0, 0
    s_cmp_lt_u32 s3, 20
    s_cselect_b32 s70, 1, s70
    v_lshrrev_b32 v8, 5, v0
    v_lshlrev_b32 v8, 2, v8
    v_bfe_u32 v60, v0, 4, 1
    v_lshl_add_u32 v8, v60, 0, v8
    v_and_b32 v9, 7, v0
    v_xor_b32 v8, v8, v9
    v_lshrrev_b32 v10, 3, v0
    v_mul_u32_u24 v10, 384, v10
    v_lshl_add_u32 v5, v8, 4, v10
    v_xor_b32 v6, 32, v5
    v_lshrrev_b32 v8, 4, v0
    v_lshlrev_b32 v8, 1, v8
    v_xor_b32 v8, v8, v9
    v_lshl_add_u32 v7, v8, 4, v10
    v_lshrrev_b32 v2, 3, v0
    v_mul_u32_u24 v2, 12288, v2
    v_and_b32 v60, 7, v0
    v_lshl_add_u32 v2, v60, 4, v2
    s_mul_i32 s57, s73, 12582912
    s_mul_i32 s58, s54, 3072
    s_add_u32 s57, s57, s58
    s_add_u32 s57, s57, 11009024
    s_sub_u32 s58, 1573888, s58
    s_and_b32 s71, s73, 7
    s_mul_i32 s59, s73, 384
    s_mul_i32 s60, s54, 983040
    s_add_u32 s59, s59, s60
    s_sub_u32 s60, 7866368, s59
    s_lshl_b32 s61, s30, 11
    s_add_u32 s61, s61, 92160
    s_mul_i32 s62, s31, 120832
    s_add_u32 s62, s62, 299008
    s_lshl_b32 s72, s31, 9
    s_add_u32 s72, s72, 294912
    s_mov_b32 s56, 65536
    s_mov_b32 s55, 1
    s_getreg_b32 s63, hwreg(20, 0, 3)
    s_andn2_b32 s64, 1, s63
    s_mul_i32 s64, s64, 1
    s_add_u32 s70, s70, s64
    v_mov_b32 v3, 0
    v_mov_b32 v4, 0
    v_mov_b32 v11, 0
    v_mov_b32 v24, 0
    v_mov_b32 v34, 0
    v_mov_b64 v[12:13], -1
    v_mov_b64 v[14:15], -1
    v_lshlrev_b32 v10, 4, v0
    s_waitcnt lgkmcnt(0)
    s_add_u32 s32, s6, s57
    s_addc_u32 s33, s7, 0
    s_mov_b32 s34, s58
    s_mov_b32 s35, 0x20000
    s_add_u32 s36, s8, s57
    s_addc_u32 s37, s9, 0
    s_mov_b32 s38, s58
    s_mov_b32 s39, 0x20000
    s_mov_b32 s40, s28
    s_mov_b32 s41, s29
    s_mov_b32 s42, 2232320
    s_mov_b32 s43, 0x20000
    s_add_u32 s44, s10, s59
    s_addc_u32 s45, s11, 0
    s_mov_b32 s46, s60
    s_mov_b32 s47, 0x20000
    s_sub_u32 s44, s44, 2048
    s_subb_u32 s45, s45, 0
    s_cmp_eq_u32 s30, 6
    s_cbranch_scc0 L_skip_1
    s_setprio 3
    s_xor_b32 s57, s71, 0
    s_mul_i32 s57, s57, 196608
    s_add_u32 s57, s57, 1024
    s_xor_b32 s58, s71, 1
    s_mul_i32 s58, s58, 196608
    s_add_u32 s58, s58, 0
    s_mov_b32 m0, 92160
L_dma_2:
    s_nop 0
    buffer_load_dwordx4 v5, s[32:35], s57 offen offset:0 nt lds
    buffer_load_dwordx4 v6, s[32:35], s58 offen offset:1024 nt lds
    s_add_u32 s57, s57, 24576
    s_add_u32 s58, s58, 24576
    s_add_u32 m0, m0, 2048
    s_cmp_lg_u32 m0, 108544
    s_cbranch_scc1 L_dma_2
    s_xor_b32 s57, s71, 0
    s_mul_i32 s57, s57, 196608
    s_add_u32 s57, s57, 1152
    s_xor_b32 s58, s71, 1
    s_mul_i32 s58, s58, 196608
    s_add_u32 s58, s58, 128
    s_mov_b32 m0, 108544
L_dma_3:
    s_waitcnt vmcnt(23)
    s_cmp_ge_u32 s70, 2
    s_cbranch_scc1 L_go_4
    s_waitcnt vmcnt(22)
    s_cmp_ge_u32 s70, 1
    s_cbranch_scc1 L_go_4
    s_waitcnt vmcnt(21)
L_go_4:
    buffer_load_dwordx4 v5, s[32:35], s57 offen offset:0 nt lds
    buffer_load_dwordx4 v6, s[32:35], s58 offen offset:1024 nt lds
    s_add_u32 s57, s57, 24576
    s_add_u32 s58, s58, 24576
    s_add_u32 m0, m0, 2048
    s_cmp_lg_u32 m0, 124928
    s_cbranch_scc1 L_dma_3
    s_mov_b32 s57, 2048
    s_mov_b32 s58, 1152
    s_mov_b32 s59, 256
    s_mov_b32 m0, 0
L_dma_5:
    s_waitcnt vmcnt(23)
    s_cmp_ge_u32 s70, 2
    s_cbranch_scc1 L_go_6
    s_waitcnt vmcnt(22)
    s_cmp_ge_u32 s70, 1
    s_cbranch_scc1 L_go_6
    s_waitcnt vmcnt(21)
L_go_6:
    buffer_load_dwordx4 v2, s[44:47], s57 offen offset:0 nt lds
    buffer_load_dwordx4 v2, s[44:47], s58 offen offset:1024 nt lds
    buffer_load_dwordx4 v2, s[44:47], s59 offen offset:2048 nt lds
    s_add_u32 s57, s57, 98304
    s_add_u32 s58, s58, 98304
    s_add_u32 s59, s59, 98304
    s_add_u32 m0, m0, 3072
    s_cmp_lg_u32 m0, 15360
    s_cbranch_scc1 L_dma_5
L_skip_1:
    s_cmp_lt_u32 s3, 20
    s_cselect_b32 s57, 7864320, 0
    s_add_u32 s58, s54, 1
    s_mul_i32 s58, s58, 245760
    s_cmp_lg_u32 s53, 3
    s_cselect_b64 s[48:49], s[12:13], s[16:17]
    s_cselect_b32 s50, s57, s58
    s_mov_b32 s51, 0x20000
    s_add_u32 s57, s28, 0
    s_sub_u32 s57, 0, s57
    s_and_b32 s57, s57, 0x3fff
    s_add_u32 s57, s57, 0
    s_lshr_b32 s58, s31, 1
    s_lshl_b32 s58, s58, 14
    s_add_u32 s6, s57, s58
    s_and_b32 s58, s31, 1
    s_lshl_b32 s58, s58, 12
    s_add_u32 s6, s6, s58
    s_lshl_b32 s58, s3, 7
    s_add_u32 s6, s6, s58
    s_mov_b32 s8, s57
    s_and_b32 s59, s3, 3
    s_lshl_b32 s58, s31, 2
    s_add_u32 s59, s59, s58
    s_lshl_b32 s59, s59, 7
    s_add_u32 s59, s59, s57
    s_add_u32 s59, s59, 262144
    s_add_u32 s10, s28, s59
    s_addc_u32 s11, s29, 0
    s_lshr_b32 s58, s63, 2
    s_xor_b32 s58, s58, 0
    s_mul_i32 s58, s58, 8192
    s_add_u32 s7, s57, s58
    s_cmp_eq_u32 s30, 5
    s_cbranch_scc0 L_skip_7
    s_cmp_eq_u32 s52, 31
    s_cbranch_scc0 L_skip_8
    s_mov_b64 exec, 0xffffff
    buffer_store_dwordx4 v[12:15], v10, s[40:43], s72 offen sc1
    s_mov_b64 exec, -1
L_skip_8:
    s_cmp_lt_u32 s3, 20
    s_cbranch_scc0 L_skip_9
    v_and_b32 v16, 7, v0
    v_lshlrev_b32 v16, 4, v16
    v_bfe_u32 v17, v0, 3, 1
    v_lshl_add_u32 v16, v17, 13, v16
    v_lshrrev_b32 v17, 4, v0
    v_mul_u32_u24 v17, 66048, v17
    v_add_u32 v16, v17, v16
    s_add_u32 s57, s6, 0
    buffer_store_dwordx4 v[12:15], v16, s[40:43], s57 offen sc1
L_skip_9:
    s_cmp_eq_u32 s3, 20
    s_cbranch_scc0 L_skip_10
    s_lshl_b32 s58, s31, 9
    s_add_u32 s58, s58, s8
    s_add_u32 s58, s58, 266240
    v_and_b32 v16, 7, v0
    v_lshlrev_b32 v16, 4, v16
    v_bfe_u32 v60, v0, 3, 1
    v_lshl_add_u32 v16, v60, 13, v16
    v_lshrrev_b32 v60, 4, v0
    v_lshl_add_u32 v16, v60, 28, v16
    buffer_store_dwordx4 v[12:15], v16, s[40:43], s58 offen sc1
L_skip_10:
    s_sub_u32 s58, s3, 20
    s_cmp_lt_u32 s58, 4
    s_cselect_b32 s59, s59, 0x7f000000
    v_and_b32 v16, 7, v0
    v_lshlrev_b32 v16, 4, v16
    v_bfe_u32 v60, v0, 3, 1
    v_lshl_add_u32 v16, v60, 13, v16
    v_lshrrev_b32 v60, 4, v0
    v_lshl_add_u32 v16, v60, 28, v16
    buffer_store_dwordx4 v[12:15], v16, s[40:43], s59 offen sc1
    s_mul_i32 s57, s52, 2208
    s_add_u32 s57, s57, s62
    s_mov_b64 exec, 0x3ff
    buffer_store_dwordx4 v[12:15], v10, s[40:43], s57 offen offset:2048
    s_mov_b64 exec, -1
    buffer_store_dwordx4 v[12:15], v10, s[40:43], s57 offen offset:0
    buffer_store_dwordx4 v[12:15], v10, s[40:43], s57 offen offset:1024
    s_mov_b64 exec, -1
    v_lshlrev_b32 v16, 4, v0
    v_add_u32 v16, 159744, v16
    ds_write_b128 v16, v[12:15]
    v_subrev_u32 v16, 8, v0
    v_cmp_gt_u32 vcc, 40, v16
    v_mov_b32 v16, 0x3f803f80
    s_nop 0
    v_cndmask_b32 v18, 0, v16, vcc
    v_min_u32 v16, 55, v0
    v_lshlrev_b32 v16, 2, v16
    v_add_u32 v16, 160992, v16
    ds_write_b32 v16, v18
    v_and_b32 v3, 7, v0
    v_lshlrev_b32 v3, 5, v3
L_skip_7:
    s_cmp_eq_u32 s30, 7
    s_cbranch_scc0 L_skip_11
    v_and_b32 v60, 31, v0
    v_min_u32 v60, 19, v60
    s_mul_i32 s57, s54, 160
    v_lshrrev_b32 v16, 5, v0
    v_lshlrev_b32 v16, 2, v16
    v_add_u32 v16, s57, v16
    v_lshl_add_u32 v16, v60, 3, v16
    global_load_dword v28, v16, s[4:5]
    global_load_dword v4, v16, s[22:23]
L_skip_11:
    s_sub_u32 s58, s30, 4
    s_cmp_lt_u32 s58, 3
    s_cbranch_scc0 L_skip_12
    s_mul_i32 s57, s31, 3
    s_add_u32 s57, s57, s58
    s_lshl_b32 s57, s57, 7
    v_and_b32 v16, 15, v0
    v_lshlrev_b32 v16, 3, v16
    v_lshrrev_b32 v60, 4, v0
    v_lshl_add_u32 v16, v60, 1, v16
    v_add_u32 v16, s57, v16
    global_load_short_d16_hi v4, v16, s[18:19]
L_skip_12:
    v_bfe_u32 v8, v0, 1, 3
    v_lshrrev_b32 v9, 4, v0
    v_xor_b32 v9, v8, v9
    v_bfe_u32 v8, v0, 2, 1
    v_lshlrev_b32 v8, 10, v8
    v_bfe_u32 v60, v0, 3, 1
    v_lshl_add_u32 v8, v60, 9, v8
    v_and_b32 v60, 3, v0
    v_lshl_add_u32 v8, v60, 7, v8
    v_add_u32 v8, s61, v8
    v_lshl_add_u32 v8, v9, 4, v8
    v_xor_b32 v9, 64, v8
    v_bfe_u32 v1, v0, 1, 1
    v_mul_u32_u24 v1, 43690, v1
    v_add_u32 v1, 17476, v1
    s_waitcnt vmcnt(31)
    s_barrier
    ds_read_b128 v[64:67], v8 offset:0
    ds_read_b128 v[68:71], v9 offset:0
    s_cmp_eq_u32 s30, 6
    s_cbranch_scc0 L_skip_13
    s_xor_b32 s57, s71, 0
    s_mul_i32 s57, s57, 196608
    s_add_u32 s57, s57, 1280
    s_xor_b32 s58, s71, 1
    s_mul_i32 s58, s58, 196608
    s_add_u32 s58, s58, 256
    s_mov_b32 m0, 124928
L_dma_14:
    s_waitcnt vmcnt(23)
    s_cmp_ge_u32 s70, 2
    s_cbranch_scc1 L_go_15
    s_waitcnt vmcnt(22)
    s_cmp_ge_u32 s70, 1
    s_cbranch_scc1 L_go_15
    s_waitcnt vmcnt(21)
L_go_15:
    buffer_load_dwordx4 v5, s[32:35], s57 offen offset:0 nt lds
    buffer_load_dwordx4 v6, s[32:35], s58 offen offset:1024 nt lds
    s_add_u32 s57, s57, 24576
    s_add_u32 s58, s58, 24576
    s_add_u32 m0, m0, 2048
    s_cmp_lg_u32 m0, 141312
    s_cbranch_scc1 L_dma_14
L_skip_13:
    s_waitcnt lgkmcnt(0)
    s_cmp_eq_u32 s30, 5
    s_cbranch_scc0 L_skip_16
    s_cmp_eq_u32 s52, 31
    s_cbranch_scc0 L_skip_17
    s_lshl_b32 s57, s31, 5
    v_mov_b32 v16, s57
    s_add_u32 s57, s63, 1
    v_mov_b32 v12, s57
    s_waitcnt vmcnt(5)
    s_mov_b64 exec, 0x1
    global_store_dword v16, v12, s[26:27] sc1
    s_mov_b64 exec, -1
L_skip_17:
L_skip_16:
    s_waitcnt vmcnt(31)
    s_barrier
    ds_read_b128 v[72:75], v8 offset:16384
    ds_read_b128 v[76:79], v9 offset:16384
    s_cmp_eq_u32 s30, 6
    s_cbranch_scc0 L_skip_18
    s_mov_b32 s57, 493568
    s_mov_b32 s58, 492672
    s_mov_b32 s59, 491776
    s_mov_b32 m0, 15360
L_dma_19:
    s_waitcnt vmcnt(23)
    s_cmp_ge_u32 s70, 2
    s_cbranch_scc1 L_go_20
    s_waitcnt vmcnt(22)
    s_cmp_ge_u32 s70, 1
    s_cbranch_scc1 L_go_20
    s_waitcnt vmcnt(21)
L_go_20:
    buffer_load_dwordx4 v2, s[44:47], s57 offen offset:0 nt lds
    buffer_load_dwordx4 v2, s[44:47], s58 offen offset:1024 nt lds
    buffer_load_dwordx4 v2, s[44:47], s59 offen offset:2048 nt lds
    s_add_u32 s57, s57, 98304
    s_add_u32 s58, s58, 98304
    s_add_u32 s59, s59, 98304
    s_add_u32 m0, m0, 3072
    s_cmp_lg_u32 m0, 30720
    s_cbranch_scc1 L_dma_19
    s_xor_b32 s57, s71, 2
    s_mul_i32 s57, s57, 196608
    s_add_u32 s57, s57, 1024
    s_xor_b32 s58, s71, 3
    s_mul_i32 s58, s58, 196608
    s_add_u32 s58, s58, 0
    s_mov_b32 m0, 141312
L_dma_21:
    s_waitcnt vmcnt(23)
    s_cmp_ge_u32 s70, 2
    s_cbranch_scc1 L_go_22
    s_waitcnt vmcnt(22)
    s_cmp_ge_u32 s70, 1
    s_cbranch_scc1 L_go_22
    s_waitcnt vmcnt(21)
L_go_22:
    buffer_load_dwordx4 v5, s[32:35], s57 offen offset:0 nt lds
    buffer_load_dwordx4 v6, s[32:35], s58 offen offset:1024 nt lds
    s_add_u32 s57, s57, 24576
    s_add_u32 s58, s58, 24576
    s_add_u32 m0, m0, 2048
    s_cmp_lg_u32 m0, 157696
    s_cbranch_scc1 L_dma_21
L_skip_18:
    s_waitcnt lgkmcnt(0)
    s_cmp_lt_u32 s30, 4
    s_cbranch_scc0 L_skip_23
    s_mov_b64 exec, 0
    s_cmp_eq_u32 s30, 1
    s_cbranch_scc1 L_pad1
    s_cmp_eq_u32 s30, 2
    s_cbranch_scc1 L_pad2
    s_cmp_eq_u32 s30, 3
    s_cbranch_scc1 L_pad3
    s_branch L_pad0
L_padback:
    s_mov_b64 exec, -1
L_skip_23:
    s_waitcnt vmcnt(31)
    s_barrier
    ds_read_b128 v[80:83], v8 offset:32768
    ds_read_b128 v[84:87], v9 offset:32768
    s_cmp_eq_u32 s30, 6
    s_cbranch_scc0 L_skip_24
    s_cmp_lg_u32 s53, 3
    s_cbranch_scc0 L_wb_25
    s_mul_i32 s57, s31, 983040
    s_lshl_b32 s58, s3, 6
    s_add_u32 s57, s57, s58
    v_bfe_u32 v38, v0, 4, 1
    v_lshlrev_b32 v38, 1, v38
    v_xor_b32 v38, v38, v0
    v_and_b32 v38, 3, v38
    v_lshrrev_b32 v3, 5, v0
    v_mul_u32_u24 v3, 10240, v3
    v_bfe_u32 v39, v0, 4, 1
    v_mul_u32_u24 v39, 2560, v39
    v_add_u32 v3, v39, v3
    v_bfe_u32 v39, v0, 3, 1
    v_mul_u32_u24 v39, 5120, v39
    v_add_u32 v3, v39, v3
    v_bfe_u32 v39, v0, 2, 1
    v_mul_u32_u24 v39, 20480, v39
    v_add_u32 v3, v39, v3
    v_add_u32 v3, s57, v3
    v_lshl_add_u32 v3, v38, 4, v3
    s_mov_b32 s14, 40960
    s_mov_b32 s15, 256
    s_branch L_we_26
L_wb_25:
    s_mul_i32 s57, s31, 384
    s_mul_i32 s58, s54, 245760
    s_add_u32 s57, s57, s58
    v_lshlrev_b32 v3, 4, v0
    v_add_u32 v3, s57, v3
    v_mov_b32 v38, 2688
    v_cmp_lt_u32 vcc, 23, v0
    s_nop 1
    v_cndmask_b32 v38, 0, v38, vcc
    v_add_u32 v3, v38, v3
    v_mov_b32 v38, 0x7f000000
    v_cmp_lt_u32 vcc, 47, v0
    s_nop 1
    v_cndmask_b32 v3, v3, v38, vcc
    s_mov_b32 s14, 12288
    s_mov_b32 s15, 5120
L_we_26:
    s_mul_i32 s57, s14, 0
    s_mov_b32 m0, 30720
    s_nop 0
    buffer_load_dwordx4 v3, s[48:51], s57 offen offset:0 nt lds
    s_mul_i32 s57, s14, 0
    s_add_u32 s57, s57, s15
    s_mov_b32 m0, 30720
    s_nop 0
    buffer_load_dwordx4 v3, s[48:51], s57 offen offset:1024 nt lds
    s_xor_b32 s57, s71, 2
    s_mul_i32 s57, s57, 196608
    s_add_u32 s57, s57, 1152
    s_xor_b32 s58, s71, 3
    s_mul_i32 s58, s58, 196608
    s_add_u32 s58, s58, 128
    s_mov_b32 m0, 92160
L_dma_27:
    s_waitcnt vmcnt(23)
    s_cmp_ge_u32 s70, 2
    s_cbranch_scc1 L_go_28
    s_waitcnt vmcnt(22)
    s_cmp_ge_u32 s70, 1
    s_cbranch_scc1 L_go_28
    s_waitcnt vmcnt(21)
L_go_28:
    buffer_load_dwordx4 v5, s[32:35], s57 offen offset:0 nt lds
    buffer_load_dwordx4 v6, s[32:35], s58 offen offset:1024 nt lds
    s_add_u32 s57, s57, 24576
    s_add_u32 s58, s58, 24576
    s_add_u32 m0, m0, 2048
    s_cmp_lg_u32 m0, 108544
    s_cbranch_scc1 L_dma_27
    s_mul_i32 s57, s14, 1
    s_mov_b32 m0, 32768
    s_nop 0
    buffer_load_dwordx4 v3, s[48:51], s57 offen offset:0 nt lds
    s_mul_i32 s57, s14, 1
    s_add_u32 s57, s57, s15
    s_mov_b32 m0, 32768
    s_nop 0
    buffer_load_dwordx4 v3, s[48:51], s57 offen offset:1024 nt lds
    s_xor_b32 s57, s71, 2
    s_mul_i32 s57, s57, 196608
    s_add_u32 s57, s57, 1280
    s_xor_b32 s58, s71, 3
    s_mul_i32 s58, s58, 196608
    s_add_u32 s58, s58, 256
    s_mov_b32 m0, 108544
L_dma_29:
    s_waitcnt vmcnt(23)
    s_cmp_ge_u32 s70, 2
    s_cbranch_scc1 L_go_30
    s_waitcnt vmcnt(22)
    s_cmp_ge_u32 s70, 1
    s_cbranch_scc1 L_go_30
    s_waitcnt vmcnt(21)
L_go_30:
    buffer_load_dwordx4 v5, s[32:35], s57 offen offset:0 nt lds
    buffer_load_dwordx4 v6, s[32:35], s58 offen offset:1024 nt lds
    s_add_u32 s57, s57, 24576
    s_add_u32 s58, s58, 24576
    s_add_u32 m0, m0, 2048
    s_cmp_lg_u32 m0, 124928
    s_cbranch_scc1 L_dma_29
L_skip_24:
    s_waitcnt lgkmcnt(0)
    s_cmp_lt_u32 s30, 5
    s_cbranch_scc0 L_skip_31
    s_waitcnt vmcnt(0)
L_skip_31:
    s_cmp_eq_u32 s30, 7
    s_cbranch_scc0 L_skip_32
    v_and_b32 v60, 31, v0
    v_cmp_gt_u32 s[64:65], 20, v60
    v_min_u32 v60, 19, v60
    v_lshrrev_b32 v35, 5, v0
    v_lshlrev_b32 v35, 2, v35
    v_add_u32 v35, 160832, v35
    v_lshl_add_u32 v35, v60, 3, v35
    s_mul_i32 s66, s53, 12416
    s_add_u32 s66, s66, s62
    s_add_u32 s66, s66, 70656
    s_add_u32 s67, s66, 12288
    s_lshl_b32 s57, s54, 3
    v_lshrrev_b32 v34, 5, v0
    v_lshlrev_b32 v34, 2, v34
    v_add_u32 v34, s57, v34
    v_and_b32 v60, 31, v0
    v_mov_b32 v61, 0x7f000000
    v_cmp_ne_u32 vcc, 31, v60
    s_nop 1
    v_cndmask_b32 v34, v34, v61, vcc
    v_mov_b32 v61, 0x3f803f80
    s_waitcnt vmcnt(0)
    ds_write_b32 v35, v28
    s_waitcnt lgkmcnt(0)
L_skip_32:
    s_cmp_eq_u32 s30, 5
    s_cbranch_scc0 L_skip_33
    s_waitcnt vmcnt(0)
    s_lshr_b32 s65, s63, 2
    s_sub_u32 s58, s3, 20
    s_cmp_lt_u32 s58, 4
    s_cbranch_scc0 L_skip_34
    s_mov_b32 s67, 0
    s_load_dword s66, s[10:11], 0
    s_load_dword s67, s[10:11], 8192
    s_waitcnt lgkmcnt(1)
    s_sleep 1
    s_mov_b32 s65, s67
L_skip_34:
L_skip_33:
    s_waitcnt vmcnt(36)
    s_barrier
    ds_read_b128 v[88:91], v8 offset:49152
    ds_read_b128 v[92:95], v9 offset:49152
    s_cmp_eq_u32 s30, 6
    s_cbranch_scc0 L_skip_35
    s_mul_i32 s57, s14, 2
    s_mov_b32 m0, 34816
    s_nop 0
    buffer_load_dwordx4 v3, s[48:51], s57 offen offset:0 nt lds
    s_mul_i32 s57, s14, 2
    s_add_u32 s57, s57, s15
    s_mov_b32 m0, 34816
    s_nop 0
    buffer_load_dwordx4 v3, s[48:51], s57 offen offset:1024 nt lds
    s_xor_b32 s57, s71, 4
    s_mul_i32 s57, s57, 196608
    s_add_u32 s57, s57, 1024
    s_xor_b32 s58, s71, 5
    s_mul_i32 s58, s58, 196608
    s_add_u32 s58, s58, 0
    s_mov_b32 m0, 124928
L_dma_36:
    s_waitcnt vmcnt(23)
    s_cmp_ge_u32 s70, 2
    s_cbranch_scc1 L_go_37
    s_waitcnt vmcnt(22)
    s_cmp_ge_u32 s70, 1
    s_cbranch_scc1 L_go_37
    s_waitcnt vmcnt(21)
L_go_37:
    buffer_load_dwordx4 v5, s[32:35], s57 offen offset:0 nt lds
    buffer_load_dwordx4 v6, s[32:35], s58 offen offset:1024 nt lds
    s_add_u32 s57, s57, 24576
    s_add_u32 s58, s58, 24576
    s_add_u32 m0, m0, 2048
    s_cmp_lg_u32 m0, 141312
    s_cbranch_scc1 L_dma_36
L_skip_35:
    s_waitcnt lgkmcnt(0)
    s_cmp_eq_u32 s30, 7
    s_cbranch_scc0 L_skip_38
    v_cndmask_b32 v29, 0, v28, s[64:65]
    v_dot2_f32_bf16 v33, v29, v61, 0
    v_dot2_f32_bf16 v32, v29, v29, 0
    v_lshlrev_b32 v2, 16, v28
    v_and_b32 v3, 0xffff0000, v28
    s_cmp_eq_u32 s55, 0
    v_permlane32_swap_b32 v33, v32
    v_add_f32 v33, v33, v32
    s_nop 1
    v_add_f32_dpp v33, v33, v33 row_ror:8 row_mask:0xf bank_mask:0xf
    s_nop 1
    v_add_f32_dpp v33, v33, v33 row_ror:4 row_mask:0xf bank_mask:0xf
    s_nop 1
    v_add_f32_dpp v33, v33, v33 row_ror:2 row_mask:0xf bank_mask:0xf
    s_nop 1
    v_add_f32_dpp v33, v33, v33 row_ror:1 row_mask:0xf bank_mask:0xf
    s_nop 1
    v_add_f32_dpp v33, v33, v33 row_bcast:15 row_mask:0xa bank_mask:0xf
    v_min_u32 v33, -2, v33
    s_cbranch_scc1 L_gs_39
    buffer_store_dword v33, v34, s[40:43], s67 offen
L_gb_40:
    s_waitcnt vmcnt(1)
L_skip_38:
    s_cmp_lt_u32 s30, 6
    s_cbranch_scc0 L_skip_41
    s_lshr_b32 s57, s30, 1
    s_mul_i32 s57, s57, 1024
    s_and_b32 s58, s30, 1
    s_lshl_b32 s58, s58, 6
    s_add_u32 s57, s57, s58
    v_lshrrev_b32 v18, 5, v0
    v_mul_u32_u24 v18, 6144, v18
    v_bfe_u32 v60, v0, 3, 1
    v_mul_u32_u24 v60, 3072, v60
    v_add_u32 v18, v60, v18
    v_bfe_u32 v60, v0, 4, 1
    v_lshl_add_u32 v18, v60, 9, v18
    v_bfe_u32 v60, v0, 2, 1
    v_lshl_add_u32 v18, v60, 7, v18
    v_and_b32 v60, 3, v0
    v_lshl_add_u32 v18, v60, 3, v18
    v_add_u32 v18, s57, v18
    v_bfe_u32 v19, v0, 4, 1
    v_mul_u32_u24 v19, 3072, v19
    v_bfe_u32 v60, v0, 3, 1
    v_lshl_add_u32 v19, v60, 9, v19
    v_bfe_u32 v60, v0, 2, 1
    v_lshl_add_u32 v19, v60, 7, v19
    v_and_b32 v60, 3, v0
    v_lshl_add_u32 v19, v60, 3, v19
    v_add_u32 v19, s57, v19
    v_add_u32 v19, 24576, v19
    ds_read_b64_tr_b16 v[28:29], v18 offset:0
    ds_read_b64_tr_b16 v[30:31], v18 offset:256
    ds_read_b64_tr_b16 v[32:33], v18 offset:12288
    ds_read_b64_tr_b16 v[34:35], v18 offset:12544
    ds_read_b64_tr_b16 v[36:37], v19 offset:0
    ds_read_b64_tr_b16 v[38:39], v19 offset:256
    ds_read_b64_tr_b16 v[40:41], v18 offset:32
    ds_read_b64_tr_b16 v[42:43], v18 offset:288
    ds_read_b64_tr_b16 v[44:45], v18 offset:12320
    ds_read_b64_tr_b16 v[46:47], v18 offset:12576
    ds_read_b64_tr_b16 v[48:49], v19 offset:32
    ds_read_b64_tr_b16 v[50:51], v19 offset:288
    v_lshrrev_b32 v52, 4, v0
    v_lshlrev_b32 v52, 5, v52
    v_bfe_u32 v60, v0, 1, 1
    v_lshl_add_u32 v52, v60, 4, v52
    v_and_b32 v60, 1, v0
    v_mul_u32_u24 v60, 192, v60
    v_add_u32 v52, v60, v52
    v_add_u32 v52, 160832, v52
    v_lshrrev_b32 v53, 4, v0
    v_lshlrev_b32 v53, 4, v53
    v_bfe_u32 v60, v0, 1, 1
    v_lshl_add_u32 v53, v60, 3, v53
    v_and_b32 v60, 1, v0
    v_mul_u32_u24 v60, 192, v60
    v_add_u32 v53, v60, v53
    v_add_u32 v53, 160960, v53
    v_mov_b64 v[20:21], 0
    v_mov_b64 v[22:23], 0
    v_mov_b64 v[24:25], 0
    v_mov_b64 v[26:27], 0
    s_lshr_b32 s57, s30, 1
    s_lshl_b32 s57, s57, 11
    s_lshl_b32 s58, s58, 1
    s_add_u32 s57, s57, s58
    s_lshl_b32 s58, s54, 8
    s_add_u32 s57, s57, s58
    v_and_b32 v54, 31, v0
    v_lshlrev_b32 v54, 2, v54
    v_lshrrev_b32 v60, 5, v0
    v_mul_u32_u24 v60, 6144, v60
    v_add_u32 v54, v60, v54
    v_add_u32 v54, s57, v54
    s_mul_i32 s59, s53, 12416
    s_add_u32 s59, s59, s62
    s_add_u32 s59, s59, 70656
    s_add_u32 s60, s59, 12288
    ds_read_b128 v[12:15], v52
    ds_read_b64 v[16:17], v53
    s_waitcnt lgkmcnt(1)
    v_smfmac_f32_16x16x64_bf16 v[20:23], v[12:15], v[28:35], v1
    v_smfmac_f32_16x16x64_bf16 v[24:27], v[12:15], v[40:47], v1
    s_waitcnt lgkmcnt(0)
    v_smfmac_f32_16x16x32_bf16 v[20:23], v[16:17], v[36:39], v1
    v_smfmac_f32_16x16x32_bf16 v[24:27], v[16:17], v[48:51], v1
    s_cmp_eq_u32 s55, 0
    s_nop 5
    v_add_f32 v12, v20, v22
    s_nop 1
    v_add_f32_dpp v12, v24, v26 quad_perm:[0,1,2,3] row_mask:0x2 bank_mask:0xf
    s_nop 1
    v_add_f32_dpp v12, v21, v23 quad_perm:[0,1,2,3] row_mask:0x4 bank_mask:0xf
    s_nop 1
    v_add_f32_dpp v12, v25, v27 quad_perm:[0,1,2,3] row_mask:0x8 bank_mask:0xf
    v_min_u32 v12, -2, v12
    s_cbranch_scc1 L_gs_42
    buffer_store_dword v12, v54, s[40:43], s59 offen
L_gb_43:
L_skip_41:
    s_cmp_eq_u32 s30, 5
    s_cbranch_scc0 L_skip_44
    global_load_dword v2, v3, s[26:27] sc1
L_skip_44:
    s_waitcnt vmcnt(36)
    s_barrier
    ds_read_b128 v[96:99], v8 offset:0
    ds_read_b128 v[100:103], v9 offset:0
    s_cmp_eq_u32 s30, 6
    s_cbranch_scc0 L_skip_45
    s_mul_i32 s57, s14, 3
    s_mov_b32 m0, 36864
    s_nop 0
    buffer_load_dwordx4 v3, s[48:51], s57 offen offset:0 nt lds
    s_mul_i32 s57, s14, 3
    s_add_u32 s57, s57, s15
    s_mov_b32 m0, 36864
    s_nop 0
    buffer_load_dwordx4 v3, s[48:51], s57 offen offset:1024 nt lds
    s_xor_b32 s57, s71, 4
    s_mul_i32 s57, s57, 196608
    s_add_u32 s57, s57, 1152
    s_xor_b32 s58, s71, 5
    s_mul_i32 s58, s58, 196608
    s_add_u32 s58, s58, 128
    s_mov_b32 m0, 141312
L_dma_46:
    s_waitcnt vmcnt(23)
    s_cmp_ge_u32 s70, 2
    s_cbranch_scc1 L_go_47
    s_waitcnt vmcnt(22)
    s_cmp_ge_u32 s70, 1
    s_cbranch_scc1 L_go_47
    s_waitcnt vmcnt(21)
L_go_47:
    buffer_load_dwordx4 v5, s[32:35], s57 offen offset:0 nt lds
    buffer_load_dwordx4 v6, s[32:35], s58 offen offset:1024 nt lds
    s_add_u32 s57, s57, 24576
    s_add_u32 s58, s58, 24576
    s_add_u32 m0, m0, 2048
    s_cmp_lg_u32 m0, 157696
    s_cbranch_scc1 L_dma_46
L_skip_45:
    s_waitcnt lgkmcnt(0)
    s_waitcnt vmcnt(36)
    s_barrier
    ds_read_b128 v[104:107], v8 offset:16384
    ds_read_b128 v[108:111], v9 offset:16384
    s_cmp_eq_u32 s30, 6
    s_cbranch_scc0 L_skip_48
    s_mul_i32 s57, s14, 4
    s_mov_b32 m0, 38912
    s_nop 0
    buffer_load_dwordx4 v3, s[48:51], s57 offen offset:0 nt lds
    s_mul_i32 s57, s14, 4
    s_add_u32 s57, s57, s15
    s_mov_b32 m0, 38912
    s_nop 0
    buffer_load_dwordx4 v3, s[48:51], s57 offen offset:1024 nt lds
    s_xor_b32 s57, s71, 4
    s_mul_i32 s57, s57, 196608
    s_add_u32 s57, s57, 1280
    s_xor_b32 s58, s71, 5
    s_mul_i32 s58, s58, 196608
    s_add_u32 s58, s58, 256
    s_mov_b32 m0, 92160
L_dma_49:
    s_waitcnt vmcnt(23)
    s_cmp_ge_u32 s70, 2
    s_cbranch_scc1 L_go_50
    s_waitcnt vmcnt(22)
    s_cmp_ge_u32 s70, 1
    s_cbranch_scc1 L_go_50
    s_waitcnt vmcnt(21)
L_go_50:
    buffer_load_dwordx4 v5, s[32:35], s57 offen offset:0 nt lds
    buffer_load_dwordx4 v6, s[32:35], s58 offen offset:1024 nt lds
    s_add_u32 s57, s57, 24576
    s_add_u32 s58, s58, 24576
    s_add_u32 m0, m0, 2048
    s_cmp_lg_u32 m0, 108544
    s_cbranch_scc1 L_dma_49
L_skip_48:
    s_waitcnt lgkmcnt(0)
    s_cmp_lg_u32 s30, 6
    s_cbranch_scc0 L_skip_51
    s_waitcnt vmcnt(0)
L_skip_51:
    s_waitcnt vmcnt(36)
    s_barrier
    ds_read_b128 v[112:115], v8 offset:32768
    ds_read_b128 v[116:119], v9 offset:32768
    s_cmp_eq_u32 s30, 6
    s_cbranch_scc0 L_skip_52
    s_mul_i32 s57, s14, 5
    s_mov_b32 m0, 40960
    s_nop 0
    buffer_load_dwordx4 v3, s[48:51], s57 offen offset:0 nt lds
    s_mul_i32 s57, s14, 5
    s_add_u32 s57, s57, s15
    s_mov_b32 m0, 40960
    s_nop 0
    buffer_load_dwordx4 v3, s[48:51], s57 offen offset:1024 nt lds
    s_xor_b32 s57, s71, 6
    s_mul_i32 s57, s57, 196608
    s_add_u32 s57, s57, 1024
    s_xor_b32 s58, s71, 7
    s_mul_i32 s58, s58, 196608
    s_add_u32 s58, s58, 0
    s_mov_b32 m0, 108544
L_dma_53:
    s_waitcnt vmcnt(23)
    s_cmp_ge_u32 s70, 2
    s_cbranch_scc1 L_go_54
    s_waitcnt vmcnt(22)
    s_cmp_ge_u32 s70, 1
    s_cbranch_scc1 L_go_54
    s_waitcnt vmcnt(21)
L_go_54:
    buffer_load_dwordx4 v5, s[32:35], s57 offen offset:0 nt lds
    buffer_load_dwordx4 v6, s[32:35], s58 offen offset:1024 nt lds
    s_add_u32 s57, s57, 24576
    s_add_u32 s58, s58, 24576
    s_add_u32 m0, m0, 2048
    s_cmp_lg_u32 m0, 124928
    s_cbranch_scc1 L_dma_53
L_skip_52:
    s_waitcnt lgkmcnt(0)
    s_cmp_eq_u32 s30, 5
    s_cbranch_scc0 L_skip_55
L_cw_56:
    v_readlane_b32 s57, v2, s31
    s_cmp_eq_u32 s57, 0
    s_cbranch_scc1 L_cr_57
    s_lshr_b32 s58, s63, 2
    s_xor_b32 s58, s58, s65
    s_and_b32 s58, s58, 1
    v_mov_b32 v25, s58
    s_sub_u32 s57, s57, 1
    s_cmp_eq_u32 s57, s63
    s_cselect_b32 s64, 1, 0
    s_cbranch_scc0 L_far_58
    s_lshl_b32 s57, s52, 2
    s_add_u32 s57, s57, s72
    s_mov_b64 exec, 1
    buffer_store_dword v25, v0, s[40:43], s57 offen offset:0
    s_mov_b64 exec, -1
L_fb_59:
L_skip_55:
    s_waitcnt vmcnt(36)
    s_barrier
    ds_read_b128 v[120:123], v8 offset:49152
    ds_read_b128 v[124:127], v9 offset:49152
    s_cmp_eq_u32 s30, 6
    s_cbranch_scc0 L_skip_60
    s_mul_i32 s57, s14, 6
    s_mov_b32 m0, 43008
    s_nop 0
    buffer_load_dwordx4 v3, s[48:51], s57 offen offset:0 nt lds
    s_mul_i32 s57, s14, 6
    s_add_u32 s57, s57, s15
    s_mov_b32 m0, 43008
    s_nop 0
    buffer_load_dwordx4 v3, s[48:51], s57 offen offset:1024 nt lds
    s_xor_b32 s57, s71, 6
    s_mul_i32 s57, s57, 196608
    s_add_u32 s57, s57, 1152
    s_xor_b32 s58, s71, 7
    s_mul_i32 s58, s58, 196608
    s_add_u32 s58, s58, 128
    s_mov_b32 m0, 124928
L_dma_61:
    s_waitcnt vmcnt(23)
    s_cmp_ge_u32 s70, 2
    s_cbranch_scc1 L_go_62
    s_waitcnt vmcnt(22)
    s_cmp_ge_u32 s70, 1
    s_cbranch_scc1 L_go_62
    s_waitcnt vmcnt(21)
L_go_62:
    buffer_load_dwordx4 v5, s[32:35], s57 offen offset:0 nt lds
    buffer_load_dwordx4 v6, s[32:35], s58 offen offset:1024 nt lds
    s_add_u32 s57, s57, 24576
    s_add_u32 s58, s58, 24576
    s_add_u32 m0, m0, 2048
    s_cmp_lg_u32 m0, 141312
    s_cbranch_scc1 L_dma_61
L_skip_60:
    s_waitcnt lgkmcnt(0)
    s_waitcnt vmcnt(36)
    s_barrier
    ds_read_b128 v[128:131], v8 offset:0
    ds_read_b128 v[132:135], v9 offset:0
    s_cmp_eq_u32 s30, 6
    s_cbranch_scc0 L_skip_63
    s_mul_i32 s57, s14, 7
    s_mov_b32 m0, 45056
    s_nop 0
    buffer_load_dwordx4 v3, s[48:51], s57 offen offset:0 nt lds
    s_mul_i32 s57, s14, 7
    s_add_u32 s57, s57, s15
    s_mov_b32 m0, 45056
    s_nop 0
    buffer_load_dwordx4 v3, s[48:51], s57 offen offset:1024 nt lds
    s_xor_b32 s57, s71, 6
    s_mul_i32 s57, s57, 196608
    s_add_u32 s57, s57, 1280
    s_xor_b32 s58, s71, 7
    s_mul_i32 s58, s58, 196608
    s_add_u32 s58, s58, 256
    s_mov_b32 m0, 141312
L_dma_64:
    s_waitcnt vmcnt(23)
    s_cmp_ge_u32 s70, 2
    s_cbranch_scc1 L_go_65
    s_waitcnt vmcnt(22)
    s_cmp_ge_u32 s70, 1
    s_cbranch_scc1 L_go_65
    s_waitcnt vmcnt(21)
L_go_65:
    buffer_load_dwordx4 v5, s[32:35], s57 offen offset:0 nt lds
    buffer_load_dwordx4 v6, s[32:35], s58 offen offset:1024 nt lds
    s_add_u32 s57, s57, 24576
    s_add_u32 s58, s58, 24576
    s_add_u32 m0, m0, 2048
    s_cmp_lg_u32 m0, 157696
    s_cbranch_scc1 L_dma_64
L_skip_63:
    s_waitcnt lgkmcnt(0)
    s_cmp_eq_u32 s30, 5
    s_cbranch_scc0 L_skip_66
    v_lshlrev_b32 v24, 2, v0
    buffer_load_dword v2, v24, s[40:43], s72 offen sc1
L_skip_66:
    s_waitcnt vmcnt(36)
    s_barrier
    ds_read_b128 v[136:139], v8 offset:16384
    ds_read_b128 v[140:143], v9 offset:16384
    s_cmp_eq_u32 s30, 6
    s_cbranch_scc0 L_skip_67
    s_mul_i32 s57, s14, 8
    s_mov_b32 m0, 47104
    s_nop 0
    buffer_load_dwordx4 v3, s[48:51], s57 offen offset:0 nt lds
    s_mul_i32 s57, s14, 8
    s_add_u32 s57, s57, s15
    s_mov_b32 m0, 47104
    s_nop 0
    buffer_load_dwordx4 v3, s[48:51], s57 offen offset:1024 nt lds
    s_xor_b32 s57, s71, 0
    s_mul_i32 s57, s57, 196608
    s_add_u32 s57, s57, 1024
    s_xor_b32 s58, s71, 2
    s_mul_i32 s58, s58, 196608
    s_add_u32 s58, s58, 0
    s_mov_b32 m0, 92160
L_dma_68:
    s_waitcnt vmcnt(23)
    s_cmp_ge_u32 s70, 2
    s_cbranch_scc1 L_go_69
    s_waitcnt vmcnt(22)
    s_cmp_ge_u32 s70, 1
    s_cbranch_scc1 L_go_69
    s_waitcnt vmcnt(21)
L_go_69:
    buffer_load_dwordx4 v7, s[36:39], s57 offen offset:0 nt lds
    buffer_load_dwordx4 v7, s[36:39], s58 offen offset:1024 nt lds
    s_add_u32 s57, s57, 24576
    s_add_u32 s58, s58, 24576
    s_add_u32 m0, m0, 2048
    s_cmp_lg_u32 m0, 108544
    s_cbranch_scc1 L_dma_68
L_skip_67:
    s_waitcnt lgkmcnt(0)
    s_waitcnt vmcnt(36)
    s_barrier
    ds_read_b128 v[144:147], v8 offset:32768
    ds_read_b128 v[148:151], v9 offset:32768
    s_cmp_eq_u32 s30, 6
    s_cbranch_scc0 L_skip_70
    s_mul_i32 s57, s14, 9
    s_mov_b32 m0, 49152
    s_nop 0
    buffer_load_dwordx4 v3, s[48:51], s57 offen offset:0 nt lds
    s_mul_i32 s57, s14, 9
    s_add_u32 s57, s57, s15
    s_mov_b32 m0, 49152
    s_nop 0
    buffer_load_dwordx4 v3, s[48:51], s57 offen offset:1024 nt lds
    s_xor_b32 s57, s71, 0
    s_mul_i32 s57, s57, 196608
    s_add_u32 s57, s57, 1152
    s_xor_b32 s58, s71, 2
    s_mul_i32 s58, s58, 196608
    s_add_u32 s58, s58, 128
    s_mov_b32 m0, 108544
L_dma_71:
    s_waitcnt vmcnt(23)
    s_cmp_ge_u32 s70, 2
    s_cbranch_scc1 L_go_72
    s_waitcnt vmcnt(22)
    s_cmp_ge_u32 s70, 1
    s_cbranch_scc1 L_go_72
    s_waitcnt vmcnt(21)
L_go_72:
    buffer_load_dwordx4 v7, s[36:39], s57 offen offset:0 nt lds
    buffer_load_dwordx4 v7, s[36:39], s58 offen offset:1024 nt lds
    s_add_u32 s57, s57, 24576
    s_add_u32 s58, s58, 24576
    s_add_u32 m0, m0, 2048
    s_cmp_lg_u32 m0, 124928
    s_cbranch_scc1 L_dma_71
L_skip_70:
    s_waitcnt lgkmcnt(0)
    s_cmp_eq_u32 s30, 5
    s_cbranch_scc0 L_skip_73
L_cw_74:
    s_waitcnt vmcnt(0)
    v_cmp_ne_u32 vcc, -1, v2
    s_mov_b32 s57, 0
    s_mov_b32 s68, 2
    s_cmp_eq_u32 s64, 0
    s_cbranch_scc1 L_cd_76
    s_cmp_lg_u32 vcc_hi, 0
    s_cbranch_scc1 L_cd_76
    s_cmp_lg_u32 vcc_lo, -1
    s_cbranch_scc1 L_cr_75
    v_cmp_eq_u32 vcc, 1, v2
    s_bcnt1_i32_b32 s68, vcc_lo
    s_mov_b32 s57, 1
L_cd_76:
    v_mov_b32 v37, 160768
    v_mov_b32 v38, s57
    ds_write_b32 v37, v38
    s_waitcnt lgkmcnt(0)
L_skip_73:
    s_waitcnt vmcnt(36)
    s_barrier
    ds_read_b128 v[152:155], v8 offset:49152
    ds_read_b128 v[156:159], v9 offset:49152
    s_cmp_eq_u32 s30, 6
    s_cbranch_scc0 L_skip_77
    s_mul_i32 s57, s14, 10
    s_mov_b32 m0, 51200
    s_nop 0
    buffer_load_dwordx4 v3, s[48:51], s57 offen offset:0 nt lds
    s_mul_i32 s57, s14, 10
    s_add_u32 s57, s57, s15
    s_mov_b32 m0, 51200
    s_nop 0
    buffer_load_dwordx4 v3, s[48:51], s57 offen offset:1024 nt lds
    s_xor_b32 s57, s71, 0
    s_mul_i32 s57, s57, 196608
    s_add_u32 s57, s57, 1280
    s_xor_b32 s58, s71, 2
    s_mul_i32 s58, s58, 196608
    s_add_u32 s58, s58, 256
    s_mov_b32 m0, 124928
L_dma_78:
    s_waitcnt vmcnt(23)
    s_cmp_ge_u32 s70, 2
    s_cbranch_scc1 L_go_79
    s_waitcnt vmcnt(22)
    s_cmp_ge_u32 s70, 1
    s_cbranch_scc1 L_go_79
    s_waitcnt vmcnt(21)
L_go_79:
    buffer_load_dwordx4 v7, s[36:39], s57 offen offset:0 nt lds
    buffer_load_dwordx4 v7, s[36:39], s58 offen offset:1024 nt lds
    s_add_u32 s57, s57, 24576
    s_add_u32 s58, s58, 24576
    s_add_u32 m0, m0, 2048
    s_cmp_lg_u32 m0, 141312
    s_cbranch_scc1 L_dma_78
L_skip_77:
    s_waitcnt lgkmcnt(0)
    v_lshrrev_b32 v8, 2, v0
    v_lshlrev_b32 v8, 7, v8
    v_bfe_u32 v60, v0, 3, 2
    v_lshl_add_u32 v8, v60, 5, v8
    v_and_b32 v60, 3, v0
    v_lshl_add_u32 v8, v60, 3, v8
    v_add_u32 v8, s61, v8
    v_xor_b32 v9, 32, v8
    v_xor_b32 v10, 64, v8
    v_xor_b32 v11, 96, v8
    v_mov_b32 v41, 160768
    ds_read_b32 v42, v41
    s_waitcnt lgkmcnt(0)
    v_readfirstlane_b32 s55, v42
    s_cmp_eq_u32 s55, 0
    s_cbranch_scc1 L_spread
L_spread_back:
    s_cmp_eq_u32 s30, 5
    s_cbranch_scc0 L_skip_91
    s_cmp_eq_u32 s52, 31
    s_cbranch_scc0 L_skip_92
    s_lshl_b32 s57, s31, 5
    v_mov_b32 v16, s57
    s_add_u32 s57, s68, 1
    v_mov_b32 v12, s57
    s_mov_b64 exec, 0x1
    global_store_dword v16, v12, s[26:27] offset:4 sc1
    s_mov_b64 exec, -1
L_skip_92:
L_skip_91:
    s_sub_u32 s58, s30, 1
    s_cmp_lt_u32 s58, 3
    s_cbranch_scc0 L_skip_93
    s_mul_i32 s59, s53, 12416
    s_add_u32 s59, s59, s62
    s_add_u32 s59, s59, 70656
    s_add_u32 s60, s59, 12288
    s_lshl_b32 s57, s58, 11
    v_lshlrev_b32 v48, 4, v0
    v_add_u32 v48, s57, v48
    v_and_b32 v49, 7, v0
    v_lshlrev_b32 v49, 3, v49
    s_add_u32 s57, s59, 6144
    buffer_load_dwordx4 v[12:15], v48, s[40:43], s59 offen offset:0 sc1 nt
    buffer_load_dwordx4 v[16:19], v48, s[40:43], s59 offen offset:1024 sc1 nt
    buffer_load_dwordx4 v[28:31], v48, s[40:43], s57 offen offset:0 sc1 nt
    buffer_load_dwordx4 v[32:35], v48, s[40:43], s57 offen offset:1024 sc1 nt
    buffer_load_dwordx2 v[24:25], v49, s[40:43], s60 offen sc1 nt
L_skip_93:
    s_waitcnt vmcnt(36)
    s_barrier
    ds_read_b64_tr_b16 v[160:161], v8 offset:0
    ds_read_b64_tr_b16 v[168:169], v9 offset:0
    ds_read_b64_tr_b16 v[176:177], v10 offset:0
    ds_read_b64_tr_b16 v[184:185], v11 offset:0
    s_cmp_eq_u32 s30, 6
    s_cbranch_scc0 L_skip_94
    s_mul_i32 s57, s14, 11
    s_mov_b32 m0, 53248
    s_nop 0
    buffer_load_dwordx4 v3, s[48:51], s57 offen offset:0 nt lds
    s_mul_i32 s57, s14, 11
    s_add_u32 s57, s57, s15
    s_mov_b32 m0, 53248
    s_nop 0
    buffer_load_dwordx4 v3, s[48:51], s57 offen offset:1024 nt lds
    s_xor_b32 s57, s71, 1
    s_mul_i32 s57, s57, 196608
    s_add_u32 s57, s57, 1024
    s_xor_b32 s58, s71, 3
    s_mul_i32 s58, s58, 196608
    s_add_u32 s58, s58, 0
    s_mov_b32 m0, 141312
L_dma_95:
    s_waitcnt vmcnt(23)
    s_cmp_ge_u32 s70, 2
    s_cbranch_scc1 L_go_96
    s_waitcnt vmcnt(22)
    s_cmp_ge_u32 s70, 1
    s_cbranch_scc1 L_go_96
    s_waitcnt vmcnt(21)
L_go_96:
    buffer_load_dwordx4 v7, s[36:39], s57 offen offset:0 nt lds
    buffer_load_dwordx4 v7, s[36:39], s58 offen offset:1024 nt lds
    s_add_u32 s57, s57, 24576
    s_add_u32 s58, s58, 24576
    s_add_u32 m0, m0, 2048
    s_cmp_lg_u32 m0, 157696
    s_cbranch_scc1 L_dma_95
L_skip_94:
    s_waitcnt lgkmcnt(0)
    s_waitcnt vmcnt(36)
    s_barrier
    ds_read_b64_tr_b16 v[192:193], v8 offset:16384
    ds_read_b64_tr_b16 v[200:201], v9 offset:16384
    ds_read_b64_tr_b16 v[208:209], v10 offset:16384
    ds_read_b64_tr_b16 v[216:217], v11 offset:16384
    s_cmp_eq_u32 s30, 6
    s_cbranch_scc0 L_skip_97
    s_mul_i32 s57, s14, 12
    s_mov_b32 m0, 55296
    s_nop 0
    buffer_load_dwordx4 v3, s[48:51], s57 offen offset:0 nt lds
    s_mul_i32 s57, s14, 12
    s_add_u32 s57, s57, s15
    s_mov_b32 m0, 55296
    s_nop 0
    buffer_load_dwordx4 v3, s[48:51], s57 offen offset:1024 nt lds
    s_xor_b32 s57, s71, 1
    s_mul_i32 s57, s57, 196608
    s_add_u32 s57, s57, 1152
    s_xor_b32 s58, s71, 3
    s_mul_i32 s58, s58, 196608
    s_add_u32 s58, s58, 128
    s_mov_b32 m0, 92160
L_dma_98:
    s_waitcnt vmcnt(23)
    s_cmp_ge_u32 s70, 2
    s_cbranch_scc1 L_go_99
    s_waitcnt vmcnt(22)
    s_cmp_ge_u32 s70, 1
    s_cbranch_scc1 L_go_99
    s_waitcnt vmcnt(21)
L_go_99:
    buffer_load_dwordx4 v7, s[36:39], s57 offen offset:0 nt lds
    buffer_load_dwordx4 v7, s[36:39], s58 offen offset:1024 nt lds
    s_add_u32 s57, s57, 24576
    s_add_u32 s58, s58, 24576
    s_add_u32 m0, m0, 2048
    s_cmp_lg_u32 m0, 108544
    s_cbranch_scc1 L_dma_98
L_skip_97:
    s_waitcnt lgkmcnt(0)
    s_sub_u32 s58, s30, 1
    s_cmp_lt_u32 s58, 3
    s_cbranch_scc0 L_skip_100
    s_lshl_b32 s57, s58, 7
    v_bfe_u32 v51, v0, 2, 2
    v_lshlrev_b32 v51, 5, v51
    v_lshrrev_b32 v60, 5, v0
    v_lshl_add_u32 v51, v60, 4, v51
    v_and_b32 v60, 3, v0
    v_lshl_add_u32 v51, v60, 2, v51
    v_bfe_u32 v60, v0, 4, 1
    v_lshl_add_u32 v51, v60, 1, v51
    v_add_u32 v51, s57, v51
    v_add_u32 v51, 157696, v51
    v_mov_b32 v60, 0x3c75e03e
    v_mov_b32 v61, 0x3a71d1e6
    v_mov_b32 v47, 0x3e13985d
    s_waitcnt vmcnt(0)
    v_pk_add_f32 v[36:37], v[28:29], v[32:33]
    v_pk_add_f32 v[38:39], v[30:31], v[34:35]
    s_nop 1
    v_permlane32_swap_b32 v36, v38
    v_permlane32_swap_b32 v37, v39
    v_pk_add_f32 v[36:37], v[36:37], v[38:39]
    s_nop 1
    v_permlane16_swap_b32 v36, v37
    v_add_f32 v36, v36, v37
    v_mul_f32 v6, 0x3dd53b95, v36
    v_add_f32_dpp v48, v24, v24 row_ror:4 row_mask:0xf bank_mask:0xf
    v_add_f32_dpp v49, v25, v25 row_ror:4 row_mask:0xf bank_mask:0xf
    v_pk_add_f32 v[20:21], v[12:13], v[16:17]
    v_pk_add_f32 v[22:23], v[14:15], v[18:19]
    v_add_f32_dpp v48, v48, v48 row_ror:2 row_mask:0xf bank_mask:0xf
    v_add_f32_dpp v49, v49, v49 row_ror:2 row_mask:0xf bank_mask:0xf
    v_permlane32_swap_b32 v20, v22
    v_permlane32_swap_b32 v21, v23
    v_add_f32_dpp v48, v48, v48 row_ror:1 row_mask:0xf bank_mask:0xf
    v_add_f32_dpp v49, v49, v49 row_ror:1 row_mask:0xf bank_mask:0xf
    v_pk_add_f32 v[20:21], v[20:21], v[22:23]
    v_mul_f32 v48, v48, v60
    v_fma_f32 v49, v49, v47, v61
    v_permlane16_swap_b32 v20, v21
    v_fma_f32 v49, -v48, v48, v49
    v_add_f32 v20, v20, v21
    v_max_f32 v49, v49, v61
    v_mul_f32 v50, v6, v48
    v_rsq_f32 v49, v49
    v_cmp_u_f32 vcc, v20, v20
    v_sub_f32 v20, v20, v50
    v_mul_f32 v20, v20, v49
    v_cvt_pk_bf16_f32 v20, v20, v20
    ds_write_b16 v51, v20
    s_waitcnt lgkmcnt(0)
L_skip_100:
    s_lshl_b32 s57, s30, 7
    s_add_u32 s57, s57, 158720
    v_lshrrev_b32 v58, 4, v0
    v_lshlrev_b32 v58, 5, v58
    v_bfe_u32 v60, v0, 1, 1
    v_lshl_add_u32 v58, v60, 4, v58
    v_bfe_u32 v60, v0, 2, 2
    v_lshl_add_u32 v58, v60, 2, v58
    v_and_b32 v60, 1, v0
    v_lshl_add_u32 v58, v60, 1, v58
    v_add_u32 v58, s57, v58
    v_lshrrev_b32 v61, 4, v0
    v_lshlrev_b32 v61, 5, v61
    v_bfe_u32 v60, v0, 1, 1
    v_lshl_add_u32 v61, v60, 4, v61
    v_add_u32 v61, s57, v61
    v_bfe_u32 v62, v0, 2, 2
    v_lshlrev_b32 v62, 1, v62
    v_and_b32 v60, 1, v0
    v_lshl_add_u32 v62, v60, 0, v62
    v_mov_b32 v60, 160992
    v_cmp_eq_u32 vcc, 0, v62
    s_nop 1
    v_cndmask_b32 v52, v60, v61, vcc
    v_cmp_eq_u32 vcc, 1, v62
    s_nop 1
    v_cndmask_b32 v53, v60, v61, vcc
    v_cmp_eq_u32 vcc, 2, v62
    s_nop 1
    v_cndmask_b32 v54, v60, v61, vcc
    v_cmp_eq_u32 vcc, 3, v62
    s_nop 1
    v_cndmask_b32 v55, v60, v61, vcc
    v_cmp_eq_u32 vcc, 4, v62
    s_nop 1
    v_cndmask_b32 v56, v60, v61, vcc
    v_cmp_eq_u32 vcc, 5, v62
    s_nop 1
    v_cndmask_b32 v57, v60, v61, vcc
    s_lshl_b32 s58, s30, 2
    s_add_u32 s58, s58, 159744
    v_mov_b32 v60, s58
    v_lshlrev_b32 v59, 2, v0
    v_add_u32 v59, 158208, v59
    v_cmp_eq_u32 vcc, 63, v0
    s_nop 1
    v_cndmask_b32 v59, v59, v60, vcc
    v_and_b32 v62, 7, v0
    v_lshlrev_b32 v62, 2, v62
    v_add_u32 v62, 159744, v62
    s_lshl_b32 s57, s30, 11
    v_lshlrev_b32 v63, 4, v0
    v_add_u32 v63, s57, v63
    v_add_u32 v63, 92160, v63
    s_waitcnt vmcnt(36)
    s_barrier
    ds_read_b64_tr_b16 v[224:225], v8 offset:32768
    ds_read_b64_tr_b16 v[232:233], v9 offset:32768
    ds_read_b64_tr_b16 v[240:241], v10 offset:32768
    ds_read_b64_tr_b16 v[248:249], v11 offset:32768
    s_cmp_eq_u32 s30, 6
    s_cbranch_scc0 L_skip_101
    s_mul_i32 s57, s14, 13
    s_mov_b32 m0, 57344
    s_nop 0
    buffer_load_dwordx4 v3, s[48:51], s57 offen offset:0 nt lds
    s_mul_i32 s57, s14, 13
    s_add_u32 s57, s57, s15
    s_mov_b32 m0, 57344
    s_nop 0
    buffer_load_dwordx4 v3, s[48:51], s57 offen offset:1024 nt lds
    s_xor_b32 s57, s71, 1
    s_mul_i32 s57, s57, 196608
    s_add_u32 s57, s57, 1280
    s_xor_b32 s58, s71, 3
    s_mul_i32 s58, s58, 196608
    s_add_u32 s58, s58, 256
    s_mov_b32 m0, 108544
L_dma_102:
    s_nop 0
    buffer_load_dwordx4 v7, s[36:39], s57 offen offset:0 nt lds
    buffer_load_dwordx4 v7, s[36:39], s58 offen offset:1024 nt lds
    s_add_u32 s57, s57, 24576
    s_add_u32 s58, s58, 24576
    s_add_u32 m0, m0, 2048
    s_cmp_lg_u32 m0, 124928
    s_cbranch_scc1 L_dma_102
L_skip_101:
    s_waitcnt lgkmcnt(0)
    v_lshrrev_b32 v5, 4, v0
    v_lshlrev_b32 v5, 5, v5
    v_bfe_u32 v60, v0, 1, 1
    v_lshl_add_u32 v5, v60, 4, v5
    v_add_u32 v5, 157696, v5
    ds_read_b128 v[12:15], v5 offset:0
    ds_read_b128 v[16:19], v5 offset:128
    ds_read_b128 v[20:23], v5 offset:256
    v_mov_b64 v[24:25], 0
    v_mov_b64 v[26:27], 0
    v_mov_b64 v[28:29], 0
    v_mov_b64 v[30:31], 0
    v_mov_b64 v[32:33], 0
    v_mov_b64 v[34:35], 0
    v_mov_b64 v[36:37], 0
    v_mov_b64 v[38:39], 0
    v_mov_b64 v[40:41], 0
    v_mov_b64 v[42:43], 0
    v_mov_b64 v[44:45], 0
    v_mov_b64 v[46:47], 0
    s_waitcnt lgkmcnt(0)
    v_smfmac_f32_16x16x64_bf16 v[24:27], v[12:15], v[64:71], v1
    v_smfmac_f32_16x16x64_bf16 v[24:27], v[16:19], v[72:79], v1
    v_smfmac_f32_16x16x64_bf16 v[24:27], v[20:23], v[80:87], v1
    v_smfmac_f32_16x16x64_bf16 v[28:31], v[12:15], v[88:95], v1
    v_smfmac_f32_16x16x64_bf16 v[28:31], v[16:19], v[96:103], v1
    v_smfmac_f32_16x16x64_bf16 v[28:31], v[20:23], v[104:111], v1
    v_smfmac_f32_16x16x64_bf16 v[32:35], v[12:15], v[112:119], v1
    v_smfmac_f32_16x16x64_bf16 v[32:35], v[16:19], v[120:127], v1
    v_smfmac_f32_16x16x64_bf16 v[32:35], v[20:23], v[128:135], v1
    v_smfmac_f32_16x16x64_bf16 v[36:39], v[12:15], v[136:143], v1
    v_smfmac_f32_16x16x64_bf16 v[36:39], v[16:19], v[144:151], v1
    v_smfmac_f32_16x16x64_bf16 v[36:39], v[20:23], v[152:159], v1
    v_add_f32 v24, v24, v26
    s_nop 0
    v_add_f32 v28, v28, v30
    s_nop 1
    v_add_f32 v32, v32, v34
    v_max3_f32 v61, v24, v28, v32
    v_mov_b32_dpp v24, v28 quad_perm:[0,1,2,3] row_mask:0x2 bank_mask:0xf
    v_add_f32 v36, v36, v38
    v_max_f32 v61, v61, v36
    v_mov_b32_dpp v24, v32 quad_perm:[0,1,2,3] row_mask:0x4 bank_mask:0xf
    s_nop 0
    v_max_f32_dpp v61, v61, v61 row_ror:8 row_mask:0xf bank_mask:0xf
    s_nop 0
    v_mov_b32_dpp v24, v36 quad_perm:[0,1,2,3] row_mask:0x8 bank_mask:0xf
    v_max_f32_dpp v61, v61, v61 row_ror:4 row_mask:0xf bank_mask:0xf
    s_nop 1
    v_max_f32_dpp v61, v61, v61 row_ror:2 row_mask:0xf bank_mask:0xf
    s_nop 1
    v_max_f32_dpp v61, v61, v61 row_ror:1 row_mask:0xf bank_mask:0xf
    v_sub_f32 v36, v24, v61
    ds_write_b32 v59, v61
    v_exp_f32 v36, v36
    s_nop 0
    v_cvt_pk_bf16_f32 v39, v36, v36
    ds_write_b16 v58, v39
    ds_read_b128 v[12:15], v52
    ds_read_b128 v[16:19], v53
    ds_read_b128 v[20:23], v54
    ds_read_b128 v[24:27], v55
    ds_read_b128 v[28:31], v56
    ds_read_b128 v[32:35], v57
    v_add_f32_dpp v38, v36, v36 row_ror:8 row_mask:0xf bank_mask:0xf
    s_nop 1
    v_add_f32_dpp v38, v38, v38 row_ror:4 row_mask:0xf bank_mask:0xf
    s_nop 1
    v_add_f32_dpp v38, v38, v38 row_ror:2 row_mask:0xf bank_mask:0xf
    s_nop 1
    v_add_f32_dpp v38, v38, v38 row_ror:1 row_mask:0xf bank_mask:0xf
    s_nop 1
    v_add_f32_dpp v38, v38, v38 row_bcast:15 row_mask:0xa bank_mask:0xf
    s_nop 1
    v_add_f32_dpp v38, v38, v38 row_bcast:31 row_mask:0xc bank_mask:0xf
    s_waitcnt lgkmcnt(0)
    s_waitcnt vmcnt(36)
    s_barrier
    ds_read_b64_tr_b16 v[162:163], v8 offset:49152
    ds_read_b64_tr_b16 v[170:171], v9 offset:49152
    ds_read_b64_tr_b16 v[178:179], v10 offset:49152
    ds_read_b64_tr_b16 v[186:187], v11 offset:49152
    s_cmp_eq_u32 s30, 6
    s_cbranch_scc0 L_skip_103
    s_mul_i32 s57, s14, 14
    s_mov_b32 m0, 59392
    s_nop 0
    buffer_load_dwordx4 v3, s[48:51], s57 offen offset:0 nt lds
    s_mul_i32 s57, s14, 14
    s_add_u32 s57, s57, s15
    s_mov_b32 m0, 59392
    s_nop 0
    buffer_load_dwordx4 v3, s[48:51], s57 offen offset:1024 nt lds
    s_xor_b32 s57, s71, 4
    s_mul_i32 s57, s57, 196608
    s_add_u32 s57, s57, 1024
    s_xor_b32 s58, s71, 6
    s_mul_i32 s58, s58, 196608
    s_add_u32 s58, s58, 0
    s_mov_b32 m0, 124928
L_dma_104:
    s_waitcnt vmcnt(23)
    s_cmp_ge_u32 s70, 2
    s_cbranch_scc1 L_go_105
    s_waitcnt vmcnt(22)
    s_cmp_ge_u32 s70, 1
    s_cbranch_scc1 L_go_105
    s_waitcnt vmcnt(21)
L_go_105:
    buffer_load_dwordx4 v7, s[36:39], s57 offen offset:0 nt lds
    buffer_load_dwordx4 v7, s[36:39], s58 offen offset:1024 nt lds
    s_add_u32 s57, s57, 24576
    s_add_u32 s58, s58, 24576
    s_add_u32 m0, m0, 2048
    s_cmp_lg_u32 m0, 141312
    s_cbranch_scc1 L_dma_104
L_skip_103:
    s_waitcnt lgkmcnt(0)
    ds_read_b32 v36, v62
    s_waitcnt lgkmcnt(0)
    v_max_f32_dpp v37, v36, v36 row_ror:4 row_mask:0xf bank_mask:0xf
    s_nop 1
    v_max_f32_dpp v37, v37, v37 row_ror:2 row_mask:0xf bank_mask:0xf
    s_nop 1
    v_max_f32_dpp v37, v37, v37 row_ror:1 row_mask:0xf bank_mask:0xf
    v_sub_f32 v39, v61, v37
    v_exp_f32 v39, v39
    s_cmp_lt_u32 s30, 2
    s_cbranch_scc0 L_skip_106
    s_lshl_b32 s57, s30, 3
    v_lshlrev_b32 v2, 4, v0
    v_add_u32 v2, s57, v2
    v_add_u32 v2, 92160, v2
    v_mov_b32 v60, 94192
    v_cmp_le_u32 vcc, 48, v0
    s_nop 1
    v_cndmask_b32 v2, v2, v60, vcc
    s_lshr_b32 s57, s54, 1
    s_lshl_b32 s57, s57, 2
    s_and_b32 s58, s54, 1
    s_add_u32 s57, s57, s58
    s_lshl_b32 s58, s57, 4
    s_lshl_b32 s57, s57, 3
    v_bfe_u32 v3, v0, 3, 2
    v_lshlrev_b32 v3, 8, v3
    v_bfe_u32 v61, v0, 2, 1
    v_lshl_add_u32 v3, v61, 5, v3
    v_and_b32 v61, 3, v0
    v_lshl_add_u32 v3, v61, 2, v3
    v_add_u32 v3, s58, v3
    v_bfe_u32 v60, v0, 3, 1
    v_lshlrev_b32 v60, 8, v60
    v_bfe_u32 v61, v0, 1, 1
    v_lshl_add_u32 v60, v61, 7, v60
    v_bfe_u32 v61, v0, 2, 1
    v_lshl_add_u32 v60, v61, 4, v60
    v_and_b32 v61, 1, v0
    v_lshl_add_u32 v60, v61, 2, v60
    v_add_u32 v60, s57, v60
    v_add_u32 v60, 1024, v60
    v_cmp_gt_u32 vcc, 32, v0
    s_nop 1
    v_cndmask_b32 v3, v60, v3, vcc
    s_lshl_b32 s57, s53, 1
    s_add_u32 s57, s57, s30
    s_mul_i32 s57, s57, 1664
    s_add_u32 s57, s57, s62
    v_add_u32 v3, s57, v3
    v_mov_b32 v60, 0x7f000000
    v_cmp_le_u32 vcc, 48, v0
    s_nop 1
    v_cndmask_b32 v3, v3, v60, vcc
    s_lshl_b32 s58, s54, 2
    s_add_u32 s57, s57, s58
    s_add_u32 s57, s57, 1536
    v_mov_b32 v4, s57
    v_mov_b32 v60, 0x7f000000
    v_cmp_ne_u32 vcc, 48, v0
    s_nop 1
    v_cndmask_b32 v4, v4, v60, vcc
    s_mov_b32 s58, 0
    v_min_u32 v37, -2, v37
    s_cmp_eq_u32 s55, 0
    s_cbranch_scc1 L_gs_107
    buffer_store_dword v37, v4, s[40:43], s58 offen
L_gb_108:
L_skip_106:
    s_cmp_eq_u32 s30, 2
    s_cbranch_scc0 L_skip_109
    v_lshlrev_b32 v2, 2, v0
    v_add_u32 v2, 157696, v2
    v_and_b32 v3, 15, v0
    v_lshlrev_b32 v3, 2, v3
    v_lshrrev_b32 v60, 5, v0
    v_lshl_add_u32 v3, v60, 6, v3
    v_bfe_u32 v60, v0, 4, 1
    v_lshl_add_u32 v3, v60, 13, v3
L_skip_109:
    s_waitcnt vmcnt(36)
    s_barrier
    ds_read_b64_tr_b16 v[194:195], v8 offset:0
    ds_read_b64_tr_b16 v[202:203], v9 offset:0
    ds_read_b64_tr_b16 v[210:211], v10 offset:0
    ds_read_b64_tr_b16 v[218:219], v11 offset:0
    s_cmp_eq_u32 s30, 6
    s_cbranch_scc0 L_skip_110
    s_mul_i32 s57, s14, 15
    s_mov_b32 m0, 61440
    s_nop 0
    buffer_load_dwordx4 v3, s[48:51], s57 offen offset:0 nt lds
    s_mul_i32 s57, s14, 15
    s_add_u32 s57, s57, s15
    s_mov_b32 m0, 61440
    s_nop 0
    buffer_load_dwordx4 v3, s[48:51], s57 offen offset:1024 nt lds
    s_xor_b32 s57, s71, 4
    s_mul_i32 s57, s57, 196608
    s_add_u32 s57, s57, 1152
    s_xor_b32 s58, s71, 6
    s_mul_i32 s58, s58, 196608
    s_add_u32 s58, s58, 128
    s_mov_b32 m0, 141312
L_dma_111:
    s_waitcnt vmcnt(23)
    s_cmp_ge_u32 s70, 2
    s_cbranch_scc1 L_go_112
    s_waitcnt vmcnt(22)
    s_cmp_ge_u32 s70, 1
    s_cbranch_scc1 L_go_112
    s_waitcnt vmcnt(21)
L_go_112:
    buffer_load_dwordx4 v7, s[36:39], s57 offen offset:0 nt lds
    buffer_load_dwordx4 v7, s[36:39], s58 offen offset:1024 nt lds
    s_add_u32 s57, s57, 24576
    s_add_u32 s58, s58, 24576
    s_add_u32 m0, m0, 2048
    s_cmp_lg_u32 m0, 157696
    s_cbranch_scc1 L_dma_111
L_skip_110:
    s_waitcnt lgkmcnt(0)
    s_waitcnt vmcnt(36)
    s_barrier
    ds_read_b64_tr_b16 v[226:227], v8 offset:16384
    ds_read_b64_tr_b16 v[234:235], v9 offset:16384
    ds_read_b64_tr_b16 v[242:243], v10 offset:16384
    ds_read_b64_tr_b16 v[250:251], v11 offset:16384
    s_cmp_eq_u32 s30, 6
    s_cbranch_scc0 L_skip_113
    s_xor_b32 s57, s71, 4
    s_mul_i32 s57, s57, 196608
    s_add_u32 s57, s57, 1280
    s_xor_b32 s58, s71, 6
    s_mul_i32 s58, s58, 196608
    s_add_u32 s58, s58, 256
    s_mov_b32 m0, 92160
L_dma_114:
    s_nop 0
    buffer_load_dwordx4 v7, s[36:39], s57 offen offset:0 nt lds
    buffer_load_dwordx4 v7, s[36:39], s58 offen offset:1024 nt lds
    s_add_u32 s57, s57, 24576
    s_add_u32 s58, s58, 24576
    s_add_u32 m0, m0, 2048
    s_cmp_lg_u32 m0, 108544
    s_cbranch_scc1 L_dma_114
L_skip_113:
    s_waitcnt lgkmcnt(0)
    s_cmp_eq_u32 s30, 5
    s_cbranch_scc0 L_skip_115
    global_load_dword v2, v3, s[26:27] offset:4 sc1
L_skip_115:
    s_waitcnt vmcnt(34)
    s_barrier
    ds_read_b64_tr_b16 v[164:165], v8 offset:32768
    ds_read_b64_tr_b16 v[172:173], v9 offset:32768
    ds_read_b64_tr_b16 v[180:181], v10 offset:32768
    ds_read_b64_tr_b16 v[188:189], v11 offset:32768
    s_cmp_eq_u32 s30, 6
    s_cbranch_scc0 L_skip_116
    s_xor_b32 s57, s71, 5
    s_mul_i32 s57, s57, 196608
    s_add_u32 s57, s57, 1024
    s_xor_b32 s58, s71, 7
    s_mul_i32 s58, s58, 196608
    s_add_u32 s58, s58, 0
    s_mov_b32 m0, 108544
L_dma_117:
    s_nop 0
    buffer_load_dwordx4 v7, s[36:39], s57 offen offset:0 nt lds
    buffer_load_dwordx4 v7, s[36:39], s58 offen offset:1024 nt lds
    s_add_u32 s57, s57, 24576
    s_add_u32 s58, s58, 24576
    s_add_u32 m0, m0, 2048
    s_cmp_lg_u32 m0, 124928
    s_cbranch_scc1 L_dma_117
L_skip_116:
    s_waitcnt lgkmcnt(0)
    s_waitcnt vmcnt(32)
    s_barrier
    ds_read_b64_tr_b16 v[196:197], v8 offset:49152
    ds_read_b64_tr_b16 v[204:205], v9 offset:49152
    ds_read_b64_tr_b16 v[212:213], v10 offset:49152
    ds_read_b64_tr_b16 v[220:221], v11 offset:49152
    s_cmp_eq_u32 s30, 6
    s_cbranch_scc0 L_skip_118
    s_xor_b32 s57, s71, 5
    s_mul_i32 s57, s57, 196608
    s_add_u32 s57, s57, 1152
    s_xor_b32 s58, s71, 7
    s_mul_i32 s58, s58, 196608
    s_add_u32 s58, s58, 128
    s_mov_b32 m0, 124928
L_dma_119:
    s_nop 0
    buffer_load_dwordx4 v7, s[36:39], s57 offen offset:0 nt lds
    buffer_load_dwordx4 v7, s[36:39], s58 offen offset:1024 nt lds
    s_add_u32 s57, s57, 24576
    s_add_u32 s58, s58, 24576
    s_add_u32 m0, m0, 2048
    s_cmp_lg_u32 m0, 141312
    s_cbranch_scc1 L_dma_119
L_skip_118:
    s_waitcnt lgkmcnt(0)
    s_cmp_eq_u32 s30, 5
    s_cbranch_scc0 L_skip_120
L_cw_121:
    s_waitcnt vmcnt(0)
    v_cmp_eq_u32 vcc, 0, v2
    s_cbranch_vccnz L_cr_122
    v_add_u32_dpp v2, v2, v2 row_ror:4 row_mask:0xf bank_mask:0xf
    s_nop 1
    v_add_u32_dpp v2, v2, v2 row_ror:2 row_mask:0xf bank_mask:0xf
    s_nop 1
    v_add_u32_dpp v2, v2, v2 row_ror:1 row_mask:0xf bank_mask:0xf
    v_mov_b32 v60, 160772
    ds_write_b32 v60, v2
    s_waitcnt lgkmcnt(0)
L_skip_120:
    s_cmp_lt_u32 s3, 20
    s_cbranch_scc0 L_skip_123
    s_mul_i32 s74, s30, 1664
    s_add_u32 s74, s74, s62
    s_add_u32 s74, s74, 0
    v_and_b32 v56, 7, v0
    v_lshlrev_b32 v56, 2, v56
    v_lshrrev_b32 v62, 4, v0
    v_lshlrev_b32 v62, 3, v62
    s_cmp_lg_u32 s30, 6
    s_cbranch_scc0 L_skip_123
    buffer_load_dword v52, v56, s[40:43], s74 offen offset:1536 sc1
    buffer_load_dwordx2 v[54:55], v62, s[40:43], s74 offen offset:1536 sc1
L_skip_123:
    s_cmp_eq_u32 s30, 2
    s_cbranch_scc0 L_skip_124
    s_sub_u32 s57, s3, 20
    s_cmp_lt_u32 s57, 4
    s_cbranch_scc0 L_skip_125
    s_sub_u32 s57, s3, 20
    s_lshl_b32 s57, s57, 6
    v_add_u32 v50, s57, v0
    v_min_u32 v50, 207, v50
    v_lshlrev_b32 v50, 7, v50
    s_add_u32 s57, s62, 0
    buffer_load_dword v50, v50, s[40:43], s57 offen sc1 nt
    s_sub_u32 s57, s3, 20
    s_lshl_b32 s57, s57, 6
    v_add_u32 v51, s57, v0
    v_min_u32 v51, 151, v51
    v_lshlrev_b32 v51, 7, v51
    s_add_u32 s57, s62, 26624
    buffer_load_dword v51, v51, s[40:43], s57 offen sc1 nt
    s_sub_u32 s57, s3, 20
    s_lshl_b32 s57, s57, 6
    v_add_u32 v49, s57, v0
    v_min_u32 v49, 191, v49
    v_lshlrev_b32 v49, 7, v49
    s_add_u32 s57, s62, 46080
    buffer_load_dword v49, v49, s[40:43], s57 offen sc1 nt
L_skip_125:
L_skip_124:
    s_waitcnt vmcnt(32)
    s_barrier
    ds_read_b64_tr_b16 v[228:229], v8 offset:0
    ds_read_b64_tr_b16 v[236:237], v9 offset:0
    ds_read_b64_tr_b16 v[244:245], v10 offset:0
    ds_read_b64_tr_b16 v[252:253], v11 offset:0
    s_cmp_eq_u32 s30, 6
    s_cbranch_scc0 L_skip_126
    s_xor_b32 s57, s71, 5
    s_mul_i32 s57, s57, 196608
    s_add_u32 s57, s57, 1280
    s_xor_b32 s58, s71, 7
    s_mul_i32 s58, s58, 196608
    s_add_u32 s58, s58, 256
    s_mov_b32 m0, 141312
L_dma_127:
    s_nop 0
    buffer_load_dwordx4 v7, s[36:39], s57 offen offset:0 nt lds
    buffer_load_dwordx4 v7, s[36:39], s58 offen offset:1024 nt lds
    s_add_u32 s57, s57, 24576
    s_add_u32 s58, s58, 24576
    s_add_u32 m0, m0, 2048
    s_cmp_lg_u32 m0, 157696
    s_cbranch_scc1 L_dma_127
L_skip_126:
    s_waitcnt lgkmcnt(0)
    s_cmp_ge_u32 s30, 6
    s_cbranch_scc0 L_skip_128
    v_mov_b32 v60, 160772
    ds_read_b32 v60, v60
    s_lshr_b32 s58, s63, 2
    s_waitcnt lgkmcnt(0)
    v_readfirstlane_b32 s57, v60
    s_cmp_gt_u32 s57, 24
    s_cselect_b32 s57, 1, 0
    s_xor_b32 s57, s57, s58
    s_lshl_b32 s57, s57, 13
    s_add_u32 s7, s8, s57
L_skip_128:
    s_branch L_tail
.p2align 10
L_tail:
L_pad0:
    s_cbranch_execz L_pad4
    s_waitcnt vmcnt(32)
    s_barrier
    ds_read_b64_tr_b16 v[166:167], v8 offset:16384
    ds_read_b64_tr_b16 v[174:175], v9 offset:16384
    ds_read_b64_tr_b16 v[182:183], v10 offset:16384
    ds_read_b64_tr_b16 v[190:191], v11 offset:16384
    s_waitcnt lgkmcnt(0)
    s_cmp_lt_u32 s30, 5
    s_cbranch_scc0 L_skip_129
    s_waitcnt vmcnt(0)
L_skip_129:
    s_cmp_lt_u32 s3, 20
    s_cbranch_scc0 L_skip_130
    v_lshlrev_b32 v57, 4, v0
    v_lshlrev_b32 v58, 3, v0
    s_mul_i32 s57, s30, 6144
    s_add_u32 s57, s57, 30720
    v_lshrrev_b32 v59, 2, v0
    v_lshlrev_b32 v59, 6, v59
    v_bfe_u32 v53, v0, 4, 1
    v_lshl_add_u32 v59, v53, 5, v59
    v_and_b32 v53, 3, v0
    v_lshl_add_u32 v59, v53, 3, v59
    v_add_u32 v59, s57, v59
    v_xor_b32 v60, 32, v59
    s_lshl_b32 s57, s30, 8
    s_add_u32 s57, s57, 157696
    v_lshl_add_u32 v61, v0, 2, s57
    s_cmp_lg_u32 s30, 6
    s_cbranch_scc0 L_skip_130
L_cw_131:
    s_waitcnt vmcnt(0)
    v_max3_u32 v53, v52, v54, v55
    v_cmp_eq_u32 vcc, -1, v53
    s_cbranch_vccnz L_cr_132
    v_max_f32_dpp v53, v52, v52 row_ror:4 row_mask:0xf bank_mask:0xf
    s_nop 1
    v_max_f32_dpp v53, v53, v53 row_ror:2 row_mask:0xf bank_mask:0xf
    s_nop 1
    v_max_f32_dpp v53, v53, v53 row_ror:1 row_mask:0xf bank_mask:0xf
    v_sub_f32 v52, v52, v53
    v_sub_f32 v54, v54, v53
    v_sub_f32 v55, v55, v53
    v_exp_f32 v52, v52
    v_exp_f32 v54, v54
    v_exp_f32 v55, v55
    s_cmp_eq_u32 s30, 7
    s_cbranch_scc0 L_skip_130
    v_add_u32 v62, 158720, v57
    ds_write_b128 v62, v[52:55]
    s_waitcnt lgkmcnt(0)
L_skip_130:
    v_smfmac_f32_16x16x64_bf16 v[40:43], v[12:15], v[160:167], v1
    v_smfmac_f32_16x16x64_bf16 v[40:43], v[16:19], v[168:175], v1
    v_smfmac_f32_16x16x64_bf16 v[40:43], v[20:23], v[176:183], v1
    v_smfmac_f32_16x16x64_bf16 v[40:43], v[24:27], v[184:191], v1
    s_cmp_eq_u32 s30, 6
    s_cbranch_scc0 L_skip_133
    s_mul_i32 s57, s14, 16
    s_add_u32 s58, s57, s15
    s_mov_b32 m0, 63488
L_dma_134:
    s_nop 0
    buffer_load_dwordx4 v3, s[48:51], s57 offen offset:0 nt lds
    buffer_load_dwordx4 v3, s[48:51], s58 offen offset:1024 nt lds
    s_add_u32 s57, s57, s14
    s_add_u32 s58, s58, s14
    s_add_u32 m0, m0, 2048
    s_cmp_lg_u32 m0, 71680
    s_cbranch_scc1 L_dma_134
    s_mul_i32 s57, s14, 20
    s_add_u32 s58, s57, s15
    s_mov_b32 m0, 71680
L_dma_135:
    s_nop 0
    buffer_load_dwordx4 v3, s[48:51], s57 offen offset:0 nt lds
    buffer_load_dwordx4 v3, s[48:51], s58 offen offset:1024 nt lds
    s_add_u32 s57, s57, s14
    s_add_u32 s58, s58, s14
    s_add_u32 m0, m0, 2048
    s_cmp_lg_u32 m0, 79872
    s_cbranch_scc1 L_dma_135
L_skip_133:
    s_waitcnt vmcnt(32)
    s_barrier
    ds_read_b64_tr_b16 v[198:199], v8 offset:32768
    ds_read_b64_tr_b16 v[206:207], v9 offset:32768
    ds_read_b64_tr_b16 v[214:215], v10 offset:32768
    ds_read_b64_tr_b16 v[222:223], v11 offset:32768
    s_waitcnt lgkmcnt(0)
    s_cmp_lt_u32 s3, 20
    s_cbranch_scc0 L_skip_136
    s_cmp_eq_u32 s30, 6
    s_cbranch_scc0 L_skip_136
    v_add_u32 v62, 158720, v57
    ds_read_b128 v[52:55], v62
L_skip_136:
L_pad1:
    s_cbranch_execz L_pad5
    v_smfmac_f32_16x16x64_bf16 v[40:43], v[28:31], v[192:199], v1
    v_smfmac_f32_16x16x64_bf16 v[40:43], v[32:35], v[200:207], v1
    v_smfmac_f32_16x16x64_bf16 v[44:47], v[12:15], v[208:215], v1
    v_smfmac_f32_16x16x64_bf16 v[44:47], v[16:19], v[216:223], v1
    v_mul_f32 v38, v38, v39
    ds_write_b32 v63, v38 offset:1024
    s_waitcnt vmcnt(16)
    s_barrier
    ds_read_b64_tr_b16 v[230:231], v8 offset:49152
    ds_read_b64_tr_b16 v[238:239], v9 offset:49152
    ds_read_b64_tr_b16 v[246:247], v10 offset:49152
    ds_read_b64_tr_b16 v[254:255], v11 offset:49152
    s_waitcnt lgkmcnt(0)
    v_smfmac_f32_16x16x64_bf16 v[44:47], v[20:23], v[224:231], v1
    v_smfmac_f32_16x16x64_bf16 v[44:47], v[24:27], v[232:239], v1
    v_smfmac_f32_16x16x64_bf16 v[44:47], v[28:31], v[240:247], v1
    v_smfmac_f32_16x16x64_bf16 v[44:47], v[32:35], v[248:255], v1
    s_setprio 0
    s_cmp_lt_u32 s30, 2
    v_pk_add_f32 v[40:41], v[40:41], v[42:43]
    s_nop 4
    v_pk_add_f32 v[42:43], v[44:45], v[46:47]
    v_pk_mul_f32 v[40:41], v[40:41], v[38:39] op_sel:[0,1] op_sel_hi:[1,1]
    v_pk_mul_f32 v[42:43], v[42:43], v[38:39] op_sel:[0,1] op_sel_hi:[1,1]
    ds_write_b128 v63, v[40:43]
    s_cbranch_scc1 L_comb_0
    s_waitcnt lgkmcnt(0)
    s_barrier
L_comb_0b:
    s_cmp_eq_u32 s30, 6
    s_cbranch_scc0 L_skip_141
    s_waitcnt vmcnt(0)
L_skip_141:
    s_barrier
    s_cmp_lt_u32 s3, 20
    s_cbranch_scc0 L_typeB_0
    buffer_load_dwordx4 v[12:15], v57, s[40:43], s74 offen sc1
    buffer_load_dwordx2 v[16:17], v58, s[40:43], s74 offen offset:1024 sc1
    buffer_load_dword v18, v56, s[40:43], s74 offen offset:1568 sc1
    ds_read_b64_tr_b16 v[28:29], v59 offset:0
    ds_read_b64_tr_b16 v[30:31], v59 offset:1024
    ds_read_b64_tr_b16 v[32:33], v59 offset:2048
    ds_read_b64_tr_b16 v[34:35], v59 offset:3072
    ds_read_b64_tr_b16 v[36:37], v59 offset:4096
    ds_read_b64_tr_b16 v[38:39], v59 offset:5120
    ds_read_b64_tr_b16 v[40:41], v60 offset:0
    ds_read_b64_tr_b16 v[42:43], v60 offset:1024
    ds_read_b64_tr_b16 v[44:45], v60 offset:2048
    ds_read_b64_tr_b16 v[46:47], v60 offset:3072
    ds_read_b64_tr_b16 v[48:49], v60 offset:4096
    ds_read_b64_tr_b16 v[50:51], v60 offset:5120
    v_mov_b64 v[20:21], 0
    v_mov_b64 v[22:23], 0
    v_mov_b64 v[24:25], 0
    v_mov_b64 v[26:27], 0
    s_add_u32 s58, s6, 0
    s_waitcnt lgkmcnt(0)
    s_branch L_pw_142
L_pr_143:
    buffer_load_dwordx4 v[12:15], v57, s[40:43], s74 offen sc1
    buffer_load_dwordx2 v[16:17], v58, s[40:43], s74 offen offset:1024 sc1
    buffer_load_dword v18, v56, s[40:43], s74 offen offset:1568 sc1
    s_sub_u32 s56, s56, 1
    s_cbranch_scc1 L_done
L_pw_142:
    s_waitcnt vmcnt(0)
    v_max3_u32 v19, v12, v13, v14
    v_max3_u32 v19, v19, v15, v16
    v_max3_u32 v19, v19, v17, v18
    v_cmp_eq_u32 vcc, -1, v19
    s_cbranch_vccnz L_pr_143
    v_smfmac_f32_16x16x64_bf16 v[20:23], v[12:15], v[28:35], v1
    v_mul_f32 v52, v52, v18
    v_smfmac_f32_16x16x64_bf16 v[24:27], v[12:15], v[40:47], v1
    v_smfmac_f32_16x16x32_bf16 v[20:23], v[16:17], v[36:39], v1
    v_add_f32_dpp v52, v52, v52 row_ror:4 row_mask:0xf bank_mask:0xf
    v_smfmac_f32_16x16x32_bf16 v[24:27], v[16:17], v[48:51], v1
    s_cmp_eq_u32 s30, 2
    v_add_f32_dpp v52, v52, v52 row_ror:2 row_mask:0xf bank_mask:0xf
    s_nop 1
    v_add_f32_dpp v52, v52, v52 row_ror:1 row_mask:0xf bank_mask:0xf
    v_rcp_f32 v52, v52
    v_pk_add_f32 v[20:21], v[20:21], v[22:23]
    s_nop 0
L_pad2:
    s_cbranch_execz L_pad6
    v_pk_add_f32 v[24:25], v[24:25], v[26:27]
    v_pk_mul_f32 v[54:55], v[54:55], v[52:53] op_sel:[0,0] op_sel_hi:[1,0]
    v_mul_f32 v20, v20, v54
    v_mul_f32 v24, v24, v54
    v_fmac_f32 v20, v21, v55
    v_fmac_f32 v24, v25, v55
    s_nop 1
    v_permlane32_swap_b32 v20, v24
    v_add_f32 v20, v20, v24
    ds_write_b32 v61, v20
    s_waitcnt lgkmcnt(0)
    s_barrier
    s_cbranch_scc0 L_finb_144
    ds_read2st64_b32 v[12:13], v2 offset0:0 offset1:1
    ds_read2st64_b32 v[14:15], v2 offset0:2 offset1:3
    ds_read2st64_b32 v[16:17], v2 offset0:4 offset1:5
    ds_read2st64_b32 v[18:19], v2 offset0:6 offset1:7
    s_waitcnt lgkmcnt(2)
    v_pk_add_f32 v[12:13], v[12:13], v[14:15]
    s_waitcnt lgkmcnt(0)
    v_pk_add_f32 v[16:17], v[16:17], v[18:19]
    v_pk_add_f32 v[12:13], v[12:13], v[16:17]
    v_add_f32 v14, v12, v13
    v_add_f32 v15, v12, v13
    s_nop 1
    v_permlane16_swap_b32 v14, v15
    v_add_f32 v12, v14, v15
    v_min_u32 v12, -2, v12
    buffer_store_dword v12, v3, s[40:43], s58 offen sc1
L_finb_144:
    s_sub_u32 s57, s30, 4
    s_cmp_lt_u32 s57, 3
    s_cbranch_scc0 L_skip_145
    s_sub_u32 s60, s30, 4
    s_lshl_b32 s57, s60, 11
    v_lshlrev_b32 v11, 4, v0
    v_add_u32 v11, s57, v11
    s_add_u32 s65, s62, 19456
    buffer_load_dwordx4 v[52:55], v11, s[40:43], s65 offen offset:0 sc1
    buffer_load_dwordx4 v[56:59], v11, s[40:43], s65 offen offset:1024 sc1
    s_lshl_b32 s59, s60, 12
    s_add_u32 s59, s59, 79872
    s_mov_b32 s44, s20
    s_mov_b32 s45, s21
    s_mov_b32 s46, 1966080
    s_mov_b32 s47, 0x20000
    s_mul_i32 s57, s31, 3
    s_add_u32 s57, s57, s60
    s_mul_i32 s57, s57, 81920
    s_lshl_b32 s64, s3, 6
    s_add_u32 s57, s57, s64
    v_lshrrev_b32 v5, 2, v0
    v_mul_u32_u24 v5, 1280, v5
    v_and_b32 v60, 3, v0
    v_lshl_add_u32 v5, v60, 4, v5
    v_add_u32 v5, s57, v5
    s_add_u32 m0, s59, 0
    s_mov_b32 s57, 0
    buffer_load_dwordx4 v5, s[44:47], s57 offen nt lds
    s_add_u32 m0, s59, 1024
    s_mov_b32 s57, 20480
    buffer_load_dwordx4 v5, s[44:47], s57 offen nt lds
    s_add_u32 m0, s59, 2048
    s_mov_b32 s57, 40960
    buffer_load_dwordx4 v5, s[44:47], s57 offen nt lds
    s_add_u32 m0, s59, 3072
    s_mov_b32 s57, 61440
    buffer_load_dwordx4 v5, s[44:47], s57 offen nt lds
    v_bfe_u32 v35, v0, 4, 1
    v_lshlrev_b32 v35, 11, v35
    v_bfe_u32 v60, v0, 2, 2
    v_lshl_add_u32 v35, v60, 8, v35
    v_lshrrev_b32 v60, 5, v0
    v_lshl_add_u32 v35, v60, 6, v35
    v_and_b32 v60, 3, v0
    v_lshl_add_u32 v35, v60, 3, v35
    v_add_u32 v35, s59, v35
    v_mov_b32 v9, 0xbdd2d3e8
    v_mov_b32 v10, 0xc0135761
    s_lshl_b32 s57, s60, 7
    s_add_u32 s57, s57, 159872
    v_lshlrev_b32 v32, 3, v0
    v_add_u32 v32, s57, v32
    v_lshlrev_b32 v33, 3, v0
    v_add_u32 v33, 129024, v33
    v_cmp_gt_u32 vcc, 16, v0
    s_nop 1
    v_cndmask_b32 v32, v33, v32, vcc
    v_and_b32 v33, 15, v0
L_pad3:
    s_cbranch_execz L_pad7
    v_lshlrev_b32 v33, 3, v33
    v_lshrrev_b32 v60, 5, v0
    v_lshl_add_u32 v33, v60, 2, v33
    v_add_u32 v33, 159872, v33
    v_and_b32 v34, 15, v0
    v_lshlrev_b32 v34, 2, v34
    v_lshrrev_b32 v60, 5, v0
    v_lshl_add_u32 v34, v60, 6, v34
    v_bfe_u32 v60, v0, 4, 1
    v_lshl_add_u32 v34, v60, 13, v34
    s_add_u32 s60, s6, 66048
    s_add_u32 s58, s62, 13312
    s_add_u32 s57, s62, 25856
    v_and_b32 v7, 7, v0
    v_lshlrev_b32 v7, 3, v7
    v_mov_b32 v60, 0x3acccccd
    v_mov_b32 v61, 0x3727c5ac
    s_waitcnt vmcnt(0)
    buffer_load_dwordx2 v[24:25], v7, s[40:43], s57 offen sc1
    buffer_load_dwordx4 v[12:15], v11, s[40:43], s58 offen offset:0 sc1
    buffer_load_dwordx4 v[16:19], v11, s[40:43], s58 offen offset:1024 sc1
    ds_read_b64_tr_b16 v[36:37], v35 offset:0
    ds_read_b64_tr_b16 v[38:39], v35 offset:1024
    ds_read_b64_tr_b16 v[40:41], v35 offset:128
    ds_read_b64_tr_b16 v[42:43], v35 offset:1152
    ds_read_b64_tr_b16 v[44:45], v35 offset:32
    ds_read_b64_tr_b16 v[46:47], v35 offset:1056
    ds_read_b64_tr_b16 v[48:49], v35 offset:160
    ds_read_b64_tr_b16 v[50:51], v35 offset:1184
L_sw_148:
    v_max3_u32 v20, v52, v53, v54
    v_max3_u32 v20, v20, v55, v56
    v_max3_u32 v20, v20, v57, v58
    v_max_u32 v20, v20, v59
    v_cmp_eq_u32 vcc, -1, v20
    s_cbranch_vccnz L_sr_149
    v_pk_add_f32 v[28:29], v[52:53], v[56:57]
    v_pk_add_f32 v[30:31], v[54:55], v[58:59]
    s_nop 1
    v_permlane32_swap_b32 v28, v30
    v_permlane32_swap_b32 v29, v31
    v_pk_add_f32 v[28:29], v[28:29], v[30:31]
    s_nop 1
    v_permlane16_swap_b32 v28, v29
    v_add_f32 v28, v28, v29
    v_mov_b64 v[52:53], 0
    v_mov_b64 v[54:55], 0
    v_mov_b64 v[56:57], 0
    v_mov_b64 v[58:59], 0
    s_waitcnt lgkmcnt(0)
L_pr_147:
    buffer_load_dwordx2 v[24:25], v7, s[40:43], s57 offen sc1
    buffer_load_dwordx4 v[12:15], v11, s[40:43], s58 offen offset:0 sc1
    buffer_load_dwordx4 v[16:19], v11, s[40:43], s58 offen offset:1024 sc1
    s_sub_u32 s56, s56, 1
    s_cbranch_scc1 L_done
L_pw_146:
    s_waitcnt vmcnt(3)
    v_max_u32 v20, v24, v25
    v_cmp_eq_u32 vcc, -1, v20
    s_cbranch_vccnz L_pr_147
    buffer_load_dwordx4 v[12:15], v11, s[40:43], s58 offen offset:0 sc1
    buffer_load_dwordx4 v[16:19], v11, s[40:43], s58 offen offset:1024 sc1
    v_add_f32_dpp v2, v24, v24 row_ror:4 row_mask:0xf bank_mask:0xf
    v_add_f32_dpp v3, v25, v25 row_ror:4 row_mask:0xf bank_mask:0xf
    v_pk_add_f32 v[20:21], v[12:13], v[16:17]
    v_pk_add_f32 v[22:23], v[14:15], v[18:19]
    v_add_f32_dpp v2, v2, v2 row_ror:2 row_mask:0xf bank_mask:0xf
    v_add_f32_dpp v3, v3, v3 row_ror:2 row_mask:0xf bank_mask:0xf
    v_permlane32_swap_b32 v20, v22
    v_permlane32_swap_b32 v21, v23
    v_add_f32_dpp v2, v2, v2 row_ror:1 row_mask:0xf bank_mask:0xf
    v_add_f32_dpp v3, v3, v3 row_ror:1 row_mask:0xf bank_mask:0xf
    v_pk_add_f32 v[20:21], v[20:21], v[22:23]
    v_mul_f32 v2, v2, v60
    v_fma_f32 v3, v3, v60, v61
    v_permlane16_swap_b32 v20, v21
    v_fma_f32 v3, -v2, v2, v3
    v_add_f32 v20, v20, v21
    v_max_f32 v3, v3, v61
    v_mul_f32 v26, v28, v2
    v_rsq_f32 v3, v3
    v_cmp_u_f32 vcc, v20, v20
    v_sub_f32 v20, v20, v26
    s_cbranch_vccnz L_hr_150
L_hk_151:
    v_fma_f32 v20, v20, v3, v4
L_pad4:
    s_cbranch_execz L_pad8
    v_mul_f32 v21, v20, v20
    v_fma_f32 v21, v21, v9, v10
    v_mul_f32 v21, v21, v20
    v_exp_f32 v21, v21
    s_nop 0
    v_add_f32 v21, 1.0, v21
    v_rcp_f32 v21, v21
    s_nop 0
    v_mul_f32 v20, v20, v21
    s_nop 1
    v_mov_b32_dpp v21, v20 row_shl:1 row_mask:0xf bank_mask:0xf bound_ctrl:0
    v_cvt_pk_bf16_f32 v28, v20, v21
    s_nop 1
    v_mov_b32_dpp v29, v28 row_shl:4 row_mask:0xf bank_mask:0xf bound_ctrl:0
    v_mov_b32_dpp v30, v28 row_shl:8 row_mask:0xf bank_mask:0xf bound_ctrl:0
    v_mov_b32_dpp v31, v28 row_shl:12 row_mask:0xf bank_mask:0xf bound_ctrl:0
    s_nop 1
    v_smfmac_f32_16x16x64_bf16 v[52:55], v[28:31], v[36:43], v1
    v_smfmac_f32_16x16x64_bf16 v[56:59], v[28:31], v[44:51], v1
    s_cmp_eq_u32 s30, 4
    s_nop 5
    v_add_f32 v22, v52, v54
    v_add_f32 v23, v56, v58
    ds_write_b64 v32, v[22:23]
    s_cbranch_scc0 L_skip_153
L_xw_154:
    ds_read2_b32 v[20:21], v33 offset0:0 offset1:32
    ds_read_b32 v22, v33 offset:256
    s_sub_u32 s56, s56, 1
    s_cbranch_scc1 L_done
    s_waitcnt lgkmcnt(0)
    v_max3_u32 v23, v20, v21, v22
    v_add_f32 v20, v20, v21
    v_cmp_eq_u32 vcc, -1, v23
    v_add_f32 v20, v20, v22
    s_cbranch_vccnz L_xw_154
    v_min_u32 v20, -2, v20
    buffer_store_dword v20, v34, s[40:43], s60 offen sc1
    s_waitcnt vmcnt(1)
    s_branch L_pe_155
L_skip_153:
    s_waitcnt vmcnt(0)
L_pe_155:
L_skip_145:
    s_branch L_p1
L_typeB_0:
    s_cmp_eq_u32 s53, 3
    s_cbranch_scc0 L_typeC_156
    s_cmp_eq_u32 s30, 7
    s_cbranch_scc1 L_w7_166
    s_cmp_lt_u32 s30, 6
    s_cbranch_scc0 L_skip_168
    s_lshr_b32 s57, s30, 1
    s_mul_i32 s57, s57, 128
    s_and_b32 s58, s30, 1
    s_lshl_b32 s58, s58, 6
    s_add_u32 s57, s57, s58
    v_lshrrev_b32 v18, 5, v0
    v_lshlrev_b32 v18, 13, v18
    v_bfe_u32 v60, v0, 3, 1
    v_lshl_add_u32 v18, v60, 12, v18
    v_bfe_u32 v60, v0, 4, 1
    v_lshl_add_u32 v18, v60, 11, v18
    v_bfe_u32 v60, v0, 2, 1
    v_mul_u32_u24 v60, 384, v60
    v_add_u32 v18, v60, v18
    v_and_b32 v60, 3, v0
    v_lshl_add_u32 v18, v60, 3, v18
    v_add_u32 v18, s57, v18
    v_add_u32 v18, 30720, v18
    v_bfe_u32 v19, v0, 4, 1
    v_lshlrev_b32 v19, 12, v19
    v_bfe_u32 v60, v0, 3, 1
    v_lshl_add_u32 v19, v60, 11, v19
    v_bfe_u32 v60, v0, 2, 1
    v_mul_u32_u24 v60, 384, v60
    v_add_u32 v19, v60, v19
    v_and_b32 v60, 3, v0
    v_lshl_add_u32 v19, v60, 3, v19
    v_add_u32 v19, s57, v19
    v_add_u32 v19, 63488, v19
    ds_read_b64_tr_b16 v[28:29], v18 offset:0
    ds_read_b64_tr_b16 v[30:31], v18 offset:1024
    ds_read_b64_tr_b16 v[32:33], v18 offset:16384
    ds_read_b64_tr_b16 v[34:35], v18 offset:17408
    ds_read_b64_tr_b16 v[36:37], v19 offset:0
    ds_read_b64_tr_b16 v[38:39], v19 offset:1024
    ds_read_b64_tr_b16 v[40:41], v18 offset:32
    ds_read_b64_tr_b16 v[42:43], v18 offset:1056
    ds_read_b64_tr_b16 v[44:45], v18 offset:16416
    ds_read_b64_tr_b16 v[46:47], v18 offset:17440
    ds_read_b64_tr_b16 v[48:49], v19 offset:32
L_pad5:
    s_cbranch_execz L_pad9
    ds_read_b64_tr_b16 v[50:51], v19 offset:1056
    v_lshrrev_b32 v9, 4, v0
    v_lshlrev_b32 v9, 5, v9
    v_bfe_u32 v60, v0, 1, 1
    v_lshl_add_u32 v9, v60, 4, v9
    v_and_b32 v60, 1, v0
    v_mul_u32_u24 v60, 192, v60
    v_add_u32 v9, v60, v9
    v_add_u32 v9, 160832, v9
    v_lshrrev_b32 v10, 4, v0
    v_lshlrev_b32 v10, 4, v10
    v_bfe_u32 v60, v0, 1, 1
    v_lshl_add_u32 v10, v60, 3, v10
    v_and_b32 v60, 1, v0
    v_mul_u32_u24 v60, 192, v60
    v_add_u32 v10, v60, v10
    v_add_u32 v10, 160960, v10
    v_mov_b64 v[20:21], 0
    v_mov_b64 v[22:23], 0
    v_mov_b64 v[24:25], 0
    v_mov_b64 v[26:27], 0
    s_lshr_b32 s57, s30, 1
    s_lshl_b32 s57, s57, 11
    s_lshl_b32 s58, s58, 1
    s_add_u32 s57, s57, s58
    s_lshl_b32 s58, s54, 8
    s_add_u32 s57, s57, s58
    v_and_b32 v11, 31, v0
    v_lshlrev_b32 v11, 2, v11
    v_lshrrev_b32 v60, 5, v0
    v_lshl_add_u32 v11, v60, 30, v11
    v_add_u32 v11, s57, v11
    s_add_u32 s59, s62, 13312
    s_add_u32 s60, s62, 25856
    ds_read_b128 v[12:15], v9
    ds_read_b64 v[16:17], v10
    s_waitcnt lgkmcnt(1)
    v_smfmac_f32_16x16x64_bf16 v[20:23], v[12:15], v[28:35], v1
    v_smfmac_f32_16x16x64_bf16 v[24:27], v[12:15], v[40:47], v1
    s_waitcnt lgkmcnt(0)
    v_smfmac_f32_16x16x32_bf16 v[20:23], v[16:17], v[36:39], v1
    v_smfmac_f32_16x16x32_bf16 v[24:27], v[16:17], v[48:51], v1
    s_add_u32 s60, s62, 19456
    s_cmp_eq_u32 s55, 0
    s_nop 4
    v_add_f32 v12, v21, v23
    s_nop 1
    v_add_f32_dpp v12, v25, v27 quad_perm:[0,1,2,3] row_mask:0x2 bank_mask:0xf
    v_min_u32 v12, -2, v12
    s_cbranch_scc1 L_gs_169
    buffer_store_dword v12, v11, s[40:43], s60 offen
L_gb_170:
    v_mov_b64 v[20:21], 0
    v_mov_b64 v[22:23], 0
    v_mov_b64 v[24:25], 0
    v_mov_b64 v[26:27], 0
L_skip_168:
    s_cmp_lt_u32 s30, 6
    s_barrier
    s_cbranch_scc0 L_se_167
    ds_read_b128 v[12:15], v9
    ds_read_b64 v[16:17], v10
    s_waitcnt lgkmcnt(1)
    v_smfmac_f32_16x16x64_bf16 v[20:23], v[12:15], v[28:35], v1
    v_smfmac_f32_16x16x64_bf16 v[24:27], v[12:15], v[40:47], v1
    s_waitcnt lgkmcnt(0)
    v_smfmac_f32_16x16x32_bf16 v[20:23], v[16:17], v[36:39], v1
    v_smfmac_f32_16x16x32_bf16 v[24:27], v[16:17], v[48:51], v1
    s_cmp_eq_u32 s55, 0
    s_nop 5
    v_add_f32 v12, v20, v22
    s_nop 1
    v_add_f32_dpp v12, v24, v26 quad_perm:[0,1,2,3] row_mask:0x2 bank_mask:0xf
    v_min_u32 v12, -2, v12
    s_cbranch_scc1 L_gs_171
    buffer_store_dword v12, v11, s[40:43], s59 offen
L_gb_172:
L_se_167:
L_p1:
    s_lshl_b32 s57, s30, 7
    s_add_u32 s57, s57, 158720
    v_lshrrev_b32 v58, 4, v0
    v_lshlrev_b32 v58, 5, v58
    v_bfe_u32 v60, v0, 1, 1
    v_lshl_add_u32 v58, v60, 4, v58
    v_bfe_u32 v60, v0, 2, 2
    v_lshl_add_u32 v58, v60, 2, v58
    v_and_b32 v60, 1, v0
    v_lshl_add_u32 v58, v60, 1, v58
    v_add_u32 v58, s57, v58
    v_lshrrev_b32 v61, 4, v0
    v_lshlrev_b32 v61, 5, v61
    v_bfe_u32 v60, v0, 1, 1
    v_lshl_add_u32 v61, v60, 4, v61
    v_add_u32 v61, s57, v61
L_pad6:
    s_cbranch_execz L_pad10
    v_bfe_u32 v62, v0, 2, 2
    v_lshlrev_b32 v62, 1, v62
    v_and_b32 v60, 1, v0
    v_lshl_add_u32 v62, v60, 0, v62
    v_mov_b32 v60, 160992
    v_cmp_eq_u32 vcc, 0, v62
    s_nop 1
    v_cndmask_b32 v52, v60, v61, vcc
    v_cmp_eq_u32 vcc, 1, v62
    s_nop 1
    v_cndmask_b32 v53, v60, v61, vcc
    v_cmp_eq_u32 vcc, 2, v62
    s_nop 1
    v_cndmask_b32 v54, v60, v61, vcc
    v_cmp_eq_u32 vcc, 3, v62
    s_nop 1
    v_cndmask_b32 v55, v60, v61, vcc
    v_cmp_eq_u32 vcc, 4, v62
    s_nop 1
    v_cndmask_b32 v56, v60, v61, vcc
    v_cmp_eq_u32 vcc, 5, v62
    s_nop 1
    v_cndmask_b32 v57, v60, v61, vcc
    s_lshl_b32 s58, s30, 2
    s_add_u32 s58, s58, 159808
    v_mov_b32 v60, s58
    v_lshlrev_b32 v59, 2, v0
    v_add_u32 v59, 158208, v59
    v_cmp_eq_u32 vcc, 63, v0
    s_nop 1
    v_cndmask_b32 v59, v59, v60, vcc
    v_and_b32 v62, 7, v0
    v_lshlrev_b32 v62, 2, v62
    v_add_u32 v62, 159808, v62
    s_lshl_b32 s57, s30, 11
    v_lshlrev_b32 v63, 4, v0
    v_add_u32 v63, s57, v63
    v_add_u32 v63, 92160, v63
    s_sub_u32 s57, s30, 1
    s_lshl_b32 s58, s57, 11
    v_lshlrev_b32 v7, 4, v0
    v_add_u32 v7, s58, v7
    s_lshl_b32 s58, s57, 7
    v_bfe_u32 v8, v0, 2, 2
    v_lshlrev_b32 v8, 5, v8
    v_lshrrev_b32 v60, 5, v0
    v_lshl_add_u32 v8, v60, 4, v8
    v_and_b32 v60, 3, v0
    v_lshl_add_u32 v8, v60, 2, v8
    v_bfe_u32 v60, v0, 4, 1
    v_lshl_add_u32 v8, v60, 1, v8
    v_add_u32 v8, s58, v8
    v_add_u32 v8, 124928, v8
    s_cmp_eq_u32 s30, 7
    s_cbranch_scc1 L_w7_180
    s_cmp_lt_u32 s30, 6
    s_cbranch_scc0 L_skip_182
    s_lshr_b32 s57, s30, 1
    s_mul_i32 s57, s57, 1024
    s_and_b32 s58, s30, 1
    s_lshl_b32 s58, s58, 6
    s_add_u32 s57, s57, s58
    v_lshrrev_b32 v18, 5, v0
    v_mul_u32_u24 v18, 6144, v18
    v_bfe_u32 v60, v0, 3, 1
    v_mul_u32_u24 v60, 3072, v60
    v_add_u32 v18, v60, v18
    v_bfe_u32 v60, v0, 4, 1
    v_lshl_add_u32 v18, v60, 9, v18
    v_bfe_u32 v60, v0, 2, 1
    v_lshl_add_u32 v18, v60, 7, v18
    v_and_b32 v60, 3, v0
    v_lshl_add_u32 v18, v60, 3, v18
    v_add_u32 v18, s57, v18
    v_bfe_u32 v19, v0, 4, 1
    v_mul_u32_u24 v19, 3072, v19
    v_bfe_u32 v60, v0, 3, 1
    v_lshl_add_u32 v19, v60, 9, v19
    v_bfe_u32 v60, v0, 2, 1
    v_lshl_add_u32 v19, v60, 7, v19
    v_and_b32 v60, 3, v0
    v_lshl_add_u32 v19, v60, 3, v19
    v_add_u32 v19, s57, v19
    v_add_u32 v19, 24576, v19
    ds_read_b64_tr_b16 v[28:29], v18 offset:0
    ds_read_b64_tr_b16 v[30:31], v18 offset:256
    ds_read_b64_tr_b16 v[32:33], v18 offset:12288
    ds_read_b64_tr_b16 v[34:35], v18 offset:12544
    ds_read_b64_tr_b16 v[36:37], v19 offset:0
    ds_read_b64_tr_b16 v[38:39], v19 offset:256
    ds_read_b64_tr_b16 v[40:41], v18 offset:32
L_pad7:
    s_cbranch_execz L_pad11
    ds_read_b64_tr_b16 v[42:43], v18 offset:288
    ds_read_b64_tr_b16 v[44:45], v18 offset:12320
    ds_read_b64_tr_b16 v[46:47], v18 offset:12576
    ds_read_b64_tr_b16 v[48:49], v19 offset:32
    ds_read_b64_tr_b16 v[50:51], v19 offset:288
    v_lshrrev_b32 v9, 4, v0
    v_lshlrev_b32 v9, 5, v9
    v_bfe_u32 v60, v0, 1, 1
    v_lshl_add_u32 v9, v60, 4, v9
    v_and_b32 v60, 1, v0
    v_mul_u32_u24 v60, 192, v60
    v_add_u32 v9, v60, v9
    v_add_u32 v9, 160832, v9
    v_lshrrev_b32 v10, 4, v0
    v_lshlrev_b32 v10, 4, v10
    v_bfe_u32 v60, v0, 1, 1
    v_lshl_add_u32 v10, v60, 3, v10
    v_and_b32 v60, 1, v0
    v_mul_u32_u24 v60, 192, v60
    v_add_u32 v10, v60, v10
    v_add_u32 v10, 160960, v10
    v_mov_b64 v[20:21], 0
    v_mov_b64 v[22:23], 0
    v_mov_b64 v[24:25], 0
    v_mov_b64 v[26:27], 0
    s_lshr_b32 s57, s30, 1
    s_lshl_b32 s57, s57, 11
    s_lshl_b32 s58, s58, 1
    s_add_u32 s57, s57, s58
    s_lshl_b32 s58, s54, 8
    s_add_u32 s57, s57, s58
    v_and_b32 v11, 31, v0
    v_lshlrev_b32 v11, 2, v11
    v_lshrrev_b32 v60, 5, v0
    v_lshl_add_u32 v11, v60, 30, v11
    v_add_u32 v11, s57, v11
    s_mul_i32 s59, s53, 6144
    s_add_u32 s59, s59, s62
    s_add_u32 s59, s59, 46080
    s_lshl_b32 s60, s53, 6
    s_add_u32 s60, s60, s62
    s_add_u32 s60, s60, 25600
L_skip_182:
    s_cmp_lt_u32 s30, 6
    s_barrier
    s_cbranch_scc0 L_se_181
    ds_read_b128 v[12:15], v9
    ds_read_b64 v[16:17], v10
    s_waitcnt lgkmcnt(1)
    v_smfmac_f32_16x16x64_bf16 v[20:23], v[12:15], v[28:35], v1
    v_smfmac_f32_16x16x64_bf16 v[24:27], v[12:15], v[40:47], v1
    s_waitcnt lgkmcnt(0)
    v_smfmac_f32_16x16x32_bf16 v[20:23], v[16:17], v[36:39], v1
    v_smfmac_f32_16x16x32_bf16 v[24:27], v[16:17], v[48:51], v1
    s_cmp_eq_u32 s55, 0
    s_nop 5
    v_add_f32 v12, v20, v22
    s_nop 1
    v_add_f32_dpp v12, v24, v26 quad_perm:[0,1,2,3] row_mask:0x2 bank_mask:0xf
    v_min_u32 v12, -2, v12
    s_cbranch_scc1 L_gs_183
    buffer_store_dword v12, v11, s[40:43], s59 offen
L_gb_184:
L_se_181:
    s_sub_u32 s57, s30, 1
    s_cmp_lt_u32 s57, 3
    s_cbranch_scc0 L_qo_198
    v_and_b32 v9, 7, v0
    v_lshlrev_b32 v9, 3, v9
    buffer_load_dwordx2 v[10:11], v9, s[40:43], s60 offen sc1
    buffer_load_dwordx4 v[12:15], v7, s[40:43], s59 offen offset:0 sc1
    buffer_load_dwordx4 v[16:19], v7, s[40:43], s59 offen offset:1024 sc1
    v_mov_b64 v[24:25], 0
    v_mov_b64 v[26:27], 0
    v_mov_b64 v[28:29], 0
    v_mov_b64 v[30:31], 0
    v_mov_b64 v[32:33], 0
    v_mov_b64 v[34:35], 0
    v_mov_b64 v[36:37], 0
    v_mov_b64 v[38:39], 0
    v_mov_b64 v[40:41], 0
    v_mov_b64 v[42:43], 0
    v_mov_b64 v[44:45], 0
    v_mov_b64 v[46:47], 0
    v_lshrrev_b32 v5, 4, v0
    v_lshlrev_b32 v5, 5, v5
    v_bfe_u32 v60, v0, 1, 1
    v_lshl_add_u32 v5, v60, 4, v5
    v_add_u32 v5, 124928, v5
    v_mov_b32 v60, 0x3c75e03e
    v_mov_b32 v61, 0x3a71d1e6
    v_mov_b32 v51, 0x3e13985d
    s_branch L_pw_200
L_pr_201:
    buffer_load_dwordx2 v[10:11], v9, s[40:43], s60 offen sc1
L_pad8:
    s_cbranch_execz L_pad12
    buffer_load_dwordx4 v[12:15], v7, s[40:43], s59 offen offset:0 sc1
    buffer_load_dwordx4 v[16:19], v7, s[40:43], s59 offen offset:1024 sc1
    s_sub_u32 s56, s56, 1
    s_cbranch_scc1 L_done
L_pw_200:
    s_waitcnt vmcnt(0)
    v_max_u32 v20, v10, v11
    v_cmp_eq_u32 vcc, -1, v20
    s_cbranch_vccnz L_pr_201
    v_add_f32_dpp v48, v10, v10 row_ror:4 row_mask:0xf bank_mask:0xf
    v_add_f32_dpp v49, v11, v11 row_ror:4 row_mask:0xf bank_mask:0xf
    v_pk_add_f32 v[20:21], v[12:13], v[16:17]
    v_pk_add_f32 v[22:23], v[14:15], v[18:19]
    v_add_f32_dpp v48, v48, v48 row_ror:2 row_mask:0xf bank_mask:0xf
    v_add_f32_dpp v49, v49, v49 row_ror:2 row_mask:0xf bank_mask:0xf
    v_permlane32_swap_b32 v20, v22
    v_permlane32_swap_b32 v21, v23
    v_add_f32_dpp v48, v48, v48 row_ror:1 row_mask:0xf bank_mask:0xf
    v_add_f32_dpp v49, v49, v49 row_ror:1 row_mask:0xf bank_mask:0xf
    v_pk_add_f32 v[20:21], v[20:21], v[22:23]
    v_mul_f32 v48, v48, v60
    v_fma_f32 v49, v49, v51, v61
    v_permlane16_swap_b32 v20, v21
    v_fma_f32 v49, -v48, v48, v49
    v_add_f32 v20, v20, v21
    v_max_f32 v49, v49, v61
    v_mul_f32 v50, v6, v48
    v_rsq_f32 v49, v49
    v_cmp_u_f32 vcc, v20, v20
    v_sub_f32 v20, v20, v50
    s_cbranch_vccnz L_hr_202
L_hk_203:
    v_mul_f32 v20, v20, v49
    v_cvt_pk_bf16_f32 v20, v20, v20
    ds_write_b16 v8, v20
L_qb_199:
    s_waitcnt lgkmcnt(0)
    s_barrier
    ds_read_b128 v[12:15], v5 offset:0
    ds_read_b128 v[16:19], v5 offset:128
    ds_read_b128 v[20:23], v5 offset:256
    s_waitcnt lgkmcnt(0)
    v_smfmac_f32_16x16x64_bf16 v[24:27], v[12:15], v[64:71], v1
    v_smfmac_f32_16x16x64_bf16 v[24:27], v[16:19], v[72:79], v1
    v_smfmac_f32_16x16x64_bf16 v[24:27], v[20:23], v[80:87], v1
    v_smfmac_f32_16x16x64_bf16 v[28:31], v[12:15], v[88:95], v1
    v_smfmac_f32_16x16x64_bf16 v[28:31], v[16:19], v[96:103], v1
    v_smfmac_f32_16x16x64_bf16 v[28:31], v[20:23], v[104:111], v1
    v_smfmac_f32_16x16x64_bf16 v[32:35], v[12:15], v[112:119], v1
    v_smfmac_f32_16x16x64_bf16 v[32:35], v[16:19], v[120:127], v1
    v_smfmac_f32_16x16x64_bf16 v[32:35], v[20:23], v[128:135], v1
    v_smfmac_f32_16x16x64_bf16 v[36:39], v[12:15], v[136:143], v1
    v_smfmac_f32_16x16x64_bf16 v[36:39], v[16:19], v[144:151], v1
    v_smfmac_f32_16x16x64_bf16 v[36:39], v[20:23], v[152:159], v1
    v_add_f32 v24, v24, v26
    s_nop 0
    v_add_f32 v28, v28, v30
    s_nop 1
    v_add_f32 v32, v32, v34
    v_max3_f32 v61, v24, v28, v32
    v_mov_b32_dpp v24, v28 quad_perm:[0,1,2,3] row_mask:0x2 bank_mask:0xf
    v_add_f32 v36, v36, v38
    v_max_f32 v61, v61, v36
    v_mov_b32_dpp v24, v32 quad_perm:[0,1,2,3] row_mask:0x4 bank_mask:0xf
    s_nop 0
    v_max_f32_dpp v61, v61, v61 row_ror:8 row_mask:0xf bank_mask:0xf
    s_nop 0
    v_mov_b32_dpp v24, v36 quad_perm:[0,1,2,3] row_mask:0x8 bank_mask:0xf
    v_max_f32_dpp v61, v61, v61 row_ror:4 row_mask:0xf bank_mask:0xf
    s_nop 1
    v_max_f32_dpp v61, v61, v61 row_ror:2 row_mask:0xf bank_mask:0xf
    s_nop 1
    v_max_f32_dpp v61, v61, v61 row_ror:1 row_mask:0xf bank_mask:0xf
    v_sub_f32 v36, v24, v61
    ds_write_b32 v59, v61
    v_exp_f32 v36, v36
    s_nop 0
    v_cvt_pk_bf16_f32 v39, v36, v36
    ds_write_b16 v58, v39
    ds_read_b128 v[12:15], v52
    ds_read_b128 v[16:19], v53
    ds_read_b128 v[20:23], v54
    ds_read_b128 v[24:27], v55
    ds_read_b128 v[28:31], v56
L_pad9:
    s_cbranch_execz L_pad13
    ds_read_b128 v[32:35], v57
    v_add_f32_dpp v38, v36, v36 row_ror:8 row_mask:0xf bank_mask:0xf
    s_nop 1
    v_add_f32_dpp v38, v38, v38 row_ror:4 row_mask:0xf bank_mask:0xf
    s_nop 1
    v_add_f32_dpp v38, v38, v38 row_ror:2 row_mask:0xf bank_mask:0xf
    s_nop 1
    v_add_f32_dpp v38, v38, v38 row_ror:1 row_mask:0xf bank_mask:0xf
    s_waitcnt lgkmcnt(5)
    v_smfmac_f32_16x16x64_bf16 v[40:43], v[12:15], v[160:167], v1
    v_add_f32_dpp v38, v38, v38 row_bcast:15 row_mask:0xa bank_mask:0xf
    v_smfmac_f32_16x16x64_bf16 v[44:47], v[12:15], v[208:215], v1
    s_waitcnt lgkmcnt(4)
    v_smfmac_f32_16x16x64_bf16 v[40:43], v[16:19], v[168:175], v1
    v_add_f32_dpp v38, v38, v38 row_bcast:31 row_mask:0xc bank_mask:0xf
    v_smfmac_f32_16x16x64_bf16 v[44:47], v[16:19], v[216:223], v1
    ds_read_b32 v36, v62
    s_waitcnt lgkmcnt(4)
    v_smfmac_f32_16x16x64_bf16 v[40:43], v[20:23], v[176:183], v1
    v_smfmac_f32_16x16x64_bf16 v[44:47], v[20:23], v[224:231], v1
    s_waitcnt lgkmcnt(0)
    v_max_f32_dpp v37, v36, v36 row_ror:4 row_mask:0xf bank_mask:0xf
    v_smfmac_f32_16x16x64_bf16 v[40:43], v[24:27], v[184:191], v1
    v_smfmac_f32_16x16x64_bf16 v[44:47], v[24:27], v[232:239], v1
    v_max_f32_dpp v37, v37, v37 row_ror:2 row_mask:0xf bank_mask:0xf
    v_smfmac_f32_16x16x64_bf16 v[40:43], v[28:31], v[192:199], v1
    v_cmp_eq_u32 vcc, -1, v36
    v_smfmac_f32_16x16x64_bf16 v[44:47], v[28:31], v[240:247], v1
    v_max_f32_dpp v37, v37, v37 row_ror:1 row_mask:0xf bank_mask:0xf
    v_smfmac_f32_16x16x64_bf16 v[40:43], v[32:35], v[200:207], v1
    v_sub_f32 v39, v61, v37
    v_smfmac_f32_16x16x64_bf16 v[44:47], v[32:35], v[248:255], v1
    v_exp_f32 v39, v39
    s_cbranch_vccnz L_mr_205
L_mk_206:
    v_mul_f32 v38, v38, v39
    ds_write_b32 v63, v38 offset:1024
    s_cmp_lt_u32 s30, 2
    s_nop 0
    v_pk_add_f32 v[40:41], v[40:41], v[42:43]
    s_nop 0
    v_pk_add_f32 v[42:43], v[44:45], v[46:47]
    v_pk_mul_f32 v[40:41], v[40:41], v[38:39] op_sel:[0,1] op_sel_hi:[1,1]
    v_pk_mul_f32 v[42:43], v[42:43], v[38:39] op_sel:[0,1] op_sel_hi:[1,1]
    ds_write_b128 v63, v[40:43]
    s_cbranch_scc1 L_comb_1
    s_waitcnt lgkmcnt(0)
    s_barrier
L_comb_1b:
    s_cmp_lt_u32 s3, 20
    s_cbranch_scc0 L_typeB_1
    s_mul_i32 s74, s30, 1664
    s_add_u32 s74, s74, s62
    s_add_u32 s74, s74, 26624
    v_and_b32 v56, 7, v0
    v_lshlrev_b32 v56, 2, v56
    v_lshrrev_b32 v62, 4, v0
    v_lshlrev_b32 v62, 3, v62
    buffer_load_dword v52, v56, s[40:43], s74 offen offset:1536 sc1
    buffer_load_dwordx2 v[54:55], v62, s[40:43], s74 offen offset:1536 sc1
    v_lshlrev_b32 v57, 4, v0
    v_lshlrev_b32 v58, 3, v0
    s_mul_i32 s57, s30, 6144
    s_add_u32 s57, s57, 30720
    v_lshrrev_b32 v59, 2, v0
    v_lshlrev_b32 v59, 6, v59
    v_bfe_u32 v53, v0, 4, 1
    v_lshl_add_u32 v59, v53, 5, v59
    v_and_b32 v53, 3, v0
    v_lshl_add_u32 v59, v53, 3, v59
    v_add_u32 v59, s57, v59
    v_xor_b32 v60, 32, v59
    s_lshl_b32 s57, s30, 8
    s_add_u32 s57, s57, 157696
    v_lshl_add_u32 v61, v0, 2, s57
    ds_read_b64_tr_b16 v[28:29], v59 offset:0
    ds_read_b64_tr_b16 v[30:31], v59 offset:1024
    ds_read_b64_tr_b16 v[32:33], v59 offset:2048
    ds_read_b64_tr_b16 v[34:35], v59 offset:3072
    ds_read_b64_tr_b16 v[36:37], v59 offset:4096
    ds_read_b64_tr_b16 v[38:39], v59 offset:5120
    ds_read_b64_tr_b16 v[40:41], v60 offset:0
L_pad10:
    s_cbranch_execz L_pad14
    ds_read_b64_tr_b16 v[42:43], v60 offset:1024
    ds_read_b64_tr_b16 v[44:45], v60 offset:2048
    ds_read_b64_tr_b16 v[46:47], v60 offset:3072
    ds_read_b64_tr_b16 v[48:49], v60 offset:4096
    ds_read_b64_tr_b16 v[50:51], v60 offset:5120
    v_mov_b64 v[20:21], 0
    v_mov_b64 v[22:23], 0
    v_mov_b64 v[24:25], 0
    v_mov_b64 v[26:27], 0
    s_add_u32 s58, s6, 132096
    s_branch L_pw_213
L_pr_214:
    buffer_load_dword v52, v56, s[40:43], s74 offen offset:1536 sc1
    buffer_load_dwordx2 v[54:55], v62, s[40:43], s74 offen offset:1536 sc1
    s_sub_u32 s56, s56, 1
    s_cbranch_scc1 L_done
L_pw_213:
    s_waitcnt vmcnt(0)
    v_max3_u32 v53, v52, v54, v55
    v_cmp_eq_u32 vcc, -1, v53
    s_cbranch_vccnz L_pr_214
    buffer_load_dwordx4 v[12:15], v57, s[40:43], s74 offen sc1
    buffer_load_dwordx2 v[16:17], v58, s[40:43], s74 offen offset:1024 sc1
    buffer_load_dword v18, v56, s[40:43], s74 offen offset:1568 sc1
    v_max_f32_dpp v53, v52, v52 row_ror:4 row_mask:0xf bank_mask:0xf
    s_nop 1
    v_max_f32_dpp v53, v53, v53 row_ror:2 row_mask:0xf bank_mask:0xf
    s_nop 1
    v_max_f32_dpp v53, v53, v53 row_ror:1 row_mask:0xf bank_mask:0xf
    v_sub_f32 v52, v52, v53
    v_sub_f32 v54, v54, v53
    v_sub_f32 v55, v55, v53
    v_exp_f32 v52, v52
    v_exp_f32 v54, v54
    v_exp_f32 v55, v55
    s_waitcnt lgkmcnt(0)
    s_branch L_pw_215
L_pr_216:
    buffer_load_dwordx4 v[12:15], v57, s[40:43], s74 offen sc1
    buffer_load_dwordx2 v[16:17], v58, s[40:43], s74 offen offset:1024 sc1
    buffer_load_dword v18, v56, s[40:43], s74 offen offset:1568 sc1
    s_sub_u32 s56, s56, 1
    s_cbranch_scc1 L_done
L_pw_215:
    s_waitcnt vmcnt(0)
    v_max3_u32 v19, v12, v13, v14
    v_max3_u32 v19, v19, v15, v16
    v_max3_u32 v19, v19, v17, v18
    v_cmp_eq_u32 vcc, -1, v19
    s_cbranch_vccnz L_pr_216
    v_smfmac_f32_16x16x64_bf16 v[20:23], v[12:15], v[28:35], v1
    v_mul_f32 v52, v52, v18
    v_smfmac_f32_16x16x64_bf16 v[24:27], v[12:15], v[40:47], v1
    v_smfmac_f32_16x16x32_bf16 v[20:23], v[16:17], v[36:39], v1
    v_add_f32_dpp v52, v52, v52 row_ror:4 row_mask:0xf bank_mask:0xf
    v_smfmac_f32_16x16x32_bf16 v[24:27], v[16:17], v[48:51], v1
    s_cmp_eq_u32 s30, 2
    v_add_f32_dpp v52, v52, v52 row_ror:2 row_mask:0xf bank_mask:0xf
    s_nop 1
    v_add_f32_dpp v52, v52, v52 row_ror:1 row_mask:0xf bank_mask:0xf
    v_rcp_f32 v52, v52
    v_pk_add_f32 v[20:21], v[20:21], v[22:23]
    s_nop 0
    v_pk_add_f32 v[24:25], v[24:25], v[26:27]
    v_pk_mul_f32 v[54:55], v[54:55], v[52:53] op_sel:[0,0] op_sel_hi:[1,0]
    v_mul_f32 v20, v20, v54
    v_mul_f32 v24, v24, v54
    v_fmac_f32 v20, v21, v55
    v_fmac_f32 v24, v25, v55
    s_nop 1
    v_permlane32_swap_b32 v20, v24
    v_add_f32 v20, v20, v24
    ds_write_b32 v61, v20
    s_waitcnt lgkmcnt(0)
    s_barrier
    s_cbranch_scc0 L_finb_217
    ds_read2st64_b32 v[12:13], v2 offset0:0 offset1:1
    ds_read2st64_b32 v[14:15], v2 offset0:2 offset1:3
    ds_read2st64_b32 v[16:17], v2 offset0:4 offset1:5
    ds_read2st64_b32 v[18:19], v2 offset0:6 offset1:7
    s_waitcnt lgkmcnt(2)
    v_pk_add_f32 v[12:13], v[12:13], v[14:15]
    s_waitcnt lgkmcnt(0)
    v_pk_add_f32 v[16:17], v[16:17], v[18:19]
    v_pk_add_f32 v[12:13], v[12:13], v[16:17]
    v_add_f32 v14, v12, v13
    v_add_f32 v15, v12, v13
    s_nop 1
    v_permlane16_swap_b32 v14, v15
    v_add_f32 v12, v14, v15
    v_min_u32 v12, -2, v12
    buffer_store_dword v12, v3, s[40:43], s58 offen sc1
L_finb_217:
L_pad11:
    s_cbranch_execz L_pad15
    s_sub_u32 s57, s30, 4
    s_cmp_lt_u32 s57, 3
    s_cbranch_scc0 L_skip_218
    s_sub_u32 s60, s30, 4
    s_lshl_b32 s57, s60, 11
    v_lshlrev_b32 v11, 4, v0
    v_add_u32 v11, s57, v11
    s_add_u32 s65, s62, 19456
    buffer_load_dwordx4 v[52:55], v11, s[40:43], s65 offen offset:0 sc1
    buffer_load_dwordx4 v[56:59], v11, s[40:43], s65 offen offset:1024 sc1
    s_lshl_b32 s59, s60, 12
    s_add_u32 s59, s59, 79872
    v_bfe_u32 v35, v0, 4, 1
    v_lshlrev_b32 v35, 11, v35
    v_bfe_u32 v60, v0, 2, 2
    v_lshl_add_u32 v35, v60, 8, v35
    v_lshrrev_b32 v60, 5, v0
    v_lshl_add_u32 v35, v60, 6, v35
    v_and_b32 v60, 3, v0
    v_lshl_add_u32 v35, v60, 3, v35
    v_add_u32 v35, s59, v35
    v_mov_b32 v9, 0xbdd2d3e8
    v_mov_b32 v10, 0xc0135761
    s_lshl_b32 s57, s60, 7
    s_add_u32 s57, s57, 160256
    v_lshlrev_b32 v32, 3, v0
    v_add_u32 v32, s57, v32
    v_lshlrev_b32 v33, 3, v0
    v_add_u32 v33, 129024, v33
    v_cmp_gt_u32 vcc, 16, v0
    s_nop 1
    v_cndmask_b32 v32, v33, v32, vcc
    v_and_b32 v33, 15, v0
    v_lshlrev_b32 v33, 3, v33
    v_lshrrev_b32 v60, 5, v0
    v_lshl_add_u32 v33, v60, 2, v33
    v_add_u32 v33, 160256, v33
    v_and_b32 v34, 15, v0
    v_lshlrev_b32 v34, 2, v34
    v_lshrrev_b32 v60, 5, v0
    v_lshl_add_u32 v34, v60, 6, v34
    v_bfe_u32 v60, v0, 4, 1
    v_lshl_add_u32 v34, v60, 13, v34
    s_add_u32 s60, s6, 198144
    s_add_u32 s58, s62, 39936
    s_add_u32 s57, s62, 25984
    v_and_b32 v7, 7, v0
    v_lshlrev_b32 v7, 3, v7
    v_mov_b32 v60, 0x3acccccd
    v_mov_b32 v61, 0x3727c5ac
    s_waitcnt vmcnt(0)
    buffer_load_dwordx2 v[24:25], v7, s[40:43], s57 offen sc1
    buffer_load_dwordx4 v[12:15], v11, s[40:43], s58 offen offset:0 sc1
    buffer_load_dwordx4 v[16:19], v11, s[40:43], s58 offen offset:1024 sc1
    ds_read_b64_tr_b16 v[36:37], v35 offset:0
    ds_read_b64_tr_b16 v[38:39], v35 offset:1024
    ds_read_b64_tr_b16 v[40:41], v35 offset:128
    ds_read_b64_tr_b16 v[42:43], v35 offset:1152
    ds_read_b64_tr_b16 v[44:45], v35 offset:32
    ds_read_b64_tr_b16 v[46:47], v35 offset:1056
    ds_read_b64_tr_b16 v[48:49], v35 offset:160
    ds_read_b64_tr_b16 v[50:51], v35 offset:1184
L_sw_221:
    v_max3_u32 v20, v52, v53, v54
    v_max3_u32 v20, v20, v55, v56
    v_max3_u32 v20, v20, v57, v58
    v_max_u32 v20, v20, v59
    v_cmp_eq_u32 vcc, -1, v20
    s_cbranch_vccnz L_sr_222
    v_pk_add_f32 v[28:29], v[52:53], v[56:57]
    v_pk_add_f32 v[30:31], v[54:55], v[58:59]
    s_nop 1
    v_permlane32_swap_b32 v28, v30
    v_permlane32_swap_b32 v29, v31
    v_pk_add_f32 v[28:29], v[28:29], v[30:31]
    s_nop 1
    v_permlane16_swap_b32 v28, v29
    v_add_f32 v28, v28, v29
    v_mov_b64 v[52:53], 0
    v_mov_b64 v[54:55], 0
    v_mov_b64 v[56:57], 0
    v_mov_b64 v[58:59], 0
    s_waitcnt lgkmcnt(0)
L_pr_220:
    buffer_load_dwordx2 v[24:25], v7, s[40:43], s57 offen sc1
    buffer_load_dwordx4 v[12:15], v11, s[40:43], s58 offen offset:0 sc1
L_pad12:
    s_cbranch_execz L_pad16
    buffer_load_dwordx4 v[16:19], v11, s[40:43], s58 offen offset:1024 sc1
    s_sub_u32 s56, s56, 1
    s_cbranch_scc1 L_done
L_pw_219:
    s_waitcnt vmcnt(3)
    v_max_u32 v20, v24, v25
    v_cmp_eq_u32 vcc, -1, v20
    s_cbranch_vccnz L_pr_220
    buffer_load_dwordx4 v[12:15], v11, s[40:43], s58 offen offset:0 sc1
    buffer_load_dwordx4 v[16:19], v11, s[40:43], s58 offen offset:1024 sc1
    v_add_f32_dpp v2, v24, v24 row_ror:4 row_mask:0xf bank_mask:0xf
    v_add_f32_dpp v3, v25, v25 row_ror:4 row_mask:0xf bank_mask:0xf
    v_pk_add_f32 v[20:21], v[12:13], v[16:17]
    v_pk_add_f32 v[22:23], v[14:15], v[18:19]
    v_add_f32_dpp v2, v2, v2 row_ror:2 row_mask:0xf bank_mask:0xf
    v_add_f32_dpp v3, v3, v3 row_ror:2 row_mask:0xf bank_mask:0xf
    v_permlane32_swap_b32 v20, v22
    v_permlane32_swap_b32 v21, v23
    v_add_f32_dpp v2, v2, v2 row_ror:1 row_mask:0xf bank_mask:0xf
    v_add_f32_dpp v3, v3, v3 row_ror:1 row_mask:0xf bank_mask:0xf
    v_pk_add_f32 v[20:21], v[20:21], v[22:23]
    v_mul_f32 v2, v2, v60
    v_fma_f32 v3, v3, v60, v61
    v_permlane16_swap_b32 v20, v21
    v_fma_f32 v3, -v2, v2, v3
    v_add_f32 v20, v20, v21
    v_max_f32 v3, v3, v61
    v_mul_f32 v26, v28, v2
    v_rsq_f32 v3, v3
    v_cmp_u_f32 vcc, v20, v20
    v_sub_f32 v20, v20, v26
    s_cbranch_vccnz L_hr_223
L_hk_224:
    v_fma_f32 v20, v20, v3, v4
    v_mul_f32 v21, v20, v20
    v_fma_f32 v21, v21, v9, v10
    v_mul_f32 v21, v21, v20
    v_exp_f32 v21, v21
    s_nop 0
    v_add_f32 v21, 1.0, v21
    v_rcp_f32 v21, v21
    s_nop 0
    v_mul_f32 v20, v20, v21
    s_nop 1
    v_mov_b32_dpp v21, v20 row_shl:1 row_mask:0xf bank_mask:0xf bound_ctrl:0
    v_cvt_pk_bf16_f32 v28, v20, v21
    s_nop 1
    v_mov_b32_dpp v29, v28 row_shl:4 row_mask:0xf bank_mask:0xf bound_ctrl:0
    v_mov_b32_dpp v30, v28 row_shl:8 row_mask:0xf bank_mask:0xf bound_ctrl:0
    v_mov_b32_dpp v31, v28 row_shl:12 row_mask:0xf bank_mask:0xf bound_ctrl:0
    s_nop 1
    v_smfmac_f32_16x16x64_bf16 v[52:55], v[28:31], v[36:43], v1
    v_smfmac_f32_16x16x64_bf16 v[56:59], v[28:31], v[44:51], v1
    s_cmp_eq_u32 s30, 4
    s_nop 5
    v_add_f32 v22, v52, v54
    v_add_f32 v23, v56, v58
    ds_write_b64 v32, v[22:23]
    s_cbranch_scc0 L_skip_226
L_xw_227:
    ds_read2_b32 v[20:21], v33 offset0:0 offset1:32
    ds_read_b32 v22, v33 offset:256
    s_sub_u32 s56, s56, 1
    s_cbranch_scc1 L_done
    s_waitcnt lgkmcnt(0)
    v_max3_u32 v23, v20, v21, v22
    v_add_f32 v20, v20, v21
    v_cmp_eq_u32 vcc, -1, v23
    v_add_f32 v20, v20, v22
    s_cbranch_vccnz L_xw_227
    v_min_u32 v20, -2, v20
    buffer_store_dword v20, v34, s[40:43], s60 offen sc1
L_skip_226:
L_skip_218:
    s_branch L_done
L_typeB_1:
    s_cmp_eq_u32 s53, 3
    s_cbranch_scc0 L_typeC_228
    s_cmp_eq_u32 s30, 7
    s_cbranch_scc1 L_w7_233
    s_cmp_lt_u32 s30, 6
    s_cbranch_scc0 L_skip_235
    s_lshr_b32 s57, s30, 1
    s_mul_i32 s57, s57, 128
    s_and_b32 s58, s30, 1
    s_lshl_b32 s58, s58, 6
    s_add_u32 s57, s57, s58
    v_lshrrev_b32 v18, 5, v0
    v_lshlrev_b32 v18, 13, v18
    v_bfe_u32 v60, v0, 3, 1
    v_lshl_add_u32 v18, v60, 12, v18
    v_bfe_u32 v60, v0, 4, 1
    v_lshl_add_u32 v18, v60, 11, v18
    v_bfe_u32 v60, v0, 2, 1
    v_mul_u32_u24 v60, 384, v60
    v_add_u32 v18, v60, v18
    v_and_b32 v60, 3, v0
    v_lshl_add_u32 v18, v60, 3, v18
L_pad13:
    s_cbranch_execz L_pad17
    v_add_u32 v18, s57, v18
    v_add_u32 v18, 30720, v18
    v_bfe_u32 v19, v0, 4, 1
    v_lshlrev_b32 v19, 12, v19
    v_bfe_u32 v60, v0, 3, 1
    v_lshl_add_u32 v19, v60, 11, v19
    v_bfe_u32 v60, v0, 2, 1
    v_mul_u32_u24 v60, 384, v60
    v_add_u32 v19, v60, v19
    v_and_b32 v60, 3, v0
    v_lshl_add_u32 v19, v60, 3, v19
    v_add_u32 v19, s57, v19
    v_add_u32 v19, 63488, v19
    ds_read_b64_tr_b16 v[28:29], v18 offset:0
    ds_read_b64_tr_b16 v[30:31], v18 offset:1024
    ds_read_b64_tr_b16 v[32:33], v18 offset:16384
    ds_read_b64_tr_b16 v[34:35], v18 offset:17408
    ds_read_b64_tr_b16 v[36:37], v19 offset:0
    ds_read_b64_tr_b16 v[38:39], v19 offset:1024
    ds_read_b64_tr_b16 v[40:41], v18 offset:32
    ds_read_b64_tr_b16 v[42:43], v18 offset:1056
    ds_read_b64_tr_b16 v[44:45], v18 offset:16416
    ds_read_b64_tr_b16 v[46:47], v18 offset:17440
    ds_read_b64_tr_b16 v[48:49], v19 offset:32
    ds_read_b64_tr_b16 v[50:51], v19 offset:1056
    v_lshrrev_b32 v9, 4, v0
    v_lshlrev_b32 v9, 5, v9
    v_bfe_u32 v60, v0, 1, 1
    v_lshl_add_u32 v9, v60, 4, v9
    v_and_b32 v60, 1, v0
    v_mul_u32_u24 v60, 192, v60
    v_add_u32 v9, v60, v9
    v_add_u32 v9, 160832, v9
    v_lshrrev_b32 v10, 4, v0
    v_lshlrev_b32 v10, 4, v10
    v_bfe_u32 v60, v0, 1, 1
    v_lshl_add_u32 v10, v60, 3, v10
    v_and_b32 v60, 1, v0
    v_mul_u32_u24 v60, 192, v60
    v_add_u32 v10, v60, v10
    v_add_u32 v10, 160960, v10
    v_mov_b64 v[20:21], 0
    v_mov_b64 v[22:23], 0
    v_mov_b64 v[24:25], 0
    v_mov_b64 v[26:27], 0
    s_lshr_b32 s57, s30, 1
    s_lshl_b32 s57, s57, 11
    s_lshl_b32 s58, s58, 1
    s_add_u32 s57, s57, s58
    s_lshl_b32 s58, s54, 8
    s_add_u32 s57, s57, s58
    v_and_b32 v11, 31, v0
    v_lshlrev_b32 v11, 2, v11
    v_lshrrev_b32 v60, 5, v0
    v_lshl_add_u32 v11, v60, 30, v11
    v_add_u32 v11, s57, v11
    s_add_u32 s59, s62, 39936
    s_add_u32 s60, s62, 25984
L_skip_235:
    s_cmp_lt_u32 s30, 6
    s_barrier
    s_cbranch_scc0 L_se_234
    ds_read_b128 v[12:15], v9
    ds_read_b64 v[16:17], v10
    s_waitcnt lgkmcnt(1)
    v_smfmac_f32_16x16x64_bf16 v[20:23], v[12:15], v[28:35], v1
    v_smfmac_f32_16x16x64_bf16 v[24:27], v[12:15], v[40:47], v1
    s_waitcnt lgkmcnt(0)
    v_smfmac_f32_16x16x32_bf16 v[20:23], v[16:17], v[36:39], v1
    v_smfmac_f32_16x16x32_bf16 v[24:27], v[16:17], v[48:51], v1
    s_cmp_eq_u32 s55, 0
    s_nop 5
    v_add_f32 v12, v20, v22
    s_nop 1
    v_add_f32_dpp v12, v24, v26 quad_perm:[0,1,2,3] row_mask:0x2 bank_mask:0xf
    v_min_u32 v12, -2, v12
    s_cbranch_scc1 L_gs_236
    buffer_store_dword v12, v11, s[40:43], s59 offen
L_gb_237:
L_se_234:
    s_cmp_eq_u32 s30, 7
    s_cbranch_scc0 L_done
    s_cmp_eq_u32 s31, 0
    s_cbranch_scc0 L_done
    v_lshlrev_b32 v60, 16, v4
    v_add_f32 v2, v2, v60
    v_and_b32 v60, 0xffff0000, v4
    v_add_f32 v3, v3, v60
    v_and_b32 v60, 31, v0
L_pad14:
    s_cbranch_execz L_pad18
    v_min_u32 v60, 19, v60
    s_mul_i32 s57, s54, 160
    v_lshrrev_b32 v7, 5, v0
    v_lshlrev_b32 v7, 2, v7
    v_add_u32 v7, s57, v7
    v_lshl_add_u32 v7, v60, 3, v7
    s_add_u32 s57, s7, 198144
    s_add_u32 s58, s7, 214528
    s_add_u32 s59, s7, 230912
    s_add_u32 s60, s7, 247296
    s_add_u32 s75, s7, 266252
    v_and_b32 v9, 7, v0
    v_lshlrev_b32 v9, 9, v9
    buffer_load_dword v12, v9, s[40:43], s75 offen sc1
    s_sleep 2
L_pr_249:
    buffer_load_dword v12, v9, s[40:43], s75 offen sc1
    s_sub_u32 s56, s56, 1
    s_cbranch_scc1 L_done
L_pw_248:
    s_waitcnt vmcnt(1)
    v_cmp_eq_u32 vcc, -1, v12
    s_cbranch_vccnz L_pr_249
    s_sleep 2
    buffer_load_dwordx4 v[12:15], v5, s[40:43], s57 offen sc1
    buffer_load_dwordx4 v[16:19], v5, s[40:43], s58 offen sc1
    buffer_load_dwordx4 v[20:23], v5, s[40:43], s59 offen sc1
    buffer_load_dwordx4 v[24:27], v5, s[40:43], s60 offen sc1
    s_sleep 2
L_gw_245:
    buffer_load_dwordx4 v[12:15], v5, s[40:43], s57 offen sc1
    buffer_load_dwordx4 v[16:19], v5, s[40:43], s58 offen sc1
    buffer_load_dwordx4 v[20:23], v5, s[40:43], s59 offen sc1
    buffer_load_dwordx4 v[24:27], v5, s[40:43], s60 offen sc1
    s_sub_u32 s56, s56, 1
    s_cbranch_scc1 L_done
    s_and_b32 s74, s56, 31
    s_waitcnt vmcnt(6)
    v_pk_add_f32 v[28:29], v[12:13], v[16:17]
    v_pk_add_f32 v[30:31], v[14:15], v[18:19]
    s_waitcnt vmcnt(5)
    v_pk_add_f32 v[28:29], v[28:29], v[20:21]
    v_pk_add_f32 v[30:31], v[30:31], v[22:23]
    s_waitcnt vmcnt(4)
    v_pk_add_f32 v[28:29], v[28:29], v[24:25]
    v_pk_add_f32 v[30:31], v[30:31], v[26:27]
    v_pk_add_f32 v[32:33], v[28:29], v[30:31]
    v_cmp_u_f32 vcc, v32, v33
    v_permlane32_swap_b32 v28, v30
    v_permlane32_swap_b32 v29, v31
    s_cbranch_vccnz L_gr_246
L_gk_247:
    v_pk_add_f32 v[28:29], v[28:29], v[30:31]
    v_pk_add_f32 v[28:29], v[28:29], v[2:3]
    v_cvt_pk_bf16_f32 v28, v28, v29
    global_store_dword v7, v28, s[24:25]
    s_branch L_done
L_gs_39:
    buffer_store_dword v33, v34, s[40:43], s67 offen sc1
    s_branch L_gb_40
L_gs_42:
    buffer_store_dword v12, v54, s[40:43], s59 offen sc1
    s_branch L_gb_43
L_cr_57:
    s_sub_u32 s56, s56, 1
    s_cbranch_scc1 L_done
    global_load_dword v2, v3, s[26:27] sc1
    s_waitcnt vmcnt(0)
    s_branch L_cw_56
L_far_58:
    s_lshl_b32 s57, s52, 2
    s_add_u32 s57, s57, s72
    s_mov_b64 exec, 1
    buffer_store_dword v25, v0, s[40:43], s57 offen offset:128 sc1
    s_mov_b64 exec, -1
    s_branch L_fb_59
L_cr_75:
    s_sub_u32 s56, s56, 1
    s_cbranch_scc1 L_done
    buffer_load_dword v2, v24, s[40:43], s72 offen sc1
    s_branch L_cw_74
L_gs_83:
    buffer_store_dword v33, v34, s[40:43], s67 offen sc1
    s_branch L_gb_84
L_gs_86:
    buffer_store_dword v12, v54, s[40:43], s59 offen sc1
    s_branch L_gb_87
L_gs_107:
    buffer_store_dword v37, v4, s[40:43], s58 offen sc1
    s_branch L_gb_108
L_cr_122:
    s_sub_u32 s56, s56, 1
    s_cbranch_scc1 L_done
    global_load_dword v2, v3, s[26:27] offset:4 sc1
    s_branch L_cw_121
L_cr_132:
    buffer_load_dword v52, v56, s[40:43], s74 offen offset:1536 sc1
    buffer_load_dwordx2 v[54:55], v62, s[40:43], s74 offen offset:1536 sc1
    s_sub_u32 s56, s56, 1
    s_cbranch_scc1 L_done
    s_branch L_cw_131
L_gs_137:
    buffer_store_dword v14, v3, s[40:43], s57 offen sc1
L_pad15:
    s_cbranch_execz L_pad19
    s_branch L_gb_138
L_gs_139:
    buffer_store_dword v12, v4, s[40:43], s57 offen offset:32 sc1
    s_branch L_gb_140
L_comb_0:
    s_mov_b32 s57, 0
    s_cmp_eq_u32 s55, 0
    s_waitcnt lgkmcnt(0)
    s_barrier
    ds_read2st64_b64 v[12:15], v2 offset0:0 offset1:4
    ds_read2st64_b64 v[16:19], v2 offset0:8 offset1:12
    ds_read2st64_b64 v[20:23], v2 offset0:16 offset1:20
    ds_read2st64_b64 v[24:27], v2 offset0:24 offset1:28
    s_waitcnt lgkmcnt(2)
    v_pk_add_f32 v[12:13], v[12:13], v[14:15]
    v_pk_add_f32 v[16:17], v[16:17], v[18:19]
    v_pk_add_f32 v[12:13], v[12:13], v[16:17]
    s_waitcnt lgkmcnt(0)
    v_pk_add_f32 v[20:21], v[20:21], v[22:23]
    v_pk_add_f32 v[24:25], v[24:25], v[26:27]
    v_pk_add_f32 v[12:13], v[12:13], v[20:21]
    v_pk_add_f32 v[12:13], v[12:13], v[24:25]
    v_cvt_pk_bf16_f32 v14, v12, v13
    v_min_u32 v12, -2, v12
    v_min_u32 v14, -2, v14
    s_cbranch_scc1 L_gs_137
    buffer_store_dword v14, v3, s[40:43], s57 offen
L_gb_138:
    s_cbranch_scc1 L_gs_139
    buffer_store_dword v12, v4, s[40:43], s57 offen offset:32
L_gb_140:
    s_branch L_comb_0b
L_sr_149:
    buffer_load_dwordx4 v[52:55], v11, s[40:43], s65 offen offset:0 sc1
    buffer_load_dwordx4 v[56:59], v11, s[40:43], s65 offen offset:1024 sc1
    s_sub_u32 s56, s56, 1
    s_cbranch_scc1 L_done
    s_waitcnt vmcnt(0)
    s_branch L_sw_148
L_hr_150:
    buffer_load_dwordx4 v[12:15], v11, s[40:43], s58 offen offset:0 sc1
    buffer_load_dwordx4 v[16:19], v11, s[40:43], s58 offen offset:1024 sc1
    s_sub_u32 s56, s56, 1
    s_cbranch_scc1 L_done
    s_and_b32 s64, s56, 31
    s_cbranch_scc0 L_hx_152
    s_waitcnt vmcnt(2)
    v_pk_add_f32 v[20:21], v[12:13], v[16:17]
    v_pk_add_f32 v[22:23], v[14:15], v[18:19]
    s_nop 1
    v_permlane32_swap_b32 v20, v22
    v_permlane32_swap_b32 v21, v23
    v_pk_add_f32 v[20:21], v[20:21], v[22:23]
    s_nop 1
    v_permlane16_swap_b32 v20, v21
    v_add_f32 v20, v20, v21
    v_cmp_u_f32 vcc, v20, v20
    v_sub_f32 v20, v20, v26
    s_cbranch_vccnz L_hr_150
    s_branch L_hk_151
L_hx_152:
    s_waitcnt vmcnt(0)
    v_max3_u32 v20, v12, v13, v14
    v_max3_u32 v20, v20, v15, v16
    v_max3_u32 v20, v20, v17, v18
    v_max_u32 v20, v20, v19
    v_cmp_eq_u32 vcc, -1, v20
    s_cbranch_vccnz L_hr_150
    v_pk_add_f32 v[20:21], v[12:13], v[16:17]
    v_pk_add_f32 v[22:23], v[14:15], v[18:19]
    s_nop 1
    v_permlane32_swap_b32 v20, v22
    v_permlane32_swap_b32 v21, v23
    v_pk_add_f32 v[20:21], v[20:21], v[22:23]
    s_nop 1
    v_permlane16_swap_b32 v20, v21
    v_add_f32 v20, v20, v21
    v_sub_f32 v20, v20, v26
    s_branch L_hk_151
L_gs_160:
    buffer_store_dword v0, v11, s[40:43], s58 offen sc1
    s_branch L_gb_161
L_typeC_156:
    s_cmp_eq_u32 s30, 6
    s_cbranch_scc0 L_p1
    s_cmp_eq_u32 s3, 21
    s_cbranch_scc0 L_skip_157
    v_and_b32 v11, 3, v0
    v_lshlrev_b32 v11, 7, v11
    v_lshrrev_b32 v60, 2, v0
    v_lshl_add_u32 v11, v60, 24, v11
    s_add_u32 s58, s62, 26116
    s_add_u32 s75, s7, 266244
    v_and_b32 v9, 7, v0
    v_lshlrev_b32 v9, 9, v9
    buffer_load_dword v12, v9, s[40:43], s75 offen sc1
    s_sleep 2
L_pr_159:
    buffer_load_dword v12, v9, s[40:43], s75 offen sc1
    s_sub_u32 s56, s56, 1
    s_cbranch_scc1 L_done
L_pw_158:
    s_waitcnt vmcnt(1)
L_pad16:
    s_cbranch_execz L_pad20
    v_cmp_eq_u32 vcc, -1, v12
    s_cbranch_vccnz L_pr_159
    s_cmp_eq_u32 s55, 0
    s_cbranch_scc1 L_gs_160
    buffer_store_dword v0, v11, s[40:43], s58 offen
L_gb_161:
    s_waitcnt vmcnt(1)
    s_branch L_p1
L_skip_157:
    s_cmp_eq_u32 s3, 20
    s_cbranch_scc0 L_p1
    s_lshl_b32 s59, s31, 9
    s_add_u32 s59, s59, s8
    s_add_u32 s59, s59, 266240
    v_and_b32 v10, 1, v0
    v_lshlrev_b32 v10, 13, v10
    v_lshrrev_b32 v60, 1, v0
    v_lshl_add_u32 v10, v60, 24, v10
    s_add_u32 s58, s62, 1568
    v_lshrrev_b32 v9, 3, v0
    v_mul_u32_u24 v9, 1664, v9
    v_and_b32 v60, 7, v0
    v_lshl_add_u32 v9, v60, 2, v9
    buffer_load_dword v12, v9, s[40:43], s58 offen sc1
    s_sleep 2
L_pr_163:
    buffer_load_dword v12, v9, s[40:43], s58 offen sc1
    s_sub_u32 s56, s56, 1
    s_cbranch_scc1 L_done
L_pw_162:
    s_waitcnt vmcnt(1)
    v_cmp_eq_u32 vcc, -1, v12
    s_cbranch_vccnz L_pr_163
    buffer_store_dword v0, v10, s[40:43], s59 offen offset:0 sc1
    s_add_u32 s58, s62, 25856
    v_and_b32 v9, 15, v0
    v_lshlrev_b32 v9, 2, v9
    buffer_load_dword v13, v9, s[40:43], s58 offen sc1
    s_sleep 2
L_pr_165:
    buffer_load_dword v13, v9, s[40:43], s58 offen sc1
    s_sub_u32 s56, s56, 1
    s_cbranch_scc1 L_done
L_pw_164:
    s_waitcnt vmcnt(1)
    v_cmp_eq_u32 vcc, -1, v13
    s_cbranch_vccnz L_pr_165
    buffer_store_dword v0, v10, s[40:43], s59 offen offset:4 sc1
    s_waitcnt vmcnt(1)
    s_branch L_p1
L_gs_169:
    buffer_store_dword v12, v11, s[40:43], s60 offen sc1
    s_branch L_gb_170
L_gs_171:
    buffer_store_dword v12, v11, s[40:43], s59 offen sc1
    s_branch L_gb_172
L_gr_174:
    s_cbranch_scc1 L_gw_173
    s_waitcnt vmcnt(0)
    v_max3_u32 v32, v12, v13, v14
    v_max3_u32 v32, v32, v15, v16
    v_max3_u32 v32, v32, v17, v18
    v_max3_u32 v32, v32, v19, v20
    v_max3_u32 v32, v32, v21, v22
    v_max3_u32 v32, v32, v23, v24
    v_max3_u32 v32, v32, v25, v26
    v_max_u32 v32, v32, v27
    v_cmp_eq_u32 vcc, -1, v32
    s_cbranch_vccnz L_gw_173
    v_pk_add_f32 v[28:29], v[12:13], v[16:17]
    v_pk_add_f32 v[30:31], v[14:15], v[18:19]
    v_pk_add_f32 v[28:29], v[28:29], v[20:21]
    v_pk_add_f32 v[30:31], v[30:31], v[22:23]
    v_pk_add_f32 v[28:29], v[28:29], v[24:25]
    v_pk_add_f32 v[30:31], v[30:31], v[26:27]
    s_nop 1
    v_permlane32_swap_b32 v28, v30
    v_permlane32_swap_b32 v29, v31
    s_branch L_gk_175
L_gs_178:
    buffer_store_dword v33, v34, s[40:43], s67 offen sc1
    s_branch L_gb_179
L_w7_166:
    v_and_b32 v60, 31, v0
    v_min_u32 v60, 19, v60
    s_mul_i32 s57, s54, 320
    v_lshrrev_b32 v5, 5, v0
    v_lshlrev_b32 v5, 12, v5
    v_add_u32 v5, s57, v5
    v_lshl_add_u32 v5, v60, 4, v5
    v_and_b32 v60, 31, v0
    v_cmp_gt_u32 s[64:65], 20, v60
    v_min_u32 v60, 19, v60
    v_lshrrev_b32 v35, 5, v0
    v_lshlrev_b32 v35, 2, v35
    v_add_u32 v35, 160832, v35
    v_lshl_add_u32 v35, v60, 3, v35
    s_add_u32 s66, s62, 13312
    s_add_u32 s67, s62, 25856
    s_lshl_b32 s57, s54, 3
    v_lshrrev_b32 v34, 5, v0
    v_lshlrev_b32 v34, 2, v34
L_pad17:
    s_cbranch_execz L_pad21
    v_add_u32 v34, s57, v34
    v_and_b32 v60, 31, v0
    v_mov_b32 v61, 0x7f000000
    v_cmp_ne_u32 vcc, 31, v60
    s_nop 1
    v_cndmask_b32 v34, v34, v61, vcc
    v_mov_b32 v61, 0x3f803f80
    s_add_u32 s57, s7, 0
    s_add_u32 s58, s7, 16384
    s_add_u32 s59, s7, 32768
    s_add_u32 s60, s7, 49152
    s_add_u32 s75, s7, 266240
    v_and_b32 v9, 7, v0
    v_lshlrev_b32 v9, 9, v9
    buffer_load_dword v12, v9, s[40:43], s75 offen sc1
    s_sleep 2
L_pr_177:
    buffer_load_dword v12, v9, s[40:43], s75 offen sc1
    s_sub_u32 s56, s56, 1
    s_cbranch_scc1 L_done
L_pw_176:
    s_waitcnt vmcnt(1)
    v_cmp_eq_u32 vcc, -1, v12
    s_cbranch_vccnz L_pr_177
    s_sleep 1
    buffer_load_dwordx4 v[12:15], v5, s[40:43], s57 offen sc1
    buffer_load_dwordx4 v[16:19], v5, s[40:43], s58 offen sc1
    buffer_load_dwordx4 v[20:23], v5, s[40:43], s59 offen sc1
    buffer_load_dwordx4 v[24:27], v5, s[40:43], s60 offen sc1
    s_sleep 2
L_gw_173:
    buffer_load_dwordx4 v[12:15], v5, s[40:43], s57 offen sc1
    buffer_load_dwordx4 v[16:19], v5, s[40:43], s58 offen sc1
    buffer_load_dwordx4 v[20:23], v5, s[40:43], s59 offen sc1
    buffer_load_dwordx4 v[24:27], v5, s[40:43], s60 offen sc1
    s_sub_u32 s56, s56, 1
    s_cbranch_scc1 L_done
    s_and_b32 s74, s56, 31
    s_waitcnt vmcnt(6)
    v_pk_add_f32 v[28:29], v[12:13], v[16:17]
    v_pk_add_f32 v[30:31], v[14:15], v[18:19]
    s_waitcnt vmcnt(5)
    v_pk_add_f32 v[28:29], v[28:29], v[20:21]
    v_pk_add_f32 v[30:31], v[30:31], v[22:23]
    s_waitcnt vmcnt(4)
    v_pk_add_f32 v[28:29], v[28:29], v[24:25]
    v_pk_add_f32 v[30:31], v[30:31], v[26:27]
    v_pk_add_f32 v[32:33], v[28:29], v[30:31]
    v_cmp_u_f32 vcc, v32, v33
    v_permlane32_swap_b32 v28, v30
    v_permlane32_swap_b32 v29, v31
    s_cbranch_vccnz L_gr_174
L_gk_175:
    v_pk_add_f32 v[28:29], v[28:29], v[30:31]
    v_pk_add_f32 v[28:29], v[28:29], v[2:3]
    v_cvt_pk_bf16_f32 v28, v28, v29
    ds_write_b32 v35, v28
    s_waitcnt lgkmcnt(0)
    s_barrier
    v_cndmask_b32 v29, 0, v28, s[64:65]
    v_dot2_f32_bf16 v33, v29, v61, 0
    v_dot2_f32_bf16 v32, v29, v29, 0
    v_lshlrev_b32 v2, 16, v28
    v_and_b32 v3, 0xffff0000, v28
    s_cmp_eq_u32 s55, 0
    v_permlane32_swap_b32 v33, v32
    v_add_f32 v33, v33, v32
    s_nop 1
    v_add_f32_dpp v33, v33, v33 row_ror:8 row_mask:0xf bank_mask:0xf
    s_nop 1
    v_add_f32_dpp v33, v33, v33 row_ror:4 row_mask:0xf bank_mask:0xf
    s_nop 1
    v_add_f32_dpp v33, v33, v33 row_ror:2 row_mask:0xf bank_mask:0xf
    s_nop 1
    v_add_f32_dpp v33, v33, v33 row_ror:1 row_mask:0xf bank_mask:0xf
    s_nop 1
    v_add_f32_dpp v33, v33, v33 row_bcast:15 row_mask:0xa bank_mask:0xf
    v_min_u32 v33, -2, v33
    s_cbranch_scc1 L_gs_178
    buffer_store_dword v33, v34, s[40:43], s67 offen
L_gb_179:
    s_waitcnt vmcnt(1)
    s_branch L_se_167
L_gs_183:
    buffer_store_dword v12, v11, s[40:43], s59 offen sc1
    s_branch L_gb_184
L_gr_189:
    s_cbranch_scc1 L_gw_188
    s_waitcnt vmcnt(0)
    v_max3_u32 v32, v12, v13, v14
    v_max3_u32 v32, v32, v15, v16
    v_max3_u32 v32, v32, v17, v18
    v_max3_u32 v32, v32, v19, v20
L_pad18:
    s_cbranch_execz L_pad22
    v_max3_u32 v32, v32, v21, v22
    v_max3_u32 v32, v32, v23, v24
    v_max3_u32 v32, v32, v25, v26
    v_max_u32 v32, v32, v27
    v_cmp_eq_u32 vcc, -1, v32
    s_cbranch_vccnz L_gw_188
    v_pk_add_f32 v[28:29], v[12:13], v[16:17]
    v_pk_add_f32 v[30:31], v[14:15], v[18:19]
    v_pk_add_f32 v[28:29], v[28:29], v[20:21]
    v_pk_add_f32 v[30:31], v[30:31], v[22:23]
    v_pk_add_f32 v[28:29], v[28:29], v[24:25]
    v_pk_add_f32 v[30:31], v[30:31], v[26:27]
    s_nop 1
    v_permlane32_swap_b32 v28, v30
    v_permlane32_swap_b32 v29, v31
    s_branch L_gk_190
L_gr_192:
    s_cbranch_scc1 L_gw_191
    s_waitcnt vmcnt(0)
    v_max3_u32 v32, v12, v13, v14
    v_max3_u32 v32, v32, v15, v16
    v_max3_u32 v32, v32, v17, v18
    v_max3_u32 v32, v32, v19, v20
    v_max3_u32 v32, v32, v21, v22
    v_max3_u32 v32, v32, v23, v24
    v_max3_u32 v32, v32, v25, v26
    v_max_u32 v32, v32, v27
    v_cmp_eq_u32 vcc, -1, v32
    s_cbranch_vccnz L_gw_191
    v_pk_add_f32 v[28:29], v[12:13], v[16:17]
    v_pk_add_f32 v[30:31], v[14:15], v[18:19]
    v_pk_add_f32 v[28:29], v[28:29], v[20:21]
    v_pk_add_f32 v[30:31], v[30:31], v[22:23]
    v_pk_add_f32 v[28:29], v[28:29], v[24:25]
    v_pk_add_f32 v[30:31], v[30:31], v[26:27]
    s_nop 1
    v_permlane32_swap_b32 v28, v30
    v_permlane32_swap_b32 v29, v31
    s_branch L_gk_193
L_gs_196:
    buffer_store_dword v33, v34, s[40:43], s67 offen sc1
    s_branch L_gb_197
L_w7_180:
    v_and_b32 v60, 31, v0
    v_min_u32 v60, 19, v60
    s_mul_i32 s57, s54, 320
    v_lshrrev_b32 v5, 5, v0
    v_lshlrev_b32 v5, 12, v5
    v_add_u32 v5, s57, v5
    v_lshl_add_u32 v5, v60, 4, v5
    v_and_b32 v60, 31, v0
    v_cmp_gt_u32 s[64:65], 20, v60
    v_min_u32 v60, 19, v60
    v_lshrrev_b32 v35, 5, v0
    v_lshlrev_b32 v35, 2, v35
    v_add_u32 v35, 160832, v35
    v_lshl_add_u32 v35, v60, 3, v35
    s_mul_i32 s66, s53, 6144
    s_add_u32 s66, s66, s62
    s_add_u32 s66, s66, 46080
    s_lshl_b32 s67, s53, 6
    s_add_u32 s67, s67, s62
    s_add_u32 s67, s67, 25600
    s_lshl_b32 s57, s54, 3
    v_lshrrev_b32 v34, 5, v0
    v_lshlrev_b32 v34, 2, v34
    v_add_u32 v34, s57, v34
    v_and_b32 v60, 31, v0
    v_mov_b32 v61, 0x7f000000
    v_cmp_ne_u32 vcc, 31, v60
    s_nop 1
    v_cndmask_b32 v34, v34, v61, vcc
    v_mov_b32 v61, 0x3f803f80
    s_cmp_lg_u32 s53, 3
    s_cbranch_scc0 L_skip_185
    s_add_u32 s57, s62, 25856
    v_mov_b32 v9, 0
L_pr_187:
    buffer_load_dword v12, v9, s[40:43], s57 offen sc1
    s_sub_u32 s56, s56, 1
    s_cbranch_scc1 L_done
L_pw_186:
    s_waitcnt vmcnt(0)
    v_cmp_eq_u32 vcc, -1, v12
    s_cbranch_vccnz L_pr_187
    s_add_u32 s57, s7, 0
    s_add_u32 s58, s7, 16384
    s_add_u32 s59, s7, 32768
    s_add_u32 s60, s7, 49152
L_gw_188:
    buffer_load_dwordx4 v[12:15], v5, s[40:43], s57 offen sc1
    buffer_load_dwordx4 v[16:19], v5, s[40:43], s58 offen sc1
L_pad19:
    s_cbranch_execz L_pad23
    buffer_load_dwordx4 v[20:23], v5, s[40:43], s59 offen sc1
    buffer_load_dwordx4 v[24:27], v5, s[40:43], s60 offen sc1
    s_sub_u32 s56, s56, 1
    s_cbranch_scc1 L_done
    s_and_b32 s74, s56, 31
    s_waitcnt vmcnt(2)
    v_pk_add_f32 v[28:29], v[12:13], v[16:17]
    v_pk_add_f32 v[30:31], v[14:15], v[18:19]
    s_waitcnt vmcnt(1)
    v_pk_add_f32 v[28:29], v[28:29], v[20:21]
    v_pk_add_f32 v[30:31], v[30:31], v[22:23]
    s_waitcnt vmcnt(0)
    v_pk_add_f32 v[28:29], v[28:29], v[24:25]
    v_pk_add_f32 v[30:31], v[30:31], v[26:27]
    v_pk_add_f32 v[32:33], v[28:29], v[30:31]
    v_cmp_u_f32 vcc, v32, v33
    v_permlane32_swap_b32 v28, v30
    v_permlane32_swap_b32 v29, v31
    s_cbranch_vccnz L_gr_189
L_gk_190:
    v_pk_add_f32 v[28:29], v[28:29], v[30:31]
    v_pk_add_f32 v[28:29], v[28:29], v[2:3]
    v_cvt_pk_bf16_f32 v28, v28, v29
    v_lshlrev_b32 v2, 16, v28
    v_and_b32 v3, 0xffff0000, v28
L_skip_185:
    v_lshlrev_b32 v60, 16, v4
    v_add_f32 v2, v2, v60
    v_and_b32 v60, 0xffff0000, v4
    v_add_f32 v3, v3, v60
    s_add_u32 s57, s7, 66048
    s_add_u32 s58, s7, 82432
    s_add_u32 s59, s7, 98816
    s_add_u32 s60, s7, 115200
    s_lshl_b32 s74, s53, 7
    s_add_u32 s75, s62, s74
    s_add_u32 s75, s75, 26116
    v_mov_b32 v9, 0
    buffer_load_dword v12, v9, s[40:43], s75 offen sc1
    s_sleep 2
L_pr_195:
    buffer_load_dword v12, v9, s[40:43], s75 offen sc1
    s_sub_u32 s56, s56, 1
    s_cbranch_scc1 L_done
L_pw_194:
    s_waitcnt vmcnt(1)
    v_cmp_eq_u32 vcc, -1, v12
    s_cbranch_vccnz L_pr_195
    buffer_load_dwordx4 v[12:15], v5, s[40:43], s57 offen sc1
    buffer_load_dwordx4 v[16:19], v5, s[40:43], s58 offen sc1
    buffer_load_dwordx4 v[20:23], v5, s[40:43], s59 offen sc1
    buffer_load_dwordx4 v[24:27], v5, s[40:43], s60 offen sc1
    s_sleep 2
L_gw_191:
    buffer_load_dwordx4 v[12:15], v5, s[40:43], s57 offen sc1
    buffer_load_dwordx4 v[16:19], v5, s[40:43], s58 offen sc1
    buffer_load_dwordx4 v[20:23], v5, s[40:43], s59 offen sc1
    buffer_load_dwordx4 v[24:27], v5, s[40:43], s60 offen sc1
    s_sub_u32 s56, s56, 1
    s_cbranch_scc1 L_done
    s_and_b32 s74, s56, 31
    s_waitcnt vmcnt(6)
    v_pk_add_f32 v[28:29], v[12:13], v[16:17]
    v_pk_add_f32 v[30:31], v[14:15], v[18:19]
    s_waitcnt vmcnt(5)
    v_pk_add_f32 v[28:29], v[28:29], v[20:21]
    v_pk_add_f32 v[30:31], v[30:31], v[22:23]
    s_waitcnt vmcnt(4)
    v_pk_add_f32 v[28:29], v[28:29], v[24:25]
    v_pk_add_f32 v[30:31], v[30:31], v[26:27]
    v_pk_add_f32 v[32:33], v[28:29], v[30:31]
    v_cmp_u_f32 vcc, v32, v33
    v_permlane32_swap_b32 v28, v30
    v_permlane32_swap_b32 v29, v31
    s_cbranch_vccnz L_gr_192
L_gk_193:
    v_pk_add_f32 v[28:29], v[28:29], v[30:31]
    v_pk_add_f32 v[28:29], v[28:29], v[2:3]
    v_cvt_pk_bf16_f32 v28, v28, v29
    ds_write_b32 v35, v28
    s_waitcnt lgkmcnt(0)
    s_barrier
    v_cndmask_b32 v29, 0, v28, s[64:65]
    v_dot2_f32_bf16 v33, v29, v61, 0
    v_dot2_f32_bf16 v32, v29, v29, 0
    v_lshlrev_b32 v2, 16, v28
    v_and_b32 v3, 0xffff0000, v28
    s_cmp_eq_u32 s55, 0
    v_permlane32_swap_b32 v33, v32
L_pad20:
    s_cbranch_execz L_padback
    v_add_f32 v33, v33, v32
    s_nop 1
    v_add_f32_dpp v33, v33, v33 row_ror:8 row_mask:0xf bank_mask:0xf
    s_nop 1
    v_add_f32_dpp v33, v33, v33 row_ror:4 row_mask:0xf bank_mask:0xf
    s_nop 1
    v_add_f32_dpp v33, v33, v33 row_ror:2 row_mask:0xf bank_mask:0xf
    s_nop 1
    v_add_f32_dpp v33, v33, v33 row_ror:1 row_mask:0xf bank_mask:0xf
    s_nop 1
    v_add_f32_dpp v33, v33, v33 row_bcast:15 row_mask:0xa bank_mask:0xf
    v_min_u32 v33, -2, v33
    s_cbranch_scc1 L_gs_196
    buffer_store_dword v33, v34, s[40:43], s67 offen
L_gb_197:
    s_waitcnt vmcnt(1)
    s_branch L_se_181
L_hr_202:
    buffer_load_dwordx4 v[12:15], v7, s[40:43], s59 offen offset:0 sc1
    buffer_load_dwordx4 v[16:19], v7, s[40:43], s59 offen offset:1024 sc1
    s_sub_u32 s56, s56, 1
    s_cbranch_scc1 L_done
    s_and_b32 s64, s56, 31
    s_cbranch_scc0 L_hx_204
    s_waitcnt vmcnt(0)
    v_pk_add_f32 v[20:21], v[12:13], v[16:17]
    v_pk_add_f32 v[22:23], v[14:15], v[18:19]
    s_nop 1
    v_permlane32_swap_b32 v20, v22
    v_permlane32_swap_b32 v21, v23
    v_pk_add_f32 v[20:21], v[20:21], v[22:23]
    s_nop 1
    v_permlane16_swap_b32 v20, v21
    v_add_f32 v20, v20, v21
    v_cmp_u_f32 vcc, v20, v20
    v_sub_f32 v20, v20, v50
    s_cbranch_vccnz L_hr_202
    s_branch L_hk_203
L_hx_204:
    s_waitcnt vmcnt(0)
    v_max3_u32 v20, v12, v13, v14
    v_max3_u32 v20, v20, v15, v16
    v_max3_u32 v20, v20, v17, v18
    v_max_u32 v20, v20, v19
    v_cmp_eq_u32 vcc, -1, v20
    s_cbranch_vccnz L_hr_202
    v_pk_add_f32 v[20:21], v[12:13], v[16:17]
    v_pk_add_f32 v[22:23], v[14:15], v[18:19]
    s_nop 1
    v_permlane32_swap_b32 v20, v22
    v_permlane32_swap_b32 v21, v23
    v_pk_add_f32 v[20:21], v[20:21], v[22:23]
    s_nop 1
    v_permlane16_swap_b32 v20, v21
    v_add_f32 v20, v20, v21
    v_sub_f32 v20, v20, v50
    s_branch L_hk_203
L_qo_198:
    v_mov_b64 v[24:25], 0
    v_mov_b64 v[26:27], 0
    v_mov_b64 v[28:29], 0
    v_mov_b64 v[30:31], 0
    v_mov_b64 v[32:33], 0
    v_mov_b64 v[34:35], 0
    v_mov_b64 v[36:37], 0
    v_mov_b64 v[38:39], 0
    v_mov_b64 v[40:41], 0
    v_mov_b64 v[42:43], 0
    v_mov_b64 v[44:45], 0
    v_mov_b64 v[46:47], 0
    v_lshrrev_b32 v5, 4, v0
    v_lshlrev_b32 v5, 5, v5
    v_bfe_u32 v60, v0, 1, 1
    v_lshl_add_u32 v5, v60, 4, v5
    v_add_u32 v5, 124928, v5
    s_branch L_qb_199
L_mr_205:
    ds_read_b32 v36, v62
    s_sub_u32 s56, s56, 1
    s_cbranch_scc1 L_done
    s_waitcnt lgkmcnt(0)
    v_cmp_eq_u32 vcc, -1, v36
    s_cbranch_vccnz L_mr_205
    v_max_f32_dpp v37, v36, v36 row_ror:4 row_mask:0xf bank_mask:0xf
    s_nop 1
    v_max_f32_dpp v37, v37, v37 row_ror:2 row_mask:0xf bank_mask:0xf
    s_nop 1
    v_max_f32_dpp v37, v37, v37 row_ror:1 row_mask:0xf bank_mask:0xf
    v_sub_f32 v39, v61, v37
    v_exp_f32 v39, v39
    s_branch L_mk_206
L_gs_207:
    buffer_store_dword v37, v4, s[40:43], s58 offen sc1
    s_branch L_gb_208
L_gs_209:
    buffer_store_dword v14, v3, s[40:43], s57 offen sc1
    s_branch L_gb_210
L_gs_211:
    buffer_store_dword v12, v4, s[40:43], s57 offen offset:32 sc1
    s_branch L_gb_212
L_comb_1:
    s_mov_b32 s58, 26624
    v_min_u32 v37, -2, v37
    s_cmp_eq_u32 s55, 0
    s_cbranch_scc1 L_gs_207
    buffer_store_dword v37, v4, s[40:43], s58 offen
L_gb_208:
    s_mov_b32 s57, 26624
L_pad21:
    s_cbranch_execz L_padback
    s_cmp_eq_u32 s55, 0
    s_waitcnt lgkmcnt(0)
    s_barrier
    ds_read2st64_b64 v[12:15], v2 offset0:0 offset1:4
    ds_read2st64_b64 v[16:19], v2 offset0:8 offset1:12
    ds_read2st64_b64 v[20:23], v2 offset0:16 offset1:20
    ds_read2st64_b64 v[24:27], v2 offset0:24 offset1:28
    s_waitcnt lgkmcnt(2)
    v_pk_add_f32 v[12:13], v[12:13], v[14:15]
    v_pk_add_f32 v[16:17], v[16:17], v[18:19]
    v_pk_add_f32 v[12:13], v[12:13], v[16:17]
    s_waitcnt lgkmcnt(0)
    v_pk_add_f32 v[20:21], v[20:21], v[22:23]
    v_pk_add_f32 v[24:25], v[24:25], v[26:27]
    v_pk_add_f32 v[12:13], v[12:13], v[20:21]
    v_pk_add_f32 v[12:13], v[12:13], v[24:25]
    v_cvt_pk_bf16_f32 v14, v12, v13
    v_min_u32 v12, -2, v12
    v_min_u32 v14, -2, v14
    s_cbranch_scc1 L_gs_209
    buffer_store_dword v14, v3, s[40:43], s57 offen
L_gb_210:
    s_cbranch_scc1 L_gs_211
    buffer_store_dword v12, v4, s[40:43], s57 offen offset:32
L_gb_212:
    s_branch L_comb_1b
L_sr_222:
    buffer_load_dwordx4 v[52:55], v11, s[40:43], s65 offen offset:0 sc1
    buffer_load_dwordx4 v[56:59], v11, s[40:43], s65 offen offset:1024 sc1
    s_sub_u32 s56, s56, 1
    s_cbranch_scc1 L_done
    s_waitcnt vmcnt(0)
    s_branch L_sw_221
L_hr_223:
    buffer_load_dwordx4 v[12:15], v11, s[40:43], s58 offen offset:0 sc1
    buffer_load_dwordx4 v[16:19], v11, s[40:43], s58 offen offset:1024 sc1
    s_sub_u32 s56, s56, 1
    s_cbranch_scc1 L_done
    s_and_b32 s64, s56, 31
    s_cbranch_scc0 L_hx_225
    s_waitcnt vmcnt(2)
    v_pk_add_f32 v[20:21], v[12:13], v[16:17]
    v_pk_add_f32 v[22:23], v[14:15], v[18:19]
    s_nop 1
    v_permlane32_swap_b32 v20, v22
    v_permlane32_swap_b32 v21, v23
    v_pk_add_f32 v[20:21], v[20:21], v[22:23]
    s_nop 1
    v_permlane16_swap_b32 v20, v21
    v_add_f32 v20, v20, v21
    v_cmp_u_f32 vcc, v20, v20
    v_sub_f32 v20, v20, v26
    s_cbranch_vccnz L_hr_223
    s_branch L_hk_224
L_hx_225:
    s_waitcnt vmcnt(0)
    v_max3_u32 v20, v12, v13, v14
    v_max3_u32 v20, v20, v15, v16
    v_max3_u32 v20, v20, v17, v18
    v_max_u32 v20, v20, v19
    v_cmp_eq_u32 vcc, -1, v20
    s_cbranch_vccnz L_hr_223
    v_pk_add_f32 v[20:21], v[12:13], v[16:17]
    v_pk_add_f32 v[22:23], v[14:15], v[18:19]
    s_nop 1
    v_permlane32_swap_b32 v20, v22
    v_permlane32_swap_b32 v21, v23
    v_pk_add_f32 v[20:21], v[20:21], v[22:23]
    s_nop 1
    v_permlane16_swap_b32 v20, v21
    v_add_f32 v20, v20, v21
    v_sub_f32 v20, v20, v26
    s_branch L_hk_224
L_typeC_228:
    s_cmp_eq_u32 s30, 6
    s_cbranch_scc0 L_done
    s_cmp_eq_u32 s3, 20
    s_cbranch_scc0 L_done
    s_lshl_b32 s59, s31, 9
    s_add_u32 s59, s59, s8
    s_add_u32 s59, s59, 266240
    v_and_b32 v10, 1, v0
    v_lshlrev_b32 v10, 13, v10
    v_lshrrev_b32 v60, 1, v0
    v_lshl_add_u32 v10, v60, 24, v10
    s_add_u32 s58, s62, 28192
    v_lshrrev_b32 v9, 3, v0
    v_mul_u32_u24 v9, 1664, v9
    v_and_b32 v60, 7, v0
    v_lshl_add_u32 v9, v60, 2, v9
    buffer_load_dword v12, v9, s[40:43], s58 offen sc1
    s_sleep 2
L_pr_230:
    buffer_load_dword v12, v9, s[40:43], s58 offen sc1
    s_sub_u32 s56, s56, 1
    s_cbranch_scc1 L_done
L_pw_229:
    s_waitcnt vmcnt(1)
    v_cmp_eq_u32 vcc, -1, v12
    s_cbranch_vccnz L_pr_230
L_pad22:
    s_cbranch_execz L_padback
    buffer_store_dword v0, v10, s[40:43], s59 offen offset:8 sc1
    s_add_u32 s58, s62, 25984
    v_and_b32 v9, 15, v0
    v_lshlrev_b32 v9, 2, v9
    buffer_load_dword v13, v9, s[40:43], s58 offen sc1
    s_sleep 2
L_pr_232:
    buffer_load_dword v13, v9, s[40:43], s58 offen sc1
    s_sub_u32 s56, s56, 1
    s_cbranch_scc1 L_done
L_pw_231:
    s_waitcnt vmcnt(1)
    v_cmp_eq_u32 vcc, -1, v13
    s_cbranch_vccnz L_pr_232
    buffer_store_dword v0, v10, s[40:43], s59 offen offset:12 sc1
    s_waitcnt vmcnt(1)
    s_branch L_done
L_gs_236:
    buffer_store_dword v12, v11, s[40:43], s59 offen sc1
    s_branch L_gb_237
L_gr_239:
    s_cbranch_scc1 L_gw_238
    s_waitcnt vmcnt(0)
    v_max3_u32 v32, v12, v13, v14
    v_max3_u32 v32, v32, v15, v16
    v_max3_u32 v32, v32, v17, v18
    v_max3_u32 v32, v32, v19, v20
    v_max3_u32 v32, v32, v21, v22
    v_max3_u32 v32, v32, v23, v24
    v_max3_u32 v32, v32, v25, v26
    v_max_u32 v32, v32, v27
    v_cmp_eq_u32 vcc, -1, v32
    s_cbranch_vccnz L_gw_238
    v_pk_add_f32 v[28:29], v[12:13], v[16:17]
    v_pk_add_f32 v[30:31], v[14:15], v[18:19]
    v_pk_add_f32 v[28:29], v[28:29], v[20:21]
    v_pk_add_f32 v[30:31], v[30:31], v[22:23]
    v_pk_add_f32 v[28:29], v[28:29], v[24:25]
    v_pk_add_f32 v[30:31], v[30:31], v[26:27]
    s_nop 1
    v_permlane32_swap_b32 v28, v30
    v_permlane32_swap_b32 v29, v31
    s_branch L_gk_240
L_gs_243:
    buffer_store_dword v33, v34, s[40:43], s67 offen sc1
    s_branch L_gb_244
L_w7_233:
    v_and_b32 v60, 31, v0
    v_min_u32 v60, 19, v60
    s_mul_i32 s57, s54, 320
    v_lshrrev_b32 v5, 5, v0
    v_lshlrev_b32 v5, 12, v5
    v_add_u32 v5, s57, v5
    v_lshl_add_u32 v5, v60, 4, v5
    v_and_b32 v60, 31, v0
    v_cmp_gt_u32 s[64:65], 20, v60
    v_min_u32 v60, 19, v60
    v_lshrrev_b32 v35, 5, v0
    v_lshlrev_b32 v35, 2, v35
    v_add_u32 v35, 160832, v35
    v_lshl_add_u32 v35, v60, 3, v35
    s_add_u32 s66, s62, 39936
    s_add_u32 s67, s62, 25984
    s_lshl_b32 s57, s54, 3
    v_lshrrev_b32 v34, 5, v0
    v_lshlrev_b32 v34, 2, v34
    v_add_u32 v34, s57, v34
    v_and_b32 v60, 31, v0
    v_mov_b32 v61, 0x7f000000
    v_cmp_ne_u32 vcc, 31, v60
    s_nop 1
    v_cndmask_b32 v34, v34, v61, vcc
    v_mov_b32 v61, 0x3f803f80
    s_add_u32 s57, s7, 132096
    s_add_u32 s58, s7, 148480
    s_add_u32 s59, s7, 164864
    s_add_u32 s60, s7, 181248
    s_add_u32 s75, s7, 266248
    v_and_b32 v9, 7, v0
    v_lshlrev_b32 v9, 9, v9
    buffer_load_dword v12, v9, s[40:43], s75 offen sc1
    s_sleep 2
L_pr_242:
    buffer_load_dword v12, v9, s[40:43], s75 offen sc1
    s_sub_u32 s56, s56, 1
    s_cbranch_scc1 L_done
L_pw_241:
    s_waitcnt vmcnt(1)
    v_cmp_eq_u32 vcc, -1, v12
    s_cbranch_vccnz L_pr_242
    s_sleep 2
    buffer_load_dwordx4 v[12:15], v5, s[40:43], s57 offen sc1
    buffer_load_dwordx4 v[16:19], v5, s[40:43], s58 offen sc1
    buffer_load_dwordx4 v[20:23], v5, s[40:43], s59 offen sc1
    buffer_load_dwordx4 v[24:27], v5, s[40:43], s60 offen sc1
L_pad23:
    s_cbranch_execz L_padback
    s_sleep 2
L_gw_238:
    buffer_load_dwordx4 v[12:15], v5, s[40:43], s57 offen sc1
    buffer_load_dwordx4 v[16:19], v5, s[40:43], s58 offen sc1
    buffer_load_dwordx4 v[20:23], v5, s[40:43], s59 offen sc1
    buffer_load_dwordx4 v[24:27], v5, s[40:43], s60 offen sc1
    s_sub_u32 s56, s56, 1
    s_cbranch_scc1 L_done
    s_and_b32 s74, s56, 31
    s_waitcnt vmcnt(6)
    v_pk_add_f32 v[28:29], v[12:13], v[16:17]
    v_pk_add_f32 v[30:31], v[14:15], v[18:19]
    s_waitcnt vmcnt(5)
    v_pk_add_f32 v[28:29], v[28:29], v[20:21]
    v_pk_add_f32 v[30:31], v[30:31], v[22:23]
    s_waitcnt vmcnt(4)
    v_pk_add_f32 v[28:29], v[28:29], v[24:25]
    v_pk_add_f32 v[30:31], v[30:31], v[26:27]
    v_pk_add_f32 v[32:33], v[28:29], v[30:31]
    v_cmp_u_f32 vcc, v32, v33
    v_permlane32_swap_b32 v28, v30
    v_permlane32_swap_b32 v29, v31
    s_cbranch_vccnz L_gr_239
L_gk_240:
    v_pk_add_f32 v[28:29], v[28:29], v[30:31]
    v_pk_add_f32 v[28:29], v[28:29], v[2:3]
    v_cvt_pk_bf16_f32 v28, v28, v29
    ds_write_b32 v35, v28
    s_waitcnt lgkmcnt(0)
    s_barrier
    v_cndmask_b32 v29, 0, v28, s[64:65]
    v_dot2_f32_bf16 v33, v29, v61, 0
    v_dot2_f32_bf16 v32, v29, v29, 0
    v_lshlrev_b32 v2, 16, v28
    v_and_b32 v3, 0xffff0000, v28
    s_cmp_eq_u32 s55, 0
    v_permlane32_swap_b32 v33, v32
    v_add_f32 v33, v33, v32
    s_nop 1
    v_add_f32_dpp v33, v33, v33 row_ror:8 row_mask:0xf bank_mask:0xf
    s_nop 1
    v_add_f32_dpp v33, v33, v33 row_ror:4 row_mask:0xf bank_mask:0xf
    s_nop 1
    v_add_f32_dpp v33, v33, v33 row_ror:2 row_mask:0xf bank_mask:0xf
    s_nop 1
    v_add_f32_dpp v33, v33, v33 row_ror:1 row_mask:0xf bank_mask:0xf
    s_nop 1
    v_add_f32_dpp v33, v33, v33 row_bcast:15 row_mask:0xa bank_mask:0xf
    v_min_u32 v33, -2, v33
    s_cbranch_scc1 L_gs_243
    buffer_store_dword v33, v34, s[40:43], s67 offen
L_gb_244:
    s_waitcnt vmcnt(1)
    s_branch L_se_234
L_gr_246:
    s_cbranch_scc1 L_gw_245
    s_waitcnt vmcnt(0)
    v_max3_u32 v32, v12, v13, v14
    v_max3_u32 v32, v32, v15, v16
    v_max3_u32 v32, v32, v17, v18
    v_max3_u32 v32, v32, v19, v20
    v_max3_u32 v32, v32, v21, v22
    v_max3_u32 v32, v32, v23, v24
    v_max3_u32 v32, v32, v25, v26
    v_max_u32 v32, v32, v27
    v_cmp_eq_u32 vcc, -1, v32
    s_cbranch_vccnz L_gw_245
    v_pk_add_f32 v[28:29], v[12:13], v[16:17]
    v_pk_add_f32 v[30:31], v[14:15], v[18:19]
    v_pk_add_f32 v[28:29], v[28:29], v[20:21]
    v_pk_add_f32 v[30:31], v[30:31], v[22:23]
    v_pk_add_f32 v[28:29], v[28:29], v[24:25]
    v_pk_add_f32 v[30:31], v[30:31], v[26:27]
    s_nop 1
    v_permlane32_swap_b32 v28, v30
    v_permlane32_swap_b32 v29, v31
    s_branch L_gk_247
L_tail_end:
L_spread:
    s_add_u32 s62, s62, 966656
    s_cmp_eq_u32 s30, 5
    s_cbranch_scc0 L_skip_80
    v_mov_b64 v[12:13], -1
    v_mov_b64 v[14:15], -1
    v_lshlrev_b32 v16, 4, v0
    s_mul_i32 s57, s52, 2208
    s_add_u32 s57, s57, s62
    s_mov_b64 exec, 0x3ff
    buffer_store_dwordx4 v[12:15], v16, s[40:43], s57 offen offset:2048 sc1
    s_mov_b64 exec, -1
    buffer_store_dwordx4 v[12:15], v16, s[40:43], s57 offen offset:0 sc1
    buffer_store_dwordx4 v[12:15], v16, s[40:43], s57 offen offset:1024 sc1
L_skip_80:
    s_cmp_eq_u32 s30, 7
    s_cbranch_scc0 L_skip_81
    v_and_b32 v60, 31, v0
    v_cmp_gt_u32 s[64:65], 20, v60
    v_min_u32 v60, 19, v60
    v_lshrrev_b32 v35, 5, v0
    v_lshlrev_b32 v35, 2, v35
    v_add_u32 v35, 160832, v35
    v_lshl_add_u32 v35, v60, 3, v35
    s_mul_i32 s66, s53, 12416
    s_add_u32 s66, s66, s62
    s_add_u32 s66, s66, 70656
    s_add_u32 s67, s66, 12288
    s_lshl_b32 s57, s54, 3
    v_lshrrev_b32 v34, 5, v0
    v_lshlrev_b32 v34, 2, v34
    v_add_u32 v34, s57, v34
    v_and_b32 v60, 31, v0
    v_mov_b32 v61, 0x7f000000
    v_cmp_ne_u32 vcc, 31, v60
    s_nop 1
    v_cndmask_b32 v34, v34, v61, vcc
    v_mov_b32 v61, 0x3f803f80
    v_cvt_pk_bf16_f32 v28, v2, v3
L_skip_81:
    s_cmp_eq_u32 s30, 7
    s_cbranch_scc0 L_skip_82
    v_cndmask_b32 v29, 0, v28, s[64:65]
    v_dot2_f32_bf16 v33, v29, v61, 0
    v_dot2_f32_bf16 v32, v29, v29, 0
    v_lshlrev_b32 v2, 16, v28
    v_and_b32 v3, 0xffff0000, v28
    s_cmp_eq_u32 s55, 0
    v_permlane32_swap_b32 v33, v32
    v_add_f32 v33, v33, v32
    s_nop 1
    v_add_f32_dpp v33, v33, v33 row_ror:8 row_mask:0xf bank_mask:0xf
    s_nop 1
    v_add_f32_dpp v33, v33, v33 row_ror:4 row_mask:0xf bank_mask:0xf
    s_nop 1
    v_add_f32_dpp v33, v33, v33 row_ror:2 row_mask:0xf bank_mask:0xf
    s_nop 1
    v_add_f32_dpp v33, v33, v33 row_ror:1 row_mask:0xf bank_mask:0xf
    s_nop 1
    v_add_f32_dpp v33, v33, v33 row_bcast:15 row_mask:0xa bank_mask:0xf
    v_min_u32 v33, -2, v33
    s_cbranch_scc1 L_gs_83
    buffer_store_dword v33, v34, s[40:43], s67 offen
L_gb_84:
    s_waitcnt vmcnt(1)
L_skip_82:
    s_cmp_lt_u32 s30, 6
    s_cbranch_scc0 L_skip_85
    s_lshr_b32 s57, s30, 1
    s_mul_i32 s57, s57, 1024
    s_and_b32 s58, s30, 1
    s_lshl_b32 s58, s58, 6
    s_add_u32 s57, s57, s58
    v_lshrrev_b32 v18, 5, v0
    v_mul_u32_u24 v18, 6144, v18
    v_bfe_u32 v60, v0, 3, 1
    v_mul_u32_u24 v60, 3072, v60
    v_add_u32 v18, v60, v18
    v_bfe_u32 v60, v0, 4, 1
    v_lshl_add_u32 v18, v60, 9, v18
    v_bfe_u32 v60, v0, 2, 1
    v_lshl_add_u32 v18, v60, 7, v18
    v_and_b32 v60, 3, v0
    v_lshl_add_u32 v18, v60, 3, v18
    v_add_u32 v18, s57, v18
    v_bfe_u32 v19, v0, 4, 1
    v_mul_u32_u24 v19, 3072, v19
    v_bfe_u32 v60, v0, 3, 1
    v_lshl_add_u32 v19, v60, 9, v19
    v_bfe_u32 v60, v0, 2, 1
    v_lshl_add_u32 v19, v60, 7, v19
    v_and_b32 v60, 3, v0
    v_lshl_add_u32 v19, v60, 3, v19
    v_add_u32 v19, s57, v19
    v_add_u32 v19, 24576, v19
    ds_read_b64_tr_b16 v[28:29], v18 offset:0
    ds_read_b64_tr_b16 v[30:31], v18 offset:256
    ds_read_b64_tr_b16 v[32:33], v18 offset:12288
    ds_read_b64_tr_b16 v[34:35], v18 offset:12544
    ds_read_b64_tr_b16 v[36:37], v19 offset:0
    ds_read_b64_tr_b16 v[38:39], v19 offset:256
    ds_read_b64_tr_b16 v[40:41], v18 offset:32
    ds_read_b64_tr_b16 v[42:43], v18 offset:288
    ds_read_b64_tr_b16 v[44:45], v18 offset:12320
    ds_read_b64_tr_b16 v[46:47], v18 offset:12576
    ds_read_b64_tr_b16 v[48:49], v19 offset:32
    ds_read_b64_tr_b16 v[50:51], v19 offset:288
    v_lshrrev_b32 v52, 4, v0
    v_lshlrev_b32 v52, 5, v52
    v_bfe_u32 v60, v0, 1, 1
    v_lshl_add_u32 v52, v60, 4, v52
    v_and_b32 v60, 1, v0
    v_mul_u32_u24 v60, 192, v60
    v_add_u32 v52, v60, v52
    v_add_u32 v52, 160832, v52
    v_lshrrev_b32 v53, 4, v0
    v_lshlrev_b32 v53, 4, v53
    v_bfe_u32 v60, v0, 1, 1
    v_lshl_add_u32 v53, v60, 3, v53
    v_and_b32 v60, 1, v0
    v_mul_u32_u24 v60, 192, v60
    v_add_u32 v53, v60, v53
    v_add_u32 v53, 160960, v53
    v_mov_b64 v[20:21], 0
    v_mov_b64 v[22:23], 0
    v_mov_b64 v[24:25], 0
    v_mov_b64 v[26:27], 0
    s_lshr_b32 s57, s30, 1
    s_lshl_b32 s57, s57, 11
    s_lshl_b32 s58, s58, 1
    s_add_u32 s57, s57, s58
    s_lshl_b32 s58, s54, 8
    s_add_u32 s57, s57, s58
    v_and_b32 v54, 31, v0
    v_lshlrev_b32 v54, 2, v54
    v_lshrrev_b32 v60, 5, v0
    v_mul_u32_u24 v60, 6144, v60
    v_add_u32 v54, v60, v54
    v_add_u32 v54, s57, v54
    s_mul_i32 s59, s53, 12416
    s_add_u32 s59, s59, s62
    s_add_u32 s59, s59, 70656
    s_add_u32 s60, s59, 12288
    ds_read_b128 v[12:15], v52
    ds_read_b64 v[16:17], v53
    s_waitcnt lgkmcnt(1)
    v_smfmac_f32_16x16x64_bf16 v[20:23], v[12:15], v[28:35], v1
    v_smfmac_f32_16x16x64_bf16 v[24:27], v[12:15], v[40:47], v1
    s_waitcnt lgkmcnt(0)
    v_smfmac_f32_16x16x32_bf16 v[20:23], v[16:17], v[36:39], v1
    v_smfmac_f32_16x16x32_bf16 v[24:27], v[16:17], v[48:51], v1
    s_cmp_eq_u32 s55, 0
    s_nop 5
    v_add_f32 v12, v20, v22
    s_nop 1
    v_add_f32_dpp v12, v24, v26 quad_perm:[0,1,2,3] row_mask:0x2 bank_mask:0xf
    s_nop 1
    v_add_f32_dpp v12, v21, v23 quad_perm:[0,1,2,3] row_mask:0x4 bank_mask:0xf
    s_nop 1
    v_add_f32_dpp v12, v25, v27 quad_perm:[0,1,2,3] row_mask:0x8 bank_mask:0xf
    v_min_u32 v12, -2, v12
    s_cbranch_scc1 L_gs_86
    buffer_store_dword v12, v54, s[40:43], s59 offen
L_gb_87:
L_skip_85:
    s_waitcnt vmcnt(0)
    s_barrier
    s_cmp_eq_u32 s30, 5
    s_cbranch_scc0 L_skip_88
    v_mov_b32 v25, 0
    s_lshl_b32 s57, s52, 2
    s_add_u32 s57, s57, s72
    s_mov_b64 exec, 1
    buffer_store_dword v25, v0, s[40:43], s57 offen offset:256 sc1
    s_mov_b64 exec, -1
    v_and_b32 v16, 31, v0
    v_lshlrev_b32 v16, 2, v16
L_pr_90:
    buffer_load_dword v17, v16, s[40:43], s72 offen offset:256 sc1
    s_sub_u32 s56, s56, 1
    s_cbranch_scc1 L_done
L_pw_89:
    s_waitcnt vmcnt(0)
    v_cmp_eq_u32 vcc, -1, v17
    s_cbranch_vccnz L_pr_90
L_skip_88:
    s_barrier
    s_branch L_spread_back
L_done:
L_exit:
    s_endpgm
.section .rodata,"a"
.p2align 6
.amdhsa_kernel interleave_layers__sliding_block_cached__dense_activation_gelu__decode_kernel
  .amdhsa_next_free_vgpr 256
  .amdhsa_next_free_sgpr 102
  .amdhsa_accum_offset 256
  .amdhsa_group_segment_fixed_size 0
  .amdhsa_kernarg_size 104
  .amdhsa_user_sgpr_count 2
  .amdhsa_user_sgpr_kernarg_segment_ptr 1
  .amdhsa_system_sgpr_workgroup_id_x 1
  .amdhsa_float_denorm_mode_32 3
.end_amdhsa_kernel
```

```asm
; @launch grid=(256,1,1) block=(512,1,1) lds=161216
.amdgcn_target "amdgcn-amd-amdhsa--gfx950"
.text
.fill 64, 4, 0xbf800000
.globl interleave_layers__sliding_block_cached__dense_activation_gelu__decode_kernel
.p2align 8
.type interleave_layers__sliding_block_cached__dense_activation_gelu__decode_kernel,@function
interleave_layers__sliding_block_cached__dense_activation_gelu__decode_kernel:
    s_load_dwordx16 s[4:19], s[0:1], 0
    s_load_dwordx8 s[20:27], s[0:1], 64
    s_load_dwordx2 s[28:29], s[0:1], 96
    s_cmp_ge_u32 s2, 256
    s_cbranch_scc1 L_exit
    s_getpc_b64 s[74:75]
L_pc:
    v_lshlrev_b32 v5, 6, v0
    v_min_u32 v5, L_exit-L_pc, v5
    global_load_dword v63, v5, s[74:75]
    v_lshrrev_b32 v5, 6, v0
    v_and_b32 v0, 63, v0
    v_readfirstlane_b32 s30, v5
    s_and_b32 s31, s2, 7
    s_lshr_b32 s52, s2, 3
    s_and_b32 s53, s52, 3
    s_lshr_b32 s54, s52, 2
    s_lshl_b32 s73, s31, 2
    s_add_u32 s73, s73, s53
    s_mul_i32 s3, s54, 3
    s_add_u32 s3, s3, s53
    s_cmp_eq_u32 s53, 3
    s_cselect_b32 s3, 31, s3
    v_lshrrev_b32 v8, 5, v0
    v_lshlrev_b32 v8, 2, v8
    v_bfe_u32 v60, v0, 4, 1
    v_lshl_add_u32 v8, v60, 0, v8
    v_and_b32 v9, 7, v0
    v_xor_b32 v8, v8, v9
    v_lshrrev_b32 v10, 3, v0
    v_mul_u32_u24 v10, 384, v10
    v_lshl_add_u32 v5, v8, 4, v10
    v_xor_b32 v6, 32, v5
    v_lshrrev_b32 v8, 4, v0
    v_lshlrev_b32 v8, 1, v8
    v_xor_b32 v8, v8, v9
    v_lshl_add_u32 v7, v8, 4, v10
    v_lshrrev_b32 v2, 3, v0
    v_mul_u32_u24 v2, 12288, v2
    v_and_b32 v60, 7, v0
    v_lshl_add_u32 v2, v60, 4, v2
    s_mul_i32 s57, s73, 12582912
    s_mul_i32 s58, s54, 3072
    s_add_u32 s57, s57, s58
    s_add_u32 s57, s57, 11010048
    s_sub_u32 s58, 1572864, s58
    s_mul_i32 s59, s73, 384
    s_mul_i32 s60, s54, 983040
    s_add_u32 s59, s59, s60
    s_sub_u32 s60, 7866368, s59
    s_lshl_b32 s61, s30, 11
    s_add_u32 s61, s61, 92160
    s_mul_i32 s62, s31, 120832
    s_add_u32 s62, s62, 299008
    s_lshl_b32 s72, s31, 9
    s_add_u32 s72, s72, 294912
    s_mov_b32 s56, 65536
    s_mov_b32 s55, 1
    s_getreg_b32 s63, hwreg(20, 0, 3)
    v_mov_b32 v3, 0
    v_mov_b32 v4, 0
    v_mov_b32 v11, 0
    v_mov_b32 v24, 0
    v_mov_b32 v34, 0
    v_mov_b64 v[12:13], -1
    v_mov_b64 v[14:15], -1
    v_lshlrev_b32 v10, 4, v0
    s_waitcnt lgkmcnt(0)
    s_add_u32 s32, s6, s57
    s_addc_u32 s33, s7, 0
    s_mov_b32 s34, s58
    s_mov_b32 s35, 0x20000
    s_add_u32 s36, s8, s57
    s_addc_u32 s37, s9, 0
    s_mov_b32 s38, s58
    s_mov_b32 s39, 0x20000
    s_mov_b32 s40, s28
    s_mov_b32 s41, s29
    s_mov_b32 s42, 2232320
    s_mov_b32 s43, 0x20000
    s_add_u32 s44, s10, s59
    s_addc_u32 s45, s11, 0
    s_mov_b32 s46, s60
    s_mov_b32 s47, 0x20000
    s_sub_u32 s44, s44, 2048
    s_subb_u32 s45, s45, 0
    s_cmp_eq_u32 s30, 6
    s_cbranch_scc0 L_skip_1
    s_setprio 3
    s_mov_b32 s57, 0
    s_mov_b32 s58, 195584
    s_mov_b32 m0, 92160
L_dma_2:
    s_nop 0
    buffer_load_dwordx4 v5, s[32:35], s57 offen offset:0 nt lds
    buffer_load_dwordx4 v6, s[32:35], s58 offen offset:1024 nt lds
    s_add_u32 s57, s57, 24576
    s_add_u32 s58, s58, 24576
    s_add_u32 m0, m0, 2048
    s_cmp_lg_u32 m0, 108544
    s_cbranch_scc1 L_dma_2
    s_mov_b32 s57, 128
    s_mov_b32 s58, 195712
    s_mov_b32 m0, 108544
L_dma_3:
    s_waitcnt vmcnt(22)
L_go_4:
    buffer_load_dwordx4 v5, s[32:35], s57 offen offset:0 nt lds
    buffer_load_dwordx4 v6, s[32:35], s58 offen offset:1024 nt lds
    s_add_u32 s57, s57, 24576
    s_add_u32 s58, s58, 24576
    s_add_u32 m0, m0, 2048
    s_cmp_lg_u32 m0, 124928
    s_cbranch_scc1 L_dma_3
    s_mov_b32 s57, 2048
    s_mov_b32 s58, 1152
    s_mov_b32 s59, 256
    s_mov_b32 m0, 0
L_dma_5:
    s_waitcnt vmcnt(22)
L_go_6:
    buffer_load_dwordx4 v2, s[44:47], s57 offen offset:0 nt lds
    buffer_load_dwordx4 v2, s[44:47], s58 offen offset:1024 nt lds
    buffer_load_dwordx4 v2, s[44:47], s59 offen offset:2048 nt lds
    s_add_u32 s57, s57, 98304
    s_add_u32 s58, s58, 98304
    s_add_u32 s59, s59, 98304
    s_add_u32 m0, m0, 3072
    s_cmp_lg_u32 m0, 15360
    s_cbranch_scc1 L_dma_5
L_skip_1:
    s_cmp_lt_u32 s3, 20
    s_cselect_b32 s57, 7864320, 0
    s_add_u32 s58, s54, 1
    s_mul_i32 s58, s58, 245760
    s_cmp_lg_u32 s53, 3
    s_cselect_b64 s[48:49], s[12:13], s[16:17]
    s_cselect_b32 s50, s57, s58
    s_mov_b32 s51, 0x20000
    s_add_u32 s57, s28, 0
    s_sub_u32 s57, 0, s57
    s_and_b32 s57, s57, 0x3fff
    s_add_u32 s57, s57, 0
    s_lshr_b32 s58, s31, 1
    s_lshl_b32 s58, s58, 14
    s_add_u32 s6, s57, s58
    s_and_b32 s58, s31, 1
    s_lshl_b32 s58, s58, 12
    s_add_u32 s6, s6, s58
    s_lshl_b32 s58, s3, 7
    s_add_u32 s6, s6, s58
    s_mov_b32 s8, s57
    s_and_b32 s59, s3, 3
    s_lshl_b32 s58, s31, 2
    s_add_u32 s59, s59, s58
    s_lshl_b32 s59, s59, 7
    s_add_u32 s59, s59, s57
    s_add_u32 s59, s59, 262144
    s_add_u32 s10, s28, s59
    s_addc_u32 s11, s29, 0
    s_lshr_b32 s58, s63, 2
    s_xor_b32 s58, s58, 0
    s_mul_i32 s58, s58, 8192
    s_add_u32 s7, s57, s58
    s_cmp_eq_u32 s30, 5
    s_cbranch_scc0 L_skip_7
    s_cmp_eq_u32 s52, 31
    s_cbranch_scc0 L_skip_8
    s_mov_b64 exec, 0xffffff
    buffer_store_dwordx4 v[12:15], v10, s[40:43], s72 offen sc1
    s_mov_b64 exec, -1
L_skip_8:
    s_cmp_lt_u32 s3, 20
    s_cbranch_scc0 L_skip_9
    v_and_b32 v16, 7, v0
    v_lshlrev_b32 v16, 4, v16
    v_bfe_u32 v17, v0, 3, 1
    v_lshl_add_u32 v16, v17, 13, v16
    v_lshrrev_b32 v17, 4, v0
    v_mul_u32_u24 v17, 66048, v17
    v_add_u32 v16, v17, v16
    s_add_u32 s57, s6, 0
    buffer_store_dwordx4 v[12:15], v16, s[40:43], s57 offen sc1
L_skip_9:
    s_cmp_eq_u32 s3, 20
    s_cbranch_scc0 L_skip_10
    s_lshl_b32 s58, s31, 9
    s_add_u32 s58, s58, s8
    s_add_u32 s58, s58, 266240
    v_and_b32 v16, 7, v0
    v_lshlrev_b32 v16, 4, v16
    v_bfe_u32 v60, v0, 3, 1
    v_lshl_add_u32 v16, v60, 13, v16
    v_lshrrev_b32 v60, 4, v0
    v_lshl_add_u32 v16, v60, 28, v16
    buffer_store_dwordx4 v[12:15], v16, s[40:43], s58 offen sc1
L_skip_10:
    s_sub_u32 s58, s3, 20
    s_cmp_lt_u32 s58, 4
    s_cselect_b32 s59, s59, 0x7f000000
    v_and_b32 v16, 7, v0
    v_lshlrev_b32 v16, 4, v16
    v_bfe_u32 v60, v0, 3, 1
    v_lshl_add_u32 v16, v60, 13, v16
    v_lshrrev_b32 v60, 4, v0
    v_lshl_add_u32 v16, v60, 28, v16
    buffer_store_dwordx4 v[12:15], v16, s[40:43], s59 offen sc1
    s_mul_i32 s57, s52, 2208
    s_add_u32 s57, s57, s62
    s_mov_b64 exec, 0x3ff
    buffer_store_dwordx4 v[12:15], v10, s[40:43], s57 offen offset:2048
    s_mov_b64 exec, -1
    buffer_store_dwordx4 v[12:15], v10, s[40:43], s57 offen offset:0
    buffer_store_dwordx4 v[12:15], v10, s[40:43], s57 offen offset:1024
    s_mov_b64 exec, -1
    v_lshlrev_b32 v16, 4, v0
    v_add_u32 v16, 159744, v16
    ds_write_b128 v16, v[12:15]
    v_subrev_u32 v16, 8, v0
    v_cmp_gt_u32 vcc, 40, v16
    v_mov_b32 v16, 0x3f803f80
    s_nop 0
    v_cndmask_b32 v18, 0, v16, vcc
    v_min_u32 v16, 55, v0
    v_lshlrev_b32 v16, 2, v16
    v_add_u32 v16, 160992, v16
    ds_write_b32 v16, v18
    v_and_b32 v3, 7, v0
    v_lshlrev_b32 v3, 5, v3
L_skip_7:
    s_cmp_eq_u32 s30, 7
    s_cbranch_scc0 L_skip_11
    v_and_b32 v60, 31, v0
    v_min_u32 v60, 19, v60
    s_mul_i32 s57, s54, 160
    v_lshrrev_b32 v16, 5, v0
    v_lshlrev_b32 v16, 2, v16
    v_add_u32 v16, s57, v16
    v_lshl_add_u32 v16, v60, 3, v16
    global_load_dword v28, v16, s[4:5]
    global_load_dword v4, v16, s[22:23]
L_skip_11:
    s_sub_u32 s58, s30, 4
    s_cmp_lt_u32 s58, 3
    s_cbranch_scc0 L_skip_12
    s_mul_i32 s57, s31, 3
    s_add_u32 s57, s57, s58
    s_lshl_b32 s57, s57, 7
    v_and_b32 v16, 15, v0
    v_lshlrev_b32 v16, 3, v16
    v_lshrrev_b32 v60, 4, v0
    v_lshl_add_u32 v16, v60, 1, v16
    v_add_u32 v16, s57, v16
    global_load_short_d16_hi v4, v16, s[18:19]
L_skip_12:
    v_bfe_u32 v8, v0, 1, 3
    v_lshrrev_b32 v9, 4, v0
    v_xor_b32 v9, v8, v9
    v_bfe_u32 v8, v0, 2, 1
    v_lshlrev_b32 v8, 10, v8
    v_bfe_u32 v60, v0, 3, 1
    v_lshl_add_u32 v8, v60, 9, v8
    v_and_b32 v60, 3, v0
    v_lshl_add_u32 v8, v60, 7, v8
    v_add_u32 v8, s61, v8
    v_lshl_add_u32 v8, v9, 4, v8
    v_xor_b32 v9, 64, v8
    v_bfe_u32 v1, v0, 1, 1
    v_mul_u32_u24 v1, 43690, v1
    v_add_u32 v1, 17476, v1
    s_waitcnt vmcnt(31)
    s_barrier
    ds_read_b128 v[64:67], v8 offset:0
    ds_read_b128 v[68:71], v9 offset:0
    s_cmp_eq_u32 s30, 6
    s_cbranch_scc0 L_skip_13
    s_mov_b32 s57, 256
    s_mov_b32 s58, 195840
    s_mov_b32 m0, 124928
L_dma_14:
    s_waitcnt vmcnt(22)
L_go_15:
    buffer_load_dwordx4 v5, s[32:35], s57 offen offset:0 nt lds
    buffer_load_dwordx4 v6, s[32:35], s58 offen offset:1024 nt lds
    s_add_u32 s57, s57, 24576
    s_add_u32 s58, s58, 24576
    s_add_u32 m0, m0, 2048
    s_cmp_lg_u32 m0, 141312
    s_cbranch_scc1 L_dma_14
L_skip_13:
    s_waitcnt lgkmcnt(0)
    s_cmp_eq_u32 s30, 5
    s_cbranch_scc0 L_skip_16
    s_cmp_eq_u32 s52, 31
    s_cbranch_scc0 L_skip_17
    s_lshl_b32 s57, s31, 5
    v_mov_b32 v16, s57
    s_add_u32 s57, s63, 1
    v_mov_b32 v12, s57
    s_waitcnt vmcnt(5)
    s_mov_b64 exec, 0x1
    global_store_dword v16, v12, s[26:27] sc1
    s_mov_b64 exec, -1
L_skip_17:
L_skip_16:
    s_waitcnt vmcnt(31)
    s_barrier
    ds_read_b128 v[72:75], v8 offset:16384
    ds_read_b128 v[76:79], v9 offset:16384
    s_cmp_eq_u32 s30, 6
    s_cbranch_scc0 L_skip_18
    s_mov_b32 s57, 493568
    s_mov_b32 s58, 492672
    s_mov_b32 s59, 491776
    s_mov_b32 m0, 15360
L_dma_19:
    s_waitcnt vmcnt(22)
L_go_20:
    buffer_load_dwordx4 v2, s[44:47], s57 offen offset:0 nt lds
    buffer_load_dwordx4 v2, s[44:47], s58 offen offset:1024 nt lds
    buffer_load_dwordx4 v2, s[44:47], s59 offen offset:2048 nt lds
    s_add_u32 s57, s57, 98304
    s_add_u32 s58, s58, 98304
    s_add_u32 s59, s59, 98304
    s_add_u32 m0, m0, 3072
    s_cmp_lg_u32 m0, 30720
    s_cbranch_scc1 L_dma_19
    s_mov_b32 s57, 393216
    s_mov_b32 s58, 588800
    s_mov_b32 m0, 141312
L_dma_21:
    s_waitcnt vmcnt(22)
L_go_22:
    buffer_load_dwordx4 v5, s[32:35], s57 offen offset:0 nt lds
    buffer_load_dwordx4 v6, s[32:35], s58 offen offset:1024 nt lds
    s_add_u32 s57, s57, 24576
    s_add_u32 s58, s58, 24576
    s_add_u32 m0, m0, 2048
    s_cmp_lg_u32 m0, 157696
    s_cbranch_scc1 L_dma_21
L_skip_18:
    s_waitcnt lgkmcnt(0)
    s_cmp_lt_u32 s30, 4
    s_cbranch_scc0 L_skip_23
    s_mov_b64 exec, 0
    s_cmp_eq_u32 s30, 1
    s_cbranch_scc1 L_pad1
    s_cmp_eq_u32 s30, 2
    s_cbranch_scc1 L_pad2
    s_cmp_eq_u32 s30, 3
    s_cbranch_scc1 L_pad3
    s_branch L_pad0
L_padback:
    s_mov_b64 exec, -1
L_skip_23:
    s_waitcnt vmcnt(31)
    s_barrier
    ds_read_b128 v[80:83], v8 offset:32768
    ds_read_b128 v[84:87], v9 offset:32768
    s_cmp_eq_u32 s30, 6
    s_cbranch_scc0 L_skip_24
    s_cmp_lg_u32 s53, 3
    s_cbranch_scc0 L_wb_25
    s_mul_i32 s57, s31, 983040
    s_lshl_b32 s58, s3, 6
    s_add_u32 s57, s57, s58
    v_bfe_u32 v38, v0, 4, 1
    v_lshlrev_b32 v38, 1, v38
    v_xor_b32 v38, v38, v0
    v_and_b32 v38, 3, v38
    v_lshrrev_b32 v3, 5, v0
    v_mul_u32_u24 v3, 10240, v3
    v_bfe_u32 v39, v0, 4, 1
    v_mul_u32_u24 v39, 2560, v39
    v_add_u32 v3, v39, v3
    v_bfe_u32 v39, v0, 3, 1
    v_mul_u32_u24 v39, 5120, v39
    v_add_u32 v3, v39, v3
    v_bfe_u32 v39, v0, 2, 1
    v_mul_u32_u24 v39, 20480, v39
    v_add_u32 v3, v39, v3
    v_add_u32 v3, s57, v3
    v_lshl_add_u32 v3, v38, 4, v3
    s_mov_b32 s14, 40960
    s_mov_b32 s15, 256
    s_branch L_we_26
L_wb_25:
    s_mul_i32 s57, s31, 384
    s_mul_i32 s58, s54, 245760
    s_add_u32 s57, s57, s58
    v_lshlrev_b32 v3, 4, v0
    v_add_u32 v3, s57, v3
    v_mov_b32 v38, 2688
    v_cmp_lt_u32 vcc, 23, v0
    s_nop 1
    v_cndmask_b32 v38, 0, v38, vcc
    v_add_u32 v3, v38, v3
    v_mov_b32 v38, 0x7f000000
    v_cmp_lt_u32 vcc, 47, v0
    s_nop 1
    v_cndmask_b32 v3, v3, v38, vcc
    s_mov_b32 s14, 12288
    s_mov_b32 s15, 5120
L_we_26:
    s_mul_i32 s57, s14, 0
    s_mov_b32 m0, 30720
    s_nop 0
    buffer_load_dwordx4 v3, s[48:51], s57 offen offset:0 nt lds
    s_mul_i32 s57, s14, 0
    s_add_u32 s57, s57, s15
    s_mov_b32 m0, 30720
    s_nop 0
    buffer_load_dwordx4 v3, s[48:51], s57 offen offset:1024 nt lds
    s_mov_b32 s57, 393344
    s_mov_b32 s58, 588928
    s_mov_b32 m0, 92160
L_dma_27:
    s_waitcnt vmcnt(22)
L_go_28:
    buffer_load_dwordx4 v5, s[32:35], s57 offen offset:0 nt lds
    buffer_load_dwordx4 v6, s[32:35], s58 offen offset:1024 nt lds
    s_add_u32 s57, s57, 24576
    s_add_u32 s58, s58, 24576
    s_add_u32 m0, m0, 2048
    s_cmp_lg_u32 m0, 108544
    s_cbranch_scc1 L_dma_27
    s_mul_i32 s57, s14, 1
    s_mov_b32 m0, 32768
    s_nop 0
    buffer_load_dwordx4 v3, s[48:51], s57 offen offset:0 nt lds
    s_mul_i32 s57, s14, 1
    s_add_u32 s57, s57, s15
    s_mov_b32 m0, 32768
    s_nop 0
    buffer_load_dwordx4 v3, s[48:51], s57 offen offset:1024 nt lds
    s_mov_b32 s57, 393472
    s_mov_b32 s58, 589056
    s_mov_b32 m0, 108544
L_dma_29:
    s_waitcnt vmcnt(22)
L_go_30:
    buffer_load_dwordx4 v5, s[32:35], s57 offen offset:0 nt lds
    buffer_load_dwordx4 v6, s[32:35], s58 offen offset:1024 nt lds
    s_add_u32 s57, s57, 24576
    s_add_u32 s58, s58, 24576
    s_add_u32 m0, m0, 2048
    s_cmp_lg_u32 m0, 124928
    s_cbranch_scc1 L_dma_29
L_skip_24:
    s_waitcnt lgkmcnt(0)
    s_cmp_lt_u32 s30, 5
    s_cbranch_scc0 L_skip_31
    s_waitcnt vmcnt(0)
L_skip_31:
    s_cmp_eq_u32 s30, 7
    s_cbranch_scc0 L_skip_32
    v_and_b32 v60, 31, v0
    v_cmp_gt_u32 s[64:65], 20, v60
    v_min_u32 v60, 19, v60
    v_lshrrev_b32 v35, 5, v0
    v_lshlrev_b32 v35, 2, v35
    v_add_u32 v35, 160832, v35
    v_lshl_add_u32 v35, v60, 3, v35
    s_mul_i32 s66, s53, 12416
    s_add_u32 s66, s66, s62
    s_add_u32 s66, s66, 70656
    s_add_u32 s67, s66, 12288
    s_lshl_b32 s57, s54, 3
    v_lshrrev_b32 v34, 5, v0
    v_lshlrev_b32 v34, 2, v34
    v_add_u32 v34, s57, v34
    v_and_b32 v60, 31, v0
    v_mov_b32 v61, 0x7f000000
    v_cmp_ne_u32 vcc, 31, v60
    s_nop 1
    v_cndmask_b32 v34, v34, v61, vcc
    v_mov_b32 v61, 0x3f803f80
    s_waitcnt vmcnt(0)
    ds_write_b32 v35, v28
    s_waitcnt lgkmcnt(0)
L_skip_32:
    s_cmp_eq_u32 s30, 5
    s_cbranch_scc0 L_skip_33
    s_waitcnt vmcnt(0)
    s_lshr_b32 s65, s63, 2
    s_sub_u32 s58, s3, 20
    s_cmp_lt_u32 s58, 4
    s_cbranch_scc0 L_skip_34
    s_mov_b32 s67, 0
    s_load_dword s66, s[10:11], 0
    s_load_dword s67, s[10:11], 8192
    s_waitcnt lgkmcnt(1)
    s_sleep 1
    s_mov_b32 s65, s67
L_skip_34:
L_skip_33:
    s_waitcnt vmcnt(36)
    s_barrier
    ds_read_b128 v[88:91], v8 offset:49152
    ds_read_b128 v[92:95], v9 offset:49152
    s_cmp_eq_u32 s30, 6
    s_cbranch_scc0 L_skip_35
    s_mul_i32 s57, s14, 2
    s_mov_b32 m0, 34816
    s_nop 0
    buffer_load_dwordx4 v3, s[48:51], s57 offen offset:0 nt lds
    s_mul_i32 s57, s14, 2
    s_add_u32 s57, s57, s15
    s_mov_b32 m0, 34816
    s_nop 0
    buffer_load_dwordx4 v3, s[48:51], s57 offen offset:1024 nt lds
    s_mov_b32 s57, 786432
    s_mov_b32 s58, 982016
    s_mov_b32 m0, 124928
L_dma_36:
    s_waitcnt vmcnt(22)
L_go_37:
    buffer_load_dwordx4 v5, s[32:35], s57 offen offset:0 nt lds
    buffer_load_dwordx4 v6, s[32:35], s58 offen offset:1024 nt lds
    s_add_u32 s57, s57, 24576
    s_add_u32 s58, s58, 24576
    s_add_u32 m0, m0, 2048
    s_cmp_lg_u32 m0, 141312
    s_cbranch_scc1 L_dma_36
L_skip_35:
    s_waitcnt lgkmcnt(0)
    s_cmp_eq_u32 s30, 7
    s_cbranch_scc0 L_skip_38
    v_cndmask_b32 v29, 0, v28, s[64:65]
    v_dot2_f32_bf16 v33, v29, v61, 0
    v_dot2_f32_bf16 v32, v29, v29, 0
    v_lshlrev_b32 v2, 16, v28
    v_and_b32 v3, 0xffff0000, v28
    s_cmp_eq_u32 s55, 0
    v_permlane32_swap_b32 v33, v32
    v_add_f32 v33, v33, v32
    s_nop 1
    v_add_f32_dpp v33, v33, v33 row_ror:8 row_mask:0xf bank_mask:0xf
    s_nop 1
    v_add_f32_dpp v33, v33, v33 row_ror:4 row_mask:0xf bank_mask:0xf
    s_nop 1
    v_add_f32_dpp v33, v33, v33 row_ror:2 row_mask:0xf bank_mask:0xf
    s_nop 1
    v_add_f32_dpp v33, v33, v33 row_ror:1 row_mask:0xf bank_mask:0xf
    s_nop 1
    v_add_f32_dpp v33, v33, v33 row_bcast:15 row_mask:0xa bank_mask:0xf
    v_min_u32 v33, -2, v33
    s_cbranch_scc1 L_gs_39
    buffer_store_dword v33, v34, s[40:43], s67 offen
L_gb_40:
    s_waitcnt vmcnt(1)
L_skip_38:
    s_cmp_lt_u32 s30, 6
    s_cbranch_scc0 L_skip_41
    s_lshr_b32 s57, s30, 1
    s_mul_i32 s57, s57, 1024
    s_and_b32 s58, s30, 1
    s_lshl_b32 s58, s58, 6
    s_add_u32 s57, s57, s58
    v_lshrrev_b32 v18, 5, v0
    v_mul_u32_u24 v18, 6144, v18
    v_bfe_u32 v60, v0, 3, 1
    v_mul_u32_u24 v60, 3072, v60
    v_add_u32 v18, v60, v18
    v_bfe_u32 v60, v0, 4, 1
    v_lshl_add_u32 v18, v60, 9, v18
    v_bfe_u32 v60, v0, 2, 1
    v_lshl_add_u32 v18, v60, 7, v18
    v_and_b32 v60, 3, v0
    v_lshl_add_u32 v18, v60, 3, v18
    v_add_u32 v18, s57, v18
    v_bfe_u32 v19, v0, 4, 1
    v_mul_u32_u24 v19, 3072, v19
    v_bfe_u32 v60, v0, 3, 1
    v_lshl_add_u32 v19, v60, 9, v19
    v_bfe_u32 v60, v0, 2, 1
    v_lshl_add_u32 v19, v60, 7, v19
    v_and_b32 v60, 3, v0
    v_lshl_add_u32 v19, v60, 3, v19
    v_add_u32 v19, s57, v19
    v_add_u32 v19, 24576, v19
    ds_read_b64_tr_b16 v[28:29], v18 offset:0
    ds_read_b64_tr_b16 v[30:31], v18 offset:256
    ds_read_b64_tr_b16 v[32:33], v18 offset:12288
    ds_read_b64_tr_b16 v[34:35], v18 offset:12544
    ds_read_b64_tr_b16 v[36:37], v19 offset:0
    ds_read_b64_tr_b16 v[38:39], v19 offset:256
    ds_read_b64_tr_b16 v[40:41], v18 offset:32
    ds_read_b64_tr_b16 v[42:43], v18 offset:288
    ds_read_b64_tr_b16 v[44:45], v18 offset:12320
    ds_read_b64_tr_b16 v[46:47], v18 offset:12576
    ds_read_b64_tr_b16 v[48:49], v19 offset:32
    ds_read_b64_tr_b16 v[50:51], v19 offset:288
    v_lshrrev_b32 v52, 4, v0
    v_lshlrev_b32 v52, 5, v52
    v_bfe_u32 v60, v0, 1, 1
    v_lshl_add_u32 v52, v60, 4, v52
    v_and_b32 v60, 1, v0
    v_mul_u32_u24 v60, 192, v60
    v_add_u32 v52, v60, v52
    v_add_u32 v52, 160832, v52
    v_lshrrev_b32 v53, 4, v0
    v_lshlrev_b32 v53, 4, v53
    v_bfe_u32 v60, v0, 1, 1
    v_lshl_add_u32 v53, v60, 3, v53
    v_and_b32 v60, 1, v0
    v_mul_u32_u24 v60, 192, v60
    v_add_u32 v53, v60, v53
    v_add_u32 v53, 160960, v53
    v_mov_b64 v[20:21], 0
    v_mov_b64 v[22:23], 0
    v_mov_b64 v[24:25], 0
    v_mov_b64 v[26:27], 0
    s_lshr_b32 s57, s30, 1
    s_lshl_b32 s57, s57, 11
    s_lshl_b32 s58, s58, 1
    s_add_u32 s57, s57, s58
    s_lshl_b32 s58, s54, 8
    s_add_u32 s57, s57, s58
    v_and_b32 v54, 31, v0
    v_lshlrev_b32 v54, 2, v54
    v_lshrrev_b32 v60, 5, v0
    v_mul_u32_u24 v60, 6144, v60
    v_add_u32 v54, v60, v54
    v_add_u32 v54, s57, v54
    s_mul_i32 s59, s53, 12416
    s_add_u32 s59, s59, s62
    s_add_u32 s59, s59, 70656
    s_add_u32 s60, s59, 12288
    ds_read_b128 v[12:15], v52
    ds_read_b64 v[16:17], v53
    s_waitcnt lgkmcnt(1)
    v_smfmac_f32_16x16x64_bf16 v[20:23], v[12:15], v[28:35], v1
    v_smfmac_f32_16x16x64_bf16 v[24:27], v[12:15], v[40:47], v1
    s_waitcnt lgkmcnt(0)
    v_smfmac_f32_16x16x32_bf16 v[20:23], v[16:17], v[36:39], v1
    v_smfmac_f32_16x16x32_bf16 v[24:27], v[16:17], v[48:51], v1
    s_cmp_eq_u32 s55, 0
    s_nop 5
    v_add_f32 v12, v20, v22
    s_nop 1
    v_add_f32_dpp v12, v24, v26 quad_perm:[0,1,2,3] row_mask:0x2 bank_mask:0xf
    s_nop 1
    v_add_f32_dpp v12, v21, v23 quad_perm:[0,1,2,3] row_mask:0x4 bank_mask:0xf
    s_nop 1
    v_add_f32_dpp v12, v25, v27 quad_perm:[0,1,2,3] row_mask:0x8 bank_mask:0xf
    v_min_u32 v12, -2, v12
    s_cbranch_scc1 L_gs_42
    buffer_store_dword v12, v54, s[40:43], s59 offen
L_gb_43:
L_skip_41:
    s_cmp_eq_u32 s30, 5
    s_cbranch_scc0 L_skip_44
    global_load_dword v2, v3, s[26:27] sc1
L_skip_44:
    s_waitcnt vmcnt(36)
    s_barrier
    ds_read_b128 v[96:99], v8 offset:0
    ds_read_b128 v[100:103], v9 offset:0
    s_cmp_eq_u32 s30, 6
    s_cbranch_scc0 L_skip_45
    s_mul_i32 s57, s14, 3
    s_mov_b32 m0, 36864
    s_nop 0
    buffer_load_dwordx4 v3, s[48:51], s57 offen offset:0 nt lds
    s_mul_i32 s57, s14, 3
    s_add_u32 s57, s57, s15
    s_mov_b32 m0, 36864
    s_nop 0
    buffer_load_dwordx4 v3, s[48:51], s57 offen offset:1024 nt lds
    s_mov_b32 s57, 786560
    s_mov_b32 s58, 982144
    s_mov_b32 m0, 141312
L_dma_46:
    s_waitcnt vmcnt(22)
L_go_47:
    buffer_load_dwordx4 v5, s[32:35], s57 offen offset:0 nt lds
    buffer_load_dwordx4 v6, s[32:35], s58 offen offset:1024 nt lds
    s_add_u32 s57, s57, 24576
    s_add_u32 s58, s58, 24576
    s_add_u32 m0, m0, 2048
    s_cmp_lg_u32 m0, 157696
    s_cbranch_scc1 L_dma_46
L_skip_45:
    s_waitcnt lgkmcnt(0)
    s_waitcnt vmcnt(36)
    s_barrier
    ds_read_b128 v[104:107], v8 offset:16384
    ds_read_b128 v[108:111], v9 offset:16384
    s_cmp_eq_u32 s30, 6
    s_cbranch_scc0 L_skip_48
    s_mul_i32 s57, s14, 4
    s_mov_b32 m0, 38912
    s_nop 0
    buffer_load_dwordx4 v3, s[48:51], s57 offen offset:0 nt lds
    s_mul_i32 s57, s14, 4
    s_add_u32 s57, s57, s15
    s_mov_b32 m0, 38912
    s_nop 0
    buffer_load_dwordx4 v3, s[48:51], s57 offen offset:1024 nt lds
    s_mov_b32 s57, 786688
    s_mov_b32 s58, 982272
    s_mov_b32 m0, 92160
L_dma_49:
    s_waitcnt vmcnt(22)
L_go_50:
    buffer_load_dwordx4 v5, s[32:35], s57 offen offset:0 nt lds
    buffer_load_dwordx4 v6, s[32:35], s58 offen offset:1024 nt lds
    s_add_u32 s57, s57, 24576
    s_add_u32 s58, s58, 24576
    s_add_u32 m0, m0, 2048
    s_cmp_lg_u32 m0, 108544
    s_cbranch_scc1 L_dma_49
L_skip_48:
    s_waitcnt lgkmcnt(0)
    s_cmp_lg_u32 s30, 6
    s_cbranch_scc0 L_skip_51
    s_waitcnt vmcnt(0)
L_skip_51:
    s_waitcnt vmcnt(36)
    s_barrier
    ds_read_b128 v[112:115], v8 offset:32768
    ds_read_b128 v[116:119], v9 offset:32768
    s_cmp_eq_u32 s30, 6
    s_cbranch_scc0 L_skip_52
    s_mul_i32 s57, s14, 5
    s_mov_b32 m0, 40960
    s_nop 0
    buffer_load_dwordx4 v3, s[48:51], s57 offen offset:0 nt lds
    s_mul_i32 s57, s14, 5
    s_add_u32 s57, s57, s15
    s_mov_b32 m0, 40960
    s_nop 0
    buffer_load_dwordx4 v3, s[48:51], s57 offen offset:1024 nt lds
    s_mov_b32 s57, 1179648
    s_mov_b32 s58, 1375232
    s_mov_b32 m0, 108544
L_dma_53:
    s_waitcnt vmcnt(22)
L_go_54:
    buffer_load_dwordx4 v5, s[32:35], s57 offen offset:0 nt lds
    buffer_load_dwordx4 v6, s[32:35], s58 offen offset:1024 nt lds
    s_add_u32 s57, s57, 24576
    s_add_u32 s58, s58, 24576
    s_add_u32 m0, m0, 2048
    s_cmp_lg_u32 m0, 124928
    s_cbranch_scc1 L_dma_53
L_skip_52:
    s_waitcnt lgkmcnt(0)
    s_cmp_eq_u32 s30, 5
    s_cbranch_scc0 L_skip_55
L_cw_56:
    v_readlane_b32 s57, v2, s31
    s_cmp_eq_u32 s57, 0
    s_cbranch_scc1 L_cr_57
    s_lshr_b32 s58, s63, 2
    s_xor_b32 s58, s58, s65
    s_and_b32 s58, s58, 1
    v_mov_b32 v25, s58
    s_sub_u32 s57, s57, 1
    s_cmp_eq_u32 s57, s63
    s_cselect_b32 s64, 1, 0
    s_cbranch_scc0 L_far_58
    s_lshl_b32 s57, s52, 2
    s_add_u32 s57, s57, s72
    s_mov_b64 exec, 1
    buffer_store_dword v25, v0, s[40:43], s57 offen offset:0
    s_mov_b64 exec, -1
L_fb_59:
L_skip_55:
    s_waitcnt vmcnt(36)
    s_barrier
    ds_read_b128 v[120:123], v8 offset:49152
    ds_read_b128 v[124:127], v9 offset:49152
    s_cmp_eq_u32 s30, 6
    s_cbranch_scc0 L_skip_60
    s_mul_i32 s57, s14, 6
    s_mov_b32 m0, 43008
    s_nop 0
    buffer_load_dwordx4 v3, s[48:51], s57 offen offset:0 nt lds
    s_mul_i32 s57, s14, 6
    s_add_u32 s57, s57, s15
    s_mov_b32 m0, 43008
    s_nop 0
    buffer_load_dwordx4 v3, s[48:51], s57 offen offset:1024 nt lds
    s_mov_b32 s57, 1179776
    s_mov_b32 s58, 1375360
    s_mov_b32 m0, 124928
L_dma_61:
    s_waitcnt vmcnt(22)
L_go_62:
    buffer_load_dwordx4 v5, s[32:35], s57 offen offset:0 nt lds
    buffer_load_dwordx4 v6, s[32:35], s58 offen offset:1024 nt lds
    s_add_u32 s57, s57, 24576
    s_add_u32 s58, s58, 24576
    s_add_u32 m0, m0, 2048
    s_cmp_lg_u32 m0, 141312
    s_cbranch_scc1 L_dma_61
L_skip_60:
    s_waitcnt lgkmcnt(0)
    s_waitcnt vmcnt(36)
    s_barrier
    ds_read_b128 v[128:131], v8 offset:0
    ds_read_b128 v[132:135], v9 offset:0
    s_cmp_eq_u32 s30, 6
    s_cbranch_scc0 L_skip_63
    s_mul_i32 s57, s14, 7
    s_mov_b32 m0, 45056
    s_nop 0
    buffer_load_dwordx4 v3, s[48:51], s57 offen offset:0 nt lds
    s_mul_i32 s57, s14, 7
    s_add_u32 s57, s57, s15
    s_mov_b32 m0, 45056
    s_nop 0
    buffer_load_dwordx4 v3, s[48:51], s57 offen offset:1024 nt lds
    s_mov_b32 s57, 1179904
    s_mov_b32 s58, 1375488
    s_mov_b32 m0, 141312
L_dma_64:
    s_waitcnt vmcnt(22)
L_go_65:
    buffer_load_dwordx4 v5, s[32:35], s57 offen offset:0 nt lds
    buffer_load_dwordx4 v6, s[32:35], s58 offen offset:1024 nt lds
    s_add_u32 s57, s57, 24576
    s_add_u32 s58, s58, 24576
    s_add_u32 m0, m0, 2048
    s_cmp_lg_u32 m0, 157696
    s_cbranch_scc1 L_dma_64
L_skip_63:
    s_waitcnt lgkmcnt(0)
    s_cmp_eq_u32 s30, 5
    s_cbranch_scc0 L_skip_66
    v_lshlrev_b32 v24, 2, v0
    buffer_load_dword v2, v24, s[40:43], s72 offen sc1
L_skip_66:
    s_waitcnt vmcnt(36)
    s_barrier
    ds_read_b128 v[136:139], v8 offset:16384
    ds_read_b128 v[140:143], v9 offset:16384
    s_cmp_eq_u32 s30, 6
    s_cbranch_scc0 L_skip_67
    s_mul_i32 s57, s14, 8
    s_mov_b32 m0, 47104
    s_nop 0
    buffer_load_dwordx4 v3, s[48:51], s57 offen offset:0 nt lds
    s_mul_i32 s57, s14, 8
    s_add_u32 s57, s57, s15
    s_mov_b32 m0, 47104
    s_nop 0
    buffer_load_dwordx4 v3, s[48:51], s57 offen offset:1024 nt lds
    s_mov_b32 s57, 0
    s_mov_b32 s58, 392192
    s_mov_b32 m0, 92160
L_dma_68:
    s_waitcnt vmcnt(22)
L_go_69:
    buffer_load_dwordx4 v7, s[36:39], s57 offen offset:0 nt lds
    buffer_load_dwordx4 v7, s[36:39], s58 offen offset:1024 nt lds
    s_add_u32 s57, s57, 24576
    s_add_u32 s58, s58, 24576
    s_add_u32 m0, m0, 2048
    s_cmp_lg_u32 m0, 108544
    s_cbranch_scc1 L_dma_68
L_skip_67:
    s_waitcnt lgkmcnt(0)
    s_waitcnt vmcnt(36)
    s_barrier
    ds_read_b128 v[144:147], v8 offset:32768
    ds_read_b128 v[148:151], v9 offset:32768
    s_cmp_eq_u32 s30, 6
    s_cbranch_scc0 L_skip_70
    s_mul_i32 s57, s14, 9
    s_mov_b32 m0, 49152
    s_nop 0
    buffer_load_dwordx4 v3, s[48:51], s57 offen offset:0 nt lds
    s_mul_i32 s57, s14, 9
    s_add_u32 s57, s57, s15
    s_mov_b32 m0, 49152
    s_nop 0
    buffer_load_dwordx4 v3, s[48:51], s57 offen offset:1024 nt lds
    s_mov_b32 s57, 128
    s_mov_b32 s58, 392320
    s_mov_b32 m0, 108544
L_dma_71:
    s_waitcnt vmcnt(22)
L_go_72:
    buffer_load_dwordx4 v7, s[36:39], s57 offen offset:0 nt lds
    buffer_load_dwordx4 v7, s[36:39], s58 offen offset:1024 nt lds
    s_add_u32 s57, s57, 24576
    s_add_u32 s58, s58, 24576
    s_add_u32 m0, m0, 2048
    s_cmp_lg_u32 m0, 124928
    s_cbranch_scc1 L_dma_71
L_skip_70:
    s_waitcnt lgkmcnt(0)
    s_cmp_eq_u32 s30, 5
    s_cbranch_scc0 L_skip_73
L_cw_74:
    s_waitcnt vmcnt(0)
    v_cmp_ne_u32 vcc, -1, v2
    s_mov_b32 s57, 0
    s_mov_b32 s68, 2
    s_cmp_eq_u32 s64, 0
    s_cbranch_scc1 L_cd_76
    s_cmp_lg_u32 vcc_hi, 0
    s_cbranch_scc1 L_cd_76
    s_cmp_lg_u32 vcc_lo, -1
    s_cbranch_scc1 L_cr_75
    v_cmp_eq_u32 vcc, 1, v2
    s_bcnt1_i32_b32 s68, vcc_lo
    s_mov_b32 s57, 1
L_cd_76:
    v_mov_b32 v37, 160768
    v_mov_b32 v38, s57
    ds_write_b32 v37, v38
    s_waitcnt lgkmcnt(0)
L_skip_73:
    s_waitcnt vmcnt(36)
    s_barrier
    ds_read_b128 v[152:155], v8 offset:49152
    ds_read_b128 v[156:159], v9 offset:49152
    s_cmp_eq_u32 s30, 6
    s_cbranch_scc0 L_skip_77
    s_mul_i32 s57, s14, 10
    s_mov_b32 m0, 51200
    s_nop 0
    buffer_load_dwordx4 v3, s[48:51], s57 offen offset:0 nt lds
    s_mul_i32 s57, s14, 10
    s_add_u32 s57, s57, s15
    s_mov_b32 m0, 51200
    s_nop 0
    buffer_load_dwordx4 v3, s[48:51], s57 offen offset:1024 nt lds
    s_mov_b32 s57, 256
    s_mov_b32 s58, 392448
    s_mov_b32 m0, 124928
L_dma_78:
    s_waitcnt vmcnt(22)
L_go_79:
    buffer_load_dwordx4 v7, s[36:39], s57 offen offset:0 nt lds
    buffer_load_dwordx4 v7, s[36:39], s58 offen offset:1024 nt lds
    s_add_u32 s57, s57, 24576
    s_add_u32 s58, s58, 24576
    s_add_u32 m0, m0, 2048
    s_cmp_lg_u32 m0, 141312
    s_cbranch_scc1 L_dma_78
L_skip_77:
    s_waitcnt lgkmcnt(0)
    v_lshrrev_b32 v8, 2, v0
    v_lshlrev_b32 v8, 7, v8
    v_bfe_u32 v60, v0, 3, 2
    v_lshl_add_u32 v8, v60, 5, v8
    v_and_b32 v60, 3, v0
    v_lshl_add_u32 v8, v60, 3, v8
    v_add_u32 v8, s61, v8
    v_xor_b32 v9, 32, v8
    v_xor_b32 v10, 64, v8
    v_xor_b32 v11, 96, v8
    v_mov_b32 v41, 160768
    ds_read_b32 v42, v41
    s_waitcnt lgkmcnt(0)
    v_readfirstlane_b32 s55, v42
    s_cmp_eq_u32 s55, 0
    s_cbranch_scc1 L_spread
L_spread_back:
    s_cmp_eq_u32 s30, 5
    s_cbranch_scc0 L_skip_91
    s_cmp_eq_u32 s52, 31
    s_cbranch_scc0 L_skip_92
    s_lshl_b32 s57, s31, 5
    v_mov_b32 v16, s57
    s_add_u32 s57, s68, 1
    v_mov_b32 v12, s57
    s_mov_b64 exec, 0x1
    global_store_dword v16, v12, s[26:27] offset:4 sc1
    s_mov_b64 exec, -1
L_skip_92:
L_skip_91:
    s_sub_u32 s58, s30, 1
    s_cmp_lt_u32 s58, 3
    s_cbranch_scc0 L_skip_93
    s_mul_i32 s59, s53, 12416
    s_add_u32 s59, s59, s62
    s_add_u32 s59, s59, 70656
    s_add_u32 s60, s59, 12288
    s_lshl_b32 s57, s58, 11
    v_lshlrev_b32 v48, 4, v0
    v_add_u32 v48, s57, v48
    v_and_b32 v49, 7, v0
    v_lshlrev_b32 v49, 3, v49
    s_add_u32 s57, s59, 6144
    buffer_load_dwordx4 v[12:15], v48, s[40:43], s59 offen offset:0 sc1 nt
    buffer_load_dwordx4 v[16:19], v48, s[40:43], s59 offen offset:1024 sc1 nt
    buffer_load_dwordx4 v[28:31], v48, s[40:43], s57 offen offset:0 sc1 nt
    buffer_load_dwordx4 v[32:35], v48, s[40:43], s57 offen offset:1024 sc1 nt
    buffer_load_dwordx2 v[24:25], v49, s[40:43], s60 offen sc1 nt
L_skip_93:
    s_waitcnt vmcnt(36)
    s_barrier
    ds_read_b64_tr_b16 v[160:161], v8 offset:0
    ds_read_b64_tr_b16 v[168:169], v9 offset:0
    ds_read_b64_tr_b16 v[176:177], v10 offset:0
    ds_read_b64_tr_b16 v[184:185], v11 offset:0
    s_cmp_eq_u32 s30, 6
    s_cbranch_scc0 L_skip_94
    s_mul_i32 s57, s14, 11
    s_mov_b32 m0, 53248
    s_nop 0
    buffer_load_dwordx4 v3, s[48:51], s57 offen offset:0 nt lds
    s_mul_i32 s57, s14, 11
    s_add_u32 s57, s57, s15
    s_mov_b32 m0, 53248
    s_nop 0
    buffer_load_dwordx4 v3, s[48:51], s57 offen offset:1024 nt lds
    s_mov_b32 s57, 196608
    s_mov_b32 s58, 588800
    s_mov_b32 m0, 141312
L_dma_95:
    s_waitcnt vmcnt(22)
L_go_96:
    buffer_load_dwordx4 v7, s[36:39], s57 offen offset:0 nt lds
    buffer_load_dwordx4 v7, s[36:39], s58 offen offset:1024 nt lds
    s_add_u32 s57, s57, 24576
    s_add_u32 s58, s58, 24576
    s_add_u32 m0, m0, 2048
    s_cmp_lg_u32 m0, 157696
    s_cbranch_scc1 L_dma_95
L_skip_94:
    s_waitcnt lgkmcnt(0)
    s_waitcnt vmcnt(36)
    s_barrier
    ds_read_b64_tr_b16 v[192:193], v8 offset:16384
    ds_read_b64_tr_b16 v[200:201], v9 offset:16384
    ds_read_b64_tr_b16 v[208:209], v10 offset:16384
    ds_read_b64_tr_b16 v[216:217], v11 offset:16384
    s_cmp_eq_u32 s30, 6
    s_cbranch_scc0 L_skip_97
    s_mov_b32 s57, 196736
    s_mov_b32 s58, 588928
    s_mov_b32 m0, 92160
L_dma_98:
    s_waitcnt vmcnt(22)
L_go_99:
    buffer_load_dwordx4 v7, s[36:39], s57 offen offset:0 nt lds
    buffer_load_dwordx4 v7, s[36:39], s58 offen offset:1024 nt lds
    s_add_u32 s57, s57, 24576
    s_add_u32 s58, s58, 24576
    s_add_u32 m0, m0, 2048
    s_cmp_lg_u32 m0, 108544
    s_cbranch_scc1 L_dma_98
L_skip_97:
    s_waitcnt lgkmcnt(0)
    s_sub_u32 s58, s30, 1
    s_cmp_lt_u32 s58, 3
    s_cbranch_scc0 L_skip_100
    s_lshl_b32 s57, s58, 7
    v_bfe_u32 v51, v0, 2, 2
    v_lshlrev_b32 v51, 5, v51
    v_lshrrev_b32 v60, 5, v0
    v_lshl_add_u32 v51, v60, 4, v51
    v_and_b32 v60, 3, v0
    v_lshl_add_u32 v51, v60, 2, v51
    v_bfe_u32 v60, v0, 4, 1
    v_lshl_add_u32 v51, v60, 1, v51
    v_add_u32 v51, s57, v51
    v_add_u32 v51, 157696, v51
    v_mov_b32 v60, 0x3c75e03e
    v_mov_b32 v61, 0x3a71d1e6
    v_mov_b32 v47, 0x3e13985d
    s_waitcnt vmcnt(0)
    v_pk_add_f32 v[36:37], v[28:29], v[32:33]
    v_pk_add_f32 v[38:39], v[30:31], v[34:35]
    s_nop 1
    v_permlane32_swap_b32 v36, v38
    v_permlane32_swap_b32 v37, v39
    v_pk_add_f32 v[36:37], v[36:37], v[38:39]
    s_nop 1
    v_permlane16_swap_b32 v36, v37
    v_add_f32 v36, v36, v37
    v_mul_f32 v6, 0x3dd53b95, v36
    v_add_f32_dpp v48, v24, v24 row_ror:4 row_mask:0xf bank_mask:0xf
    v_add_f32_dpp v49, v25, v25 row_ror:4 row_mask:0xf bank_mask:0xf
    v_pk_add_f32 v[20:21], v[12:13], v[16:17]
    v_pk_add_f32 v[22:23], v[14:15], v[18:19]
    v_add_f32_dpp v48, v48, v48 row_ror:2 row_mask:0xf bank_mask:0xf
    v_add_f32_dpp v49, v49, v49 row_ror:2 row_mask:0xf bank_mask:0xf
    v_permlane32_swap_b32 v20, v22
    v_permlane32_swap_b32 v21, v23
    v_add_f32_dpp v48, v48, v48 row_ror:1 row_mask:0xf bank_mask:0xf
    v_add_f32_dpp v49, v49, v49 row_ror:1 row_mask:0xf bank_mask:0xf
    v_pk_add_f32 v[20:21], v[20:21], v[22:23]
    v_mul_f32 v48, v48, v60
    v_fma_f32 v49, v49, v47, v61
    v_permlane16_swap_b32 v20, v21
    v_fma_f32 v49, -v48, v48, v49
    v_add_f32 v20, v20, v21
    v_max_f32 v49, v49, v61
    v_mul_f32 v50, v6, v48
    v_rsq_f32 v49, v49
    v_cmp_u_f32 vcc, v20, v20
    v_sub_f32 v20, v20, v50
    v_mul_f32 v20, v20, v49
    v_cvt_pk_bf16_f32 v20, v20, v20
    ds_write_b16 v51, v20
    s_waitcnt lgkmcnt(0)
L_skip_100:
    s_lshl_b32 s57, s30, 7
    s_add_u32 s57, s57, 158720
    v_lshrrev_b32 v58, 4, v0
    v_lshlrev_b32 v58, 5, v58
    v_bfe_u32 v60, v0, 1, 1
    v_lshl_add_u32 v58, v60, 4, v58
    v_bfe_u32 v60, v0, 2, 2
    v_lshl_add_u32 v58, v60, 2, v58
    v_and_b32 v60, 1, v0
    v_lshl_add_u32 v58, v60, 1, v58
    v_add_u32 v58, s57, v58
    v_lshrrev_b32 v61, 4, v0
    v_lshlrev_b32 v61, 5, v61
    v_bfe_u32 v60, v0, 1, 1
    v_lshl_add_u32 v61, v60, 4, v61
    v_add_u32 v61, s57, v61
    v_bfe_u32 v62, v0, 2, 2
    v_lshlrev_b32 v62, 1, v62
    v_and_b32 v60, 1, v0
    v_lshl_add_u32 v62, v60, 0, v62
    v_mov_b32 v60, 160992
    v_cmp_eq_u32 vcc, 0, v62
    s_nop 1
    v_cndmask_b32 v52, v60, v61, vcc
    v_cmp_eq_u32 vcc, 1, v62
    s_nop 1
    v_cndmask_b32 v53, v60, v61, vcc
    v_cmp_eq_u32 vcc, 2, v62
    s_nop 1
    v_cndmask_b32 v54, v60, v61, vcc
    v_cmp_eq_u32 vcc, 3, v62
    s_nop 1
    v_cndmask_b32 v55, v60, v61, vcc
    v_cmp_eq_u32 vcc, 4, v62
    s_nop 1
    v_cndmask_b32 v56, v60, v61, vcc
    v_cmp_eq_u32 vcc, 5, v62
    s_nop 1
    v_cndmask_b32 v57, v60, v61, vcc
    s_lshl_b32 s58, s30, 2
    s_add_u32 s58, s58, 159744
    v_mov_b32 v60, s58
    v_lshlrev_b32 v59, 2, v0
    v_add_u32 v59, 158208, v59
    v_cmp_eq_u32 vcc, 63, v0
    s_nop 1
    v_cndmask_b32 v59, v59, v60, vcc
    v_and_b32 v62, 7, v0
    v_lshlrev_b32 v62, 2, v62
    v_add_u32 v62, 159744, v62
    s_lshl_b32 s57, s30, 11
    v_lshlrev_b32 v63, 4, v0
    v_add_u32 v63, s57, v63
    v_add_u32 v63, 92160, v63
    s_waitcnt vmcnt(34)
    s_barrier
    ds_read_b64_tr_b16 v[224:225], v8 offset:32768
    ds_read_b64_tr_b16 v[232:233], v9 offset:32768
    ds_read_b64_tr_b16 v[240:241], v10 offset:32768
    ds_read_b64_tr_b16 v[248:249], v11 offset:32768
    s_cmp_eq_u32 s30, 6
    s_cbranch_scc0 L_skip_101
    s_mov_b32 s57, 196864
    s_mov_b32 s58, 589056
    s_mov_b32 m0, 108544
L_dma_102:
    s_nop 0
    buffer_load_dwordx4 v7, s[36:39], s57 offen offset:0 nt lds
    buffer_load_dwordx4 v7, s[36:39], s58 offen offset:1024 nt lds
    s_add_u32 s57, s57, 24576
    s_add_u32 s58, s58, 24576
    s_add_u32 m0, m0, 2048
    s_cmp_lg_u32 m0, 124928
    s_cbranch_scc1 L_dma_102
L_skip_101:
    s_waitcnt lgkmcnt(0)
    v_lshrrev_b32 v5, 4, v0
    v_lshlrev_b32 v5, 5, v5
    v_bfe_u32 v60, v0, 1, 1
    v_lshl_add_u32 v5, v60, 4, v5
    v_add_u32 v5, 157696, v5
    ds_read_b128 v[12:15], v5 offset:0
    ds_read_b128 v[16:19], v5 offset:128
    ds_read_b128 v[20:23], v5 offset:256
    v_mov_b64 v[24:25], 0
    v_mov_b64 v[26:27], 0
    v_mov_b64 v[28:29], 0
    v_mov_b64 v[30:31], 0
    v_mov_b64 v[32:33], 0
    v_mov_b64 v[34:35], 0
    v_mov_b64 v[36:37], 0
    v_mov_b64 v[38:39], 0
    v_mov_b64 v[40:41], 0
    v_mov_b64 v[42:43], 0
    v_mov_b64 v[44:45], 0
    v_mov_b64 v[46:47], 0
    s_waitcnt lgkmcnt(0)
    v_smfmac_f32_16x16x64_bf16 v[24:27], v[12:15], v[64:71], v1
    v_smfmac_f32_16x16x64_bf16 v[24:27], v[16:19], v[72:79], v1
    v_smfmac_f32_16x16x64_bf16 v[24:27], v[20:23], v[80:87], v1
    v_smfmac_f32_16x16x64_bf16 v[28:31], v[12:15], v[88:95], v1
    v_smfmac_f32_16x16x64_bf16 v[28:31], v[16:19], v[96:103], v1
    v_smfmac_f32_16x16x64_bf16 v[28:31], v[20:23], v[104:111], v1
    v_smfmac_f32_16x16x64_bf16 v[32:35], v[12:15], v[112:119], v1
    v_smfmac_f32_16x16x64_bf16 v[32:35], v[16:19], v[120:127], v1
    v_smfmac_f32_16x16x64_bf16 v[32:35], v[20:23], v[128:135], v1
    v_smfmac_f32_16x16x64_bf16 v[36:39], v[12:15], v[136:143], v1
    v_smfmac_f32_16x16x64_bf16 v[36:39], v[16:19], v[144:151], v1
    v_smfmac_f32_16x16x64_bf16 v[36:39], v[20:23], v[152:159], v1
    v_add_f32 v24, v24, v26
    s_nop 0
    v_add_f32 v28, v28, v30
    s_nop 1
    v_add_f32 v32, v32, v34
    v_max3_f32 v61, v24, v28, v32
    v_mov_b32_dpp v24, v28 quad_perm:[0,1,2,3] row_mask:0x2 bank_mask:0xf
    v_add_f32 v36, v36, v38
    v_max_f32 v61, v61, v36
    v_mov_b32_dpp v24, v32 quad_perm:[0,1,2,3] row_mask:0x4 bank_mask:0xf
    s_nop 0
    v_max_f32_dpp v61, v61, v61 row_ror:8 row_mask:0xf bank_mask:0xf
    s_nop 0
    v_mov_b32_dpp v24, v36 quad_perm:[0,1,2,3] row_mask:0x8 bank_mask:0xf
    v_max_f32_dpp v61, v61, v61 row_ror:4 row_mask:0xf bank_mask:0xf
    s_nop 1
    v_max_f32_dpp v61, v61, v61 row_ror:2 row_mask:0xf bank_mask:0xf
    s_nop 1
    v_max_f32_dpp v61, v61, v61 row_ror:1 row_mask:0xf bank_mask:0xf
    v_sub_f32 v36, v24, v61
    ds_write_b32 v59, v61
    v_exp_f32 v36, v36
    s_nop 0
    v_cvt_pk_bf16_f32 v39, v36, v36
    ds_write_b16 v58, v39
    ds_read_b128 v[12:15], v52
    ds_read_b128 v[16:19], v53
    ds_read_b128 v[20:23], v54
    ds_read_b128 v[24:27], v55
    ds_read_b128 v[28:31], v56
    ds_read_b128 v[32:35], v57
    v_add_f32_dpp v38, v36, v36 row_ror:8 row_mask:0xf bank_mask:0xf
    s_nop 1
    v_add_f32_dpp v38, v38, v38 row_ror:4 row_mask:0xf bank_mask:0xf
    s_nop 1
    v_add_f32_dpp v38, v38, v38 row_ror:2 row_mask:0xf bank_mask:0xf
    s_nop 1
    v_add_f32_dpp v38, v38, v38 row_ror:1 row_mask:0xf bank_mask:0xf
    s_nop 1
    v_add_f32_dpp v38, v38, v38 row_bcast:15 row_mask:0xa bank_mask:0xf
    s_nop 1
    v_add_f32_dpp v38, v38, v38 row_bcast:31 row_mask:0xc bank_mask:0xf
    s_waitcnt lgkmcnt(0)
    s_waitcnt vmcnt(32)
    s_barrier
    ds_read_b64_tr_b16 v[162:163], v8 offset:49152
    ds_read_b64_tr_b16 v[170:171], v9 offset:49152
    ds_read_b64_tr_b16 v[178:179], v10 offset:49152
    ds_read_b64_tr_b16 v[186:187], v11 offset:49152
    s_cmp_eq_u32 s30, 6
    s_cbranch_scc0 L_skip_103
    s_mov_b32 s57, 786432
    s_mov_b32 s58, 1178624
    s_mov_b32 m0, 124928
L_dma_104:
    s_nop 0
    buffer_load_dwordx4 v7, s[36:39], s57 offen offset:0 nt lds
    buffer_load_dwordx4 v7, s[36:39], s58 offen offset:1024 nt lds
    s_add_u32 s57, s57, 24576
    s_add_u32 s58, s58, 24576
    s_add_u32 m0, m0, 2048
    s_cmp_lg_u32 m0, 141312
    s_cbranch_scc1 L_dma_104
L_skip_103:
    s_waitcnt lgkmcnt(0)
    ds_read_b32 v36, v62
    s_waitcnt lgkmcnt(0)
    v_max_f32_dpp v37, v36, v36 row_ror:4 row_mask:0xf bank_mask:0xf
    s_nop 1
    v_max_f32_dpp v37, v37, v37 row_ror:2 row_mask:0xf bank_mask:0xf
    s_nop 1
    v_max_f32_dpp v37, v37, v37 row_ror:1 row_mask:0xf bank_mask:0xf
    v_sub_f32 v39, v61, v37
    v_exp_f32 v39, v39
    s_cmp_lt_u32 s30, 2
    s_cbranch_scc0 L_skip_105
    s_lshl_b32 s57, s30, 3
    v_lshlrev_b32 v2, 4, v0
    v_add_u32 v2, s57, v2
    v_add_u32 v2, 92160, v2
    v_mov_b32 v60, 94192
    v_cmp_le_u32 vcc, 48, v0
    s_nop 1
    v_cndmask_b32 v2, v2, v60, vcc
    s_lshr_b32 s57, s54, 1
    s_lshl_b32 s57, s57, 2
    s_and_b32 s58, s54, 1
    s_add_u32 s57, s57, s58
    s_lshl_b32 s58, s57, 4
    s_lshl_b32 s57, s57, 3
    v_bfe_u32 v3, v0, 3, 2
    v_lshlrev_b32 v3, 8, v3
    v_bfe_u32 v61, v0, 2, 1
    v_lshl_add_u32 v3, v61, 5, v3
    v_and_b32 v61, 3, v0
    v_lshl_add_u32 v3, v61, 2, v3
    v_add_u32 v3, s58, v3
    v_bfe_u32 v60, v0, 3, 1
    v_lshlrev_b32 v60, 8, v60
    v_bfe_u32 v61, v0, 1, 1
    v_lshl_add_u32 v60, v61, 7, v60
    v_bfe_u32 v61, v0, 2, 1
    v_lshl_add_u32 v60, v61, 4, v60
    v_and_b32 v61, 1, v0
    v_lshl_add_u32 v60, v61, 2, v60
    v_add_u32 v60, s57, v60
    v_add_u32 v60, 1024, v60
    v_cmp_gt_u32 vcc, 32, v0
    s_nop 1
    v_cndmask_b32 v3, v60, v3, vcc
    s_lshl_b32 s57, s53, 1
    s_add_u32 s57, s57, s30
    s_mul_i32 s57, s57, 1664
    s_add_u32 s57, s57, s62
    v_add_u32 v3, s57, v3
    v_mov_b32 v60, 0x7f000000
    v_cmp_le_u32 vcc, 48, v0
    s_nop 1
    v_cndmask_b32 v3, v3, v60, vcc
    s_lshl_b32 s58, s54, 2
    s_add_u32 s57, s57, s58
    s_add_u32 s57, s57, 1536
    v_mov_b32 v4, s57
    v_mov_b32 v60, 0x7f000000
    v_cmp_ne_u32 vcc, 48, v0
    s_nop 1
    v_cndmask_b32 v4, v4, v60, vcc
    s_mov_b32 s58, 0
    v_min_u32 v37, -2, v37
    s_cmp_eq_u32 s55, 0
    s_cbranch_scc1 L_gs_106
    buffer_store_dword v37, v4, s[40:43], s58 offen
L_gb_107:
L_skip_105:
    s_cmp_eq_u32 s30, 2
    s_cbranch_scc0 L_skip_108
    v_lshlrev_b32 v2, 2, v0
    v_add_u32 v2, 157696, v2
    v_and_b32 v3, 15, v0
    v_lshlrev_b32 v3, 2, v3
    v_lshrrev_b32 v60, 5, v0
    v_lshl_add_u32 v3, v60, 6, v3
    v_bfe_u32 v60, v0, 4, 1
    v_lshl_add_u32 v3, v60, 13, v3
L_skip_108:
    s_waitcnt vmcnt(32)
    s_barrier
    ds_read_b64_tr_b16 v[194:195], v8 offset:0
    ds_read_b64_tr_b16 v[202:203], v9 offset:0
    ds_read_b64_tr_b16 v[210:211], v10 offset:0
    ds_read_b64_tr_b16 v[218:219], v11 offset:0
    s_cmp_eq_u32 s30, 6
    s_cbranch_scc0 L_skip_109
    s_mov_b32 s57, 786560
    s_mov_b32 s58, 1178752
    s_mov_b32 m0, 141312
L_dma_110:
    s_nop 0
    buffer_load_dwordx4 v7, s[36:39], s57 offen offset:0 nt lds
    buffer_load_dwordx4 v7, s[36:39], s58 offen offset:1024 nt lds
    s_add_u32 s57, s57, 24576
    s_add_u32 s58, s58, 24576
    s_add_u32 m0, m0, 2048
    s_cmp_lg_u32 m0, 157696
    s_cbranch_scc1 L_dma_110
L_skip_109:
    s_waitcnt lgkmcnt(0)
    s_waitcnt vmcnt(32)
    s_barrier
    ds_read_b64_tr_b16 v[226:227], v8 offset:16384
    ds_read_b64_tr_b16 v[234:235], v9 offset:16384
    ds_read_b64_tr_b16 v[242:243], v10 offset:16384
    ds_read_b64_tr_b16 v[250:251], v11 offset:16384
    s_cmp_eq_u32 s30, 6
    s_cbranch_scc0 L_skip_111
    s_mov_b32 s57, 786688
    s_mov_b32 s58, 1178880
    s_mov_b32 m0, 92160
L_dma_112:
    s_nop 0
    buffer_load_dwordx4 v7, s[36:39], s57 offen offset:0 nt lds
    buffer_load_dwordx4 v7, s[36:39], s58 offen offset:1024 nt lds
    s_add_u32 s57, s57, 24576
    s_add_u32 s58, s58, 24576
    s_add_u32 m0, m0, 2048
    s_cmp_lg_u32 m0, 108544
    s_cbranch_scc1 L_dma_112
L_skip_111:
    s_waitcnt lgkmcnt(0)
    s_cmp_eq_u32 s30, 5
    s_cbranch_scc0 L_skip_113
    global_load_dword v2, v3, s[26:27] offset:4 sc1
L_skip_113:
    s_waitcnt vmcnt(32)
    s_barrier
    ds_read_b64_tr_b16 v[164:165], v8 offset:32768
    ds_read_b64_tr_b16 v[172:173], v9 offset:32768
    ds_read_b64_tr_b16 v[180:181], v10 offset:32768
    ds_read_b64_tr_b16 v[188:189], v11 offset:32768
    s_cmp_eq_u32 s30, 6
    s_cbranch_scc0 L_skip_114
    s_mov_b32 s57, 983040
    s_mov_b32 s58, 1375232
    s_mov_b32 m0, 108544
L_dma_115:
    s_nop 0
    buffer_load_dwordx4 v7, s[36:39], s57 offen offset:0 nt lds
    buffer_load_dwordx4 v7, s[36:39], s58 offen offset:1024 nt lds
    s_add_u32 s57, s57, 24576
    s_add_u32 s58, s58, 24576
    s_add_u32 m0, m0, 2048
    s_cmp_lg_u32 m0, 124928
    s_cbranch_scc1 L_dma_115
L_skip_114:
    s_waitcnt lgkmcnt(0)
    s_waitcnt vmcnt(32)
    s_barrier
    ds_read_b64_tr_b16 v[196:197], v8 offset:49152
    ds_read_b64_tr_b16 v[204:205], v9 offset:49152
    ds_read_b64_tr_b16 v[212:213], v10 offset:49152
    ds_read_b64_tr_b16 v[220:221], v11 offset:49152
    s_cmp_eq_u32 s30, 6
    s_cbranch_scc0 L_skip_116
    s_mov_b32 s57, 983168
    s_mov_b32 s58, 1375360
    s_mov_b32 m0, 124928
L_dma_117:
    s_nop 0
    buffer_load_dwordx4 v7, s[36:39], s57 offen offset:0 nt lds
    buffer_load_dwordx4 v7, s[36:39], s58 offen offset:1024 nt lds
    s_add_u32 s57, s57, 24576
    s_add_u32 s58, s58, 24576
    s_add_u32 m0, m0, 2048
    s_cmp_lg_u32 m0, 141312
    s_cbranch_scc1 L_dma_117
L_skip_116:
    s_waitcnt lgkmcnt(0)
    s_cmp_eq_u32 s30, 5
    s_cbranch_scc0 L_skip_118
L_cw_119:
    s_waitcnt vmcnt(0)
    v_cmp_eq_u32 vcc, 0, v2
    s_cbranch_vccnz L_cr_120
    v_add_u32_dpp v2, v2, v2 row_ror:4 row_mask:0xf bank_mask:0xf
    s_nop 1
    v_add_u32_dpp v2, v2, v2 row_ror:2 row_mask:0xf bank_mask:0xf
    s_nop 1
    v_add_u32_dpp v2, v2, v2 row_ror:1 row_mask:0xf bank_mask:0xf
    v_mov_b32 v60, 160772
    ds_write_b32 v60, v2
    s_waitcnt lgkmcnt(0)
L_skip_118:
    s_cmp_lt_u32 s3, 20
    s_cbranch_scc0 L_skip_121
    s_mul_i32 s74, s30, 1664
    s_add_u32 s74, s74, s62
    s_add_u32 s74, s74, 0
    v_and_b32 v56, 7, v0
    v_lshlrev_b32 v56, 2, v56
    v_lshrrev_b32 v62, 4, v0
    v_lshlrev_b32 v62, 3, v62
    s_cmp_lg_u32 s30, 6
    s_cbranch_scc0 L_skip_121
    buffer_load_dword v52, v56, s[40:43], s74 offen offset:1536 sc1
    buffer_load_dwordx2 v[54:55], v62, s[40:43], s74 offen offset:1536 sc1
L_skip_121:
    s_cmp_eq_u32 s30, 2
    s_cbranch_scc0 L_skip_122
    s_sub_u32 s57, s3, 20
    s_cmp_lt_u32 s57, 4
    s_cbranch_scc0 L_skip_123
    s_sub_u32 s57, s3, 20
    s_lshl_b32 s57, s57, 6
    v_add_u32 v50, s57, v0
    v_min_u32 v50, 207, v50
    v_lshlrev_b32 v50, 7, v50
    s_add_u32 s57, s62, 0
    buffer_load_dword v50, v50, s[40:43], s57 offen sc1 nt
    s_sub_u32 s57, s3, 20
    s_lshl_b32 s57, s57, 6
    v_add_u32 v51, s57, v0
    v_min_u32 v51, 151, v51
    v_lshlrev_b32 v51, 7, v51
    s_add_u32 s57, s62, 26624
    buffer_load_dword v51, v51, s[40:43], s57 offen sc1 nt
    s_sub_u32 s57, s3, 20
    s_lshl_b32 s57, s57, 6
    v_add_u32 v49, s57, v0
    v_min_u32 v49, 191, v49
    v_lshlrev_b32 v49, 7, v49
    s_add_u32 s57, s62, 46080
    buffer_load_dword v49, v49, s[40:43], s57 offen sc1 nt
L_skip_123:
L_skip_122:
    s_waitcnt vmcnt(32)
    s_barrier
    ds_read_b64_tr_b16 v[228:229], v8 offset:0
    ds_read_b64_tr_b16 v[236:237], v9 offset:0
    ds_read_b64_tr_b16 v[244:245], v10 offset:0
    ds_read_b64_tr_b16 v[252:253], v11 offset:0
    s_cmp_eq_u32 s30, 6
    s_cbranch_scc0 L_skip_124
    s_mov_b32 s57, 983296
    s_mov_b32 s58, 1375488
    s_mov_b32 m0, 141312
L_dma_125:
    s_nop 0
    buffer_load_dwordx4 v7, s[36:39], s57 offen offset:0 nt lds
    buffer_load_dwordx4 v7, s[36:39], s58 offen offset:1024 nt lds
    s_add_u32 s57, s57, 24576
    s_add_u32 s58, s58, 24576
    s_add_u32 m0, m0, 2048
    s_cmp_lg_u32 m0, 157696
    s_cbranch_scc1 L_dma_125
L_skip_124:
    s_waitcnt lgkmcnt(0)
    s_cmp_ge_u32 s30, 6
    s_cbranch_scc0 L_skip_126
    v_mov_b32 v60, 160772
    ds_read_b32 v60, v60
    s_lshr_b32 s58, s63, 2
    s_waitcnt lgkmcnt(0)
    v_readfirstlane_b32 s57, v60
    s_cmp_gt_u32 s57, 24
    s_cselect_b32 s57, 1, 0
    s_xor_b32 s57, s57, s58
    s_lshl_b32 s57, s57, 13
    s_add_u32 s7, s8, s57
L_skip_126:
    s_branch L_tail
.p2align 10
L_tail:
L_pad0:
    s_cbranch_execz L_pad4
    s_waitcnt vmcnt(32)
    s_barrier
    ds_read_b64_tr_b16 v[166:167], v8 offset:16384
    ds_read_b64_tr_b16 v[174:175], v9 offset:16384
    ds_read_b64_tr_b16 v[182:183], v10 offset:16384
    ds_read_b64_tr_b16 v[190:191], v11 offset:16384
    s_waitcnt lgkmcnt(0)
    s_cmp_lt_u32 s30, 5
    s_cbranch_scc0 L_skip_127
    s_waitcnt vmcnt(0)
L_skip_127:
    s_cmp_lt_u32 s3, 20
    s_cbranch_scc0 L_skip_128
    v_lshlrev_b32 v57, 4, v0
    v_lshlrev_b32 v58, 3, v0
    s_mul_i32 s57, s30, 6144
    s_add_u32 s57, s57, 30720
    v_lshrrev_b32 v59, 2, v0
    v_lshlrev_b32 v59, 6, v59
    v_bfe_u32 v53, v0, 4, 1
    v_lshl_add_u32 v59, v53, 5, v59
    v_and_b32 v53, 3, v0
    v_lshl_add_u32 v59, v53, 3, v59
    v_add_u32 v59, s57, v59
    v_xor_b32 v60, 32, v59
    s_lshl_b32 s57, s30, 8
    s_add_u32 s57, s57, 157696
    v_lshl_add_u32 v61, v0, 2, s57
    s_cmp_lg_u32 s30, 6
    s_cbranch_scc0 L_skip_128
L_cw_129:
    s_waitcnt vmcnt(0)
    v_max3_u32 v53, v52, v54, v55
    v_cmp_eq_u32 vcc, -1, v53
    s_cbranch_vccnz L_cr_130
    v_max_f32_dpp v53, v52, v52 row_ror:4 row_mask:0xf bank_mask:0xf
    s_nop 1
    v_max_f32_dpp v53, v53, v53 row_ror:2 row_mask:0xf bank_mask:0xf
    s_nop 1
    v_max_f32_dpp v53, v53, v53 row_ror:1 row_mask:0xf bank_mask:0xf
    v_sub_f32 v52, v52, v53
    v_sub_f32 v54, v54, v53
    v_sub_f32 v55, v55, v53
    v_exp_f32 v52, v52
    v_exp_f32 v54, v54
    v_exp_f32 v55, v55
    s_cmp_eq_u32 s30, 7
    s_cbranch_scc0 L_skip_128
    v_add_u32 v62, 158720, v57
    ds_write_b128 v62, v[52:55]
    s_waitcnt lgkmcnt(0)
L_skip_128:
    v_smfmac_f32_16x16x64_bf16 v[40:43], v[12:15], v[160:167], v1
    v_smfmac_f32_16x16x64_bf16 v[40:43], v[16:19], v[168:175], v1
    v_smfmac_f32_16x16x64_bf16 v[40:43], v[20:23], v[176:183], v1
    v_smfmac_f32_16x16x64_bf16 v[40:43], v[24:27], v[184:191], v1
    s_cmp_eq_u32 s30, 6
    s_cbranch_scc0 L_skip_131
    s_mul_i32 s57, s14, 12
    s_add_u32 s58, s57, s15
    s_mov_b32 m0, 55296
L_dma_132:
    s_nop 0
    buffer_load_dwordx4 v3, s[48:51], s57 offen offset:0 nt lds
    buffer_load_dwordx4 v3, s[48:51], s58 offen offset:1024 nt lds
    s_add_u32 s57, s57, s14
    s_add_u32 s58, s58, s14
    s_add_u32 m0, m0, 2048
    s_cmp_lg_u32 m0, 67584
    s_cbranch_scc1 L_dma_132
    s_mul_i32 s57, s14, 18
    s_add_u32 s58, s57, s15
    s_mov_b32 m0, 67584
L_dma_133:
    s_nop 0
    buffer_load_dwordx4 v3, s[48:51], s57 offen offset:0 nt lds
    buffer_load_dwordx4 v3, s[48:51], s58 offen offset:1024 nt lds
    s_add_u32 s57, s57, s14
    s_add_u32 s58, s58, s14
    s_add_u32 m0, m0, 2048
    s_cmp_lg_u32 m0, 79872
    s_cbranch_scc1 L_dma_133
L_skip_131:
    s_waitcnt vmcnt(40)
    s_barrier
    ds_read_b64_tr_b16 v[198:199], v8 offset:32768
    ds_read_b64_tr_b16 v[206:207], v9 offset:32768
    ds_read_b64_tr_b16 v[214:215], v10 offset:32768
    ds_read_b64_tr_b16 v[222:223], v11 offset:32768
    s_waitcnt lgkmcnt(0)
    s_cmp_lt_u32 s3, 20
    s_cbranch_scc0 L_skip_134
    s_cmp_eq_u32 s30, 6
    s_cbranch_scc0 L_skip_134
    v_add_u32 v62, 158720, v57
    ds_read_b128 v[52:55], v62
L_skip_134:
L_pad1:
    s_cbranch_execz L_pad5
    v_smfmac_f32_16x16x64_bf16 v[40:43], v[28:31], v[192:199], v1
    v_smfmac_f32_16x16x64_bf16 v[40:43], v[32:35], v[200:207], v1
    v_smfmac_f32_16x16x64_bf16 v[44:47], v[12:15], v[208:215], v1
    v_smfmac_f32_16x16x64_bf16 v[44:47], v[16:19], v[216:223], v1
    v_mul_f32 v38, v38, v39
    ds_write_b32 v63, v38 offset:1024
    s_waitcnt vmcnt(24)
    s_barrier
    ds_read_b64_tr_b16 v[230:231], v8 offset:49152
    ds_read_b64_tr_b16 v[238:239], v9 offset:49152
    ds_read_b64_tr_b16 v[246:247], v10 offset:49152
    ds_read_b64_tr_b16 v[254:255], v11 offset:49152
    s_waitcnt lgkmcnt(0)
    v_smfmac_f32_16x16x64_bf16 v[44:47], v[20:23], v[224:231], v1
    v_smfmac_f32_16x16x64_bf16 v[44:47], v[24:27], v[232:239], v1
    v_smfmac_f32_16x16x64_bf16 v[44:47], v[28:31], v[240:247], v1
    v_smfmac_f32_16x16x64_bf16 v[44:47], v[32:35], v[248:255], v1
    s_setprio 0
    s_cmp_lt_u32 s30, 2
    v_pk_add_f32 v[40:41], v[40:41], v[42:43]
    s_nop 4
    v_pk_add_f32 v[42:43], v[44:45], v[46:47]
    v_pk_mul_f32 v[40:41], v[40:41], v[38:39] op_sel:[0,1] op_sel_hi:[1,1]
    v_pk_mul_f32 v[42:43], v[42:43], v[38:39] op_sel:[0,1] op_sel_hi:[1,1]
    ds_write_b128 v63, v[40:43]
    s_cbranch_scc1 L_comb_0
    s_waitcnt lgkmcnt(0)
    s_barrier
L_comb_0b:
    s_cmp_eq_u32 s30, 6
    s_cbranch_scc0 L_skip_139
    s_waitcnt vmcnt(0)
L_skip_139:
    s_barrier
    s_cmp_lt_u32 s3, 20
    s_cbranch_scc0 L_typeB_0
    buffer_load_dwordx4 v[12:15], v57, s[40:43], s74 offen sc1
    buffer_load_dwordx2 v[16:17], v58, s[40:43], s74 offen offset:1024 sc1
    buffer_load_dword v18, v56, s[40:43], s74 offen offset:1568 sc1
    ds_read_b64_tr_b16 v[28:29], v59 offset:0
    ds_read_b64_tr_b16 v[30:31], v59 offset:1024
    ds_read_b64_tr_b16 v[32:33], v59 offset:2048
    ds_read_b64_tr_b16 v[34:35], v59 offset:3072
    ds_read_b64_tr_b16 v[36:37], v59 offset:4096
    ds_read_b64_tr_b16 v[38:39], v59 offset:5120
    ds_read_b64_tr_b16 v[40:41], v60 offset:0
    ds_read_b64_tr_b16 v[42:43], v60 offset:1024
    ds_read_b64_tr_b16 v[44:45], v60 offset:2048
    ds_read_b64_tr_b16 v[46:47], v60 offset:3072
    ds_read_b64_tr_b16 v[48:49], v60 offset:4096
    ds_read_b64_tr_b16 v[50:51], v60 offset:5120
    v_mov_b64 v[20:21], 0
    v_mov_b64 v[22:23], 0
    v_mov_b64 v[24:25], 0
    v_mov_b64 v[26:27], 0
    s_add_u32 s58, s6, 0
    s_waitcnt lgkmcnt(0)
    s_branch L_pw_140
L_pr_141:
    buffer_load_dwordx4 v[12:15], v57, s[40:43], s74 offen sc1
    buffer_load_dwordx2 v[16:17], v58, s[40:43], s74 offen offset:1024 sc1
    buffer_load_dword v18, v56, s[40:43], s74 offen offset:1568 sc1
    s_sub_u32 s56, s56, 1
    s_cbranch_scc1 L_done
L_pw_140:
    s_waitcnt vmcnt(0)
    v_max3_u32 v19, v12, v13, v14
    v_max3_u32 v19, v19, v15, v16
    v_max3_u32 v19, v19, v17, v18
    v_cmp_eq_u32 vcc, -1, v19
    s_cbranch_vccnz L_pr_141
    v_smfmac_f32_16x16x64_bf16 v[20:23], v[12:15], v[28:35], v1
    v_mul_f32 v52, v52, v18
    v_smfmac_f32_16x16x64_bf16 v[24:27], v[12:15], v[40:47], v1
    v_smfmac_f32_16x16x32_bf16 v[20:23], v[16:17], v[36:39], v1
    v_add_f32_dpp v52, v52, v52 row_ror:4 row_mask:0xf bank_mask:0xf
    v_smfmac_f32_16x16x32_bf16 v[24:27], v[16:17], v[48:51], v1
    s_cmp_eq_u32 s30, 2
    v_add_f32_dpp v52, v52, v52 row_ror:2 row_mask:0xf bank_mask:0xf
    s_nop 1
    v_add_f32_dpp v52, v52, v52 row_ror:1 row_mask:0xf bank_mask:0xf
    v_rcp_f32 v52, v52
    v_pk_add_f32 v[20:21], v[20:21], v[22:23]
    s_nop 0
L_pad2:
    s_cbranch_execz L_pad6
    v_pk_add_f32 v[24:25], v[24:25], v[26:27]
    v_pk_mul_f32 v[54:55], v[54:55], v[52:53] op_sel:[0,0] op_sel_hi:[1,0]
    v_mul_f32 v20, v20, v54
    v_mul_f32 v24, v24, v54
    v_fmac_f32 v20, v21, v55
    v_fmac_f32 v24, v25, v55
    s_nop 1
    v_permlane32_swap_b32 v20, v24
    v_add_f32 v20, v20, v24
    ds_write_b32 v61, v20
    s_waitcnt lgkmcnt(0)
    s_barrier
    s_cbranch_scc0 L_finb_142
    ds_read2st64_b32 v[12:13], v2 offset0:0 offset1:1
    ds_read2st64_b32 v[14:15], v2 offset0:2 offset1:3
    ds_read2st64_b32 v[16:17], v2 offset0:4 offset1:5
    ds_read2st64_b32 v[18:19], v2 offset0:6 offset1:7
    s_waitcnt lgkmcnt(2)
    v_pk_add_f32 v[12:13], v[12:13], v[14:15]
    s_waitcnt lgkmcnt(0)
    v_pk_add_f32 v[16:17], v[16:17], v[18:19]
    v_pk_add_f32 v[12:13], v[12:13], v[16:17]
    v_add_f32 v14, v12, v13
    v_add_f32 v15, v12, v13
    s_nop 1
    v_permlane16_swap_b32 v14, v15
    v_add_f32 v12, v14, v15
    v_min_u32 v12, -2, v12
    buffer_store_dword v12, v3, s[40:43], s58 offen sc1
L_finb_142:
    s_sub_u32 s57, s30, 4
    s_cmp_lt_u32 s57, 3
    s_cbranch_scc0 L_skip_143
    s_sub_u32 s60, s30, 4
    s_lshl_b32 s57, s60, 11
    v_lshlrev_b32 v11, 4, v0
    v_add_u32 v11, s57, v11
    s_add_u32 s65, s62, 19456
    buffer_load_dwordx4 v[52:55], v11, s[40:43], s65 offen offset:0 sc1
    buffer_load_dwordx4 v[56:59], v11, s[40:43], s65 offen offset:1024 sc1
    s_lshl_b32 s59, s60, 12
    s_add_u32 s59, s59, 79872
    s_mov_b32 s44, s20
    s_mov_b32 s45, s21
    s_mov_b32 s46, 1966080
    s_mov_b32 s47, 0x20000
    s_mul_i32 s57, s31, 3
    s_add_u32 s57, s57, s60
    s_mul_i32 s57, s57, 81920
    s_lshl_b32 s64, s3, 6
    s_add_u32 s57, s57, s64
    v_lshrrev_b32 v5, 2, v0
    v_mul_u32_u24 v5, 1280, v5
    v_and_b32 v60, 3, v0
    v_lshl_add_u32 v5, v60, 4, v5
    v_add_u32 v5, s57, v5
    s_add_u32 m0, s59, 0
    s_mov_b32 s57, 0
    buffer_load_dwordx4 v5, s[44:47], s57 offen nt lds
    s_add_u32 m0, s59, 1024
    s_mov_b32 s57, 20480
    buffer_load_dwordx4 v5, s[44:47], s57 offen nt lds
    s_add_u32 m0, s59, 2048
    s_mov_b32 s57, 40960
    buffer_load_dwordx4 v5, s[44:47], s57 offen nt lds
    s_add_u32 m0, s59, 3072
    s_mov_b32 s57, 61440
    buffer_load_dwordx4 v5, s[44:47], s57 offen nt lds
    v_bfe_u32 v35, v0, 4, 1
    v_lshlrev_b32 v35, 11, v35
    v_bfe_u32 v60, v0, 2, 2
    v_lshl_add_u32 v35, v60, 8, v35
    v_lshrrev_b32 v60, 5, v0
    v_lshl_add_u32 v35, v60, 6, v35
    v_and_b32 v60, 3, v0
    v_lshl_add_u32 v35, v60, 3, v35
    v_add_u32 v35, s59, v35
    v_mov_b32 v9, 0xbdd2d3e8
    v_mov_b32 v10, 0xc0135761
    s_lshl_b32 s57, s60, 7
    s_add_u32 s57, s57, 159872
    v_lshlrev_b32 v32, 3, v0
    v_add_u32 v32, s57, v32
    v_lshlrev_b32 v33, 3, v0
    v_add_u32 v33, 129024, v33
    v_cmp_gt_u32 vcc, 16, v0
    s_nop 1
    v_cndmask_b32 v32, v33, v32, vcc
    v_and_b32 v33, 15, v0
L_pad3:
    s_cbranch_execz L_pad7
    v_lshlrev_b32 v33, 3, v33
    v_lshrrev_b32 v60, 5, v0
    v_lshl_add_u32 v33, v60, 2, v33
    v_add_u32 v33, 159872, v33
    v_and_b32 v34, 15, v0
    v_lshlrev_b32 v34, 2, v34
    v_lshrrev_b32 v60, 5, v0
    v_lshl_add_u32 v34, v60, 6, v34
    v_bfe_u32 v60, v0, 4, 1
    v_lshl_add_u32 v34, v60, 13, v34
    s_add_u32 s60, s6, 66048
    s_add_u32 s58, s62, 13312
    s_add_u32 s57, s62, 25856
    v_and_b32 v7, 7, v0
    v_lshlrev_b32 v7, 3, v7
    v_mov_b32 v60, 0x3acccccd
    v_mov_b32 v61, 0x3727c5ac
    s_waitcnt vmcnt(0)
    buffer_load_dwordx2 v[24:25], v7, s[40:43], s57 offen sc1
    buffer_load_dwordx4 v[12:15], v11, s[40:43], s58 offen offset:0 sc1
    buffer_load_dwordx4 v[16:19], v11, s[40:43], s58 offen offset:1024 sc1
    ds_read_b64_tr_b16 v[36:37], v35 offset:0
    ds_read_b64_tr_b16 v[38:39], v35 offset:1024
    ds_read_b64_tr_b16 v[40:41], v35 offset:128
    ds_read_b64_tr_b16 v[42:43], v35 offset:1152
    ds_read_b64_tr_b16 v[44:45], v35 offset:32
    ds_read_b64_tr_b16 v[46:47], v35 offset:1056
    ds_read_b64_tr_b16 v[48:49], v35 offset:160
    ds_read_b64_tr_b16 v[50:51], v35 offset:1184
L_sw_146:
    v_max3_u32 v20, v52, v53, v54
    v_max3_u32 v20, v20, v55, v56
    v_max3_u32 v20, v20, v57, v58
    v_max_u32 v20, v20, v59
    v_cmp_eq_u32 vcc, -1, v20
    s_cbranch_vccnz L_sr_147
    v_pk_add_f32 v[28:29], v[52:53], v[56:57]
    v_pk_add_f32 v[30:31], v[54:55], v[58:59]
    s_nop 1
    v_permlane32_swap_b32 v28, v30
    v_permlane32_swap_b32 v29, v31
    v_pk_add_f32 v[28:29], v[28:29], v[30:31]
    s_nop 1
    v_permlane16_swap_b32 v28, v29
    v_add_f32 v28, v28, v29
    v_mov_b64 v[52:53], 0
    v_mov_b64 v[54:55], 0
    v_mov_b64 v[56:57], 0
    v_mov_b64 v[58:59], 0
    s_waitcnt lgkmcnt(0)
L_pr_145:
    buffer_load_dwordx2 v[24:25], v7, s[40:43], s57 offen sc1
    buffer_load_dwordx4 v[12:15], v11, s[40:43], s58 offen offset:0 sc1
    buffer_load_dwordx4 v[16:19], v11, s[40:43], s58 offen offset:1024 sc1
    s_sub_u32 s56, s56, 1
    s_cbranch_scc1 L_done
L_pw_144:
    s_waitcnt vmcnt(3)
    v_max_u32 v20, v24, v25
    v_cmp_eq_u32 vcc, -1, v20
    s_cbranch_vccnz L_pr_145
    buffer_load_dwordx4 v[12:15], v11, s[40:43], s58 offen offset:0 sc1
    buffer_load_dwordx4 v[16:19], v11, s[40:43], s58 offen offset:1024 sc1
    v_add_f32_dpp v2, v24, v24 row_ror:4 row_mask:0xf bank_mask:0xf
    v_add_f32_dpp v3, v25, v25 row_ror:4 row_mask:0xf bank_mask:0xf
    v_pk_add_f32 v[20:21], v[12:13], v[16:17]
    v_pk_add_f32 v[22:23], v[14:15], v[18:19]
    v_add_f32_dpp v2, v2, v2 row_ror:2 row_mask:0xf bank_mask:0xf
    v_add_f32_dpp v3, v3, v3 row_ror:2 row_mask:0xf bank_mask:0xf
    v_permlane32_swap_b32 v20, v22
    v_permlane32_swap_b32 v21, v23
    v_add_f32_dpp v2, v2, v2 row_ror:1 row_mask:0xf bank_mask:0xf
    v_add_f32_dpp v3, v3, v3 row_ror:1 row_mask:0xf bank_mask:0xf
    v_pk_add_f32 v[20:21], v[20:21], v[22:23]
    v_mul_f32 v2, v2, v60
    v_fma_f32 v3, v3, v60, v61
    v_permlane16_swap_b32 v20, v21
    v_fma_f32 v3, -v2, v2, v3
    v_add_f32 v20, v20, v21
    v_max_f32 v3, v3, v61
    v_mul_f32 v26, v28, v2
    v_rsq_f32 v3, v3
    v_cmp_u_f32 vcc, v20, v20
    v_sub_f32 v20, v20, v26
    s_cbranch_vccnz L_hr_148
L_hk_149:
    v_fma_f32 v20, v20, v3, v4
L_pad4:
    s_cbranch_execz L_pad8
    v_mul_f32 v21, v20, v20
    v_fma_f32 v21, v21, v9, v10
    v_mul_f32 v21, v21, v20
    v_exp_f32 v21, v21
    s_nop 0
    v_add_f32 v21, 1.0, v21
    v_rcp_f32 v21, v21
    s_nop 0
    v_mul_f32 v20, v20, v21
    s_nop 1
    v_mov_b32_dpp v21, v20 row_shl:1 row_mask:0xf bank_mask:0xf bound_ctrl:0
    v_cvt_pk_bf16_f32 v28, v20, v21
    s_nop 1
    v_mov_b32_dpp v29, v28 row_shl:4 row_mask:0xf bank_mask:0xf bound_ctrl:0
    v_mov_b32_dpp v30, v28 row_shl:8 row_mask:0xf bank_mask:0xf bound_ctrl:0
    v_mov_b32_dpp v31, v28 row_shl:12 row_mask:0xf bank_mask:0xf bound_ctrl:0
    s_nop 1
    v_smfmac_f32_16x16x64_bf16 v[52:55], v[28:31], v[36:43], v1
    v_smfmac_f32_16x16x64_bf16 v[56:59], v[28:31], v[44:51], v1
    s_cmp_eq_u32 s30, 4
    s_nop 5
    v_add_f32 v22, v52, v54
    v_add_f32 v23, v56, v58
    ds_write_b64 v32, v[22:23]
    s_cbranch_scc0 L_skip_151
L_xw_152:
    ds_read2_b32 v[20:21], v33 offset0:0 offset1:32
    ds_read_b32 v22, v33 offset:256
    s_sub_u32 s56, s56, 1
    s_cbranch_scc1 L_done
    s_waitcnt lgkmcnt(0)
    v_max3_u32 v23, v20, v21, v22
    v_add_f32 v20, v20, v21
    v_cmp_eq_u32 vcc, -1, v23
    v_add_f32 v20, v20, v22
    s_cbranch_vccnz L_xw_152
    v_min_u32 v20, -2, v20
    buffer_store_dword v20, v34, s[40:43], s60 offen sc1
    s_waitcnt vmcnt(1)
    s_branch L_pe_153
L_skip_151:
    s_waitcnt vmcnt(0)
L_pe_153:
L_skip_143:
    s_branch L_p1
L_typeB_0:
    s_cmp_eq_u32 s53, 3
    s_cbranch_scc0 L_typeC_154
    s_cmp_eq_u32 s30, 7
    s_cbranch_scc1 L_w7_164
    s_cmp_lt_u32 s30, 6
    s_cbranch_scc0 L_skip_166
    s_lshr_b32 s57, s30, 1
    s_mul_i32 s57, s57, 128
    s_and_b32 s58, s30, 1
    s_lshl_b32 s58, s58, 6
    s_add_u32 s57, s57, s58
    v_lshrrev_b32 v18, 5, v0
    v_lshlrev_b32 v18, 13, v18
    v_bfe_u32 v60, v0, 3, 1
    v_lshl_add_u32 v18, v60, 12, v18
    v_bfe_u32 v60, v0, 4, 1
    v_lshl_add_u32 v18, v60, 11, v18
    v_bfe_u32 v60, v0, 2, 1
    v_mul_u32_u24 v60, 384, v60
    v_add_u32 v18, v60, v18
    v_and_b32 v60, 3, v0
    v_lshl_add_u32 v18, v60, 3, v18
    v_add_u32 v18, s57, v18
    v_add_u32 v18, 30720, v18
    v_bfe_u32 v19, v0, 4, 1
    v_lshlrev_b32 v19, 12, v19
    v_bfe_u32 v60, v0, 3, 1
    v_lshl_add_u32 v19, v60, 11, v19
    v_bfe_u32 v60, v0, 2, 1
    v_mul_u32_u24 v60, 384, v60
    v_add_u32 v19, v60, v19
    v_and_b32 v60, 3, v0
    v_lshl_add_u32 v19, v60, 3, v19
    v_add_u32 v19, s57, v19
    v_add_u32 v19, 63488, v19
    ds_read_b64_tr_b16 v[28:29], v18 offset:0
    ds_read_b64_tr_b16 v[30:31], v18 offset:1024
    ds_read_b64_tr_b16 v[32:33], v18 offset:16384
    ds_read_b64_tr_b16 v[34:35], v18 offset:17408
    ds_read_b64_tr_b16 v[36:37], v19 offset:0
    ds_read_b64_tr_b16 v[38:39], v19 offset:1024
    ds_read_b64_tr_b16 v[40:41], v18 offset:32
    ds_read_b64_tr_b16 v[42:43], v18 offset:1056
    ds_read_b64_tr_b16 v[44:45], v18 offset:16416
    ds_read_b64_tr_b16 v[46:47], v18 offset:17440
    ds_read_b64_tr_b16 v[48:49], v19 offset:32
L_pad5:
    s_cbranch_execz L_pad9
    ds_read_b64_tr_b16 v[50:51], v19 offset:1056
    v_lshrrev_b32 v9, 4, v0
    v_lshlrev_b32 v9, 5, v9
    v_bfe_u32 v60, v0, 1, 1
    v_lshl_add_u32 v9, v60, 4, v9
    v_and_b32 v60, 1, v0
    v_mul_u32_u24 v60, 192, v60
    v_add_u32 v9, v60, v9
    v_add_u32 v9, 160832, v9
    v_lshrrev_b32 v10, 4, v0
    v_lshlrev_b32 v10, 4, v10
    v_bfe_u32 v60, v0, 1, 1
    v_lshl_add_u32 v10, v60, 3, v10
    v_and_b32 v60, 1, v0
    v_mul_u32_u24 v60, 192, v60
    v_add_u32 v10, v60, v10
    v_add_u32 v10, 160960, v10
    v_mov_b64 v[20:21], 0
    v_mov_b64 v[22:23], 0
    v_mov_b64 v[24:25], 0
    v_mov_b64 v[26:27], 0
    s_lshr_b32 s57, s30, 1
    s_lshl_b32 s57, s57, 11
    s_lshl_b32 s58, s58, 1
    s_add_u32 s57, s57, s58
    s_lshl_b32 s58, s54, 8
    s_add_u32 s57, s57, s58
    v_and_b32 v11, 31, v0
    v_lshlrev_b32 v11, 2, v11
    v_lshrrev_b32 v60, 5, v0
    v_lshl_add_u32 v11, v60, 30, v11
    v_add_u32 v11, s57, v11
    s_add_u32 s59, s62, 13312
    s_add_u32 s60, s62, 25856
    ds_read_b128 v[12:15], v9
    ds_read_b64 v[16:17], v10
    s_waitcnt lgkmcnt(1)
    v_smfmac_f32_16x16x64_bf16 v[20:23], v[12:15], v[28:35], v1
    v_smfmac_f32_16x16x64_bf16 v[24:27], v[12:15], v[40:47], v1
    s_waitcnt lgkmcnt(0)
    v_smfmac_f32_16x16x32_bf16 v[20:23], v[16:17], v[36:39], v1
    v_smfmac_f32_16x16x32_bf16 v[24:27], v[16:17], v[48:51], v1
    s_add_u32 s60, s62, 19456
    s_cmp_eq_u32 s55, 0
    s_nop 4
    v_add_f32 v12, v21, v23
    s_nop 1
    v_add_f32_dpp v12, v25, v27 quad_perm:[0,1,2,3] row_mask:0x2 bank_mask:0xf
    v_min_u32 v12, -2, v12
    s_cbranch_scc1 L_gs_167
    buffer_store_dword v12, v11, s[40:43], s60 offen
L_gb_168:
    v_mov_b64 v[20:21], 0
    v_mov_b64 v[22:23], 0
    v_mov_b64 v[24:25], 0
    v_mov_b64 v[26:27], 0
L_skip_166:
    s_cmp_lt_u32 s30, 6
    s_barrier
    s_cbranch_scc0 L_se_165
    ds_read_b128 v[12:15], v9
    ds_read_b64 v[16:17], v10
    s_waitcnt lgkmcnt(1)
    v_smfmac_f32_16x16x64_bf16 v[20:23], v[12:15], v[28:35], v1
    v_smfmac_f32_16x16x64_bf16 v[24:27], v[12:15], v[40:47], v1
    s_waitcnt lgkmcnt(0)
    v_smfmac_f32_16x16x32_bf16 v[20:23], v[16:17], v[36:39], v1
    v_smfmac_f32_16x16x32_bf16 v[24:27], v[16:17], v[48:51], v1
    s_cmp_eq_u32 s55, 0
    s_nop 5
    v_add_f32 v12, v20, v22
    s_nop 1
    v_add_f32_dpp v12, v24, v26 quad_perm:[0,1,2,3] row_mask:0x2 bank_mask:0xf
    v_min_u32 v12, -2, v12
    s_cbranch_scc1 L_gs_169
    buffer_store_dword v12, v11, s[40:43], s59 offen
L_gb_170:
L_se_165:
L_p1:
    s_lshl_b32 s57, s30, 7
    s_add_u32 s57, s57, 158720
    v_lshrrev_b32 v58, 4, v0
    v_lshlrev_b32 v58, 5, v58
    v_bfe_u32 v60, v0, 1, 1
    v_lshl_add_u32 v58, v60, 4, v58
    v_bfe_u32 v60, v0, 2, 2
    v_lshl_add_u32 v58, v60, 2, v58
    v_and_b32 v60, 1, v0
    v_lshl_add_u32 v58, v60, 1, v58
    v_add_u32 v58, s57, v58
    v_lshrrev_b32 v61, 4, v0
    v_lshlrev_b32 v61, 5, v61
    v_bfe_u32 v60, v0, 1, 1
    v_lshl_add_u32 v61, v60, 4, v61
    v_add_u32 v61, s57, v61
L_pad6:
    s_cbranch_execz L_pad10
    v_bfe_u32 v62, v0, 2, 2
    v_lshlrev_b32 v62, 1, v62
    v_and_b32 v60, 1, v0
    v_lshl_add_u32 v62, v60, 0, v62
    v_mov_b32 v60, 160992
    v_cmp_eq_u32 vcc, 0, v62
    s_nop 1
    v_cndmask_b32 v52, v60, v61, vcc
    v_cmp_eq_u32 vcc, 1, v62
    s_nop 1
    v_cndmask_b32 v53, v60, v61, vcc
    v_cmp_eq_u32 vcc, 2, v62
    s_nop 1
    v_cndmask_b32 v54, v60, v61, vcc
    v_cmp_eq_u32 vcc, 3, v62
    s_nop 1
    v_cndmask_b32 v55, v60, v61, vcc
    v_cmp_eq_u32 vcc, 4, v62
    s_nop 1
    v_cndmask_b32 v56, v60, v61, vcc
    v_cmp_eq_u32 vcc, 5, v62
    s_nop 1
    v_cndmask_b32 v57, v60, v61, vcc
    s_lshl_b32 s58, s30, 2
    s_add_u32 s58, s58, 159808
    v_mov_b32 v60, s58
    v_lshlrev_b32 v59, 2, v0
    v_add_u32 v59, 158208, v59
    v_cmp_eq_u32 vcc, 63, v0
    s_nop 1
    v_cndmask_b32 v59, v59, v60, vcc
    v_and_b32 v62, 7, v0
    v_lshlrev_b32 v62, 2, v62
    v_add_u32 v62, 159808, v62
    s_lshl_b32 s57, s30, 11
    v_lshlrev_b32 v63, 4, v0
    v_add_u32 v63, s57, v63
    v_add_u32 v63, 92160, v63
    s_sub_u32 s57, s30, 1
    s_lshl_b32 s58, s57, 11
    v_lshlrev_b32 v7, 4, v0
    v_add_u32 v7, s58, v7
    s_lshl_b32 s58, s57, 7
    v_bfe_u32 v8, v0, 2, 2
    v_lshlrev_b32 v8, 5, v8
    v_lshrrev_b32 v60, 5, v0
    v_lshl_add_u32 v8, v60, 4, v8
    v_and_b32 v60, 3, v0
    v_lshl_add_u32 v8, v60, 2, v8
    v_bfe_u32 v60, v0, 4, 1
    v_lshl_add_u32 v8, v60, 1, v8
    v_add_u32 v8, s58, v8
    v_add_u32 v8, 124928, v8
    s_cmp_eq_u32 s30, 7
    s_cbranch_scc1 L_w7_178
    s_cmp_lt_u32 s30, 6
    s_cbranch_scc0 L_skip_180
    s_lshr_b32 s57, s30, 1
    s_mul_i32 s57, s57, 1024
    s_and_b32 s58, s30, 1
    s_lshl_b32 s58, s58, 6
    s_add_u32 s57, s57, s58
    v_lshrrev_b32 v18, 5, v0
    v_mul_u32_u24 v18, 6144, v18
    v_bfe_u32 v60, v0, 3, 1
    v_mul_u32_u24 v60, 3072, v60
    v_add_u32 v18, v60, v18
    v_bfe_u32 v60, v0, 4, 1
    v_lshl_add_u32 v18, v60, 9, v18
    v_bfe_u32 v60, v0, 2, 1
    v_lshl_add_u32 v18, v60, 7, v18
    v_and_b32 v60, 3, v0
    v_lshl_add_u32 v18, v60, 3, v18
    v_add_u32 v18, s57, v18
    v_bfe_u32 v19, v0, 4, 1
    v_mul_u32_u24 v19, 3072, v19
    v_bfe_u32 v60, v0, 3, 1
    v_lshl_add_u32 v19, v60, 9, v19
    v_bfe_u32 v60, v0, 2, 1
    v_lshl_add_u32 v19, v60, 7, v19
    v_and_b32 v60, 3, v0
    v_lshl_add_u32 v19, v60, 3, v19
    v_add_u32 v19, s57, v19
    v_add_u32 v19, 24576, v19
    ds_read_b64_tr_b16 v[28:29], v18 offset:0
    ds_read_b64_tr_b16 v[30:31], v18 offset:256
    ds_read_b64_tr_b16 v[32:33], v18 offset:12288
    ds_read_b64_tr_b16 v[34:35], v18 offset:12544
    ds_read_b64_tr_b16 v[36:37], v19 offset:0
    ds_read_b64_tr_b16 v[38:39], v19 offset:256
    ds_read_b64_tr_b16 v[40:41], v18 offset:32
L_pad7:
    s_cbranch_execz L_pad11
    ds_read_b64_tr_b16 v[42:43], v18 offset:288
    ds_read_b64_tr_b16 v[44:45], v18 offset:12320
    ds_read_b64_tr_b16 v[46:47], v18 offset:12576
    ds_read_b64_tr_b16 v[48:49], v19 offset:32
    ds_read_b64_tr_b16 v[50:51], v19 offset:288
    v_lshrrev_b32 v9, 4, v0
    v_lshlrev_b32 v9, 5, v9
    v_bfe_u32 v60, v0, 1, 1
    v_lshl_add_u32 v9, v60, 4, v9
    v_and_b32 v60, 1, v0
    v_mul_u32_u24 v60, 192, v60
    v_add_u32 v9, v60, v9
    v_add_u32 v9, 160832, v9
    v_lshrrev_b32 v10, 4, v0
    v_lshlrev_b32 v10, 4, v10
    v_bfe_u32 v60, v0, 1, 1
    v_lshl_add_u32 v10, v60, 3, v10
    v_and_b32 v60, 1, v0
    v_mul_u32_u24 v60, 192, v60
    v_add_u32 v10, v60, v10
    v_add_u32 v10, 160960, v10
    v_mov_b64 v[20:21], 0
    v_mov_b64 v[22:23], 0
    v_mov_b64 v[24:25], 0
    v_mov_b64 v[26:27], 0
    s_lshr_b32 s57, s30, 1
    s_lshl_b32 s57, s57, 11
    s_lshl_b32 s58, s58, 1
    s_add_u32 s57, s57, s58
    s_lshl_b32 s58, s54, 8
    s_add_u32 s57, s57, s58
    v_and_b32 v11, 31, v0
    v_lshlrev_b32 v11, 2, v11
    v_lshrrev_b32 v60, 5, v0
    v_lshl_add_u32 v11, v60, 30, v11
    v_add_u32 v11, s57, v11
    s_mul_i32 s59, s53, 6144
    s_add_u32 s59, s59, s62
    s_add_u32 s59, s59, 46080
    s_lshl_b32 s60, s53, 6
    s_add_u32 s60, s60, s62
    s_add_u32 s60, s60, 25600
L_skip_180:
    s_cmp_lt_u32 s30, 6
    s_barrier
    s_cbranch_scc0 L_se_179
    ds_read_b128 v[12:15], v9
    ds_read_b64 v[16:17], v10
    s_waitcnt lgkmcnt(1)
    v_smfmac_f32_16x16x64_bf16 v[20:23], v[12:15], v[28:35], v1
    v_smfmac_f32_16x16x64_bf16 v[24:27], v[12:15], v[40:47], v1
    s_waitcnt lgkmcnt(0)
    v_smfmac_f32_16x16x32_bf16 v[20:23], v[16:17], v[36:39], v1
    v_smfmac_f32_16x16x32_bf16 v[24:27], v[16:17], v[48:51], v1
    s_cmp_eq_u32 s55, 0
    s_nop 5
    v_add_f32 v12, v20, v22
    s_nop 1
    v_add_f32_dpp v12, v24, v26 quad_perm:[0,1,2,3] row_mask:0x2 bank_mask:0xf
    v_min_u32 v12, -2, v12
    s_cbranch_scc1 L_gs_181
    buffer_store_dword v12, v11, s[40:43], s59 offen
L_gb_182:
L_se_179:
    s_sub_u32 s57, s30, 1
    s_cmp_lt_u32 s57, 3
    s_cbranch_scc0 L_qo_196
    v_and_b32 v9, 7, v0
    v_lshlrev_b32 v9, 3, v9
    buffer_load_dwordx2 v[10:11], v9, s[40:43], s60 offen sc1
    buffer_load_dwordx4 v[12:15], v7, s[40:43], s59 offen offset:0 sc1
    buffer_load_dwordx4 v[16:19], v7, s[40:43], s59 offen offset:1024 sc1
    v_mov_b64 v[24:25], 0
    v_mov_b64 v[26:27], 0
    v_mov_b64 v[28:29], 0
    v_mov_b64 v[30:31], 0
    v_mov_b64 v[32:33], 0
    v_mov_b64 v[34:35], 0
    v_mov_b64 v[36:37], 0
    v_mov_b64 v[38:39], 0
    v_mov_b64 v[40:41], 0
    v_mov_b64 v[42:43], 0
    v_mov_b64 v[44:45], 0
    v_mov_b64 v[46:47], 0
    v_lshrrev_b32 v5, 4, v0
    v_lshlrev_b32 v5, 5, v5
    v_bfe_u32 v60, v0, 1, 1
    v_lshl_add_u32 v5, v60, 4, v5
    v_add_u32 v5, 124928, v5
    v_mov_b32 v60, 0x3c75e03e
    v_mov_b32 v61, 0x3a71d1e6
    v_mov_b32 v51, 0x3e13985d
    s_branch L_pw_198
L_pr_199:
    buffer_load_dwordx2 v[10:11], v9, s[40:43], s60 offen sc1
L_pad8:
    s_cbranch_execz L_pad12
    buffer_load_dwordx4 v[12:15], v7, s[40:43], s59 offen offset:0 sc1
    buffer_load_dwordx4 v[16:19], v7, s[40:43], s59 offen offset:1024 sc1
    s_sub_u32 s56, s56, 1
    s_cbranch_scc1 L_done
L_pw_198:
    s_waitcnt vmcnt(0)
    v_max_u32 v20, v10, v11
    v_cmp_eq_u32 vcc, -1, v20
    s_cbranch_vccnz L_pr_199
    v_add_f32_dpp v48, v10, v10 row_ror:4 row_mask:0xf bank_mask:0xf
    v_add_f32_dpp v49, v11, v11 row_ror:4 row_mask:0xf bank_mask:0xf
    v_pk_add_f32 v[20:21], v[12:13], v[16:17]
    v_pk_add_f32 v[22:23], v[14:15], v[18:19]
    v_add_f32_dpp v48, v48, v48 row_ror:2 row_mask:0xf bank_mask:0xf
    v_add_f32_dpp v49, v49, v49 row_ror:2 row_mask:0xf bank_mask:0xf
    v_permlane32_swap_b32 v20, v22
    v_permlane32_swap_b32 v21, v23
    v_add_f32_dpp v48, v48, v48 row_ror:1 row_mask:0xf bank_mask:0xf
    v_add_f32_dpp v49, v49, v49 row_ror:1 row_mask:0xf bank_mask:0xf
    v_pk_add_f32 v[20:21], v[20:21], v[22:23]
    v_mul_f32 v48, v48, v60
    v_fma_f32 v49, v49, v51, v61
    v_permlane16_swap_b32 v20, v21
    v_fma_f32 v49, -v48, v48, v49
    v_add_f32 v20, v20, v21
    v_max_f32 v49, v49, v61
    v_mul_f32 v50, v6, v48
    v_rsq_f32 v49, v49
    v_cmp_u_f32 vcc, v20, v20
    v_sub_f32 v20, v20, v50
    s_cbranch_vccnz L_hr_200
L_hk_201:
    v_mul_f32 v20, v20, v49
    v_cvt_pk_bf16_f32 v20, v20, v20
    ds_write_b16 v8, v20
L_qb_197:
    s_waitcnt lgkmcnt(0)
    s_barrier
    ds_read_b128 v[12:15], v5 offset:0
    ds_read_b128 v[16:19], v5 offset:128
    ds_read_b128 v[20:23], v5 offset:256
    s_waitcnt lgkmcnt(0)
    v_smfmac_f32_16x16x64_bf16 v[24:27], v[12:15], v[64:71], v1
    v_smfmac_f32_16x16x64_bf16 v[24:27], v[16:19], v[72:79], v1
    v_smfmac_f32_16x16x64_bf16 v[24:27], v[20:23], v[80:87], v1
    v_smfmac_f32_16x16x64_bf16 v[28:31], v[12:15], v[88:95], v1
    v_smfmac_f32_16x16x64_bf16 v[28:31], v[16:19], v[96:103], v1
    v_smfmac_f32_16x16x64_bf16 v[28:31], v[20:23], v[104:111], v1
    v_smfmac_f32_16x16x64_bf16 v[32:35], v[12:15], v[112:119], v1
    v_smfmac_f32_16x16x64_bf16 v[32:35], v[16:19], v[120:127], v1
    v_smfmac_f32_16x16x64_bf16 v[32:35], v[20:23], v[128:135], v1
    v_smfmac_f32_16x16x64_bf16 v[36:39], v[12:15], v[136:143], v1
    v_smfmac_f32_16x16x64_bf16 v[36:39], v[16:19], v[144:151], v1
    v_smfmac_f32_16x16x64_bf16 v[36:39], v[20:23], v[152:159], v1
    v_add_f32 v24, v24, v26
    s_nop 0
    v_add_f32 v28, v28, v30
    s_nop 1
    v_add_f32 v32, v32, v34
    v_max3_f32 v61, v24, v28, v32
    v_mov_b32_dpp v24, v28 quad_perm:[0,1,2,3] row_mask:0x2 bank_mask:0xf
    v_add_f32 v36, v36, v38
    v_max_f32 v61, v61, v36
    v_mov_b32_dpp v24, v32 quad_perm:[0,1,2,3] row_mask:0x4 bank_mask:0xf
    s_nop 0
    v_max_f32_dpp v61, v61, v61 row_ror:8 row_mask:0xf bank_mask:0xf
    s_nop 0
    v_mov_b32_dpp v24, v36 quad_perm:[0,1,2,3] row_mask:0x8 bank_mask:0xf
    v_max_f32_dpp v61, v61, v61 row_ror:4 row_mask:0xf bank_mask:0xf
    s_nop 1
    v_max_f32_dpp v61, v61, v61 row_ror:2 row_mask:0xf bank_mask:0xf
    s_nop 1
    v_max_f32_dpp v61, v61, v61 row_ror:1 row_mask:0xf bank_mask:0xf
    v_sub_f32 v36, v24, v61
    ds_write_b32 v59, v61
    v_exp_f32 v36, v36
    s_nop 0
    v_cvt_pk_bf16_f32 v39, v36, v36
    ds_write_b16 v58, v39
    ds_read_b128 v[12:15], v52
    ds_read_b128 v[16:19], v53
    ds_read_b128 v[20:23], v54
    ds_read_b128 v[24:27], v55
    ds_read_b128 v[28:31], v56
L_pad9:
    s_cbranch_execz L_pad13
    ds_read_b128 v[32:35], v57
    v_add_f32_dpp v38, v36, v36 row_ror:8 row_mask:0xf bank_mask:0xf
    s_nop 1
    v_add_f32_dpp v38, v38, v38 row_ror:4 row_mask:0xf bank_mask:0xf
    s_nop 1
    v_add_f32_dpp v38, v38, v38 row_ror:2 row_mask:0xf bank_mask:0xf
    s_nop 1
    v_add_f32_dpp v38, v38, v38 row_ror:1 row_mask:0xf bank_mask:0xf
    s_waitcnt lgkmcnt(5)
    v_smfmac_f32_16x16x64_bf16 v[40:43], v[12:15], v[160:167], v1
    v_add_f32_dpp v38, v38, v38 row_bcast:15 row_mask:0xa bank_mask:0xf
    v_smfmac_f32_16x16x64_bf16 v[44:47], v[12:15], v[208:215], v1
    s_waitcnt lgkmcnt(4)
    v_smfmac_f32_16x16x64_bf16 v[40:43], v[16:19], v[168:175], v1
    v_add_f32_dpp v38, v38, v38 row_bcast:31 row_mask:0xc bank_mask:0xf
    v_smfmac_f32_16x16x64_bf16 v[44:47], v[16:19], v[216:223], v1
    ds_read_b32 v36, v62
    s_waitcnt lgkmcnt(4)
    v_smfmac_f32_16x16x64_bf16 v[40:43], v[20:23], v[176:183], v1
    v_smfmac_f32_16x16x64_bf16 v[44:47], v[20:23], v[224:231], v1
    s_waitcnt lgkmcnt(0)
    v_max_f32_dpp v37, v36, v36 row_ror:4 row_mask:0xf bank_mask:0xf
    v_smfmac_f32_16x16x64_bf16 v[40:43], v[24:27], v[184:191], v1
    v_smfmac_f32_16x16x64_bf16 v[44:47], v[24:27], v[232:239], v1
    v_max_f32_dpp v37, v37, v37 row_ror:2 row_mask:0xf bank_mask:0xf
    v_smfmac_f32_16x16x64_bf16 v[40:43], v[28:31], v[192:199], v1
    v_cmp_eq_u32 vcc, -1, v36
    v_smfmac_f32_16x16x64_bf16 v[44:47], v[28:31], v[240:247], v1
    v_max_f32_dpp v37, v37, v37 row_ror:1 row_mask:0xf bank_mask:0xf
    v_smfmac_f32_16x16x64_bf16 v[40:43], v[32:35], v[200:207], v1
    v_sub_f32 v39, v61, v37
    v_smfmac_f32_16x16x64_bf16 v[44:47], v[32:35], v[248:255], v1
    v_exp_f32 v39, v39
    s_cbranch_vccnz L_mr_203
L_mk_204:
    v_mul_f32 v38, v38, v39
    ds_write_b32 v63, v38 offset:1024
    s_cmp_lt_u32 s30, 2
    s_nop 0
    v_pk_add_f32 v[40:41], v[40:41], v[42:43]
    s_nop 0
    v_pk_add_f32 v[42:43], v[44:45], v[46:47]
    v_pk_mul_f32 v[40:41], v[40:41], v[38:39] op_sel:[0,1] op_sel_hi:[1,1]
    v_pk_mul_f32 v[42:43], v[42:43], v[38:39] op_sel:[0,1] op_sel_hi:[1,1]
    ds_write_b128 v63, v[40:43]
    s_cbranch_scc1 L_comb_1
    s_waitcnt lgkmcnt(0)
    s_barrier
L_comb_1b:
    s_cmp_lt_u32 s3, 20
    s_cbranch_scc0 L_typeB_1
    s_mul_i32 s74, s30, 1664
    s_add_u32 s74, s74, s62
    s_add_u32 s74, s74, 26624
    v_and_b32 v56, 7, v0
    v_lshlrev_b32 v56, 2, v56
    v_lshrrev_b32 v62, 4, v0
    v_lshlrev_b32 v62, 3, v62
    buffer_load_dword v52, v56, s[40:43], s74 offen offset:1536 sc1
    buffer_load_dwordx2 v[54:55], v62, s[40:43], s74 offen offset:1536 sc1
    v_lshlrev_b32 v57, 4, v0
    v_lshlrev_b32 v58, 3, v0
    s_mul_i32 s57, s30, 6144
    s_add_u32 s57, s57, 30720
    v_lshrrev_b32 v59, 2, v0
    v_lshlrev_b32 v59, 6, v59
    v_bfe_u32 v53, v0, 4, 1
    v_lshl_add_u32 v59, v53, 5, v59
    v_and_b32 v53, 3, v0
    v_lshl_add_u32 v59, v53, 3, v59
    v_add_u32 v59, s57, v59
    v_xor_b32 v60, 32, v59
    s_lshl_b32 s57, s30, 8
    s_add_u32 s57, s57, 157696
    v_lshl_add_u32 v61, v0, 2, s57
    ds_read_b64_tr_b16 v[28:29], v59 offset:0
    ds_read_b64_tr_b16 v[30:31], v59 offset:1024
    ds_read_b64_tr_b16 v[32:33], v59 offset:2048
    ds_read_b64_tr_b16 v[34:35], v59 offset:3072
    ds_read_b64_tr_b16 v[36:37], v59 offset:4096
    ds_read_b64_tr_b16 v[38:39], v59 offset:5120
    ds_read_b64_tr_b16 v[40:41], v60 offset:0
L_pad10:
    s_cbranch_execz L_pad14
    ds_read_b64_tr_b16 v[42:43], v60 offset:1024
    ds_read_b64_tr_b16 v[44:45], v60 offset:2048
    ds_read_b64_tr_b16 v[46:47], v60 offset:3072
    ds_read_b64_tr_b16 v[48:49], v60 offset:4096
    ds_read_b64_tr_b16 v[50:51], v60 offset:5120
    v_mov_b64 v[20:21], 0
    v_mov_b64 v[22:23], 0
    v_mov_b64 v[24:25], 0
    v_mov_b64 v[26:27], 0
    s_add_u32 s58, s6, 132096
    s_branch L_pw_211
L_pr_212:
    buffer_load_dword v52, v56, s[40:43], s74 offen offset:1536 sc1
    buffer_load_dwordx2 v[54:55], v62, s[40:43], s74 offen offset:1536 sc1
    s_sub_u32 s56, s56, 1
    s_cbranch_scc1 L_done
L_pw_211:
    s_waitcnt vmcnt(0)
    v_max3_u32 v53, v52, v54, v55
    v_cmp_eq_u32 vcc, -1, v53
    s_cbranch_vccnz L_pr_212
    buffer_load_dwordx4 v[12:15], v57, s[40:43], s74 offen sc1
    buffer_load_dwordx2 v[16:17], v58, s[40:43], s74 offen offset:1024 sc1
    buffer_load_dword v18, v56, s[40:43], s74 offen offset:1568 sc1
    v_max_f32_dpp v53, v52, v52 row_ror:4 row_mask:0xf bank_mask:0xf
    s_nop 1
    v_max_f32_dpp v53, v53, v53 row_ror:2 row_mask:0xf bank_mask:0xf
    s_nop 1
    v_max_f32_dpp v53, v53, v53 row_ror:1 row_mask:0xf bank_mask:0xf
    v_sub_f32 v52, v52, v53
    v_sub_f32 v54, v54, v53
    v_sub_f32 v55, v55, v53
    v_exp_f32 v52, v52
    v_exp_f32 v54, v54
    v_exp_f32 v55, v55
    s_waitcnt lgkmcnt(0)
    s_branch L_pw_213
L_pr_214:
    buffer_load_dwordx4 v[12:15], v57, s[40:43], s74 offen sc1
    buffer_load_dwordx2 v[16:17], v58, s[40:43], s74 offen offset:1024 sc1
    buffer_load_dword v18, v56, s[40:43], s74 offen offset:1568 sc1
    s_sub_u32 s56, s56, 1
    s_cbranch_scc1 L_done
L_pw_213:
    s_waitcnt vmcnt(0)
    v_max3_u32 v19, v12, v13, v14
    v_max3_u32 v19, v19, v15, v16
    v_max3_u32 v19, v19, v17, v18
    v_cmp_eq_u32 vcc, -1, v19
    s_cbranch_vccnz L_pr_214
    v_smfmac_f32_16x16x64_bf16 v[20:23], v[12:15], v[28:35], v1
    v_mul_f32 v52, v52, v18
    v_smfmac_f32_16x16x64_bf16 v[24:27], v[12:15], v[40:47], v1
    v_smfmac_f32_16x16x32_bf16 v[20:23], v[16:17], v[36:39], v1
    v_add_f32_dpp v52, v52, v52 row_ror:4 row_mask:0xf bank_mask:0xf
    v_smfmac_f32_16x16x32_bf16 v[24:27], v[16:17], v[48:51], v1
    s_cmp_eq_u32 s30, 2
    v_add_f32_dpp v52, v52, v52 row_ror:2 row_mask:0xf bank_mask:0xf
    s_nop 1
    v_add_f32_dpp v52, v52, v52 row_ror:1 row_mask:0xf bank_mask:0xf
    v_rcp_f32 v52, v52
    v_pk_add_f32 v[20:21], v[20:21], v[22:23]
    s_nop 0
    v_pk_add_f32 v[24:25], v[24:25], v[26:27]
    v_pk_mul_f32 v[54:55], v[54:55], v[52:53] op_sel:[0,0] op_sel_hi:[1,0]
    v_mul_f32 v20, v20, v54
    v_mul_f32 v24, v24, v54
    v_fmac_f32 v20, v21, v55
    v_fmac_f32 v24, v25, v55
    s_nop 1
    v_permlane32_swap_b32 v20, v24
    v_add_f32 v20, v20, v24
    ds_write_b32 v61, v20
    s_waitcnt lgkmcnt(0)
    s_barrier
    s_cbranch_scc0 L_finb_215
    ds_read2st64_b32 v[12:13], v2 offset0:0 offset1:1
    ds_read2st64_b32 v[14:15], v2 offset0:2 offset1:3
    ds_read2st64_b32 v[16:17], v2 offset0:4 offset1:5
    ds_read2st64_b32 v[18:19], v2 offset0:6 offset1:7
    s_waitcnt lgkmcnt(2)
    v_pk_add_f32 v[12:13], v[12:13], v[14:15]
    s_waitcnt lgkmcnt(0)
    v_pk_add_f32 v[16:17], v[16:17], v[18:19]
    v_pk_add_f32 v[12:13], v[12:13], v[16:17]
    v_add_f32 v14, v12, v13
    v_add_f32 v15, v12, v13
    s_nop 1
    v_permlane16_swap_b32 v14, v15
    v_add_f32 v12, v14, v15
    v_min_u32 v12, -2, v12
    buffer_store_dword v12, v3, s[40:43], s58 offen sc1
L_finb_215:
L_pad11:
    s_cbranch_execz L_pad15
    s_sub_u32 s57, s30, 4
    s_cmp_lt_u32 s57, 3
    s_cbranch_scc0 L_skip_216
    s_sub_u32 s60, s30, 4
    s_lshl_b32 s57, s60, 11
    v_lshlrev_b32 v11, 4, v0
    v_add_u32 v11, s57, v11
    s_add_u32 s65, s62, 19456
    buffer_load_dwordx4 v[52:55], v11, s[40:43], s65 offen offset:0 sc1
    buffer_load_dwordx4 v[56:59], v11, s[40:43], s65 offen offset:1024 sc1
    s_lshl_b32 s59, s60, 12
    s_add_u32 s59, s59, 79872
    v_bfe_u32 v35, v0, 4, 1
    v_lshlrev_b32 v35, 11, v35
    v_bfe_u32 v60, v0, 2, 2
    v_lshl_add_u32 v35, v60, 8, v35
    v_lshrrev_b32 v60, 5, v0
    v_lshl_add_u32 v35, v60, 6, v35
    v_and_b32 v60, 3, v0
    v_lshl_add_u32 v35, v60, 3, v35
    v_add_u32 v35, s59, v35
    v_mov_b32 v9, 0xbdd2d3e8
    v_mov_b32 v10, 0xc0135761
    s_lshl_b32 s57, s60, 7
    s_add_u32 s57, s57, 160256
    v_lshlrev_b32 v32, 3, v0
    v_add_u32 v32, s57, v32
    v_lshlrev_b32 v33, 3, v0
    v_add_u32 v33, 129024, v33
    v_cmp_gt_u32 vcc, 16, v0
    s_nop 1
    v_cndmask_b32 v32, v33, v32, vcc
    v_and_b32 v33, 15, v0
    v_lshlrev_b32 v33, 3, v33
    v_lshrrev_b32 v60, 5, v0
    v_lshl_add_u32 v33, v60, 2, v33
    v_add_u32 v33, 160256, v33
    v_and_b32 v34, 15, v0
    v_lshlrev_b32 v34, 2, v34
    v_lshrrev_b32 v60, 5, v0
    v_lshl_add_u32 v34, v60, 6, v34
    v_bfe_u32 v60, v0, 4, 1
    v_lshl_add_u32 v34, v60, 13, v34
    s_add_u32 s60, s6, 198144
    s_add_u32 s58, s62, 39936
    s_add_u32 s57, s62, 25984
    v_and_b32 v7, 7, v0
    v_lshlrev_b32 v7, 3, v7
    v_mov_b32 v60, 0x3acccccd
    v_mov_b32 v61, 0x3727c5ac
    s_waitcnt vmcnt(0)
    buffer_load_dwordx2 v[24:25], v7, s[40:43], s57 offen sc1
    buffer_load_dwordx4 v[12:15], v11, s[40:43], s58 offen offset:0 sc1
    buffer_load_dwordx4 v[16:19], v11, s[40:43], s58 offen offset:1024 sc1
    ds_read_b64_tr_b16 v[36:37], v35 offset:0
    ds_read_b64_tr_b16 v[38:39], v35 offset:1024
    ds_read_b64_tr_b16 v[40:41], v35 offset:128
    ds_read_b64_tr_b16 v[42:43], v35 offset:1152
    ds_read_b64_tr_b16 v[44:45], v35 offset:32
    ds_read_b64_tr_b16 v[46:47], v35 offset:1056
    ds_read_b64_tr_b16 v[48:49], v35 offset:160
    ds_read_b64_tr_b16 v[50:51], v35 offset:1184
L_sw_219:
    v_max3_u32 v20, v52, v53, v54
    v_max3_u32 v20, v20, v55, v56
    v_max3_u32 v20, v20, v57, v58
    v_max_u32 v20, v20, v59
    v_cmp_eq_u32 vcc, -1, v20
    s_cbranch_vccnz L_sr_220
    v_pk_add_f32 v[28:29], v[52:53], v[56:57]
    v_pk_add_f32 v[30:31], v[54:55], v[58:59]
    s_nop 1
    v_permlane32_swap_b32 v28, v30
    v_permlane32_swap_b32 v29, v31
    v_pk_add_f32 v[28:29], v[28:29], v[30:31]
    s_nop 1
    v_permlane16_swap_b32 v28, v29
    v_add_f32 v28, v28, v29
    v_mov_b64 v[52:53], 0
    v_mov_b64 v[54:55], 0
    v_mov_b64 v[56:57], 0
    v_mov_b64 v[58:59], 0
    s_waitcnt lgkmcnt(0)
L_pr_218:
    buffer_load_dwordx2 v[24:25], v7, s[40:43], s57 offen sc1
    buffer_load_dwordx4 v[12:15], v11, s[40:43], s58 offen offset:0 sc1
L_pad12:
    s_cbranch_execz L_pad16
    buffer_load_dwordx4 v[16:19], v11, s[40:43], s58 offen offset:1024 sc1
    s_sub_u32 s56, s56, 1
    s_cbranch_scc1 L_done
L_pw_217:
    s_waitcnt vmcnt(3)
    v_max_u32 v20, v24, v25
    v_cmp_eq_u32 vcc, -1, v20
    s_cbranch_vccnz L_pr_218
    buffer_load_dwordx4 v[12:15], v11, s[40:43], s58 offen offset:0 sc1
    buffer_load_dwordx4 v[16:19], v11, s[40:43], s58 offen offset:1024 sc1
    v_add_f32_dpp v2, v24, v24 row_ror:4 row_mask:0xf bank_mask:0xf
    v_add_f32_dpp v3, v25, v25 row_ror:4 row_mask:0xf bank_mask:0xf
    v_pk_add_f32 v[20:21], v[12:13], v[16:17]
    v_pk_add_f32 v[22:23], v[14:15], v[18:19]
    v_add_f32_dpp v2, v2, v2 row_ror:2 row_mask:0xf bank_mask:0xf
    v_add_f32_dpp v3, v3, v3 row_ror:2 row_mask:0xf bank_mask:0xf
    v_permlane32_swap_b32 v20, v22
    v_permlane32_swap_b32 v21, v23
    v_add_f32_dpp v2, v2, v2 row_ror:1 row_mask:0xf bank_mask:0xf
    v_add_f32_dpp v3, v3, v3 row_ror:1 row_mask:0xf bank_mask:0xf
    v_pk_add_f32 v[20:21], v[20:21], v[22:23]
    v_mul_f32 v2, v2, v60
    v_fma_f32 v3, v3, v60, v61
    v_permlane16_swap_b32 v20, v21
    v_fma_f32 v3, -v2, v2, v3
    v_add_f32 v20, v20, v21
    v_max_f32 v3, v3, v61
    v_mul_f32 v26, v28, v2
    v_rsq_f32 v3, v3
    v_cmp_u_f32 vcc, v20, v20
    v_sub_f32 v20, v20, v26
    s_cbranch_vccnz L_hr_221
L_hk_222:
    v_fma_f32 v20, v20, v3, v4
    v_mul_f32 v21, v20, v20
    v_fma_f32 v21, v21, v9, v10
    v_mul_f32 v21, v21, v20
    v_exp_f32 v21, v21
    s_nop 0
    v_add_f32 v21, 1.0, v21
    v_rcp_f32 v21, v21
    s_nop 0
    v_mul_f32 v20, v20, v21
    s_nop 1
    v_mov_b32_dpp v21, v20 row_shl:1 row_mask:0xf bank_mask:0xf bound_ctrl:0
    v_cvt_pk_bf16_f32 v28, v20, v21
    s_nop 1
    v_mov_b32_dpp v29, v28 row_shl:4 row_mask:0xf bank_mask:0xf bound_ctrl:0
    v_mov_b32_dpp v30, v28 row_shl:8 row_mask:0xf bank_mask:0xf bound_ctrl:0
    v_mov_b32_dpp v31, v28 row_shl:12 row_mask:0xf bank_mask:0xf bound_ctrl:0
    s_nop 1
    v_smfmac_f32_16x16x64_bf16 v[52:55], v[28:31], v[36:43], v1
    v_smfmac_f32_16x16x64_bf16 v[56:59], v[28:31], v[44:51], v1
    s_cmp_eq_u32 s30, 4
    s_nop 5
    v_add_f32 v22, v52, v54
    v_add_f32 v23, v56, v58
    ds_write_b64 v32, v[22:23]
    s_cbranch_scc0 L_skip_224
L_xw_225:
    ds_read2_b32 v[20:21], v33 offset0:0 offset1:32
    ds_read_b32 v22, v33 offset:256
    s_sub_u32 s56, s56, 1
    s_cbranch_scc1 L_done
    s_waitcnt lgkmcnt(0)
    v_max3_u32 v23, v20, v21, v22
    v_add_f32 v20, v20, v21
    v_cmp_eq_u32 vcc, -1, v23
    v_add_f32 v20, v20, v22
    s_cbranch_vccnz L_xw_225
    v_min_u32 v20, -2, v20
    buffer_store_dword v20, v34, s[40:43], s60 offen sc1
L_skip_224:
L_skip_216:
    s_branch L_done
L_typeB_1:
    s_cmp_eq_u32 s53, 3
    s_cbranch_scc0 L_typeC_226
    s_cmp_eq_u32 s30, 7
    s_cbranch_scc1 L_w7_231
    s_cmp_lt_u32 s30, 6
    s_cbranch_scc0 L_skip_233
    s_lshr_b32 s57, s30, 1
    s_mul_i32 s57, s57, 128
    s_and_b32 s58, s30, 1
    s_lshl_b32 s58, s58, 6
    s_add_u32 s57, s57, s58
    v_lshrrev_b32 v18, 5, v0
    v_lshlrev_b32 v18, 13, v18
    v_bfe_u32 v60, v0, 3, 1
    v_lshl_add_u32 v18, v60, 12, v18
    v_bfe_u32 v60, v0, 4, 1
    v_lshl_add_u32 v18, v60, 11, v18
    v_bfe_u32 v60, v0, 2, 1
    v_mul_u32_u24 v60, 384, v60
    v_add_u32 v18, v60, v18
    v_and_b32 v60, 3, v0
    v_lshl_add_u32 v18, v60, 3, v18
L_pad13:
    s_cbranch_execz L_pad17
    v_add_u32 v18, s57, v18
    v_add_u32 v18, 30720, v18
    v_bfe_u32 v19, v0, 4, 1
    v_lshlrev_b32 v19, 12, v19
    v_bfe_u32 v60, v0, 3, 1
    v_lshl_add_u32 v19, v60, 11, v19
    v_bfe_u32 v60, v0, 2, 1
    v_mul_u32_u24 v60, 384, v60
    v_add_u32 v19, v60, v19
    v_and_b32 v60, 3, v0
    v_lshl_add_u32 v19, v60, 3, v19
    v_add_u32 v19, s57, v19
    v_add_u32 v19, 63488, v19
    ds_read_b64_tr_b16 v[28:29], v18 offset:0
    ds_read_b64_tr_b16 v[30:31], v18 offset:1024
    ds_read_b64_tr_b16 v[32:33], v18 offset:16384
    ds_read_b64_tr_b16 v[34:35], v18 offset:17408
    ds_read_b64_tr_b16 v[36:37], v19 offset:0
    ds_read_b64_tr_b16 v[38:39], v19 offset:1024
    ds_read_b64_tr_b16 v[40:41], v18 offset:32
    ds_read_b64_tr_b16 v[42:43], v18 offset:1056
    ds_read_b64_tr_b16 v[44:45], v18 offset:16416
    ds_read_b64_tr_b16 v[46:47], v18 offset:17440
    ds_read_b64_tr_b16 v[48:49], v19 offset:32
    ds_read_b64_tr_b16 v[50:51], v19 offset:1056
    v_lshrrev_b32 v9, 4, v0
    v_lshlrev_b32 v9, 5, v9
    v_bfe_u32 v60, v0, 1, 1
    v_lshl_add_u32 v9, v60, 4, v9
    v_and_b32 v60, 1, v0
    v_mul_u32_u24 v60, 192, v60
    v_add_u32 v9, v60, v9
    v_add_u32 v9, 160832, v9
    v_lshrrev_b32 v10, 4, v0
    v_lshlrev_b32 v10, 4, v10
    v_bfe_u32 v60, v0, 1, 1
    v_lshl_add_u32 v10, v60, 3, v10
    v_and_b32 v60, 1, v0
    v_mul_u32_u24 v60, 192, v60
    v_add_u32 v10, v60, v10
    v_add_u32 v10, 160960, v10
    v_mov_b64 v[20:21], 0
    v_mov_b64 v[22:23], 0
    v_mov_b64 v[24:25], 0
    v_mov_b64 v[26:27], 0
    s_lshr_b32 s57, s30, 1
    s_lshl_b32 s57, s57, 11
    s_lshl_b32 s58, s58, 1
    s_add_u32 s57, s57, s58
    s_lshl_b32 s58, s54, 8
    s_add_u32 s57, s57, s58
    v_and_b32 v11, 31, v0
    v_lshlrev_b32 v11, 2, v11
    v_lshrrev_b32 v60, 5, v0
    v_lshl_add_u32 v11, v60, 30, v11
    v_add_u32 v11, s57, v11
    s_add_u32 s59, s62, 39936
    s_add_u32 s60, s62, 25984
L_skip_233:
    s_cmp_lt_u32 s30, 6
    s_barrier
    s_cbranch_scc0 L_se_232
    ds_read_b128 v[12:15], v9
    ds_read_b64 v[16:17], v10
    s_waitcnt lgkmcnt(1)
    v_smfmac_f32_16x16x64_bf16 v[20:23], v[12:15], v[28:35], v1
    v_smfmac_f32_16x16x64_bf16 v[24:27], v[12:15], v[40:47], v1
    s_waitcnt lgkmcnt(0)
    v_smfmac_f32_16x16x32_bf16 v[20:23], v[16:17], v[36:39], v1
    v_smfmac_f32_16x16x32_bf16 v[24:27], v[16:17], v[48:51], v1
    s_cmp_eq_u32 s55, 0
    s_nop 5
    v_add_f32 v12, v20, v22
    s_nop 1
    v_add_f32_dpp v12, v24, v26 quad_perm:[0,1,2,3] row_mask:0x2 bank_mask:0xf
    v_min_u32 v12, -2, v12
    s_cbranch_scc1 L_gs_234
    buffer_store_dword v12, v11, s[40:43], s59 offen
L_gb_235:
L_se_232:
    s_cmp_eq_u32 s30, 7
    s_cbranch_scc0 L_done
    s_cmp_eq_u32 s31, 0
    s_cbranch_scc0 L_done
    v_lshlrev_b32 v60, 16, v4
    v_add_f32 v2, v2, v60
    v_and_b32 v60, 0xffff0000, v4
    v_add_f32 v3, v3, v60
    v_and_b32 v60, 31, v0
L_pad14:
    s_cbranch_execz L_pad18
    v_min_u32 v60, 19, v60
    s_mul_i32 s57, s54, 160
    v_lshrrev_b32 v7, 5, v0
    v_lshlrev_b32 v7, 2, v7
    v_add_u32 v7, s57, v7
    v_lshl_add_u32 v7, v60, 3, v7
    s_add_u32 s57, s7, 198144
    s_add_u32 s58, s7, 214528
    s_add_u32 s59, s7, 230912
    s_add_u32 s60, s7, 247296
    s_add_u32 s75, s7, 266252
    v_and_b32 v9, 7, v0
    v_lshlrev_b32 v9, 9, v9
    buffer_load_dword v12, v9, s[40:43], s75 offen sc1
    s_sleep 2
L_pr_247:
    buffer_load_dword v12, v9, s[40:43], s75 offen sc1
    s_sub_u32 s56, s56, 1
    s_cbranch_scc1 L_done
L_pw_246:
    s_waitcnt vmcnt(1)
    v_cmp_eq_u32 vcc, -1, v12
    s_cbranch_vccnz L_pr_247
    s_sleep 2
    buffer_load_dwordx4 v[12:15], v5, s[40:43], s57 offen sc1
    buffer_load_dwordx4 v[16:19], v5, s[40:43], s58 offen sc1
    buffer_load_dwordx4 v[20:23], v5, s[40:43], s59 offen sc1
    buffer_load_dwordx4 v[24:27], v5, s[40:43], s60 offen sc1
    s_sleep 2
L_gw_243:
    buffer_load_dwordx4 v[12:15], v5, s[40:43], s57 offen sc1
    buffer_load_dwordx4 v[16:19], v5, s[40:43], s58 offen sc1
    buffer_load_dwordx4 v[20:23], v5, s[40:43], s59 offen sc1
    buffer_load_dwordx4 v[24:27], v5, s[40:43], s60 offen sc1
    s_sub_u32 s56, s56, 1
    s_cbranch_scc1 L_done
    s_and_b32 s74, s56, 31
    s_waitcnt vmcnt(6)
    v_pk_add_f32 v[28:29], v[12:13], v[16:17]
    v_pk_add_f32 v[30:31], v[14:15], v[18:19]
    s_waitcnt vmcnt(5)
    v_pk_add_f32 v[28:29], v[28:29], v[20:21]
    v_pk_add_f32 v[30:31], v[30:31], v[22:23]
    s_waitcnt vmcnt(4)
    v_pk_add_f32 v[28:29], v[28:29], v[24:25]
    v_pk_add_f32 v[30:31], v[30:31], v[26:27]
    v_pk_add_f32 v[32:33], v[28:29], v[30:31]
    v_cmp_u_f32 vcc, v32, v33
    v_permlane32_swap_b32 v28, v30
    v_permlane32_swap_b32 v29, v31
    s_cbranch_vccnz L_gr_244
L_gk_245:
    v_pk_add_f32 v[28:29], v[28:29], v[30:31]
    v_pk_add_f32 v[28:29], v[28:29], v[2:3]
    v_cvt_pk_bf16_f32 v28, v28, v29
    global_store_dword v7, v28, s[24:25]
    s_branch L_done
L_gs_39:
    buffer_store_dword v33, v34, s[40:43], s67 offen sc1
    s_branch L_gb_40
L_gs_42:
    buffer_store_dword v12, v54, s[40:43], s59 offen sc1
    s_branch L_gb_43
L_cr_57:
    s_sub_u32 s56, s56, 1
    s_cbranch_scc1 L_done
    global_load_dword v2, v3, s[26:27] sc1
    s_waitcnt vmcnt(0)
    s_branch L_cw_56
L_far_58:
    s_lshl_b32 s57, s52, 2
    s_add_u32 s57, s57, s72
    s_mov_b64 exec, 1
    buffer_store_dword v25, v0, s[40:43], s57 offen offset:128 sc1
    s_mov_b64 exec, -1
    s_branch L_fb_59
L_cr_75:
    s_sub_u32 s56, s56, 1
    s_cbranch_scc1 L_done
    buffer_load_dword v2, v24, s[40:43], s72 offen sc1
    s_branch L_cw_74
L_gs_83:
    buffer_store_dword v33, v34, s[40:43], s67 offen sc1
    s_branch L_gb_84
L_gs_86:
    buffer_store_dword v12, v54, s[40:43], s59 offen sc1
    s_branch L_gb_87
L_gs_106:
    buffer_store_dword v37, v4, s[40:43], s58 offen sc1
    s_branch L_gb_107
L_cr_120:
    s_sub_u32 s56, s56, 1
    s_cbranch_scc1 L_done
    global_load_dword v2, v3, s[26:27] offset:4 sc1
    s_branch L_cw_119
L_cr_130:
    buffer_load_dword v52, v56, s[40:43], s74 offen offset:1536 sc1
    buffer_load_dwordx2 v[54:55], v62, s[40:43], s74 offen offset:1536 sc1
    s_sub_u32 s56, s56, 1
    s_cbranch_scc1 L_done
    s_branch L_cw_129
L_gs_135:
    buffer_store_dword v14, v3, s[40:43], s57 offen sc1
L_pad15:
    s_cbranch_execz L_pad19
    s_branch L_gb_136
L_gs_137:
    buffer_store_dword v12, v4, s[40:43], s57 offen offset:32 sc1
    s_branch L_gb_138
L_comb_0:
    s_mov_b32 s57, 0
    s_cmp_eq_u32 s55, 0
    s_waitcnt lgkmcnt(0)
    s_barrier
    ds_read2st64_b64 v[12:15], v2 offset0:0 offset1:4
    ds_read2st64_b64 v[16:19], v2 offset0:8 offset1:12
    ds_read2st64_b64 v[20:23], v2 offset0:16 offset1:20
    ds_read2st64_b64 v[24:27], v2 offset0:24 offset1:28
    s_waitcnt lgkmcnt(2)
    v_pk_add_f32 v[12:13], v[12:13], v[14:15]
    v_pk_add_f32 v[16:17], v[16:17], v[18:19]
    v_pk_add_f32 v[12:13], v[12:13], v[16:17]
    s_waitcnt lgkmcnt(0)
    v_pk_add_f32 v[20:21], v[20:21], v[22:23]
    v_pk_add_f32 v[24:25], v[24:25], v[26:27]
    v_pk_add_f32 v[12:13], v[12:13], v[20:21]
    v_pk_add_f32 v[12:13], v[12:13], v[24:25]
    v_cvt_pk_bf16_f32 v14, v12, v13
    v_min_u32 v12, -2, v12
    v_min_u32 v14, -2, v14
    s_cbranch_scc1 L_gs_135
    buffer_store_dword v14, v3, s[40:43], s57 offen
L_gb_136:
    s_cbranch_scc1 L_gs_137
    buffer_store_dword v12, v4, s[40:43], s57 offen offset:32
L_gb_138:
    s_branch L_comb_0b
L_sr_147:
    buffer_load_dwordx4 v[52:55], v11, s[40:43], s65 offen offset:0 sc1
    buffer_load_dwordx4 v[56:59], v11, s[40:43], s65 offen offset:1024 sc1
    s_sub_u32 s56, s56, 1
    s_cbranch_scc1 L_done
    s_waitcnt vmcnt(0)
    s_branch L_sw_146
L_hr_148:
    buffer_load_dwordx4 v[12:15], v11, s[40:43], s58 offen offset:0 sc1
    buffer_load_dwordx4 v[16:19], v11, s[40:43], s58 offen offset:1024 sc1
    s_sub_u32 s56, s56, 1
    s_cbranch_scc1 L_done
    s_and_b32 s64, s56, 31
    s_cbranch_scc0 L_hx_150
    s_waitcnt vmcnt(2)
    v_pk_add_f32 v[20:21], v[12:13], v[16:17]
    v_pk_add_f32 v[22:23], v[14:15], v[18:19]
    s_nop 1
    v_permlane32_swap_b32 v20, v22
    v_permlane32_swap_b32 v21, v23
    v_pk_add_f32 v[20:21], v[20:21], v[22:23]
    s_nop 1
    v_permlane16_swap_b32 v20, v21
    v_add_f32 v20, v20, v21
    v_cmp_u_f32 vcc, v20, v20
    v_sub_f32 v20, v20, v26
    s_cbranch_vccnz L_hr_148
    s_branch L_hk_149
L_hx_150:
    s_waitcnt vmcnt(0)
    v_max3_u32 v20, v12, v13, v14
    v_max3_u32 v20, v20, v15, v16
    v_max3_u32 v20, v20, v17, v18
    v_max_u32 v20, v20, v19
    v_cmp_eq_u32 vcc, -1, v20
    s_cbranch_vccnz L_hr_148
    v_pk_add_f32 v[20:21], v[12:13], v[16:17]
    v_pk_add_f32 v[22:23], v[14:15], v[18:19]
    s_nop 1
    v_permlane32_swap_b32 v20, v22
    v_permlane32_swap_b32 v21, v23
    v_pk_add_f32 v[20:21], v[20:21], v[22:23]
    s_nop 1
    v_permlane16_swap_b32 v20, v21
    v_add_f32 v20, v20, v21
    v_sub_f32 v20, v20, v26
    s_branch L_hk_149
L_gs_158:
    buffer_store_dword v0, v11, s[40:43], s58 offen sc1
    s_branch L_gb_159
L_typeC_154:
    s_cmp_eq_u32 s30, 6
    s_cbranch_scc0 L_p1
    s_cmp_eq_u32 s3, 21
    s_cbranch_scc0 L_skip_155
    v_and_b32 v11, 3, v0
    v_lshlrev_b32 v11, 7, v11
    v_lshrrev_b32 v60, 2, v0
    v_lshl_add_u32 v11, v60, 24, v11
    s_add_u32 s58, s62, 26116
    s_add_u32 s75, s7, 266244
    v_and_b32 v9, 7, v0
    v_lshlrev_b32 v9, 9, v9
    buffer_load_dword v12, v9, s[40:43], s75 offen sc1
    s_sleep 2
L_pr_157:
    buffer_load_dword v12, v9, s[40:43], s75 offen sc1
    s_sub_u32 s56, s56, 1
    s_cbranch_scc1 L_done
L_pw_156:
    s_waitcnt vmcnt(1)
L_pad16:
    s_cbranch_execz L_pad20
    v_cmp_eq_u32 vcc, -1, v12
    s_cbranch_vccnz L_pr_157
    s_cmp_eq_u32 s55, 0
    s_cbranch_scc1 L_gs_158
    buffer_store_dword v0, v11, s[40:43], s58 offen
L_gb_159:
    s_waitcnt vmcnt(1)
    s_branch L_p1
L_skip_155:
    s_cmp_eq_u32 s3, 20
    s_cbranch_scc0 L_p1
    s_lshl_b32 s59, s31, 9
    s_add_u32 s59, s59, s8
    s_add_u32 s59, s59, 266240
    v_and_b32 v10, 1, v0
    v_lshlrev_b32 v10, 13, v10
    v_lshrrev_b32 v60, 1, v0
    v_lshl_add_u32 v10, v60, 24, v10
    s_add_u32 s58, s62, 1568
    v_lshrrev_b32 v9, 3, v0
    v_mul_u32_u24 v9, 1664, v9
    v_and_b32 v60, 7, v0
    v_lshl_add_u32 v9, v60, 2, v9
    buffer_load_dword v12, v9, s[40:43], s58 offen sc1
    s_sleep 2
L_pr_161:
    buffer_load_dword v12, v9, s[40:43], s58 offen sc1
    s_sub_u32 s56, s56, 1
    s_cbranch_scc1 L_done
L_pw_160:
    s_waitcnt vmcnt(1)
    v_cmp_eq_u32 vcc, -1, v12
    s_cbranch_vccnz L_pr_161
    buffer_store_dword v0, v10, s[40:43], s59 offen offset:0 sc1
    s_add_u32 s58, s62, 25856
    v_and_b32 v9, 15, v0
    v_lshlrev_b32 v9, 2, v9
    buffer_load_dword v13, v9, s[40:43], s58 offen sc1
    s_sleep 2
L_pr_163:
    buffer_load_dword v13, v9, s[40:43], s58 offen sc1
    s_sub_u32 s56, s56, 1
    s_cbranch_scc1 L_done
L_pw_162:
    s_waitcnt vmcnt(1)
    v_cmp_eq_u32 vcc, -1, v13
    s_cbranch_vccnz L_pr_163
    buffer_store_dword v0, v10, s[40:43], s59 offen offset:4 sc1
    s_waitcnt vmcnt(1)
    s_branch L_p1
L_gs_167:
    buffer_store_dword v12, v11, s[40:43], s60 offen sc1
    s_branch L_gb_168
L_gs_169:
    buffer_store_dword v12, v11, s[40:43], s59 offen sc1
    s_branch L_gb_170
L_gr_172:
    s_cbranch_scc1 L_gw_171
    s_waitcnt vmcnt(0)
    v_max3_u32 v32, v12, v13, v14
    v_max3_u32 v32, v32, v15, v16
    v_max3_u32 v32, v32, v17, v18
    v_max3_u32 v32, v32, v19, v20
    v_max3_u32 v32, v32, v21, v22
    v_max3_u32 v32, v32, v23, v24
    v_max3_u32 v32, v32, v25, v26
    v_max_u32 v32, v32, v27
    v_cmp_eq_u32 vcc, -1, v32
    s_cbranch_vccnz L_gw_171
    v_pk_add_f32 v[28:29], v[12:13], v[16:17]
    v_pk_add_f32 v[30:31], v[14:15], v[18:19]
    v_pk_add_f32 v[28:29], v[28:29], v[20:21]
    v_pk_add_f32 v[30:31], v[30:31], v[22:23]
    v_pk_add_f32 v[28:29], v[28:29], v[24:25]
    v_pk_add_f32 v[30:31], v[30:31], v[26:27]
    s_nop 1
    v_permlane32_swap_b32 v28, v30
    v_permlane32_swap_b32 v29, v31
    s_branch L_gk_173
L_gs_176:
    buffer_store_dword v33, v34, s[40:43], s67 offen sc1
    s_branch L_gb_177
L_w7_164:
    v_and_b32 v60, 31, v0
    v_min_u32 v60, 19, v60
    s_mul_i32 s57, s54, 320
    v_lshrrev_b32 v5, 5, v0
    v_lshlrev_b32 v5, 12, v5
    v_add_u32 v5, s57, v5
    v_lshl_add_u32 v5, v60, 4, v5
    v_and_b32 v60, 31, v0
    v_cmp_gt_u32 s[64:65], 20, v60
    v_min_u32 v60, 19, v60
    v_lshrrev_b32 v35, 5, v0
    v_lshlrev_b32 v35, 2, v35
    v_add_u32 v35, 160832, v35
    v_lshl_add_u32 v35, v60, 3, v35
    s_add_u32 s66, s62, 13312
    s_add_u32 s67, s62, 25856
    s_lshl_b32 s57, s54, 3
    v_lshrrev_b32 v34, 5, v0
    v_lshlrev_b32 v34, 2, v34
L_pad17:
    s_cbranch_execz L_pad21
    v_add_u32 v34, s57, v34
    v_and_b32 v60, 31, v0
    v_mov_b32 v61, 0x7f000000
    v_cmp_ne_u32 vcc, 31, v60
    s_nop 1
    v_cndmask_b32 v34, v34, v61, vcc
    v_mov_b32 v61, 0x3f803f80
    s_add_u32 s57, s7, 0
    s_add_u32 s58, s7, 16384
    s_add_u32 s59, s7, 32768
    s_add_u32 s60, s7, 49152
    s_add_u32 s75, s7, 266240
    v_and_b32 v9, 7, v0
    v_lshlrev_b32 v9, 9, v9
    buffer_load_dword v12, v9, s[40:43], s75 offen sc1
    s_sleep 2
L_pr_175:
    buffer_load_dword v12, v9, s[40:43], s75 offen sc1
    s_sub_u32 s56, s56, 1
    s_cbranch_scc1 L_done
L_pw_174:
    s_waitcnt vmcnt(1)
    v_cmp_eq_u32 vcc, -1, v12
    s_cbranch_vccnz L_pr_175
    s_sleep 1
    buffer_load_dwordx4 v[12:15], v5, s[40:43], s57 offen sc1
    buffer_load_dwordx4 v[16:19], v5, s[40:43], s58 offen sc1
    buffer_load_dwordx4 v[20:23], v5, s[40:43], s59 offen sc1
    buffer_load_dwordx4 v[24:27], v5, s[40:43], s60 offen sc1
    s_sleep 2
L_gw_171:
    buffer_load_dwordx4 v[12:15], v5, s[40:43], s57 offen sc1
    buffer_load_dwordx4 v[16:19], v5, s[40:43], s58 offen sc1
    buffer_load_dwordx4 v[20:23], v5, s[40:43], s59 offen sc1
    buffer_load_dwordx4 v[24:27], v5, s[40:43], s60 offen sc1
    s_sub_u32 s56, s56, 1
    s_cbranch_scc1 L_done
    s_and_b32 s74, s56, 31
    s_waitcnt vmcnt(6)
    v_pk_add_f32 v[28:29], v[12:13], v[16:17]
    v_pk_add_f32 v[30:31], v[14:15], v[18:19]
    s_waitcnt vmcnt(5)
    v_pk_add_f32 v[28:29], v[28:29], v[20:21]
    v_pk_add_f32 v[30:31], v[30:31], v[22:23]
    s_waitcnt vmcnt(4)
    v_pk_add_f32 v[28:29], v[28:29], v[24:25]
    v_pk_add_f32 v[30:31], v[30:31], v[26:27]
    v_pk_add_f32 v[32:33], v[28:29], v[30:31]
    v_cmp_u_f32 vcc, v32, v33
    v_permlane32_swap_b32 v28, v30
    v_permlane32_swap_b32 v29, v31
    s_cbranch_vccnz L_gr_172
L_gk_173:
    v_pk_add_f32 v[28:29], v[28:29], v[30:31]
    v_pk_add_f32 v[28:29], v[28:29], v[2:3]
    v_cvt_pk_bf16_f32 v28, v28, v29
    ds_write_b32 v35, v28
    s_waitcnt lgkmcnt(0)
    s_barrier
    v_cndmask_b32 v29, 0, v28, s[64:65]
    v_dot2_f32_bf16 v33, v29, v61, 0
    v_dot2_f32_bf16 v32, v29, v29, 0
    v_lshlrev_b32 v2, 16, v28
    v_and_b32 v3, 0xffff0000, v28
    s_cmp_eq_u32 s55, 0
    v_permlane32_swap_b32 v33, v32
    v_add_f32 v33, v33, v32
    s_nop 1
    v_add_f32_dpp v33, v33, v33 row_ror:8 row_mask:0xf bank_mask:0xf
    s_nop 1
    v_add_f32_dpp v33, v33, v33 row_ror:4 row_mask:0xf bank_mask:0xf
    s_nop 1
    v_add_f32_dpp v33, v33, v33 row_ror:2 row_mask:0xf bank_mask:0xf
    s_nop 1
    v_add_f32_dpp v33, v33, v33 row_ror:1 row_mask:0xf bank_mask:0xf
    s_nop 1
    v_add_f32_dpp v33, v33, v33 row_bcast:15 row_mask:0xa bank_mask:0xf
    v_min_u32 v33, -2, v33
    s_cbranch_scc1 L_gs_176
    buffer_store_dword v33, v34, s[40:43], s67 offen
L_gb_177:
    s_waitcnt vmcnt(1)
    s_branch L_se_165
L_gs_181:
    buffer_store_dword v12, v11, s[40:43], s59 offen sc1
    s_branch L_gb_182
L_gr_187:
    s_cbranch_scc1 L_gw_186
    s_waitcnt vmcnt(0)
    v_max3_u32 v32, v12, v13, v14
    v_max3_u32 v32, v32, v15, v16
    v_max3_u32 v32, v32, v17, v18
    v_max3_u32 v32, v32, v19, v20
L_pad18:
    s_cbranch_execz L_pad22
    v_max3_u32 v32, v32, v21, v22
    v_max3_u32 v32, v32, v23, v24
    v_max3_u32 v32, v32, v25, v26
    v_max_u32 v32, v32, v27
    v_cmp_eq_u32 vcc, -1, v32
    s_cbranch_vccnz L_gw_186
    v_pk_add_f32 v[28:29], v[12:13], v[16:17]
    v_pk_add_f32 v[30:31], v[14:15], v[18:19]
    v_pk_add_f32 v[28:29], v[28:29], v[20:21]
    v_pk_add_f32 v[30:31], v[30:31], v[22:23]
    v_pk_add_f32 v[28:29], v[28:29], v[24:25]
    v_pk_add_f32 v[30:31], v[30:31], v[26:27]
    s_nop 1
    v_permlane32_swap_b32 v28, v30
    v_permlane32_swap_b32 v29, v31
    s_branch L_gk_188
L_gr_190:
    s_cbranch_scc1 L_gw_189
    s_waitcnt vmcnt(0)
    v_max3_u32 v32, v12, v13, v14
    v_max3_u32 v32, v32, v15, v16
    v_max3_u32 v32, v32, v17, v18
    v_max3_u32 v32, v32, v19, v20
    v_max3_u32 v32, v32, v21, v22
    v_max3_u32 v32, v32, v23, v24
    v_max3_u32 v32, v32, v25, v26
    v_max_u32 v32, v32, v27
    v_cmp_eq_u32 vcc, -1, v32
    s_cbranch_vccnz L_gw_189
    v_pk_add_f32 v[28:29], v[12:13], v[16:17]
    v_pk_add_f32 v[30:31], v[14:15], v[18:19]
    v_pk_add_f32 v[28:29], v[28:29], v[20:21]
    v_pk_add_f32 v[30:31], v[30:31], v[22:23]
    v_pk_add_f32 v[28:29], v[28:29], v[24:25]
    v_pk_add_f32 v[30:31], v[30:31], v[26:27]
    s_nop 1
    v_permlane32_swap_b32 v28, v30
    v_permlane32_swap_b32 v29, v31
    s_branch L_gk_191
L_gs_194:
    buffer_store_dword v33, v34, s[40:43], s67 offen sc1
    s_branch L_gb_195
L_w7_178:
    v_and_b32 v60, 31, v0
    v_min_u32 v60, 19, v60
    s_mul_i32 s57, s54, 320
    v_lshrrev_b32 v5, 5, v0
    v_lshlrev_b32 v5, 12, v5
    v_add_u32 v5, s57, v5
    v_lshl_add_u32 v5, v60, 4, v5
    v_and_b32 v60, 31, v0
    v_cmp_gt_u32 s[64:65], 20, v60
    v_min_u32 v60, 19, v60
    v_lshrrev_b32 v35, 5, v0
    v_lshlrev_b32 v35, 2, v35
    v_add_u32 v35, 160832, v35
    v_lshl_add_u32 v35, v60, 3, v35
    s_mul_i32 s66, s53, 6144
    s_add_u32 s66, s66, s62
    s_add_u32 s66, s66, 46080
    s_lshl_b32 s67, s53, 6
    s_add_u32 s67, s67, s62
    s_add_u32 s67, s67, 25600
    s_lshl_b32 s57, s54, 3
    v_lshrrev_b32 v34, 5, v0
    v_lshlrev_b32 v34, 2, v34
    v_add_u32 v34, s57, v34
    v_and_b32 v60, 31, v0
    v_mov_b32 v61, 0x7f000000
    v_cmp_ne_u32 vcc, 31, v60
    s_nop 1
    v_cndmask_b32 v34, v34, v61, vcc
    v_mov_b32 v61, 0x3f803f80
    s_cmp_lg_u32 s53, 3
    s_cbranch_scc0 L_skip_183
    s_add_u32 s57, s62, 25856
    v_mov_b32 v9, 0
L_pr_185:
    buffer_load_dword v12, v9, s[40:43], s57 offen sc1
    s_sub_u32 s56, s56, 1
    s_cbranch_scc1 L_done
L_pw_184:
    s_waitcnt vmcnt(0)
    v_cmp_eq_u32 vcc, -1, v12
    s_cbranch_vccnz L_pr_185
    s_add_u32 s57, s7, 0
    s_add_u32 s58, s7, 16384
    s_add_u32 s59, s7, 32768
    s_add_u32 s60, s7, 49152
L_gw_186:
    buffer_load_dwordx4 v[12:15], v5, s[40:43], s57 offen sc1
    buffer_load_dwordx4 v[16:19], v5, s[40:43], s58 offen sc1
L_pad19:
    s_cbranch_execz L_pad23
    buffer_load_dwordx4 v[20:23], v5, s[40:43], s59 offen sc1
    buffer_load_dwordx4 v[24:27], v5, s[40:43], s60 offen sc1
    s_sub_u32 s56, s56, 1
    s_cbranch_scc1 L_done
    s_and_b32 s74, s56, 31
    s_waitcnt vmcnt(2)
    v_pk_add_f32 v[28:29], v[12:13], v[16:17]
    v_pk_add_f32 v[30:31], v[14:15], v[18:19]
    s_waitcnt vmcnt(1)
    v_pk_add_f32 v[28:29], v[28:29], v[20:21]
    v_pk_add_f32 v[30:31], v[30:31], v[22:23]
    s_waitcnt vmcnt(0)
    v_pk_add_f32 v[28:29], v[28:29], v[24:25]
    v_pk_add_f32 v[30:31], v[30:31], v[26:27]
    v_pk_add_f32 v[32:33], v[28:29], v[30:31]
    v_cmp_u_f32 vcc, v32, v33
    v_permlane32_swap_b32 v28, v30
    v_permlane32_swap_b32 v29, v31
    s_cbranch_vccnz L_gr_187
L_gk_188:
    v_pk_add_f32 v[28:29], v[28:29], v[30:31]
    v_pk_add_f32 v[28:29], v[28:29], v[2:3]
    v_cvt_pk_bf16_f32 v28, v28, v29
    v_lshlrev_b32 v2, 16, v28
    v_and_b32 v3, 0xffff0000, v28
L_skip_183:
    v_lshlrev_b32 v60, 16, v4
    v_add_f32 v2, v2, v60
    v_and_b32 v60, 0xffff0000, v4
    v_add_f32 v3, v3, v60
    s_add_u32 s57, s7, 66048
    s_add_u32 s58, s7, 82432
    s_add_u32 s59, s7, 98816
    s_add_u32 s60, s7, 115200
    s_lshl_b32 s74, s53, 7
    s_add_u32 s75, s62, s74
    s_add_u32 s75, s75, 26116
    v_mov_b32 v9, 0
    buffer_load_dword v12, v9, s[40:43], s75 offen sc1
    s_sleep 2
L_pr_193:
    buffer_load_dword v12, v9, s[40:43], s75 offen sc1
    s_sub_u32 s56, s56, 1
    s_cbranch_scc1 L_done
L_pw_192:
    s_waitcnt vmcnt(1)
    v_cmp_eq_u32 vcc, -1, v12
    s_cbranch_vccnz L_pr_193
    buffer_load_dwordx4 v[12:15], v5, s[40:43], s57 offen sc1
    buffer_load_dwordx4 v[16:19], v5, s[40:43], s58 offen sc1
    buffer_load_dwordx4 v[20:23], v5, s[40:43], s59 offen sc1
    buffer_load_dwordx4 v[24:27], v5, s[40:43], s60 offen sc1
    s_sleep 2
L_gw_189:
    buffer_load_dwordx4 v[12:15], v5, s[40:43], s57 offen sc1
    buffer_load_dwordx4 v[16:19], v5, s[40:43], s58 offen sc1
    buffer_load_dwordx4 v[20:23], v5, s[40:43], s59 offen sc1
    buffer_load_dwordx4 v[24:27], v5, s[40:43], s60 offen sc1
    s_sub_u32 s56, s56, 1
    s_cbranch_scc1 L_done
    s_and_b32 s74, s56, 31
    s_waitcnt vmcnt(6)
    v_pk_add_f32 v[28:29], v[12:13], v[16:17]
    v_pk_add_f32 v[30:31], v[14:15], v[18:19]
    s_waitcnt vmcnt(5)
    v_pk_add_f32 v[28:29], v[28:29], v[20:21]
    v_pk_add_f32 v[30:31], v[30:31], v[22:23]
    s_waitcnt vmcnt(4)
    v_pk_add_f32 v[28:29], v[28:29], v[24:25]
    v_pk_add_f32 v[30:31], v[30:31], v[26:27]
    v_pk_add_f32 v[32:33], v[28:29], v[30:31]
    v_cmp_u_f32 vcc, v32, v33
    v_permlane32_swap_b32 v28, v30
    v_permlane32_swap_b32 v29, v31
    s_cbranch_vccnz L_gr_190
L_gk_191:
    v_pk_add_f32 v[28:29], v[28:29], v[30:31]
    v_pk_add_f32 v[28:29], v[28:29], v[2:3]
    v_cvt_pk_bf16_f32 v28, v28, v29
    ds_write_b32 v35, v28
    s_waitcnt lgkmcnt(0)
    s_barrier
    v_cndmask_b32 v29, 0, v28, s[64:65]
    v_dot2_f32_bf16 v33, v29, v61, 0
    v_dot2_f32_bf16 v32, v29, v29, 0
    v_lshlrev_b32 v2, 16, v28
    v_and_b32 v3, 0xffff0000, v28
    s_cmp_eq_u32 s55, 0
    v_permlane32_swap_b32 v33, v32
L_pad20:
    s_cbranch_execz L_padback
    v_add_f32 v33, v33, v32
    s_nop 1
    v_add_f32_dpp v33, v33, v33 row_ror:8 row_mask:0xf bank_mask:0xf
    s_nop 1
    v_add_f32_dpp v33, v33, v33 row_ror:4 row_mask:0xf bank_mask:0xf
    s_nop 1
    v_add_f32_dpp v33, v33, v33 row_ror:2 row_mask:0xf bank_mask:0xf
    s_nop 1
    v_add_f32_dpp v33, v33, v33 row_ror:1 row_mask:0xf bank_mask:0xf
    s_nop 1
    v_add_f32_dpp v33, v33, v33 row_bcast:15 row_mask:0xa bank_mask:0xf
    v_min_u32 v33, -2, v33
    s_cbranch_scc1 L_gs_194
    buffer_store_dword v33, v34, s[40:43], s67 offen
L_gb_195:
    s_waitcnt vmcnt(1)
    s_branch L_se_179
L_hr_200:
    buffer_load_dwordx4 v[12:15], v7, s[40:43], s59 offen offset:0 sc1
    buffer_load_dwordx4 v[16:19], v7, s[40:43], s59 offen offset:1024 sc1
    s_sub_u32 s56, s56, 1
    s_cbranch_scc1 L_done
    s_and_b32 s64, s56, 31
    s_cbranch_scc0 L_hx_202
    s_waitcnt vmcnt(0)
    v_pk_add_f32 v[20:21], v[12:13], v[16:17]
    v_pk_add_f32 v[22:23], v[14:15], v[18:19]
    s_nop 1
    v_permlane32_swap_b32 v20, v22
    v_permlane32_swap_b32 v21, v23
    v_pk_add_f32 v[20:21], v[20:21], v[22:23]
    s_nop 1
    v_permlane16_swap_b32 v20, v21
    v_add_f32 v20, v20, v21
    v_cmp_u_f32 vcc, v20, v20
    v_sub_f32 v20, v20, v50
    s_cbranch_vccnz L_hr_200
    s_branch L_hk_201
L_hx_202:
    s_waitcnt vmcnt(0)
    v_max3_u32 v20, v12, v13, v14
    v_max3_u32 v20, v20, v15, v16
    v_max3_u32 v20, v20, v17, v18
    v_max_u32 v20, v20, v19
    v_cmp_eq_u32 vcc, -1, v20
    s_cbranch_vccnz L_hr_200
    v_pk_add_f32 v[20:21], v[12:13], v[16:17]
    v_pk_add_f32 v[22:23], v[14:15], v[18:19]
    s_nop 1
    v_permlane32_swap_b32 v20, v22
    v_permlane32_swap_b32 v21, v23
    v_pk_add_f32 v[20:21], v[20:21], v[22:23]
    s_nop 1
    v_permlane16_swap_b32 v20, v21
    v_add_f32 v20, v20, v21
    v_sub_f32 v20, v20, v50
    s_branch L_hk_201
L_qo_196:
    v_mov_b64 v[24:25], 0
    v_mov_b64 v[26:27], 0
    v_mov_b64 v[28:29], 0
    v_mov_b64 v[30:31], 0
    v_mov_b64 v[32:33], 0
    v_mov_b64 v[34:35], 0
    v_mov_b64 v[36:37], 0
    v_mov_b64 v[38:39], 0
    v_mov_b64 v[40:41], 0
    v_mov_b64 v[42:43], 0
    v_mov_b64 v[44:45], 0
    v_mov_b64 v[46:47], 0
    v_lshrrev_b32 v5, 4, v0
    v_lshlrev_b32 v5, 5, v5
    v_bfe_u32 v60, v0, 1, 1
    v_lshl_add_u32 v5, v60, 4, v5
    v_add_u32 v5, 124928, v5
    s_branch L_qb_197
L_mr_203:
    ds_read_b32 v36, v62
    s_sub_u32 s56, s56, 1
    s_cbranch_scc1 L_done
    s_waitcnt lgkmcnt(0)
    v_cmp_eq_u32 vcc, -1, v36
    s_cbranch_vccnz L_mr_203
    v_max_f32_dpp v37, v36, v36 row_ror:4 row_mask:0xf bank_mask:0xf
    s_nop 1
    v_max_f32_dpp v37, v37, v37 row_ror:2 row_mask:0xf bank_mask:0xf
    s_nop 1
    v_max_f32_dpp v37, v37, v37 row_ror:1 row_mask:0xf bank_mask:0xf
    v_sub_f32 v39, v61, v37
    v_exp_f32 v39, v39
    s_branch L_mk_204
L_gs_205:
    buffer_store_dword v37, v4, s[40:43], s58 offen sc1
    s_branch L_gb_206
L_gs_207:
    buffer_store_dword v14, v3, s[40:43], s57 offen sc1
    s_branch L_gb_208
L_gs_209:
    buffer_store_dword v12, v4, s[40:43], s57 offen offset:32 sc1
    s_branch L_gb_210
L_comb_1:
    s_mov_b32 s58, 26624
    v_min_u32 v37, -2, v37
    s_cmp_eq_u32 s55, 0
    s_cbranch_scc1 L_gs_205
    buffer_store_dword v37, v4, s[40:43], s58 offen
L_gb_206:
    s_mov_b32 s57, 26624
L_pad21:
    s_cbranch_execz L_padback
    s_cmp_eq_u32 s55, 0
    s_waitcnt lgkmcnt(0)
    s_barrier
    ds_read2st64_b64 v[12:15], v2 offset0:0 offset1:4
    ds_read2st64_b64 v[16:19], v2 offset0:8 offset1:12
    ds_read2st64_b64 v[20:23], v2 offset0:16 offset1:20
    ds_read2st64_b64 v[24:27], v2 offset0:24 offset1:28
    s_waitcnt lgkmcnt(2)
    v_pk_add_f32 v[12:13], v[12:13], v[14:15]
    v_pk_add_f32 v[16:17], v[16:17], v[18:19]
    v_pk_add_f32 v[12:13], v[12:13], v[16:17]
    s_waitcnt lgkmcnt(0)
    v_pk_add_f32 v[20:21], v[20:21], v[22:23]
    v_pk_add_f32 v[24:25], v[24:25], v[26:27]
    v_pk_add_f32 v[12:13], v[12:13], v[20:21]
    v_pk_add_f32 v[12:13], v[12:13], v[24:25]
    v_cvt_pk_bf16_f32 v14, v12, v13
    v_min_u32 v12, -2, v12
    v_min_u32 v14, -2, v14
    s_cbranch_scc1 L_gs_207
    buffer_store_dword v14, v3, s[40:43], s57 offen
L_gb_208:
    s_cbranch_scc1 L_gs_209
    buffer_store_dword v12, v4, s[40:43], s57 offen offset:32
L_gb_210:
    s_branch L_comb_1b
L_sr_220:
    buffer_load_dwordx4 v[52:55], v11, s[40:43], s65 offen offset:0 sc1
    buffer_load_dwordx4 v[56:59], v11, s[40:43], s65 offen offset:1024 sc1
    s_sub_u32 s56, s56, 1
    s_cbranch_scc1 L_done
    s_waitcnt vmcnt(0)
    s_branch L_sw_219
L_hr_221:
    buffer_load_dwordx4 v[12:15], v11, s[40:43], s58 offen offset:0 sc1
    buffer_load_dwordx4 v[16:19], v11, s[40:43], s58 offen offset:1024 sc1
    s_sub_u32 s56, s56, 1
    s_cbranch_scc1 L_done
    s_and_b32 s64, s56, 31
    s_cbranch_scc0 L_hx_223
    s_waitcnt vmcnt(2)
    v_pk_add_f32 v[20:21], v[12:13], v[16:17]
    v_pk_add_f32 v[22:23], v[14:15], v[18:19]
    s_nop 1
    v_permlane32_swap_b32 v20, v22
    v_permlane32_swap_b32 v21, v23
    v_pk_add_f32 v[20:21], v[20:21], v[22:23]
    s_nop 1
    v_permlane16_swap_b32 v20, v21
    v_add_f32 v20, v20, v21
    v_cmp_u_f32 vcc, v20, v20
    v_sub_f32 v20, v20, v26
    s_cbranch_vccnz L_hr_221
    s_branch L_hk_222
L_hx_223:
    s_waitcnt vmcnt(0)
    v_max3_u32 v20, v12, v13, v14
    v_max3_u32 v20, v20, v15, v16
    v_max3_u32 v20, v20, v17, v18
    v_max_u32 v20, v20, v19
    v_cmp_eq_u32 vcc, -1, v20
    s_cbranch_vccnz L_hr_221
    v_pk_add_f32 v[20:21], v[12:13], v[16:17]
    v_pk_add_f32 v[22:23], v[14:15], v[18:19]
    s_nop 1
    v_permlane32_swap_b32 v20, v22
    v_permlane32_swap_b32 v21, v23
    v_pk_add_f32 v[20:21], v[20:21], v[22:23]
    s_nop 1
    v_permlane16_swap_b32 v20, v21
    v_add_f32 v20, v20, v21
    v_sub_f32 v20, v20, v26
    s_branch L_hk_222
L_typeC_226:
    s_cmp_eq_u32 s30, 6
    s_cbranch_scc0 L_done
    s_cmp_eq_u32 s3, 20
    s_cbranch_scc0 L_done
    s_lshl_b32 s59, s31, 9
    s_add_u32 s59, s59, s8
    s_add_u32 s59, s59, 266240
    v_and_b32 v10, 1, v0
    v_lshlrev_b32 v10, 13, v10
    v_lshrrev_b32 v60, 1, v0
    v_lshl_add_u32 v10, v60, 24, v10
    s_add_u32 s58, s62, 28192
    v_lshrrev_b32 v9, 3, v0
    v_mul_u32_u24 v9, 1664, v9
    v_and_b32 v60, 7, v0
    v_lshl_add_u32 v9, v60, 2, v9
    buffer_load_dword v12, v9, s[40:43], s58 offen sc1
    s_sleep 2
L_pr_228:
    buffer_load_dword v12, v9, s[40:43], s58 offen sc1
    s_sub_u32 s56, s56, 1
    s_cbranch_scc1 L_done
L_pw_227:
    s_waitcnt vmcnt(1)
    v_cmp_eq_u32 vcc, -1, v12
    s_cbranch_vccnz L_pr_228
L_pad22:
    s_cbranch_execz L_padback
    buffer_store_dword v0, v10, s[40:43], s59 offen offset:8 sc1
    s_add_u32 s58, s62, 25984
    v_and_b32 v9, 15, v0
    v_lshlrev_b32 v9, 2, v9
    buffer_load_dword v13, v9, s[40:43], s58 offen sc1
    s_sleep 2
L_pr_230:
    buffer_load_dword v13, v9, s[40:43], s58 offen sc1
    s_sub_u32 s56, s56, 1
    s_cbranch_scc1 L_done
L_pw_229:
    s_waitcnt vmcnt(1)
    v_cmp_eq_u32 vcc, -1, v13
    s_cbranch_vccnz L_pr_230
    buffer_store_dword v0, v10, s[40:43], s59 offen offset:12 sc1
    s_waitcnt vmcnt(1)
    s_branch L_done
L_gs_234:
    buffer_store_dword v12, v11, s[40:43], s59 offen sc1
    s_branch L_gb_235
L_gr_237:
    s_cbranch_scc1 L_gw_236
    s_waitcnt vmcnt(0)
    v_max3_u32 v32, v12, v13, v14
    v_max3_u32 v32, v32, v15, v16
    v_max3_u32 v32, v32, v17, v18
    v_max3_u32 v32, v32, v19, v20
    v_max3_u32 v32, v32, v21, v22
    v_max3_u32 v32, v32, v23, v24
    v_max3_u32 v32, v32, v25, v26
    v_max_u32 v32, v32, v27
    v_cmp_eq_u32 vcc, -1, v32
    s_cbranch_vccnz L_gw_236
    v_pk_add_f32 v[28:29], v[12:13], v[16:17]
    v_pk_add_f32 v[30:31], v[14:15], v[18:19]
    v_pk_add_f32 v[28:29], v[28:29], v[20:21]
    v_pk_add_f32 v[30:31], v[30:31], v[22:23]
    v_pk_add_f32 v[28:29], v[28:29], v[24:25]
    v_pk_add_f32 v[30:31], v[30:31], v[26:27]
    s_nop 1
    v_permlane32_swap_b32 v28, v30
    v_permlane32_swap_b32 v29, v31
    s_branch L_gk_238
L_gs_241:
    buffer_store_dword v33, v34, s[40:43], s67 offen sc1
    s_branch L_gb_242
L_w7_231:
    v_and_b32 v60, 31, v0
    v_min_u32 v60, 19, v60
    s_mul_i32 s57, s54, 320
    v_lshrrev_b32 v5, 5, v0
    v_lshlrev_b32 v5, 12, v5
    v_add_u32 v5, s57, v5
    v_lshl_add_u32 v5, v60, 4, v5
    v_and_b32 v60, 31, v0
    v_cmp_gt_u32 s[64:65], 20, v60
    v_min_u32 v60, 19, v60
    v_lshrrev_b32 v35, 5, v0
    v_lshlrev_b32 v35, 2, v35
    v_add_u32 v35, 160832, v35
    v_lshl_add_u32 v35, v60, 3, v35
    s_add_u32 s66, s62, 39936
    s_add_u32 s67, s62, 25984
    s_lshl_b32 s57, s54, 3
    v_lshrrev_b32 v34, 5, v0
    v_lshlrev_b32 v34, 2, v34
    v_add_u32 v34, s57, v34
    v_and_b32 v60, 31, v0
    v_mov_b32 v61, 0x7f000000
    v_cmp_ne_u32 vcc, 31, v60
    s_nop 1
    v_cndmask_b32 v34, v34, v61, vcc
    v_mov_b32 v61, 0x3f803f80
    s_add_u32 s57, s7, 132096
    s_add_u32 s58, s7, 148480
    s_add_u32 s59, s7, 164864
    s_add_u32 s60, s7, 181248
    s_add_u32 s75, s7, 266248
    v_and_b32 v9, 7, v0
    v_lshlrev_b32 v9, 9, v9
    buffer_load_dword v12, v9, s[40:43], s75 offen sc1
    s_sleep 2
L_pr_240:
    buffer_load_dword v12, v9, s[40:43], s75 offen sc1
    s_sub_u32 s56, s56, 1
    s_cbranch_scc1 L_done
L_pw_239:
    s_waitcnt vmcnt(1)
    v_cmp_eq_u32 vcc, -1, v12
    s_cbranch_vccnz L_pr_240
    s_sleep 2
    buffer_load_dwordx4 v[12:15], v5, s[40:43], s57 offen sc1
    buffer_load_dwordx4 v[16:19], v5, s[40:43], s58 offen sc1
    buffer_load_dwordx4 v[20:23], v5, s[40:43], s59 offen sc1
    buffer_load_dwordx4 v[24:27], v5, s[40:43], s60 offen sc1
L_pad23:
    s_cbranch_execz L_padback
    s_sleep 2
L_gw_236:
    buffer_load_dwordx4 v[12:15], v5, s[40:43], s57 offen sc1
    buffer_load_dwordx4 v[16:19], v5, s[40:43], s58 offen sc1
    buffer_load_dwordx4 v[20:23], v5, s[40:43], s59 offen sc1
    buffer_load_dwordx4 v[24:27], v5, s[40:43], s60 offen sc1
    s_sub_u32 s56, s56, 1
    s_cbranch_scc1 L_done
    s_and_b32 s74, s56, 31
    s_waitcnt vmcnt(6)
    v_pk_add_f32 v[28:29], v[12:13], v[16:17]
    v_pk_add_f32 v[30:31], v[14:15], v[18:19]
    s_waitcnt vmcnt(5)
    v_pk_add_f32 v[28:29], v[28:29], v[20:21]
    v_pk_add_f32 v[30:31], v[30:31], v[22:23]
    s_waitcnt vmcnt(4)
    v_pk_add_f32 v[28:29], v[28:29], v[24:25]
    v_pk_add_f32 v[30:31], v[30:31], v[26:27]
    v_pk_add_f32 v[32:33], v[28:29], v[30:31]
    v_cmp_u_f32 vcc, v32, v33
    v_permlane32_swap_b32 v28, v30
    v_permlane32_swap_b32 v29, v31
    s_cbranch_vccnz L_gr_237
L_gk_238:
    v_pk_add_f32 v[28:29], v[28:29], v[30:31]
    v_pk_add_f32 v[28:29], v[28:29], v[2:3]
    v_cvt_pk_bf16_f32 v28, v28, v29
    ds_write_b32 v35, v28
    s_waitcnt lgkmcnt(0)
    s_barrier
    v_cndmask_b32 v29, 0, v28, s[64:65]
    v_dot2_f32_bf16 v33, v29, v61, 0
    v_dot2_f32_bf16 v32, v29, v29, 0
    v_lshlrev_b32 v2, 16, v28
    v_and_b32 v3, 0xffff0000, v28
    s_cmp_eq_u32 s55, 0
    v_permlane32_swap_b32 v33, v32
    v_add_f32 v33, v33, v32
    s_nop 1
    v_add_f32_dpp v33, v33, v33 row_ror:8 row_mask:0xf bank_mask:0xf
    s_nop 1
    v_add_f32_dpp v33, v33, v33 row_ror:4 row_mask:0xf bank_mask:0xf
    s_nop 1
    v_add_f32_dpp v33, v33, v33 row_ror:2 row_mask:0xf bank_mask:0xf
    s_nop 1
    v_add_f32_dpp v33, v33, v33 row_ror:1 row_mask:0xf bank_mask:0xf
    s_nop 1
    v_add_f32_dpp v33, v33, v33 row_bcast:15 row_mask:0xa bank_mask:0xf
    v_min_u32 v33, -2, v33
    s_cbranch_scc1 L_gs_241
    buffer_store_dword v33, v34, s[40:43], s67 offen
L_gb_242:
    s_waitcnt vmcnt(1)
    s_branch L_se_232
L_gr_244:
    s_cbranch_scc1 L_gw_243
    s_waitcnt vmcnt(0)
    v_max3_u32 v32, v12, v13, v14
    v_max3_u32 v32, v32, v15, v16
    v_max3_u32 v32, v32, v17, v18
    v_max3_u32 v32, v32, v19, v20
    v_max3_u32 v32, v32, v21, v22
    v_max3_u32 v32, v32, v23, v24
    v_max3_u32 v32, v32, v25, v26
    v_max_u32 v32, v32, v27
    v_cmp_eq_u32 vcc, -1, v32
    s_cbranch_vccnz L_gw_243
    v_pk_add_f32 v[28:29], v[12:13], v[16:17]
    v_pk_add_f32 v[30:31], v[14:15], v[18:19]
    v_pk_add_f32 v[28:29], v[28:29], v[20:21]
    v_pk_add_f32 v[30:31], v[30:31], v[22:23]
    v_pk_add_f32 v[28:29], v[28:29], v[24:25]
    v_pk_add_f32 v[30:31], v[30:31], v[26:27]
    s_nop 1
    v_permlane32_swap_b32 v28, v30
    v_permlane32_swap_b32 v29, v31
    s_branch L_gk_245
L_tail_end:
L_spread:
    s_add_u32 s62, s62, 966656
    s_cmp_eq_u32 s30, 5
    s_cbranch_scc0 L_skip_80
    v_mov_b64 v[12:13], -1
    v_mov_b64 v[14:15], -1
    v_lshlrev_b32 v16, 4, v0
    s_mul_i32 s57, s52, 2208
    s_add_u32 s57, s57, s62
    s_mov_b64 exec, 0x3ff
    buffer_store_dwordx4 v[12:15], v16, s[40:43], s57 offen offset:2048 sc1
    s_mov_b64 exec, -1
    buffer_store_dwordx4 v[12:15], v16, s[40:43], s57 offen offset:0 sc1
    buffer_store_dwordx4 v[12:15], v16, s[40:43], s57 offen offset:1024 sc1
L_skip_80:
    s_cmp_eq_u32 s30, 7
    s_cbranch_scc0 L_skip_81
    v_and_b32 v60, 31, v0
    v_cmp_gt_u32 s[64:65], 20, v60
    v_min_u32 v60, 19, v60
    v_lshrrev_b32 v35, 5, v0
    v_lshlrev_b32 v35, 2, v35
    v_add_u32 v35, 160832, v35
    v_lshl_add_u32 v35, v60, 3, v35
    s_mul_i32 s66, s53, 12416
    s_add_u32 s66, s66, s62
    s_add_u32 s66, s66, 70656
    s_add_u32 s67, s66, 12288
    s_lshl_b32 s57, s54, 3
    v_lshrrev_b32 v34, 5, v0
    v_lshlrev_b32 v34, 2, v34
    v_add_u32 v34, s57, v34
    v_and_b32 v60, 31, v0
    v_mov_b32 v61, 0x7f000000
    v_cmp_ne_u32 vcc, 31, v60
    s_nop 1
    v_cndmask_b32 v34, v34, v61, vcc
    v_mov_b32 v61, 0x3f803f80
    v_cvt_pk_bf16_f32 v28, v2, v3
L_skip_81:
    s_cmp_eq_u32 s30, 7
    s_cbranch_scc0 L_skip_82
    v_cndmask_b32 v29, 0, v28, s[64:65]
    v_dot2_f32_bf16 v33, v29, v61, 0
    v_dot2_f32_bf16 v32, v29, v29, 0
    v_lshlrev_b32 v2, 16, v28
    v_and_b32 v3, 0xffff0000, v28
    s_cmp_eq_u32 s55, 0
    v_permlane32_swap_b32 v33, v32
    v_add_f32 v33, v33, v32
    s_nop 1
    v_add_f32_dpp v33, v33, v33 row_ror:8 row_mask:0xf bank_mask:0xf
    s_nop 1
    v_add_f32_dpp v33, v33, v33 row_ror:4 row_mask:0xf bank_mask:0xf
    s_nop 1
    v_add_f32_dpp v33, v33, v33 row_ror:2 row_mask:0xf bank_mask:0xf
    s_nop 1
    v_add_f32_dpp v33, v33, v33 row_ror:1 row_mask:0xf bank_mask:0xf
    s_nop 1
    v_add_f32_dpp v33, v33, v33 row_bcast:15 row_mask:0xa bank_mask:0xf
    v_min_u32 v33, -2, v33
    s_cbranch_scc1 L_gs_83
    buffer_store_dword v33, v34, s[40:43], s67 offen
L_gb_84:
    s_waitcnt vmcnt(1)
L_skip_82:
    s_cmp_lt_u32 s30, 6
    s_cbranch_scc0 L_skip_85
    s_lshr_b32 s57, s30, 1
    s_mul_i32 s57, s57, 1024
    s_and_b32 s58, s30, 1
    s_lshl_b32 s58, s58, 6
    s_add_u32 s57, s57, s58
    v_lshrrev_b32 v18, 5, v0
    v_mul_u32_u24 v18, 6144, v18
    v_bfe_u32 v60, v0, 3, 1
    v_mul_u32_u24 v60, 3072, v60
    v_add_u32 v18, v60, v18
    v_bfe_u32 v60, v0, 4, 1
    v_lshl_add_u32 v18, v60, 9, v18
    v_bfe_u32 v60, v0, 2, 1
    v_lshl_add_u32 v18, v60, 7, v18
    v_and_b32 v60, 3, v0
    v_lshl_add_u32 v18, v60, 3, v18
    v_add_u32 v18, s57, v18
    v_bfe_u32 v19, v0, 4, 1
    v_mul_u32_u24 v19, 3072, v19
    v_bfe_u32 v60, v0, 3, 1
    v_lshl_add_u32 v19, v60, 9, v19
    v_bfe_u32 v60, v0, 2, 1
    v_lshl_add_u32 v19, v60, 7, v19
    v_and_b32 v60, 3, v0
    v_lshl_add_u32 v19, v60, 3, v19
    v_add_u32 v19, s57, v19
    v_add_u32 v19, 24576, v19
    ds_read_b64_tr_b16 v[28:29], v18 offset:0
    ds_read_b64_tr_b16 v[30:31], v18 offset:256
    ds_read_b64_tr_b16 v[32:33], v18 offset:12288
    ds_read_b64_tr_b16 v[34:35], v18 offset:12544
    ds_read_b64_tr_b16 v[36:37], v19 offset:0
    ds_read_b64_tr_b16 v[38:39], v19 offset:256
    ds_read_b64_tr_b16 v[40:41], v18 offset:32
    ds_read_b64_tr_b16 v[42:43], v18 offset:288
    ds_read_b64_tr_b16 v[44:45], v18 offset:12320
    ds_read_b64_tr_b16 v[46:47], v18 offset:12576
    ds_read_b64_tr_b16 v[48:49], v19 offset:32
    ds_read_b64_tr_b16 v[50:51], v19 offset:288
    v_lshrrev_b32 v52, 4, v0
    v_lshlrev_b32 v52, 5, v52
    v_bfe_u32 v60, v0, 1, 1
    v_lshl_add_u32 v52, v60, 4, v52
    v_and_b32 v60, 1, v0
    v_mul_u32_u24 v60, 192, v60
    v_add_u32 v52, v60, v52
    v_add_u32 v52, 160832, v52
    v_lshrrev_b32 v53, 4, v0
    v_lshlrev_b32 v53, 4, v53
    v_bfe_u32 v60, v0, 1, 1
    v_lshl_add_u32 v53, v60, 3, v53
    v_and_b32 v60, 1, v0
    v_mul_u32_u24 v60, 192, v60
    v_add_u32 v53, v60, v53
    v_add_u32 v53, 160960, v53
    v_mov_b64 v[20:21], 0
    v_mov_b64 v[22:23], 0
    v_mov_b64 v[24:25], 0
    v_mov_b64 v[26:27], 0
    s_lshr_b32 s57, s30, 1
    s_lshl_b32 s57, s57, 11
    s_lshl_b32 s58, s58, 1
    s_add_u32 s57, s57, s58
    s_lshl_b32 s58, s54, 8
    s_add_u32 s57, s57, s58
    v_and_b32 v54, 31, v0
    v_lshlrev_b32 v54, 2, v54
    v_lshrrev_b32 v60, 5, v0
    v_mul_u32_u24 v60, 6144, v60
    v_add_u32 v54, v60, v54
    v_add_u32 v54, s57, v54
    s_mul_i32 s59, s53, 12416
    s_add_u32 s59, s59, s62
    s_add_u32 s59, s59, 70656
    s_add_u32 s60, s59, 12288
    ds_read_b128 v[12:15], v52
    ds_read_b64 v[16:17], v53
    s_waitcnt lgkmcnt(1)
    v_smfmac_f32_16x16x64_bf16 v[20:23], v[12:15], v[28:35], v1
    v_smfmac_f32_16x16x64_bf16 v[24:27], v[12:15], v[40:47], v1
    s_waitcnt lgkmcnt(0)
    v_smfmac_f32_16x16x32_bf16 v[20:23], v[16:17], v[36:39], v1
    v_smfmac_f32_16x16x32_bf16 v[24:27], v[16:17], v[48:51], v1
    s_cmp_eq_u32 s55, 0
    s_nop 5
    v_add_f32 v12, v20, v22
    s_nop 1
    v_add_f32_dpp v12, v24, v26 quad_perm:[0,1,2,3] row_mask:0x2 bank_mask:0xf
    s_nop 1
    v_add_f32_dpp v12, v21, v23 quad_perm:[0,1,2,3] row_mask:0x4 bank_mask:0xf
    s_nop 1
    v_add_f32_dpp v12, v25, v27 quad_perm:[0,1,2,3] row_mask:0x8 bank_mask:0xf
    v_min_u32 v12, -2, v12
    s_cbranch_scc1 L_gs_86
    buffer_store_dword v12, v54, s[40:43], s59 offen
L_gb_87:
L_skip_85:
    s_waitcnt vmcnt(0)
    s_barrier
    s_cmp_eq_u32 s30, 5
    s_cbranch_scc0 L_skip_88
    v_mov_b32 v25, 0
    s_lshl_b32 s57, s52, 2
    s_add_u32 s57, s57, s72
    s_mov_b64 exec, 1
    buffer_store_dword v25, v0, s[40:43], s57 offen offset:256 sc1
    s_mov_b64 exec, -1
    v_and_b32 v16, 31, v0
    v_lshlrev_b32 v16, 2, v16
L_pr_90:
    buffer_load_dword v17, v16, s[40:43], s72 offen offset:256 sc1
    s_sub_u32 s56, s56, 1
    s_cbranch_scc1 L_done
L_pw_89:
    s_waitcnt vmcnt(0)
    v_cmp_eq_u32 vcc, -1, v17
    s_cbranch_vccnz L_pr_90
L_skip_88:
    s_barrier
    s_branch L_spread_back
L_done:
L_exit:
    s_endpgm
.section .rodata,"a"
.p2align 6
.amdhsa_kernel interleave_layers__sliding_block_cached__dense_activation_gelu__decode_kernel
  .amdhsa_next_free_vgpr 256
  .amdhsa_next_free_sgpr 102
  .amdhsa_accum_offset 256
  .amdhsa_group_segment_fixed_size 0
  .amdhsa_kernarg_size 104
  .amdhsa_user_sgpr_count 2
  .amdhsa_user_sgpr_kernarg_segment_ptr 1
  .amdhsa_system_sgpr_workgroup_id_x 1
  .amdhsa_float_denorm_mode_32 3
.end_amdhsa_kernel
```

```asm
; @launch grid=(256,1,1) block=(512,1,1) lds=161216
.amdgcn_target "amdgcn-amd-amdhsa--gfx950"
.text
.fill 64, 4, 0xbf800000
.globl interleave_layers__sliding_block_cached__dense_activation_gelu__decode_kernel
.p2align 8
.type interleave_layers__sliding_block_cached__dense_activation_gelu__decode_kernel,@function
interleave_layers__sliding_block_cached__dense_activation_gelu__decode_kernel:
    s_load_dwordx16 s[4:19], s[0:1], 0
    s_load_dwordx8 s[20:27], s[0:1], 64
    s_load_dwordx2 s[28:29], s[0:1], 96
    s_cmp_ge_u32 s2, 256
    s_cbranch_scc1 L_exit
    s_getpc_b64 s[74:75]
L_pc:
    v_lshlrev_b32 v5, 6, v0
    v_min_u32 v5, L_exit-L_pc, v5
    global_load_dword v63, v5, s[74:75]
    v_lshrrev_b32 v5, 6, v0
    v_and_b32 v0, 63, v0
    v_readfirstlane_b32 s30, v5
    s_cmp_eq_u32 s30, 6
    s_cbranch_scc0 L_skip_1
    s_setprio 3
L_skip_1:
    s_and_b32 s31, s2, 7
    s_lshr_b32 s52, s2, 3
    s_and_b32 s53, s52, 3
    s_lshr_b32 s54, s52, 2
    s_lshl_b32 s73, s31, 2
    s_add_u32 s73, s73, s53
    s_mul_i32 s3, s54, 3
    s_add_u32 s3, s3, s53
    s_cmp_eq_u32 s53, 3
    s_cselect_b32 s3, 31, s3
    v_lshrrev_b32 v8, 5, v0
    v_lshlrev_b32 v8, 2, v8
    v_bfe_u32 v60, v0, 4, 1
    v_lshl_add_u32 v8, v60, 0, v8
    v_and_b32 v9, 7, v0
    v_xor_b32 v8, v8, v9
    v_lshrrev_b32 v10, 3, v0
    v_mul_u32_u24 v10, 384, v10
    v_lshl_add_u32 v5, v8, 4, v10
    v_xor_b32 v6, 32, v5
    v_lshrrev_b32 v8, 4, v0
    v_lshlrev_b32 v8, 1, v8
    v_xor_b32 v8, v8, v9
    v_lshl_add_u32 v7, v8, 4, v10
    v_lshrrev_b32 v2, 3, v0
    v_mul_u32_u24 v2, 12288, v2
    v_and_b32 v60, 7, v0
    v_lshl_add_u32 v2, v60, 4, v2
    s_mul_i32 s57, s73, 12582912
    s_mul_i32 s58, s54, 3072
    s_add_u32 s57, s57, s58
    s_add_u32 s57, s57, 11010048
    s_sub_u32 s58, 1572864, s58
    s_mul_i32 s59, s73, 384
    s_mul_i32 s60, s54, 983040
    s_add_u32 s59, s59, s60
    s_sub_u32 s60, 7866368, s59
    s_lshl_b32 s61, s30, 11
    s_add_u32 s61, s61, 92160
    s_mul_i32 s62, s31, 120832
    s_add_u32 s62, s62, 299008
    s_lshl_b32 s72, s31, 9
    s_add_u32 s72, s72, 294912
    s_mov_b32 s56, 65536
    s_mov_b32 s55, 1
    s_getreg_b32 s63, hwreg(20, 0, 3)
    v_mov_b32 v3, 0
    v_mov_b32 v4, 0
    v_mov_b32 v11, 0
    v_mov_b32 v24, 0
    v_mov_b32 v34, 0
    v_mov_b64 v[12:13], -1
    v_mov_b64 v[14:15], -1
    v_lshlrev_b32 v10, 4, v0
    s_mov_b32 s64, s57
    s_mov_b32 s34, s58
    s_mov_b32 s35, 0x20000
    s_mov_b32 s57, 0
    s_mov_b32 s58, 195584
    s_mov_b32 m0, 92160
    s_cmp_eq_u32 s30, 6
    s_cselect_b64 vcc, -1, 0
    s_waitcnt lgkmcnt(0)
    s_add_u32 s32, s6, s64
    s_addc_u32 s33, s7, 0
    s_cbranch_vccz L_skip_3
L_dma_2:
    buffer_load_dwordx4 v5, s[32:35], s57 offen offset:0 nt lds
    buffer_load_dwordx4 v6, s[32:35], s58 offen offset:1024 nt lds
    s_add_u32 s57, s57, 24576
    s_add_u32 s58, s58, 24576
    s_add_u32 m0, m0, 2048
    s_cmp_lg_u32 m0, 108544
    s_cbranch_scc1 L_dma_2
L_skip_3:
    s_add_u32 s36, s8, s64
    s_addc_u32 s37, s9, 0
    s_mov_b32 s38, s34
    s_mov_b32 s39, 0x20000
    s_mov_b32 s40, s28
    s_mov_b32 s41, s29
    s_mov_b32 s42, 2232320
    s_mov_b32 s43, 0x20000
    s_add_u32 s44, s10, s59
    s_addc_u32 s45, s11, 0
    s_mov_b32 s46, s60
    s_mov_b32 s47, 0x20000
    s_sub_u32 s44, s44, 2048
    s_subb_u32 s45, s45, 0
    s_cmp_eq_u32 s30, 6
    s_cbranch_scc0 L_skip_4
    s_mov_b32 s57, 128
    s_mov_b32 s58, 195712
    s_mov_b32 m0, 108544
L_dma_5:
    s_waitcnt vmcnt(22)
L_go_6:
    buffer_load_dwordx4 v5, s[32:35], s57 offen offset:0 nt lds
    buffer_load_dwordx4 v6, s[32:35], s58 offen offset:1024 nt lds
    s_add_u32 s57, s57, 24576
    s_add_u32 s58, s58, 24576
    s_add_u32 m0, m0, 2048
    s_cmp_lg_u32 m0, 124928
    s_cbranch_scc1 L_dma_5
    s_mov_b32 s57, 2048
    s_mov_b32 s58, 1152
    s_mov_b32 s59, 256
    s_mov_b32 m0, 0
L_dma_7:
    s_waitcnt vmcnt(22)
L_go_8:
    buffer_load_dwordx4 v2, s[44:47], s57 offen offset:0 nt lds
    buffer_load_dwordx4 v2, s[44:47], s58 offen offset:1024 nt lds
    buffer_load_dwordx4 v2, s[44:47], s59 offen offset:2048 nt lds
    s_add_u32 s57, s57, 98304
    s_add_u32 s58, s58, 98304
    s_add_u32 s59, s59, 98304
    s_add_u32 m0, m0, 3072
    s_cmp_lg_u32 m0, 15360
    s_cbranch_scc1 L_dma_7
L_skip_4:
    s_cmp_lt_u32 s3, 20
    s_cselect_b32 s57, 7864320, 0
    s_add_u32 s58, s54, 1
    s_mul_i32 s58, s58, 245760
    s_cmp_lg_u32 s53, 3
    s_cselect_b64 s[48:49], s[12:13], s[16:17]
    s_cselect_b32 s50, s57, s58
    s_mov_b32 s51, 0x20000
    s_add_u32 s57, s28, 0
    s_sub_u32 s57, 0, s57
    s_and_b32 s57, s57, 0x3fff
    s_add_u32 s57, s57, 0
    s_lshr_b32 s58, s31, 1
    s_lshl_b32 s58, s58, 14
    s_add_u32 s6, s57, s58
    s_and_b32 s58, s31, 1
    s_lshl_b32 s58, s58, 12
    s_add_u32 s6, s6, s58
    s_lshl_b32 s58, s3, 7
    s_add_u32 s6, s6, s58
    s_mov_b32 s8, s57
    s_and_b32 s59, s3, 3
    s_lshl_b32 s58, s31, 2
    s_add_u32 s59, s59, s58
    s_lshl_b32 s59, s59, 7
    s_add_u32 s59, s59, s57
    s_add_u32 s59, s59, 262144
    s_add_u32 s10, s28, s59
    s_addc_u32 s11, s29, 0
    s_lshr_b32 s58, s63, 2
    s_xor_b32 s58, s58, 0
    s_mul_i32 s58, s58, 8192
    s_add_u32 s7, s57, s58
    s_cmp_eq_u32 s30, 5
    s_cbranch_scc0 L_skip_9
    s_cmp_eq_u32 s52, 31
    s_cbranch_scc0 L_skip_10
    s_mov_b64 exec, 0xffffff
    buffer_store_dwordx4 v[12:15], v10, s[40:43], s72 offen sc1
    s_mov_b64 exec, -1
L_skip_10:
    s_cmp_lt_u32 s3, 20
    s_cbranch_scc0 L_skip_11
    v_and_b32 v16, 7, v0
    v_lshlrev_b32 v16, 4, v16
    v_bfe_u32 v17, v0, 3, 1
    v_lshl_add_u32 v16, v17, 13, v16
    v_lshrrev_b32 v17, 4, v0
    v_mul_u32_u24 v17, 66048, v17
    v_add_u32 v16, v17, v16
    s_add_u32 s57, s6, 0
    buffer_store_dwordx4 v[12:15], v16, s[40:43], s57 offen sc1
L_skip_11:
    s_cmp_eq_u32 s3, 20
    s_cbranch_scc0 L_skip_12
    s_lshl_b32 s58, s31, 9
    s_add_u32 s58, s58, s8
    s_add_u32 s58, s58, 266240
    v_and_b32 v16, 7, v0
    v_lshlrev_b32 v16, 4, v16
    v_bfe_u32 v60, v0, 3, 1
    v_lshl_add_u32 v16, v60, 13, v16
    v_lshrrev_b32 v60, 4, v0
    v_lshl_add_u32 v16, v60, 28, v16
    buffer_store_dwordx4 v[12:15], v16, s[40:43], s58 offen sc1
L_skip_12:
    s_sub_u32 s58, s3, 20
    s_cmp_lt_u32 s58, 4
    s_cselect_b32 s59, s59, 0x7f000000
    v_and_b32 v16, 7, v0
    v_lshlrev_b32 v16, 4, v16
    v_bfe_u32 v60, v0, 3, 1
    v_lshl_add_u32 v16, v60, 13, v16
    v_lshrrev_b32 v60, 4, v0
    v_lshl_add_u32 v16, v60, 28, v16
    buffer_store_dwordx4 v[12:15], v16, s[40:43], s59 offen sc1
    s_mul_i32 s57, s52, 2208
    s_add_u32 s57, s57, s62
    s_mov_b64 exec, 0x3ff
    buffer_store_dwordx4 v[12:15], v10, s[40:43], s57 offen offset:2048
    s_mov_b64 exec, -1
    buffer_store_dwordx4 v[12:15], v10, s[40:43], s57 offen offset:0
    buffer_store_dwordx4 v[12:15], v10, s[40:43], s57 offen offset:1024
    s_mov_b64 exec, -1
    v_lshlrev_b32 v16, 4, v0
    v_add_u32 v16, 159744, v16
    ds_write_b128 v16, v[12:15]
    v_subrev_u32 v16, 8, v0
    v_cmp_gt_u32 vcc, 40, v16
    v_mov_b32 v16, 0x3f803f80
    s_nop 0
    v_cndmask_b32 v18, 0, v16, vcc
    v_min_u32 v16, 55, v0
    v_lshlrev_b32 v16, 2, v16
    v_add_u32 v16, 160992, v16
    ds_write_b32 v16, v18
    v_and_b32 v3, 7, v0
    v_lshlrev_b32 v3, 5, v3
L_skip_9:
    s_cmp_eq_u32 s30, 7
    s_cbranch_scc0 L_skip_13
    v_and_b32 v60, 31, v0
    v_min_u32 v60, 19, v60
    s_mul_i32 s57, s54, 160
    v_lshrrev_b32 v16, 5, v0
    v_lshlrev_b32 v16, 2, v16
    v_add_u32 v16, s57, v16
    v_lshl_add_u32 v16, v60, 3, v16
    global_load_dword v28, v16, s[4:5]
    global_load_dword v4, v16, s[22:23]
L_skip_13:
    s_sub_u32 s58, s30, 4
    s_cmp_lt_u32 s58, 3
    s_cbranch_scc0 L_skip_14
    s_mul_i32 s57, s31, 3
    s_add_u32 s57, s57, s58
    s_lshl_b32 s57, s57, 7
    v_and_b32 v16, 15, v0
    v_lshlrev_b32 v16, 3, v16
    v_lshrrev_b32 v60, 4, v0
    v_lshl_add_u32 v16, v60, 1, v16
    v_add_u32 v16, s57, v16
    global_load_short_d16_hi v4, v16, s[18:19]
L_skip_14:
    v_bfe_u32 v8, v0, 1, 3
    v_lshrrev_b32 v9, 4, v0
    v_xor_b32 v9, v8, v9
    v_bfe_u32 v8, v0, 2, 1
    v_lshlrev_b32 v8, 10, v8
    v_bfe_u32 v60, v0, 3, 1
    v_lshl_add_u32 v8, v60, 9, v8
    v_and_b32 v60, 3, v0
    v_lshl_add_u32 v8, v60, 7, v8
    v_add_u32 v8, s61, v8
    v_lshl_add_u32 v8, v9, 4, v8
    v_xor_b32 v9, 64, v8
    v_bfe_u32 v1, v0, 1, 1
    v_mul_u32_u24 v1, 43690, v1
    v_add_u32 v1, 17476, v1
    s_waitcnt vmcnt(31)
    s_barrier
    ds_read_b128 v[64:67], v8 offset:0
    ds_read_b128 v[68:71], v9 offset:0
    s_cmp_eq_u32 s30, 6
    s_cbranch_scc0 L_skip_15
    s_mov_b32 s57, 256
    s_mov_b32 s58, 195840
    s_mov_b32 m0, 124928
L_dma_16:
    s_waitcnt vmcnt(22)
L_go_17:
    buffer_load_dwordx4 v5, s[32:35], s57 offen offset:0 nt lds
    buffer_load_dwordx4 v6, s[32:35], s58 offen offset:1024 nt lds
    s_add_u32 s57, s57, 24576
    s_add_u32 s58, s58, 24576
    s_add_u32 m0, m0, 2048
    s_cmp_lg_u32 m0, 141312
    s_cbranch_scc1 L_dma_16
L_skip_15:
    s_waitcnt lgkmcnt(0)
    s_cmp_eq_u32 s30, 5
    s_cbranch_scc0 L_skip_18
    s_cmp_eq_u32 s52, 31
    s_cbranch_scc0 L_skip_19
    s_lshl_b32 s57, s31, 5
    v_mov_b32 v16, s57
    s_add_u32 s57, s63, 1
    v_mov_b32 v12, s57
    s_waitcnt vmcnt(5)
    s_mov_b64 exec, 0x1
    global_store_dword v16, v12, s[26:27] sc1
    s_mov_b64 exec, -1
L_skip_19:
L_skip_18:
    s_waitcnt vmcnt(31)
    s_barrier
    ds_read_b128 v[72:75], v8 offset:16384
    ds_read_b128 v[76:79], v9 offset:16384
    s_cmp_eq_u32 s30, 6
    s_cbranch_scc0 L_skip_20
    s_mov_b32 s57, 493568
    s_mov_b32 s58, 492672
    s_mov_b32 s59, 491776
    s_mov_b32 m0, 15360
L_dma_21:
    s_waitcnt vmcnt(22)
L_go_22:
    buffer_load_dwordx4 v2, s[44:47], s57 offen offset:0 nt lds
    buffer_load_dwordx4 v2, s[44:47], s58 offen offset:1024 nt lds
    buffer_load_dwordx4 v2, s[44:47], s59 offen offset:2048 nt lds
    s_add_u32 s57, s57, 98304
    s_add_u32 s58, s58, 98304
    s_add_u32 s59, s59, 98304
    s_add_u32 m0, m0, 3072
    s_cmp_lg_u32 m0, 30720
    s_cbranch_scc1 L_dma_21
    s_mov_b32 s57, 393216
    s_mov_b32 s58, 588800
    s_mov_b32 m0, 141312
L_dma_23:
    s_waitcnt vmcnt(22)
L_go_24:
    buffer_load_dwordx4 v5, s[32:35], s57 offen offset:0 nt lds
    buffer_load_dwordx4 v6, s[32:35], s58 offen offset:1024 nt lds
    s_add_u32 s57, s57, 24576
    s_add_u32 s58, s58, 24576
    s_add_u32 m0, m0, 2048
    s_cmp_lg_u32 m0, 157696
    s_cbranch_scc1 L_dma_23
L_skip_20:
    s_waitcnt lgkmcnt(0)
    s_cmp_lt_u32 s30, 4
    s_cbranch_scc0 L_skip_25
    s_mov_b64 exec, 0
    s_cmp_eq_u32 s30, 1
    s_cbranch_scc1 L_pad1
    s_cmp_eq_u32 s30, 2
    s_cbranch_scc1 L_pad2
    s_cmp_eq_u32 s30, 3
    s_cbranch_scc1 L_pad3
    s_branch L_pad0
L_padback:
    s_mov_b64 exec, -1
L_skip_25:
    s_waitcnt vmcnt(31)
    s_barrier
    ds_read_b128 v[80:83], v8 offset:32768
    ds_read_b128 v[84:87], v9 offset:32768
    s_cmp_eq_u32 s30, 6
    s_cbranch_scc0 L_skip_26
    s_cmp_lg_u32 s53, 3
    s_cbranch_scc0 L_wb_27
    s_mul_i32 s57, s31, 983040
    s_lshl_b32 s58, s3, 6
    s_add_u32 s57, s57, s58
    v_bfe_u32 v38, v0, 4, 1
    v_lshlrev_b32 v38, 1, v38
    v_xor_b32 v38, v38, v0
    v_and_b32 v38, 3, v38
    v_lshrrev_b32 v3, 5, v0
    v_mul_u32_u24 v3, 10240, v3
    v_bfe_u32 v39, v0, 4, 1
    v_mul_u32_u24 v39, 2560, v39
    v_add_u32 v3, v39, v3
    v_bfe_u32 v39, v0, 3, 1
    v_mul_u32_u24 v39, 5120, v39
    v_add_u32 v3, v39, v3
    v_bfe_u32 v39, v0, 2, 1
    v_mul_u32_u24 v39, 20480, v39
    v_add_u32 v3, v39, v3
    v_add_u32 v3, s57, v3
    v_lshl_add_u32 v3, v38, 4, v3
    s_mov_b32 s14, 40960
    s_mov_b32 s15, 256
    s_branch L_we_28
L_wb_27:
    s_mul_i32 s57, s31, 384
    s_mul_i32 s58, s54, 245760
    s_add_u32 s57, s57, s58
    v_lshlrev_b32 v3, 4, v0
    v_add_u32 v3, s57, v3
    v_mov_b32 v38, 2688
    v_cmp_lt_u32 vcc, 23, v0
    s_nop 1
    v_cndmask_b32 v38, 0, v38, vcc
    v_add_u32 v3, v38, v3
    v_mov_b32 v38, 0x7f000000
    v_cmp_lt_u32 vcc, 47, v0
    s_nop 1
    v_cndmask_b32 v3, v3, v38, vcc
    s_mov_b32 s14, 12288
    s_mov_b32 s15, 5120
L_we_28:
    s_mul_i32 s57, s14, 0
    s_mov_b32 m0, 30720
    s_nop 0
    buffer_load_dwordx4 v3, s[48:51], s57 offen offset:0 nt lds
    s_mul_i32 s57, s14, 0
    s_add_u32 s57, s57, s15
    s_mov_b32 m0, 30720
    s_nop 0
    buffer_load_dwordx4 v3, s[48:51], s57 offen offset:1024 nt lds
    s_mov_b32 s57, 393344
    s_mov_b32 s58, 588928
    s_mov_b32 m0, 92160
L_dma_29:
    s_waitcnt vmcnt(22)
L_go_30:
    buffer_load_dwordx4 v5, s[32:35], s57 offen offset:0 nt lds
    buffer_load_dwordx4 v6, s[32:35], s58 offen offset:1024 nt lds
    s_add_u32 s57, s57, 24576
    s_add_u32 s58, s58, 24576
    s_add_u32 m0, m0, 2048
    s_cmp_lg_u32 m0, 108544
    s_cbranch_scc1 L_dma_29
    s_mul_i32 s57, s14, 1
    s_mov_b32 m0, 32768
    s_nop 0
    buffer_load_dwordx4 v3, s[48:51], s57 offen offset:0 nt lds
    s_mul_i32 s57, s14, 1
    s_add_u32 s57, s57, s15
    s_mov_b32 m0, 32768
    s_nop 0
    buffer_load_dwordx4 v3, s[48:51], s57 offen offset:1024 nt lds
    s_mov_b32 s57, 393472
    s_mov_b32 s58, 589056
    s_mov_b32 m0, 108544
L_dma_31:
    s_waitcnt vmcnt(22)
L_go_32:
    buffer_load_dwordx4 v5, s[32:35], s57 offen offset:0 nt lds
    buffer_load_dwordx4 v6, s[32:35], s58 offen offset:1024 nt lds
    s_add_u32 s57, s57, 24576
    s_add_u32 s58, s58, 24576
    s_add_u32 m0, m0, 2048
    s_cmp_lg_u32 m0, 124928
    s_cbranch_scc1 L_dma_31
L_skip_26:
    s_waitcnt lgkmcnt(0)
    s_cmp_lt_u32 s30, 5
    s_cbranch_scc0 L_skip_33
    s_waitcnt vmcnt(0)
L_skip_33:
    s_cmp_eq_u32 s30, 7
    s_cbranch_scc0 L_skip_34
    v_and_b32 v60, 31, v0
    v_cmp_gt_u32 s[64:65], 20, v60
    v_min_u32 v60, 19, v60
    v_lshrrev_b32 v35, 5, v0
    v_lshlrev_b32 v35, 2, v35
    v_add_u32 v35, 160832, v35
    v_lshl_add_u32 v35, v60, 3, v35
    s_mul_i32 s66, s53, 12416
    s_add_u32 s66, s66, s62
    s_add_u32 s66, s66, 70656
    s_add_u32 s67, s66, 12288
    s_lshl_b32 s57, s54, 3
    v_lshrrev_b32 v34, 5, v0
    v_lshlrev_b32 v34, 2, v34
    v_add_u32 v34, s57, v34
    v_and_b32 v60, 31, v0
    v_mov_b32 v61, 0x7f000000
    v_cmp_ne_u32 vcc, 31, v60
    s_nop 1
    v_cndmask_b32 v34, v34, v61, vcc
    v_mov_b32 v61, 0x3f803f80
    s_waitcnt vmcnt(0)
    ds_write_b32 v35, v28
    s_waitcnt lgkmcnt(0)
L_skip_34:
    s_cmp_eq_u32 s30, 5
    s_cbranch_scc0 L_skip_35
    s_waitcnt vmcnt(0)
    s_lshr_b32 s65, s63, 2
    s_sub_u32 s58, s3, 20
    s_cmp_lt_u32 s58, 4
    s_cbranch_scc0 L_skip_36
    s_mov_b32 s67, 0
    s_load_dword s66, s[10:11], 0
    s_load_dword s67, s[10:11], 8192
    s_waitcnt lgkmcnt(1)
    s_sleep 1
    s_mov_b32 s65, s67
L_skip_36:
L_skip_35:
    s_waitcnt vmcnt(36)
    s_barrier
    ds_read_b128 v[88:91], v8 offset:49152
    ds_read_b128 v[92:95], v9 offset:49152
    s_cmp_eq_u32 s30, 6
    s_cbranch_scc0 L_skip_37
    s_mul_i32 s57, s14, 2
    s_mov_b32 m0, 34816
    s_nop 0
    buffer_load_dwordx4 v3, s[48:51], s57 offen offset:0 nt lds
    s_mul_i32 s57, s14, 2
    s_add_u32 s57, s57, s15
    s_mov_b32 m0, 34816
    s_nop 0
    buffer_load_dwordx4 v3, s[48:51], s57 offen offset:1024 nt lds
    s_mov_b32 s57, 786432
    s_mov_b32 s58, 982016
    s_mov_b32 m0, 124928
L_dma_38:
    s_waitcnt vmcnt(22)
L_go_39:
    buffer_load_dwordx4 v5, s[32:35], s57 offen offset:0 nt lds
    buffer_load_dwordx4 v6, s[32:35], s58 offen offset:1024 nt lds
    s_add_u32 s57, s57, 24576
    s_add_u32 s58, s58, 24576
    s_add_u32 m0, m0, 2048
    s_cmp_lg_u32 m0, 141312
    s_cbranch_scc1 L_dma_38
L_skip_37:
    s_waitcnt lgkmcnt(0)
    s_cmp_eq_u32 s30, 7
    s_cbranch_scc0 L_skip_40
    v_cndmask_b32 v29, 0, v28, s[64:65]
    v_dot2_f32_bf16 v33, v29, v61, 0
    v_dot2_f32_bf16 v32, v29, v29, 0
    v_lshlrev_b32 v2, 16, v28
    v_and_b32 v3, 0xffff0000, v28
    s_cmp_eq_u32 s55, 0
    v_permlane32_swap_b32 v33, v32
    v_add_f32 v33, v33, v32
    s_nop 1
    v_add_f32_dpp v33, v33, v33 row_ror:8 row_mask:0xf bank_mask:0xf
    s_nop 1
    v_add_f32_dpp v33, v33, v33 row_ror:4 row_mask:0xf bank_mask:0xf
    s_nop 1
    v_add_f32_dpp v33, v33, v33 row_ror:2 row_mask:0xf bank_mask:0xf
    s_nop 1
    v_add_f32_dpp v33, v33, v33 row_ror:1 row_mask:0xf bank_mask:0xf
    s_nop 1
    v_add_f32_dpp v33, v33, v33 row_bcast:15 row_mask:0xa bank_mask:0xf
    v_min_u32 v33, -2, v33
    s_cbranch_scc1 L_gs_41
    buffer_store_dword v33, v34, s[40:43], s67 offen
L_gb_42:
    s_waitcnt vmcnt(1)
L_skip_40:
    s_cmp_lt_u32 s30, 6
    s_cbranch_scc0 L_skip_43
    s_lshr_b32 s57, s30, 1
    s_mul_i32 s57, s57, 1024
    s_and_b32 s58, s30, 1
    s_lshl_b32 s58, s58, 6
    s_add_u32 s57, s57, s58
    v_lshrrev_b32 v18, 5, v0
    v_mul_u32_u24 v18, 6144, v18
    v_bfe_u32 v60, v0, 3, 1
    v_mul_u32_u24 v60, 3072, v60
    v_add_u32 v18, v60, v18
    v_bfe_u32 v60, v0, 4, 1
    v_lshl_add_u32 v18, v60, 9, v18
    v_bfe_u32 v60, v0, 2, 1
    v_lshl_add_u32 v18, v60, 7, v18
    v_and_b32 v60, 3, v0
    v_lshl_add_u32 v18, v60, 3, v18
    v_add_u32 v18, s57, v18
    v_bfe_u32 v19, v0, 4, 1
    v_mul_u32_u24 v19, 3072, v19
    v_bfe_u32 v60, v0, 3, 1
    v_lshl_add_u32 v19, v60, 9, v19
    v_bfe_u32 v60, v0, 2, 1
    v_lshl_add_u32 v19, v60, 7, v19
    v_and_b32 v60, 3, v0
    v_lshl_add_u32 v19, v60, 3, v19
    v_add_u32 v19, s57, v19
    v_add_u32 v19, 24576, v19
    ds_read_b64_tr_b16 v[28:29], v18 offset:0
    ds_read_b64_tr_b16 v[30:31], v18 offset:256
    ds_read_b64_tr_b16 v[32:33], v18 offset:12288
    ds_read_b64_tr_b16 v[34:35], v18 offset:12544
    ds_read_b64_tr_b16 v[36:37], v19 offset:0
    ds_read_b64_tr_b16 v[38:39], v19 offset:256
    ds_read_b64_tr_b16 v[40:41], v18 offset:32
    ds_read_b64_tr_b16 v[42:43], v18 offset:288
    ds_read_b64_tr_b16 v[44:45], v18 offset:12320
    ds_read_b64_tr_b16 v[46:47], v18 offset:12576
    ds_read_b64_tr_b16 v[48:49], v19 offset:32
    ds_read_b64_tr_b16 v[50:51], v19 offset:288
    v_lshrrev_b32 v52, 4, v0
    v_lshlrev_b32 v52, 5, v52
    v_bfe_u32 v60, v0, 1, 1
    v_lshl_add_u32 v52, v60, 4, v52
    v_and_b32 v60, 1, v0
    v_mul_u32_u24 v60, 192, v60
    v_add_u32 v52, v60, v52
    v_add_u32 v52, 160832, v52
    v_lshrrev_b32 v53, 4, v0
    v_lshlrev_b32 v53, 4, v53
    v_bfe_u32 v60, v0, 1, 1
    v_lshl_add_u32 v53, v60, 3, v53
    v_and_b32 v60, 1, v0
    v_mul_u32_u24 v60, 192, v60
    v_add_u32 v53, v60, v53
    v_add_u32 v53, 160960, v53
    v_mov_b64 v[20:21], 0
    v_mov_b64 v[22:23], 0
    v_mov_b64 v[24:25], 0
    v_mov_b64 v[26:27], 0
    s_lshr_b32 s57, s30, 1
    s_lshl_b32 s57, s57, 11
    s_lshl_b32 s58, s58, 1
    s_add_u32 s57, s57, s58
    s_lshl_b32 s58, s54, 8
    s_add_u32 s57, s57, s58
    v_and_b32 v54, 31, v0
    v_lshlrev_b32 v54, 2, v54
    v_lshrrev_b32 v60, 5, v0
    v_mul_u32_u24 v60, 6144, v60
    v_add_u32 v54, v60, v54
    v_add_u32 v54, s57, v54
    s_mul_i32 s59, s53, 12416
    s_add_u32 s59, s59, s62
    s_add_u32 s59, s59, 70656
    s_add_u32 s60, s59, 12288
    ds_read_b128 v[12:15], v52
    ds_read_b64 v[16:17], v53
    s_waitcnt lgkmcnt(1)
    v_smfmac_f32_16x16x64_bf16 v[20:23], v[12:15], v[28:35], v1
    v_smfmac_f32_16x16x64_bf16 v[24:27], v[12:15], v[40:47], v1
    s_waitcnt lgkmcnt(0)
    v_smfmac_f32_16x16x32_bf16 v[20:23], v[16:17], v[36:39], v1
    v_smfmac_f32_16x16x32_bf16 v[24:27], v[16:17], v[48:51], v1
    s_cmp_eq_u32 s55, 0
    s_nop 5
    v_add_f32 v12, v20, v22
    s_nop 1
    v_add_f32_dpp v12, v24, v26 quad_perm:[0,1,2,3] row_mask:0x2 bank_mask:0xf
    s_nop 1
    v_add_f32_dpp v12, v21, v23 quad_perm:[0,1,2,3] row_mask:0x4 bank_mask:0xf
    s_nop 1
    v_add_f32_dpp v12, v25, v27 quad_perm:[0,1,2,3] row_mask:0x8 bank_mask:0xf
    v_min_u32 v12, -2, v12
    s_cbranch_scc1 L_gs_44
    buffer_store_dword v12, v54, s[40:43], s59 offen
L_gb_45:
L_skip_43:
    s_cmp_eq_u32 s30, 5
    s_cbranch_scc0 L_skip_46
    global_load_dword v2, v3, s[26:27] sc1
L_skip_46:
    s_waitcnt vmcnt(36)
    s_barrier
    ds_read_b128 v[96:99], v8 offset:0
    ds_read_b128 v[100:103], v9 offset:0
    s_cmp_eq_u32 s30, 6
    s_cbranch_scc0 L_skip_47
    s_mul_i32 s57, s14, 3
    s_mov_b32 m0, 36864
    s_nop 0
    buffer_load_dwordx4 v3, s[48:51], s57 offen offset:0 nt lds
    s_mul_i32 s57, s14, 3
    s_add_u32 s57, s57, s15
    s_mov_b32 m0, 36864
    s_nop 0
    buffer_load_dwordx4 v3, s[48:51], s57 offen offset:1024 nt lds
    s_mov_b32 s57, 786560
    s_mov_b32 s58, 982144
    s_mov_b32 m0, 141312
L_dma_48:
    s_waitcnt vmcnt(22)
L_go_49:
    buffer_load_dwordx4 v5, s[32:35], s57 offen offset:0 nt lds
    buffer_load_dwordx4 v6, s[32:35], s58 offen offset:1024 nt lds
    s_add_u32 s57, s57, 24576
    s_add_u32 s58, s58, 24576
    s_add_u32 m0, m0, 2048
    s_cmp_lg_u32 m0, 157696
    s_cbranch_scc1 L_dma_48
L_skip_47:
    s_waitcnt lgkmcnt(0)
    s_waitcnt vmcnt(36)
    s_barrier
    ds_read_b128 v[104:107], v8 offset:16384
    ds_read_b128 v[108:111], v9 offset:16384
    s_cmp_eq_u32 s30, 6
    s_cbranch_scc0 L_skip_50
    s_mul_i32 s57, s14, 4
    s_mov_b32 m0, 38912
    s_nop 0
    buffer_load_dwordx4 v3, s[48:51], s57 offen offset:0 nt lds
    s_mul_i32 s57, s14, 4
    s_add_u32 s57, s57, s15
    s_mov_b32 m0, 38912
    s_nop 0
    buffer_load_dwordx4 v3, s[48:51], s57 offen offset:1024 nt lds
    s_mov_b32 s57, 786688
    s_mov_b32 s58, 982272
    s_mov_b32 m0, 92160
L_dma_51:
    s_waitcnt vmcnt(22)
L_go_52:
    buffer_load_dwordx4 v5, s[32:35], s57 offen offset:0 nt lds
    buffer_load_dwordx4 v6, s[32:35], s58 offen offset:1024 nt lds
    s_add_u32 s57, s57, 24576
    s_add_u32 s58, s58, 24576
    s_add_u32 m0, m0, 2048
    s_cmp_lg_u32 m0, 108544
    s_cbranch_scc1 L_dma_51
L_skip_50:
    s_waitcnt lgkmcnt(0)
    s_cmp_lg_u32 s30, 6
    s_cbranch_scc0 L_skip_53
    s_waitcnt vmcnt(0)
L_skip_53:
    s_waitcnt vmcnt(36)
    s_barrier
    ds_read_b128 v[112:115], v8 offset:32768
    ds_read_b128 v[116:119], v9 offset:32768
    s_cmp_eq_u32 s30, 6
    s_cbranch_scc0 L_skip_54
    s_mul_i32 s57, s14, 5
    s_mov_b32 m0, 40960
    s_nop 0
    buffer_load_dwordx4 v3, s[48:51], s57 offen offset:0 nt lds
    s_mul_i32 s57, s14, 5
    s_add_u32 s57, s57, s15
    s_mov_b32 m0, 40960
    s_nop 0
    buffer_load_dwordx4 v3, s[48:51], s57 offen offset:1024 nt lds
    s_mov_b32 s57, 1179648
    s_mov_b32 s58, 1375232
    s_mov_b32 m0, 108544
L_dma_55:
    s_waitcnt vmcnt(22)
L_go_56:
    buffer_load_dwordx4 v5, s[32:35], s57 offen offset:0 nt lds
    buffer_load_dwordx4 v6, s[32:35], s58 offen offset:1024 nt lds
    s_add_u32 s57, s57, 24576
    s_add_u32 s58, s58, 24576
    s_add_u32 m0, m0, 2048
    s_cmp_lg_u32 m0, 124928
    s_cbranch_scc1 L_dma_55
L_skip_54:
    s_waitcnt lgkmcnt(0)
    s_cmp_eq_u32 s30, 5
    s_cbranch_scc0 L_skip_57
L_cw_58:
    v_readlane_b32 s57, v2, s31
    s_cmp_eq_u32 s57, 0
    s_cbranch_scc1 L_cr_59
    s_lshr_b32 s58, s63, 2
    s_xor_b32 s58, s58, s65
    s_and_b32 s58, s58, 1
    v_mov_b32 v25, s58
    s_sub_u32 s57, s57, 1
    s_cmp_eq_u32 s57, s63
    s_cselect_b32 s64, 1, 0
    s_cbranch_scc0 L_far_60
    s_lshl_b32 s57, s52, 2
    s_add_u32 s57, s57, s72
    s_mov_b64 exec, 1
    buffer_store_dword v25, v0, s[40:43], s57 offen offset:0
    s_mov_b64 exec, -1
L_fb_61:
L_skip_57:
    s_waitcnt vmcnt(36)
    s_barrier
    ds_read_b128 v[120:123], v8 offset:49152
    ds_read_b128 v[124:127], v9 offset:49152
    s_cmp_eq_u32 s30, 6
    s_cbranch_scc0 L_skip_62
    s_mul_i32 s57, s14, 6
    s_mov_b32 m0, 43008
    s_nop 0
    buffer_load_dwordx4 v3, s[48:51], s57 offen offset:0 nt lds
    s_mul_i32 s57, s14, 6
    s_add_u32 s57, s57, s15
    s_mov_b32 m0, 43008
    s_nop 0
    buffer_load_dwordx4 v3, s[48:51], s57 offen offset:1024 nt lds
    s_mov_b32 s57, 1179776
    s_mov_b32 s58, 1375360
    s_mov_b32 m0, 124928
L_dma_63:
    s_waitcnt vmcnt(22)
L_go_64:
    buffer_load_dwordx4 v5, s[32:35], s57 offen offset:0 nt lds
    buffer_load_dwordx4 v6, s[32:35], s58 offen offset:1024 nt lds
    s_add_u32 s57, s57, 24576
    s_add_u32 s58, s58, 24576
    s_add_u32 m0, m0, 2048
    s_cmp_lg_u32 m0, 141312
    s_cbranch_scc1 L_dma_63
L_skip_62:
    s_waitcnt lgkmcnt(0)
    s_waitcnt vmcnt(36)
    s_barrier
    ds_read_b128 v[128:131], v8 offset:0
    ds_read_b128 v[132:135], v9 offset:0
    s_cmp_eq_u32 s30, 6
    s_cbranch_scc0 L_skip_65
    s_mul_i32 s57, s14, 7
    s_mov_b32 m0, 45056
    s_nop 0
    buffer_load_dwordx4 v3, s[48:51], s57 offen offset:0 nt lds
    s_mul_i32 s57, s14, 7
    s_add_u32 s57, s57, s15
    s_mov_b32 m0, 45056
    s_nop 0
    buffer_load_dwordx4 v3, s[48:51], s57 offen offset:1024 nt lds
    s_mov_b32 s57, 1179904
    s_mov_b32 s58, 1375488
    s_mov_b32 m0, 141312
L_dma_66:
    s_waitcnt vmcnt(22)
L_go_67:
    buffer_load_dwordx4 v5, s[32:35], s57 offen offset:0 nt lds
    buffer_load_dwordx4 v6, s[32:35], s58 offen offset:1024 nt lds
    s_add_u32 s57, s57, 24576
    s_add_u32 s58, s58, 24576
    s_add_u32 m0, m0, 2048
    s_cmp_lg_u32 m0, 157696
    s_cbranch_scc1 L_dma_66
L_skip_65:
    s_waitcnt lgkmcnt(0)
    s_cmp_eq_u32 s30, 5
    s_cbranch_scc0 L_skip_68
    v_lshlrev_b32 v24, 2, v0
    buffer_load_dword v2, v24, s[40:43], s72 offen sc1
L_skip_68:
    s_waitcnt vmcnt(36)
    s_barrier
    ds_read_b128 v[136:139], v8 offset:16384
    ds_read_b128 v[140:143], v9 offset:16384
    s_cmp_eq_u32 s30, 6
    s_cbranch_scc0 L_skip_69
    s_mul_i32 s57, s14, 8
    s_mov_b32 m0, 47104
    s_nop 0
    buffer_load_dwordx4 v3, s[48:51], s57 offen offset:0 nt lds
    s_mul_i32 s57, s14, 8
    s_add_u32 s57, s57, s15
    s_mov_b32 m0, 47104
    s_nop 0
    buffer_load_dwordx4 v3, s[48:51], s57 offen offset:1024 nt lds
    s_mov_b32 s57, 0
    s_mov_b32 s58, 392192
    s_mov_b32 m0, 92160
L_dma_70:
    s_waitcnt vmcnt(22)
L_go_71:
    buffer_load_dwordx4 v7, s[36:39], s57 offen offset:0 nt lds
    buffer_load_dwordx4 v7, s[36:39], s58 offen offset:1024 nt lds
    s_add_u32 s57, s57, 24576
    s_add_u32 s58, s58, 24576
    s_add_u32 m0, m0, 2048
    s_cmp_lg_u32 m0, 108544
    s_cbranch_scc1 L_dma_70
L_skip_69:
    s_waitcnt lgkmcnt(0)
    s_waitcnt vmcnt(36)
    s_barrier
    ds_read_b128 v[144:147], v8 offset:32768
    ds_read_b128 v[148:151], v9 offset:32768
    s_cmp_eq_u32 s30, 6
    s_cbranch_scc0 L_skip_72
    s_mul_i32 s57, s14, 9
    s_mov_b32 m0, 49152
    s_nop 0
    buffer_load_dwordx4 v3, s[48:51], s57 offen offset:0 nt lds
    s_mul_i32 s57, s14, 9
    s_add_u32 s57, s57, s15
    s_mov_b32 m0, 49152
    s_nop 0
    buffer_load_dwordx4 v3, s[48:51], s57 offen offset:1024 nt lds
    s_mov_b32 s57, 128
    s_mov_b32 s58, 392320
    s_mov_b32 m0, 108544
L_dma_73:
    s_waitcnt vmcnt(22)
L_go_74:
    buffer_load_dwordx4 v7, s[36:39], s57 offen offset:0 nt lds
    buffer_load_dwordx4 v7, s[36:39], s58 offen offset:1024 nt lds
    s_add_u32 s57, s57, 24576
    s_add_u32 s58, s58, 24576
    s_add_u32 m0, m0, 2048
    s_cmp_lg_u32 m0, 124928
    s_cbranch_scc1 L_dma_73
L_skip_72:
    s_waitcnt lgkmcnt(0)
    s_cmp_eq_u32 s30, 5
    s_cbranch_scc0 L_skip_75
L_cw_76:
    s_waitcnt vmcnt(0)
    v_cmp_ne_u32 vcc, -1, v2
    s_mov_b32 s57, 0
    s_mov_b32 s68, 2
    s_cmp_eq_u32 s64, 0
    s_cbranch_scc1 L_cd_78
    s_cmp_lg_u32 vcc_hi, 0
    s_cbranch_scc1 L_cd_78
    s_cmp_lg_u32 vcc_lo, -1
    s_cbranch_scc1 L_cr_77
    v_cmp_eq_u32 vcc, 1, v2
    s_bcnt1_i32_b32 s68, vcc_lo
    s_mov_b32 s57, 1
L_cd_78:
    v_mov_b32 v37, 160768
    v_mov_b32 v38, s57
    ds_write_b32 v37, v38
    s_waitcnt lgkmcnt(0)
L_skip_75:
    s_waitcnt vmcnt(36)
    s_barrier
    ds_read_b128 v[152:155], v8 offset:49152
    ds_read_b128 v[156:159], v9 offset:49152
    s_cmp_eq_u32 s30, 6
    s_cbranch_scc0 L_skip_79
    s_mul_i32 s57, s14, 10
    s_mov_b32 m0, 51200
    s_nop 0
    buffer_load_dwordx4 v3, s[48:51], s57 offen offset:0 nt lds
    s_mul_i32 s57, s14, 10
    s_add_u32 s57, s57, s15
    s_mov_b32 m0, 51200
    s_nop 0
    buffer_load_dwordx4 v3, s[48:51], s57 offen offset:1024 nt lds
    s_mov_b32 s57, 256
    s_mov_b32 s58, 392448
    s_mov_b32 m0, 124928
L_dma_80:
    s_waitcnt vmcnt(22)
L_go_81:
    buffer_load_dwordx4 v7, s[36:39], s57 offen offset:0 nt lds
    buffer_load_dwordx4 v7, s[36:39], s58 offen offset:1024 nt lds
    s_add_u32 s57, s57, 24576
    s_add_u32 s58, s58, 24576
    s_add_u32 m0, m0, 2048
    s_cmp_lg_u32 m0, 141312
    s_cbranch_scc1 L_dma_80
L_skip_79:
    s_waitcnt lgkmcnt(0)
    v_lshrrev_b32 v8, 2, v0
    v_lshlrev_b32 v8, 7, v8
    v_bfe_u32 v60, v0, 3, 2
    v_lshl_add_u32 v8, v60, 5, v8
    v_and_b32 v60, 3, v0
    v_lshl_add_u32 v8, v60, 3, v8
    v_add_u32 v8, s61, v8
    v_xor_b32 v9, 32, v8
    v_xor_b32 v10, 64, v8
    v_xor_b32 v11, 96, v8
    v_mov_b32 v41, 160768
    ds_read_b32 v42, v41
    s_waitcnt lgkmcnt(0)
    v_readfirstlane_b32 s55, v42
    s_cmp_eq_u32 s55, 0
    s_cbranch_scc1 L_spread
L_spread_back:
    s_cmp_eq_u32 s30, 5
    s_cbranch_scc0 L_skip_93
    s_cmp_eq_u32 s52, 31
    s_cbranch_scc0 L_skip_94
    s_lshl_b32 s57, s31, 5
    v_mov_b32 v16, s57
    s_add_u32 s57, s68, 1
    v_mov_b32 v12, s57
    s_mov_b64 exec, 0x1
    global_store_dword v16, v12, s[26:27] offset:4 sc1
    s_mov_b64 exec, -1
L_skip_94:
L_skip_93:
    s_sub_u32 s58, s30, 1
    s_cmp_lt_u32 s58, 3
    s_cbranch_scc0 L_skip_95
    s_mul_i32 s59, s53, 12416
    s_add_u32 s59, s59, s62
    s_add_u32 s59, s59, 70656
    s_add_u32 s60, s59, 12288
    s_lshl_b32 s57, s58, 11
    v_lshlrev_b32 v48, 4, v0
    v_add_u32 v48, s57, v48
    v_and_b32 v49, 7, v0
    v_lshlrev_b32 v49, 3, v49
    s_add_u32 s57, s59, 6144
    buffer_load_dwordx4 v[12:15], v48, s[40:43], s59 offen offset:0 sc1 nt
    buffer_load_dwordx4 v[16:19], v48, s[40:43], s59 offen offset:1024 sc1 nt
    buffer_load_dwordx4 v[28:31], v48, s[40:43], s57 offen offset:0 sc1 nt
    buffer_load_dwordx4 v[32:35], v48, s[40:43], s57 offen offset:1024 sc1 nt
    buffer_load_dwordx2 v[24:25], v49, s[40:43], s60 offen sc1 nt
L_skip_95:
    s_waitcnt vmcnt(36)
    s_barrier
    ds_read_b64_tr_b16 v[160:161], v8 offset:0
    ds_read_b64_tr_b16 v[168:169], v9 offset:0
    ds_read_b64_tr_b16 v[176:177], v10 offset:0
    ds_read_b64_tr_b16 v[184:185], v11 offset:0
    s_cmp_eq_u32 s30, 6
    s_cbranch_scc0 L_skip_96
    s_mul_i32 s57, s14, 11
    s_mov_b32 m0, 53248
    s_nop 0
    buffer_load_dwordx4 v3, s[48:51], s57 offen offset:0 nt lds
    s_mul_i32 s57, s14, 11
    s_add_u32 s57, s57, s15
    s_mov_b32 m0, 53248
    s_nop 0
    buffer_load_dwordx4 v3, s[48:51], s57 offen offset:1024 nt lds
    s_mov_b32 s57, 196608
    s_mov_b32 s58, 588800
    s_mov_b32 m0, 141312
L_dma_97:
    s_waitcnt vmcnt(22)
L_go_98:
    buffer_load_dwordx4 v7, s[36:39], s57 offen offset:0 nt lds
    buffer_load_dwordx4 v7, s[36:39], s58 offen offset:1024 nt lds
    s_add_u32 s57, s57, 24576
    s_add_u32 s58, s58, 24576
    s_add_u32 m0, m0, 2048
    s_cmp_lg_u32 m0, 157696
    s_cbranch_scc1 L_dma_97
L_skip_96:
    s_waitcnt lgkmcnt(0)
    s_waitcnt vmcnt(36)
    s_barrier
    ds_read_b64_tr_b16 v[192:193], v8 offset:16384
    ds_read_b64_tr_b16 v[200:201], v9 offset:16384
    ds_read_b64_tr_b16 v[208:209], v10 offset:16384
    ds_read_b64_tr_b16 v[216:217], v11 offset:16384
    s_cmp_eq_u32 s30, 6
    s_cbranch_scc0 L_skip_99
    s_mov_b32 s57, 196736
    s_mov_b32 s58, 588928
    s_mov_b32 m0, 92160
L_dma_100:
    s_waitcnt vmcnt(22)
L_go_101:
    buffer_load_dwordx4 v7, s[36:39], s57 offen offset:0 nt lds
    buffer_load_dwordx4 v7, s[36:39], s58 offen offset:1024 nt lds
    s_add_u32 s57, s57, 24576
    s_add_u32 s58, s58, 24576
    s_add_u32 m0, m0, 2048
    s_cmp_lg_u32 m0, 108544
    s_cbranch_scc1 L_dma_100
L_skip_99:
    s_waitcnt lgkmcnt(0)
    s_sub_u32 s58, s30, 1
    s_cmp_lt_u32 s58, 3
    s_cbranch_scc0 L_skip_102
    s_lshl_b32 s57, s58, 7
    v_bfe_u32 v51, v0, 2, 2
    v_lshlrev_b32 v51, 5, v51
    v_lshrrev_b32 v60, 5, v0
    v_lshl_add_u32 v51, v60, 4, v51
    v_and_b32 v60, 3, v0
    v_lshl_add_u32 v51, v60, 2, v51
    v_bfe_u32 v60, v0, 4, 1
    v_lshl_add_u32 v51, v60, 1, v51
    v_add_u32 v51, s57, v51
    v_add_u32 v51, 157696, v51
    v_mov_b32 v60, 0x3c75e03e
    v_mov_b32 v61, 0x3a71d1e6
    v_mov_b32 v47, 0x3e13985d
    s_waitcnt vmcnt(0)
    v_pk_add_f32 v[36:37], v[28:29], v[32:33]
    v_pk_add_f32 v[38:39], v[30:31], v[34:35]
    s_nop 1
    v_permlane32_swap_b32 v36, v38
    v_permlane32_swap_b32 v37, v39
    v_pk_add_f32 v[36:37], v[36:37], v[38:39]
    s_nop 1
    v_permlane16_swap_b32 v36, v37
    v_add_f32 v36, v36, v37
    v_mul_f32 v6, 0x3dd53b95, v36
    v_add_f32_dpp v48, v24, v24 row_ror:4 row_mask:0xf bank_mask:0xf
    v_add_f32_dpp v49, v25, v25 row_ror:4 row_mask:0xf bank_mask:0xf
    v_pk_add_f32 v[20:21], v[12:13], v[16:17]
    v_pk_add_f32 v[22:23], v[14:15], v[18:19]
    v_add_f32_dpp v48, v48, v48 row_ror:2 row_mask:0xf bank_mask:0xf
    v_add_f32_dpp v49, v49, v49 row_ror:2 row_mask:0xf bank_mask:0xf
    v_permlane32_swap_b32 v20, v22
    v_permlane32_swap_b32 v21, v23
    v_add_f32_dpp v48, v48, v48 row_ror:1 row_mask:0xf bank_mask:0xf
    v_add_f32_dpp v49, v49, v49 row_ror:1 row_mask:0xf bank_mask:0xf
    v_pk_add_f32 v[20:21], v[20:21], v[22:23]
    v_mul_f32 v48, v48, v60
    v_fma_f32 v49, v49, v47, v61
    v_permlane16_swap_b32 v20, v21
    v_fma_f32 v49, -v48, v48, v49
    v_add_f32 v20, v20, v21
    v_max_f32 v49, v49, v61
    v_mul_f32 v50, v6, v48
    v_rsq_f32 v49, v49
    v_cmp_u_f32 vcc, v20, v20
    v_sub_f32 v20, v20, v50
    v_mul_f32 v20, v20, v49
    v_cvt_pk_bf16_f32 v20, v20, v20
    ds_write_b16 v51, v20
    s_waitcnt lgkmcnt(0)
L_skip_102:
    s_lshl_b32 s57, s30, 7
    s_add_u32 s57, s57, 158720
    v_lshrrev_b32 v58, 4, v0
    v_lshlrev_b32 v58, 5, v58
    v_bfe_u32 v60, v0, 1, 1
    v_lshl_add_u32 v58, v60, 4, v58
    v_bfe_u32 v60, v0, 2, 2
    v_lshl_add_u32 v58, v60, 2, v58
    v_and_b32 v60, 1, v0
    v_lshl_add_u32 v58, v60, 1, v58
    v_add_u32 v58, s57, v58
    v_lshrrev_b32 v61, 4, v0
    v_lshlrev_b32 v61, 5, v61
    v_bfe_u32 v60, v0, 1, 1
    v_lshl_add_u32 v61, v60, 4, v61
    v_add_u32 v61, s57, v61
    v_bfe_u32 v62, v0, 2, 2
    v_lshlrev_b32 v62, 1, v62
    v_and_b32 v60, 1, v0
    v_lshl_add_u32 v62, v60, 0, v62
    v_mov_b32 v60, 160992
    v_cmp_eq_u32 vcc, 0, v62
    s_nop 1
    v_cndmask_b32 v52, v60, v61, vcc
    v_cmp_eq_u32 vcc, 1, v62
    s_nop 1
    v_cndmask_b32 v53, v60, v61, vcc
    v_cmp_eq_u32 vcc, 2, v62
    s_nop 1
    v_cndmask_b32 v54, v60, v61, vcc
    v_cmp_eq_u32 vcc, 3, v62
    s_nop 1
    v_cndmask_b32 v55, v60, v61, vcc
    v_cmp_eq_u32 vcc, 4, v62
    s_nop 1
    v_cndmask_b32 v56, v60, v61, vcc
    v_cmp_eq_u32 vcc, 5, v62
    s_nop 1
    v_cndmask_b32 v57, v60, v61, vcc
    s_lshl_b32 s58, s30, 2
    s_add_u32 s58, s58, 159744
    v_mov_b32 v60, s58
    v_lshlrev_b32 v59, 2, v0
    v_add_u32 v59, 158208, v59
    v_cmp_eq_u32 vcc, 63, v0
    s_nop 1
    v_cndmask_b32 v59, v59, v60, vcc
    v_and_b32 v62, 7, v0
    v_lshlrev_b32 v62, 2, v62
    v_add_u32 v62, 159744, v62
    s_lshl_b32 s57, s30, 11
    v_lshlrev_b32 v63, 4, v0
    v_add_u32 v63, s57, v63
    v_add_u32 v63, 92160, v63
    s_waitcnt vmcnt(34)
    s_barrier
    ds_read_b64_tr_b16 v[224:225], v8 offset:32768
    ds_read_b64_tr_b16 v[232:233], v9 offset:32768
    ds_read_b64_tr_b16 v[240:241], v10 offset:32768
    ds_read_b64_tr_b16 v[248:249], v11 offset:32768
    s_cmp_eq_u32 s30, 6
    s_cbranch_scc0 L_skip_103
    s_mov_b32 s57, 196864
    s_mov_b32 s58, 589056
    s_mov_b32 m0, 108544
L_dma_104:
    s_nop 0
    buffer_load_dwordx4 v7, s[36:39], s57 offen offset:0 nt lds
    buffer_load_dwordx4 v7, s[36:39], s58 offen offset:1024 nt lds
    s_add_u32 s57, s57, 24576
    s_add_u32 s58, s58, 24576
    s_add_u32 m0, m0, 2048
    s_cmp_lg_u32 m0, 124928
    s_cbranch_scc1 L_dma_104
L_skip_103:
    s_waitcnt lgkmcnt(0)
    v_lshrrev_b32 v5, 4, v0
    v_lshlrev_b32 v5, 5, v5
    v_bfe_u32 v60, v0, 1, 1
    v_lshl_add_u32 v5, v60, 4, v5
    v_add_u32 v5, 157696, v5
    ds_read_b128 v[12:15], v5 offset:0
    ds_read_b128 v[16:19], v5 offset:128
    ds_read_b128 v[20:23], v5 offset:256
    v_mov_b64 v[24:25], 0
    v_mov_b64 v[26:27], 0
    v_mov_b64 v[28:29], 0
    v_mov_b64 v[30:31], 0
    v_mov_b64 v[32:33], 0
    v_mov_b64 v[34:35], 0
    v_mov_b64 v[36:37], 0
    v_mov_b64 v[38:39], 0
    v_mov_b64 v[40:41], 0
    v_mov_b64 v[42:43], 0
    v_mov_b64 v[44:45], 0
    v_mov_b64 v[46:47], 0
    s_waitcnt lgkmcnt(0)
    v_smfmac_f32_16x16x64_bf16 v[24:27], v[12:15], v[64:71], v1
    v_smfmac_f32_16x16x64_bf16 v[24:27], v[16:19], v[72:79], v1
    v_smfmac_f32_16x16x64_bf16 v[24:27], v[20:23], v[80:87], v1
    v_smfmac_f32_16x16x64_bf16 v[28:31], v[12:15], v[88:95], v1
    v_smfmac_f32_16x16x64_bf16 v[28:31], v[16:19], v[96:103], v1
    v_smfmac_f32_16x16x64_bf16 v[28:31], v[20:23], v[104:111], v1
    v_smfmac_f32_16x16x64_bf16 v[32:35], v[12:15], v[112:119], v1
    v_smfmac_f32_16x16x64_bf16 v[32:35], v[16:19], v[120:127], v1
    v_smfmac_f32_16x16x64_bf16 v[32:35], v[20:23], v[128:135], v1
    v_smfmac_f32_16x16x64_bf16 v[36:39], v[12:15], v[136:143], v1
    v_smfmac_f32_16x16x64_bf16 v[36:39], v[16:19], v[144:151], v1
    v_smfmac_f32_16x16x64_bf16 v[36:39], v[20:23], v[152:159], v1
    v_add_f32 v24, v24, v26
    s_nop 0
    v_add_f32 v28, v28, v30
    s_nop 1
    v_add_f32 v32, v32, v34
    v_max3_f32 v61, v24, v28, v32
    v_mov_b32_dpp v24, v28 quad_perm:[0,1,2,3] row_mask:0x2 bank_mask:0xf
    v_add_f32 v36, v36, v38
    v_max_f32 v61, v61, v36
    v_mov_b32_dpp v24, v32 quad_perm:[0,1,2,3] row_mask:0x4 bank_mask:0xf
    s_nop 0
    v_max_f32_dpp v61, v61, v61 row_ror:8 row_mask:0xf bank_mask:0xf
    s_nop 0
    v_mov_b32_dpp v24, v36 quad_perm:[0,1,2,3] row_mask:0x8 bank_mask:0xf
    v_max_f32_dpp v61, v61, v61 row_ror:4 row_mask:0xf bank_mask:0xf
    s_nop 1
    v_max_f32_dpp v61, v61, v61 row_ror:2 row_mask:0xf bank_mask:0xf
    s_nop 1
    v_max_f32_dpp v61, v61, v61 row_ror:1 row_mask:0xf bank_mask:0xf
    v_sub_f32 v36, v24, v61
    ds_write_b32 v59, v61
    v_exp_f32 v36, v36
    s_nop 0
    v_cvt_pk_bf16_f32 v39, v36, v36
    ds_write_b16 v58, v39
    ds_read_b128 v[12:15], v52
    ds_read_b128 v[16:19], v53
    ds_read_b128 v[20:23], v54
    ds_read_b128 v[24:27], v55
    ds_read_b128 v[28:31], v56
    ds_read_b128 v[32:35], v57
    v_add_f32_dpp v38, v36, v36 row_ror:8 row_mask:0xf bank_mask:0xf
    s_nop 1
    v_add_f32_dpp v38, v38, v38 row_ror:4 row_mask:0xf bank_mask:0xf
    s_nop 1
    v_add_f32_dpp v38, v38, v38 row_ror:2 row_mask:0xf bank_mask:0xf
    s_nop 1
    v_add_f32_dpp v38, v38, v38 row_ror:1 row_mask:0xf bank_mask:0xf
    s_nop 1
    v_add_f32_dpp v38, v38, v38 row_bcast:15 row_mask:0xa bank_mask:0xf
    s_nop 1
    v_add_f32_dpp v38, v38, v38 row_bcast:31 row_mask:0xc bank_mask:0xf
    s_waitcnt lgkmcnt(0)
    s_waitcnt vmcnt(32)
    s_barrier
    ds_read_b64_tr_b16 v[162:163], v8 offset:49152
    ds_read_b64_tr_b16 v[170:171], v9 offset:49152
    ds_read_b64_tr_b16 v[178:179], v10 offset:49152
    ds_read_b64_tr_b16 v[186:187], v11 offset:49152
    s_cmp_eq_u32 s30, 6
    s_cbranch_scc0 L_skip_105
    s_mov_b32 s57, 786432
    s_mov_b32 s58, 1178624
    s_mov_b32 m0, 124928
L_dma_106:
    s_nop 0
    buffer_load_dwordx4 v7, s[36:39], s57 offen offset:0 nt lds
    buffer_load_dwordx4 v7, s[36:39], s58 offen offset:1024 nt lds
    s_add_u32 s57, s57, 24576
    s_add_u32 s58, s58, 24576
    s_add_u32 m0, m0, 2048
    s_cmp_lg_u32 m0, 141312
    s_cbranch_scc1 L_dma_106
L_skip_105:
    s_waitcnt lgkmcnt(0)
    ds_read_b32 v36, v62
    s_waitcnt lgkmcnt(0)
    v_max_f32_dpp v37, v36, v36 row_ror:4 row_mask:0xf bank_mask:0xf
    s_nop 1
    v_max_f32_dpp v37, v37, v37 row_ror:2 row_mask:0xf bank_mask:0xf
    s_nop 1
    v_max_f32_dpp v37, v37, v37 row_ror:1 row_mask:0xf bank_mask:0xf
    v_sub_f32 v39, v61, v37
    v_exp_f32 v39, v39
    s_cmp_lt_u32 s30, 2
    s_cbranch_scc0 L_skip_107
    s_lshl_b32 s57, s30, 3
    v_lshlrev_b32 v2, 4, v0
    v_add_u32 v2, s57, v2
    v_add_u32 v2, 92160, v2
    v_mov_b32 v60, 94192
    v_cmp_le_u32 vcc, 48, v0
    s_nop 1
    v_cndmask_b32 v2, v2, v60, vcc
    s_lshr_b32 s57, s54, 1
    s_lshl_b32 s57, s57, 2
    s_and_b32 s58, s54, 1
    s_add_u32 s57, s57, s58
    s_lshl_b32 s58, s57, 4
    s_lshl_b32 s57, s57, 3
    v_bfe_u32 v3, v0, 3, 2
    v_lshlrev_b32 v3, 8, v3
    v_bfe_u32 v61, v0, 2, 1
    v_lshl_add_u32 v3, v61, 5, v3
    v_and_b32 v61, 3, v0
    v_lshl_add_u32 v3, v61, 2, v3
    v_add_u32 v3, s58, v3
    v_bfe_u32 v60, v0, 3, 1
    v_lshlrev_b32 v60, 8, v60
    v_bfe_u32 v61, v0, 1, 1
    v_lshl_add_u32 v60, v61, 7, v60
    v_bfe_u32 v61, v0, 2, 1
    v_lshl_add_u32 v60, v61, 4, v60
    v_and_b32 v61, 1, v0
    v_lshl_add_u32 v60, v61, 2, v60
    v_add_u32 v60, s57, v60
    v_add_u32 v60, 1024, v60
    v_cmp_gt_u32 vcc, 32, v0
    s_nop 1
    v_cndmask_b32 v3, v60, v3, vcc
    s_lshl_b32 s57, s53, 1
    s_add_u32 s57, s57, s30
    s_mul_i32 s57, s57, 1664
    s_add_u32 s57, s57, s62
    v_add_u32 v3, s57, v3
    v_mov_b32 v60, 0x7f000000
    v_cmp_le_u32 vcc, 48, v0
    s_nop 1
    v_cndmask_b32 v3, v3, v60, vcc
    s_lshl_b32 s58, s54, 2
    s_add_u32 s57, s57, s58
    s_add_u32 s57, s57, 1536
    v_mov_b32 v4, s57
    v_mov_b32 v60, 0x7f000000
    v_cmp_ne_u32 vcc, 48, v0
    s_nop 1
    v_cndmask_b32 v4, v4, v60, vcc
    s_mov_b32 s58, 0
    v_min_u32 v37, -2, v37
    s_cmp_eq_u32 s55, 0
    s_cbranch_scc1 L_gs_108
    buffer_store_dword v37, v4, s[40:43], s58 offen
L_gb_109:
L_skip_107:
    s_cmp_eq_u32 s30, 2
    s_cbranch_scc0 L_skip_110
    v_lshlrev_b32 v2, 2, v0
    v_add_u32 v2, 157696, v2
    v_and_b32 v3, 15, v0
    v_lshlrev_b32 v3, 2, v3
    v_lshrrev_b32 v60, 5, v0
    v_lshl_add_u32 v3, v60, 6, v3
    v_bfe_u32 v60, v0, 4, 1
    v_lshl_add_u32 v3, v60, 13, v3
L_skip_110:
    s_waitcnt vmcnt(32)
    s_barrier
    ds_read_b64_tr_b16 v[194:195], v8 offset:0
    ds_read_b64_tr_b16 v[202:203], v9 offset:0
    ds_read_b64_tr_b16 v[210:211], v10 offset:0
    ds_read_b64_tr_b16 v[218:219], v11 offset:0
    s_cmp_eq_u32 s30, 6
    s_cbranch_scc0 L_skip_111
    s_mov_b32 s57, 786560
    s_mov_b32 s58, 1178752
    s_mov_b32 m0, 141312
L_dma_112:
    s_nop 0
    buffer_load_dwordx4 v7, s[36:39], s57 offen offset:0 nt lds
    buffer_load_dwordx4 v7, s[36:39], s58 offen offset:1024 nt lds
    s_add_u32 s57, s57, 24576
    s_add_u32 s58, s58, 24576
    s_add_u32 m0, m0, 2048
    s_cmp_lg_u32 m0, 157696
    s_cbranch_scc1 L_dma_112
L_skip_111:
    s_waitcnt lgkmcnt(0)
    s_waitcnt vmcnt(32)
    s_barrier
    ds_read_b64_tr_b16 v[226:227], v8 offset:16384
    ds_read_b64_tr_b16 v[234:235], v9 offset:16384
    ds_read_b64_tr_b16 v[242:243], v10 offset:16384
    ds_read_b64_tr_b16 v[250:251], v11 offset:16384
    s_cmp_eq_u32 s30, 6
    s_cbranch_scc0 L_skip_113
    s_mov_b32 s57, 786688
    s_mov_b32 s58, 1178880
    s_mov_b32 m0, 92160
L_dma_114:
    s_nop 0
    buffer_load_dwordx4 v7, s[36:39], s57 offen offset:0 nt lds
    buffer_load_dwordx4 v7, s[36:39], s58 offen offset:1024 nt lds
    s_add_u32 s57, s57, 24576
    s_add_u32 s58, s58, 24576
    s_add_u32 m0, m0, 2048
    s_cmp_lg_u32 m0, 108544
    s_cbranch_scc1 L_dma_114
L_skip_113:
    s_waitcnt lgkmcnt(0)
    s_cmp_eq_u32 s30, 5
    s_cbranch_scc0 L_skip_115
    global_load_dword v2, v3, s[26:27] offset:4 sc1
L_skip_115:
    s_waitcnt vmcnt(32)
    s_barrier
    ds_read_b64_tr_b16 v[164:165], v8 offset:32768
    ds_read_b64_tr_b16 v[172:173], v9 offset:32768
    ds_read_b64_tr_b16 v[180:181], v10 offset:32768
    ds_read_b64_tr_b16 v[188:189], v11 offset:32768
    s_cmp_eq_u32 s30, 6
    s_cbranch_scc0 L_skip_116
    s_mov_b32 s57, 983040
    s_mov_b32 s58, 1375232
    s_mov_b32 m0, 108544
L_dma_117:
    s_nop 0
    buffer_load_dwordx4 v7, s[36:39], s57 offen offset:0 nt lds
    buffer_load_dwordx4 v7, s[36:39], s58 offen offset:1024 nt lds
    s_add_u32 s57, s57, 24576
    s_add_u32 s58, s58, 24576
    s_add_u32 m0, m0, 2048
    s_cmp_lg_u32 m0, 124928
    s_cbranch_scc1 L_dma_117
L_skip_116:
    s_waitcnt lgkmcnt(0)
    s_waitcnt vmcnt(32)
    s_barrier
    ds_read_b64_tr_b16 v[196:197], v8 offset:49152
    ds_read_b64_tr_b16 v[204:205], v9 offset:49152
    ds_read_b64_tr_b16 v[212:213], v10 offset:49152
    ds_read_b64_tr_b16 v[220:221], v11 offset:49152
    s_cmp_eq_u32 s30, 6
    s_cbranch_scc0 L_skip_118
    s_mov_b32 s57, 983168
    s_mov_b32 s58, 1375360
    s_mov_b32 m0, 124928
L_dma_119:
    s_nop 0
    buffer_load_dwordx4 v7, s[36:39], s57 offen offset:0 nt lds
    buffer_load_dwordx4 v7, s[36:39], s58 offen offset:1024 nt lds
    s_add_u32 s57, s57, 24576
    s_add_u32 s58, s58, 24576
    s_add_u32 m0, m0, 2048
    s_cmp_lg_u32 m0, 141312
    s_cbranch_scc1 L_dma_119
L_skip_118:
    s_waitcnt lgkmcnt(0)
    s_cmp_eq_u32 s30, 5
    s_cbranch_scc0 L_skip_120
L_cw_121:
    s_waitcnt vmcnt(0)
    v_cmp_eq_u32 vcc, 0, v2
    s_cbranch_vccnz L_cr_122
    v_add_u32_dpp v2, v2, v2 row_ror:4 row_mask:0xf bank_mask:0xf
    s_nop 1
    v_add_u32_dpp v2, v2, v2 row_ror:2 row_mask:0xf bank_mask:0xf
    s_nop 1
    v_add_u32_dpp v2, v2, v2 row_ror:1 row_mask:0xf bank_mask:0xf
    v_mov_b32 v60, 160772
    ds_write_b32 v60, v2
    s_waitcnt lgkmcnt(0)
L_skip_120:
    s_cmp_lt_u32 s3, 20
    s_cbranch_scc0 L_skip_123
    s_mul_i32 s74, s30, 1664
    s_add_u32 s74, s74, s62
    s_add_u32 s74, s74, 0
    v_and_b32 v56, 7, v0
    v_lshlrev_b32 v56, 2, v56
    v_lshrrev_b32 v62, 4, v0
    v_lshlrev_b32 v62, 3, v62
    s_cmp_lg_u32 s30, 6
    s_cbranch_scc0 L_skip_123
    buffer_load_dword v52, v56, s[40:43], s74 offen offset:1536 sc1
    buffer_load_dwordx2 v[54:55], v62, s[40:43], s74 offen offset:1536 sc1
L_skip_123:
    s_cmp_eq_u32 s30, 2
    s_cbranch_scc0 L_skip_124
    s_sub_u32 s57, s3, 20
    s_cmp_lt_u32 s57, 4
    s_cbranch_scc0 L_skip_125
    s_sub_u32 s57, s3, 20
    s_lshl_b32 s57, s57, 6
    v_add_u32 v50, s57, v0
    v_min_u32 v50, 207, v50
    v_lshlrev_b32 v50, 7, v50
    s_add_u32 s57, s62, 0
    buffer_load_dword v50, v50, s[40:43], s57 offen sc1 nt
    s_sub_u32 s57, s3, 20
    s_lshl_b32 s57, s57, 6
    v_add_u32 v51, s57, v0
    v_min_u32 v51, 151, v51
    v_lshlrev_b32 v51, 7, v51
    s_add_u32 s57, s62, 26624
    buffer_load_dword v51, v51, s[40:43], s57 offen sc1 nt
    s_sub_u32 s57, s3, 20
    s_lshl_b32 s57, s57, 6
    v_add_u32 v49, s57, v0
    v_min_u32 v49, 191, v49
    v_lshlrev_b32 v49, 7, v49
    s_add_u32 s57, s62, 46080
    buffer_load_dword v49, v49, s[40:43], s57 offen sc1 nt
L_skip_125:
L_skip_124:
    s_waitcnt vmcnt(32)
    s_barrier
    ds_read_b64_tr_b16 v[228:229], v8 offset:0
    ds_read_b64_tr_b16 v[236:237], v9 offset:0
    ds_read_b64_tr_b16 v[244:245], v10 offset:0
    ds_read_b64_tr_b16 v[252:253], v11 offset:0
    s_cmp_eq_u32 s30, 6
    s_cbranch_scc0 L_skip_126
    s_mov_b32 s57, 983296
    s_mov_b32 s58, 1375488
    s_mov_b32 m0, 141312
L_dma_127:
    s_nop 0
    buffer_load_dwordx4 v7, s[36:39], s57 offen offset:0 nt lds
    buffer_load_dwordx4 v7, s[36:39], s58 offen offset:1024 nt lds
    s_add_u32 s57, s57, 24576
    s_add_u32 s58, s58, 24576
    s_add_u32 m0, m0, 2048
    s_cmp_lg_u32 m0, 157696
    s_cbranch_scc1 L_dma_127
L_skip_126:
    s_waitcnt lgkmcnt(0)
    s_cmp_ge_u32 s30, 6
    s_cbranch_scc0 L_skip_128
    v_mov_b32 v60, 160772
    ds_read_b32 v60, v60
    s_lshr_b32 s58, s63, 2
    s_waitcnt lgkmcnt(0)
    v_readfirstlane_b32 s57, v60
    s_cmp_gt_u32 s57, 24
    s_cselect_b32 s57, 1, 0
    s_xor_b32 s57, s57, s58
    s_lshl_b32 s57, s57, 13
    s_add_u32 s7, s8, s57
L_skip_128:
    s_branch L_tail
.p2align 10
L_tail:
L_pad0:
    s_cbranch_execz L_pad4
    s_waitcnt vmcnt(32)
    s_barrier
    ds_read_b64_tr_b16 v[166:167], v8 offset:16384
    ds_read_b64_tr_b16 v[174:175], v9 offset:16384
    ds_read_b64_tr_b16 v[182:183], v10 offset:16384
    ds_read_b64_tr_b16 v[190:191], v11 offset:16384
    s_waitcnt lgkmcnt(0)
    s_cmp_lt_u32 s30, 5
    s_cbranch_scc0 L_skip_129
    s_waitcnt vmcnt(0)
L_skip_129:
    s_cmp_lt_u32 s3, 20
    s_cbranch_scc0 L_skip_130
    v_lshlrev_b32 v57, 4, v0
    v_lshlrev_b32 v58, 3, v0
    s_mul_i32 s57, s30, 6144
    s_add_u32 s57, s57, 30720
    v_lshrrev_b32 v59, 2, v0
    v_lshlrev_b32 v59, 6, v59
    v_bfe_u32 v53, v0, 4, 1
    v_lshl_add_u32 v59, v53, 5, v59
    v_and_b32 v53, 3, v0
    v_lshl_add_u32 v59, v53, 3, v59
    v_add_u32 v59, s57, v59
    v_xor_b32 v60, 32, v59
    s_lshl_b32 s57, s30, 8
    s_add_u32 s57, s57, 157696
    v_lshl_add_u32 v61, v0, 2, s57
    s_cmp_lg_u32 s30, 6
    s_cbranch_scc0 L_skip_130
L_cw_131:
    s_waitcnt vmcnt(0)
    v_max3_u32 v53, v52, v54, v55
    v_cmp_eq_u32 vcc, -1, v53
    s_cbranch_vccnz L_cr_132
    v_max_f32_dpp v53, v52, v52 row_ror:4 row_mask:0xf bank_mask:0xf
    s_nop 1
    v_max_f32_dpp v53, v53, v53 row_ror:2 row_mask:0xf bank_mask:0xf
    s_nop 1
    v_max_f32_dpp v53, v53, v53 row_ror:1 row_mask:0xf bank_mask:0xf
    v_sub_f32 v52, v52, v53
    v_sub_f32 v54, v54, v53
    v_sub_f32 v55, v55, v53
    v_exp_f32 v52, v52
    v_exp_f32 v54, v54
    v_exp_f32 v55, v55
    s_cmp_eq_u32 s30, 7
    s_cbranch_scc0 L_skip_130
    v_add_u32 v62, 158720, v57
    ds_write_b128 v62, v[52:55]
    s_waitcnt lgkmcnt(0)
L_skip_130:
    v_smfmac_f32_16x16x64_bf16 v[40:43], v[12:15], v[160:167], v1
    v_smfmac_f32_16x16x64_bf16 v[40:43], v[16:19], v[168:175], v1
    v_smfmac_f32_16x16x64_bf16 v[40:43], v[20:23], v[176:183], v1
    v_smfmac_f32_16x16x64_bf16 v[40:43], v[24:27], v[184:191], v1
    s_cmp_eq_u32 s30, 6
    s_cbranch_scc0 L_skip_133
    s_mul_i32 s57, s14, 12
    s_add_u32 s58, s57, s15
    s_mov_b32 m0, 55296
L_dma_134:
    s_nop 0
    buffer_load_dwordx4 v3, s[48:51], s57 offen offset:0 nt lds
    buffer_load_dwordx4 v3, s[48:51], s58 offen offset:1024 nt lds
    s_add_u32 s57, s57, s14
    s_add_u32 s58, s58, s14
    s_add_u32 m0, m0, 2048
    s_cmp_lg_u32 m0, 67584
    s_cbranch_scc1 L_dma_134
    s_mul_i32 s57, s14, 18
    s_add_u32 s58, s57, s15
    s_mov_b32 m0, 67584
L_dma_135:
    s_nop 0
    buffer_load_dwordx4 v3, s[48:51], s57 offen offset:0 nt lds
    buffer_load_dwordx4 v3, s[48:51], s58 offen offset:1024 nt lds
    s_add_u32 s57, s57, s14
    s_add_u32 s58, s58, s14
    s_add_u32 m0, m0, 2048
    s_cmp_lg_u32 m0, 79872
    s_cbranch_scc1 L_dma_135
L_skip_133:
    s_waitcnt vmcnt(40)
    s_barrier
    ds_read_b64_tr_b16 v[198:199], v8 offset:32768
    ds_read_b64_tr_b16 v[206:207], v9 offset:32768
    ds_read_b64_tr_b16 v[214:215], v10 offset:32768
    ds_read_b64_tr_b16 v[222:223], v11 offset:32768
    s_waitcnt lgkmcnt(0)
    s_cmp_lt_u32 s3, 20
    s_cbranch_scc0 L_skip_136
    s_cmp_eq_u32 s30, 6
    s_cbranch_scc0 L_skip_136
    v_add_u32 v62, 158720, v57
    ds_read_b128 v[52:55], v62
L_skip_136:
L_pad1:
    s_cbranch_execz L_pad5
    v_smfmac_f32_16x16x64_bf16 v[40:43], v[28:31], v[192:199], v1
    v_smfmac_f32_16x16x64_bf16 v[40:43], v[32:35], v[200:207], v1
    v_smfmac_f32_16x16x64_bf16 v[44:47], v[12:15], v[208:215], v1
    v_smfmac_f32_16x16x64_bf16 v[44:47], v[16:19], v[216:223], v1
    v_mul_f32 v38, v38, v39
    ds_write_b32 v63, v38 offset:1024
    s_waitcnt vmcnt(24)
    s_barrier
    ds_read_b64_tr_b16 v[230:231], v8 offset:49152
    ds_read_b64_tr_b16 v[238:239], v9 offset:49152
    ds_read_b64_tr_b16 v[246:247], v10 offset:49152
    ds_read_b64_tr_b16 v[254:255], v11 offset:49152
    s_waitcnt lgkmcnt(0)
    v_smfmac_f32_16x16x64_bf16 v[44:47], v[20:23], v[224:231], v1
    v_smfmac_f32_16x16x64_bf16 v[44:47], v[24:27], v[232:239], v1
    v_smfmac_f32_16x16x64_bf16 v[44:47], v[28:31], v[240:247], v1
    v_smfmac_f32_16x16x64_bf16 v[44:47], v[32:35], v[248:255], v1
    s_setprio 0
    s_cmp_lt_u32 s30, 2
    v_pk_add_f32 v[40:41], v[40:41], v[42:43]
    s_nop 4
    v_pk_add_f32 v[42:43], v[44:45], v[46:47]
    v_pk_mul_f32 v[40:41], v[40:41], v[38:39] op_sel:[0,1] op_sel_hi:[1,1]
    v_pk_mul_f32 v[42:43], v[42:43], v[38:39] op_sel:[0,1] op_sel_hi:[1,1]
    ds_write_b128 v63, v[40:43]
    s_cbranch_scc1 L_comb_0
    s_waitcnt lgkmcnt(0)
    s_barrier
L_comb_0b:
    s_cmp_eq_u32 s30, 6
    s_cbranch_scc0 L_skip_141
    s_waitcnt vmcnt(0)
L_skip_141:
    s_barrier
    s_cmp_lt_u32 s3, 20
    s_cbranch_scc0 L_typeB_0
    buffer_load_dwordx4 v[12:15], v57, s[40:43], s74 offen sc1
    buffer_load_dwordx2 v[16:17], v58, s[40:43], s74 offen offset:1024 sc1
    buffer_load_dword v18, v56, s[40:43], s74 offen offset:1568 sc1
    ds_read_b64_tr_b16 v[28:29], v59 offset:0
    ds_read_b64_tr_b16 v[30:31], v59 offset:1024
    ds_read_b64_tr_b16 v[32:33], v59 offset:2048
    ds_read_b64_tr_b16 v[34:35], v59 offset:3072
    ds_read_b64_tr_b16 v[36:37], v59 offset:4096
    ds_read_b64_tr_b16 v[38:39], v59 offset:5120
    ds_read_b64_tr_b16 v[40:41], v60 offset:0
    ds_read_b64_tr_b16 v[42:43], v60 offset:1024
    ds_read_b64_tr_b16 v[44:45], v60 offset:2048
    ds_read_b64_tr_b16 v[46:47], v60 offset:3072
    ds_read_b64_tr_b16 v[48:49], v60 offset:4096
    ds_read_b64_tr_b16 v[50:51], v60 offset:5120
    v_mov_b64 v[20:21], 0
    v_mov_b64 v[22:23], 0
    v_mov_b64 v[24:25], 0
    v_mov_b64 v[26:27], 0
    s_add_u32 s58, s6, 0
    s_waitcnt lgkmcnt(0)
    s_branch L_pw_142
L_pr_143:
    buffer_load_dwordx4 v[12:15], v57, s[40:43], s74 offen sc1
    buffer_load_dwordx2 v[16:17], v58, s[40:43], s74 offen offset:1024 sc1
    buffer_load_dword v18, v56, s[40:43], s74 offen offset:1568 sc1
    s_sub_u32 s56, s56, 1
    s_cbranch_scc1 L_done
L_pw_142:
    s_waitcnt vmcnt(0)
    v_max3_u32 v19, v12, v13, v14
    v_max3_u32 v19, v19, v15, v16
    v_max3_u32 v19, v19, v17, v18
    v_cmp_eq_u32 vcc, -1, v19
    s_cbranch_vccnz L_pr_143
    v_smfmac_f32_16x16x64_bf16 v[20:23], v[12:15], v[28:35], v1
    v_mul_f32 v52, v52, v18
    v_smfmac_f32_16x16x64_bf16 v[24:27], v[12:15], v[40:47], v1
    v_smfmac_f32_16x16x32_bf16 v[20:23], v[16:17], v[36:39], v1
    v_add_f32_dpp v52, v52, v52 row_ror:4 row_mask:0xf bank_mask:0xf
    v_smfmac_f32_16x16x32_bf16 v[24:27], v[16:17], v[48:51], v1
    s_cmp_eq_u32 s30, 2
    v_add_f32_dpp v52, v52, v52 row_ror:2 row_mask:0xf bank_mask:0xf
    s_nop 1
    v_add_f32_dpp v52, v52, v52 row_ror:1 row_mask:0xf bank_mask:0xf
    v_rcp_f32 v52, v52
    v_pk_add_f32 v[20:21], v[20:21], v[22:23]
    s_nop 0
L_pad2:
    s_cbranch_execz L_pad6
    v_pk_add_f32 v[24:25], v[24:25], v[26:27]
    v_pk_mul_f32 v[54:55], v[54:55], v[52:53] op_sel:[0,0] op_sel_hi:[1,0]
    v_mul_f32 v20, v20, v54
    v_mul_f32 v24, v24, v54
    v_fmac_f32 v20, v21, v55
    v_fmac_f32 v24, v25, v55
    s_nop 1
    v_permlane32_swap_b32 v20, v24
    v_add_f32 v20, v20, v24
    ds_write_b32 v61, v20
    s_waitcnt lgkmcnt(0)
    s_barrier
    s_cbranch_scc0 L_finb_144
    ds_read2st64_b32 v[12:13], v2 offset0:0 offset1:1
    ds_read2st64_b32 v[14:15], v2 offset0:2 offset1:3
    ds_read2st64_b32 v[16:17], v2 offset0:4 offset1:5
    ds_read2st64_b32 v[18:19], v2 offset0:6 offset1:7
    s_waitcnt lgkmcnt(2)
    v_pk_add_f32 v[12:13], v[12:13], v[14:15]
    s_waitcnt lgkmcnt(0)
    v_pk_add_f32 v[16:17], v[16:17], v[18:19]
    v_pk_add_f32 v[12:13], v[12:13], v[16:17]
    v_add_f32 v14, v12, v13
    v_add_f32 v15, v12, v13
    s_nop 1
    v_permlane16_swap_b32 v14, v15
    v_add_f32 v12, v14, v15
    v_min_u32 v12, -2, v12
    buffer_store_dword v12, v3, s[40:43], s58 offen sc1
L_finb_144:
    s_sub_u32 s57, s30, 4
    s_cmp_lt_u32 s57, 3
    s_cbranch_scc0 L_skip_145
    s_sub_u32 s60, s30, 4
    s_lshl_b32 s57, s60, 11
    v_lshlrev_b32 v11, 4, v0
    v_add_u32 v11, s57, v11
    s_add_u32 s65, s62, 19456
    buffer_load_dwordx4 v[52:55], v11, s[40:43], s65 offen offset:0 sc1
    buffer_load_dwordx4 v[56:59], v11, s[40:43], s65 offen offset:1024 sc1
    s_lshl_b32 s59, s60, 12
    s_add_u32 s59, s59, 79872
    s_mov_b32 s44, s20
    s_mov_b32 s45, s21
    s_mov_b32 s46, 1966080
    s_mov_b32 s47, 0x20000
    s_mul_i32 s57, s31, 3
    s_add_u32 s57, s57, s60
    s_mul_i32 s57, s57, 81920
    s_lshl_b32 s64, s3, 6
    s_add_u32 s57, s57, s64
    v_lshrrev_b32 v5, 2, v0
    v_mul_u32_u24 v5, 1280, v5
    v_and_b32 v60, 3, v0
    v_lshl_add_u32 v5, v60, 4, v5
    v_add_u32 v5, s57, v5
    s_add_u32 m0, s59, 0
    s_mov_b32 s57, 0
    buffer_load_dwordx4 v5, s[44:47], s57 offen nt lds
    s_add_u32 m0, s59, 1024
    s_mov_b32 s57, 20480
    buffer_load_dwordx4 v5, s[44:47], s57 offen nt lds
    s_add_u32 m0, s59, 2048
    s_mov_b32 s57, 40960
    buffer_load_dwordx4 v5, s[44:47], s57 offen nt lds
    s_add_u32 m0, s59, 3072
    s_mov_b32 s57, 61440
    buffer_load_dwordx4 v5, s[44:47], s57 offen nt lds
    v_bfe_u32 v35, v0, 4, 1
    v_lshlrev_b32 v35, 11, v35
    v_bfe_u32 v60, v0, 2, 2
    v_lshl_add_u32 v35, v60, 8, v35
    v_lshrrev_b32 v60, 5, v0
    v_lshl_add_u32 v35, v60, 6, v35
    v_and_b32 v60, 3, v0
    v_lshl_add_u32 v35, v60, 3, v35
    v_add_u32 v35, s59, v35
    v_mov_b32 v9, 0xbdd2d3e8
    v_mov_b32 v10, 0xc0135761
    s_lshl_b32 s57, s60, 7
    s_add_u32 s57, s57, 159872
    v_lshlrev_b32 v32, 3, v0
    v_add_u32 v32, s57, v32
    v_lshlrev_b32 v33, 3, v0
    v_add_u32 v33, 129024, v33
    v_cmp_gt_u32 vcc, 16, v0
    s_nop 1
    v_cndmask_b32 v32, v33, v32, vcc
    v_and_b32 v33, 15, v0
L_pad3:
    s_cbranch_execz L_pad7
    v_lshlrev_b32 v33, 3, v33
    v_lshrrev_b32 v60, 5, v0
    v_lshl_add_u32 v33, v60, 2, v33
    v_add_u32 v33, 159872, v33
    v_and_b32 v34, 15, v0
    v_lshlrev_b32 v34, 2, v34
    v_lshrrev_b32 v60, 5, v0
    v_lshl_add_u32 v34, v60, 6, v34
    v_bfe_u32 v60, v0, 4, 1
    v_lshl_add_u32 v34, v60, 13, v34
    s_add_u32 s60, s6, 66048
    s_add_u32 s58, s62, 13312
    s_add_u32 s57, s62, 25856
    v_and_b32 v7, 7, v0
    v_lshlrev_b32 v7, 3, v7
    v_mov_b32 v60, 0x3acccccd
    v_mov_b32 v61, 0x3727c5ac
    s_waitcnt vmcnt(0)
    buffer_load_dwordx2 v[24:25], v7, s[40:43], s57 offen sc1
    buffer_load_dwordx4 v[12:15], v11, s[40:43], s58 offen offset:0 sc1
    buffer_load_dwordx4 v[16:19], v11, s[40:43], s58 offen offset:1024 sc1
    ds_read_b64_tr_b16 v[36:37], v35 offset:0
    ds_read_b64_tr_b16 v[38:39], v35 offset:1024
    ds_read_b64_tr_b16 v[40:41], v35 offset:128
    ds_read_b64_tr_b16 v[42:43], v35 offset:1152
    ds_read_b64_tr_b16 v[44:45], v35 offset:32
    ds_read_b64_tr_b16 v[46:47], v35 offset:1056
    ds_read_b64_tr_b16 v[48:49], v35 offset:160
    ds_read_b64_tr_b16 v[50:51], v35 offset:1184
L_sw_148:
    v_max3_u32 v20, v52, v53, v54
    v_max3_u32 v20, v20, v55, v56
    v_max3_u32 v20, v20, v57, v58
    v_max_u32 v20, v20, v59
    v_cmp_eq_u32 vcc, -1, v20
    s_cbranch_vccnz L_sr_149
    v_pk_add_f32 v[28:29], v[52:53], v[56:57]
    v_pk_add_f32 v[30:31], v[54:55], v[58:59]
    s_nop 1
    v_permlane32_swap_b32 v28, v30
    v_permlane32_swap_b32 v29, v31
    v_pk_add_f32 v[28:29], v[28:29], v[30:31]
    s_nop 1
    v_permlane16_swap_b32 v28, v29
    v_add_f32 v28, v28, v29
    v_mov_b64 v[52:53], 0
    v_mov_b64 v[54:55], 0
    v_mov_b64 v[56:57], 0
    v_mov_b64 v[58:59], 0
    s_waitcnt lgkmcnt(0)
L_pr_147:
    buffer_load_dwordx2 v[24:25], v7, s[40:43], s57 offen sc1
    buffer_load_dwordx4 v[12:15], v11, s[40:43], s58 offen offset:0 sc1
    buffer_load_dwordx4 v[16:19], v11, s[40:43], s58 offen offset:1024 sc1
    s_sub_u32 s56, s56, 1
    s_cbranch_scc1 L_done
L_pw_146:
    s_waitcnt vmcnt(3)
    v_max_u32 v20, v24, v25
    v_cmp_eq_u32 vcc, -1, v20
    s_cbranch_vccnz L_pr_147
    buffer_load_dwordx4 v[12:15], v11, s[40:43], s58 offen offset:0 sc1
    buffer_load_dwordx4 v[16:19], v11, s[40:43], s58 offen offset:1024 sc1
    v_add_f32_dpp v2, v24, v24 row_ror:4 row_mask:0xf bank_mask:0xf
    v_add_f32_dpp v3, v25, v25 row_ror:4 row_mask:0xf bank_mask:0xf
    v_pk_add_f32 v[20:21], v[12:13], v[16:17]
    v_pk_add_f32 v[22:23], v[14:15], v[18:19]
    v_add_f32_dpp v2, v2, v2 row_ror:2 row_mask:0xf bank_mask:0xf
    v_add_f32_dpp v3, v3, v3 row_ror:2 row_mask:0xf bank_mask:0xf
    v_permlane32_swap_b32 v20, v22
    v_permlane32_swap_b32 v21, v23
    v_add_f32_dpp v2, v2, v2 row_ror:1 row_mask:0xf bank_mask:0xf
    v_add_f32_dpp v3, v3, v3 row_ror:1 row_mask:0xf bank_mask:0xf
    v_pk_add_f32 v[20:21], v[20:21], v[22:23]
    v_mul_f32 v2, v2, v60
    v_fma_f32 v3, v3, v60, v61
    v_permlane16_swap_b32 v20, v21
    v_fma_f32 v3, -v2, v2, v3
    v_add_f32 v20, v20, v21
    v_max_f32 v3, v3, v61
    v_mul_f32 v26, v28, v2
    v_rsq_f32 v3, v3
    v_cmp_u_f32 vcc, v20, v20
    v_sub_f32 v20, v20, v26
    s_cbranch_vccnz L_hr_150
L_hk_151:
    v_fma_f32 v20, v20, v3, v4
L_pad4:
    s_cbranch_execz L_pad8
    v_mul_f32 v21, v20, v20
    v_fma_f32 v21, v21, v9, v10
    v_mul_f32 v21, v21, v20
    v_exp_f32 v21, v21
    s_nop 0
    v_add_f32 v21, 1.0, v21
    v_rcp_f32 v21, v21
    s_nop 0
    v_mul_f32 v20, v20, v21
    s_nop 1
    v_mov_b32_dpp v21, v20 row_shl:1 row_mask:0xf bank_mask:0xf bound_ctrl:0
    v_cvt_pk_bf16_f32 v28, v20, v21
    s_nop 1
    v_mov_b32_dpp v29, v28 row_shl:4 row_mask:0xf bank_mask:0xf bound_ctrl:0
    v_mov_b32_dpp v30, v28 row_shl:8 row_mask:0xf bank_mask:0xf bound_ctrl:0
    v_mov_b32_dpp v31, v28 row_shl:12 row_mask:0xf bank_mask:0xf bound_ctrl:0
    s_nop 1
    v_smfmac_f32_16x16x64_bf16 v[52:55], v[28:31], v[36:43], v1
    v_smfmac_f32_16x16x64_bf16 v[56:59], v[28:31], v[44:51], v1
    s_cmp_eq_u32 s30, 4
    s_nop 5
    v_add_f32 v22, v52, v54
    v_add_f32 v23, v56, v58
    ds_write_b64 v32, v[22:23]
    s_cbranch_scc0 L_skip_153
L_xw_154:
    ds_read2_b32 v[20:21], v33 offset0:0 offset1:32
    ds_read_b32 v22, v33 offset:256
    s_sub_u32 s56, s56, 1
    s_cbranch_scc1 L_done
    s_waitcnt lgkmcnt(0)
    v_max3_u32 v23, v20, v21, v22
    v_add_f32 v20, v20, v21
    v_cmp_eq_u32 vcc, -1, v23
    v_add_f32 v20, v20, v22
    s_cbranch_vccnz L_xw_154
    v_min_u32 v20, -2, v20
    buffer_store_dword v20, v34, s[40:43], s60 offen sc1
    s_waitcnt vmcnt(1)
    s_branch L_pe_155
L_skip_153:
    s_waitcnt vmcnt(0)
L_pe_155:
L_skip_145:
    s_branch L_p1
L_typeB_0:
    s_cmp_eq_u32 s53, 3
    s_cbranch_scc0 L_typeC_156
    s_cmp_eq_u32 s30, 7
    s_cbranch_scc1 L_w7_166
    s_cmp_lt_u32 s30, 6
    s_cbranch_scc0 L_skip_168
    s_lshr_b32 s57, s30, 1
    s_mul_i32 s57, s57, 128
    s_and_b32 s58, s30, 1
    s_lshl_b32 s58, s58, 6
    s_add_u32 s57, s57, s58
    v_lshrrev_b32 v18, 5, v0
    v_lshlrev_b32 v18, 13, v18
    v_bfe_u32 v60, v0, 3, 1
    v_lshl_add_u32 v18, v60, 12, v18
    v_bfe_u32 v60, v0, 4, 1
    v_lshl_add_u32 v18, v60, 11, v18
    v_bfe_u32 v60, v0, 2, 1
    v_mul_u32_u24 v60, 384, v60
    v_add_u32 v18, v60, v18
    v_and_b32 v60, 3, v0
    v_lshl_add_u32 v18, v60, 3, v18
    v_add_u32 v18, s57, v18
    v_add_u32 v18, 30720, v18
    v_bfe_u32 v19, v0, 4, 1
    v_lshlrev_b32 v19, 12, v19
    v_bfe_u32 v60, v0, 3, 1
    v_lshl_add_u32 v19, v60, 11, v19
    v_bfe_u32 v60, v0, 2, 1
    v_mul_u32_u24 v60, 384, v60
    v_add_u32 v19, v60, v19
    v_and_b32 v60, 3, v0
    v_lshl_add_u32 v19, v60, 3, v19
    v_add_u32 v19, s57, v19
    v_add_u32 v19, 63488, v19
    ds_read_b64_tr_b16 v[28:29], v18 offset:0
    ds_read_b64_tr_b16 v[30:31], v18 offset:1024
    ds_read_b64_tr_b16 v[32:33], v18 offset:16384
    ds_read_b64_tr_b16 v[34:35], v18 offset:17408
    ds_read_b64_tr_b16 v[36:37], v19 offset:0
    ds_read_b64_tr_b16 v[38:39], v19 offset:1024
    ds_read_b64_tr_b16 v[40:41], v18 offset:32
    ds_read_b64_tr_b16 v[42:43], v18 offset:1056
    ds_read_b64_tr_b16 v[44:45], v18 offset:16416
    ds_read_b64_tr_b16 v[46:47], v18 offset:17440
    ds_read_b64_tr_b16 v[48:49], v19 offset:32
L_pad5:
    s_cbranch_execz L_pad9
    ds_read_b64_tr_b16 v[50:51], v19 offset:1056
    v_lshrrev_b32 v9, 4, v0
    v_lshlrev_b32 v9, 5, v9
    v_bfe_u32 v60, v0, 1, 1
    v_lshl_add_u32 v9, v60, 4, v9
    v_and_b32 v60, 1, v0
    v_mul_u32_u24 v60, 192, v60
    v_add_u32 v9, v60, v9
    v_add_u32 v9, 160832, v9
    v_lshrrev_b32 v10, 4, v0
    v_lshlrev_b32 v10, 4, v10
    v_bfe_u32 v60, v0, 1, 1
    v_lshl_add_u32 v10, v60, 3, v10
    v_and_b32 v60, 1, v0
    v_mul_u32_u24 v60, 192, v60
    v_add_u32 v10, v60, v10
    v_add_u32 v10, 160960, v10
    v_mov_b64 v[20:21], 0
    v_mov_b64 v[22:23], 0
    v_mov_b64 v[24:25], 0
    v_mov_b64 v[26:27], 0
    s_lshr_b32 s57, s30, 1
    s_lshl_b32 s57, s57, 11
    s_lshl_b32 s58, s58, 1
    s_add_u32 s57, s57, s58
    s_lshl_b32 s58, s54, 8
    s_add_u32 s57, s57, s58
    v_and_b32 v11, 31, v0
    v_lshlrev_b32 v11, 2, v11
    v_lshrrev_b32 v60, 5, v0
    v_lshl_add_u32 v11, v60, 30, v11
    v_add_u32 v11, s57, v11
    s_add_u32 s59, s62, 13312
    s_add_u32 s60, s62, 25856
    ds_read_b128 v[12:15], v9
    ds_read_b64 v[16:17], v10
    s_waitcnt lgkmcnt(1)
    v_smfmac_f32_16x16x64_bf16 v[20:23], v[12:15], v[28:35], v1
    v_smfmac_f32_16x16x64_bf16 v[24:27], v[12:15], v[40:47], v1
    s_waitcnt lgkmcnt(0)
    v_smfmac_f32_16x16x32_bf16 v[20:23], v[16:17], v[36:39], v1
    v_smfmac_f32_16x16x32_bf16 v[24:27], v[16:17], v[48:51], v1
    s_add_u32 s60, s62, 19456
    s_cmp_eq_u32 s55, 0
    s_nop 4
    v_add_f32 v12, v21, v23
    s_nop 1
    v_add_f32_dpp v12, v25, v27 quad_perm:[0,1,2,3] row_mask:0x2 bank_mask:0xf
    v_min_u32 v12, -2, v12
    s_cbranch_scc1 L_gs_169
    buffer_store_dword v12, v11, s[40:43], s60 offen
L_gb_170:
    v_mov_b64 v[20:21], 0
    v_mov_b64 v[22:23], 0
    v_mov_b64 v[24:25], 0
    v_mov_b64 v[26:27], 0
L_skip_168:
    s_cmp_lt_u32 s30, 6
    s_barrier
    s_cbranch_scc0 L_se_167
    ds_read_b128 v[12:15], v9
    ds_read_b64 v[16:17], v10
    s_waitcnt lgkmcnt(1)
    v_smfmac_f32_16x16x64_bf16 v[20:23], v[12:15], v[28:35], v1
    v_smfmac_f32_16x16x64_bf16 v[24:27], v[12:15], v[40:47], v1
    s_waitcnt lgkmcnt(0)
    v_smfmac_f32_16x16x32_bf16 v[20:23], v[16:17], v[36:39], v1
    v_smfmac_f32_16x16x32_bf16 v[24:27], v[16:17], v[48:51], v1
    s_cmp_eq_u32 s55, 0
    s_nop 5
    v_add_f32 v12, v20, v22
    s_nop 1
    v_add_f32_dpp v12, v24, v26 quad_perm:[0,1,2,3] row_mask:0x2 bank_mask:0xf
    v_min_u32 v12, -2, v12
    s_cbranch_scc1 L_gs_171
    buffer_store_dword v12, v11, s[40:43], s59 offen
L_gb_172:
L_se_167:
L_p1:
    s_lshl_b32 s57, s30, 7
    s_add_u32 s57, s57, 158720
    v_lshrrev_b32 v58, 4, v0
    v_lshlrev_b32 v58, 5, v58
    v_bfe_u32 v60, v0, 1, 1
    v_lshl_add_u32 v58, v60, 4, v58
    v_bfe_u32 v60, v0, 2, 2
    v_lshl_add_u32 v58, v60, 2, v58
    v_and_b32 v60, 1, v0
    v_lshl_add_u32 v58, v60, 1, v58
    v_add_u32 v58, s57, v58
    v_lshrrev_b32 v61, 4, v0
    v_lshlrev_b32 v61, 5, v61
    v_bfe_u32 v60, v0, 1, 1
    v_lshl_add_u32 v61, v60, 4, v61
    v_add_u32 v61, s57, v61
L_pad6:
    s_cbranch_execz L_pad10
    v_bfe_u32 v62, v0, 2, 2
    v_lshlrev_b32 v62, 1, v62
    v_and_b32 v60, 1, v0
    v_lshl_add_u32 v62, v60, 0, v62
    v_mov_b32 v60, 160992
    v_cmp_eq_u32 vcc, 0, v62
    s_nop 1
    v_cndmask_b32 v52, v60, v61, vcc
    v_cmp_eq_u32 vcc, 1, v62
    s_nop 1
    v_cndmask_b32 v53, v60, v61, vcc
    v_cmp_eq_u32 vcc, 2, v62
    s_nop 1
    v_cndmask_b32 v54, v60, v61, vcc
    v_cmp_eq_u32 vcc, 3, v62
    s_nop 1
    v_cndmask_b32 v55, v60, v61, vcc
    v_cmp_eq_u32 vcc, 4, v62
    s_nop 1
    v_cndmask_b32 v56, v60, v61, vcc
    v_cmp_eq_u32 vcc, 5, v62
    s_nop 1
    v_cndmask_b32 v57, v60, v61, vcc
    s_lshl_b32 s58, s30, 2
    s_add_u32 s58, s58, 159808
    v_mov_b32 v60, s58
    v_lshlrev_b32 v59, 2, v0
    v_add_u32 v59, 158208, v59
    v_cmp_eq_u32 vcc, 63, v0
    s_nop 1
    v_cndmask_b32 v59, v59, v60, vcc
    v_and_b32 v62, 7, v0
    v_lshlrev_b32 v62, 2, v62
    v_add_u32 v62, 159808, v62
    s_lshl_b32 s57, s30, 11
    v_lshlrev_b32 v63, 4, v0
    v_add_u32 v63, s57, v63
    v_add_u32 v63, 92160, v63
    s_sub_u32 s57, s30, 1
    s_lshl_b32 s58, s57, 11
    v_lshlrev_b32 v7, 4, v0
    v_add_u32 v7, s58, v7
    s_lshl_b32 s58, s57, 7
    v_bfe_u32 v8, v0, 2, 2
    v_lshlrev_b32 v8, 5, v8
    v_lshrrev_b32 v60, 5, v0
    v_lshl_add_u32 v8, v60, 4, v8
    v_and_b32 v60, 3, v0
    v_lshl_add_u32 v8, v60, 2, v8
    v_bfe_u32 v60, v0, 4, 1
    v_lshl_add_u32 v8, v60, 1, v8
    v_add_u32 v8, s58, v8
    v_add_u32 v8, 124928, v8
    s_cmp_eq_u32 s30, 7
    s_cbranch_scc1 L_w7_180
    s_cmp_lt_u32 s30, 6
    s_cbranch_scc0 L_skip_182
    s_lshr_b32 s57, s30, 1
    s_mul_i32 s57, s57, 1024
    s_and_b32 s58, s30, 1
    s_lshl_b32 s58, s58, 6
    s_add_u32 s57, s57, s58
    v_lshrrev_b32 v18, 5, v0
    v_mul_u32_u24 v18, 6144, v18
    v_bfe_u32 v60, v0, 3, 1
    v_mul_u32_u24 v60, 3072, v60
    v_add_u32 v18, v60, v18
    v_bfe_u32 v60, v0, 4, 1
    v_lshl_add_u32 v18, v60, 9, v18
    v_bfe_u32 v60, v0, 2, 1
    v_lshl_add_u32 v18, v60, 7, v18
    v_and_b32 v60, 3, v0
    v_lshl_add_u32 v18, v60, 3, v18
    v_add_u32 v18, s57, v18
    v_bfe_u32 v19, v0, 4, 1
    v_mul_u32_u24 v19, 3072, v19
    v_bfe_u32 v60, v0, 3, 1
    v_lshl_add_u32 v19, v60, 9, v19
    v_bfe_u32 v60, v0, 2, 1
    v_lshl_add_u32 v19, v60, 7, v19
    v_and_b32 v60, 3, v0
    v_lshl_add_u32 v19, v60, 3, v19
    v_add_u32 v19, s57, v19
    v_add_u32 v19, 24576, v19
    ds_read_b64_tr_b16 v[28:29], v18 offset:0
    ds_read_b64_tr_b16 v[30:31], v18 offset:256
    ds_read_b64_tr_b16 v[32:33], v18 offset:12288
    ds_read_b64_tr_b16 v[34:35], v18 offset:12544
    ds_read_b64_tr_b16 v[36:37], v19 offset:0
    ds_read_b64_tr_b16 v[38:39], v19 offset:256
    ds_read_b64_tr_b16 v[40:41], v18 offset:32
L_pad7:
    s_cbranch_execz L_pad11
    ds_read_b64_tr_b16 v[42:43], v18 offset:288
    ds_read_b64_tr_b16 v[44:45], v18 offset:12320
    ds_read_b64_tr_b16 v[46:47], v18 offset:12576
    ds_read_b64_tr_b16 v[48:49], v19 offset:32
    ds_read_b64_tr_b16 v[50:51], v19 offset:288
    v_lshrrev_b32 v9, 4, v0
    v_lshlrev_b32 v9, 5, v9
    v_bfe_u32 v60, v0, 1, 1
    v_lshl_add_u32 v9, v60, 4, v9
    v_and_b32 v60, 1, v0
    v_mul_u32_u24 v60, 192, v60
    v_add_u32 v9, v60, v9
    v_add_u32 v9, 160832, v9
    v_lshrrev_b32 v10, 4, v0
    v_lshlrev_b32 v10, 4, v10
    v_bfe_u32 v60, v0, 1, 1
    v_lshl_add_u32 v10, v60, 3, v10
    v_and_b32 v60, 1, v0
    v_mul_u32_u24 v60, 192, v60
    v_add_u32 v10, v60, v10
    v_add_u32 v10, 160960, v10
    v_mov_b64 v[20:21], 0
    v_mov_b64 v[22:23], 0
    v_mov_b64 v[24:25], 0
    v_mov_b64 v[26:27], 0
    s_lshr_b32 s57, s30, 1
    s_lshl_b32 s57, s57, 11
    s_lshl_b32 s58, s58, 1
    s_add_u32 s57, s57, s58
    s_lshl_b32 s58, s54, 8
    s_add_u32 s57, s57, s58
    v_and_b32 v11, 31, v0
    v_lshlrev_b32 v11, 2, v11
    v_lshrrev_b32 v60, 5, v0
    v_lshl_add_u32 v11, v60, 30, v11
    v_add_u32 v11, s57, v11
    s_mul_i32 s59, s53, 6144
    s_add_u32 s59, s59, s62
    s_add_u32 s59, s59, 46080
    s_lshl_b32 s60, s53, 6
    s_add_u32 s60, s60, s62
    s_add_u32 s60, s60, 25600
L_skip_182:
    s_cmp_lt_u32 s30, 6
    s_barrier
    s_cbranch_scc0 L_se_181
    ds_read_b128 v[12:15], v9
    ds_read_b64 v[16:17], v10
    s_waitcnt lgkmcnt(1)
    v_smfmac_f32_16x16x64_bf16 v[20:23], v[12:15], v[28:35], v1
    v_smfmac_f32_16x16x64_bf16 v[24:27], v[12:15], v[40:47], v1
    s_waitcnt lgkmcnt(0)
    v_smfmac_f32_16x16x32_bf16 v[20:23], v[16:17], v[36:39], v1
    v_smfmac_f32_16x16x32_bf16 v[24:27], v[16:17], v[48:51], v1
    s_cmp_eq_u32 s55, 0
    s_nop 5
    v_add_f32 v12, v20, v22
    s_nop 1
    v_add_f32_dpp v12, v24, v26 quad_perm:[0,1,2,3] row_mask:0x2 bank_mask:0xf
    v_min_u32 v12, -2, v12
    s_cbranch_scc1 L_gs_183
    buffer_store_dword v12, v11, s[40:43], s59 offen
L_gb_184:
L_se_181:
    s_sub_u32 s57, s30, 1
    s_cmp_lt_u32 s57, 3
    s_cbranch_scc0 L_qo_198
    v_and_b32 v9, 7, v0
    v_lshlrev_b32 v9, 3, v9
    buffer_load_dwordx2 v[10:11], v9, s[40:43], s60 offen sc1
    buffer_load_dwordx4 v[12:15], v7, s[40:43], s59 offen offset:0 sc1
    buffer_load_dwordx4 v[16:19], v7, s[40:43], s59 offen offset:1024 sc1
    v_mov_b64 v[24:25], 0
    v_mov_b64 v[26:27], 0
    v_mov_b64 v[28:29], 0
    v_mov_b64 v[30:31], 0
    v_mov_b64 v[32:33], 0
    v_mov_b64 v[34:35], 0
    v_mov_b64 v[36:37], 0
    v_mov_b64 v[38:39], 0
    v_mov_b64 v[40:41], 0
    v_mov_b64 v[42:43], 0
    v_mov_b64 v[44:45], 0
    v_mov_b64 v[46:47], 0
    v_lshrrev_b32 v5, 4, v0
    v_lshlrev_b32 v5, 5, v5
    v_bfe_u32 v60, v0, 1, 1
    v_lshl_add_u32 v5, v60, 4, v5
    v_add_u32 v5, 124928, v5
    v_mov_b32 v60, 0x3c75e03e
    v_mov_b32 v61, 0x3a71d1e6
    v_mov_b32 v51, 0x3e13985d
    s_branch L_pw_200
L_pr_201:
    buffer_load_dwordx2 v[10:11], v9, s[40:43], s60 offen sc1
L_pad8:
    s_cbranch_execz L_pad12
    buffer_load_dwordx4 v[12:15], v7, s[40:43], s59 offen offset:0 sc1
    buffer_load_dwordx4 v[16:19], v7, s[40:43], s59 offen offset:1024 sc1
    s_sub_u32 s56, s56, 1
    s_cbranch_scc1 L_done
L_pw_200:
    s_waitcnt vmcnt(0)
    v_max_u32 v20, v10, v11
    v_cmp_eq_u32 vcc, -1, v20
    s_cbranch_vccnz L_pr_201
    v_add_f32_dpp v48, v10, v10 row_ror:4 row_mask:0xf bank_mask:0xf
    v_add_f32_dpp v49, v11, v11 row_ror:4 row_mask:0xf bank_mask:0xf
    v_pk_add_f32 v[20:21], v[12:13], v[16:17]
    v_pk_add_f32 v[22:23], v[14:15], v[18:19]
    v_add_f32_dpp v48, v48, v48 row_ror:2 row_mask:0xf bank_mask:0xf
    v_add_f32_dpp v49, v49, v49 row_ror:2 row_mask:0xf bank_mask:0xf
    v_permlane32_swap_b32 v20, v22
    v_permlane32_swap_b32 v21, v23
    v_add_f32_dpp v48, v48, v48 row_ror:1 row_mask:0xf bank_mask:0xf
    v_add_f32_dpp v49, v49, v49 row_ror:1 row_mask:0xf bank_mask:0xf
    v_pk_add_f32 v[20:21], v[20:21], v[22:23]
    v_mul_f32 v48, v48, v60
    v_fma_f32 v49, v49, v51, v61
    v_permlane16_swap_b32 v20, v21
    v_fma_f32 v49, -v48, v48, v49
    v_add_f32 v20, v20, v21
    v_max_f32 v49, v49, v61
    v_mul_f32 v50, v6, v48
    v_rsq_f32 v49, v49
    v_cmp_u_f32 vcc, v20, v20
    v_sub_f32 v20, v20, v50
    s_cbranch_vccnz L_hr_202
L_hk_203:
    v_mul_f32 v20, v20, v49
    v_cvt_pk_bf16_f32 v20, v20, v20
    ds_write_b16 v8, v20
L_qb_199:
    s_waitcnt lgkmcnt(0)
    s_barrier
    ds_read_b128 v[12:15], v5 offset:0
    ds_read_b128 v[16:19], v5 offset:128
    ds_read_b128 v[20:23], v5 offset:256
    s_waitcnt lgkmcnt(0)
    v_smfmac_f32_16x16x64_bf16 v[24:27], v[12:15], v[64:71], v1
    v_smfmac_f32_16x16x64_bf16 v[24:27], v[16:19], v[72:79], v1
    v_smfmac_f32_16x16x64_bf16 v[24:27], v[20:23], v[80:87], v1
    v_smfmac_f32_16x16x64_bf16 v[28:31], v[12:15], v[88:95], v1
    v_smfmac_f32_16x16x64_bf16 v[28:31], v[16:19], v[96:103], v1
    v_smfmac_f32_16x16x64_bf16 v[28:31], v[20:23], v[104:111], v1
    v_smfmac_f32_16x16x64_bf16 v[32:35], v[12:15], v[112:119], v1
    v_smfmac_f32_16x16x64_bf16 v[32:35], v[16:19], v[120:127], v1
    v_smfmac_f32_16x16x64_bf16 v[32:35], v[20:23], v[128:135], v1
    v_smfmac_f32_16x16x64_bf16 v[36:39], v[12:15], v[136:143], v1
    v_smfmac_f32_16x16x64_bf16 v[36:39], v[16:19], v[144:151], v1
    v_smfmac_f32_16x16x64_bf16 v[36:39], v[20:23], v[152:159], v1
    v_add_f32 v24, v24, v26
    s_nop 0
    v_add_f32 v28, v28, v30
    s_nop 1
    v_add_f32 v32, v32, v34
    v_max3_f32 v61, v24, v28, v32
    v_mov_b32_dpp v24, v28 quad_perm:[0,1,2,3] row_mask:0x2 bank_mask:0xf
    v_add_f32 v36, v36, v38
    v_max_f32 v61, v61, v36
    v_mov_b32_dpp v24, v32 quad_perm:[0,1,2,3] row_mask:0x4 bank_mask:0xf
    s_nop 0
    v_max_f32_dpp v61, v61, v61 row_ror:8 row_mask:0xf bank_mask:0xf
    s_nop 0
    v_mov_b32_dpp v24, v36 quad_perm:[0,1,2,3] row_mask:0x8 bank_mask:0xf
    v_max_f32_dpp v61, v61, v61 row_ror:4 row_mask:0xf bank_mask:0xf
    s_nop 1
    v_max_f32_dpp v61, v61, v61 row_ror:2 row_mask:0xf bank_mask:0xf
    s_nop 1
    v_max_f32_dpp v61, v61, v61 row_ror:1 row_mask:0xf bank_mask:0xf
    v_sub_f32 v36, v24, v61
    ds_write_b32 v59, v61
    v_exp_f32 v36, v36
    s_nop 0
    v_cvt_pk_bf16_f32 v39, v36, v36
    ds_write_b16 v58, v39
    ds_read_b128 v[12:15], v52
    ds_read_b128 v[16:19], v53
    ds_read_b128 v[20:23], v54
    ds_read_b128 v[24:27], v55
    ds_read_b128 v[28:31], v56
L_pad9:
    s_cbranch_execz L_pad13
    ds_read_b128 v[32:35], v57
    v_add_f32_dpp v38, v36, v36 row_ror:8 row_mask:0xf bank_mask:0xf
    s_nop 1
    v_add_f32_dpp v38, v38, v38 row_ror:4 row_mask:0xf bank_mask:0xf
    s_nop 1
    v_add_f32_dpp v38, v38, v38 row_ror:2 row_mask:0xf bank_mask:0xf
    s_nop 1
    v_add_f32_dpp v38, v38, v38 row_ror:1 row_mask:0xf bank_mask:0xf
    s_waitcnt lgkmcnt(5)
    v_smfmac_f32_16x16x64_bf16 v[40:43], v[12:15], v[160:167], v1
    v_add_f32_dpp v38, v38, v38 row_bcast:15 row_mask:0xa bank_mask:0xf
    v_smfmac_f32_16x16x64_bf16 v[44:47], v[12:15], v[208:215], v1
    s_waitcnt lgkmcnt(4)
    v_smfmac_f32_16x16x64_bf16 v[40:43], v[16:19], v[168:175], v1
    v_add_f32_dpp v38, v38, v38 row_bcast:31 row_mask:0xc bank_mask:0xf
    v_smfmac_f32_16x16x64_bf16 v[44:47], v[16:19], v[216:223], v1
    ds_read_b32 v36, v62
    s_waitcnt lgkmcnt(4)
    v_smfmac_f32_16x16x64_bf16 v[40:43], v[20:23], v[176:183], v1
    v_smfmac_f32_16x16x64_bf16 v[44:47], v[20:23], v[224:231], v1
    s_waitcnt lgkmcnt(0)
    v_max_f32_dpp v37, v36, v36 row_ror:4 row_mask:0xf bank_mask:0xf
    v_smfmac_f32_16x16x64_bf16 v[40:43], v[24:27], v[184:191], v1
    v_smfmac_f32_16x16x64_bf16 v[44:47], v[24:27], v[232:239], v1
    v_max_f32_dpp v37, v37, v37 row_ror:2 row_mask:0xf bank_mask:0xf
    v_smfmac_f32_16x16x64_bf16 v[40:43], v[28:31], v[192:199], v1
    v_cmp_eq_u32 vcc, -1, v36
    v_smfmac_f32_16x16x64_bf16 v[44:47], v[28:31], v[240:247], v1
    v_max_f32_dpp v37, v37, v37 row_ror:1 row_mask:0xf bank_mask:0xf
    v_smfmac_f32_16x16x64_bf16 v[40:43], v[32:35], v[200:207], v1
    v_sub_f32 v39, v61, v37
    v_smfmac_f32_16x16x64_bf16 v[44:47], v[32:35], v[248:255], v1
    v_exp_f32 v39, v39
    s_cbranch_vccnz L_mr_205
L_mk_206:
    v_mul_f32 v38, v38, v39
    ds_write_b32 v63, v38 offset:1024
    s_cmp_lt_u32 s30, 2
    s_nop 0
    v_pk_add_f32 v[40:41], v[40:41], v[42:43]
    s_nop 0
    v_pk_add_f32 v[42:43], v[44:45], v[46:47]
    v_pk_mul_f32 v[40:41], v[40:41], v[38:39] op_sel:[0,1] op_sel_hi:[1,1]
    v_pk_mul_f32 v[42:43], v[42:43], v[38:39] op_sel:[0,1] op_sel_hi:[1,1]
    ds_write_b128 v63, v[40:43]
    s_cbranch_scc1 L_comb_1
    s_waitcnt lgkmcnt(0)
    s_barrier
L_comb_1b:
    s_cmp_lt_u32 s3, 20
    s_cbranch_scc0 L_typeB_1
    s_mul_i32 s74, s30, 1664
    s_add_u32 s74, s74, s62
    s_add_u32 s74, s74, 26624
    v_and_b32 v56, 7, v0
    v_lshlrev_b32 v56, 2, v56
    v_lshrrev_b32 v62, 4, v0
    v_lshlrev_b32 v62, 3, v62
    buffer_load_dword v52, v56, s[40:43], s74 offen offset:1536 sc1
    buffer_load_dwordx2 v[54:55], v62, s[40:43], s74 offen offset:1536 sc1
    v_lshlrev_b32 v57, 4, v0
    v_lshlrev_b32 v58, 3, v0
    s_mul_i32 s57, s30, 6144
    s_add_u32 s57, s57, 30720
    v_lshrrev_b32 v59, 2, v0
    v_lshlrev_b32 v59, 6, v59
    v_bfe_u32 v53, v0, 4, 1
    v_lshl_add_u32 v59, v53, 5, v59
    v_and_b32 v53, 3, v0
    v_lshl_add_u32 v59, v53, 3, v59
    v_add_u32 v59, s57, v59
    v_xor_b32 v60, 32, v59
    s_lshl_b32 s57, s30, 8
    s_add_u32 s57, s57, 157696
    v_lshl_add_u32 v61, v0, 2, s57
    ds_read_b64_tr_b16 v[28:29], v59 offset:0
    ds_read_b64_tr_b16 v[30:31], v59 offset:1024
    ds_read_b64_tr_b16 v[32:33], v59 offset:2048
    ds_read_b64_tr_b16 v[34:35], v59 offset:3072
    ds_read_b64_tr_b16 v[36:37], v59 offset:4096
    ds_read_b64_tr_b16 v[38:39], v59 offset:5120
    ds_read_b64_tr_b16 v[40:41], v60 offset:0
L_pad10:
    s_cbranch_execz L_pad14
    ds_read_b64_tr_b16 v[42:43], v60 offset:1024
    ds_read_b64_tr_b16 v[44:45], v60 offset:2048
    ds_read_b64_tr_b16 v[46:47], v60 offset:3072
    ds_read_b64_tr_b16 v[48:49], v60 offset:4096
    ds_read_b64_tr_b16 v[50:51], v60 offset:5120
    v_mov_b64 v[20:21], 0
    v_mov_b64 v[22:23], 0
    v_mov_b64 v[24:25], 0
    v_mov_b64 v[26:27], 0
    s_add_u32 s58, s6, 132096
    s_branch L_pw_213
L_pr_214:
    buffer_load_dword v52, v56, s[40:43], s74 offen offset:1536 sc1
    buffer_load_dwordx2 v[54:55], v62, s[40:43], s74 offen offset:1536 sc1
    s_sub_u32 s56, s56, 1
    s_cbranch_scc1 L_done
L_pw_213:
    s_waitcnt vmcnt(0)
    v_max3_u32 v53, v52, v54, v55
    v_cmp_eq_u32 vcc, -1, v53
    s_cbranch_vccnz L_pr_214
    buffer_load_dwordx4 v[12:15], v57, s[40:43], s74 offen sc1
    buffer_load_dwordx2 v[16:17], v58, s[40:43], s74 offen offset:1024 sc1
    buffer_load_dword v18, v56, s[40:43], s74 offen offset:1568 sc1
    v_max_f32_dpp v53, v52, v52 row_ror:4 row_mask:0xf bank_mask:0xf
    s_nop 1
    v_max_f32_dpp v53, v53, v53 row_ror:2 row_mask:0xf bank_mask:0xf
    s_nop 1
    v_max_f32_dpp v53, v53, v53 row_ror:1 row_mask:0xf bank_mask:0xf
    v_sub_f32 v52, v52, v53
    v_sub_f32 v54, v54, v53
    v_sub_f32 v55, v55, v53
    v_exp_f32 v52, v52
    v_exp_f32 v54, v54
    v_exp_f32 v55, v55
    s_waitcnt lgkmcnt(0)
    s_branch L_pw_215
L_pr_216:
    buffer_load_dwordx4 v[12:15], v57, s[40:43], s74 offen sc1
    buffer_load_dwordx2 v[16:17], v58, s[40:43], s74 offen offset:1024 sc1
    buffer_load_dword v18, v56, s[40:43], s74 offen offset:1568 sc1
    s_sub_u32 s56, s56, 1
    s_cbranch_scc1 L_done
L_pw_215:
    s_waitcnt vmcnt(0)
    v_max3_u32 v19, v12, v13, v14
    v_max3_u32 v19, v19, v15, v16
    v_max3_u32 v19, v19, v17, v18
    v_cmp_eq_u32 vcc, -1, v19
    s_cbranch_vccnz L_pr_216
    v_smfmac_f32_16x16x64_bf16 v[20:23], v[12:15], v[28:35], v1
    v_mul_f32 v52, v52, v18
    v_smfmac_f32_16x16x64_bf16 v[24:27], v[12:15], v[40:47], v1
    v_smfmac_f32_16x16x32_bf16 v[20:23], v[16:17], v[36:39], v1
    v_add_f32_dpp v52, v52, v52 row_ror:4 row_mask:0xf bank_mask:0xf
    v_smfmac_f32_16x16x32_bf16 v[24:27], v[16:17], v[48:51], v1
    s_cmp_eq_u32 s30, 2
    v_add_f32_dpp v52, v52, v52 row_ror:2 row_mask:0xf bank_mask:0xf
    s_nop 1
    v_add_f32_dpp v52, v52, v52 row_ror:1 row_mask:0xf bank_mask:0xf
    v_rcp_f32 v52, v52
    v_pk_add_f32 v[20:21], v[20:21], v[22:23]
    s_nop 0
    v_pk_add_f32 v[24:25], v[24:25], v[26:27]
    v_pk_mul_f32 v[54:55], v[54:55], v[52:53] op_sel:[0,0] op_sel_hi:[1,0]
    v_mul_f32 v20, v20, v54
    v_mul_f32 v24, v24, v54
    v_fmac_f32 v20, v21, v55
    v_fmac_f32 v24, v25, v55
    s_nop 1
    v_permlane32_swap_b32 v20, v24
    v_add_f32 v20, v20, v24
    ds_write_b32 v61, v20
    s_waitcnt lgkmcnt(0)
    s_barrier
    s_cbranch_scc0 L_finb_217
    ds_read2st64_b32 v[12:13], v2 offset0:0 offset1:1
    ds_read2st64_b32 v[14:15], v2 offset0:2 offset1:3
    ds_read2st64_b32 v[16:17], v2 offset0:4 offset1:5
    ds_read2st64_b32 v[18:19], v2 offset0:6 offset1:7
    s_waitcnt lgkmcnt(2)
    v_pk_add_f32 v[12:13], v[12:13], v[14:15]
    s_waitcnt lgkmcnt(0)
    v_pk_add_f32 v[16:17], v[16:17], v[18:19]
    v_pk_add_f32 v[12:13], v[12:13], v[16:17]
    v_add_f32 v14, v12, v13
    v_add_f32 v15, v12, v13
    s_nop 1
    v_permlane16_swap_b32 v14, v15
    v_add_f32 v12, v14, v15
    v_min_u32 v12, -2, v12
    buffer_store_dword v12, v3, s[40:43], s58 offen sc1
L_finb_217:
L_pad11:
    s_cbranch_execz L_pad15
    s_sub_u32 s57, s30, 4
    s_cmp_lt_u32 s57, 3
    s_cbranch_scc0 L_skip_218
    s_sub_u32 s60, s30, 4
    s_lshl_b32 s57, s60, 11
    v_lshlrev_b32 v11, 4, v0
    v_add_u32 v11, s57, v11
    s_add_u32 s65, s62, 19456
    buffer_load_dwordx4 v[52:55], v11, s[40:43], s65 offen offset:0 sc1
    buffer_load_dwordx4 v[56:59], v11, s[40:43], s65 offen offset:1024 sc1
    s_lshl_b32 s59, s60, 12
    s_add_u32 s59, s59, 79872
    v_bfe_u32 v35, v0, 4, 1
    v_lshlrev_b32 v35, 11, v35
    v_bfe_u32 v60, v0, 2, 2
    v_lshl_add_u32 v35, v60, 8, v35
    v_lshrrev_b32 v60, 5, v0
    v_lshl_add_u32 v35, v60, 6, v35
    v_and_b32 v60, 3, v0
    v_lshl_add_u32 v35, v60, 3, v35
    v_add_u32 v35, s59, v35
    v_mov_b32 v9, 0xbdd2d3e8
    v_mov_b32 v10, 0xc0135761
    s_lshl_b32 s57, s60, 7
    s_add_u32 s57, s57, 160256
    v_lshlrev_b32 v32, 3, v0
    v_add_u32 v32, s57, v32
    v_lshlrev_b32 v33, 3, v0
    v_add_u32 v33, 129024, v33
    v_cmp_gt_u32 vcc, 16, v0
    s_nop 1
    v_cndmask_b32 v32, v33, v32, vcc
    v_and_b32 v33, 15, v0
    v_lshlrev_b32 v33, 3, v33
    v_lshrrev_b32 v60, 5, v0
    v_lshl_add_u32 v33, v60, 2, v33
    v_add_u32 v33, 160256, v33
    v_and_b32 v34, 15, v0
    v_lshlrev_b32 v34, 2, v34
    v_lshrrev_b32 v60, 5, v0
    v_lshl_add_u32 v34, v60, 6, v34
    v_bfe_u32 v60, v0, 4, 1
    v_lshl_add_u32 v34, v60, 13, v34
    s_add_u32 s60, s6, 198144
    s_add_u32 s58, s62, 39936
    s_add_u32 s57, s62, 25984
    v_and_b32 v7, 7, v0
    v_lshlrev_b32 v7, 3, v7
    v_mov_b32 v60, 0x3acccccd
    v_mov_b32 v61, 0x3727c5ac
    s_waitcnt vmcnt(0)
    buffer_load_dwordx2 v[24:25], v7, s[40:43], s57 offen sc1
    buffer_load_dwordx4 v[12:15], v11, s[40:43], s58 offen offset:0 sc1
    buffer_load_dwordx4 v[16:19], v11, s[40:43], s58 offen offset:1024 sc1
    ds_read_b64_tr_b16 v[36:37], v35 offset:0
    ds_read_b64_tr_b16 v[38:39], v35 offset:1024
    ds_read_b64_tr_b16 v[40:41], v35 offset:128
    ds_read_b64_tr_b16 v[42:43], v35 offset:1152
    ds_read_b64_tr_b16 v[44:45], v35 offset:32
    ds_read_b64_tr_b16 v[46:47], v35 offset:1056
    ds_read_b64_tr_b16 v[48:49], v35 offset:160
    ds_read_b64_tr_b16 v[50:51], v35 offset:1184
L_sw_221:
    v_max3_u32 v20, v52, v53, v54
    v_max3_u32 v20, v20, v55, v56
    v_max3_u32 v20, v20, v57, v58
    v_max_u32 v20, v20, v59
    v_cmp_eq_u32 vcc, -1, v20
    s_cbranch_vccnz L_sr_222
    v_pk_add_f32 v[28:29], v[52:53], v[56:57]
    v_pk_add_f32 v[30:31], v[54:55], v[58:59]
    s_nop 1
    v_permlane32_swap_b32 v28, v30
    v_permlane32_swap_b32 v29, v31
    v_pk_add_f32 v[28:29], v[28:29], v[30:31]
    s_nop 1
    v_permlane16_swap_b32 v28, v29
    v_add_f32 v28, v28, v29
    v_mov_b64 v[52:53], 0
    v_mov_b64 v[54:55], 0
    v_mov_b64 v[56:57], 0
    v_mov_b64 v[58:59], 0
    s_waitcnt lgkmcnt(0)
L_pr_220:
    buffer_load_dwordx2 v[24:25], v7, s[40:43], s57 offen sc1
    buffer_load_dwordx4 v[12:15], v11, s[40:43], s58 offen offset:0 sc1
L_pad12:
    s_cbranch_execz L_pad16
    buffer_load_dwordx4 v[16:19], v11, s[40:43], s58 offen offset:1024 sc1
    s_sub_u32 s56, s56, 1
    s_cbranch_scc1 L_done
L_pw_219:
    s_waitcnt vmcnt(3)
    v_max_u32 v20, v24, v25
    v_cmp_eq_u32 vcc, -1, v20
    s_cbranch_vccnz L_pr_220
    buffer_load_dwordx4 v[12:15], v11, s[40:43], s58 offen offset:0 sc1
    buffer_load_dwordx4 v[16:19], v11, s[40:43], s58 offen offset:1024 sc1
    v_add_f32_dpp v2, v24, v24 row_ror:4 row_mask:0xf bank_mask:0xf
    v_add_f32_dpp v3, v25, v25 row_ror:4 row_mask:0xf bank_mask:0xf
    v_pk_add_f32 v[20:21], v[12:13], v[16:17]
    v_pk_add_f32 v[22:23], v[14:15], v[18:19]
    v_add_f32_dpp v2, v2, v2 row_ror:2 row_mask:0xf bank_mask:0xf
    v_add_f32_dpp v3, v3, v3 row_ror:2 row_mask:0xf bank_mask:0xf
    v_permlane32_swap_b32 v20, v22
    v_permlane32_swap_b32 v21, v23
    v_add_f32_dpp v2, v2, v2 row_ror:1 row_mask:0xf bank_mask:0xf
    v_add_f32_dpp v3, v3, v3 row_ror:1 row_mask:0xf bank_mask:0xf
    v_pk_add_f32 v[20:21], v[20:21], v[22:23]
    v_mul_f32 v2, v2, v60
    v_fma_f32 v3, v3, v60, v61
    v_permlane16_swap_b32 v20, v21
    v_fma_f32 v3, -v2, v2, v3
    v_add_f32 v20, v20, v21
    v_max_f32 v3, v3, v61
    v_mul_f32 v26, v28, v2
    v_rsq_f32 v3, v3
    v_cmp_u_f32 vcc, v20, v20
    v_sub_f32 v20, v20, v26
    s_cbranch_vccnz L_hr_223
L_hk_224:
    v_fma_f32 v20, v20, v3, v4
    v_mul_f32 v21, v20, v20
    v_fma_f32 v21, v21, v9, v10
    v_mul_f32 v21, v21, v20
    v_exp_f32 v21, v21
    s_nop 0
    v_add_f32 v21, 1.0, v21
    v_rcp_f32 v21, v21
    s_nop 0
    v_mul_f32 v20, v20, v21
    s_nop 1
    v_mov_b32_dpp v21, v20 row_shl:1 row_mask:0xf bank_mask:0xf bound_ctrl:0
    v_cvt_pk_bf16_f32 v28, v20, v21
    s_nop 1
    v_mov_b32_dpp v29, v28 row_shl:4 row_mask:0xf bank_mask:0xf bound_ctrl:0
    v_mov_b32_dpp v30, v28 row_shl:8 row_mask:0xf bank_mask:0xf bound_ctrl:0
    v_mov_b32_dpp v31, v28 row_shl:12 row_mask:0xf bank_mask:0xf bound_ctrl:0
    s_nop 1
    v_smfmac_f32_16x16x64_bf16 v[52:55], v[28:31], v[36:43], v1
    v_smfmac_f32_16x16x64_bf16 v[56:59], v[28:31], v[44:51], v1
    s_cmp_eq_u32 s30, 4
    s_nop 5
    v_add_f32 v22, v52, v54
    v_add_f32 v23, v56, v58
    ds_write_b64 v32, v[22:23]
    s_cbranch_scc0 L_skip_226
L_xw_227:
    ds_read2_b32 v[20:21], v33 offset0:0 offset1:32
    ds_read_b32 v22, v33 offset:256
    s_sub_u32 s56, s56, 1
    s_cbranch_scc1 L_done
    s_waitcnt lgkmcnt(0)
    v_max3_u32 v23, v20, v21, v22
    v_add_f32 v20, v20, v21
    v_cmp_eq_u32 vcc, -1, v23
    v_add_f32 v20, v20, v22
    s_cbranch_vccnz L_xw_227
    v_min_u32 v20, -2, v20
    buffer_store_dword v20, v34, s[40:43], s60 offen sc1
L_skip_226:
L_skip_218:
    s_branch L_done
L_typeB_1:
    s_cmp_eq_u32 s53, 3
    s_cbranch_scc0 L_typeC_228
    s_cmp_eq_u32 s30, 7
    s_cbranch_scc1 L_w7_233
    s_cmp_lt_u32 s30, 6
    s_cbranch_scc0 L_skip_235
    s_lshr_b32 s57, s30, 1
    s_mul_i32 s57, s57, 128
    s_and_b32 s58, s30, 1
    s_lshl_b32 s58, s58, 6
    s_add_u32 s57, s57, s58
    v_lshrrev_b32 v18, 5, v0
    v_lshlrev_b32 v18, 13, v18
    v_bfe_u32 v60, v0, 3, 1
    v_lshl_add_u32 v18, v60, 12, v18
    v_bfe_u32 v60, v0, 4, 1
    v_lshl_add_u32 v18, v60, 11, v18
    v_bfe_u32 v60, v0, 2, 1
    v_mul_u32_u24 v60, 384, v60
    v_add_u32 v18, v60, v18
    v_and_b32 v60, 3, v0
    v_lshl_add_u32 v18, v60, 3, v18
L_pad13:
    s_cbranch_execz L_pad17
    v_add_u32 v18, s57, v18
    v_add_u32 v18, 30720, v18
    v_bfe_u32 v19, v0, 4, 1
    v_lshlrev_b32 v19, 12, v19
    v_bfe_u32 v60, v0, 3, 1
    v_lshl_add_u32 v19, v60, 11, v19
    v_bfe_u32 v60, v0, 2, 1
    v_mul_u32_u24 v60, 384, v60
    v_add_u32 v19, v60, v19
    v_and_b32 v60, 3, v0
    v_lshl_add_u32 v19, v60, 3, v19
    v_add_u32 v19, s57, v19
    v_add_u32 v19, 63488, v19
    ds_read_b64_tr_b16 v[28:29], v18 offset:0
    ds_read_b64_tr_b16 v[30:31], v18 offset:1024
    ds_read_b64_tr_b16 v[32:33], v18 offset:16384
    ds_read_b64_tr_b16 v[34:35], v18 offset:17408
    ds_read_b64_tr_b16 v[36:37], v19 offset:0
    ds_read_b64_tr_b16 v[38:39], v19 offset:1024
    ds_read_b64_tr_b16 v[40:41], v18 offset:32
    ds_read_b64_tr_b16 v[42:43], v18 offset:1056
    ds_read_b64_tr_b16 v[44:45], v18 offset:16416
    ds_read_b64_tr_b16 v[46:47], v18 offset:17440
    ds_read_b64_tr_b16 v[48:49], v19 offset:32
    ds_read_b64_tr_b16 v[50:51], v19 offset:1056
    v_lshrrev_b32 v9, 4, v0
    v_lshlrev_b32 v9, 5, v9
    v_bfe_u32 v60, v0, 1, 1
    v_lshl_add_u32 v9, v60, 4, v9
    v_and_b32 v60, 1, v0
    v_mul_u32_u24 v60, 192, v60
    v_add_u32 v9, v60, v9
    v_add_u32 v9, 160832, v9
    v_lshrrev_b32 v10, 4, v0
    v_lshlrev_b32 v10, 4, v10
    v_bfe_u32 v60, v0, 1, 1
    v_lshl_add_u32 v10, v60, 3, v10
    v_and_b32 v60, 1, v0
    v_mul_u32_u24 v60, 192, v60
    v_add_u32 v10, v60, v10
    v_add_u32 v10, 160960, v10
    v_mov_b64 v[20:21], 0
    v_mov_b64 v[22:23], 0
    v_mov_b64 v[24:25], 0
    v_mov_b64 v[26:27], 0
    s_lshr_b32 s57, s30, 1
    s_lshl_b32 s57, s57, 11
    s_lshl_b32 s58, s58, 1
    s_add_u32 s57, s57, s58
    s_lshl_b32 s58, s54, 8
    s_add_u32 s57, s57, s58
    v_and_b32 v11, 31, v0
    v_lshlrev_b32 v11, 2, v11
    v_lshrrev_b32 v60, 5, v0
    v_lshl_add_u32 v11, v60, 30, v11
    v_add_u32 v11, s57, v11
    s_add_u32 s59, s62, 39936
    s_add_u32 s60, s62, 25984
L_skip_235:
    s_cmp_lt_u32 s30, 6
    s_barrier
    s_cbranch_scc0 L_se_234
    ds_read_b128 v[12:15], v9
    ds_read_b64 v[16:17], v10
    s_waitcnt lgkmcnt(1)
    v_smfmac_f32_16x16x64_bf16 v[20:23], v[12:15], v[28:35], v1
    v_smfmac_f32_16x16x64_bf16 v[24:27], v[12:15], v[40:47], v1
    s_waitcnt lgkmcnt(0)
    v_smfmac_f32_16x16x32_bf16 v[20:23], v[16:17], v[36:39], v1
    v_smfmac_f32_16x16x32_bf16 v[24:27], v[16:17], v[48:51], v1
    s_cmp_eq_u32 s55, 0
    s_nop 5
    v_add_f32 v12, v20, v22
    s_nop 1
    v_add_f32_dpp v12, v24, v26 quad_perm:[0,1,2,3] row_mask:0x2 bank_mask:0xf
    v_min_u32 v12, -2, v12
    s_cbranch_scc1 L_gs_236
    buffer_store_dword v12, v11, s[40:43], s59 offen
L_gb_237:
L_se_234:
    s_cmp_eq_u32 s30, 7
    s_cbranch_scc0 L_done
    s_cmp_eq_u32 s31, 0
    s_cbranch_scc0 L_done
    v_lshlrev_b32 v60, 16, v4
    v_add_f32 v2, v2, v60
    v_and_b32 v60, 0xffff0000, v4
    v_add_f32 v3, v3, v60
    v_and_b32 v60, 31, v0
L_pad14:
    s_cbranch_execz L_pad18
    v_min_u32 v60, 19, v60
    s_mul_i32 s57, s54, 160
    v_lshrrev_b32 v7, 5, v0
    v_lshlrev_b32 v7, 2, v7
    v_add_u32 v7, s57, v7
    v_lshl_add_u32 v7, v60, 3, v7
    s_add_u32 s57, s7, 198144
    s_add_u32 s58, s7, 214528
    s_add_u32 s59, s7, 230912
    s_add_u32 s60, s7, 247296
    s_add_u32 s75, s7, 266252
    v_and_b32 v9, 7, v0
    v_lshlrev_b32 v9, 9, v9
    buffer_load_dword v12, v9, s[40:43], s75 offen sc1
    s_sleep 2
L_pr_249:
    buffer_load_dword v12, v9, s[40:43], s75 offen sc1
    s_sub_u32 s56, s56, 1
    s_cbranch_scc1 L_done
L_pw_248:
    s_waitcnt vmcnt(1)
    v_cmp_eq_u32 vcc, -1, v12
    s_cbranch_vccnz L_pr_249
    s_sleep 2
    buffer_load_dwordx4 v[12:15], v5, s[40:43], s57 offen sc1
    buffer_load_dwordx4 v[16:19], v5, s[40:43], s58 offen sc1
    buffer_load_dwordx4 v[20:23], v5, s[40:43], s59 offen sc1
    buffer_load_dwordx4 v[24:27], v5, s[40:43], s60 offen sc1
    s_sleep 2
L_gw_245:
    buffer_load_dwordx4 v[12:15], v5, s[40:43], s57 offen sc1
    buffer_load_dwordx4 v[16:19], v5, s[40:43], s58 offen sc1
    buffer_load_dwordx4 v[20:23], v5, s[40:43], s59 offen sc1
    buffer_load_dwordx4 v[24:27], v5, s[40:43], s60 offen sc1
    s_sub_u32 s56, s56, 1
    s_cbranch_scc1 L_done
    s_and_b32 s74, s56, 31
    s_waitcnt vmcnt(6)
    v_pk_add_f32 v[28:29], v[12:13], v[16:17]
    v_pk_add_f32 v[30:31], v[14:15], v[18:19]
    s_waitcnt vmcnt(5)
    v_pk_add_f32 v[28:29], v[28:29], v[20:21]
    v_pk_add_f32 v[30:31], v[30:31], v[22:23]
    s_waitcnt vmcnt(4)
    v_pk_add_f32 v[28:29], v[28:29], v[24:25]
    v_pk_add_f32 v[30:31], v[30:31], v[26:27]
    v_pk_add_f32 v[32:33], v[28:29], v[30:31]
    v_cmp_u_f32 vcc, v32, v33
    v_permlane32_swap_b32 v28, v30
    v_permlane32_swap_b32 v29, v31
    s_cbranch_vccnz L_gr_246
L_gk_247:
    v_pk_add_f32 v[28:29], v[28:29], v[30:31]
    v_pk_add_f32 v[28:29], v[28:29], v[2:3]
    v_cvt_pk_bf16_f32 v28, v28, v29
    global_store_dword v7, v28, s[24:25]
    s_branch L_done
L_gs_41:
    buffer_store_dword v33, v34, s[40:43], s67 offen sc1
    s_branch L_gb_42
L_gs_44:
    buffer_store_dword v12, v54, s[40:43], s59 offen sc1
    s_branch L_gb_45
L_cr_59:
    s_sub_u32 s56, s56, 1
    s_cbranch_scc1 L_done
    global_load_dword v2, v3, s[26:27] sc1
    s_waitcnt vmcnt(0)
    s_branch L_cw_58
L_far_60:
    s_lshl_b32 s57, s52, 2
    s_add_u32 s57, s57, s72
    s_mov_b64 exec, 1
    buffer_store_dword v25, v0, s[40:43], s57 offen offset:128 sc1
    s_mov_b64 exec, -1
    s_branch L_fb_61
L_cr_77:
    s_sub_u32 s56, s56, 1
    s_cbranch_scc1 L_done
    buffer_load_dword v2, v24, s[40:43], s72 offen sc1
    s_branch L_cw_76
L_gs_85:
    buffer_store_dword v33, v34, s[40:43], s67 offen sc1
    s_branch L_gb_86
L_gs_88:
    buffer_store_dword v12, v54, s[40:43], s59 offen sc1
    s_branch L_gb_89
L_gs_108:
    buffer_store_dword v37, v4, s[40:43], s58 offen sc1
    s_branch L_gb_109
L_cr_122:
    s_sub_u32 s56, s56, 1
    s_cbranch_scc1 L_done
    global_load_dword v2, v3, s[26:27] offset:4 sc1
    s_branch L_cw_121
L_cr_132:
    buffer_load_dword v52, v56, s[40:43], s74 offen offset:1536 sc1
    buffer_load_dwordx2 v[54:55], v62, s[40:43], s74 offen offset:1536 sc1
    s_sub_u32 s56, s56, 1
    s_cbranch_scc1 L_done
    s_branch L_cw_131
L_gs_137:
    buffer_store_dword v14, v3, s[40:43], s57 offen sc1
L_pad15:
    s_cbranch_execz L_pad19
    s_branch L_gb_138
L_gs_139:
    buffer_store_dword v12, v4, s[40:43], s57 offen offset:32 sc1
    s_branch L_gb_140
L_comb_0:
    s_mov_b32 s57, 0
    s_cmp_eq_u32 s55, 0
    s_waitcnt lgkmcnt(0)
    s_barrier
    ds_read2st64_b64 v[12:15], v2 offset0:0 offset1:4
    ds_read2st64_b64 v[16:19], v2 offset0:8 offset1:12
    ds_read2st64_b64 v[20:23], v2 offset0:16 offset1:20
    ds_read2st64_b64 v[24:27], v2 offset0:24 offset1:28
    s_waitcnt lgkmcnt(2)
    v_pk_add_f32 v[12:13], v[12:13], v[14:15]
    v_pk_add_f32 v[16:17], v[16:17], v[18:19]
    v_pk_add_f32 v[12:13], v[12:13], v[16:17]
    s_waitcnt lgkmcnt(0)
    v_pk_add_f32 v[20:21], v[20:21], v[22:23]
    v_pk_add_f32 v[24:25], v[24:25], v[26:27]
    v_pk_add_f32 v[12:13], v[12:13], v[20:21]
    v_pk_add_f32 v[12:13], v[12:13], v[24:25]
    v_cvt_pk_bf16_f32 v14, v12, v13
    v_min_u32 v12, -2, v12
    v_min_u32 v14, -2, v14
    s_cbranch_scc1 L_gs_137
    buffer_store_dword v14, v3, s[40:43], s57 offen
L_gb_138:
    s_cbranch_scc1 L_gs_139
    buffer_store_dword v12, v4, s[40:43], s57 offen offset:32
L_gb_140:
    s_branch L_comb_0b
L_sr_149:
    buffer_load_dwordx4 v[52:55], v11, s[40:43], s65 offen offset:0 sc1
    buffer_load_dwordx4 v[56:59], v11, s[40:43], s65 offen offset:1024 sc1
    s_sub_u32 s56, s56, 1
    s_cbranch_scc1 L_done
    s_waitcnt vmcnt(0)
    s_branch L_sw_148
L_hr_150:
    buffer_load_dwordx4 v[12:15], v11, s[40:43], s58 offen offset:0 sc1
    buffer_load_dwordx4 v[16:19], v11, s[40:43], s58 offen offset:1024 sc1
    s_sub_u32 s56, s56, 1
    s_cbranch_scc1 L_done
    s_and_b32 s64, s56, 31
    s_cbranch_scc0 L_hx_152
    s_waitcnt vmcnt(2)
    v_pk_add_f32 v[20:21], v[12:13], v[16:17]
    v_pk_add_f32 v[22:23], v[14:15], v[18:19]
    s_nop 1
    v_permlane32_swap_b32 v20, v22
    v_permlane32_swap_b32 v21, v23
    v_pk_add_f32 v[20:21], v[20:21], v[22:23]
    s_nop 1
    v_permlane16_swap_b32 v20, v21
    v_add_f32 v20, v20, v21
    v_cmp_u_f32 vcc, v20, v20
    v_sub_f32 v20, v20, v26
    s_cbranch_vccnz L_hr_150
    s_branch L_hk_151
L_hx_152:
    s_waitcnt vmcnt(0)
    v_max3_u32 v20, v12, v13, v14
    v_max3_u32 v20, v20, v15, v16
    v_max3_u32 v20, v20, v17, v18
    v_max_u32 v20, v20, v19
    v_cmp_eq_u32 vcc, -1, v20
    s_cbranch_vccnz L_hr_150
    v_pk_add_f32 v[20:21], v[12:13], v[16:17]
    v_pk_add_f32 v[22:23], v[14:15], v[18:19]
    s_nop 1
    v_permlane32_swap_b32 v20, v22
    v_permlane32_swap_b32 v21, v23
    v_pk_add_f32 v[20:21], v[20:21], v[22:23]
    s_nop 1
    v_permlane16_swap_b32 v20, v21
    v_add_f32 v20, v20, v21
    v_sub_f32 v20, v20, v26
    s_branch L_hk_151
L_gs_160:
    buffer_store_dword v0, v11, s[40:43], s58 offen sc1
    s_branch L_gb_161
L_typeC_156:
    s_cmp_eq_u32 s30, 6
    s_cbranch_scc0 L_p1
    s_cmp_eq_u32 s3, 21
    s_cbranch_scc0 L_skip_157
    v_and_b32 v11, 3, v0
    v_lshlrev_b32 v11, 7, v11
    v_lshrrev_b32 v60, 2, v0
    v_lshl_add_u32 v11, v60, 24, v11
    s_add_u32 s58, s62, 26116
    s_add_u32 s75, s7, 266244
    v_and_b32 v9, 7, v0
    v_lshlrev_b32 v9, 9, v9
    buffer_load_dword v12, v9, s[40:43], s75 offen sc1
    s_sleep 2
L_pr_159:
    buffer_load_dword v12, v9, s[40:43], s75 offen sc1
    s_sub_u32 s56, s56, 1
    s_cbranch_scc1 L_done
L_pw_158:
    s_waitcnt vmcnt(1)
L_pad16:
    s_cbranch_execz L_pad20
    v_cmp_eq_u32 vcc, -1, v12
    s_cbranch_vccnz L_pr_159
    s_cmp_eq_u32 s55, 0
    s_cbranch_scc1 L_gs_160
    buffer_store_dword v0, v11, s[40:43], s58 offen
L_gb_161:
    s_waitcnt vmcnt(1)
    s_branch L_p1
L_skip_157:
    s_cmp_eq_u32 s3, 20
    s_cbranch_scc0 L_p1
    s_lshl_b32 s59, s31, 9
    s_add_u32 s59, s59, s8
    s_add_u32 s59, s59, 266240
    v_and_b32 v10, 1, v0
    v_lshlrev_b32 v10, 13, v10
    v_lshrrev_b32 v60, 1, v0
    v_lshl_add_u32 v10, v60, 24, v10
    s_add_u32 s58, s62, 1568
    v_lshrrev_b32 v9, 3, v0
    v_mul_u32_u24 v9, 1664, v9
    v_and_b32 v60, 7, v0
    v_lshl_add_u32 v9, v60, 2, v9
    buffer_load_dword v12, v9, s[40:43], s58 offen sc1
    s_sleep 2
L_pr_163:
    buffer_load_dword v12, v9, s[40:43], s58 offen sc1
    s_sub_u32 s56, s56, 1
    s_cbranch_scc1 L_done
L_pw_162:
    s_waitcnt vmcnt(1)
    v_cmp_eq_u32 vcc, -1, v12
    s_cbranch_vccnz L_pr_163
    buffer_store_dword v0, v10, s[40:43], s59 offen offset:0 sc1
    s_add_u32 s58, s62, 25856
    v_and_b32 v9, 15, v0
    v_lshlrev_b32 v9, 2, v9
    buffer_load_dword v13, v9, s[40:43], s58 offen sc1
    s_sleep 2
L_pr_165:
    buffer_load_dword v13, v9, s[40:43], s58 offen sc1
    s_sub_u32 s56, s56, 1
    s_cbranch_scc1 L_done
L_pw_164:
    s_waitcnt vmcnt(1)
    v_cmp_eq_u32 vcc, -1, v13
    s_cbranch_vccnz L_pr_165
    buffer_store_dword v0, v10, s[40:43], s59 offen offset:4 sc1
    s_waitcnt vmcnt(1)
    s_branch L_p1
L_gs_169:
    buffer_store_dword v12, v11, s[40:43], s60 offen sc1
    s_branch L_gb_170
L_gs_171:
    buffer_store_dword v12, v11, s[40:43], s59 offen sc1
    s_branch L_gb_172
L_gr_174:
    s_cbranch_scc1 L_gw_173
    s_waitcnt vmcnt(0)
    v_max3_u32 v32, v12, v13, v14
    v_max3_u32 v32, v32, v15, v16
    v_max3_u32 v32, v32, v17, v18
    v_max3_u32 v32, v32, v19, v20
    v_max3_u32 v32, v32, v21, v22
    v_max3_u32 v32, v32, v23, v24
    v_max3_u32 v32, v32, v25, v26
    v_max_u32 v32, v32, v27
    v_cmp_eq_u32 vcc, -1, v32
    s_cbranch_vccnz L_gw_173
    v_pk_add_f32 v[28:29], v[12:13], v[16:17]
    v_pk_add_f32 v[30:31], v[14:15], v[18:19]
    v_pk_add_f32 v[28:29], v[28:29], v[20:21]
    v_pk_add_f32 v[30:31], v[30:31], v[22:23]
    v_pk_add_f32 v[28:29], v[28:29], v[24:25]
    v_pk_add_f32 v[30:31], v[30:31], v[26:27]
    s_nop 1
    v_permlane32_swap_b32 v28, v30
    v_permlane32_swap_b32 v29, v31
    s_branch L_gk_175
L_gs_178:
    buffer_store_dword v33, v34, s[40:43], s67 offen sc1
    s_branch L_gb_179
L_w7_166:
    v_and_b32 v60, 31, v0
    v_min_u32 v60, 19, v60
    s_mul_i32 s57, s54, 320
    v_lshrrev_b32 v5, 5, v0
    v_lshlrev_b32 v5, 12, v5
    v_add_u32 v5, s57, v5
    v_lshl_add_u32 v5, v60, 4, v5
    v_and_b32 v60, 31, v0
    v_cmp_gt_u32 s[64:65], 20, v60
    v_min_u32 v60, 19, v60
    v_lshrrev_b32 v35, 5, v0
    v_lshlrev_b32 v35, 2, v35
    v_add_u32 v35, 160832, v35
    v_lshl_add_u32 v35, v60, 3, v35
    s_add_u32 s66, s62, 13312
    s_add_u32 s67, s62, 25856
    s_lshl_b32 s57, s54, 3
    v_lshrrev_b32 v34, 5, v0
    v_lshlrev_b32 v34, 2, v34
L_pad17:
    s_cbranch_execz L_pad21
    v_add_u32 v34, s57, v34
    v_and_b32 v60, 31, v0
    v_mov_b32 v61, 0x7f000000
    v_cmp_ne_u32 vcc, 31, v60
    s_nop 1
    v_cndmask_b32 v34, v34, v61, vcc
    v_mov_b32 v61, 0x3f803f80
    s_add_u32 s57, s7, 0
    s_add_u32 s58, s7, 16384
    s_add_u32 s59, s7, 32768
    s_add_u32 s60, s7, 49152
    s_add_u32 s75, s7, 266240
    v_and_b32 v9, 7, v0
    v_lshlrev_b32 v9, 9, v9
    buffer_load_dword v12, v9, s[40:43], s75 offen sc1
    s_sleep 2
L_pr_177:
    buffer_load_dword v12, v9, s[40:43], s75 offen sc1
    s_sub_u32 s56, s56, 1
    s_cbranch_scc1 L_done
L_pw_176:
    s_waitcnt vmcnt(1)
    v_cmp_eq_u32 vcc, -1, v12
    s_cbranch_vccnz L_pr_177
    s_sleep 1
    buffer_load_dwordx4 v[12:15], v5, s[40:43], s57 offen sc1
    buffer_load_dwordx4 v[16:19], v5, s[40:43], s58 offen sc1
    buffer_load_dwordx4 v[20:23], v5, s[40:43], s59 offen sc1
    buffer_load_dwordx4 v[24:27], v5, s[40:43], s60 offen sc1
    s_sleep 2
L_gw_173:
    buffer_load_dwordx4 v[12:15], v5, s[40:43], s57 offen sc1
    buffer_load_dwordx4 v[16:19], v5, s[40:43], s58 offen sc1
    buffer_load_dwordx4 v[20:23], v5, s[40:43], s59 offen sc1
    buffer_load_dwordx4 v[24:27], v5, s[40:43], s60 offen sc1
    s_sub_u32 s56, s56, 1
    s_cbranch_scc1 L_done
    s_and_b32 s74, s56, 31
    s_waitcnt vmcnt(6)
    v_pk_add_f32 v[28:29], v[12:13], v[16:17]
    v_pk_add_f32 v[30:31], v[14:15], v[18:19]
    s_waitcnt vmcnt(5)
    v_pk_add_f32 v[28:29], v[28:29], v[20:21]
    v_pk_add_f32 v[30:31], v[30:31], v[22:23]
    s_waitcnt vmcnt(4)
    v_pk_add_f32 v[28:29], v[28:29], v[24:25]
    v_pk_add_f32 v[30:31], v[30:31], v[26:27]
    v_pk_add_f32 v[32:33], v[28:29], v[30:31]
    v_cmp_u_f32 vcc, v32, v33
    v_permlane32_swap_b32 v28, v30
    v_permlane32_swap_b32 v29, v31
    s_cbranch_vccnz L_gr_174
L_gk_175:
    v_pk_add_f32 v[28:29], v[28:29], v[30:31]
    v_pk_add_f32 v[28:29], v[28:29], v[2:3]
    v_cvt_pk_bf16_f32 v28, v28, v29
    ds_write_b32 v35, v28
    s_waitcnt lgkmcnt(0)
    s_barrier
    v_cndmask_b32 v29, 0, v28, s[64:65]
    v_dot2_f32_bf16 v33, v29, v61, 0
    v_dot2_f32_bf16 v32, v29, v29, 0
    v_lshlrev_b32 v2, 16, v28
    v_and_b32 v3, 0xffff0000, v28
    s_cmp_eq_u32 s55, 0
    v_permlane32_swap_b32 v33, v32
    v_add_f32 v33, v33, v32
    s_nop 1
    v_add_f32_dpp v33, v33, v33 row_ror:8 row_mask:0xf bank_mask:0xf
    s_nop 1
    v_add_f32_dpp v33, v33, v33 row_ror:4 row_mask:0xf bank_mask:0xf
    s_nop 1
    v_add_f32_dpp v33, v33, v33 row_ror:2 row_mask:0xf bank_mask:0xf
    s_nop 1
    v_add_f32_dpp v33, v33, v33 row_ror:1 row_mask:0xf bank_mask:0xf
    s_nop 1
    v_add_f32_dpp v33, v33, v33 row_bcast:15 row_mask:0xa bank_mask:0xf
    v_min_u32 v33, -2, v33
    s_cbranch_scc1 L_gs_178
    buffer_store_dword v33, v34, s[40:43], s67 offen
L_gb_179:
    s_waitcnt vmcnt(1)
    s_branch L_se_167
L_gs_183:
    buffer_store_dword v12, v11, s[40:43], s59 offen sc1
    s_branch L_gb_184
L_gr_189:
    s_cbranch_scc1 L_gw_188
    s_waitcnt vmcnt(0)
    v_max3_u32 v32, v12, v13, v14
    v_max3_u32 v32, v32, v15, v16
    v_max3_u32 v32, v32, v17, v18
    v_max3_u32 v32, v32, v19, v20
L_pad18:
    s_cbranch_execz L_pad22
    v_max3_u32 v32, v32, v21, v22
    v_max3_u32 v32, v32, v23, v24
    v_max3_u32 v32, v32, v25, v26
    v_max_u32 v32, v32, v27
    v_cmp_eq_u32 vcc, -1, v32
    s_cbranch_vccnz L_gw_188
    v_pk_add_f32 v[28:29], v[12:13], v[16:17]
    v_pk_add_f32 v[30:31], v[14:15], v[18:19]
    v_pk_add_f32 v[28:29], v[28:29], v[20:21]
    v_pk_add_f32 v[30:31], v[30:31], v[22:23]
    v_pk_add_f32 v[28:29], v[28:29], v[24:25]
    v_pk_add_f32 v[30:31], v[30:31], v[26:27]
    s_nop 1
    v_permlane32_swap_b32 v28, v30
    v_permlane32_swap_b32 v29, v31
    s_branch L_gk_190
L_gr_192:
    s_cbranch_scc1 L_gw_191
    s_waitcnt vmcnt(0)
    v_max3_u32 v32, v12, v13, v14
    v_max3_u32 v32, v32, v15, v16
    v_max3_u32 v32, v32, v17, v18
    v_max3_u32 v32, v32, v19, v20
    v_max3_u32 v32, v32, v21, v22
    v_max3_u32 v32, v32, v23, v24
    v_max3_u32 v32, v32, v25, v26
    v_max_u32 v32, v32, v27
    v_cmp_eq_u32 vcc, -1, v32
    s_cbranch_vccnz L_gw_191
    v_pk_add_f32 v[28:29], v[12:13], v[16:17]
    v_pk_add_f32 v[30:31], v[14:15], v[18:19]
    v_pk_add_f32 v[28:29], v[28:29], v[20:21]
    v_pk_add_f32 v[30:31], v[30:31], v[22:23]
    v_pk_add_f32 v[28:29], v[28:29], v[24:25]
    v_pk_add_f32 v[30:31], v[30:31], v[26:27]
    s_nop 1
    v_permlane32_swap_b32 v28, v30
    v_permlane32_swap_b32 v29, v31
    s_branch L_gk_193
L_gs_196:
    buffer_store_dword v33, v34, s[40:43], s67 offen sc1
    s_branch L_gb_197
L_w7_180:
    v_and_b32 v60, 31, v0
    v_min_u32 v60, 19, v60
    s_mul_i32 s57, s54, 320
    v_lshrrev_b32 v5, 5, v0
    v_lshlrev_b32 v5, 12, v5
    v_add_u32 v5, s57, v5
    v_lshl_add_u32 v5, v60, 4, v5
    v_and_b32 v60, 31, v0
    v_cmp_gt_u32 s[64:65], 20, v60
    v_min_u32 v60, 19, v60
    v_lshrrev_b32 v35, 5, v0
    v_lshlrev_b32 v35, 2, v35
    v_add_u32 v35, 160832, v35
    v_lshl_add_u32 v35, v60, 3, v35
    s_mul_i32 s66, s53, 6144
    s_add_u32 s66, s66, s62
    s_add_u32 s66, s66, 46080
    s_lshl_b32 s67, s53, 6
    s_add_u32 s67, s67, s62
    s_add_u32 s67, s67, 25600
    s_lshl_b32 s57, s54, 3
    v_lshrrev_b32 v34, 5, v0
    v_lshlrev_b32 v34, 2, v34
    v_add_u32 v34, s57, v34
    v_and_b32 v60, 31, v0
    v_mov_b32 v61, 0x7f000000
    v_cmp_ne_u32 vcc, 31, v60
    s_nop 1
    v_cndmask_b32 v34, v34, v61, vcc
    v_mov_b32 v61, 0x3f803f80
    s_cmp_lg_u32 s53, 3
    s_cbranch_scc0 L_skip_185
    s_add_u32 s57, s62, 25856
    v_mov_b32 v9, 0
L_pr_187:
    buffer_load_dword v12, v9, s[40:43], s57 offen sc1
    s_sub_u32 s56, s56, 1
    s_cbranch_scc1 L_done
L_pw_186:
    s_waitcnt vmcnt(0)
    v_cmp_eq_u32 vcc, -1, v12
    s_cbranch_vccnz L_pr_187
    s_add_u32 s57, s7, 0
    s_add_u32 s58, s7, 16384
    s_add_u32 s59, s7, 32768
    s_add_u32 s60, s7, 49152
L_gw_188:
    buffer_load_dwordx4 v[12:15], v5, s[40:43], s57 offen sc1
    buffer_load_dwordx4 v[16:19], v5, s[40:43], s58 offen sc1
L_pad19:
    s_cbranch_execz L_pad23
    buffer_load_dwordx4 v[20:23], v5, s[40:43], s59 offen sc1
    buffer_load_dwordx4 v[24:27], v5, s[40:43], s60 offen sc1
    s_sub_u32 s56, s56, 1
    s_cbranch_scc1 L_done
    s_and_b32 s74, s56, 31
    s_waitcnt vmcnt(2)
    v_pk_add_f32 v[28:29], v[12:13], v[16:17]
    v_pk_add_f32 v[30:31], v[14:15], v[18:19]
    s_waitcnt vmcnt(1)
    v_pk_add_f32 v[28:29], v[28:29], v[20:21]
    v_pk_add_f32 v[30:31], v[30:31], v[22:23]
    s_waitcnt vmcnt(0)
    v_pk_add_f32 v[28:29], v[28:29], v[24:25]
    v_pk_add_f32 v[30:31], v[30:31], v[26:27]
    v_pk_add_f32 v[32:33], v[28:29], v[30:31]
    v_cmp_u_f32 vcc, v32, v33
    v_permlane32_swap_b32 v28, v30
    v_permlane32_swap_b32 v29, v31
    s_cbranch_vccnz L_gr_189
L_gk_190:
    v_pk_add_f32 v[28:29], v[28:29], v[30:31]
    v_pk_add_f32 v[28:29], v[28:29], v[2:3]
    v_cvt_pk_bf16_f32 v28, v28, v29
    v_lshlrev_b32 v2, 16, v28
    v_and_b32 v3, 0xffff0000, v28
L_skip_185:
    v_lshlrev_b32 v60, 16, v4
    v_add_f32 v2, v2, v60
    v_and_b32 v60, 0xffff0000, v4
    v_add_f32 v3, v3, v60
    s_add_u32 s57, s7, 66048
    s_add_u32 s58, s7, 82432
    s_add_u32 s59, s7, 98816
    s_add_u32 s60, s7, 115200
    s_lshl_b32 s74, s53, 7
    s_add_u32 s75, s62, s74
    s_add_u32 s75, s75, 26116
    v_mov_b32 v9, 0
    buffer_load_dword v12, v9, s[40:43], s75 offen sc1
    s_sleep 2
L_pr_195:
    buffer_load_dword v12, v9, s[40:43], s75 offen sc1
    s_sub_u32 s56, s56, 1
    s_cbranch_scc1 L_done
L_pw_194:
    s_waitcnt vmcnt(1)
    v_cmp_eq_u32 vcc, -1, v12
    s_cbranch_vccnz L_pr_195
    buffer_load_dwordx4 v[12:15], v5, s[40:43], s57 offen sc1
    buffer_load_dwordx4 v[16:19], v5, s[40:43], s58 offen sc1
    buffer_load_dwordx4 v[20:23], v5, s[40:43], s59 offen sc1
    buffer_load_dwordx4 v[24:27], v5, s[40:43], s60 offen sc1
    s_sleep 2
L_gw_191:
    buffer_load_dwordx4 v[12:15], v5, s[40:43], s57 offen sc1
    buffer_load_dwordx4 v[16:19], v5, s[40:43], s58 offen sc1
    buffer_load_dwordx4 v[20:23], v5, s[40:43], s59 offen sc1
    buffer_load_dwordx4 v[24:27], v5, s[40:43], s60 offen sc1
    s_sub_u32 s56, s56, 1
    s_cbranch_scc1 L_done
    s_and_b32 s74, s56, 31
    s_waitcnt vmcnt(6)
    v_pk_add_f32 v[28:29], v[12:13], v[16:17]
    v_pk_add_f32 v[30:31], v[14:15], v[18:19]
    s_waitcnt vmcnt(5)
    v_pk_add_f32 v[28:29], v[28:29], v[20:21]
    v_pk_add_f32 v[30:31], v[30:31], v[22:23]
    s_waitcnt vmcnt(4)
    v_pk_add_f32 v[28:29], v[28:29], v[24:25]
    v_pk_add_f32 v[30:31], v[30:31], v[26:27]
    v_pk_add_f32 v[32:33], v[28:29], v[30:31]
    v_cmp_u_f32 vcc, v32, v33
    v_permlane32_swap_b32 v28, v30
    v_permlane32_swap_b32 v29, v31
    s_cbranch_vccnz L_gr_192
L_gk_193:
    v_pk_add_f32 v[28:29], v[28:29], v[30:31]
    v_pk_add_f32 v[28:29], v[28:29], v[2:3]
    v_cvt_pk_bf16_f32 v28, v28, v29
    ds_write_b32 v35, v28
    s_waitcnt lgkmcnt(0)
    s_barrier
    v_cndmask_b32 v29, 0, v28, s[64:65]
    v_dot2_f32_bf16 v33, v29, v61, 0
    v_dot2_f32_bf16 v32, v29, v29, 0
    v_lshlrev_b32 v2, 16, v28
    v_and_b32 v3, 0xffff0000, v28
    s_cmp_eq_u32 s55, 0
    v_permlane32_swap_b32 v33, v32
L_pad20:
    s_cbranch_execz L_padback
    v_add_f32 v33, v33, v32
    s_nop 1
    v_add_f32_dpp v33, v33, v33 row_ror:8 row_mask:0xf bank_mask:0xf
    s_nop 1
    v_add_f32_dpp v33, v33, v33 row_ror:4 row_mask:0xf bank_mask:0xf
    s_nop 1
    v_add_f32_dpp v33, v33, v33 row_ror:2 row_mask:0xf bank_mask:0xf
    s_nop 1
    v_add_f32_dpp v33, v33, v33 row_ror:1 row_mask:0xf bank_mask:0xf
    s_nop 1
    v_add_f32_dpp v33, v33, v33 row_bcast:15 row_mask:0xa bank_mask:0xf
    v_min_u32 v33, -2, v33
    s_cbranch_scc1 L_gs_196
    buffer_store_dword v33, v34, s[40:43], s67 offen
L_gb_197:
    s_waitcnt vmcnt(1)
    s_branch L_se_181
L_hr_202:
    buffer_load_dwordx4 v[12:15], v7, s[40:43], s59 offen offset:0 sc1
    buffer_load_dwordx4 v[16:19], v7, s[40:43], s59 offen offset:1024 sc1
    s_sub_u32 s56, s56, 1
    s_cbranch_scc1 L_done
    s_and_b32 s64, s56, 31
    s_cbranch_scc0 L_hx_204
    s_waitcnt vmcnt(0)
    v_pk_add_f32 v[20:21], v[12:13], v[16:17]
    v_pk_add_f32 v[22:23], v[14:15], v[18:19]
    s_nop 1
    v_permlane32_swap_b32 v20, v22
    v_permlane32_swap_b32 v21, v23
    v_pk_add_f32 v[20:21], v[20:21], v[22:23]
    s_nop 1
    v_permlane16_swap_b32 v20, v21
    v_add_f32 v20, v20, v21
    v_cmp_u_f32 vcc, v20, v20
    v_sub_f32 v20, v20, v50
    s_cbranch_vccnz L_hr_202
    s_branch L_hk_203
L_hx_204:
    s_waitcnt vmcnt(0)
    v_max3_u32 v20, v12, v13, v14
    v_max3_u32 v20, v20, v15, v16
    v_max3_u32 v20, v20, v17, v18
    v_max_u32 v20, v20, v19
    v_cmp_eq_u32 vcc, -1, v20
    s_cbranch_vccnz L_hr_202
    v_pk_add_f32 v[20:21], v[12:13], v[16:17]
    v_pk_add_f32 v[22:23], v[14:15], v[18:19]
    s_nop 1
    v_permlane32_swap_b32 v20, v22
    v_permlane32_swap_b32 v21, v23
    v_pk_add_f32 v[20:21], v[20:21], v[22:23]
    s_nop 1
    v_permlane16_swap_b32 v20, v21
    v_add_f32 v20, v20, v21
    v_sub_f32 v20, v20, v50
    s_branch L_hk_203
L_qo_198:
    v_mov_b64 v[24:25], 0
    v_mov_b64 v[26:27], 0
    v_mov_b64 v[28:29], 0
    v_mov_b64 v[30:31], 0
    v_mov_b64 v[32:33], 0
    v_mov_b64 v[34:35], 0
    v_mov_b64 v[36:37], 0
    v_mov_b64 v[38:39], 0
    v_mov_b64 v[40:41], 0
    v_mov_b64 v[42:43], 0
    v_mov_b64 v[44:45], 0
    v_mov_b64 v[46:47], 0
    v_lshrrev_b32 v5, 4, v0
    v_lshlrev_b32 v5, 5, v5
    v_bfe_u32 v60, v0, 1, 1
    v_lshl_add_u32 v5, v60, 4, v5
    v_add_u32 v5, 124928, v5
    s_branch L_qb_199
L_mr_205:
    ds_read_b32 v36, v62
    s_sub_u32 s56, s56, 1
    s_cbranch_scc1 L_done
    s_waitcnt lgkmcnt(0)
    v_cmp_eq_u32 vcc, -1, v36
    s_cbranch_vccnz L_mr_205
    v_max_f32_dpp v37, v36, v36 row_ror:4 row_mask:0xf bank_mask:0xf
    s_nop 1
    v_max_f32_dpp v37, v37, v37 row_ror:2 row_mask:0xf bank_mask:0xf
    s_nop 1
    v_max_f32_dpp v37, v37, v37 row_ror:1 row_mask:0xf bank_mask:0xf
    v_sub_f32 v39, v61, v37
    v_exp_f32 v39, v39
    s_branch L_mk_206
L_gs_207:
    buffer_store_dword v37, v4, s[40:43], s58 offen sc1
    s_branch L_gb_208
L_gs_209:
    buffer_store_dword v14, v3, s[40:43], s57 offen sc1
    s_branch L_gb_210
L_gs_211:
    buffer_store_dword v12, v4, s[40:43], s57 offen offset:32 sc1
    s_branch L_gb_212
L_comb_1:
    s_mov_b32 s58, 26624
    v_min_u32 v37, -2, v37
    s_cmp_eq_u32 s55, 0
    s_cbranch_scc1 L_gs_207
    buffer_store_dword v37, v4, s[40:43], s58 offen
L_gb_208:
    s_mov_b32 s57, 26624
L_pad21:
    s_cbranch_execz L_padback
    s_cmp_eq_u32 s55, 0
    s_waitcnt lgkmcnt(0)
    s_barrier
    ds_read2st64_b64 v[12:15], v2 offset0:0 offset1:4
    ds_read2st64_b64 v[16:19], v2 offset0:8 offset1:12
    ds_read2st64_b64 v[20:23], v2 offset0:16 offset1:20
    ds_read2st64_b64 v[24:27], v2 offset0:24 offset1:28
    s_waitcnt lgkmcnt(2)
    v_pk_add_f32 v[12:13], v[12:13], v[14:15]
    v_pk_add_f32 v[16:17], v[16:17], v[18:19]
    v_pk_add_f32 v[12:13], v[12:13], v[16:17]
    s_waitcnt lgkmcnt(0)
    v_pk_add_f32 v[20:21], v[20:21], v[22:23]
    v_pk_add_f32 v[24:25], v[24:25], v[26:27]
    v_pk_add_f32 v[12:13], v[12:13], v[20:21]
    v_pk_add_f32 v[12:13], v[12:13], v[24:25]
    v_cvt_pk_bf16_f32 v14, v12, v13
    v_min_u32 v12, -2, v12
    v_min_u32 v14, -2, v14
    s_cbranch_scc1 L_gs_209
    buffer_store_dword v14, v3, s[40:43], s57 offen
L_gb_210:
    s_cbranch_scc1 L_gs_211
    buffer_store_dword v12, v4, s[40:43], s57 offen offset:32
L_gb_212:
    s_branch L_comb_1b
L_sr_222:
    buffer_load_dwordx4 v[52:55], v11, s[40:43], s65 offen offset:0 sc1
    buffer_load_dwordx4 v[56:59], v11, s[40:43], s65 offen offset:1024 sc1
    s_sub_u32 s56, s56, 1
    s_cbranch_scc1 L_done
    s_waitcnt vmcnt(0)
    s_branch L_sw_221
L_hr_223:
    buffer_load_dwordx4 v[12:15], v11, s[40:43], s58 offen offset:0 sc1
    buffer_load_dwordx4 v[16:19], v11, s[40:43], s58 offen offset:1024 sc1
    s_sub_u32 s56, s56, 1
    s_cbranch_scc1 L_done
    s_and_b32 s64, s56, 31
    s_cbranch_scc0 L_hx_225
    s_waitcnt vmcnt(2)
    v_pk_add_f32 v[20:21], v[12:13], v[16:17]
    v_pk_add_f32 v[22:23], v[14:15], v[18:19]
    s_nop 1
    v_permlane32_swap_b32 v20, v22
    v_permlane32_swap_b32 v21, v23
    v_pk_add_f32 v[20:21], v[20:21], v[22:23]
    s_nop 1
    v_permlane16_swap_b32 v20, v21
    v_add_f32 v20, v20, v21
    v_cmp_u_f32 vcc, v20, v20
    v_sub_f32 v20, v20, v26
    s_cbranch_vccnz L_hr_223
    s_branch L_hk_224
L_hx_225:
    s_waitcnt vmcnt(0)
    v_max3_u32 v20, v12, v13, v14
    v_max3_u32 v20, v20, v15, v16
    v_max3_u32 v20, v20, v17, v18
    v_max_u32 v20, v20, v19
    v_cmp_eq_u32 vcc, -1, v20
    s_cbranch_vccnz L_hr_223
    v_pk_add_f32 v[20:21], v[12:13], v[16:17]
    v_pk_add_f32 v[22:23], v[14:15], v[18:19]
    s_nop 1
    v_permlane32_swap_b32 v20, v22
    v_permlane32_swap_b32 v21, v23
    v_pk_add_f32 v[20:21], v[20:21], v[22:23]
    s_nop 1
    v_permlane16_swap_b32 v20, v21
    v_add_f32 v20, v20, v21
    v_sub_f32 v20, v20, v26
    s_branch L_hk_224
L_typeC_228:
    s_cmp_eq_u32 s30, 6
    s_cbranch_scc0 L_done
    s_cmp_eq_u32 s3, 20
    s_cbranch_scc0 L_done
    s_lshl_b32 s59, s31, 9
    s_add_u32 s59, s59, s8
    s_add_u32 s59, s59, 266240
    v_and_b32 v10, 1, v0
    v_lshlrev_b32 v10, 13, v10
    v_lshrrev_b32 v60, 1, v0
    v_lshl_add_u32 v10, v60, 24, v10
    s_add_u32 s58, s62, 28192
    v_lshrrev_b32 v9, 3, v0
    v_mul_u32_u24 v9, 1664, v9
    v_and_b32 v60, 7, v0
    v_lshl_add_u32 v9, v60, 2, v9
    buffer_load_dword v12, v9, s[40:43], s58 offen sc1
    s_sleep 2
L_pr_230:
    buffer_load_dword v12, v9, s[40:43], s58 offen sc1
    s_sub_u32 s56, s56, 1
    s_cbranch_scc1 L_done
L_pw_229:
    s_waitcnt vmcnt(1)
    v_cmp_eq_u32 vcc, -1, v12
    s_cbranch_vccnz L_pr_230
L_pad22:
    s_cbranch_execz L_padback
    buffer_store_dword v0, v10, s[40:43], s59 offen offset:8 sc1
    s_add_u32 s58, s62, 25984
    v_and_b32 v9, 15, v0
    v_lshlrev_b32 v9, 2, v9
    buffer_load_dword v13, v9, s[40:43], s58 offen sc1
    s_sleep 2
L_pr_232:
    buffer_load_dword v13, v9, s[40:43], s58 offen sc1
    s_sub_u32 s56, s56, 1
    s_cbranch_scc1 L_done
L_pw_231:
    s_waitcnt vmcnt(1)
    v_cmp_eq_u32 vcc, -1, v13
    s_cbranch_vccnz L_pr_232
    buffer_store_dword v0, v10, s[40:43], s59 offen offset:12 sc1
    s_waitcnt vmcnt(1)
    s_branch L_done
L_gs_236:
    buffer_store_dword v12, v11, s[40:43], s59 offen sc1
    s_branch L_gb_237
L_gr_239:
    s_cbranch_scc1 L_gw_238
    s_waitcnt vmcnt(0)
    v_max3_u32 v32, v12, v13, v14
    v_max3_u32 v32, v32, v15, v16
    v_max3_u32 v32, v32, v17, v18
    v_max3_u32 v32, v32, v19, v20
    v_max3_u32 v32, v32, v21, v22
    v_max3_u32 v32, v32, v23, v24
    v_max3_u32 v32, v32, v25, v26
    v_max_u32 v32, v32, v27
    v_cmp_eq_u32 vcc, -1, v32
    s_cbranch_vccnz L_gw_238
    v_pk_add_f32 v[28:29], v[12:13], v[16:17]
    v_pk_add_f32 v[30:31], v[14:15], v[18:19]
    v_pk_add_f32 v[28:29], v[28:29], v[20:21]
    v_pk_add_f32 v[30:31], v[30:31], v[22:23]
    v_pk_add_f32 v[28:29], v[28:29], v[24:25]
    v_pk_add_f32 v[30:31], v[30:31], v[26:27]
    s_nop 1
    v_permlane32_swap_b32 v28, v30
    v_permlane32_swap_b32 v29, v31
    s_branch L_gk_240
L_gs_243:
    buffer_store_dword v33, v34, s[40:43], s67 offen sc1
    s_branch L_gb_244
L_w7_233:
    v_and_b32 v60, 31, v0
    v_min_u32 v60, 19, v60
    s_mul_i32 s57, s54, 320
    v_lshrrev_b32 v5, 5, v0
    v_lshlrev_b32 v5, 12, v5
    v_add_u32 v5, s57, v5
    v_lshl_add_u32 v5, v60, 4, v5
    v_and_b32 v60, 31, v0
    v_cmp_gt_u32 s[64:65], 20, v60
    v_min_u32 v60, 19, v60
    v_lshrrev_b32 v35, 5, v0
    v_lshlrev_b32 v35, 2, v35
    v_add_u32 v35, 160832, v35
    v_lshl_add_u32 v35, v60, 3, v35
    s_add_u32 s66, s62, 39936
    s_add_u32 s67, s62, 25984
    s_lshl_b32 s57, s54, 3
    v_lshrrev_b32 v34, 5, v0
    v_lshlrev_b32 v34, 2, v34
    v_add_u32 v34, s57, v34
    v_and_b32 v60, 31, v0
    v_mov_b32 v61, 0x7f000000
    v_cmp_ne_u32 vcc, 31, v60
    s_nop 1
    v_cndmask_b32 v34, v34, v61, vcc
    v_mov_b32 v61, 0x3f803f80
    s_add_u32 s57, s7, 132096
    s_add_u32 s58, s7, 148480
    s_add_u32 s59, s7, 164864
    s_add_u32 s60, s7, 181248
    s_add_u32 s75, s7, 266248
    v_and_b32 v9, 7, v0
    v_lshlrev_b32 v9, 9, v9
    buffer_load_dword v12, v9, s[40:43], s75 offen sc1
    s_sleep 2
L_pr_242:
    buffer_load_dword v12, v9, s[40:43], s75 offen sc1
    s_sub_u32 s56, s56, 1
    s_cbranch_scc1 L_done
L_pw_241:
    s_waitcnt vmcnt(1)
    v_cmp_eq_u32 vcc, -1, v12
    s_cbranch_vccnz L_pr_242
    s_sleep 2
    buffer_load_dwordx4 v[12:15], v5, s[40:43], s57 offen sc1
    buffer_load_dwordx4 v[16:19], v5, s[40:43], s58 offen sc1
    buffer_load_dwordx4 v[20:23], v5, s[40:43], s59 offen sc1
    buffer_load_dwordx4 v[24:27], v5, s[40:43], s60 offen sc1
L_pad23:
    s_cbranch_execz L_padback
    s_sleep 2
L_gw_238:
    buffer_load_dwordx4 v[12:15], v5, s[40:43], s57 offen sc1
    buffer_load_dwordx4 v[16:19], v5, s[40:43], s58 offen sc1
    buffer_load_dwordx4 v[20:23], v5, s[40:43], s59 offen sc1
    buffer_load_dwordx4 v[24:27], v5, s[40:43], s60 offen sc1
    s_sub_u32 s56, s56, 1
    s_cbranch_scc1 L_done
    s_and_b32 s74, s56, 31
    s_waitcnt vmcnt(6)
    v_pk_add_f32 v[28:29], v[12:13], v[16:17]
    v_pk_add_f32 v[30:31], v[14:15], v[18:19]
    s_waitcnt vmcnt(5)
    v_pk_add_f32 v[28:29], v[28:29], v[20:21]
    v_pk_add_f32 v[30:31], v[30:31], v[22:23]
    s_waitcnt vmcnt(4)
    v_pk_add_f32 v[28:29], v[28:29], v[24:25]
    v_pk_add_f32 v[30:31], v[30:31], v[26:27]
    v_pk_add_f32 v[32:33], v[28:29], v[30:31]
    v_cmp_u_f32 vcc, v32, v33
    v_permlane32_swap_b32 v28, v30
    v_permlane32_swap_b32 v29, v31
    s_cbranch_vccnz L_gr_239
L_gk_240:
    v_pk_add_f32 v[28:29], v[28:29], v[30:31]
    v_pk_add_f32 v[28:29], v[28:29], v[2:3]
    v_cvt_pk_bf16_f32 v28, v28, v29
    ds_write_b32 v35, v28
    s_waitcnt lgkmcnt(0)
    s_barrier
    v_cndmask_b32 v29, 0, v28, s[64:65]
    v_dot2_f32_bf16 v33, v29, v61, 0
    v_dot2_f32_bf16 v32, v29, v29, 0
    v_lshlrev_b32 v2, 16, v28
    v_and_b32 v3, 0xffff0000, v28
    s_cmp_eq_u32 s55, 0
    v_permlane32_swap_b32 v33, v32
    v_add_f32 v33, v33, v32
    s_nop 1
    v_add_f32_dpp v33, v33, v33 row_ror:8 row_mask:0xf bank_mask:0xf
    s_nop 1
    v_add_f32_dpp v33, v33, v33 row_ror:4 row_mask:0xf bank_mask:0xf
    s_nop 1
    v_add_f32_dpp v33, v33, v33 row_ror:2 row_mask:0xf bank_mask:0xf
    s_nop 1
    v_add_f32_dpp v33, v33, v33 row_ror:1 row_mask:0xf bank_mask:0xf
    s_nop 1
    v_add_f32_dpp v33, v33, v33 row_bcast:15 row_mask:0xa bank_mask:0xf
    v_min_u32 v33, -2, v33
    s_cbranch_scc1 L_gs_243
    buffer_store_dword v33, v34, s[40:43], s67 offen
L_gb_244:
    s_waitcnt vmcnt(1)
    s_branch L_se_234
L_gr_246:
    s_cbranch_scc1 L_gw_245
    s_waitcnt vmcnt(0)
    v_max3_u32 v32, v12, v13, v14
    v_max3_u32 v32, v32, v15, v16
    v_max3_u32 v32, v32, v17, v18
    v_max3_u32 v32, v32, v19, v20
    v_max3_u32 v32, v32, v21, v22
    v_max3_u32 v32, v32, v23, v24
    v_max3_u32 v32, v32, v25, v26
    v_max_u32 v32, v32, v27
    v_cmp_eq_u32 vcc, -1, v32
    s_cbranch_vccnz L_gw_245
    v_pk_add_f32 v[28:29], v[12:13], v[16:17]
    v_pk_add_f32 v[30:31], v[14:15], v[18:19]
    v_pk_add_f32 v[28:29], v[28:29], v[20:21]
    v_pk_add_f32 v[30:31], v[30:31], v[22:23]
    v_pk_add_f32 v[28:29], v[28:29], v[24:25]
    v_pk_add_f32 v[30:31], v[30:31], v[26:27]
    s_nop 1
    v_permlane32_swap_b32 v28, v30
    v_permlane32_swap_b32 v29, v31
    s_branch L_gk_247
L_tail_end:
L_spread:
    s_add_u32 s62, s62, 966656
    s_cmp_eq_u32 s30, 5
    s_cbranch_scc0 L_skip_82
    v_mov_b64 v[12:13], -1
    v_mov_b64 v[14:15], -1
    v_lshlrev_b32 v16, 4, v0
    s_mul_i32 s57, s52, 2208
    s_add_u32 s57, s57, s62
    s_mov_b64 exec, 0x3ff
    buffer_store_dwordx4 v[12:15], v16, s[40:43], s57 offen offset:2048 sc1
    s_mov_b64 exec, -1
    buffer_store_dwordx4 v[12:15], v16, s[40:43], s57 offen offset:0 sc1
    buffer_store_dwordx4 v[12:15], v16, s[40:43], s57 offen offset:1024 sc1
L_skip_82:
    s_cmp_eq_u32 s30, 7
    s_cbranch_scc0 L_skip_83
    v_and_b32 v60, 31, v0
    v_cmp_gt_u32 s[64:65], 20, v60
    v_min_u32 v60, 19, v60
    v_lshrrev_b32 v35, 5, v0
    v_lshlrev_b32 v35, 2, v35
    v_add_u32 v35, 160832, v35
    v_lshl_add_u32 v35, v60, 3, v35
    s_mul_i32 s66, s53, 12416
    s_add_u32 s66, s66, s62
    s_add_u32 s66, s66, 70656
    s_add_u32 s67, s66, 12288
    s_lshl_b32 s57, s54, 3
    v_lshrrev_b32 v34, 5, v0
    v_lshlrev_b32 v34, 2, v34
    v_add_u32 v34, s57, v34
    v_and_b32 v60, 31, v0
    v_mov_b32 v61, 0x7f000000
    v_cmp_ne_u32 vcc, 31, v60
    s_nop 1
    v_cndmask_b32 v34, v34, v61, vcc
    v_mov_b32 v61, 0x3f803f80
    v_cvt_pk_bf16_f32 v28, v2, v3
L_skip_83:
    s_cmp_eq_u32 s30, 7
    s_cbranch_scc0 L_skip_84
    v_cndmask_b32 v29, 0, v28, s[64:65]
    v_dot2_f32_bf16 v33, v29, v61, 0
    v_dot2_f32_bf16 v32, v29, v29, 0
    v_lshlrev_b32 v2, 16, v28
    v_and_b32 v3, 0xffff0000, v28
    s_cmp_eq_u32 s55, 0
    v_permlane32_swap_b32 v33, v32
    v_add_f32 v33, v33, v32
    s_nop 1
    v_add_f32_dpp v33, v33, v33 row_ror:8 row_mask:0xf bank_mask:0xf
    s_nop 1
    v_add_f32_dpp v33, v33, v33 row_ror:4 row_mask:0xf bank_mask:0xf
    s_nop 1
    v_add_f32_dpp v33, v33, v33 row_ror:2 row_mask:0xf bank_mask:0xf
    s_nop 1
    v_add_f32_dpp v33, v33, v33 row_ror:1 row_mask:0xf bank_mask:0xf
    s_nop 1
    v_add_f32_dpp v33, v33, v33 row_bcast:15 row_mask:0xa bank_mask:0xf
    v_min_u32 v33, -2, v33
    s_cbranch_scc1 L_gs_85
    buffer_store_dword v33, v34, s[40:43], s67 offen
L_gb_86:
    s_waitcnt vmcnt(1)
L_skip_84:
    s_cmp_lt_u32 s30, 6
    s_cbranch_scc0 L_skip_87
    s_lshr_b32 s57, s30, 1
    s_mul_i32 s57, s57, 1024
    s_and_b32 s58, s30, 1
    s_lshl_b32 s58, s58, 6
    s_add_u32 s57, s57, s58
    v_lshrrev_b32 v18, 5, v0
    v_mul_u32_u24 v18, 6144, v18
    v_bfe_u32 v60, v0, 3, 1
    v_mul_u32_u24 v60, 3072, v60
    v_add_u32 v18, v60, v18
    v_bfe_u32 v60, v0, 4, 1
    v_lshl_add_u32 v18, v60, 9, v18
    v_bfe_u32 v60, v0, 2, 1
    v_lshl_add_u32 v18, v60, 7, v18
    v_and_b32 v60, 3, v0
    v_lshl_add_u32 v18, v60, 3, v18
    v_add_u32 v18, s57, v18
    v_bfe_u32 v19, v0, 4, 1
    v_mul_u32_u24 v19, 3072, v19
    v_bfe_u32 v60, v0, 3, 1
    v_lshl_add_u32 v19, v60, 9, v19
    v_bfe_u32 v60, v0, 2, 1
    v_lshl_add_u32 v19, v60, 7, v19
    v_and_b32 v60, 3, v0
    v_lshl_add_u32 v19, v60, 3, v19
    v_add_u32 v19, s57, v19
    v_add_u32 v19, 24576, v19
    ds_read_b64_tr_b16 v[28:29], v18 offset:0
    ds_read_b64_tr_b16 v[30:31], v18 offset:256
    ds_read_b64_tr_b16 v[32:33], v18 offset:12288
    ds_read_b64_tr_b16 v[34:35], v18 offset:12544
    ds_read_b64_tr_b16 v[36:37], v19 offset:0
    ds_read_b64_tr_b16 v[38:39], v19 offset:256
    ds_read_b64_tr_b16 v[40:41], v18 offset:32
    ds_read_b64_tr_b16 v[42:43], v18 offset:288
    ds_read_b64_tr_b16 v[44:45], v18 offset:12320
    ds_read_b64_tr_b16 v[46:47], v18 offset:12576
    ds_read_b64_tr_b16 v[48:49], v19 offset:32
    ds_read_b64_tr_b16 v[50:51], v19 offset:288
    v_lshrrev_b32 v52, 4, v0
    v_lshlrev_b32 v52, 5, v52
    v_bfe_u32 v60, v0, 1, 1
    v_lshl_add_u32 v52, v60, 4, v52
    v_and_b32 v60, 1, v0
    v_mul_u32_u24 v60, 192, v60
    v_add_u32 v52, v60, v52
    v_add_u32 v52, 160832, v52
    v_lshrrev_b32 v53, 4, v0
    v_lshlrev_b32 v53, 4, v53
    v_bfe_u32 v60, v0, 1, 1
    v_lshl_add_u32 v53, v60, 3, v53
    v_and_b32 v60, 1, v0
    v_mul_u32_u24 v60, 192, v60
    v_add_u32 v53, v60, v53
    v_add_u32 v53, 160960, v53
    v_mov_b64 v[20:21], 0
    v_mov_b64 v[22:23], 0
    v_mov_b64 v[24:25], 0
    v_mov_b64 v[26:27], 0
    s_lshr_b32 s57, s30, 1
    s_lshl_b32 s57, s57, 11
    s_lshl_b32 s58, s58, 1
    s_add_u32 s57, s57, s58
    s_lshl_b32 s58, s54, 8
    s_add_u32 s57, s57, s58
    v_and_b32 v54, 31, v0
    v_lshlrev_b32 v54, 2, v54
    v_lshrrev_b32 v60, 5, v0
    v_mul_u32_u24 v60, 6144, v60
    v_add_u32 v54, v60, v54
    v_add_u32 v54, s57, v54
    s_mul_i32 s59, s53, 12416
    s_add_u32 s59, s59, s62
    s_add_u32 s59, s59, 70656
    s_add_u32 s60, s59, 12288
    ds_read_b128 v[12:15], v52
    ds_read_b64 v[16:17], v53
    s_waitcnt lgkmcnt(1)
    v_smfmac_f32_16x16x64_bf16 v[20:23], v[12:15], v[28:35], v1
    v_smfmac_f32_16x16x64_bf16 v[24:27], v[12:15], v[40:47], v1
    s_waitcnt lgkmcnt(0)
    v_smfmac_f32_16x16x32_bf16 v[20:23], v[16:17], v[36:39], v1
    v_smfmac_f32_16x16x32_bf16 v[24:27], v[16:17], v[48:51], v1
    s_cmp_eq_u32 s55, 0
    s_nop 5
    v_add_f32 v12, v20, v22
    s_nop 1
    v_add_f32_dpp v12, v24, v26 quad_perm:[0,1,2,3] row_mask:0x2 bank_mask:0xf
    s_nop 1
    v_add_f32_dpp v12, v21, v23 quad_perm:[0,1,2,3] row_mask:0x4 bank_mask:0xf
    s_nop 1
    v_add_f32_dpp v12, v25, v27 quad_perm:[0,1,2,3] row_mask:0x8 bank_mask:0xf
    v_min_u32 v12, -2, v12
    s_cbranch_scc1 L_gs_88
    buffer_store_dword v12, v54, s[40:43], s59 offen
L_gb_89:
L_skip_87:
    s_waitcnt vmcnt(0)
    s_barrier
    s_cmp_eq_u32 s30, 5
    s_cbranch_scc0 L_skip_90
    v_mov_b32 v25, 0
    s_lshl_b32 s57, s52, 2
    s_add_u32 s57, s57, s72
    s_mov_b64 exec, 1
    buffer_store_dword v25, v0, s[40:43], s57 offen offset:256 sc1
    s_mov_b64 exec, -1
    v_and_b32 v16, 31, v0
    v_lshlrev_b32 v16, 2, v16
L_pr_92:
    buffer_load_dword v17, v16, s[40:43], s72 offen offset:256 sc1
    s_sub_u32 s56, s56, 1
    s_cbranch_scc1 L_done
L_pw_91:
    s_waitcnt vmcnt(0)
    v_cmp_eq_u32 vcc, -1, v17
    s_cbranch_vccnz L_pr_92
L_skip_90:
    s_barrier
    s_branch L_spread_back
L_done:
L_exit:
    s_endpgm
.section .rodata,"a"
.p2align 6
.amdhsa_kernel interleave_layers__sliding_block_cached__dense_activation_gelu__decode_kernel
  .amdhsa_next_free_vgpr 256
  .amdhsa_next_free_sgpr 102
  .amdhsa_accum_offset 256
  .amdhsa_group_segment_fixed_size 0
  .amdhsa_kernarg_size 104
  .amdhsa_user_sgpr_count 2
  .amdhsa_user_sgpr_kernarg_segment_ptr 1
  .amdhsa_system_sgpr_workgroup_id_x 1
  .amdhsa_float_denorm_mode_32 3
.end_amdhsa_kernel
```

```asm
; @launch grid=(256,1,1) block=(512,1,1) lds=161216
.amdgcn_target "amdgcn-amd-amdhsa--gfx950"
.text
.fill 64, 4, 0xbf800000
.globl interleave_layers__sliding_block_cached__dense_activation_gelu__decode_kernel
.p2align 8
.type interleave_layers__sliding_block_cached__dense_activation_gelu__decode_kernel,@function
interleave_layers__sliding_block_cached__dense_activation_gelu__decode_kernel:
    s_load_dwordx16 s[4:19], s[0:1], 0
    s_cmp_ge_u32 s2, 256
    s_cbranch_scc1 L_exit
    v_lshrrev_b32 v5, 6, v0
    v_lshlrev_b32 v62, 6, v0
    v_readfirstlane_b32 s30, v5
    v_and_b32 v0, 63, v0
    s_getpc_b64 s[74:75]
L_pc:
    v_min_u32 v62, L_exit-L_pc, v62
    global_load_dword v63, v62, s[74:75]
    s_cmp_eq_u32 s30, 6
    s_cbranch_scc0 L_skip_1
    s_setprio 3
L_skip_1:
    s_and_b32 s31, s2, 7
    s_lshr_b32 s52, s2, 3
    s_and_b32 s53, s52, 3
    s_lshr_b32 s54, s52, 2
    s_lshl_b32 s73, s31, 2
    s_add_u32 s73, s73, s53
    v_lshrrev_b32 v8, 5, v0
    v_lshlrev_b32 v8, 2, v8
    v_bfe_u32 v60, v0, 4, 1
    v_lshl_add_u32 v8, v60, 0, v8
    v_and_b32 v9, 7, v0
    v_xor_b32 v8, v8, v9
    v_lshrrev_b32 v10, 3, v0
    v_mul_u32_u24 v10, 384, v10
    v_lshl_add_u32 v5, v8, 4, v10
    v_xor_b32 v6, 32, v5
    s_mul_i32 s64, s73, 12582912
    s_mul_i32 s58, s54, 3072
    s_add_u32 s64, s64, s58
    s_add_u32 s64, s64, 11010048
    s_sub_u32 s34, 1572864, s58
    s_mov_b32 s35, 0x20000
    s_mov_b32 s57, 0
    s_mov_b32 s58, 195584
    s_mov_b32 m0, 92160
    s_cmp_eq_u32 s30, 6
    s_cselect_b64 vcc, -1, 0
    s_waitcnt lgkmcnt(0)
    s_add_u32 s32, s6, s64
    s_addc_u32 s33, s7, 0
    s_load_dwordx8 s[20:27], s[0:1], 64
    s_load_dwordx2 s[28:29], s[0:1], 96
    s_cbranch_vccz L_skip_3
L_dma_2:
    buffer_load_dwordx4 v5, s[32:35], s57 offen offset:0 nt lds
    buffer_load_dwordx4 v6, s[32:35], s58 offen offset:1024 nt lds
    s_add_u32 s57, s57, 24576
    s_add_u32 s58, s58, 24576
    s_add_u32 m0, m0, 2048
    s_cmp_lg_u32 m0, 108544
    s_cbranch_scc1 L_dma_2
    s_mov_b32 s57, 128
    s_mov_b32 s58, 195712
    s_mov_b32 m0, 108544
L_dma_4:
    s_nop 0
    buffer_load_dwordx4 v5, s[32:35], s57 offen offset:0 nt lds
    buffer_load_dwordx4 v6, s[32:35], s58 offen offset:1024 nt lds
    s_add_u32 s57, s57, 24576
    s_add_u32 s58, s58, 24576
    s_add_u32 m0, m0, 2048
    s_cmp_lg_u32 m0, 116736
    s_cbranch_scc1 L_dma_4
L_skip_3:
    s_mul_i32 s3, s54, 3
    s_add_u32 s3, s3, s53
    s_cmp_eq_u32 s53, 3
    s_cselect_b32 s3, 31, s3
    v_lshrrev_b32 v8, 4, v0
    v_lshlrev_b32 v8, 1, v8
    v_xor_b32 v8, v8, v9
    v_lshl_add_u32 v7, v8, 4, v10
    v_lshrrev_b32 v2, 3, v0
    v_mul_u32_u24 v2, 12288, v2
    v_and_b32 v60, 7, v0
    v_lshl_add_u32 v2, v60, 4, v2
    s_mul_i32 s59, s73, 384
    s_mul_i32 s60, s54, 983040
    s_add_u32 s59, s59, s60
    s_sub_u32 s60, 7866368, s59
    s_lshl_b32 s61, s30, 11
    s_add_u32 s61, s61, 92160
    s_mul_i32 s62, s31, 120832
    s_add_u32 s62, s62, 299008
    s_lshl_b32 s72, s31, 9
    s_add_u32 s72, s72, 294912
    s_mov_b32 s56, 65536
    s_mov_b32 s55, 1
    s_getreg_b32 s63, hwreg(20, 0, 3)
    v_mov_b32 v3, 0
    v_mov_b32 v4, 0
    v_mov_b32 v11, 0
    v_mov_b32 v24, 0
    v_mov_b32 v34, 0
    v_mov_b64 v[12:13], -1
    v_mov_b64 v[14:15], -1
    v_lshlrev_b32 v10, 4, v0
    s_waitcnt lgkmcnt(0)
    s_add_u32 s36, s8, s64
    s_addc_u32 s37, s9, 0
    s_mov_b32 s38, s34
    s_mov_b32 s39, 0x20000
    s_mov_b32 s40, s28
    s_mov_b32 s41, s29
    s_mov_b32 s42, 2232320
    s_mov_b32 s43, 0x20000
    s_add_u32 s44, s10, s59
    s_addc_u32 s45, s11, 0
    s_mov_b32 s46, s60
    s_mov_b32 s47, 0x20000
    s_sub_u32 s44, s44, 2048
    s_subb_u32 s45, s45, 0
    s_cmp_eq_u32 s30, 6
    s_cbranch_scc0 L_skip_5
    s_mov_b32 s57, 98432
    s_mov_b32 s58, 294016
    s_mov_b32 m0, 116736
L_dma_6:
    s_waitcnt vmcnt(22)
L_go_7:
    buffer_load_dwordx4 v5, s[32:35], s57 offen offset:0 nt lds
    buffer_load_dwordx4 v6, s[32:35], s58 offen offset:1024 nt lds
    s_add_u32 s57, s57, 24576
    s_add_u32 s58, s58, 24576
    s_add_u32 m0, m0, 2048
    s_cmp_lg_u32 m0, 124928
    s_cbranch_scc1 L_dma_6
    s_mov_b32 s57, 2048
    s_mov_b32 s58, 1152
    s_mov_b32 s59, 256
    s_mov_b32 m0, 0
L_dma_8:
    s_waitcnt vmcnt(22)
L_go_9:
    buffer_load_dwordx4 v2, s[44:47], s57 offen offset:0 nt lds
    buffer_load_dwordx4 v2, s[44:47], s58 offen offset:1024 nt lds
    buffer_load_dwordx4 v2, s[44:47], s59 offen offset:2048 nt lds
    s_add_u32 s57, s57, 98304
    s_add_u32 s58, s58, 98304
    s_add_u32 s59, s59, 98304
    s_add_u32 m0, m0, 3072
    s_cmp_lg_u32 m0, 15360
    s_cbranch_scc1 L_dma_8
L_skip_5:
    s_cmp_lt_u32 s3, 20
    s_cselect_b32 s57, 7864320, 0
    s_add_u32 s58, s54, 1
    s_mul_i32 s58, s58, 245760
    s_cmp_lg_u32 s53, 3
    s_cselect_b64 s[48:49], s[12:13], s[16:17]
    s_cselect_b32 s50, s57, s58
    s_mov_b32 s51, 0x20000
    s_add_u32 s57, s28, 0
    s_sub_u32 s57, 0, s57
    s_and_b32 s57, s57, 0x3fff
    s_add_u32 s57, s57, 0
    s_lshr_b32 s58, s31, 1
    s_lshl_b32 s58, s58, 14
    s_add_u32 s6, s57, s58
    s_and_b32 s58, s31, 1
    s_lshl_b32 s58, s58, 12
    s_add_u32 s6, s6, s58
    s_lshl_b32 s58, s3, 7
    s_add_u32 s6, s6, s58
    s_mov_b32 s8, s57
    s_and_b32 s59, s3, 3
    s_lshl_b32 s58, s31, 2
    s_add_u32 s59, s59, s58
    s_lshl_b32 s59, s59, 7
    s_add_u32 s59, s59, s57
    s_add_u32 s59, s59, 262144
    s_add_u32 s10, s28, s59
    s_addc_u32 s11, s29, 0
    s_lshr_b32 s58, s63, 2
    s_xor_b32 s58, s58, 0
    s_mul_i32 s58, s58, 8192
    s_add_u32 s7, s57, s58
    s_cmp_eq_u32 s30, 5
    s_cbranch_scc0 L_skip_10
    s_cmp_eq_u32 s52, 31
    s_cbranch_scc0 L_skip_11
    s_mov_b64 exec, 0xffffff
    buffer_store_dwordx4 v[12:15], v10, s[40:43], s72 offen sc1
    s_mov_b64 exec, -1
L_skip_11:
    s_cmp_lt_u32 s3, 20
    s_cbranch_scc0 L_skip_12
    v_and_b32 v16, 7, v0
    v_lshlrev_b32 v16, 4, v16
    v_bfe_u32 v17, v0, 3, 1
    v_lshl_add_u32 v16, v17, 13, v16
    v_lshrrev_b32 v17, 4, v0
    v_mul_u32_u24 v17, 66048, v17
    v_add_u32 v16, v17, v16
    s_add_u32 s57, s6, 0
    buffer_store_dwordx4 v[12:15], v16, s[40:43], s57 offen sc1
L_skip_12:
    s_cmp_eq_u32 s3, 20
    s_cbranch_scc0 L_skip_13
    s_lshl_b32 s58, s31, 9
    s_add_u32 s58, s58, s8
    s_add_u32 s58, s58, 266240
    v_and_b32 v16, 7, v0
    v_lshlrev_b32 v16, 4, v16
    v_bfe_u32 v60, v0, 3, 1
    v_lshl_add_u32 v16, v60, 13, v16
    v_lshrrev_b32 v60, 4, v0
    v_lshl_add_u32 v16, v60, 28, v16
    buffer_store_dwordx4 v[12:15], v16, s[40:43], s58 offen sc1
L_skip_13:
    s_sub_u32 s58, s3, 20
    s_cmp_lt_u32 s58, 4
    s_cselect_b32 s59, s59, 0x7f000000
    v_and_b32 v16, 7, v0
    v_lshlrev_b32 v16, 4, v16
    v_bfe_u32 v60, v0, 3, 1
    v_lshl_add_u32 v16, v60, 13, v16
    v_lshrrev_b32 v60, 4, v0
    v_lshl_add_u32 v16, v60, 28, v16
    buffer_store_dwordx4 v[12:15], v16, s[40:43], s59 offen sc1
    s_mul_i32 s57, s52, 2208
    s_add_u32 s57, s57, s62
    s_mov_b64 exec, 0x3ff
    buffer_store_dwordx4 v[12:15], v10, s[40:43], s57 offen offset:2048
    s_mov_b64 exec, -1
    buffer_store_dwordx4 v[12:15], v10, s[40:43], s57 offen offset:0
    buffer_store_dwordx4 v[12:15], v10, s[40:43], s57 offen offset:1024
    s_mov_b64 exec, -1
    v_lshlrev_b32 v16, 4, v0
    v_add_u32 v16, 159744, v16
    ds_write_b128 v16, v[12:15]
    v_subrev_u32 v16, 8, v0
    v_cmp_gt_u32 vcc, 40, v16
    v_mov_b32 v16, 0x3f803f80
    s_nop 0
    v_cndmask_b32 v18, 0, v16, vcc
    v_min_u32 v16, 55, v0
    v_lshlrev_b32 v16, 2, v16
    v_add_u32 v16, 160992, v16
    ds_write_b32 v16, v18
    v_and_b32 v3, 7, v0
    v_lshlrev_b32 v3, 5, v3
L_skip_10:
    s_cmp_eq_u32 s30, 7
    s_cbranch_scc0 L_skip_14
    v_and_b32 v60, 31, v0
    v_min_u32 v60, 19, v60
    s_mul_i32 s57, s54, 160
    v_lshrrev_b32 v16, 5, v0
    v_lshlrev_b32 v16, 2, v16
    v_add_u32 v16, s57, v16
    v_lshl_add_u32 v16, v60, 3, v16
    global_load_dword v28, v16, s[4:5]
    global_load_dword v4, v16, s[22:23]
L_skip_14:
    s_sub_u32 s58, s30, 4
    s_cmp_lt_u32 s58, 3
    s_cbranch_scc0 L_skip_15
    s_mul_i32 s57, s31, 3
    s_add_u32 s57, s57, s58
    s_lshl_b32 s57, s57, 7
    v_and_b32 v16, 15, v0
    v_lshlrev_b32 v16, 3, v16
    v_lshrrev_b32 v60, 4, v0
    v_lshl_add_u32 v16, v60, 1, v16
    v_add_u32 v16, s57, v16
    global_load_short_d16_hi v4, v16, s[18:19]
L_skip_15:
    v_bfe_u32 v8, v0, 1, 3
    v_lshrrev_b32 v9, 4, v0
    v_xor_b32 v9, v8, v9
    v_bfe_u32 v8, v0, 2, 1
    v_lshlrev_b32 v8, 10, v8
    v_bfe_u32 v60, v0, 3, 1
    v_lshl_add_u32 v8, v60, 9, v8
    v_and_b32 v60, 3, v0
    v_lshl_add_u32 v8, v60, 7, v8
    v_add_u32 v8, s61, v8
    v_lshl_add_u32 v8, v9, 4, v8
    v_xor_b32 v9, 64, v8
    v_bfe_u32 v1, v0, 1, 1
    v_mul_u32_u24 v1, 43690, v1
    v_add_u32 v1, 17476, v1
    s_waitcnt vmcnt(31)
    s_barrier
    ds_read_b128 v[64:67], v8 offset:0
    ds_read_b128 v[68:71], v9 offset:0
    s_cmp_eq_u32 s30, 6
    s_cbranch_scc0 L_skip_16
    s_mov_b32 s57, 256
    s_mov_b32 s58, 195840
    s_mov_b32 m0, 124928
L_dma_17:
    s_waitcnt vmcnt(22)
L_go_18:
    buffer_load_dwordx4 v5, s[32:35], s57 offen offset:0 nt lds
    buffer_load_dwordx4 v6, s[32:35], s58 offen offset:1024 nt lds
    s_add_u32 s57, s57, 24576
    s_add_u32 s58, s58, 24576
    s_add_u32 m0, m0, 2048
    s_cmp_lg_u32 m0, 141312
    s_cbranch_scc1 L_dma_17
L_skip_16:
    s_waitcnt lgkmcnt(0)
    s_cmp_eq_u32 s30, 5
    s_cbranch_scc0 L_skip_19
    s_cmp_eq_u32 s52, 31
    s_cbranch_scc0 L_skip_20
    s_lshl_b32 s57, s31, 5
    v_mov_b32 v16, s57
    s_add_u32 s57, s63, 1
    v_mov_b32 v12, s57
    s_waitcnt vmcnt(5)
    s_mov_b64 exec, 0x1
    global_store_dword v16, v12, s[26:27] sc1
    s_mov_b64 exec, -1
L_skip_20:
L_skip_19:
    s_waitcnt vmcnt(31)
    s_barrier
    ds_read_b128 v[72:75], v8 offset:16384
    ds_read_b128 v[76:79], v9 offset:16384
    s_cmp_eq_u32 s30, 6
    s_cbranch_scc0 L_skip_21
    s_mov_b32 s57, 493568
    s_mov_b32 s58, 492672
    s_mov_b32 s59, 491776
    s_mov_b32 m0, 15360
L_dma_22:
    s_waitcnt vmcnt(22)
L_go_23:
    buffer_load_dwordx4 v2, s[44:47], s57 offen offset:0 nt lds
    buffer_load_dwordx4 v2, s[44:47], s58 offen offset:1024 nt lds
    buffer_load_dwordx4 v2, s[44:47], s59 offen offset:2048 nt lds
    s_add_u32 s57, s57, 98304
    s_add_u32 s58, s58, 98304
    s_add_u32 s59, s59, 98304
    s_add_u32 m0, m0, 3072
    s_cmp_lg_u32 m0, 30720
    s_cbranch_scc1 L_dma_22
    s_mov_b32 s57, 393216
    s_mov_b32 s58, 588800
    s_mov_b32 m0, 141312
L_dma_24:
    s_waitcnt vmcnt(22)
L_go_25:
    buffer_load_dwordx4 v5, s[32:35], s57 offen offset:0 nt lds
    buffer_load_dwordx4 v6, s[32:35], s58 offen offset:1024 nt lds
    s_add_u32 s57, s57, 24576
    s_add_u32 s58, s58, 24576
    s_add_u32 m0, m0, 2048
    s_cmp_lg_u32 m0, 157696
    s_cbranch_scc1 L_dma_24
L_skip_21:
    s_waitcnt lgkmcnt(0)
    s_cmp_lt_u32 s30, 4
    s_cbranch_scc0 L_skip_26
    s_mov_b64 exec, 0
    s_cmp_eq_u32 s30, 1
    s_cbranch_scc1 L_pad1
    s_cmp_eq_u32 s30, 2
    s_cbranch_scc1 L_pad2
    s_cmp_eq_u32 s30, 3
    s_cbranch_scc1 L_pad3
    s_branch L_pad0
L_padback:
    s_mov_b64 exec, -1
L_skip_26:
    s_waitcnt vmcnt(31)
    s_barrier
    ds_read_b128 v[80:83], v8 offset:32768
    ds_read_b128 v[84:87], v9 offset:32768
    s_cmp_eq_u32 s30, 6
    s_cbranch_scc0 L_skip_27
    s_cmp_lg_u32 s53, 3
    s_cbranch_scc0 L_wb_28
    s_mul_i32 s57, s31, 983040
    s_lshl_b32 s58, s3, 6
    s_add_u32 s57, s57, s58
    v_bfe_u32 v38, v0, 4, 1
    v_lshlrev_b32 v38, 1, v38
    v_xor_b32 v38, v38, v0
    v_and_b32 v38, 3, v38
    v_lshrrev_b32 v3, 5, v0
    v_mul_u32_u24 v3, 10240, v3
    v_bfe_u32 v39, v0, 4, 1
    v_mul_u32_u24 v39, 2560, v39
    v_add_u32 v3, v39, v3
    v_bfe_u32 v39, v0, 3, 1
    v_mul_u32_u24 v39, 5120, v39
    v_add_u32 v3, v39, v3
    v_bfe_u32 v39, v0, 2, 1
    v_mul_u32_u24 v39, 20480, v39
    v_add_u32 v3, v39, v3
    v_add_u32 v3, s57, v3
    v_lshl_add_u32 v3, v38, 4, v3
    s_mov_b32 s14, 40960
    s_mov_b32 s15, 256
    s_branch L_we_29
L_wb_28:
    s_mul_i32 s57, s31, 384
    s_mul_i32 s58, s54, 245760
    s_add_u32 s57, s57, s58
    v_lshlrev_b32 v3, 4, v0
    v_add_u32 v3, s57, v3
    v_mov_b32 v38, 2688
    v_cmp_lt_u32 vcc, 23, v0
    s_nop 1
    v_cndmask_b32 v38, 0, v38, vcc
    v_add_u32 v3, v38, v3
    v_mov_b32 v38, 0x7f000000
    v_cmp_lt_u32 vcc, 47, v0
    s_nop 1
    v_cndmask_b32 v3, v3, v38, vcc
    s_mov_b32 s14, 12288
    s_mov_b32 s15, 5120
L_we_29:
    s_mul_i32 s57, s14, 0
    s_mov_b32 m0, 30720
    s_nop 0
    buffer_load_dwordx4 v3, s[48:51], s57 offen offset:0 nt lds
    s_mul_i32 s57, s14, 0
    s_add_u32 s57, s57, s15
    s_mov_b32 m0, 30720
    s_nop 0
    buffer_load_dwordx4 v3, s[48:51], s57 offen offset:1024 nt lds
    s_mov_b32 s57, 393344
    s_mov_b32 s58, 588928
    s_mov_b32 m0, 92160
L_dma_30:
    s_waitcnt vmcnt(22)
L_go_31:
    buffer_load_dwordx4 v5, s[32:35], s57 offen offset:0 nt lds
    buffer_load_dwordx4 v6, s[32:35], s58 offen offset:1024 nt lds
    s_add_u32 s57, s57, 24576
    s_add_u32 s58, s58, 24576
    s_add_u32 m0, m0, 2048
    s_cmp_lg_u32 m0, 108544
    s_cbranch_scc1 L_dma_30
    s_mul_i32 s57, s14, 1
    s_mov_b32 m0, 32768
    s_nop 0
    buffer_load_dwordx4 v3, s[48:51], s57 offen offset:0 nt lds
    s_mul_i32 s57, s14, 1
    s_add_u32 s57, s57, s15
    s_mov_b32 m0, 32768
    s_nop 0
    buffer_load_dwordx4 v3, s[48:51], s57 offen offset:1024 nt lds
    s_mov_b32 s57, 393472
    s_mov_b32 s58, 589056
    s_mov_b32 m0, 108544
L_dma_32:
    s_waitcnt vmcnt(22)
L_go_33:
    buffer_load_dwordx4 v5, s[32:35], s57 offen offset:0 nt lds
    buffer_load_dwordx4 v6, s[32:35], s58 offen offset:1024 nt lds
    s_add_u32 s57, s57, 24576
    s_add_u32 s58, s58, 24576
    s_add_u32 m0, m0, 2048
    s_cmp_lg_u32 m0, 124928
    s_cbranch_scc1 L_dma_32
L_skip_27:
    s_waitcnt lgkmcnt(0)
    s_cmp_lt_u32 s30, 5
    s_cbranch_scc0 L_skip_34
    s_waitcnt vmcnt(0)
L_skip_34:
    s_cmp_eq_u32 s30, 7
    s_cbranch_scc0 L_skip_35
    v_and_b32 v60, 31, v0
    v_cmp_gt_u32 s[64:65], 20, v60
    v_min_u32 v60, 19, v60
    v_lshrrev_b32 v35, 5, v0
    v_lshlrev_b32 v35, 2, v35
    v_add_u32 v35, 160832, v35
    v_lshl_add_u32 v35, v60, 3, v35
    s_mul_i32 s66, s53, 12416
    s_add_u32 s66, s66, s62
    s_add_u32 s66, s66, 70656
    s_add_u32 s67, s66, 12288
    s_lshl_b32 s57, s54, 3
    v_lshrrev_b32 v34, 5, v0
    v_lshlrev_b32 v34, 2, v34
    v_add_u32 v34, s57, v34
    v_and_b32 v60, 31, v0
    v_mov_b32 v61, 0x7f000000
    v_cmp_ne_u32 vcc, 31, v60
    s_nop 1
    v_cndmask_b32 v34, v34, v61, vcc
    v_mov_b32 v61, 0x3f803f80
    s_waitcnt vmcnt(0)
    ds_write_b32 v35, v28
    s_waitcnt lgkmcnt(0)
L_skip_35:
    s_cmp_eq_u32 s30, 5
    s_cbranch_scc0 L_skip_36
    s_waitcnt vmcnt(0)
    s_lshr_b32 s65, s63, 2
    s_sub_u32 s58, s3, 20
    s_cmp_lt_u32 s58, 4
    s_cbranch_scc0 L_skip_37
    s_mov_b32 s67, 0
    s_load_dword s66, s[10:11], 0
    s_load_dword s67, s[10:11], 8192
    s_waitcnt lgkmcnt(1)
    s_sleep 1
    s_mov_b32 s65, s67
L_skip_37:
L_skip_36:
    s_waitcnt vmcnt(36)
    s_barrier
    ds_read_b128 v[88:91], v8 offset:49152
    ds_read_b128 v[92:95], v9 offset:49152
    s_cmp_eq_u32 s30, 6
    s_cbranch_scc0 L_skip_38
    s_mul_i32 s57, s14, 2
    s_mov_b32 m0, 34816
    s_nop 0
    buffer_load_dwordx4 v3, s[48:51], s57 offen offset:0 nt lds
    s_mul_i32 s57, s14, 2
    s_add_u32 s57, s57, s15
    s_mov_b32 m0, 34816
    s_nop 0
    buffer_load_dwordx4 v3, s[48:51], s57 offen offset:1024 nt lds
    s_mov_b32 s57, 786432
    s_mov_b32 s58, 982016
    s_mov_b32 m0, 124928
L_dma_39:
    s_waitcnt vmcnt(22)
L_go_40:
    buffer_load_dwordx4 v5, s[32:35], s57 offen offset:0 nt lds
    buffer_load_dwordx4 v6, s[32:35], s58 offen offset:1024 nt lds
    s_add_u32 s57, s57, 24576
    s_add_u32 s58, s58, 24576
    s_add_u32 m0, m0, 2048
    s_cmp_lg_u32 m0, 141312
    s_cbranch_scc1 L_dma_39
L_skip_38:
    s_waitcnt lgkmcnt(0)
    s_cmp_eq_u32 s30, 7
    s_cbranch_scc0 L_skip_41
    v_cndmask_b32 v29, 0, v28, s[64:65]
    v_dot2_f32_bf16 v33, v29, v61, 0
    v_dot2_f32_bf16 v32, v29, v29, 0
    v_lshlrev_b32 v2, 16, v28
    v_and_b32 v3, 0xffff0000, v28
    s_cmp_eq_u32 s55, 0
    v_permlane32_swap_b32 v33, v32
    v_add_f32 v33, v33, v32
    s_nop 1
    v_add_f32_dpp v33, v33, v33 row_ror:8 row_mask:0xf bank_mask:0xf
    s_nop 1
    v_add_f32_dpp v33, v33, v33 row_ror:4 row_mask:0xf bank_mask:0xf
    s_nop 1
    v_add_f32_dpp v33, v33, v33 row_ror:2 row_mask:0xf bank_mask:0xf
    s_nop 1
    v_add_f32_dpp v33, v33, v33 row_ror:1 row_mask:0xf bank_mask:0xf
    s_nop 1
    v_add_f32_dpp v33, v33, v33 row_bcast:15 row_mask:0xa bank_mask:0xf
    v_min_u32 v33, -2, v33
    s_cbranch_scc1 L_gs_42
    buffer_store_dword v33, v34, s[40:43], s67 offen
L_gb_43:
    s_waitcnt vmcnt(1)
L_skip_41:
    s_cmp_lt_u32 s30, 6
    s_cbranch_scc0 L_skip_44
    s_lshr_b32 s57, s30, 1
    s_mul_i32 s57, s57, 1024
    s_and_b32 s58, s30, 1
    s_lshl_b32 s58, s58, 6
    s_add_u32 s57, s57, s58
    v_lshrrev_b32 v18, 5, v0
    v_mul_u32_u24 v18, 6144, v18
    v_bfe_u32 v60, v0, 3, 1
    v_mul_u32_u24 v60, 3072, v60
    v_add_u32 v18, v60, v18
    v_bfe_u32 v60, v0, 4, 1
    v_lshl_add_u32 v18, v60, 9, v18
    v_bfe_u32 v60, v0, 2, 1
    v_lshl_add_u32 v18, v60, 7, v18
    v_and_b32 v60, 3, v0
    v_lshl_add_u32 v18, v60, 3, v18
    v_add_u32 v18, s57, v18
    v_bfe_u32 v19, v0, 4, 1
    v_mul_u32_u24 v19, 3072, v19
    v_bfe_u32 v60, v0, 3, 1
    v_lshl_add_u32 v19, v60, 9, v19
    v_bfe_u32 v60, v0, 2, 1
    v_lshl_add_u32 v19, v60, 7, v19
    v_and_b32 v60, 3, v0
    v_lshl_add_u32 v19, v60, 3, v19
    v_add_u32 v19, s57, v19
    v_add_u32 v19, 24576, v19
    ds_read_b64_tr_b16 v[28:29], v18 offset:0
    ds_read_b64_tr_b16 v[30:31], v18 offset:256
    ds_read_b64_tr_b16 v[32:33], v18 offset:12288
    ds_read_b64_tr_b16 v[34:35], v18 offset:12544
    ds_read_b64_tr_b16 v[36:37], v19 offset:0
    ds_read_b64_tr_b16 v[38:39], v19 offset:256
    ds_read_b64_tr_b16 v[40:41], v18 offset:32
    ds_read_b64_tr_b16 v[42:43], v18 offset:288
    ds_read_b64_tr_b16 v[44:45], v18 offset:12320
    ds_read_b64_tr_b16 v[46:47], v18 offset:12576
    ds_read_b64_tr_b16 v[48:49], v19 offset:32
    ds_read_b64_tr_b16 v[50:51], v19 offset:288
    v_lshrrev_b32 v52, 4, v0
    v_lshlrev_b32 v52, 5, v52
    v_bfe_u32 v60, v0, 1, 1
    v_lshl_add_u32 v52, v60, 4, v52
    v_and_b32 v60, 1, v0
    v_mul_u32_u24 v60, 192, v60
    v_add_u32 v52, v60, v52
    v_add_u32 v52, 160832, v52
    v_lshrrev_b32 v53, 4, v0
    v_lshlrev_b32 v53, 4, v53
    v_bfe_u32 v60, v0, 1, 1
    v_lshl_add_u32 v53, v60, 3, v53
    v_and_b32 v60, 1, v0
    v_mul_u32_u24 v60, 192, v60
    v_add_u32 v53, v60, v53
    v_add_u32 v53, 160960, v53
    v_mov_b64 v[20:21], 0
    v_mov_b64 v[22:23], 0
    v_mov_b64 v[24:25], 0
    v_mov_b64 v[26:27], 0
    s_lshr_b32 s57, s30, 1
    s_lshl_b32 s57, s57, 11
    s_lshl_b32 s58, s58, 1
    s_add_u32 s57, s57, s58
    s_lshl_b32 s58, s54, 8
    s_add_u32 s57, s57, s58
    v_and_b32 v54, 31, v0
    v_lshlrev_b32 v54, 2, v54
    v_lshrrev_b32 v60, 5, v0
    v_mul_u32_u24 v60, 6144, v60
    v_add_u32 v54, v60, v54
    v_add_u32 v54, s57, v54
    s_mul_i32 s59, s53, 12416
    s_add_u32 s59, s59, s62
    s_add_u32 s59, s59, 70656
    s_add_u32 s60, s59, 12288
    ds_read_b128 v[12:15], v52
    ds_read_b64 v[16:17], v53
    s_waitcnt lgkmcnt(1)
    v_smfmac_f32_16x16x64_bf16 v[20:23], v[12:15], v[28:35], v1
    v_smfmac_f32_16x16x64_bf16 v[24:27], v[12:15], v[40:47], v1
    s_waitcnt lgkmcnt(0)
    v_smfmac_f32_16x16x32_bf16 v[20:23], v[16:17], v[36:39], v1
    v_smfmac_f32_16x16x32_bf16 v[24:27], v[16:17], v[48:51], v1
    s_cmp_eq_u32 s55, 0
    s_nop 5
    v_add_f32 v12, v20, v22
    s_nop 1
    v_add_f32_dpp v12, v24, v26 quad_perm:[0,1,2,3] row_mask:0x2 bank_mask:0xf
    s_nop 1
    v_add_f32_dpp v12, v21, v23 quad_perm:[0,1,2,3] row_mask:0x4 bank_mask:0xf
    s_nop 1
    v_add_f32_dpp v12, v25, v27 quad_perm:[0,1,2,3] row_mask:0x8 bank_mask:0xf
    v_min_u32 v12, -2, v12
    s_cbranch_scc1 L_gs_45
    buffer_store_dword v12, v54, s[40:43], s59 offen
L_gb_46:
L_skip_44:
    s_cmp_eq_u32 s30, 5
    s_cbranch_scc0 L_skip_47
    global_load_dword v2, v3, s[26:27] sc1
L_skip_47:
    s_waitcnt vmcnt(36)
    s_barrier
    ds_read_b128 v[96:99], v8 offset:0
    ds_read_b128 v[100:103], v9 offset:0
    s_cmp_eq_u32 s30, 6
    s_cbranch_scc0 L_skip_48
    s_mul_i32 s57, s14, 3
    s_mov_b32 m0, 36864
    s_nop 0
    buffer_load_dwordx4 v3, s[48:51], s57 offen offset:0 nt lds
    s_mul_i32 s57, s14, 3
    s_add_u32 s57, s57, s15
    s_mov_b32 m0, 36864
    s_nop 0
    buffer_load_dwordx4 v3, s[48:51], s57 offen offset:1024 nt lds
    s_mov_b32 s57, 786560
    s_mov_b32 s58, 982144
    s_mov_b32 m0, 141312
L_dma_49:
    s_waitcnt vmcnt(22)
L_go_50:
    buffer_load_dwordx4 v5, s[32:35], s57 offen offset:0 nt lds
    buffer_load_dwordx4 v6, s[32:35], s58 offen offset:1024 nt lds
    s_add_u32 s57, s57, 24576
    s_add_u32 s58, s58, 24576
    s_add_u32 m0, m0, 2048
    s_cmp_lg_u32 m0, 157696
    s_cbranch_scc1 L_dma_49
L_skip_48:
    s_waitcnt lgkmcnt(0)
    s_waitcnt vmcnt(36)
    s_barrier
    ds_read_b128 v[104:107], v8 offset:16384
    ds_read_b128 v[108:111], v9 offset:16384
    s_cmp_eq_u32 s30, 6
    s_cbranch_scc0 L_skip_51
    s_mul_i32 s57, s14, 4
    s_mov_b32 m0, 38912
    s_nop 0
    buffer_load_dwordx4 v3, s[48:51], s57 offen offset:0 nt lds
    s_mul_i32 s57, s14, 4
    s_add_u32 s57, s57, s15
    s_mov_b32 m0, 38912
    s_nop 0
    buffer_load_dwordx4 v3, s[48:51], s57 offen offset:1024 nt lds
    s_mov_b32 s57, 786688
    s_mov_b32 s58, 982272
    s_mov_b32 m0, 92160
L_dma_52:
    s_waitcnt vmcnt(22)
L_go_53:
    buffer_load_dwordx4 v5, s[32:35], s57 offen offset:0 nt lds
    buffer_load_dwordx4 v6, s[32:35], s58 offen offset:1024 nt lds
    s_add_u32 s57, s57, 24576
    s_add_u32 s58, s58, 24576
    s_add_u32 m0, m0, 2048
    s_cmp_lg_u32 m0, 108544
    s_cbranch_scc1 L_dma_52
L_skip_51:
    s_waitcnt lgkmcnt(0)
    s_cmp_lg_u32 s30, 6
    s_cbranch_scc0 L_skip_54
    s_waitcnt vmcnt(0)
L_skip_54:
    s_waitcnt vmcnt(36)
    s_barrier
    ds_read_b128 v[112:115], v8 offset:32768
    ds_read_b128 v[116:119], v9 offset:32768
    s_cmp_eq_u32 s30, 6
    s_cbranch_scc0 L_skip_55
    s_mul_i32 s57, s14, 5
    s_mov_b32 m0, 40960
    s_nop 0
    buffer_load_dwordx4 v3, s[48:51], s57 offen offset:0 nt lds
    s_mul_i32 s57, s14, 5
    s_add_u32 s57, s57, s15
    s_mov_b32 m0, 40960
    s_nop 0
    buffer_load_dwordx4 v3, s[48:51], s57 offen offset:1024 nt lds
    s_mov_b32 s57, 1179648
    s_mov_b32 s58, 1375232
    s_mov_b32 m0, 108544
L_dma_56:
    s_waitcnt vmcnt(22)
L_go_57:
    buffer_load_dwordx4 v5, s[32:35], s57 offen offset:0 nt lds
    buffer_load_dwordx4 v6, s[32:35], s58 offen offset:1024 nt lds
    s_add_u32 s57, s57, 24576
    s_add_u32 s58, s58, 24576
    s_add_u32 m0, m0, 2048
    s_cmp_lg_u32 m0, 124928
    s_cbranch_scc1 L_dma_56
L_skip_55:
    s_waitcnt lgkmcnt(0)
    s_cmp_eq_u32 s30, 5
    s_cbranch_scc0 L_skip_58
L_cw_59:
    v_readlane_b32 s57, v2, s31
    s_cmp_eq_u32 s57, 0
    s_cbranch_scc1 L_cr_60
    s_lshr_b32 s58, s63, 2
    s_xor_b32 s58, s58, s65
    s_and_b32 s58, s58, 1
    v_mov_b32 v25, s58
    s_sub_u32 s57, s57, 1
    s_cmp_eq_u32 s57, s63
    s_cselect_b32 s64, 1, 0
    s_cbranch_scc0 L_far_61
    s_lshl_b32 s57, s52, 2
    s_add_u32 s57, s57, s72
    s_mov_b64 exec, 1
    buffer_store_dword v25, v0, s[40:43], s57 offen offset:0
    s_mov_b64 exec, -1
L_fb_62:
L_skip_58:
    s_waitcnt vmcnt(36)
    s_barrier
    ds_read_b128 v[120:123], v8 offset:49152
    ds_read_b128 v[124:127], v9 offset:49152
    s_cmp_eq_u32 s30, 6
    s_cbranch_scc0 L_skip_63
    s_mul_i32 s57, s14, 6
    s_mov_b32 m0, 43008
    s_nop 0
    buffer_load_dwordx4 v3, s[48:51], s57 offen offset:0 nt lds
    s_mul_i32 s57, s14, 6
    s_add_u32 s57, s57, s15
    s_mov_b32 m0, 43008
    s_nop 0
    buffer_load_dwordx4 v3, s[48:51], s57 offen offset:1024 nt lds
    s_mov_b32 s57, 1179776
    s_mov_b32 s58, 1375360
    s_mov_b32 m0, 124928
L_dma_64:
    s_waitcnt vmcnt(22)
L_go_65:
    buffer_load_dwordx4 v5, s[32:35], s57 offen offset:0 nt lds
    buffer_load_dwordx4 v6, s[32:35], s58 offen offset:1024 nt lds
    s_add_u32 s57, s57, 24576
    s_add_u32 s58, s58, 24576
    s_add_u32 m0, m0, 2048
    s_cmp_lg_u32 m0, 141312
    s_cbranch_scc1 L_dma_64
L_skip_63:
    s_waitcnt lgkmcnt(0)
    s_waitcnt vmcnt(36)
    s_barrier
    ds_read_b128 v[128:131], v8 offset:0
    ds_read_b128 v[132:135], v9 offset:0
    s_cmp_eq_u32 s30, 6
    s_cbranch_scc0 L_skip_66
    s_mul_i32 s57, s14, 7
    s_mov_b32 m0, 45056
    s_nop 0
    buffer_load_dwordx4 v3, s[48:51], s57 offen offset:0 nt lds
    s_mul_i32 s57, s14, 7
    s_add_u32 s57, s57, s15
    s_mov_b32 m0, 45056
    s_nop 0
    buffer_load_dwordx4 v3, s[48:51], s57 offen offset:1024 nt lds
    s_mov_b32 s57, 1179904
    s_mov_b32 s58, 1375488
    s_mov_b32 m0, 141312
L_dma_67:
    s_waitcnt vmcnt(22)
L_go_68:
    buffer_load_dwordx4 v5, s[32:35], s57 offen offset:0 nt lds
    buffer_load_dwordx4 v6, s[32:35], s58 offen offset:1024 nt lds
    s_add_u32 s57, s57, 24576
    s_add_u32 s58, s58, 24576
    s_add_u32 m0, m0, 2048
    s_cmp_lg_u32 m0, 157696
    s_cbranch_scc1 L_dma_67
L_skip_66:
    s_waitcnt lgkmcnt(0)
    s_cmp_eq_u32 s30, 5
    s_cbranch_scc0 L_skip_69
    v_lshlrev_b32 v24, 2, v0
    buffer_load_dword v2, v24, s[40:43], s72 offen sc1
L_skip_69:
    s_waitcnt vmcnt(36)
    s_barrier
    ds_read_b128 v[136:139], v8 offset:16384
    ds_read_b128 v[140:143], v9 offset:16384
    s_cmp_eq_u32 s30, 6
    s_cbranch_scc0 L_skip_70
    s_mul_i32 s57, s14, 8
    s_mov_b32 m0, 47104
    s_nop 0
    buffer_load_dwordx4 v3, s[48:51], s57 offen offset:0 nt lds
    s_mul_i32 s57, s14, 8
    s_add_u32 s57, s57, s15
    s_mov_b32 m0, 47104
    s_nop 0
    buffer_load_dwordx4 v3, s[48:51], s57 offen offset:1024 nt lds
    s_mov_b32 s57, 0
    s_mov_b32 s58, 392192
    s_mov_b32 m0, 92160
L_dma_71:
    s_waitcnt vmcnt(22)
L_go_72:
    buffer_load_dwordx4 v7, s[36:39], s57 offen offset:0 nt lds
    buffer_load_dwordx4 v7, s[36:39], s58 offen offset:1024 nt lds
    s_add_u32 s57, s57, 24576
    s_add_u32 s58, s58, 24576
    s_add_u32 m0, m0, 2048
    s_cmp_lg_u32 m0, 108544
    s_cbranch_scc1 L_dma_71
L_skip_70:
    s_waitcnt lgkmcnt(0)
    s_waitcnt vmcnt(36)
    s_barrier
    ds_read_b128 v[144:147], v8 offset:32768
    ds_read_b128 v[148:151], v9 offset:32768
    s_cmp_eq_u32 s30, 6
    s_cbranch_scc0 L_skip_73
    s_mul_i32 s57, s14, 9
    s_mov_b32 m0, 49152
    s_nop 0
    buffer_load_dwordx4 v3, s[48:51], s57 offen offset:0 nt lds
    s_mul_i32 s57, s14, 9
    s_add_u32 s57, s57, s15
    s_mov_b32 m0, 49152
    s_nop 0
    buffer_load_dwordx4 v3, s[48:51], s57 offen offset:1024 nt lds
    s_mov_b32 s57, 128
    s_mov_b32 s58, 392320
    s_mov_b32 m0, 108544
L_dma_74:
    s_waitcnt vmcnt(22)
L_go_75:
    buffer_load_dwordx4 v7, s[36:39], s57 offen offset:0 nt lds
    buffer_load_dwordx4 v7, s[36:39], s58 offen offset:1024 nt lds
    s_add_u32 s57, s57, 24576
    s_add_u32 s58, s58, 24576
    s_add_u32 m0, m0, 2048
    s_cmp_lg_u32 m0, 124928
    s_cbranch_scc1 L_dma_74
L_skip_73:
    s_waitcnt lgkmcnt(0)
    s_cmp_eq_u32 s30, 5
    s_cbranch_scc0 L_skip_76
L_cw_77:
    s_waitcnt vmcnt(0)
    v_cmp_ne_u32 vcc, -1, v2
    s_mov_b32 s57, 0
    s_mov_b32 s68, 2
    s_cmp_eq_u32 s64, 0
    s_cbranch_scc1 L_cd_79
    s_cmp_lg_u32 vcc_hi, 0
    s_cbranch_scc1 L_cd_79
    s_cmp_lg_u32 vcc_lo, -1
    s_cbranch_scc1 L_cr_78
    v_cmp_eq_u32 vcc, 1, v2
    s_bcnt1_i32_b32 s68, vcc_lo
    s_mov_b32 s57, 1
L_cd_79:
    v_mov_b32 v37, 160768
    v_mov_b32 v38, s57
    ds_write_b32 v37, v38
    s_waitcnt lgkmcnt(0)
L_skip_76:
    s_waitcnt vmcnt(36)
    s_barrier
    ds_read_b128 v[152:155], v8 offset:49152
    ds_read_b128 v[156:159], v9 offset:49152
    s_cmp_eq_u32 s30, 6
    s_cbranch_scc0 L_skip_80
    s_mul_i32 s57, s14, 10
    s_mov_b32 m0, 51200
    s_nop 0
    buffer_load_dwordx4 v3, s[48:51], s57 offen offset:0 nt lds
    s_mul_i32 s57, s14, 10
    s_add_u32 s57, s57, s15
    s_mov_b32 m0, 51200
    s_nop 0
    buffer_load_dwordx4 v3, s[48:51], s57 offen offset:1024 nt lds
    s_mov_b32 s57, 256
    s_mov_b32 s58, 392448
    s_mov_b32 m0, 124928
L_dma_81:
    s_waitcnt vmcnt(22)
L_go_82:
    buffer_load_dwordx4 v7, s[36:39], s57 offen offset:0 nt lds
    buffer_load_dwordx4 v7, s[36:39], s58 offen offset:1024 nt lds
    s_add_u32 s57, s57, 24576
    s_add_u32 s58, s58, 24576
    s_add_u32 m0, m0, 2048
    s_cmp_lg_u32 m0, 141312
    s_cbranch_scc1 L_dma_81
L_skip_80:
    s_waitcnt lgkmcnt(0)
    v_lshrrev_b32 v8, 2, v0
    v_lshlrev_b32 v8, 7, v8
    v_bfe_u32 v60, v0, 3, 2
    v_lshl_add_u32 v8, v60, 5, v8
    v_and_b32 v60, 3, v0
    v_lshl_add_u32 v8, v60, 3, v8
    v_add_u32 v8, s61, v8
    v_xor_b32 v9, 32, v8
    v_xor_b32 v10, 64, v8
    v_xor_b32 v11, 96, v8
    v_mov_b32 v41, 160768
    ds_read_b32 v42, v41
    s_waitcnt lgkmcnt(0)
    v_readfirstlane_b32 s55, v42
    s_cmp_eq_u32 s55, 0
    s_cbranch_scc1 L_spread
L_spread_back:
    s_cmp_eq_u32 s30, 5
    s_cbranch_scc0 L_skip_94
    s_cmp_eq_u32 s52, 31
    s_cbranch_scc0 L_skip_95
    s_lshl_b32 s57, s31, 5
    v_mov_b32 v16, s57
    s_add_u32 s57, s68, 1
    v_mov_b32 v12, s57
    s_mov_b64 exec, 0x1
    global_store_dword v16, v12, s[26:27] offset:4 sc1
    s_mov_b64 exec, -1
L_skip_95:
L_skip_94:
    s_sub_u32 s58, s30, 1
    s_cmp_lt_u32 s58, 3
    s_cbranch_scc0 L_skip_96
    s_mul_i32 s59, s53, 12416
    s_add_u32 s59, s59, s62
    s_add_u32 s59, s59, 70656
    s_add_u32 s60, s59, 12288
    s_lshl_b32 s57, s58, 11
    v_lshlrev_b32 v48, 4, v0
    v_add_u32 v48, s57, v48
    v_and_b32 v49, 7, v0
    v_lshlrev_b32 v49, 3, v49
    s_add_u32 s57, s59, 6144
    buffer_load_dwordx4 v[12:15], v48, s[40:43], s59 offen offset:0 sc1 nt
    buffer_load_dwordx4 v[16:19], v48, s[40:43], s59 offen offset:1024 sc1 nt
    buffer_load_dwordx4 v[28:31], v48, s[40:43], s57 offen offset:0 sc1 nt
    buffer_load_dwordx4 v[32:35], v48, s[40:43], s57 offen offset:1024 sc1 nt
    buffer_load_dwordx2 v[24:25], v49, s[40:43], s60 offen sc1 nt
L_skip_96:
    s_waitcnt vmcnt(36)
    s_barrier
    ds_read_b64_tr_b16 v[160:161], v8 offset:0
    ds_read_b64_tr_b16 v[168:169], v9 offset:0
    ds_read_b64_tr_b16 v[176:177], v10 offset:0
    ds_read_b64_tr_b16 v[184:185], v11 offset:0
    s_cmp_eq_u32 s30, 6
    s_cbranch_scc0 L_skip_97
    s_mul_i32 s57, s14, 11
    s_mov_b32 m0, 53248
    s_nop 0
    buffer_load_dwordx4 v3, s[48:51], s57 offen offset:0 nt lds
    s_mul_i32 s57, s14, 11
    s_add_u32 s57, s57, s15
    s_mov_b32 m0, 53248
    s_nop 0
    buffer_load_dwordx4 v3, s[48:51], s57 offen offset:1024 nt lds
    s_mov_b32 s57, 196608
    s_mov_b32 s58, 588800
    s_mov_b32 m0, 141312
L_dma_98:
    s_waitcnt vmcnt(22)
L_go_99:
    buffer_load_dwordx4 v7, s[36:39], s57 offen offset:0 nt lds
    buffer_load_dwordx4 v7, s[36:39], s58 offen offset:1024 nt lds
    s_add_u32 s57, s57, 24576
    s_add_u32 s58, s58, 24576
    s_add_u32 m0, m0, 2048
    s_cmp_lg_u32 m0, 157696
    s_cbranch_scc1 L_dma_98
L_skip_97:
    s_waitcnt lgkmcnt(0)
    s_waitcnt vmcnt(36)
    s_barrier
    ds_read_b64_tr_b16 v[192:193], v8 offset:16384
    ds_read_b64_tr_b16 v[200:201], v9 offset:16384
    ds_read_b64_tr_b16 v[208:209], v10 offset:16384
    ds_read_b64_tr_b16 v[216:217], v11 offset:16384
    s_cmp_eq_u32 s30, 6
    s_cbranch_scc0 L_skip_100
    s_mov_b32 s57, 196736
    s_mov_b32 s58, 588928
    s_mov_b32 m0, 92160
L_dma_101:
    s_waitcnt vmcnt(22)
L_go_102:
    buffer_load_dwordx4 v7, s[36:39], s57 offen offset:0 nt lds
    buffer_load_dwordx4 v7, s[36:39], s58 offen offset:1024 nt lds
    s_add_u32 s57, s57, 24576
    s_add_u32 s58, s58, 24576
    s_add_u32 m0, m0, 2048
    s_cmp_lg_u32 m0, 108544
    s_cbranch_scc1 L_dma_101
L_skip_100:
    s_waitcnt lgkmcnt(0)
    s_sub_u32 s58, s30, 1
    s_cmp_lt_u32 s58, 3
    s_cbranch_scc0 L_skip_103
    s_lshl_b32 s57, s58, 7
    v_bfe_u32 v51, v0, 2, 2
    v_lshlrev_b32 v51, 5, v51
    v_lshrrev_b32 v60, 5, v0
    v_lshl_add_u32 v51, v60, 4, v51
    v_and_b32 v60, 3, v0
    v_lshl_add_u32 v51, v60, 2, v51
    v_bfe_u32 v60, v0, 4, 1
    v_lshl_add_u32 v51, v60, 1, v51
    v_add_u32 v51, s57, v51
    v_add_u32 v51, 157696, v51
    v_mov_b32 v60, 0x3c75e03e
    v_mov_b32 v61, 0x3a71d1e6
    v_mov_b32 v47, 0x3e13985d
    s_waitcnt vmcnt(0)
    v_pk_add_f32 v[36:37], v[28:29], v[32:33]
    v_pk_add_f32 v[38:39], v[30:31], v[34:35]
    s_nop 1
    v_permlane32_swap_b32 v36, v38
    v_permlane32_swap_b32 v37, v39
    v_pk_add_f32 v[36:37], v[36:37], v[38:39]
    s_nop 1
    v_permlane16_swap_b32 v36, v37
    v_add_f32 v36, v36, v37
    v_mul_f32 v6, 0x3dd53b95, v36
    v_add_f32_dpp v48, v24, v24 row_ror:4 row_mask:0xf bank_mask:0xf
    v_add_f32_dpp v49, v25, v25 row_ror:4 row_mask:0xf bank_mask:0xf
    v_pk_add_f32 v[20:21], v[12:13], v[16:17]
    v_pk_add_f32 v[22:23], v[14:15], v[18:19]
    v_add_f32_dpp v48, v48, v48 row_ror:2 row_mask:0xf bank_mask:0xf
    v_add_f32_dpp v49, v49, v49 row_ror:2 row_mask:0xf bank_mask:0xf
    v_permlane32_swap_b32 v20, v22
    v_permlane32_swap_b32 v21, v23
    v_add_f32_dpp v48, v48, v48 row_ror:1 row_mask:0xf bank_mask:0xf
    v_add_f32_dpp v49, v49, v49 row_ror:1 row_mask:0xf bank_mask:0xf
    v_pk_add_f32 v[20:21], v[20:21], v[22:23]
    v_mul_f32 v48, v48, v60
    v_fma_f32 v49, v49, v47, v61
    v_permlane16_swap_b32 v20, v21
    v_fma_f32 v49, -v48, v48, v49
    v_add_f32 v20, v20, v21
    v_max_f32 v49, v49, v61
    v_mul_f32 v50, v6, v48
    v_rsq_f32 v49, v49
    v_cmp_u_f32 vcc, v20, v20
    v_sub_f32 v20, v20, v50
    v_mul_f32 v20, v20, v49
    v_cvt_pk_bf16_f32 v20, v20, v20
    ds_write_b16 v51, v20
    s_waitcnt lgkmcnt(0)
L_skip_103:
    s_lshl_b32 s57, s30, 7
    s_add_u32 s57, s57, 158720
    v_lshrrev_b32 v58, 4, v0
    v_lshlrev_b32 v58, 5, v58
    v_bfe_u32 v60, v0, 1, 1
    v_lshl_add_u32 v58, v60, 4, v58
    v_bfe_u32 v60, v0, 2, 2
    v_lshl_add_u32 v58, v60, 2, v58
    v_and_b32 v60, 1, v0
    v_lshl_add_u32 v58, v60, 1, v58
    v_add_u32 v58, s57, v58
    v_lshrrev_b32 v61, 4, v0
    v_lshlrev_b32 v61, 5, v61
    v_bfe_u32 v60, v0, 1, 1
    v_lshl_add_u32 v61, v60, 4, v61
    v_add_u32 v61, s57, v61
    v_bfe_u32 v62, v0, 2, 2
    v_lshlrev_b32 v62, 1, v62
    v_and_b32 v60, 1, v0
    v_lshl_add_u32 v62, v60, 0, v62
    v_mov_b32 v60, 160992
    v_cmp_eq_u32 vcc, 0, v62
    s_nop 1
    v_cndmask_b32 v52, v60, v61, vcc
    v_cmp_eq_u32 vcc, 1, v62
    s_nop 1
    v_cndmask_b32 v53, v60, v61, vcc
    v_cmp_eq_u32 vcc, 2, v62
    s_nop 1
    v_cndmask_b32 v54, v60, v61, vcc
    v_cmp_eq_u32 vcc, 3, v62
    s_nop 1
    v_cndmask_b32 v55, v60, v61, vcc
    v_cmp_eq_u32 vcc, 4, v62
    s_nop 1
    v_cndmask_b32 v56, v60, v61, vcc
    v_cmp_eq_u32 vcc, 5, v62
    s_nop 1
    v_cndmask_b32 v57, v60, v61, vcc
    s_lshl_b32 s58, s30, 2
    s_add_u32 s58, s58, 159744
    v_mov_b32 v60, s58
    v_lshlrev_b32 v59, 2, v0
    v_add_u32 v59, 158208, v59
    v_cmp_eq_u32 vcc, 63, v0
    s_nop 1
    v_cndmask_b32 v59, v59, v60, vcc
    v_and_b32 v62, 7, v0
    v_lshlrev_b32 v62, 2, v62
    v_add_u32 v62, 159744, v62
    s_lshl_b32 s57, s30, 11
    v_lshlrev_b32 v63, 4, v0
    v_add_u32 v63, s57, v63
    v_add_u32 v63, 92160, v63
    s_waitcnt vmcnt(34)
    s_barrier
    ds_read_b64_tr_b16 v[224:225], v8 offset:32768
    ds_read_b64_tr_b16 v[232:233], v9 offset:32768
    ds_read_b64_tr_b16 v[240:241], v10 offset:32768
    ds_read_b64_tr_b16 v[248:249], v11 offset:32768
    s_cmp_eq_u32 s30, 6
    s_cbranch_scc0 L_skip_104
    s_mov_b32 s57, 196864
    s_mov_b32 s58, 589056
    s_mov_b32 m0, 108544
L_dma_105:
    s_nop 0
    buffer_load_dwordx4 v7, s[36:39], s57 offen offset:0 nt lds
    buffer_load_dwordx4 v7, s[36:39], s58 offen offset:1024 nt lds
    s_add_u32 s57, s57, 24576
    s_add_u32 s58, s58, 24576
    s_add_u32 m0, m0, 2048
    s_cmp_lg_u32 m0, 124928
    s_cbranch_scc1 L_dma_105
L_skip_104:
    s_waitcnt lgkmcnt(0)
    v_lshrrev_b32 v5, 4, v0
    v_lshlrev_b32 v5, 5, v5
    v_bfe_u32 v60, v0, 1, 1
    v_lshl_add_u32 v5, v60, 4, v5
    v_add_u32 v5, 157696, v5
    ds_read_b128 v[12:15], v5 offset:0
    ds_read_b128 v[16:19], v5 offset:128
    ds_read_b128 v[20:23], v5 offset:256
    v_mov_b64 v[24:25], 0
    v_mov_b64 v[26:27], 0
    v_mov_b64 v[28:29], 0
    v_mov_b64 v[30:31], 0
    v_mov_b64 v[32:33], 0
    v_mov_b64 v[34:35], 0
    v_mov_b64 v[36:37], 0
    v_mov_b64 v[38:39], 0
    v_mov_b64 v[40:41], 0
    v_mov_b64 v[42:43], 0
    v_mov_b64 v[44:45], 0
    v_mov_b64 v[46:47], 0
    s_waitcnt lgkmcnt(0)
    v_smfmac_f32_16x16x64_bf16 v[24:27], v[12:15], v[64:71], v1
    v_smfmac_f32_16x16x64_bf16 v[24:27], v[16:19], v[72:79], v1
    v_smfmac_f32_16x16x64_bf16 v[24:27], v[20:23], v[80:87], v1
    v_smfmac_f32_16x16x64_bf16 v[28:31], v[12:15], v[88:95], v1
    v_smfmac_f32_16x16x64_bf16 v[28:31], v[16:19], v[96:103], v1
    v_smfmac_f32_16x16x64_bf16 v[28:31], v[20:23], v[104:111], v1
    v_smfmac_f32_16x16x64_bf16 v[32:35], v[12:15], v[112:119], v1
    v_smfmac_f32_16x16x64_bf16 v[32:35], v[16:19], v[120:127], v1
    v_smfmac_f32_16x16x64_bf16 v[32:35], v[20:23], v[128:135], v1
    v_smfmac_f32_16x16x64_bf16 v[36:39], v[12:15], v[136:143], v1
    v_smfmac_f32_16x16x64_bf16 v[36:39], v[16:19], v[144:151], v1
    v_smfmac_f32_16x16x64_bf16 v[36:39], v[20:23], v[152:159], v1
    v_add_f32 v24, v24, v26
    s_nop 0
    v_add_f32 v28, v28, v30
    s_nop 1
    v_add_f32 v32, v32, v34
    v_max3_f32 v61, v24, v28, v32
    v_mov_b32_dpp v24, v28 quad_perm:[0,1,2,3] row_mask:0x2 bank_mask:0xf
    v_add_f32 v36, v36, v38
    v_max_f32 v61, v61, v36
    v_mov_b32_dpp v24, v32 quad_perm:[0,1,2,3] row_mask:0x4 bank_mask:0xf
    s_nop 0
    v_max_f32_dpp v61, v61, v61 row_ror:8 row_mask:0xf bank_mask:0xf
    s_nop 0
    v_mov_b32_dpp v24, v36 quad_perm:[0,1,2,3] row_mask:0x8 bank_mask:0xf
    v_max_f32_dpp v61, v61, v61 row_ror:4 row_mask:0xf bank_mask:0xf
    s_nop 1
    v_max_f32_dpp v61, v61, v61 row_ror:2 row_mask:0xf bank_mask:0xf
    s_nop 1
    v_max_f32_dpp v61, v61, v61 row_ror:1 row_mask:0xf bank_mask:0xf
    v_sub_f32 v36, v24, v61
    ds_write_b32 v59, v61
    v_exp_f32 v36, v36
    s_nop 0
    v_cvt_pk_bf16_f32 v39, v36, v36
    ds_write_b16 v58, v39
    ds_read_b128 v[12:15], v52
    ds_read_b128 v[16:19], v53
    ds_read_b128 v[20:23], v54
    ds_read_b128 v[24:27], v55
    ds_read_b128 v[28:31], v56
    ds_read_b128 v[32:35], v57
    v_add_f32_dpp v38, v36, v36 row_ror:8 row_mask:0xf bank_mask:0xf
    s_nop 1
    v_add_f32_dpp v38, v38, v38 row_ror:4 row_mask:0xf bank_mask:0xf
    s_nop 1
    v_add_f32_dpp v38, v38, v38 row_ror:2 row_mask:0xf bank_mask:0xf
    s_nop 1
    v_add_f32_dpp v38, v38, v38 row_ror:1 row_mask:0xf bank_mask:0xf
    s_nop 1
    v_add_f32_dpp v38, v38, v38 row_bcast:15 row_mask:0xa bank_mask:0xf
    s_nop 1
    v_add_f32_dpp v38, v38, v38 row_bcast:31 row_mask:0xc bank_mask:0xf
    s_waitcnt lgkmcnt(0)
    s_waitcnt vmcnt(32)
    s_barrier
    ds_read_b64_tr_b16 v[162:163], v8 offset:49152
    ds_read_b64_tr_b16 v[170:171], v9 offset:49152
    ds_read_b64_tr_b16 v[178:179], v10 offset:49152
    ds_read_b64_tr_b16 v[186:187], v11 offset:49152
    s_cmp_eq_u32 s30, 6
    s_cbranch_scc0 L_skip_106
    s_mov_b32 s57, 786432
    s_mov_b32 s58, 1178624
    s_mov_b32 m0, 124928
L_dma_107:
    s_nop 0
    buffer_load_dwordx4 v7, s[36:39], s57 offen offset:0 nt lds
    buffer_load_dwordx4 v7, s[36:39], s58 offen offset:1024 nt lds
    s_add_u32 s57, s57, 24576
    s_add_u32 s58, s58, 24576
    s_add_u32 m0, m0, 2048
    s_cmp_lg_u32 m0, 141312
    s_cbranch_scc1 L_dma_107
L_skip_106:
    s_waitcnt lgkmcnt(0)
    ds_read_b32 v36, v62
    s_waitcnt lgkmcnt(0)
    v_max_f32_dpp v37, v36, v36 row_ror:4 row_mask:0xf bank_mask:0xf
    s_nop 1
    v_max_f32_dpp v37, v37, v37 row_ror:2 row_mask:0xf bank_mask:0xf
    s_nop 1
    v_max_f32_dpp v37, v37, v37 row_ror:1 row_mask:0xf bank_mask:0xf
    v_sub_f32 v39, v61, v37
    v_exp_f32 v39, v39
    s_cmp_lt_u32 s30, 2
    s_cbranch_scc0 L_skip_108
    s_lshl_b32 s57, s30, 3
    v_lshlrev_b32 v2, 4, v0
    v_add_u32 v2, s57, v2
    v_add_u32 v2, 92160, v2
    v_mov_b32 v60, 94192
    v_cmp_le_u32 vcc, 48, v0
    s_nop 1
    v_cndmask_b32 v2, v2, v60, vcc
    s_lshr_b32 s57, s54, 1
    s_lshl_b32 s57, s57, 2
    s_and_b32 s58, s54, 1
    s_add_u32 s57, s57, s58
    s_lshl_b32 s58, s57, 4
    s_lshl_b32 s57, s57, 3
    v_bfe_u32 v3, v0, 3, 2
    v_lshlrev_b32 v3, 8, v3
    v_bfe_u32 v61, v0, 2, 1
    v_lshl_add_u32 v3, v61, 5, v3
    v_and_b32 v61, 3, v0
    v_lshl_add_u32 v3, v61, 2, v3
    v_add_u32 v3, s58, v3
    v_bfe_u32 v60, v0, 3, 1
    v_lshlrev_b32 v60, 8, v60
    v_bfe_u32 v61, v0, 1, 1
    v_lshl_add_u32 v60, v61, 7, v60
    v_bfe_u32 v61, v0, 2, 1
    v_lshl_add_u32 v60, v61, 4, v60
    v_and_b32 v61, 1, v0
    v_lshl_add_u32 v60, v61, 2, v60
    v_add_u32 v60, s57, v60
    v_add_u32 v60, 1024, v60
    v_cmp_gt_u32 vcc, 32, v0
    s_nop 1
    v_cndmask_b32 v3, v60, v3, vcc
    s_lshl_b32 s57, s53, 1
    s_add_u32 s57, s57, s30
    s_mul_i32 s57, s57, 1664
    s_add_u32 s57, s57, s62
    v_add_u32 v3, s57, v3
    v_mov_b32 v60, 0x7f000000
    v_cmp_le_u32 vcc, 48, v0
    s_nop 1
    v_cndmask_b32 v3, v3, v60, vcc
    s_lshl_b32 s58, s54, 2
    s_add_u32 s57, s57, s58
    s_add_u32 s57, s57, 1536
    v_mov_b32 v4, s57
    v_mov_b32 v60, 0x7f000000
    v_cmp_ne_u32 vcc, 48, v0
    s_nop 1
    v_cndmask_b32 v4, v4, v60, vcc
    s_mov_b32 s58, 0
    v_min_u32 v37, -2, v37
    s_cmp_eq_u32 s55, 0
    s_cbranch_scc1 L_gs_109
    buffer_store_dword v37, v4, s[40:43], s58 offen
L_gb_110:
L_skip_108:
    s_cmp_eq_u32 s30, 2
    s_cbranch_scc0 L_skip_111
    v_lshlrev_b32 v2, 2, v0
    v_add_u32 v2, 157696, v2
    v_and_b32 v3, 15, v0
    v_lshlrev_b32 v3, 2, v3
    v_lshrrev_b32 v60, 5, v0
    v_lshl_add_u32 v3, v60, 6, v3
    v_bfe_u32 v60, v0, 4, 1
    v_lshl_add_u32 v3, v60, 13, v3
L_skip_111:
    s_waitcnt vmcnt(32)
    s_barrier
    ds_read_b64_tr_b16 v[194:195], v8 offset:0
    ds_read_b64_tr_b16 v[202:203], v9 offset:0
    ds_read_b64_tr_b16 v[210:211], v10 offset:0
    ds_read_b64_tr_b16 v[218:219], v11 offset:0
    s_cmp_eq_u32 s30, 6
    s_cbranch_scc0 L_skip_112
    s_mov_b32 s57, 786560
    s_mov_b32 s58, 1178752
    s_mov_b32 m0, 141312
L_dma_113:
    s_nop 0
    buffer_load_dwordx4 v7, s[36:39], s57 offen offset:0 nt lds
    buffer_load_dwordx4 v7, s[36:39], s58 offen offset:1024 nt lds
    s_add_u32 s57, s57, 24576
    s_add_u32 s58, s58, 24576
    s_add_u32 m0, m0, 2048
    s_cmp_lg_u32 m0, 157696
    s_cbranch_scc1 L_dma_113
L_skip_112:
    s_waitcnt lgkmcnt(0)
    s_waitcnt vmcnt(32)
    s_barrier
    ds_read_b64_tr_b16 v[226:227], v8 offset:16384
    ds_read_b64_tr_b16 v[234:235], v9 offset:16384
    ds_read_b64_tr_b16 v[242:243], v10 offset:16384
    ds_read_b64_tr_b16 v[250:251], v11 offset:16384
    s_cmp_eq_u32 s30, 6
    s_cbranch_scc0 L_skip_114
    s_mov_b32 s57, 786688
    s_mov_b32 s58, 1178880
    s_mov_b32 m0, 92160
L_dma_115:
    s_nop 0
    buffer_load_dwordx4 v7, s[36:39], s57 offen offset:0 nt lds
    buffer_load_dwordx4 v7, s[36:39], s58 offen offset:1024 nt lds
    s_add_u32 s57, s57, 24576
    s_add_u32 s58, s58, 24576
    s_add_u32 m0, m0, 2048
    s_cmp_lg_u32 m0, 108544
    s_cbranch_scc1 L_dma_115
L_skip_114:
    s_waitcnt lgkmcnt(0)
    s_cmp_eq_u32 s30, 5
    s_cbranch_scc0 L_skip_116
    global_load_dword v2, v3, s[26:27] offset:4 sc1
L_skip_116:
    s_waitcnt vmcnt(32)
    s_barrier
    ds_read_b64_tr_b16 v[164:165], v8 offset:32768
    ds_read_b64_tr_b16 v[172:173], v9 offset:32768
    ds_read_b64_tr_b16 v[180:181], v10 offset:32768
    ds_read_b64_tr_b16 v[188:189], v11 offset:32768
    s_cmp_eq_u32 s30, 6
    s_cbranch_scc0 L_skip_117
    s_mov_b32 s57, 983040
    s_mov_b32 s58, 1375232
    s_mov_b32 m0, 108544
L_dma_118:
    s_nop 0
    buffer_load_dwordx4 v7, s[36:39], s57 offen offset:0 nt lds
    buffer_load_dwordx4 v7, s[36:39], s58 offen offset:1024 nt lds
    s_add_u32 s57, s57, 24576
    s_add_u32 s58, s58, 24576
    s_add_u32 m0, m0, 2048
    s_cmp_lg_u32 m0, 124928
    s_cbranch_scc1 L_dma_118
L_skip_117:
    s_waitcnt lgkmcnt(0)
    s_waitcnt vmcnt(32)
    s_barrier
    ds_read_b64_tr_b16 v[196:197], v8 offset:49152
    ds_read_b64_tr_b16 v[204:205], v9 offset:49152
    ds_read_b64_tr_b16 v[212:213], v10 offset:49152
    ds_read_b64_tr_b16 v[220:221], v11 offset:49152
    s_cmp_eq_u32 s30, 6
    s_cbranch_scc0 L_skip_119
    s_mov_b32 s57, 983168
    s_mov_b32 s58, 1375360
    s_mov_b32 m0, 124928
L_dma_120:
    s_nop 0
    buffer_load_dwordx4 v7, s[36:39], s57 offen offset:0 nt lds
    buffer_load_dwordx4 v7, s[36:39], s58 offen offset:1024 nt lds
    s_add_u32 s57, s57, 24576
    s_add_u32 s58, s58, 24576
    s_add_u32 m0, m0, 2048
    s_cmp_lg_u32 m0, 141312
    s_cbranch_scc1 L_dma_120
L_skip_119:
    s_waitcnt lgkmcnt(0)
    s_cmp_eq_u32 s30, 5
    s_cbranch_scc0 L_skip_121
L_cw_122:
    s_waitcnt vmcnt(0)
    v_cmp_eq_u32 vcc, 0, v2
    s_cbranch_vccnz L_cr_123
    v_add_u32_dpp v2, v2, v2 row_ror:4 row_mask:0xf bank_mask:0xf
    s_nop 1
    v_add_u32_dpp v2, v2, v2 row_ror:2 row_mask:0xf bank_mask:0xf
    s_nop 1
    v_add_u32_dpp v2, v2, v2 row_ror:1 row_mask:0xf bank_mask:0xf
    v_mov_b32 v60, 160772
    ds_write_b32 v60, v2
    s_waitcnt lgkmcnt(0)
L_skip_121:
    s_cmp_lt_u32 s3, 20
    s_cbranch_scc0 L_skip_124
    s_mul_i32 s74, s30, 1664
    s_add_u32 s74, s74, s62
    s_add_u32 s74, s74, 0
    v_and_b32 v56, 7, v0
    v_lshlrev_b32 v56, 2, v56
    v_lshrrev_b32 v62, 4, v0
    v_lshlrev_b32 v62, 3, v62
    s_cmp_lg_u32 s30, 6
    s_cbranch_scc0 L_skip_124
    buffer_load_dword v52, v56, s[40:43], s74 offen offset:1536 sc1
    buffer_load_dwordx2 v[54:55], v62, s[40:43], s74 offen offset:1536 sc1
L_skip_124:
    s_cmp_eq_u32 s30, 2
    s_cbranch_scc0 L_skip_125
    s_sub_u32 s57, s3, 20
    s_cmp_lt_u32 s57, 4
    s_cbranch_scc0 L_skip_126
    s_sub_u32 s57, s3, 20
    s_lshl_b32 s57, s57, 6
    v_add_u32 v50, s57, v0
    v_min_u32 v50, 207, v50
    v_lshlrev_b32 v50, 7, v50
    s_add_u32 s57, s62, 0
    buffer_load_dword v50, v50, s[40:43], s57 offen sc1 nt
    s_sub_u32 s57, s3, 20
    s_lshl_b32 s57, s57, 6
    v_add_u32 v51, s57, v0
    v_min_u32 v51, 151, v51
    v_lshlrev_b32 v51, 7, v51
    s_add_u32 s57, s62, 26624
    buffer_load_dword v51, v51, s[40:43], s57 offen sc1 nt
    s_sub_u32 s57, s3, 20
    s_lshl_b32 s57, s57, 6
    v_add_u32 v49, s57, v0
    v_min_u32 v49, 191, v49
    v_lshlrev_b32 v49, 7, v49
    s_add_u32 s57, s62, 46080
    buffer_load_dword v49, v49, s[40:43], s57 offen sc1 nt
L_skip_126:
L_skip_125:
    s_waitcnt vmcnt(32)
    s_barrier
    ds_read_b64_tr_b16 v[228:229], v8 offset:0
    ds_read_b64_tr_b16 v[236:237], v9 offset:0
    ds_read_b64_tr_b16 v[244:245], v10 offset:0
    ds_read_b64_tr_b16 v[252:253], v11 offset:0
    s_cmp_eq_u32 s30, 6
    s_cbranch_scc0 L_skip_127
    s_mov_b32 s57, 983296
    s_mov_b32 s58, 1375488
    s_mov_b32 m0, 141312
L_dma_128:
    s_nop 0
    buffer_load_dwordx4 v7, s[36:39], s57 offen offset:0 nt lds
    buffer_load_dwordx4 v7, s[36:39], s58 offen offset:1024 nt lds
    s_add_u32 s57, s57, 24576
    s_add_u32 s58, s58, 24576
    s_add_u32 m0, m0, 2048
    s_cmp_lg_u32 m0, 157696
    s_cbranch_scc1 L_dma_128
L_skip_127:
    s_waitcnt lgkmcnt(0)
    s_cmp_ge_u32 s30, 6
    s_cbranch_scc0 L_skip_129
    v_mov_b32 v60, 160772
    ds_read_b32 v60, v60
    s_lshr_b32 s58, s63, 2
    s_waitcnt lgkmcnt(0)
    v_readfirstlane_b32 s57, v60
    s_cmp_gt_u32 s57, 24
    s_cselect_b32 s57, 1, 0
    s_xor_b32 s57, s57, s58
    s_lshl_b32 s57, s57, 13
    s_add_u32 s7, s8, s57
L_skip_129:
    s_branch L_tail
.p2align 10
L_tail:
L_pad0:
    s_cbranch_execz L_pad4
    s_waitcnt vmcnt(32)
    s_barrier
    ds_read_b64_tr_b16 v[166:167], v8 offset:16384
    ds_read_b64_tr_b16 v[174:175], v9 offset:16384
    ds_read_b64_tr_b16 v[182:183], v10 offset:16384
    ds_read_b64_tr_b16 v[190:191], v11 offset:16384
    s_waitcnt lgkmcnt(0)
    s_cmp_lt_u32 s30, 5
    s_cbranch_scc0 L_skip_130
    s_waitcnt vmcnt(0)
L_skip_130:
    s_cmp_lt_u32 s3, 20
    s_cbranch_scc0 L_skip_131
    v_lshlrev_b32 v57, 4, v0
    v_lshlrev_b32 v58, 3, v0
    s_mul_i32 s57, s30, 6144
    s_add_u32 s57, s57, 30720
    v_lshrrev_b32 v59, 2, v0
    v_lshlrev_b32 v59, 6, v59
    v_bfe_u32 v53, v0, 4, 1
    v_lshl_add_u32 v59, v53, 5, v59
    v_and_b32 v53, 3, v0
    v_lshl_add_u32 v59, v53, 3, v59
    v_add_u32 v59, s57, v59
    v_xor_b32 v60, 32, v59
    s_lshl_b32 s57, s30, 8
    s_add_u32 s57, s57, 157696
    v_lshl_add_u32 v61, v0, 2, s57
    s_cmp_lg_u32 s30, 6
    s_cbranch_scc0 L_skip_131
L_cw_132:
    s_waitcnt vmcnt(0)
    v_max3_u32 v53, v52, v54, v55
    v_cmp_eq_u32 vcc, -1, v53
    s_cbranch_vccnz L_cr_133
    v_max_f32_dpp v53, v52, v52 row_ror:4 row_mask:0xf bank_mask:0xf
    s_nop 1
    v_max_f32_dpp v53, v53, v53 row_ror:2 row_mask:0xf bank_mask:0xf
    s_nop 1
    v_max_f32_dpp v53, v53, v53 row_ror:1 row_mask:0xf bank_mask:0xf
    v_sub_f32 v52, v52, v53
    v_sub_f32 v54, v54, v53
    v_sub_f32 v55, v55, v53
    v_exp_f32 v52, v52
    v_exp_f32 v54, v54
    v_exp_f32 v55, v55
    s_cmp_eq_u32 s30, 7
    s_cbranch_scc0 L_skip_131
    v_add_u32 v62, 158720, v57
    ds_write_b128 v62, v[52:55]
    s_waitcnt lgkmcnt(0)
L_skip_131:
    v_smfmac_f32_16x16x64_bf16 v[40:43], v[12:15], v[160:167], v1
    v_smfmac_f32_16x16x64_bf16 v[40:43], v[16:19], v[168:175], v1
    v_smfmac_f32_16x16x64_bf16 v[40:43], v[20:23], v[176:183], v1
    v_smfmac_f32_16x16x64_bf16 v[40:43], v[24:27], v[184:191], v1
    s_cmp_eq_u32 s30, 6
    s_cbranch_scc0 L_skip_134
    s_mul_i32 s57, s14, 12
    s_add_u32 s58, s57, s15
    s_mov_b32 m0, 55296
L_dma_135:
    s_nop 0
    buffer_load_dwordx4 v3, s[48:51], s57 offen offset:0 nt lds
    buffer_load_dwordx4 v3, s[48:51], s58 offen offset:1024 nt lds
    s_add_u32 s57, s57, s14
    s_add_u32 s58, s58, s14
    s_add_u32 m0, m0, 2048
    s_cmp_lg_u32 m0, 67584
    s_cbranch_scc1 L_dma_135
    s_mul_i32 s57, s14, 18
    s_add_u32 s58, s57, s15
    s_mov_b32 m0, 67584
L_dma_136:
    s_nop 0
    buffer_load_dwordx4 v3, s[48:51], s57 offen offset:0 nt lds
    buffer_load_dwordx4 v3, s[48:51], s58 offen offset:1024 nt lds
    s_add_u32 s57, s57, s14
    s_add_u32 s58, s58, s14
    s_add_u32 m0, m0, 2048
    s_cmp_lg_u32 m0, 79872
    s_cbranch_scc1 L_dma_136
L_skip_134:
    s_waitcnt vmcnt(40)
    s_barrier
    ds_read_b64_tr_b16 v[198:199], v8 offset:32768
    ds_read_b64_tr_b16 v[206:207], v9 offset:32768
    ds_read_b64_tr_b16 v[214:215], v10 offset:32768
    ds_read_b64_tr_b16 v[222:223], v11 offset:32768
    s_waitcnt lgkmcnt(0)
    s_cmp_lt_u32 s3, 20
    s_cbranch_scc0 L_skip_137
    s_cmp_eq_u32 s30, 6
    s_cbranch_scc0 L_skip_137
    v_add_u32 v62, 158720, v57
    ds_read_b128 v[52:55], v62
L_skip_137:
L_pad1:
    s_cbranch_execz L_pad5
    v_smfmac_f32_16x16x64_bf16 v[40:43], v[28:31], v[192:199], v1
    v_smfmac_f32_16x16x64_bf16 v[40:43], v[32:35], v[200:207], v1
    v_smfmac_f32_16x16x64_bf16 v[44:47], v[12:15], v[208:215], v1
    v_smfmac_f32_16x16x64_bf16 v[44:47], v[16:19], v[216:223], v1
    v_mul_f32 v38, v38, v39
    ds_write_b32 v63, v38 offset:1024
    s_waitcnt vmcnt(24)
    s_barrier
    ds_read_b64_tr_b16 v[230:231], v8 offset:49152
    ds_read_b64_tr_b16 v[238:239], v9 offset:49152
    ds_read_b64_tr_b16 v[246:247], v10 offset:49152
    ds_read_b64_tr_b16 v[254:255], v11 offset:49152
    s_waitcnt lgkmcnt(0)
    v_smfmac_f32_16x16x64_bf16 v[44:47], v[20:23], v[224:231], v1
    v_smfmac_f32_16x16x64_bf16 v[44:47], v[24:27], v[232:239], v1
    v_smfmac_f32_16x16x64_bf16 v[44:47], v[28:31], v[240:247], v1
    v_smfmac_f32_16x16x64_bf16 v[44:47], v[32:35], v[248:255], v1
    s_setprio 0
    s_cmp_lt_u32 s30, 2
    v_pk_add_f32 v[40:41], v[40:41], v[42:43]
    s_nop 4
    v_pk_add_f32 v[42:43], v[44:45], v[46:47]
    v_pk_mul_f32 v[40:41], v[40:41], v[38:39] op_sel:[0,1] op_sel_hi:[1,1]
    v_pk_mul_f32 v[42:43], v[42:43], v[38:39] op_sel:[0,1] op_sel_hi:[1,1]
    ds_write_b128 v63, v[40:43]
    s_cbranch_scc1 L_comb_0
    s_waitcnt lgkmcnt(0)
    s_barrier
L_comb_0b:
    s_cmp_eq_u32 s30, 6
    s_cbranch_scc0 L_skip_142
    s_waitcnt vmcnt(0)
L_skip_142:
    s_barrier
    s_cmp_lt_u32 s3, 20
    s_cbranch_scc0 L_typeB_0
    buffer_load_dwordx4 v[12:15], v57, s[40:43], s74 offen sc1
    buffer_load_dwordx2 v[16:17], v58, s[40:43], s74 offen offset:1024 sc1
    buffer_load_dword v18, v56, s[40:43], s74 offen offset:1568 sc1
    ds_read_b64_tr_b16 v[28:29], v59 offset:0
    ds_read_b64_tr_b16 v[30:31], v59 offset:1024
    ds_read_b64_tr_b16 v[32:33], v59 offset:2048
    ds_read_b64_tr_b16 v[34:35], v59 offset:3072
    ds_read_b64_tr_b16 v[36:37], v59 offset:4096
    ds_read_b64_tr_b16 v[38:39], v59 offset:5120
    ds_read_b64_tr_b16 v[40:41], v60 offset:0
    ds_read_b64_tr_b16 v[42:43], v60 offset:1024
    ds_read_b64_tr_b16 v[44:45], v60 offset:2048
    ds_read_b64_tr_b16 v[46:47], v60 offset:3072
    ds_read_b64_tr_b16 v[48:49], v60 offset:4096
    ds_read_b64_tr_b16 v[50:51], v60 offset:5120
    v_mov_b64 v[20:21], 0
    v_mov_b64 v[22:23], 0
    v_mov_b64 v[24:25], 0
    v_mov_b64 v[26:27], 0
    s_add_u32 s58, s6, 0
    s_waitcnt lgkmcnt(0)
    s_branch L_pw_143
L_pr_144:
    buffer_load_dwordx4 v[12:15], v57, s[40:43], s74 offen sc1
    buffer_load_dwordx2 v[16:17], v58, s[40:43], s74 offen offset:1024 sc1
    buffer_load_dword v18, v56, s[40:43], s74 offen offset:1568 sc1
    s_sub_u32 s56, s56, 1
    s_cbranch_scc1 L_done
L_pw_143:
    s_waitcnt vmcnt(0)
    v_max3_u32 v19, v12, v13, v14
    v_max3_u32 v19, v19, v15, v16
    v_max3_u32 v19, v19, v17, v18
    v_cmp_eq_u32 vcc, -1, v19
    s_cbranch_vccnz L_pr_144
    v_smfmac_f32_16x16x64_bf16 v[20:23], v[12:15], v[28:35], v1
    v_mul_f32 v52, v52, v18
    v_smfmac_f32_16x16x64_bf16 v[24:27], v[12:15], v[40:47], v1
    v_smfmac_f32_16x16x32_bf16 v[20:23], v[16:17], v[36:39], v1
    v_add_f32_dpp v52, v52, v52 row_ror:4 row_mask:0xf bank_mask:0xf
    v_smfmac_f32_16x16x32_bf16 v[24:27], v[16:17], v[48:51], v1
    s_cmp_eq_u32 s30, 2
    v_add_f32_dpp v52, v52, v52 row_ror:2 row_mask:0xf bank_mask:0xf
    s_nop 1
    v_add_f32_dpp v52, v52, v52 row_ror:1 row_mask:0xf bank_mask:0xf
    v_rcp_f32 v52, v52
    v_pk_add_f32 v[20:21], v[20:21], v[22:23]
    s_nop 0
L_pad2:
    s_cbranch_execz L_pad6
    v_pk_add_f32 v[24:25], v[24:25], v[26:27]
    v_pk_mul_f32 v[54:55], v[54:55], v[52:53] op_sel:[0,0] op_sel_hi:[1,0]
    v_mul_f32 v20, v20, v54
    v_mul_f32 v24, v24, v54
    v_fmac_f32 v20, v21, v55
    v_fmac_f32 v24, v25, v55
    s_nop 1
    v_permlane32_swap_b32 v20, v24
    v_add_f32 v20, v20, v24
    ds_write_b32 v61, v20
    s_waitcnt lgkmcnt(0)
    s_barrier
    s_cbranch_scc0 L_finb_145
    ds_read2st64_b32 v[12:13], v2 offset0:0 offset1:1
    ds_read2st64_b32 v[14:15], v2 offset0:2 offset1:3
    ds_read2st64_b32 v[16:17], v2 offset0:4 offset1:5
    ds_read2st64_b32 v[18:19], v2 offset0:6 offset1:7
    s_waitcnt lgkmcnt(2)
    v_pk_add_f32 v[12:13], v[12:13], v[14:15]
    s_waitcnt lgkmcnt(0)
    v_pk_add_f32 v[16:17], v[16:17], v[18:19]
    v_pk_add_f32 v[12:13], v[12:13], v[16:17]
    v_add_f32 v14, v12, v13
    v_add_f32 v15, v12, v13
    s_nop 1
    v_permlane16_swap_b32 v14, v15
    v_add_f32 v12, v14, v15
    v_min_u32 v12, -2, v12
    buffer_store_dword v12, v3, s[40:43], s58 offen sc1
L_finb_145:
    s_sub_u32 s57, s30, 4
    s_cmp_lt_u32 s57, 3
    s_cbranch_scc0 L_skip_146
    s_sub_u32 s60, s30, 4
    s_lshl_b32 s57, s60, 11
    v_lshlrev_b32 v11, 4, v0
    v_add_u32 v11, s57, v11
    s_add_u32 s65, s62, 19456
    buffer_load_dwordx4 v[52:55], v11, s[40:43], s65 offen offset:0 sc1
    buffer_load_dwordx4 v[56:59], v11, s[40:43], s65 offen offset:1024 sc1
    s_lshl_b32 s59, s60, 12
    s_add_u32 s59, s59, 79872
    s_mov_b32 s44, s20
    s_mov_b32 s45, s21
    s_mov_b32 s46, 1966080
    s_mov_b32 s47, 0x20000
    s_mul_i32 s57, s31, 3
    s_add_u32 s57, s57, s60
    s_mul_i32 s57, s57, 81920
    s_lshl_b32 s64, s3, 6
    s_add_u32 s57, s57, s64
    v_lshrrev_b32 v5, 2, v0
    v_mul_u32_u24 v5, 1280, v5
    v_and_b32 v60, 3, v0
    v_lshl_add_u32 v5, v60, 4, v5
    v_add_u32 v5, s57, v5
    s_add_u32 m0, s59, 0
    s_mov_b32 s57, 0
    buffer_load_dwordx4 v5, s[44:47], s57 offen nt lds
    s_add_u32 m0, s59, 1024
    s_mov_b32 s57, 20480
    buffer_load_dwordx4 v5, s[44:47], s57 offen nt lds
    s_add_u32 m0, s59, 2048
    s_mov_b32 s57, 40960
    buffer_load_dwordx4 v5, s[44:47], s57 offen nt lds
    s_add_u32 m0, s59, 3072
    s_mov_b32 s57, 61440
    buffer_load_dwordx4 v5, s[44:47], s57 offen nt lds
    v_bfe_u32 v35, v0, 4, 1
    v_lshlrev_b32 v35, 11, v35
    v_bfe_u32 v60, v0, 2, 2
    v_lshl_add_u32 v35, v60, 8, v35
    v_lshrrev_b32 v60, 5, v0
    v_lshl_add_u32 v35, v60, 6, v35
    v_and_b32 v60, 3, v0
    v_lshl_add_u32 v35, v60, 3, v35
    v_add_u32 v35, s59, v35
    v_mov_b32 v9, 0xbdd2d3e8
    v_mov_b32 v10, 0xc0135761
    s_lshl_b32 s57, s60, 7
    s_add_u32 s57, s57, 159872
    v_lshlrev_b32 v32, 3, v0
    v_add_u32 v32, s57, v32
    v_lshlrev_b32 v33, 3, v0
    v_add_u32 v33, 129024, v33
    v_cmp_gt_u32 vcc, 16, v0
    s_nop 1
    v_cndmask_b32 v32, v33, v32, vcc
    v_and_b32 v33, 15, v0
L_pad3:
    s_cbranch_execz L_pad7
    v_lshlrev_b32 v33, 3, v33
    v_lshrrev_b32 v60, 5, v0
    v_lshl_add_u32 v33, v60, 2, v33
    v_add_u32 v33, 159872, v33
    v_and_b32 v34, 15, v0
    v_lshlrev_b32 v34, 2, v34
    v_lshrrev_b32 v60, 5, v0
    v_lshl_add_u32 v34, v60, 6, v34
    v_bfe_u32 v60, v0, 4, 1
    v_lshl_add_u32 v34, v60, 13, v34
    s_add_u32 s60, s6, 66048
    s_add_u32 s58, s62, 13312
    s_add_u32 s57, s62, 25856
    v_and_b32 v7, 7, v0
    v_lshlrev_b32 v7, 3, v7
    v_mov_b32 v60, 0x3acccccd
    v_mov_b32 v61, 0x3727c5ac
    s_waitcnt vmcnt(0)
    buffer_load_dwordx2 v[24:25], v7, s[40:43], s57 offen sc1
    buffer_load_dwordx4 v[12:15], v11, s[40:43], s58 offen offset:0 sc1
    buffer_load_dwordx4 v[16:19], v11, s[40:43], s58 offen offset:1024 sc1
    ds_read_b64_tr_b16 v[36:37], v35 offset:0
    ds_read_b64_tr_b16 v[38:39], v35 offset:1024
    ds_read_b64_tr_b16 v[40:41], v35 offset:128
    ds_read_b64_tr_b16 v[42:43], v35 offset:1152
    ds_read_b64_tr_b16 v[44:45], v35 offset:32
    ds_read_b64_tr_b16 v[46:47], v35 offset:1056
    ds_read_b64_tr_b16 v[48:49], v35 offset:160
    ds_read_b64_tr_b16 v[50:51], v35 offset:1184
L_sw_149:
    v_max3_u32 v20, v52, v53, v54
    v_max3_u32 v20, v20, v55, v56
    v_max3_u32 v20, v20, v57, v58
    v_max_u32 v20, v20, v59
    v_cmp_eq_u32 vcc, -1, v20
    s_cbranch_vccnz L_sr_150
    v_pk_add_f32 v[28:29], v[52:53], v[56:57]
    v_pk_add_f32 v[30:31], v[54:55], v[58:59]
    s_nop 1
    v_permlane32_swap_b32 v28, v30
    v_permlane32_swap_b32 v29, v31
    v_pk_add_f32 v[28:29], v[28:29], v[30:31]
    s_nop 1
    v_permlane16_swap_b32 v28, v29
    v_add_f32 v28, v28, v29
    v_mov_b64 v[52:53], 0
    v_mov_b64 v[54:55], 0
    v_mov_b64 v[56:57], 0
    v_mov_b64 v[58:59], 0
    s_waitcnt lgkmcnt(0)
L_pr_148:
    buffer_load_dwordx2 v[24:25], v7, s[40:43], s57 offen sc1
    buffer_load_dwordx4 v[12:15], v11, s[40:43], s58 offen offset:0 sc1
    buffer_load_dwordx4 v[16:19], v11, s[40:43], s58 offen offset:1024 sc1
    s_sub_u32 s56, s56, 1
    s_cbranch_scc1 L_done
L_pw_147:
    s_waitcnt vmcnt(3)
    v_max_u32 v20, v24, v25
    v_cmp_eq_u32 vcc, -1, v20
    s_cbranch_vccnz L_pr_148
    buffer_load_dwordx4 v[12:15], v11, s[40:43], s58 offen offset:0 sc1
    buffer_load_dwordx4 v[16:19], v11, s[40:43], s58 offen offset:1024 sc1
    v_add_f32_dpp v2, v24, v24 row_ror:4 row_mask:0xf bank_mask:0xf
    v_add_f32_dpp v3, v25, v25 row_ror:4 row_mask:0xf bank_mask:0xf
    v_pk_add_f32 v[20:21], v[12:13], v[16:17]
    v_pk_add_f32 v[22:23], v[14:15], v[18:19]
    v_add_f32_dpp v2, v2, v2 row_ror:2 row_mask:0xf bank_mask:0xf
    v_add_f32_dpp v3, v3, v3 row_ror:2 row_mask:0xf bank_mask:0xf
    v_permlane32_swap_b32 v20, v22
    v_permlane32_swap_b32 v21, v23
    v_add_f32_dpp v2, v2, v2 row_ror:1 row_mask:0xf bank_mask:0xf
    v_add_f32_dpp v3, v3, v3 row_ror:1 row_mask:0xf bank_mask:0xf
    v_pk_add_f32 v[20:21], v[20:21], v[22:23]
    v_mul_f32 v2, v2, v60
    v_fma_f32 v3, v3, v60, v61
    v_permlane16_swap_b32 v20, v21
    v_fma_f32 v3, -v2, v2, v3
    v_add_f32 v20, v20, v21
    v_max_f32 v3, v3, v61
    v_mul_f32 v26, v28, v2
    v_rsq_f32 v3, v3
    v_cmp_u_f32 vcc, v20, v20
    v_sub_f32 v20, v20, v26
    s_cbranch_vccnz L_hr_151
L_hk_152:
    v_fma_f32 v20, v20, v3, v4
L_pad4:
    s_cbranch_execz L_pad8
    v_mul_f32 v21, v20, v20
    v_fma_f32 v21, v21, v9, v10
    v_mul_f32 v21, v21, v20
    v_exp_f32 v21, v21
    s_nop 0
    v_add_f32 v21, 1.0, v21
    v_rcp_f32 v21, v21
    s_nop 0
    v_mul_f32 v20, v20, v21
    s_nop 1
    v_mov_b32_dpp v21, v20 row_shl:1 row_mask:0xf bank_mask:0xf bound_ctrl:0
    v_cvt_pk_bf16_f32 v28, v20, v21
    s_nop 1
    v_mov_b32_dpp v29, v28 row_shl:4 row_mask:0xf bank_mask:0xf bound_ctrl:0
    v_mov_b32_dpp v30, v28 row_shl:8 row_mask:0xf bank_mask:0xf bound_ctrl:0
    v_mov_b32_dpp v31, v28 row_shl:12 row_mask:0xf bank_mask:0xf bound_ctrl:0
    s_nop 1
    v_smfmac_f32_16x16x64_bf16 v[52:55], v[28:31], v[36:43], v1
    v_smfmac_f32_16x16x64_bf16 v[56:59], v[28:31], v[44:51], v1
    s_cmp_eq_u32 s30, 4
    s_nop 5
    v_add_f32 v22, v52, v54
    v_add_f32 v23, v56, v58
    ds_write_b64 v32, v[22:23]
    s_cbranch_scc0 L_skip_154
L_xw_155:
    ds_read2_b32 v[20:21], v33 offset0:0 offset1:32
    ds_read_b32 v22, v33 offset:256
    s_sub_u32 s56, s56, 1
    s_cbranch_scc1 L_done
    s_waitcnt lgkmcnt(0)
    v_max3_u32 v23, v20, v21, v22
    v_add_f32 v20, v20, v21
    v_cmp_eq_u32 vcc, -1, v23
    v_add_f32 v20, v20, v22
    s_cbranch_vccnz L_xw_155
    v_min_u32 v20, -2, v20
    buffer_store_dword v20, v34, s[40:43], s60 offen sc1
    s_waitcnt vmcnt(1)
    s_branch L_pe_156
L_skip_154:
    s_waitcnt vmcnt(0)
L_pe_156:
L_skip_146:
    s_branch L_p1
L_typeB_0:
    s_cmp_eq_u32 s53, 3
    s_cbranch_scc0 L_typeC_157
    s_cmp_eq_u32 s30, 7
    s_cbranch_scc1 L_w7_167
    s_cmp_lt_u32 s30, 6
    s_cbranch_scc0 L_skip_169
    s_lshr_b32 s57, s30, 1
    s_mul_i32 s57, s57, 128
    s_and_b32 s58, s30, 1
    s_lshl_b32 s58, s58, 6
    s_add_u32 s57, s57, s58
    v_lshrrev_b32 v18, 5, v0
    v_lshlrev_b32 v18, 13, v18
    v_bfe_u32 v60, v0, 3, 1
    v_lshl_add_u32 v18, v60, 12, v18
    v_bfe_u32 v60, v0, 4, 1
    v_lshl_add_u32 v18, v60, 11, v18
    v_bfe_u32 v60, v0, 2, 1
    v_mul_u32_u24 v60, 384, v60
    v_add_u32 v18, v60, v18
    v_and_b32 v60, 3, v0
    v_lshl_add_u32 v18, v60, 3, v18
    v_add_u32 v18, s57, v18
    v_add_u32 v18, 30720, v18
    v_bfe_u32 v19, v0, 4, 1
    v_lshlrev_b32 v19, 12, v19
    v_bfe_u32 v60, v0, 3, 1
    v_lshl_add_u32 v19, v60, 11, v19
    v_bfe_u32 v60, v0, 2, 1
    v_mul_u32_u24 v60, 384, v60
    v_add_u32 v19, v60, v19
    v_and_b32 v60, 3, v0
    v_lshl_add_u32 v19, v60, 3, v19
    v_add_u32 v19, s57, v19
    v_add_u32 v19, 63488, v19
    ds_read_b64_tr_b16 v[28:29], v18 offset:0
    ds_read_b64_tr_b16 v[30:31], v18 offset:1024
    ds_read_b64_tr_b16 v[32:33], v18 offset:16384
    ds_read_b64_tr_b16 v[34:35], v18 offset:17408
    ds_read_b64_tr_b16 v[36:37], v19 offset:0
    ds_read_b64_tr_b16 v[38:39], v19 offset:1024
    ds_read_b64_tr_b16 v[40:41], v18 offset:32
    ds_read_b64_tr_b16 v[42:43], v18 offset:1056
    ds_read_b64_tr_b16 v[44:45], v18 offset:16416
    ds_read_b64_tr_b16 v[46:47], v18 offset:17440
    ds_read_b64_tr_b16 v[48:49], v19 offset:32
L_pad5:
    s_cbranch_execz L_pad9
    ds_read_b64_tr_b16 v[50:51], v19 offset:1056
    v_lshrrev_b32 v9, 4, v0
    v_lshlrev_b32 v9, 5, v9
    v_bfe_u32 v60, v0, 1, 1
    v_lshl_add_u32 v9, v60, 4, v9
    v_and_b32 v60, 1, v0
    v_mul_u32_u24 v60, 192, v60
    v_add_u32 v9, v60, v9
    v_add_u32 v9, 160832, v9
    v_lshrrev_b32 v10, 4, v0
    v_lshlrev_b32 v10, 4, v10
    v_bfe_u32 v60, v0, 1, 1
    v_lshl_add_u32 v10, v60, 3, v10
    v_and_b32 v60, 1, v0
    v_mul_u32_u24 v60, 192, v60
    v_add_u32 v10, v60, v10
    v_add_u32 v10, 160960, v10
    v_mov_b64 v[20:21], 0
    v_mov_b64 v[22:23], 0
    v_mov_b64 v[24:25], 0
    v_mov_b64 v[26:27], 0
    s_lshr_b32 s57, s30, 1
    s_lshl_b32 s57, s57, 11
    s_lshl_b32 s58, s58, 1
    s_add_u32 s57, s57, s58
    s_lshl_b32 s58, s54, 8
    s_add_u32 s57, s57, s58
    v_and_b32 v11, 31, v0
    v_lshlrev_b32 v11, 2, v11
    v_lshrrev_b32 v60, 5, v0
    v_lshl_add_u32 v11, v60, 30, v11
    v_add_u32 v11, s57, v11
    s_add_u32 s59, s62, 13312
    s_add_u32 s60, s62, 25856
    ds_read_b128 v[12:15], v9
    ds_read_b64 v[16:17], v10
    s_waitcnt lgkmcnt(1)
    v_smfmac_f32_16x16x64_bf16 v[20:23], v[12:15], v[28:35], v1
    v_smfmac_f32_16x16x64_bf16 v[24:27], v[12:15], v[40:47], v1
    s_waitcnt lgkmcnt(0)
    v_smfmac_f32_16x16x32_bf16 v[20:23], v[16:17], v[36:39], v1
    v_smfmac_f32_16x16x32_bf16 v[24:27], v[16:17], v[48:51], v1
    s_add_u32 s60, s62, 19456
    s_cmp_eq_u32 s55, 0
    s_nop 4
    v_add_f32 v12, v21, v23
    s_nop 1
    v_add_f32_dpp v12, v25, v27 quad_perm:[0,1,2,3] row_mask:0x2 bank_mask:0xf
    v_min_u32 v12, -2, v12
    s_cbranch_scc1 L_gs_170
    buffer_store_dword v12, v11, s[40:43], s60 offen
L_gb_171:
    v_mov_b64 v[20:21], 0
    v_mov_b64 v[22:23], 0
    v_mov_b64 v[24:25], 0
    v_mov_b64 v[26:27], 0
L_skip_169:
    s_cmp_lt_u32 s30, 6
    s_barrier
    s_cbranch_scc0 L_se_168
    ds_read_b128 v[12:15], v9
    ds_read_b64 v[16:17], v10
    s_waitcnt lgkmcnt(1)
    v_smfmac_f32_16x16x64_bf16 v[20:23], v[12:15], v[28:35], v1
    v_smfmac_f32_16x16x64_bf16 v[24:27], v[12:15], v[40:47], v1
    s_waitcnt lgkmcnt(0)
    v_smfmac_f32_16x16x32_bf16 v[20:23], v[16:17], v[36:39], v1
    v_smfmac_f32_16x16x32_bf16 v[24:27], v[16:17], v[48:51], v1
    s_cmp_eq_u32 s55, 0
    s_nop 5
    v_add_f32 v12, v20, v22
    s_nop 1
    v_add_f32_dpp v12, v24, v26 quad_perm:[0,1,2,3] row_mask:0x2 bank_mask:0xf
    v_min_u32 v12, -2, v12
    s_cbranch_scc1 L_gs_172
    buffer_store_dword v12, v11, s[40:43], s59 offen
L_gb_173:
L_se_168:
L_p1:
    s_lshl_b32 s57, s30, 7
    s_add_u32 s57, s57, 158720
    v_lshrrev_b32 v58, 4, v0
    v_lshlrev_b32 v58, 5, v58
    v_bfe_u32 v60, v0, 1, 1
    v_lshl_add_u32 v58, v60, 4, v58
    v_bfe_u32 v60, v0, 2, 2
    v_lshl_add_u32 v58, v60, 2, v58
    v_and_b32 v60, 1, v0
    v_lshl_add_u32 v58, v60, 1, v58
    v_add_u32 v58, s57, v58
    v_lshrrev_b32 v61, 4, v0
    v_lshlrev_b32 v61, 5, v61
    v_bfe_u32 v60, v0, 1, 1
    v_lshl_add_u32 v61, v60, 4, v61
    v_add_u32 v61, s57, v61
L_pad6:
    s_cbranch_execz L_pad10
    v_bfe_u32 v62, v0, 2, 2
    v_lshlrev_b32 v62, 1, v62
    v_and_b32 v60, 1, v0
    v_lshl_add_u32 v62, v60, 0, v62
    v_mov_b32 v60, 160992
    v_cmp_eq_u32 vcc, 0, v62
    s_nop 1
    v_cndmask_b32 v52, v60, v61, vcc
    v_cmp_eq_u32 vcc, 1, v62
    s_nop 1
    v_cndmask_b32 v53, v60, v61, vcc
    v_cmp_eq_u32 vcc, 2, v62
    s_nop 1
    v_cndmask_b32 v54, v60, v61, vcc
    v_cmp_eq_u32 vcc, 3, v62
    s_nop 1
    v_cndmask_b32 v55, v60, v61, vcc
    v_cmp_eq_u32 vcc, 4, v62
    s_nop 1
    v_cndmask_b32 v56, v60, v61, vcc
    v_cmp_eq_u32 vcc, 5, v62
    s_nop 1
    v_cndmask_b32 v57, v60, v61, vcc
    s_lshl_b32 s58, s30, 2
    s_add_u32 s58, s58, 159808
    v_mov_b32 v60, s58
    v_lshlrev_b32 v59, 2, v0
    v_add_u32 v59, 158208, v59
    v_cmp_eq_u32 vcc, 63, v0
    s_nop 1
    v_cndmask_b32 v59, v59, v60, vcc
    v_and_b32 v62, 7, v0
    v_lshlrev_b32 v62, 2, v62
    v_add_u32 v62, 159808, v62
    s_lshl_b32 s57, s30, 11
    v_lshlrev_b32 v63, 4, v0
    v_add_u32 v63, s57, v63
    v_add_u32 v63, 92160, v63
    s_sub_u32 s57, s30, 1
    s_lshl_b32 s58, s57, 11
    v_lshlrev_b32 v7, 4, v0
    v_add_u32 v7, s58, v7
    s_lshl_b32 s58, s57, 7
    v_bfe_u32 v8, v0, 2, 2
    v_lshlrev_b32 v8, 5, v8
    v_lshrrev_b32 v60, 5, v0
    v_lshl_add_u32 v8, v60, 4, v8
    v_and_b32 v60, 3, v0
    v_lshl_add_u32 v8, v60, 2, v8
    v_bfe_u32 v60, v0, 4, 1
    v_lshl_add_u32 v8, v60, 1, v8
    v_add_u32 v8, s58, v8
    v_add_u32 v8, 124928, v8
    s_cmp_eq_u32 s30, 7
    s_cbranch_scc1 L_w7_181
    s_cmp_lt_u32 s30, 6
    s_cbranch_scc0 L_skip_183
    s_lshr_b32 s57, s30, 1
    s_mul_i32 s57, s57, 1024
    s_and_b32 s58, s30, 1
    s_lshl_b32 s58, s58, 6
    s_add_u32 s57, s57, s58
    v_lshrrev_b32 v18, 5, v0
    v_mul_u32_u24 v18, 6144, v18
    v_bfe_u32 v60, v0, 3, 1
    v_mul_u32_u24 v60, 3072, v60
    v_add_u32 v18, v60, v18
    v_bfe_u32 v60, v0, 4, 1
    v_lshl_add_u32 v18, v60, 9, v18
    v_bfe_u32 v60, v0, 2, 1
    v_lshl_add_u32 v18, v60, 7, v18
    v_and_b32 v60, 3, v0
    v_lshl_add_u32 v18, v60, 3, v18
    v_add_u32 v18, s57, v18
    v_bfe_u32 v19, v0, 4, 1
    v_mul_u32_u24 v19, 3072, v19
    v_bfe_u32 v60, v0, 3, 1
    v_lshl_add_u32 v19, v60, 9, v19
    v_bfe_u32 v60, v0, 2, 1
    v_lshl_add_u32 v19, v60, 7, v19
    v_and_b32 v60, 3, v0
    v_lshl_add_u32 v19, v60, 3, v19
    v_add_u32 v19, s57, v19
    v_add_u32 v19, 24576, v19
    ds_read_b64_tr_b16 v[28:29], v18 offset:0
    ds_read_b64_tr_b16 v[30:31], v18 offset:256
    ds_read_b64_tr_b16 v[32:33], v18 offset:12288
    ds_read_b64_tr_b16 v[34:35], v18 offset:12544
    ds_read_b64_tr_b16 v[36:37], v19 offset:0
    ds_read_b64_tr_b16 v[38:39], v19 offset:256
    ds_read_b64_tr_b16 v[40:41], v18 offset:32
L_pad7:
    s_cbranch_execz L_pad11
    ds_read_b64_tr_b16 v[42:43], v18 offset:288
    ds_read_b64_tr_b16 v[44:45], v18 offset:12320
    ds_read_b64_tr_b16 v[46:47], v18 offset:12576
    ds_read_b64_tr_b16 v[48:49], v19 offset:32
    ds_read_b64_tr_b16 v[50:51], v19 offset:288
    v_lshrrev_b32 v9, 4, v0
    v_lshlrev_b32 v9, 5, v9
    v_bfe_u32 v60, v0, 1, 1
    v_lshl_add_u32 v9, v60, 4, v9
    v_and_b32 v60, 1, v0
    v_mul_u32_u24 v60, 192, v60
    v_add_u32 v9, v60, v9
    v_add_u32 v9, 160832, v9
    v_lshrrev_b32 v10, 4, v0
    v_lshlrev_b32 v10, 4, v10
    v_bfe_u32 v60, v0, 1, 1
    v_lshl_add_u32 v10, v60, 3, v10
    v_and_b32 v60, 1, v0
    v_mul_u32_u24 v60, 192, v60
    v_add_u32 v10, v60, v10
    v_add_u32 v10, 160960, v10
    v_mov_b64 v[20:21], 0
    v_mov_b64 v[22:23], 0
    v_mov_b64 v[24:25], 0
    v_mov_b64 v[26:27], 0
    s_lshr_b32 s57, s30, 1
    s_lshl_b32 s57, s57, 11
    s_lshl_b32 s58, s58, 1
    s_add_u32 s57, s57, s58
    s_lshl_b32 s58, s54, 8
    s_add_u32 s57, s57, s58
    v_and_b32 v11, 31, v0
    v_lshlrev_b32 v11, 2, v11
    v_lshrrev_b32 v60, 5, v0
    v_lshl_add_u32 v11, v60, 30, v11
    v_add_u32 v11, s57, v11
    s_mul_i32 s59, s53, 6144
    s_add_u32 s59, s59, s62
    s_add_u32 s59, s59, 46080
    s_lshl_b32 s60, s53, 6
    s_add_u32 s60, s60, s62
    s_add_u32 s60, s60, 25600
L_skip_183:
    s_cmp_lt_u32 s30, 6
    s_barrier
    s_cbranch_scc0 L_se_182
    ds_read_b128 v[12:15], v9
    ds_read_b64 v[16:17], v10
    s_waitcnt lgkmcnt(1)
    v_smfmac_f32_16x16x64_bf16 v[20:23], v[12:15], v[28:35], v1
    v_smfmac_f32_16x16x64_bf16 v[24:27], v[12:15], v[40:47], v1
    s_waitcnt lgkmcnt(0)
    v_smfmac_f32_16x16x32_bf16 v[20:23], v[16:17], v[36:39], v1
    v_smfmac_f32_16x16x32_bf16 v[24:27], v[16:17], v[48:51], v1
    s_cmp_eq_u32 s55, 0
    s_nop 5
    v_add_f32 v12, v20, v22
    s_nop 1
    v_add_f32_dpp v12, v24, v26 quad_perm:[0,1,2,3] row_mask:0x2 bank_mask:0xf
    v_min_u32 v12, -2, v12
    s_cbranch_scc1 L_gs_184
    buffer_store_dword v12, v11, s[40:43], s59 offen
L_gb_185:
L_se_182:
    s_sub_u32 s57, s30, 1
    s_cmp_lt_u32 s57, 3
    s_cbranch_scc0 L_qo_199
    v_and_b32 v9, 7, v0
    v_lshlrev_b32 v9, 3, v9
    buffer_load_dwordx2 v[10:11], v9, s[40:43], s60 offen sc1
    buffer_load_dwordx4 v[12:15], v7, s[40:43], s59 offen offset:0 sc1
    buffer_load_dwordx4 v[16:19], v7, s[40:43], s59 offen offset:1024 sc1
    v_mov_b64 v[24:25], 0
    v_mov_b64 v[26:27], 0
    v_mov_b64 v[28:29], 0
    v_mov_b64 v[30:31], 0
    v_mov_b64 v[32:33], 0
    v_mov_b64 v[34:35], 0
    v_mov_b64 v[36:37], 0
    v_mov_b64 v[38:39], 0
    v_mov_b64 v[40:41], 0
    v_mov_b64 v[42:43], 0
    v_mov_b64 v[44:45], 0
    v_mov_b64 v[46:47], 0
    v_lshrrev_b32 v5, 4, v0
    v_lshlrev_b32 v5, 5, v5
    v_bfe_u32 v60, v0, 1, 1
    v_lshl_add_u32 v5, v60, 4, v5
    v_add_u32 v5, 124928, v5
    v_mov_b32 v60, 0x3c75e03e
    v_mov_b32 v61, 0x3a71d1e6
    v_mov_b32 v51, 0x3e13985d
    s_branch L_pw_201
L_pr_202:
    buffer_load_dwordx2 v[10:11], v9, s[40:43], s60 offen sc1
L_pad8:
    s_cbranch_execz L_pad12
    buffer_load_dwordx4 v[12:15], v7, s[40:43], s59 offen offset:0 sc1
    buffer_load_dwordx4 v[16:19], v7, s[40:43], s59 offen offset:1024 sc1
    s_sub_u32 s56, s56, 1
    s_cbranch_scc1 L_done
L_pw_201:
    s_waitcnt vmcnt(0)
    v_max_u32 v20, v10, v11
    v_cmp_eq_u32 vcc, -1, v20
    s_cbranch_vccnz L_pr_202
    v_add_f32_dpp v48, v10, v10 row_ror:4 row_mask:0xf bank_mask:0xf
    v_add_f32_dpp v49, v11, v11 row_ror:4 row_mask:0xf bank_mask:0xf
    v_pk_add_f32 v[20:21], v[12:13], v[16:17]
    v_pk_add_f32 v[22:23], v[14:15], v[18:19]
    v_add_f32_dpp v48, v48, v48 row_ror:2 row_mask:0xf bank_mask:0xf
    v_add_f32_dpp v49, v49, v49 row_ror:2 row_mask:0xf bank_mask:0xf
    v_permlane32_swap_b32 v20, v22
    v_permlane32_swap_b32 v21, v23
    v_add_f32_dpp v48, v48, v48 row_ror:1 row_mask:0xf bank_mask:0xf
    v_add_f32_dpp v49, v49, v49 row_ror:1 row_mask:0xf bank_mask:0xf
    v_pk_add_f32 v[20:21], v[20:21], v[22:23]
    v_mul_f32 v48, v48, v60
    v_fma_f32 v49, v49, v51, v61
    v_permlane16_swap_b32 v20, v21
    v_fma_f32 v49, -v48, v48, v49
    v_add_f32 v20, v20, v21
    v_max_f32 v49, v49, v61
    v_mul_f32 v50, v6, v48
    v_rsq_f32 v49, v49
    v_cmp_u_f32 vcc, v20, v20
    v_sub_f32 v20, v20, v50
    s_cbranch_vccnz L_hr_203
L_hk_204:
    v_mul_f32 v20, v20, v49
    v_cvt_pk_bf16_f32 v20, v20, v20
    ds_write_b16 v8, v20
L_qb_200:
    s_waitcnt lgkmcnt(0)
    s_barrier
    ds_read_b128 v[12:15], v5 offset:0
    ds_read_b128 v[16:19], v5 offset:128
    ds_read_b128 v[20:23], v5 offset:256
    s_waitcnt lgkmcnt(0)
    v_smfmac_f32_16x16x64_bf16 v[24:27], v[12:15], v[64:71], v1
    v_smfmac_f32_16x16x64_bf16 v[24:27], v[16:19], v[72:79], v1
    v_smfmac_f32_16x16x64_bf16 v[24:27], v[20:23], v[80:87], v1
    v_smfmac_f32_16x16x64_bf16 v[28:31], v[12:15], v[88:95], v1
    v_smfmac_f32_16x16x64_bf16 v[28:31], v[16:19], v[96:103], v1
    v_smfmac_f32_16x16x64_bf16 v[28:31], v[20:23], v[104:111], v1
    v_smfmac_f32_16x16x64_bf16 v[32:35], v[12:15], v[112:119], v1
    v_smfmac_f32_16x16x64_bf16 v[32:35], v[16:19], v[120:127], v1
    v_smfmac_f32_16x16x64_bf16 v[32:35], v[20:23], v[128:135], v1
    v_smfmac_f32_16x16x64_bf16 v[36:39], v[12:15], v[136:143], v1
    v_smfmac_f32_16x16x64_bf16 v[36:39], v[16:19], v[144:151], v1
    v_smfmac_f32_16x16x64_bf16 v[36:39], v[20:23], v[152:159], v1
    v_add_f32 v24, v24, v26
    s_nop 0
    v_add_f32 v28, v28, v30
    s_nop 1
    v_add_f32 v32, v32, v34
    v_max3_f32 v61, v24, v28, v32
    v_mov_b32_dpp v24, v28 quad_perm:[0,1,2,3] row_mask:0x2 bank_mask:0xf
    v_add_f32 v36, v36, v38
    v_max_f32 v61, v61, v36
    v_mov_b32_dpp v24, v32 quad_perm:[0,1,2,3] row_mask:0x4 bank_mask:0xf
    s_nop 0
    v_max_f32_dpp v61, v61, v61 row_ror:8 row_mask:0xf bank_mask:0xf
    s_nop 0
    v_mov_b32_dpp v24, v36 quad_perm:[0,1,2,3] row_mask:0x8 bank_mask:0xf
    v_max_f32_dpp v61, v61, v61 row_ror:4 row_mask:0xf bank_mask:0xf
    s_nop 1
    v_max_f32_dpp v61, v61, v61 row_ror:2 row_mask:0xf bank_mask:0xf
    s_nop 1
    v_max_f32_dpp v61, v61, v61 row_ror:1 row_mask:0xf bank_mask:0xf
    v_sub_f32 v36, v24, v61
    ds_write_b32 v59, v61
    v_exp_f32 v36, v36
    s_nop 0
    v_cvt_pk_bf16_f32 v39, v36, v36
    ds_write_b16 v58, v39
    ds_read_b128 v[12:15], v52
    ds_read_b128 v[16:19], v53
    ds_read_b128 v[20:23], v54
    ds_read_b128 v[24:27], v55
    ds_read_b128 v[28:31], v56
L_pad9:
    s_cbranch_execz L_pad13
    ds_read_b128 v[32:35], v57
    v_add_f32_dpp v38, v36, v36 row_ror:8 row_mask:0xf bank_mask:0xf
    s_nop 1
    v_add_f32_dpp v38, v38, v38 row_ror:4 row_mask:0xf bank_mask:0xf
    s_nop 1
    v_add_f32_dpp v38, v38, v38 row_ror:2 row_mask:0xf bank_mask:0xf
    s_nop 1
    v_add_f32_dpp v38, v38, v38 row_ror:1 row_mask:0xf bank_mask:0xf
    s_waitcnt lgkmcnt(5)
    v_smfmac_f32_16x16x64_bf16 v[40:43], v[12:15], v[160:167], v1
    v_add_f32_dpp v38, v38, v38 row_bcast:15 row_mask:0xa bank_mask:0xf
    v_smfmac_f32_16x16x64_bf16 v[44:47], v[12:15], v[208:215], v1
    s_waitcnt lgkmcnt(4)
    v_smfmac_f32_16x16x64_bf16 v[40:43], v[16:19], v[168:175], v1
    v_add_f32_dpp v38, v38, v38 row_bcast:31 row_mask:0xc bank_mask:0xf
    v_smfmac_f32_16x16x64_bf16 v[44:47], v[16:19], v[216:223], v1
    ds_read_b32 v36, v62
    s_waitcnt lgkmcnt(4)
    v_smfmac_f32_16x16x64_bf16 v[40:43], v[20:23], v[176:183], v1
    v_smfmac_f32_16x16x64_bf16 v[44:47], v[20:23], v[224:231], v1
    s_waitcnt lgkmcnt(0)
    v_max_f32_dpp v37, v36, v36 row_ror:4 row_mask:0xf bank_mask:0xf
    v_smfmac_f32_16x16x64_bf16 v[40:43], v[24:27], v[184:191], v1
    v_smfmac_f32_16x16x64_bf16 v[44:47], v[24:27], v[232:239], v1
    v_max_f32_dpp v37, v37, v37 row_ror:2 row_mask:0xf bank_mask:0xf
    v_smfmac_f32_16x16x64_bf16 v[40:43], v[28:31], v[192:199], v1
    v_cmp_eq_u32 vcc, -1, v36
    v_smfmac_f32_16x16x64_bf16 v[44:47], v[28:31], v[240:247], v1
    v_max_f32_dpp v37, v37, v37 row_ror:1 row_mask:0xf bank_mask:0xf
    v_smfmac_f32_16x16x64_bf16 v[40:43], v[32:35], v[200:207], v1
    v_sub_f32 v39, v61, v37
    v_smfmac_f32_16x16x64_bf16 v[44:47], v[32:35], v[248:255], v1
    v_exp_f32 v39, v39
    s_cbranch_vccnz L_mr_206
L_mk_207:
    v_mul_f32 v38, v38, v39
    ds_write_b32 v63, v38 offset:1024
    s_cmp_lt_u32 s30, 2
    s_nop 0
    v_pk_add_f32 v[40:41], v[40:41], v[42:43]
    s_nop 0
    v_pk_add_f32 v[42:43], v[44:45], v[46:47]
    v_pk_mul_f32 v[40:41], v[40:41], v[38:39] op_sel:[0,1] op_sel_hi:[1,1]
    v_pk_mul_f32 v[42:43], v[42:43], v[38:39] op_sel:[0,1] op_sel_hi:[1,1]
    ds_write_b128 v63, v[40:43]
    s_cbranch_scc1 L_comb_1
    s_waitcnt lgkmcnt(0)
    s_barrier
L_comb_1b:
    s_cmp_lt_u32 s3, 20
    s_cbranch_scc0 L_typeB_1
    s_mul_i32 s74, s30, 1664
    s_add_u32 s74, s74, s62
    s_add_u32 s74, s74, 26624
    v_and_b32 v56, 7, v0
    v_lshlrev_b32 v56, 2, v56
    v_lshrrev_b32 v62, 4, v0
    v_lshlrev_b32 v62, 3, v62
    buffer_load_dword v52, v56, s[40:43], s74 offen offset:1536 sc1
    buffer_load_dwordx2 v[54:55], v62, s[40:43], s74 offen offset:1536 sc1
    v_lshlrev_b32 v57, 4, v0
    v_lshlrev_b32 v58, 3, v0
    s_mul_i32 s57, s30, 6144
    s_add_u32 s57, s57, 30720
    v_lshrrev_b32 v59, 2, v0
    v_lshlrev_b32 v59, 6, v59
    v_bfe_u32 v53, v0, 4, 1
    v_lshl_add_u32 v59, v53, 5, v59
    v_and_b32 v53, 3, v0
    v_lshl_add_u32 v59, v53, 3, v59
    v_add_u32 v59, s57, v59
    v_xor_b32 v60, 32, v59
    s_lshl_b32 s57, s30, 8
    s_add_u32 s57, s57, 157696
    v_lshl_add_u32 v61, v0, 2, s57
    ds_read_b64_tr_b16 v[28:29], v59 offset:0
    ds_read_b64_tr_b16 v[30:31], v59 offset:1024
    ds_read_b64_tr_b16 v[32:33], v59 offset:2048
    ds_read_b64_tr_b16 v[34:35], v59 offset:3072
    ds_read_b64_tr_b16 v[36:37], v59 offset:4096
    ds_read_b64_tr_b16 v[38:39], v59 offset:5120
    ds_read_b64_tr_b16 v[40:41], v60 offset:0
L_pad10:
    s_cbranch_execz L_pad14
    ds_read_b64_tr_b16 v[42:43], v60 offset:1024
    ds_read_b64_tr_b16 v[44:45], v60 offset:2048
    ds_read_b64_tr_b16 v[46:47], v60 offset:3072
    ds_read_b64_tr_b16 v[48:49], v60 offset:4096
    ds_read_b64_tr_b16 v[50:51], v60 offset:5120
    v_mov_b64 v[20:21], 0
    v_mov_b64 v[22:23], 0
    v_mov_b64 v[24:25], 0
    v_mov_b64 v[26:27], 0
    s_add_u32 s58, s6, 132096
    s_branch L_pw_214
L_pr_215:
    buffer_load_dword v52, v56, s[40:43], s74 offen offset:1536 sc1
    buffer_load_dwordx2 v[54:55], v62, s[40:43], s74 offen offset:1536 sc1
    s_sub_u32 s56, s56, 1
    s_cbranch_scc1 L_done
L_pw_214:
    s_waitcnt vmcnt(0)
    v_max3_u32 v53, v52, v54, v55
    v_cmp_eq_u32 vcc, -1, v53
    s_cbranch_vccnz L_pr_215
    buffer_load_dwordx4 v[12:15], v57, s[40:43], s74 offen sc1
    buffer_load_dwordx2 v[16:17], v58, s[40:43], s74 offen offset:1024 sc1
    buffer_load_dword v18, v56, s[40:43], s74 offen offset:1568 sc1
    v_max_f32_dpp v53, v52, v52 row_ror:4 row_mask:0xf bank_mask:0xf
    s_nop 1
    v_max_f32_dpp v53, v53, v53 row_ror:2 row_mask:0xf bank_mask:0xf
    s_nop 1
    v_max_f32_dpp v53, v53, v53 row_ror:1 row_mask:0xf bank_mask:0xf
    v_sub_f32 v52, v52, v53
    v_sub_f32 v54, v54, v53
    v_sub_f32 v55, v55, v53
    v_exp_f32 v52, v52
    v_exp_f32 v54, v54
    v_exp_f32 v55, v55
    s_waitcnt lgkmcnt(0)
    s_branch L_pw_216
L_pr_217:
    buffer_load_dwordx4 v[12:15], v57, s[40:43], s74 offen sc1
    buffer_load_dwordx2 v[16:17], v58, s[40:43], s74 offen offset:1024 sc1
    buffer_load_dword v18, v56, s[40:43], s74 offen offset:1568 sc1
    s_sub_u32 s56, s56, 1
    s_cbranch_scc1 L_done
L_pw_216:
    s_waitcnt vmcnt(0)
    v_max3_u32 v19, v12, v13, v14
    v_max3_u32 v19, v19, v15, v16
    v_max3_u32 v19, v19, v17, v18
    v_cmp_eq_u32 vcc, -1, v19
    s_cbranch_vccnz L_pr_217
    v_smfmac_f32_16x16x64_bf16 v[20:23], v[12:15], v[28:35], v1
    v_mul_f32 v52, v52, v18
    v_smfmac_f32_16x16x64_bf16 v[24:27], v[12:15], v[40:47], v1
    v_smfmac_f32_16x16x32_bf16 v[20:23], v[16:17], v[36:39], v1
    v_add_f32_dpp v52, v52, v52 row_ror:4 row_mask:0xf bank_mask:0xf
    v_smfmac_f32_16x16x32_bf16 v[24:27], v[16:17], v[48:51], v1
    s_cmp_eq_u32 s30, 2
    v_add_f32_dpp v52, v52, v52 row_ror:2 row_mask:0xf bank_mask:0xf
    s_nop 1
    v_add_f32_dpp v52, v52, v52 row_ror:1 row_mask:0xf bank_mask:0xf
    v_rcp_f32 v52, v52
    v_pk_add_f32 v[20:21], v[20:21], v[22:23]
    s_nop 0
    v_pk_add_f32 v[24:25], v[24:25], v[26:27]
    v_pk_mul_f32 v[54:55], v[54:55], v[52:53] op_sel:[0,0] op_sel_hi:[1,0]
    v_mul_f32 v20, v20, v54
    v_mul_f32 v24, v24, v54
    v_fmac_f32 v20, v21, v55
    v_fmac_f32 v24, v25, v55
    s_nop 1
    v_permlane32_swap_b32 v20, v24
    v_add_f32 v20, v20, v24
    ds_write_b32 v61, v20
    s_waitcnt lgkmcnt(0)
    s_barrier
    s_cbranch_scc0 L_finb_218
    ds_read2st64_b32 v[12:13], v2 offset0:0 offset1:1
    ds_read2st64_b32 v[14:15], v2 offset0:2 offset1:3
    ds_read2st64_b32 v[16:17], v2 offset0:4 offset1:5
    ds_read2st64_b32 v[18:19], v2 offset0:6 offset1:7
    s_waitcnt lgkmcnt(2)
    v_pk_add_f32 v[12:13], v[12:13], v[14:15]
    s_waitcnt lgkmcnt(0)
    v_pk_add_f32 v[16:17], v[16:17], v[18:19]
    v_pk_add_f32 v[12:13], v[12:13], v[16:17]
    v_add_f32 v14, v12, v13
    v_add_f32 v15, v12, v13
    s_nop 1
    v_permlane16_swap_b32 v14, v15
    v_add_f32 v12, v14, v15
    v_min_u32 v12, -2, v12
    buffer_store_dword v12, v3, s[40:43], s58 offen sc1
L_finb_218:
L_pad11:
    s_cbranch_execz L_pad15
    s_sub_u32 s57, s30, 4
    s_cmp_lt_u32 s57, 3
    s_cbranch_scc0 L_skip_219
    s_sub_u32 s60, s30, 4
    s_lshl_b32 s57, s60, 11
    v_lshlrev_b32 v11, 4, v0
    v_add_u32 v11, s57, v11
    s_add_u32 s65, s62, 19456
    buffer_load_dwordx4 v[52:55], v11, s[40:43], s65 offen offset:0 sc1
    buffer_load_dwordx4 v[56:59], v11, s[40:43], s65 offen offset:1024 sc1
    s_lshl_b32 s59, s60, 12
    s_add_u32 s59, s59, 79872
    v_bfe_u32 v35, v0, 4, 1
    v_lshlrev_b32 v35, 11, v35
    v_bfe_u32 v60, v0, 2, 2
    v_lshl_add_u32 v35, v60, 8, v35
    v_lshrrev_b32 v60, 5, v0
    v_lshl_add_u32 v35, v60, 6, v35
    v_and_b32 v60, 3, v0
    v_lshl_add_u32 v35, v60, 3, v35
    v_add_u32 v35, s59, v35
    v_mov_b32 v9, 0xbdd2d3e8
    v_mov_b32 v10, 0xc0135761
    s_lshl_b32 s57, s60, 7
    s_add_u32 s57, s57, 160256
    v_lshlrev_b32 v32, 3, v0
    v_add_u32 v32, s57, v32
    v_lshlrev_b32 v33, 3, v0
    v_add_u32 v33, 129024, v33
    v_cmp_gt_u32 vcc, 16, v0
    s_nop 1
    v_cndmask_b32 v32, v33, v32, vcc
    v_and_b32 v33, 15, v0
    v_lshlrev_b32 v33, 3, v33
    v_lshrrev_b32 v60, 5, v0
    v_lshl_add_u32 v33, v60, 2, v33
    v_add_u32 v33, 160256, v33
    v_and_b32 v34, 15, v0
    v_lshlrev_b32 v34, 2, v34
    v_lshrrev_b32 v60, 5, v0
    v_lshl_add_u32 v34, v60, 6, v34
    v_bfe_u32 v60, v0, 4, 1
    v_lshl_add_u32 v34, v60, 13, v34
    s_add_u32 s60, s6, 198144
    s_add_u32 s58, s62, 39936
    s_add_u32 s57, s62, 25984
    v_and_b32 v7, 7, v0
    v_lshlrev_b32 v7, 3, v7
    v_mov_b32 v60, 0x3acccccd
    v_mov_b32 v61, 0x3727c5ac
    s_waitcnt vmcnt(0)
    buffer_load_dwordx2 v[24:25], v7, s[40:43], s57 offen sc1
    buffer_load_dwordx4 v[12:15], v11, s[40:43], s58 offen offset:0 sc1
    buffer_load_dwordx4 v[16:19], v11, s[40:43], s58 offen offset:1024 sc1
    ds_read_b64_tr_b16 v[36:37], v35 offset:0
    ds_read_b64_tr_b16 v[38:39], v35 offset:1024
    ds_read_b64_tr_b16 v[40:41], v35 offset:128
    ds_read_b64_tr_b16 v[42:43], v35 offset:1152
    ds_read_b64_tr_b16 v[44:45], v35 offset:32
    ds_read_b64_tr_b16 v[46:47], v35 offset:1056
    ds_read_b64_tr_b16 v[48:49], v35 offset:160
    ds_read_b64_tr_b16 v[50:51], v35 offset:1184
L_sw_222:
    v_max3_u32 v20, v52, v53, v54
    v_max3_u32 v20, v20, v55, v56
    v_max3_u32 v20, v20, v57, v58
    v_max_u32 v20, v20, v59
    v_cmp_eq_u32 vcc, -1, v20
    s_cbranch_vccnz L_sr_223
    v_pk_add_f32 v[28:29], v[52:53], v[56:57]
    v_pk_add_f32 v[30:31], v[54:55], v[58:59]
    s_nop 1
    v_permlane32_swap_b32 v28, v30
    v_permlane32_swap_b32 v29, v31
    v_pk_add_f32 v[28:29], v[28:29], v[30:31]
    s_nop 1
    v_permlane16_swap_b32 v28, v29
    v_add_f32 v28, v28, v29
    v_mov_b64 v[52:53], 0
    v_mov_b64 v[54:55], 0
    v_mov_b64 v[56:57], 0
    v_mov_b64 v[58:59], 0
    s_waitcnt lgkmcnt(0)
L_pr_221:
    buffer_load_dwordx2 v[24:25], v7, s[40:43], s57 offen sc1
    buffer_load_dwordx4 v[12:15], v11, s[40:43], s58 offen offset:0 sc1
L_pad12:
    s_cbranch_execz L_pad16
    buffer_load_dwordx4 v[16:19], v11, s[40:43], s58 offen offset:1024 sc1
    s_sub_u32 s56, s56, 1
    s_cbranch_scc1 L_done
L_pw_220:
    s_waitcnt vmcnt(3)
    v_max_u32 v20, v24, v25
    v_cmp_eq_u32 vcc, -1, v20
    s_cbranch_vccnz L_pr_221
    buffer_load_dwordx4 v[12:15], v11, s[40:43], s58 offen offset:0 sc1
    buffer_load_dwordx4 v[16:19], v11, s[40:43], s58 offen offset:1024 sc1
    v_add_f32_dpp v2, v24, v24 row_ror:4 row_mask:0xf bank_mask:0xf
    v_add_f32_dpp v3, v25, v25 row_ror:4 row_mask:0xf bank_mask:0xf
    v_pk_add_f32 v[20:21], v[12:13], v[16:17]
    v_pk_add_f32 v[22:23], v[14:15], v[18:19]
    v_add_f32_dpp v2, v2, v2 row_ror:2 row_mask:0xf bank_mask:0xf
    v_add_f32_dpp v3, v3, v3 row_ror:2 row_mask:0xf bank_mask:0xf
    v_permlane32_swap_b32 v20, v22
    v_permlane32_swap_b32 v21, v23
    v_add_f32_dpp v2, v2, v2 row_ror:1 row_mask:0xf bank_mask:0xf
    v_add_f32_dpp v3, v3, v3 row_ror:1 row_mask:0xf bank_mask:0xf
    v_pk_add_f32 v[20:21], v[20:21], v[22:23]
    v_mul_f32 v2, v2, v60
    v_fma_f32 v3, v3, v60, v61
    v_permlane16_swap_b32 v20, v21
    v_fma_f32 v3, -v2, v2, v3
    v_add_f32 v20, v20, v21
    v_max_f32 v3, v3, v61
    v_mul_f32 v26, v28, v2
    v_rsq_f32 v3, v3
    v_cmp_u_f32 vcc, v20, v20
    v_sub_f32 v20, v20, v26
    s_cbranch_vccnz L_hr_224
L_hk_225:
    v_fma_f32 v20, v20, v3, v4
    v_mul_f32 v21, v20, v20
    v_fma_f32 v21, v21, v9, v10
    v_mul_f32 v21, v21, v20
    v_exp_f32 v21, v21
    s_nop 0
    v_add_f32 v21, 1.0, v21
    v_rcp_f32 v21, v21
    s_nop 0
    v_mul_f32 v20, v20, v21
    s_nop 1
    v_mov_b32_dpp v21, v20 row_shl:1 row_mask:0xf bank_mask:0xf bound_ctrl:0
    v_cvt_pk_bf16_f32 v28, v20, v21
    s_nop 1
    v_mov_b32_dpp v29, v28 row_shl:4 row_mask:0xf bank_mask:0xf bound_ctrl:0
    v_mov_b32_dpp v30, v28 row_shl:8 row_mask:0xf bank_mask:0xf bound_ctrl:0
    v_mov_b32_dpp v31, v28 row_shl:12 row_mask:0xf bank_mask:0xf bound_ctrl:0
    s_nop 1
    v_smfmac_f32_16x16x64_bf16 v[52:55], v[28:31], v[36:43], v1
    v_smfmac_f32_16x16x64_bf16 v[56:59], v[28:31], v[44:51], v1
    s_cmp_eq_u32 s30, 4
    s_nop 5
    v_add_f32 v22, v52, v54
    v_add_f32 v23, v56, v58
    ds_write_b64 v32, v[22:23]
    s_cbranch_scc0 L_skip_227
L_xw_228:
    ds_read2_b32 v[20:21], v33 offset0:0 offset1:32
    ds_read_b32 v22, v33 offset:256
    s_sub_u32 s56, s56, 1
    s_cbranch_scc1 L_done
    s_waitcnt lgkmcnt(0)
    v_max3_u32 v23, v20, v21, v22
    v_add_f32 v20, v20, v21
    v_cmp_eq_u32 vcc, -1, v23
    v_add_f32 v20, v20, v22
    s_cbranch_vccnz L_xw_228
    v_min_u32 v20, -2, v20
    buffer_store_dword v20, v34, s[40:43], s60 offen sc1
L_skip_227:
L_skip_219:
    s_branch L_done
L_typeB_1:
    s_cmp_eq_u32 s53, 3
    s_cbranch_scc0 L_typeC_229
    s_cmp_eq_u32 s30, 7
    s_cbranch_scc1 L_w7_234
    s_cmp_lt_u32 s30, 6
    s_cbranch_scc0 L_skip_236
    s_lshr_b32 s57, s30, 1
    s_mul_i32 s57, s57, 128
    s_and_b32 s58, s30, 1
    s_lshl_b32 s58, s58, 6
    s_add_u32 s57, s57, s58
    v_lshrrev_b32 v18, 5, v0
    v_lshlrev_b32 v18, 13, v18
    v_bfe_u32 v60, v0, 3, 1
    v_lshl_add_u32 v18, v60, 12, v18
    v_bfe_u32 v60, v0, 4, 1
    v_lshl_add_u32 v18, v60, 11, v18
    v_bfe_u32 v60, v0, 2, 1
    v_mul_u32_u24 v60, 384, v60
    v_add_u32 v18, v60, v18
    v_and_b32 v60, 3, v0
    v_lshl_add_u32 v18, v60, 3, v18
L_pad13:
    s_cbranch_execz L_pad17
    v_add_u32 v18, s57, v18
    v_add_u32 v18, 30720, v18
    v_bfe_u32 v19, v0, 4, 1
    v_lshlrev_b32 v19, 12, v19
    v_bfe_u32 v60, v0, 3, 1
    v_lshl_add_u32 v19, v60, 11, v19
    v_bfe_u32 v60, v0, 2, 1
    v_mul_u32_u24 v60, 384, v60
    v_add_u32 v19, v60, v19
    v_and_b32 v60, 3, v0
    v_lshl_add_u32 v19, v60, 3, v19
    v_add_u32 v19, s57, v19
    v_add_u32 v19, 63488, v19
    ds_read_b64_tr_b16 v[28:29], v18 offset:0
    ds_read_b64_tr_b16 v[30:31], v18 offset:1024
    ds_read_b64_tr_b16 v[32:33], v18 offset:16384
    ds_read_b64_tr_b16 v[34:35], v18 offset:17408
    ds_read_b64_tr_b16 v[36:37], v19 offset:0
    ds_read_b64_tr_b16 v[38:39], v19 offset:1024
    ds_read_b64_tr_b16 v[40:41], v18 offset:32
    ds_read_b64_tr_b16 v[42:43], v18 offset:1056
    ds_read_b64_tr_b16 v[44:45], v18 offset:16416
    ds_read_b64_tr_b16 v[46:47], v18 offset:17440
    ds_read_b64_tr_b16 v[48:49], v19 offset:32
    ds_read_b64_tr_b16 v[50:51], v19 offset:1056
    v_lshrrev_b32 v9, 4, v0
    v_lshlrev_b32 v9, 5, v9
    v_bfe_u32 v60, v0, 1, 1
    v_lshl_add_u32 v9, v60, 4, v9
    v_and_b32 v60, 1, v0
    v_mul_u32_u24 v60, 192, v60
    v_add_u32 v9, v60, v9
    v_add_u32 v9, 160832, v9
    v_lshrrev_b32 v10, 4, v0
    v_lshlrev_b32 v10, 4, v10
    v_bfe_u32 v60, v0, 1, 1
    v_lshl_add_u32 v10, v60, 3, v10
    v_and_b32 v60, 1, v0
    v_mul_u32_u24 v60, 192, v60
    v_add_u32 v10, v60, v10
    v_add_u32 v10, 160960, v10
    v_mov_b64 v[20:21], 0
    v_mov_b64 v[22:23], 0
    v_mov_b64 v[24:25], 0
    v_mov_b64 v[26:27], 0
    s_lshr_b32 s57, s30, 1
    s_lshl_b32 s57, s57, 11
    s_lshl_b32 s58, s58, 1
    s_add_u32 s57, s57, s58
    s_lshl_b32 s58, s54, 8
    s_add_u32 s57, s57, s58
    v_and_b32 v11, 31, v0
    v_lshlrev_b32 v11, 2, v11
    v_lshrrev_b32 v60, 5, v0
    v_lshl_add_u32 v11, v60, 30, v11
    v_add_u32 v11, s57, v11
    s_add_u32 s59, s62, 39936
    s_add_u32 s60, s62, 25984
L_skip_236:
    s_cmp_lt_u32 s30, 6
    s_barrier
    s_cbranch_scc0 L_se_235
    ds_read_b128 v[12:15], v9
    ds_read_b64 v[16:17], v10
    s_waitcnt lgkmcnt(1)
    v_smfmac_f32_16x16x64_bf16 v[20:23], v[12:15], v[28:35], v1
    v_smfmac_f32_16x16x64_bf16 v[24:27], v[12:15], v[40:47], v1
    s_waitcnt lgkmcnt(0)
    v_smfmac_f32_16x16x32_bf16 v[20:23], v[16:17], v[36:39], v1
    v_smfmac_f32_16x16x32_bf16 v[24:27], v[16:17], v[48:51], v1
    s_cmp_eq_u32 s55, 0
    s_nop 5
    v_add_f32 v12, v20, v22
    s_nop 1
    v_add_f32_dpp v12, v24, v26 quad_perm:[0,1,2,3] row_mask:0x2 bank_mask:0xf
    v_min_u32 v12, -2, v12
    s_cbranch_scc1 L_gs_237
    buffer_store_dword v12, v11, s[40:43], s59 offen
L_gb_238:
L_se_235:
    s_cmp_eq_u32 s30, 7
    s_cbranch_scc0 L_done
    s_cmp_eq_u32 s31, 0
    s_cbranch_scc0 L_done
    v_lshlrev_b32 v60, 16, v4
    v_add_f32 v2, v2, v60
    v_and_b32 v60, 0xffff0000, v4
    v_add_f32 v3, v3, v60
    v_and_b32 v60, 31, v0
L_pad14:
    s_cbranch_execz L_pad18
    v_min_u32 v60, 19, v60
    s_mul_i32 s57, s54, 160
    v_lshrrev_b32 v7, 5, v0
    v_lshlrev_b32 v7, 2, v7
    v_add_u32 v7, s57, v7
    v_lshl_add_u32 v7, v60, 3, v7
    s_add_u32 s57, s7, 198144
    s_add_u32 s58, s7, 214528
    s_add_u32 s59, s7, 230912
    s_add_u32 s60, s7, 247296
    s_add_u32 s75, s7, 266252
    v_and_b32 v9, 7, v0
    v_lshlrev_b32 v9, 9, v9
    buffer_load_dword v12, v9, s[40:43], s75 offen sc1
    s_sleep 2
L_pr_250:
    buffer_load_dword v12, v9, s[40:43], s75 offen sc1
    s_sub_u32 s56, s56, 1
    s_cbranch_scc1 L_done
L_pw_249:
    s_waitcnt vmcnt(1)
    v_cmp_eq_u32 vcc, -1, v12
    s_cbranch_vccnz L_pr_250
    s_sleep 2
    buffer_load_dwordx4 v[12:15], v5, s[40:43], s57 offen sc1
    buffer_load_dwordx4 v[16:19], v5, s[40:43], s58 offen sc1
    buffer_load_dwordx4 v[20:23], v5, s[40:43], s59 offen sc1
    buffer_load_dwordx4 v[24:27], v5, s[40:43], s60 offen sc1
    s_sleep 2
L_gw_246:
    buffer_load_dwordx4 v[12:15], v5, s[40:43], s57 offen sc1
    buffer_load_dwordx4 v[16:19], v5, s[40:43], s58 offen sc1
    buffer_load_dwordx4 v[20:23], v5, s[40:43], s59 offen sc1
    buffer_load_dwordx4 v[24:27], v5, s[40:43], s60 offen sc1
    s_sub_u32 s56, s56, 1
    s_cbranch_scc1 L_done
    s_and_b32 s74, s56, 31
    s_waitcnt vmcnt(6)
    v_pk_add_f32 v[28:29], v[12:13], v[16:17]
    v_pk_add_f32 v[30:31], v[14:15], v[18:19]
    s_waitcnt vmcnt(5)
    v_pk_add_f32 v[28:29], v[28:29], v[20:21]
    v_pk_add_f32 v[30:31], v[30:31], v[22:23]
    s_waitcnt vmcnt(4)
    v_pk_add_f32 v[28:29], v[28:29], v[24:25]
    v_pk_add_f32 v[30:31], v[30:31], v[26:27]
    v_pk_add_f32 v[32:33], v[28:29], v[30:31]
    v_cmp_u_f32 vcc, v32, v33
    v_permlane32_swap_b32 v28, v30
    v_permlane32_swap_b32 v29, v31
    s_cbranch_vccnz L_gr_247
L_gk_248:
    v_pk_add_f32 v[28:29], v[28:29], v[30:31]
    v_pk_add_f32 v[28:29], v[28:29], v[2:3]
    v_cvt_pk_bf16_f32 v28, v28, v29
    global_store_dword v7, v28, s[24:25]
    s_branch L_done
L_gs_42:
    buffer_store_dword v33, v34, s[40:43], s67 offen sc1
    s_branch L_gb_43
L_gs_45:
    buffer_store_dword v12, v54, s[40:43], s59 offen sc1
    s_branch L_gb_46
L_cr_60:
    s_sub_u32 s56, s56, 1
    s_cbranch_scc1 L_done
    global_load_dword v2, v3, s[26:27] sc1
    s_waitcnt vmcnt(0)
    s_branch L_cw_59
L_far_61:
    s_lshl_b32 s57, s52, 2
    s_add_u32 s57, s57, s72
    s_mov_b64 exec, 1
    buffer_store_dword v25, v0, s[40:43], s57 offen offset:128 sc1
    s_mov_b64 exec, -1
    s_branch L_fb_62
L_cr_78:
    s_sub_u32 s56, s56, 1
    s_cbranch_scc1 L_done
    buffer_load_dword v2, v24, s[40:43], s72 offen sc1
    s_branch L_cw_77
L_gs_86:
    buffer_store_dword v33, v34, s[40:43], s67 offen sc1
    s_branch L_gb_87
L_gs_89:
    buffer_store_dword v12, v54, s[40:43], s59 offen sc1
    s_branch L_gb_90
L_gs_109:
    buffer_store_dword v37, v4, s[40:43], s58 offen sc1
    s_branch L_gb_110
L_cr_123:
    s_sub_u32 s56, s56, 1
    s_cbranch_scc1 L_done
    global_load_dword v2, v3, s[26:27] offset:4 sc1
    s_branch L_cw_122
L_cr_133:
    buffer_load_dword v52, v56, s[40:43], s74 offen offset:1536 sc1
    buffer_load_dwordx2 v[54:55], v62, s[40:43], s74 offen offset:1536 sc1
    s_sub_u32 s56, s56, 1
    s_cbranch_scc1 L_done
    s_branch L_cw_132
L_gs_138:
    buffer_store_dword v14, v3, s[40:43], s57 offen sc1
L_pad15:
    s_cbranch_execz L_pad19
    s_branch L_gb_139
L_gs_140:
    buffer_store_dword v12, v4, s[40:43], s57 offen offset:32 sc1
    s_branch L_gb_141
L_comb_0:
    s_mov_b32 s57, 0
    s_cmp_eq_u32 s55, 0
    s_waitcnt lgkmcnt(0)
    s_barrier
    ds_read2st64_b64 v[12:15], v2 offset0:0 offset1:4
    ds_read2st64_b64 v[16:19], v2 offset0:8 offset1:12
    ds_read2st64_b64 v[20:23], v2 offset0:16 offset1:20
    ds_read2st64_b64 v[24:27], v2 offset0:24 offset1:28
    s_waitcnt lgkmcnt(2)
    v_pk_add_f32 v[12:13], v[12:13], v[14:15]
    v_pk_add_f32 v[16:17], v[16:17], v[18:19]
    v_pk_add_f32 v[12:13], v[12:13], v[16:17]
    s_waitcnt lgkmcnt(0)
    v_pk_add_f32 v[20:21], v[20:21], v[22:23]
    v_pk_add_f32 v[24:25], v[24:25], v[26:27]
    v_pk_add_f32 v[12:13], v[12:13], v[20:21]
    v_pk_add_f32 v[12:13], v[12:13], v[24:25]
    v_cvt_pk_bf16_f32 v14, v12, v13
    v_min_u32 v12, -2, v12
    v_min_u32 v14, -2, v14
    s_cbranch_scc1 L_gs_138
    buffer_store_dword v14, v3, s[40:43], s57 offen
L_gb_139:
    s_cbranch_scc1 L_gs_140
    buffer_store_dword v12, v4, s[40:43], s57 offen offset:32
L_gb_141:
    s_branch L_comb_0b
L_sr_150:
    buffer_load_dwordx4 v[52:55], v11, s[40:43], s65 offen offset:0 sc1
    buffer_load_dwordx4 v[56:59], v11, s[40:43], s65 offen offset:1024 sc1
    s_sub_u32 s56, s56, 1
    s_cbranch_scc1 L_done
    s_waitcnt vmcnt(0)
    s_branch L_sw_149
L_hr_151:
    buffer_load_dwordx4 v[12:15], v11, s[40:43], s58 offen offset:0 sc1
    buffer_load_dwordx4 v[16:19], v11, s[40:43], s58 offen offset:1024 sc1
    s_sub_u32 s56, s56, 1
    s_cbranch_scc1 L_done
    s_and_b32 s64, s56, 31
    s_cbranch_scc0 L_hx_153
    s_waitcnt vmcnt(2)
    v_pk_add_f32 v[20:21], v[12:13], v[16:17]
    v_pk_add_f32 v[22:23], v[14:15], v[18:19]
    s_nop 1
    v_permlane32_swap_b32 v20, v22
    v_permlane32_swap_b32 v21, v23
    v_pk_add_f32 v[20:21], v[20:21], v[22:23]
    s_nop 1
    v_permlane16_swap_b32 v20, v21
    v_add_f32 v20, v20, v21
    v_cmp_u_f32 vcc, v20, v20
    v_sub_f32 v20, v20, v26
    s_cbranch_vccnz L_hr_151
    s_branch L_hk_152
L_hx_153:
    s_waitcnt vmcnt(0)
    v_max3_u32 v20, v12, v13, v14
    v_max3_u32 v20, v20, v15, v16
    v_max3_u32 v20, v20, v17, v18
    v_max_u32 v20, v20, v19
    v_cmp_eq_u32 vcc, -1, v20
    s_cbranch_vccnz L_hr_151
    v_pk_add_f32 v[20:21], v[12:13], v[16:17]
    v_pk_add_f32 v[22:23], v[14:15], v[18:19]
    s_nop 1
    v_permlane32_swap_b32 v20, v22
    v_permlane32_swap_b32 v21, v23
    v_pk_add_f32 v[20:21], v[20:21], v[22:23]
    s_nop 1
    v_permlane16_swap_b32 v20, v21
    v_add_f32 v20, v20, v21
    v_sub_f32 v20, v20, v26
    s_branch L_hk_152
L_gs_161:
    buffer_store_dword v0, v11, s[40:43], s58 offen sc1
    s_branch L_gb_162
L_typeC_157:
    s_cmp_eq_u32 s30, 6
    s_cbranch_scc0 L_p1
    s_cmp_eq_u32 s3, 21
    s_cbranch_scc0 L_skip_158
    v_and_b32 v11, 3, v0
    v_lshlrev_b32 v11, 7, v11
    v_lshrrev_b32 v60, 2, v0
    v_lshl_add_u32 v11, v60, 24, v11
    s_add_u32 s58, s62, 26116
    s_add_u32 s75, s7, 266244
    v_and_b32 v9, 7, v0
    v_lshlrev_b32 v9, 9, v9
    buffer_load_dword v12, v9, s[40:43], s75 offen sc1
    s_sleep 2
L_pr_160:
    buffer_load_dword v12, v9, s[40:43], s75 offen sc1
    s_sub_u32 s56, s56, 1
    s_cbranch_scc1 L_done
L_pw_159:
    s_waitcnt vmcnt(1)
L_pad16:
    s_cbranch_execz L_pad20
    v_cmp_eq_u32 vcc, -1, v12
    s_cbranch_vccnz L_pr_160
    s_cmp_eq_u32 s55, 0
    s_cbranch_scc1 L_gs_161
    buffer_store_dword v0, v11, s[40:43], s58 offen
L_gb_162:
    s_waitcnt vmcnt(1)
    s_branch L_p1
L_skip_158:
    s_cmp_eq_u32 s3, 20
    s_cbranch_scc0 L_p1
    s_lshl_b32 s59, s31, 9
    s_add_u32 s59, s59, s8
    s_add_u32 s59, s59, 266240
    v_and_b32 v10, 1, v0
    v_lshlrev_b32 v10, 13, v10
    v_lshrrev_b32 v60, 1, v0
    v_lshl_add_u32 v10, v60, 24, v10
    s_add_u32 s58, s62, 1568
    v_lshrrev_b32 v9, 3, v0
    v_mul_u32_u24 v9, 1664, v9
    v_and_b32 v60, 7, v0
    v_lshl_add_u32 v9, v60, 2, v9
    buffer_load_dword v12, v9, s[40:43], s58 offen sc1
    s_sleep 2
L_pr_164:
    buffer_load_dword v12, v9, s[40:43], s58 offen sc1
    s_sub_u32 s56, s56, 1
    s_cbranch_scc1 L_done
L_pw_163:
    s_waitcnt vmcnt(1)
    v_cmp_eq_u32 vcc, -1, v12
    s_cbranch_vccnz L_pr_164
    buffer_store_dword v0, v10, s[40:43], s59 offen offset:0 sc1
    s_add_u32 s58, s62, 25856
    v_and_b32 v9, 15, v0
    v_lshlrev_b32 v9, 2, v9
    buffer_load_dword v13, v9, s[40:43], s58 offen sc1
    s_sleep 2
L_pr_166:
    buffer_load_dword v13, v9, s[40:43], s58 offen sc1
    s_sub_u32 s56, s56, 1
    s_cbranch_scc1 L_done
L_pw_165:
    s_waitcnt vmcnt(1)
    v_cmp_eq_u32 vcc, -1, v13
    s_cbranch_vccnz L_pr_166
    buffer_store_dword v0, v10, s[40:43], s59 offen offset:4 sc1
    s_waitcnt vmcnt(1)
    s_branch L_p1
L_gs_170:
    buffer_store_dword v12, v11, s[40:43], s60 offen sc1
    s_branch L_gb_171
L_gs_172:
    buffer_store_dword v12, v11, s[40:43], s59 offen sc1
    s_branch L_gb_173
L_gr_175:
    s_cbranch_scc1 L_gw_174
    s_waitcnt vmcnt(0)
    v_max3_u32 v32, v12, v13, v14
    v_max3_u32 v32, v32, v15, v16
    v_max3_u32 v32, v32, v17, v18
    v_max3_u32 v32, v32, v19, v20
    v_max3_u32 v32, v32, v21, v22
    v_max3_u32 v32, v32, v23, v24
    v_max3_u32 v32, v32, v25, v26
    v_max_u32 v32, v32, v27
    v_cmp_eq_u32 vcc, -1, v32
    s_cbranch_vccnz L_gw_174
    v_pk_add_f32 v[28:29], v[12:13], v[16:17]
    v_pk_add_f32 v[30:31], v[14:15], v[18:19]
    v_pk_add_f32 v[28:29], v[28:29], v[20:21]
    v_pk_add_f32 v[30:31], v[30:31], v[22:23]
    v_pk_add_f32 v[28:29], v[28:29], v[24:25]
    v_pk_add_f32 v[30:31], v[30:31], v[26:27]
    s_nop 1
    v_permlane32_swap_b32 v28, v30
    v_permlane32_swap_b32 v29, v31
    s_branch L_gk_176
L_gs_179:
    buffer_store_dword v33, v34, s[40:43], s67 offen sc1
    s_branch L_gb_180
L_w7_167:
    v_and_b32 v60, 31, v0
    v_min_u32 v60, 19, v60
    s_mul_i32 s57, s54, 320
    v_lshrrev_b32 v5, 5, v0
    v_lshlrev_b32 v5, 12, v5
    v_add_u32 v5, s57, v5
    v_lshl_add_u32 v5, v60, 4, v5
    v_and_b32 v60, 31, v0
    v_cmp_gt_u32 s[64:65], 20, v60
    v_min_u32 v60, 19, v60
    v_lshrrev_b32 v35, 5, v0
    v_lshlrev_b32 v35, 2, v35
    v_add_u32 v35, 160832, v35
    v_lshl_add_u32 v35, v60, 3, v35
    s_add_u32 s66, s62, 13312
    s_add_u32 s67, s62, 25856
    s_lshl_b32 s57, s54, 3
    v_lshrrev_b32 v34, 5, v0
    v_lshlrev_b32 v34, 2, v34
L_pad17:
    s_cbranch_execz L_pad21
    v_add_u32 v34, s57, v34
    v_and_b32 v60, 31, v0
    v_mov_b32 v61, 0x7f000000
    v_cmp_ne_u32 vcc, 31, v60
    s_nop 1
    v_cndmask_b32 v34, v34, v61, vcc
    v_mov_b32 v61, 0x3f803f80
    s_add_u32 s57, s7, 0
    s_add_u32 s58, s7, 16384
    s_add_u32 s59, s7, 32768
    s_add_u32 s60, s7, 49152
    s_add_u32 s75, s7, 266240
    v_and_b32 v9, 7, v0
    v_lshlrev_b32 v9, 9, v9
    buffer_load_dword v12, v9, s[40:43], s75 offen sc1
    s_sleep 2
L_pr_178:
    buffer_load_dword v12, v9, s[40:43], s75 offen sc1
    s_sub_u32 s56, s56, 1
    s_cbranch_scc1 L_done
L_pw_177:
    s_waitcnt vmcnt(1)
    v_cmp_eq_u32 vcc, -1, v12
    s_cbranch_vccnz L_pr_178
    s_sleep 1
    buffer_load_dwordx4 v[12:15], v5, s[40:43], s57 offen sc1
    buffer_load_dwordx4 v[16:19], v5, s[40:43], s58 offen sc1
    buffer_load_dwordx4 v[20:23], v5, s[40:43], s59 offen sc1
    buffer_load_dwordx4 v[24:27], v5, s[40:43], s60 offen sc1
    s_sleep 2
L_gw_174:
    buffer_load_dwordx4 v[12:15], v5, s[40:43], s57 offen sc1
    buffer_load_dwordx4 v[16:19], v5, s[40:43], s58 offen sc1
    buffer_load_dwordx4 v[20:23], v5, s[40:43], s59 offen sc1
    buffer_load_dwordx4 v[24:27], v5, s[40:43], s60 offen sc1
    s_sub_u32 s56, s56, 1
    s_cbranch_scc1 L_done
    s_and_b32 s74, s56, 31
    s_waitcnt vmcnt(6)
    v_pk_add_f32 v[28:29], v[12:13], v[16:17]
    v_pk_add_f32 v[30:31], v[14:15], v[18:19]
    s_waitcnt vmcnt(5)
    v_pk_add_f32 v[28:29], v[28:29], v[20:21]
    v_pk_add_f32 v[30:31], v[30:31], v[22:23]
    s_waitcnt vmcnt(4)
    v_pk_add_f32 v[28:29], v[28:29], v[24:25]
    v_pk_add_f32 v[30:31], v[30:31], v[26:27]
    v_pk_add_f32 v[32:33], v[28:29], v[30:31]
    v_cmp_u_f32 vcc, v32, v33
    v_permlane32_swap_b32 v28, v30
    v_permlane32_swap_b32 v29, v31
    s_cbranch_vccnz L_gr_175
L_gk_176:
    v_pk_add_f32 v[28:29], v[28:29], v[30:31]
    v_pk_add_f32 v[28:29], v[28:29], v[2:3]
    v_cvt_pk_bf16_f32 v28, v28, v29
    ds_write_b32 v35, v28
    s_waitcnt lgkmcnt(0)
    s_barrier
    v_cndmask_b32 v29, 0, v28, s[64:65]
    v_dot2_f32_bf16 v33, v29, v61, 0
    v_dot2_f32_bf16 v32, v29, v29, 0
    v_lshlrev_b32 v2, 16, v28
    v_and_b32 v3, 0xffff0000, v28
    s_cmp_eq_u32 s55, 0
    v_permlane32_swap_b32 v33, v32
    v_add_f32 v33, v33, v32
    s_nop 1
    v_add_f32_dpp v33, v33, v33 row_ror:8 row_mask:0xf bank_mask:0xf
    s_nop 1
    v_add_f32_dpp v33, v33, v33 row_ror:4 row_mask:0xf bank_mask:0xf
    s_nop 1
    v_add_f32_dpp v33, v33, v33 row_ror:2 row_mask:0xf bank_mask:0xf
    s_nop 1
    v_add_f32_dpp v33, v33, v33 row_ror:1 row_mask:0xf bank_mask:0xf
    s_nop 1
    v_add_f32_dpp v33, v33, v33 row_bcast:15 row_mask:0xa bank_mask:0xf
    v_min_u32 v33, -2, v33
    s_cbranch_scc1 L_gs_179
    buffer_store_dword v33, v34, s[40:43], s67 offen
L_gb_180:
    s_waitcnt vmcnt(1)
    s_branch L_se_168
L_gs_184:
    buffer_store_dword v12, v11, s[40:43], s59 offen sc1
    s_branch L_gb_185
L_gr_190:
    s_cbranch_scc1 L_gw_189
    s_waitcnt vmcnt(0)
    v_max3_u32 v32, v12, v13, v14
    v_max3_u32 v32, v32, v15, v16
    v_max3_u32 v32, v32, v17, v18
    v_max3_u32 v32, v32, v19, v20
L_pad18:
    s_cbranch_execz L_pad22
    v_max3_u32 v32, v32, v21, v22
    v_max3_u32 v32, v32, v23, v24
    v_max3_u32 v32, v32, v25, v26
    v_max_u32 v32, v32, v27
    v_cmp_eq_u32 vcc, -1, v32
    s_cbranch_vccnz L_gw_189
    v_pk_add_f32 v[28:29], v[12:13], v[16:17]
    v_pk_add_f32 v[30:31], v[14:15], v[18:19]
    v_pk_add_f32 v[28:29], v[28:29], v[20:21]
    v_pk_add_f32 v[30:31], v[30:31], v[22:23]
    v_pk_add_f32 v[28:29], v[28:29], v[24:25]
    v_pk_add_f32 v[30:31], v[30:31], v[26:27]
    s_nop 1
    v_permlane32_swap_b32 v28, v30
    v_permlane32_swap_b32 v29, v31
    s_branch L_gk_191
L_gr_193:
    s_cbranch_scc1 L_gw_192
    s_waitcnt vmcnt(0)
    v_max3_u32 v32, v12, v13, v14
    v_max3_u32 v32, v32, v15, v16
    v_max3_u32 v32, v32, v17, v18
    v_max3_u32 v32, v32, v19, v20
    v_max3_u32 v32, v32, v21, v22
    v_max3_u32 v32, v32, v23, v24
    v_max3_u32 v32, v32, v25, v26
    v_max_u32 v32, v32, v27
    v_cmp_eq_u32 vcc, -1, v32
    s_cbranch_vccnz L_gw_192
    v_pk_add_f32 v[28:29], v[12:13], v[16:17]
    v_pk_add_f32 v[30:31], v[14:15], v[18:19]
    v_pk_add_f32 v[28:29], v[28:29], v[20:21]
    v_pk_add_f32 v[30:31], v[30:31], v[22:23]
    v_pk_add_f32 v[28:29], v[28:29], v[24:25]
    v_pk_add_f32 v[30:31], v[30:31], v[26:27]
    s_nop 1
    v_permlane32_swap_b32 v28, v30
    v_permlane32_swap_b32 v29, v31
    s_branch L_gk_194
L_gs_197:
    buffer_store_dword v33, v34, s[40:43], s67 offen sc1
    s_branch L_gb_198
L_w7_181:
    v_and_b32 v60, 31, v0
    v_min_u32 v60, 19, v60
    s_mul_i32 s57, s54, 320
    v_lshrrev_b32 v5, 5, v0
    v_lshlrev_b32 v5, 12, v5
    v_add_u32 v5, s57, v5
    v_lshl_add_u32 v5, v60, 4, v5
    v_and_b32 v60, 31, v0
    v_cmp_gt_u32 s[64:65], 20, v60
    v_min_u32 v60, 19, v60
    v_lshrrev_b32 v35, 5, v0
    v_lshlrev_b32 v35, 2, v35
    v_add_u32 v35, 160832, v35
    v_lshl_add_u32 v35, v60, 3, v35
    s_mul_i32 s66, s53, 6144
    s_add_u32 s66, s66, s62
    s_add_u32 s66, s66, 46080
    s_lshl_b32 s67, s53, 6
    s_add_u32 s67, s67, s62
    s_add_u32 s67, s67, 25600
    s_lshl_b32 s57, s54, 3
    v_lshrrev_b32 v34, 5, v0
    v_lshlrev_b32 v34, 2, v34
    v_add_u32 v34, s57, v34
    v_and_b32 v60, 31, v0
    v_mov_b32 v61, 0x7f000000
    v_cmp_ne_u32 vcc, 31, v60
    s_nop 1
    v_cndmask_b32 v34, v34, v61, vcc
    v_mov_b32 v61, 0x3f803f80
    s_cmp_lg_u32 s53, 3
    s_cbranch_scc0 L_skip_186
    s_add_u32 s57, s62, 25856
    v_mov_b32 v9, 0
L_pr_188:
    buffer_load_dword v12, v9, s[40:43], s57 offen sc1
    s_sub_u32 s56, s56, 1
    s_cbranch_scc1 L_done
L_pw_187:
    s_waitcnt vmcnt(0)
    v_cmp_eq_u32 vcc, -1, v12
    s_cbranch_vccnz L_pr_188
    s_add_u32 s57, s7, 0
    s_add_u32 s58, s7, 16384
    s_add_u32 s59, s7, 32768
    s_add_u32 s60, s7, 49152
L_gw_189:
    buffer_load_dwordx4 v[12:15], v5, s[40:43], s57 offen sc1
    buffer_load_dwordx4 v[16:19], v5, s[40:43], s58 offen sc1
L_pad19:
    s_cbranch_execz L_pad23
    buffer_load_dwordx4 v[20:23], v5, s[40:43], s59 offen sc1
    buffer_load_dwordx4 v[24:27], v5, s[40:43], s60 offen sc1
    s_sub_u32 s56, s56, 1
    s_cbranch_scc1 L_done
    s_and_b32 s74, s56, 31
    s_waitcnt vmcnt(2)
    v_pk_add_f32 v[28:29], v[12:13], v[16:17]
    v_pk_add_f32 v[30:31], v[14:15], v[18:19]
    s_waitcnt vmcnt(1)
    v_pk_add_f32 v[28:29], v[28:29], v[20:21]
    v_pk_add_f32 v[30:31], v[30:31], v[22:23]
    s_waitcnt vmcnt(0)
    v_pk_add_f32 v[28:29], v[28:29], v[24:25]
    v_pk_add_f32 v[30:31], v[30:31], v[26:27]
    v_pk_add_f32 v[32:33], v[28:29], v[30:31]
    v_cmp_u_f32 vcc, v32, v33
    v_permlane32_swap_b32 v28, v30
    v_permlane32_swap_b32 v29, v31
    s_cbranch_vccnz L_gr_190
L_gk_191:
    v_pk_add_f32 v[28:29], v[28:29], v[30:31]
    v_pk_add_f32 v[28:29], v[28:29], v[2:3]
    v_cvt_pk_bf16_f32 v28, v28, v29
    v_lshlrev_b32 v2, 16, v28
    v_and_b32 v3, 0xffff0000, v28
L_skip_186:
    v_lshlrev_b32 v60, 16, v4
    v_add_f32 v2, v2, v60
    v_and_b32 v60, 0xffff0000, v4
    v_add_f32 v3, v3, v60
    s_add_u32 s57, s7, 66048
    s_add_u32 s58, s7, 82432
    s_add_u32 s59, s7, 98816
    s_add_u32 s60, s7, 115200
    s_lshl_b32 s74, s53, 7
    s_add_u32 s75, s62, s74
    s_add_u32 s75, s75, 26116
    v_mov_b32 v9, 0
    buffer_load_dword v12, v9, s[40:43], s75 offen sc1
    s_sleep 2
L_pr_196:
    buffer_load_dword v12, v9, s[40:43], s75 offen sc1
    s_sub_u32 s56, s56, 1
    s_cbranch_scc1 L_done
L_pw_195:
    s_waitcnt vmcnt(1)
    v_cmp_eq_u32 vcc, -1, v12
    s_cbranch_vccnz L_pr_196
    buffer_load_dwordx4 v[12:15], v5, s[40:43], s57 offen sc1
    buffer_load_dwordx4 v[16:19], v5, s[40:43], s58 offen sc1
    buffer_load_dwordx4 v[20:23], v5, s[40:43], s59 offen sc1
    buffer_load_dwordx4 v[24:27], v5, s[40:43], s60 offen sc1
    s_sleep 2
L_gw_192:
    buffer_load_dwordx4 v[12:15], v5, s[40:43], s57 offen sc1
    buffer_load_dwordx4 v[16:19], v5, s[40:43], s58 offen sc1
    buffer_load_dwordx4 v[20:23], v5, s[40:43], s59 offen sc1
    buffer_load_dwordx4 v[24:27], v5, s[40:43], s60 offen sc1
    s_sub_u32 s56, s56, 1
    s_cbranch_scc1 L_done
    s_and_b32 s74, s56, 31
    s_waitcnt vmcnt(6)
    v_pk_add_f32 v[28:29], v[12:13], v[16:17]
    v_pk_add_f32 v[30:31], v[14:15], v[18:19]
    s_waitcnt vmcnt(5)
    v_pk_add_f32 v[28:29], v[28:29], v[20:21]
    v_pk_add_f32 v[30:31], v[30:31], v[22:23]
    s_waitcnt vmcnt(4)
    v_pk_add_f32 v[28:29], v[28:29], v[24:25]
    v_pk_add_f32 v[30:31], v[30:31], v[26:27]
    v_pk_add_f32 v[32:33], v[28:29], v[30:31]
    v_cmp_u_f32 vcc, v32, v33
    v_permlane32_swap_b32 v28, v30
    v_permlane32_swap_b32 v29, v31
    s_cbranch_vccnz L_gr_193
L_gk_194:
    v_pk_add_f32 v[28:29], v[28:29], v[30:31]
    v_pk_add_f32 v[28:29], v[28:29], v[2:3]
    v_cvt_pk_bf16_f32 v28, v28, v29
    ds_write_b32 v35, v28
    s_waitcnt lgkmcnt(0)
    s_barrier
    v_cndmask_b32 v29, 0, v28, s[64:65]
    v_dot2_f32_bf16 v33, v29, v61, 0
    v_dot2_f32_bf16 v32, v29, v29, 0
    v_lshlrev_b32 v2, 16, v28
    v_and_b32 v3, 0xffff0000, v28
    s_cmp_eq_u32 s55, 0
    v_permlane32_swap_b32 v33, v32
L_pad20:
    s_cbranch_execz L_padback
    v_add_f32 v33, v33, v32
    s_nop 1
    v_add_f32_dpp v33, v33, v33 row_ror:8 row_mask:0xf bank_mask:0xf
    s_nop 1
    v_add_f32_dpp v33, v33, v33 row_ror:4 row_mask:0xf bank_mask:0xf
    s_nop 1
    v_add_f32_dpp v33, v33, v33 row_ror:2 row_mask:0xf bank_mask:0xf
    s_nop 1
    v_add_f32_dpp v33, v33, v33 row_ror:1 row_mask:0xf bank_mask:0xf
    s_nop 1
    v_add_f32_dpp v33, v33, v33 row_bcast:15 row_mask:0xa bank_mask:0xf
    v_min_u32 v33, -2, v33
    s_cbranch_scc1 L_gs_197
    buffer_store_dword v33, v34, s[40:43], s67 offen
L_gb_198:
    s_waitcnt vmcnt(1)
    s_branch L_se_182
L_hr_203:
    buffer_load_dwordx4 v[12:15], v7, s[40:43], s59 offen offset:0 sc1
    buffer_load_dwordx4 v[16:19], v7, s[40:43], s59 offen offset:1024 sc1
    s_sub_u32 s56, s56, 1
    s_cbranch_scc1 L_done
    s_and_b32 s64, s56, 31
    s_cbranch_scc0 L_hx_205
    s_waitcnt vmcnt(0)
    v_pk_add_f32 v[20:21], v[12:13], v[16:17]
    v_pk_add_f32 v[22:23], v[14:15], v[18:19]
    s_nop 1
    v_permlane32_swap_b32 v20, v22
    v_permlane32_swap_b32 v21, v23
    v_pk_add_f32 v[20:21], v[20:21], v[22:23]
    s_nop 1
    v_permlane16_swap_b32 v20, v21
    v_add_f32 v20, v20, v21
    v_cmp_u_f32 vcc, v20, v20
    v_sub_f32 v20, v20, v50
    s_cbranch_vccnz L_hr_203
    s_branch L_hk_204
L_hx_205:
    s_waitcnt vmcnt(0)
    v_max3_u32 v20, v12, v13, v14
    v_max3_u32 v20, v20, v15, v16
    v_max3_u32 v20, v20, v17, v18
    v_max_u32 v20, v20, v19
    v_cmp_eq_u32 vcc, -1, v20
    s_cbranch_vccnz L_hr_203
    v_pk_add_f32 v[20:21], v[12:13], v[16:17]
    v_pk_add_f32 v[22:23], v[14:15], v[18:19]
    s_nop 1
    v_permlane32_swap_b32 v20, v22
    v_permlane32_swap_b32 v21, v23
    v_pk_add_f32 v[20:21], v[20:21], v[22:23]
    s_nop 1
    v_permlane16_swap_b32 v20, v21
    v_add_f32 v20, v20, v21
    v_sub_f32 v20, v20, v50
    s_branch L_hk_204
L_qo_199:
    v_mov_b64 v[24:25], 0
    v_mov_b64 v[26:27], 0
    v_mov_b64 v[28:29], 0
    v_mov_b64 v[30:31], 0
    v_mov_b64 v[32:33], 0
    v_mov_b64 v[34:35], 0
    v_mov_b64 v[36:37], 0
    v_mov_b64 v[38:39], 0
    v_mov_b64 v[40:41], 0
    v_mov_b64 v[42:43], 0
    v_mov_b64 v[44:45], 0
    v_mov_b64 v[46:47], 0
    v_lshrrev_b32 v5, 4, v0
    v_lshlrev_b32 v5, 5, v5
    v_bfe_u32 v60, v0, 1, 1
    v_lshl_add_u32 v5, v60, 4, v5
    v_add_u32 v5, 124928, v5
    s_branch L_qb_200
L_mr_206:
    ds_read_b32 v36, v62
    s_sub_u32 s56, s56, 1
    s_cbranch_scc1 L_done
    s_waitcnt lgkmcnt(0)
    v_cmp_eq_u32 vcc, -1, v36
    s_cbranch_vccnz L_mr_206
    v_max_f32_dpp v37, v36, v36 row_ror:4 row_mask:0xf bank_mask:0xf
    s_nop 1
    v_max_f32_dpp v37, v37, v37 row_ror:2 row_mask:0xf bank_mask:0xf
    s_nop 1
    v_max_f32_dpp v37, v37, v37 row_ror:1 row_mask:0xf bank_mask:0xf
    v_sub_f32 v39, v61, v37
    v_exp_f32 v39, v39
    s_branch L_mk_207
L_gs_208:
    buffer_store_dword v37, v4, s[40:43], s58 offen sc1
    s_branch L_gb_209
L_gs_210:
    buffer_store_dword v14, v3, s[40:43], s57 offen sc1
    s_branch L_gb_211
L_gs_212:
    buffer_store_dword v12, v4, s[40:43], s57 offen offset:32 sc1
    s_branch L_gb_213
L_comb_1:
    s_mov_b32 s58, 26624
    v_min_u32 v37, -2, v37
    s_cmp_eq_u32 s55, 0
    s_cbranch_scc1 L_gs_208
    buffer_store_dword v37, v4, s[40:43], s58 offen
L_gb_209:
    s_mov_b32 s57, 26624
L_pad21:
    s_cbranch_execz L_padback
    s_cmp_eq_u32 s55, 0
    s_waitcnt lgkmcnt(0)
    s_barrier
    ds_read2st64_b64 v[12:15], v2 offset0:0 offset1:4
    ds_read2st64_b64 v[16:19], v2 offset0:8 offset1:12
    ds_read2st64_b64 v[20:23], v2 offset0:16 offset1:20
    ds_read2st64_b64 v[24:27], v2 offset0:24 offset1:28
    s_waitcnt lgkmcnt(2)
    v_pk_add_f32 v[12:13], v[12:13], v[14:15]
    v_pk_add_f32 v[16:17], v[16:17], v[18:19]
    v_pk_add_f32 v[12:13], v[12:13], v[16:17]
    s_waitcnt lgkmcnt(0)
    v_pk_add_f32 v[20:21], v[20:21], v[22:23]
    v_pk_add_f32 v[24:25], v[24:25], v[26:27]
    v_pk_add_f32 v[12:13], v[12:13], v[20:21]
    v_pk_add_f32 v[12:13], v[12:13], v[24:25]
    v_cvt_pk_bf16_f32 v14, v12, v13
    v_min_u32 v12, -2, v12
    v_min_u32 v14, -2, v14
    s_cbranch_scc1 L_gs_210
    buffer_store_dword v14, v3, s[40:43], s57 offen
L_gb_211:
    s_cbranch_scc1 L_gs_212
    buffer_store_dword v12, v4, s[40:43], s57 offen offset:32
L_gb_213:
    s_branch L_comb_1b
L_sr_223:
    buffer_load_dwordx4 v[52:55], v11, s[40:43], s65 offen offset:0 sc1
    buffer_load_dwordx4 v[56:59], v11, s[40:43], s65 offen offset:1024 sc1
    s_sub_u32 s56, s56, 1
    s_cbranch_scc1 L_done
    s_waitcnt vmcnt(0)
    s_branch L_sw_222
L_hr_224:
    buffer_load_dwordx4 v[12:15], v11, s[40:43], s58 offen offset:0 sc1
    buffer_load_dwordx4 v[16:19], v11, s[40:43], s58 offen offset:1024 sc1
    s_sub_u32 s56, s56, 1
    s_cbranch_scc1 L_done
    s_and_b32 s64, s56, 31
    s_cbranch_scc0 L_hx_226
    s_waitcnt vmcnt(2)
    v_pk_add_f32 v[20:21], v[12:13], v[16:17]
    v_pk_add_f32 v[22:23], v[14:15], v[18:19]
    s_nop 1
    v_permlane32_swap_b32 v20, v22
    v_permlane32_swap_b32 v21, v23
    v_pk_add_f32 v[20:21], v[20:21], v[22:23]
    s_nop 1
    v_permlane16_swap_b32 v20, v21
    v_add_f32 v20, v20, v21
    v_cmp_u_f32 vcc, v20, v20
    v_sub_f32 v20, v20, v26
    s_cbranch_vccnz L_hr_224
    s_branch L_hk_225
L_hx_226:
    s_waitcnt vmcnt(0)
    v_max3_u32 v20, v12, v13, v14
    v_max3_u32 v20, v20, v15, v16
    v_max3_u32 v20, v20, v17, v18
    v_max_u32 v20, v20, v19
    v_cmp_eq_u32 vcc, -1, v20
    s_cbranch_vccnz L_hr_224
    v_pk_add_f32 v[20:21], v[12:13], v[16:17]
    v_pk_add_f32 v[22:23], v[14:15], v[18:19]
    s_nop 1
    v_permlane32_swap_b32 v20, v22
    v_permlane32_swap_b32 v21, v23
    v_pk_add_f32 v[20:21], v[20:21], v[22:23]
    s_nop 1
    v_permlane16_swap_b32 v20, v21
    v_add_f32 v20, v20, v21
    v_sub_f32 v20, v20, v26
    s_branch L_hk_225
L_typeC_229:
    s_cmp_eq_u32 s30, 6
    s_cbranch_scc0 L_done
    s_cmp_eq_u32 s3, 20
    s_cbranch_scc0 L_done
    s_lshl_b32 s59, s31, 9
    s_add_u32 s59, s59, s8
    s_add_u32 s59, s59, 266240
    v_and_b32 v10, 1, v0
    v_lshlrev_b32 v10, 13, v10
    v_lshrrev_b32 v60, 1, v0
    v_lshl_add_u32 v10, v60, 24, v10
    s_add_u32 s58, s62, 28192
    v_lshrrev_b32 v9, 3, v0
    v_mul_u32_u24 v9, 1664, v9
    v_and_b32 v60, 7, v0
    v_lshl_add_u32 v9, v60, 2, v9
    buffer_load_dword v12, v9, s[40:43], s58 offen sc1
    s_sleep 2
L_pr_231:
    buffer_load_dword v12, v9, s[40:43], s58 offen sc1
    s_sub_u32 s56, s56, 1
    s_cbranch_scc1 L_done
L_pw_230:
    s_waitcnt vmcnt(1)
    v_cmp_eq_u32 vcc, -1, v12
    s_cbranch_vccnz L_pr_231
L_pad22:
    s_cbranch_execz L_padback
    buffer_store_dword v0, v10, s[40:43], s59 offen offset:8 sc1
    s_add_u32 s58, s62, 25984
    v_and_b32 v9, 15, v0
    v_lshlrev_b32 v9, 2, v9
    buffer_load_dword v13, v9, s[40:43], s58 offen sc1
    s_sleep 2
L_pr_233:
    buffer_load_dword v13, v9, s[40:43], s58 offen sc1
    s_sub_u32 s56, s56, 1
    s_cbranch_scc1 L_done
L_pw_232:
    s_waitcnt vmcnt(1)
    v_cmp_eq_u32 vcc, -1, v13
    s_cbranch_vccnz L_pr_233
    buffer_store_dword v0, v10, s[40:43], s59 offen offset:12 sc1
    s_waitcnt vmcnt(1)
    s_branch L_done
L_gs_237:
    buffer_store_dword v12, v11, s[40:43], s59 offen sc1
    s_branch L_gb_238
L_gr_240:
    s_cbranch_scc1 L_gw_239
    s_waitcnt vmcnt(0)
    v_max3_u32 v32, v12, v13, v14
    v_max3_u32 v32, v32, v15, v16
    v_max3_u32 v32, v32, v17, v18
    v_max3_u32 v32, v32, v19, v20
    v_max3_u32 v32, v32, v21, v22
    v_max3_u32 v32, v32, v23, v24
    v_max3_u32 v32, v32, v25, v26
    v_max_u32 v32, v32, v27
    v_cmp_eq_u32 vcc, -1, v32
    s_cbranch_vccnz L_gw_239
    v_pk_add_f32 v[28:29], v[12:13], v[16:17]
    v_pk_add_f32 v[30:31], v[14:15], v[18:19]
    v_pk_add_f32 v[28:29], v[28:29], v[20:21]
    v_pk_add_f32 v[30:31], v[30:31], v[22:23]
    v_pk_add_f32 v[28:29], v[28:29], v[24:25]
    v_pk_add_f32 v[30:31], v[30:31], v[26:27]
    s_nop 1
    v_permlane32_swap_b32 v28, v30
    v_permlane32_swap_b32 v29, v31
    s_branch L_gk_241
L_gs_244:
    buffer_store_dword v33, v34, s[40:43], s67 offen sc1
    s_branch L_gb_245
L_w7_234:
    v_and_b32 v60, 31, v0
    v_min_u32 v60, 19, v60
    s_mul_i32 s57, s54, 320
    v_lshrrev_b32 v5, 5, v0
    v_lshlrev_b32 v5, 12, v5
    v_add_u32 v5, s57, v5
    v_lshl_add_u32 v5, v60, 4, v5
    v_and_b32 v60, 31, v0
    v_cmp_gt_u32 s[64:65], 20, v60
    v_min_u32 v60, 19, v60
    v_lshrrev_b32 v35, 5, v0
    v_lshlrev_b32 v35, 2, v35
    v_add_u32 v35, 160832, v35
    v_lshl_add_u32 v35, v60, 3, v35
    s_add_u32 s66, s62, 39936
    s_add_u32 s67, s62, 25984
    s_lshl_b32 s57, s54, 3
    v_lshrrev_b32 v34, 5, v0
    v_lshlrev_b32 v34, 2, v34
    v_add_u32 v34, s57, v34
    v_and_b32 v60, 31, v0
    v_mov_b32 v61, 0x7f000000
    v_cmp_ne_u32 vcc, 31, v60
    s_nop 1
    v_cndmask_b32 v34, v34, v61, vcc
    v_mov_b32 v61, 0x3f803f80
    s_add_u32 s57, s7, 132096
    s_add_u32 s58, s7, 148480
    s_add_u32 s59, s7, 164864
    s_add_u32 s60, s7, 181248
    s_add_u32 s75, s7, 266248
    v_and_b32 v9, 7, v0
    v_lshlrev_b32 v9, 9, v9
    buffer_load_dword v12, v9, s[40:43], s75 offen sc1
    s_sleep 2
L_pr_243:
    buffer_load_dword v12, v9, s[40:43], s75 offen sc1
    s_sub_u32 s56, s56, 1
    s_cbranch_scc1 L_done
L_pw_242:
    s_waitcnt vmcnt(1)
    v_cmp_eq_u32 vcc, -1, v12
    s_cbranch_vccnz L_pr_243
    s_sleep 2
    buffer_load_dwordx4 v[12:15], v5, s[40:43], s57 offen sc1
    buffer_load_dwordx4 v[16:19], v5, s[40:43], s58 offen sc1
    buffer_load_dwordx4 v[20:23], v5, s[40:43], s59 offen sc1
    buffer_load_dwordx4 v[24:27], v5, s[40:43], s60 offen sc1
L_pad23:
    s_cbranch_execz L_padback
    s_sleep 2
L_gw_239:
    buffer_load_dwordx4 v[12:15], v5, s[40:43], s57 offen sc1
    buffer_load_dwordx4 v[16:19], v5, s[40:43], s58 offen sc1
    buffer_load_dwordx4 v[20:23], v5, s[40:43], s59 offen sc1
    buffer_load_dwordx4 v[24:27], v5, s[40:43], s60 offen sc1
    s_sub_u32 s56, s56, 1
    s_cbranch_scc1 L_done
    s_and_b32 s74, s56, 31
    s_waitcnt vmcnt(6)
    v_pk_add_f32 v[28:29], v[12:13], v[16:17]
    v_pk_add_f32 v[30:31], v[14:15], v[18:19]
    s_waitcnt vmcnt(5)
    v_pk_add_f32 v[28:29], v[28:29], v[20:21]
    v_pk_add_f32 v[30:31], v[30:31], v[22:23]
    s_waitcnt vmcnt(4)
    v_pk_add_f32 v[28:29], v[28:29], v[24:25]
    v_pk_add_f32 v[30:31], v[30:31], v[26:27]
    v_pk_add_f32 v[32:33], v[28:29], v[30:31]
    v_cmp_u_f32 vcc, v32, v33
    v_permlane32_swap_b32 v28, v30
    v_permlane32_swap_b32 v29, v31
    s_cbranch_vccnz L_gr_240
L_gk_241:
    v_pk_add_f32 v[28:29], v[28:29], v[30:31]
    v_pk_add_f32 v[28:29], v[28:29], v[2:3]
    v_cvt_pk_bf16_f32 v28, v28, v29
    ds_write_b32 v35, v28
    s_waitcnt lgkmcnt(0)
    s_barrier
    v_cndmask_b32 v29, 0, v28, s[64:65]
    v_dot2_f32_bf16 v33, v29, v61, 0
    v_dot2_f32_bf16 v32, v29, v29, 0
    v_lshlrev_b32 v2, 16, v28
    v_and_b32 v3, 0xffff0000, v28
    s_cmp_eq_u32 s55, 0
    v_permlane32_swap_b32 v33, v32
    v_add_f32 v33, v33, v32
    s_nop 1
    v_add_f32_dpp v33, v33, v33 row_ror:8 row_mask:0xf bank_mask:0xf
    s_nop 1
    v_add_f32_dpp v33, v33, v33 row_ror:4 row_mask:0xf bank_mask:0xf
    s_nop 1
    v_add_f32_dpp v33, v33, v33 row_ror:2 row_mask:0xf bank_mask:0xf
    s_nop 1
    v_add_f32_dpp v33, v33, v33 row_ror:1 row_mask:0xf bank_mask:0xf
    s_nop 1
    v_add_f32_dpp v33, v33, v33 row_bcast:15 row_mask:0xa bank_mask:0xf
    v_min_u32 v33, -2, v33
    s_cbranch_scc1 L_gs_244
    buffer_store_dword v33, v34, s[40:43], s67 offen
L_gb_245:
    s_waitcnt vmcnt(1)
    s_branch L_se_235
L_gr_247:
    s_cbranch_scc1 L_gw_246
    s_waitcnt vmcnt(0)
    v_max3_u32 v32, v12, v13, v14
    v_max3_u32 v32, v32, v15, v16
    v_max3_u32 v32, v32, v17, v18
    v_max3_u32 v32, v32, v19, v20
    v_max3_u32 v32, v32, v21, v22
    v_max3_u32 v32, v32, v23, v24
    v_max3_u32 v32, v32, v25, v26
    v_max_u32 v32, v32, v27
    v_cmp_eq_u32 vcc, -1, v32
    s_cbranch_vccnz L_gw_246
    v_pk_add_f32 v[28:29], v[12:13], v[16:17]
    v_pk_add_f32 v[30:31], v[14:15], v[18:19]
    v_pk_add_f32 v[28:29], v[28:29], v[20:21]
    v_pk_add_f32 v[30:31], v[30:31], v[22:23]
    v_pk_add_f32 v[28:29], v[28:29], v[24:25]
    v_pk_add_f32 v[30:31], v[30:31], v[26:27]
    s_nop 1
    v_permlane32_swap_b32 v28, v30
    v_permlane32_swap_b32 v29, v31
    s_branch L_gk_248
L_tail_end:
L_spread:
    s_add_u32 s62, s62, 966656
    s_cmp_eq_u32 s30, 5
    s_cbranch_scc0 L_skip_83
    v_mov_b64 v[12:13], -1
    v_mov_b64 v[14:15], -1
    v_lshlrev_b32 v16, 4, v0
    s_mul_i32 s57, s52, 2208
    s_add_u32 s57, s57, s62
    s_mov_b64 exec, 0x3ff
    buffer_store_dwordx4 v[12:15], v16, s[40:43], s57 offen offset:2048 sc1
    s_mov_b64 exec, -1
    buffer_store_dwordx4 v[12:15], v16, s[40:43], s57 offen offset:0 sc1
    buffer_store_dwordx4 v[12:15], v16, s[40:43], s57 offen offset:1024 sc1
L_skip_83:
    s_cmp_eq_u32 s30, 7
    s_cbranch_scc0 L_skip_84
    v_and_b32 v60, 31, v0
    v_cmp_gt_u32 s[64:65], 20, v60
    v_min_u32 v60, 19, v60
    v_lshrrev_b32 v35, 5, v0
    v_lshlrev_b32 v35, 2, v35
    v_add_u32 v35, 160832, v35
    v_lshl_add_u32 v35, v60, 3, v35
    s_mul_i32 s66, s53, 12416
    s_add_u32 s66, s66, s62
    s_add_u32 s66, s66, 70656
    s_add_u32 s67, s66, 12288
    s_lshl_b32 s57, s54, 3
    v_lshrrev_b32 v34, 5, v0
    v_lshlrev_b32 v34, 2, v34
    v_add_u32 v34, s57, v34
    v_and_b32 v60, 31, v0
    v_mov_b32 v61, 0x7f000000
    v_cmp_ne_u32 vcc, 31, v60
    s_nop 1
    v_cndmask_b32 v34, v34, v61, vcc
    v_mov_b32 v61, 0x3f803f80
    v_cvt_pk_bf16_f32 v28, v2, v3
L_skip_84:
    s_cmp_eq_u32 s30, 7
    s_cbranch_scc0 L_skip_85
    v_cndmask_b32 v29, 0, v28, s[64:65]
    v_dot2_f32_bf16 v33, v29, v61, 0
    v_dot2_f32_bf16 v32, v29, v29, 0
    v_lshlrev_b32 v2, 16, v28
    v_and_b32 v3, 0xffff0000, v28
    s_cmp_eq_u32 s55, 0
    v_permlane32_swap_b32 v33, v32
    v_add_f32 v33, v33, v32
    s_nop 1
    v_add_f32_dpp v33, v33, v33 row_ror:8 row_mask:0xf bank_mask:0xf
    s_nop 1
    v_add_f32_dpp v33, v33, v33 row_ror:4 row_mask:0xf bank_mask:0xf
    s_nop 1
    v_add_f32_dpp v33, v33, v33 row_ror:2 row_mask:0xf bank_mask:0xf
    s_nop 1
    v_add_f32_dpp v33, v33, v33 row_ror:1 row_mask:0xf bank_mask:0xf
    s_nop 1
    v_add_f32_dpp v33, v33, v33 row_bcast:15 row_mask:0xa bank_mask:0xf
    v_min_u32 v33, -2, v33
    s_cbranch_scc1 L_gs_86
    buffer_store_dword v33, v34, s[40:43], s67 offen
L_gb_87:
    s_waitcnt vmcnt(1)
L_skip_85:
    s_cmp_lt_u32 s30, 6
    s_cbranch_scc0 L_skip_88
    s_lshr_b32 s57, s30, 1
    s_mul_i32 s57, s57, 1024
    s_and_b32 s58, s30, 1
    s_lshl_b32 s58, s58, 6
    s_add_u32 s57, s57, s58
    v_lshrrev_b32 v18, 5, v0
    v_mul_u32_u24 v18, 6144, v18
    v_bfe_u32 v60, v0, 3, 1
    v_mul_u32_u24 v60, 3072, v60
    v_add_u32 v18, v60, v18
    v_bfe_u32 v60, v0, 4, 1
    v_lshl_add_u32 v18, v60, 9, v18
    v_bfe_u32 v60, v0, 2, 1
    v_lshl_add_u32 v18, v60, 7, v18
    v_and_b32 v60, 3, v0
    v_lshl_add_u32 v18, v60, 3, v18
    v_add_u32 v18, s57, v18
    v_bfe_u32 v19, v0, 4, 1
    v_mul_u32_u24 v19, 3072, v19
    v_bfe_u32 v60, v0, 3, 1
    v_lshl_add_u32 v19, v60, 9, v19
    v_bfe_u32 v60, v0, 2, 1
    v_lshl_add_u32 v19, v60, 7, v19
    v_and_b32 v60, 3, v0
    v_lshl_add_u32 v19, v60, 3, v19
    v_add_u32 v19, s57, v19
    v_add_u32 v19, 24576, v19
    ds_read_b64_tr_b16 v[28:29], v18 offset:0
    ds_read_b64_tr_b16 v[30:31], v18 offset:256
    ds_read_b64_tr_b16 v[32:33], v18 offset:12288
    ds_read_b64_tr_b16 v[34:35], v18 offset:12544
    ds_read_b64_tr_b16 v[36:37], v19 offset:0
    ds_read_b64_tr_b16 v[38:39], v19 offset:256
    ds_read_b64_tr_b16 v[40:41], v18 offset:32
    ds_read_b64_tr_b16 v[42:43], v18 offset:288
    ds_read_b64_tr_b16 v[44:45], v18 offset:12320
    ds_read_b64_tr_b16 v[46:47], v18 offset:12576
    ds_read_b64_tr_b16 v[48:49], v19 offset:32
    ds_read_b64_tr_b16 v[50:51], v19 offset:288
    v_lshrrev_b32 v52, 4, v0
    v_lshlrev_b32 v52, 5, v52
    v_bfe_u32 v60, v0, 1, 1
    v_lshl_add_u32 v52, v60, 4, v52
    v_and_b32 v60, 1, v0
    v_mul_u32_u24 v60, 192, v60
    v_add_u32 v52, v60, v52
    v_add_u32 v52, 160832, v52
    v_lshrrev_b32 v53, 4, v0
    v_lshlrev_b32 v53, 4, v53
    v_bfe_u32 v60, v0, 1, 1
    v_lshl_add_u32 v53, v60, 3, v53
    v_and_b32 v60, 1, v0
    v_mul_u32_u24 v60, 192, v60
    v_add_u32 v53, v60, v53
    v_add_u32 v53, 160960, v53
    v_mov_b64 v[20:21], 0
    v_mov_b64 v[22:23], 0
    v_mov_b64 v[24:25], 0
    v_mov_b64 v[26:27], 0
    s_lshr_b32 s57, s30, 1
    s_lshl_b32 s57, s57, 11
    s_lshl_b32 s58, s58, 1
    s_add_u32 s57, s57, s58
    s_lshl_b32 s58, s54, 8
    s_add_u32 s57, s57, s58
    v_and_b32 v54, 31, v0
    v_lshlrev_b32 v54, 2, v54
    v_lshrrev_b32 v60, 5, v0
    v_mul_u32_u24 v60, 6144, v60
    v_add_u32 v54, v60, v54
    v_add_u32 v54, s57, v54
    s_mul_i32 s59, s53, 12416
    s_add_u32 s59, s59, s62
    s_add_u32 s59, s59, 70656
    s_add_u32 s60, s59, 12288
    ds_read_b128 v[12:15], v52
    ds_read_b64 v[16:17], v53
    s_waitcnt lgkmcnt(1)
    v_smfmac_f32_16x16x64_bf16 v[20:23], v[12:15], v[28:35], v1
    v_smfmac_f32_16x16x64_bf16 v[24:27], v[12:15], v[40:47], v1
    s_waitcnt lgkmcnt(0)
    v_smfmac_f32_16x16x32_bf16 v[20:23], v[16:17], v[36:39], v1
    v_smfmac_f32_16x16x32_bf16 v[24:27], v[16:17], v[48:51], v1
    s_cmp_eq_u32 s55, 0
    s_nop 5
    v_add_f32 v12, v20, v22
    s_nop 1
    v_add_f32_dpp v12, v24, v26 quad_perm:[0,1,2,3] row_mask:0x2 bank_mask:0xf
    s_nop 1
    v_add_f32_dpp v12, v21, v23 quad_perm:[0,1,2,3] row_mask:0x4 bank_mask:0xf
    s_nop 1
    v_add_f32_dpp v12, v25, v27 quad_perm:[0,1,2,3] row_mask:0x8 bank_mask:0xf
    v_min_u32 v12, -2, v12
    s_cbranch_scc1 L_gs_89
    buffer_store_dword v12, v54, s[40:43], s59 offen
L_gb_90:
L_skip_88:
    s_waitcnt vmcnt(0)
    s_barrier
    s_cmp_eq_u32 s30, 5
    s_cbranch_scc0 L_skip_91
    v_mov_b32 v25, 0
    s_lshl_b32 s57, s52, 2
    s_add_u32 s57, s57, s72
    s_mov_b64 exec, 1
    buffer_store_dword v25, v0, s[40:43], s57 offen offset:256 sc1
    s_mov_b64 exec, -1
    v_and_b32 v16, 31, v0
    v_lshlrev_b32 v16, 2, v16
L_pr_93:
    buffer_load_dword v17, v16, s[40:43], s72 offen offset:256 sc1
    s_sub_u32 s56, s56, 1
    s_cbranch_scc1 L_done
L_pw_92:
    s_waitcnt vmcnt(0)
    v_cmp_eq_u32 vcc, -1, v17
    s_cbranch_vccnz L_pr_93
L_skip_91:
    s_barrier
    s_branch L_spread_back
L_done:
L_exit:
    s_endpgm
.section .rodata,"a"
.p2align 6
.amdhsa_kernel interleave_layers__sliding_block_cached__dense_activation_gelu__decode_kernel
  .amdhsa_next_free_vgpr 256
  .amdhsa_next_free_sgpr 102
  .amdhsa_accum_offset 256
  .amdhsa_group_segment_fixed_size 0
  .amdhsa_kernarg_size 104
  .amdhsa_user_sgpr_count 2
  .amdhsa_user_sgpr_kernarg_segment_ptr 1
  .amdhsa_system_sgpr_workgroup_id_x 1
  .amdhsa_float_denorm_mode_32 3
.end_amdhsa_kernel
```

```asm
; @launch grid=(256,1,1) block=(512,1,1) lds=161216
.amdgcn_target "amdgcn-amd-amdhsa--gfx950"
.text
.fill 64, 4, 0xbf800000
.globl interleave_layers__sliding_block_cached__dense_activation_gelu__decode_kernel
.p2align 8
.type interleave_layers__sliding_block_cached__dense_activation_gelu__decode_kernel,@function
interleave_layers__sliding_block_cached__dense_activation_gelu__decode_kernel:
    s_load_dwordx16 s[4:19], s[0:1], 0
    s_cmp_ge_u32 s2, 256
    s_cbranch_scc1 L_exit
    v_lshrrev_b32 v5, 6, v0
    v_lshlrev_b32 v62, 6, v0
    v_readfirstlane_b32 s30, v5
    v_and_b32 v0, 63, v0
    s_getpc_b64 s[74:75]
L_pc:
    v_min_u32 v62, L_exit-L_pc, v62
    global_load_dword v63, v62, s[74:75]
    s_cmp_eq_u32 s30, 6
    s_cbranch_scc0 L_skip_1
    s_setprio 3
L_skip_1:
    s_and_b32 s31, s2, 7
    s_lshr_b32 s52, s2, 3
    s_and_b32 s53, s52, 3
    s_lshr_b32 s54, s52, 2
    s_lshl_b32 s73, s31, 2
    s_add_u32 s73, s73, s53
    v_lshrrev_b32 v8, 5, v0
    v_lshlrev_b32 v8, 2, v8
    v_bfe_u32 v60, v0, 4, 1
    v_lshl_add_u32 v8, v60, 0, v8
    v_and_b32 v9, 7, v0
    v_xor_b32 v8, v8, v9
    v_lshrrev_b32 v10, 3, v0
    v_mul_u32_u24 v10, 384, v10
    v_lshl_add_u32 v5, v8, 4, v10
    v_xor_b32 v6, 32, v5
    s_mul_i32 s64, s73, 12582912
    s_mul_i32 s58, s54, 3072
    s_add_u32 s64, s64, s58
    s_add_u32 s64, s64, 11010048
    s_sub_u32 s34, 1572864, s58
    s_mov_b32 s35, 0x20000
    s_mov_b32 s57, 0
    s_mov_b32 s58, 195584
    s_mov_b32 m0, 92160
    s_cmp_eq_u32 s30, 6
    s_cselect_b64 vcc, -1, 0
    s_waitcnt lgkmcnt(0)
    s_add_u32 s32, s6, s64
    s_addc_u32 s33, s7, 0
    s_load_dwordx8 s[20:27], s[0:1], 64
    s_load_dwordx2 s[28:29], s[0:1], 96
    s_cbranch_vccz L_skip_3
L_dma_2:
    buffer_load_dwordx4 v5, s[32:35], s57 offen offset:0 nt lds
    buffer_load_dwordx4 v6, s[32:35], s58 offen offset:1024 nt lds
    s_add_u32 s57, s57, 24576
    s_add_u32 s58, s58, 24576
    s_add_u32 m0, m0, 2048
    s_cmp_lg_u32 m0, 108544
    s_cbranch_scc1 L_dma_2
    s_mov_b32 s57, 128
    s_mov_b32 s58, 195712
    s_mov_b32 m0, 108544
L_dma_4:
    s_nop 0
    buffer_load_dwordx4 v5, s[32:35], s57 offen offset:0 nt lds
    buffer_load_dwordx4 v6, s[32:35], s58 offen offset:1024 nt lds
    s_add_u32 s57, s57, 24576
    s_add_u32 s58, s58, 24576
    s_add_u32 m0, m0, 2048
    s_cmp_lg_u32 m0, 116736
    s_cbranch_scc1 L_dma_4
L_skip_3:
    s_mul_i32 s3, s54, 3
    s_add_u32 s3, s3, s53
    s_cmp_eq_u32 s53, 3
    s_cselect_b32 s3, 31, s3
    v_lshrrev_b32 v8, 4, v0
    v_lshlrev_b32 v8, 1, v8
    v_xor_b32 v8, v8, v9
    v_lshl_add_u32 v7, v8, 4, v10
    v_lshrrev_b32 v2, 3, v0
    v_mul_u32_u24 v2, 12288, v2
    v_and_b32 v60, 7, v0
    v_lshl_add_u32 v2, v60, 4, v2
    s_mul_i32 s59, s73, 384
    s_mul_i32 s60, s54, 983040
    s_add_u32 s59, s59, s60
    s_sub_u32 s60, 7866368, s59
    s_lshl_b32 s61, s30, 11
    s_add_u32 s61, s61, 92160
    s_mul_i32 s62, s31, 120832
    s_add_u32 s62, s62, 299008
    s_lshl_b32 s72, s31, 9
    s_add_u32 s72, s72, 294912
    s_mov_b32 s56, 65536
    s_mov_b32 s55, 1
    s_getreg_b32 s63, hwreg(20, 0, 3)
    v_mov_b32 v3, 0
    v_mov_b32 v4, 0
    v_mov_b32 v11, 0
    v_mov_b32 v24, 0
    v_mov_b32 v34, 0
    v_mov_b64 v[12:13], -1
    v_mov_b64 v[14:15], -1
    v_lshlrev_b32 v10, 4, v0
    s_waitcnt lgkmcnt(0)
    s_add_u32 s36, s8, s64
    s_addc_u32 s37, s9, 0
    s_mov_b32 s38, s34
    s_mov_b32 s39, 0x20000
    s_mov_b32 s40, s28
    s_mov_b32 s41, s29
    s_mov_b32 s42, 2232320
    s_mov_b32 s43, 0x20000
    s_add_u32 s44, s10, s59
    s_addc_u32 s45, s11, 0
    s_mov_b32 s46, s60
    s_mov_b32 s47, 0x20000
    s_sub_u32 s44, s44, 2048
    s_subb_u32 s45, s45, 0
    s_cmp_eq_u32 s30, 6
    s_cbranch_scc0 L_skip_5
    s_mov_b32 s57, 98432
    s_mov_b32 s58, 294016
    s_mov_b32 m0, 116736
L_dma_6:
    s_waitcnt vmcnt(22)
L_go_7:
    buffer_load_dwordx4 v5, s[32:35], s57 offen offset:0 nt lds
    buffer_load_dwordx4 v6, s[32:35], s58 offen offset:1024 nt lds
    s_add_u32 s57, s57, 24576
    s_add_u32 s58, s58, 24576
    s_add_u32 m0, m0, 2048
    s_cmp_lg_u32 m0, 124928
    s_cbranch_scc1 L_dma_6
    s_mov_b32 s57, 2048
    s_mov_b32 s58, 1152
    s_mov_b32 s59, 256
    s_mov_b32 m0, 0
L_dma_8:
    s_waitcnt vmcnt(22)
L_go_9:
    buffer_load_dwordx4 v2, s[44:47], s57 offen offset:0 nt lds
    buffer_load_dwordx4 v2, s[44:47], s58 offen offset:1024 nt lds
    buffer_load_dwordx4 v2, s[44:47], s59 offen offset:2048 nt lds
    s_add_u32 s57, s57, 98304
    s_add_u32 s58, s58, 98304
    s_add_u32 s59, s59, 98304
    s_add_u32 m0, m0, 3072
    s_cmp_lg_u32 m0, 15360
    s_cbranch_scc1 L_dma_8
L_skip_5:
    s_cmp_lt_u32 s3, 20
    s_cselect_b32 s57, 7864320, 0
    s_add_u32 s58, s54, 1
    s_mul_i32 s58, s58, 245760
    s_cmp_lg_u32 s53, 3
    s_cselect_b64 s[48:49], s[12:13], s[16:17]
    s_cselect_b32 s50, s57, s58
    s_mov_b32 s51, 0x20000
    s_add_u32 s57, s28, 0
    s_sub_u32 s57, 0, s57
    s_and_b32 s57, s57, 0x3fff
    s_add_u32 s57, s57, 0
    s_lshr_b32 s58, s31, 1
    s_lshl_b32 s58, s58, 14
    s_add_u32 s6, s57, s58
    s_and_b32 s58, s31, 1
    s_lshl_b32 s58, s58, 12
    s_add_u32 s6, s6, s58
    s_lshl_b32 s58, s3, 7
    s_add_u32 s6, s6, s58
    s_mov_b32 s8, s57
    s_and_b32 s59, s3, 3
    s_lshl_b32 s58, s31, 2
    s_add_u32 s59, s59, s58
    s_lshl_b32 s59, s59, 7
    s_add_u32 s59, s59, s57
    s_add_u32 s59, s59, 262144
    s_add_u32 s10, s28, s59
    s_addc_u32 s11, s29, 0
    s_lshr_b32 s58, s63, 2
    s_xor_b32 s58, s58, 0
    s_mul_i32 s58, s58, 8192
    s_add_u32 s7, s57, s58
    s_cmp_eq_u32 s30, 5
    s_cbranch_scc0 L_skip_10
    s_cmp_eq_u32 s52, 31
    s_cbranch_scc0 L_skip_11
    s_mov_b64 exec, 0xffffff
    buffer_store_dwordx4 v[12:15], v10, s[40:43], s72 offen sc1
    s_mov_b64 exec, -1
L_skip_11:
    s_cmp_lt_u32 s3, 20
    s_cbranch_scc0 L_skip_12
    v_and_b32 v16, 7, v0
    v_lshlrev_b32 v16, 4, v16
    v_bfe_u32 v17, v0, 3, 1
    v_lshl_add_u32 v16, v17, 13, v16
    v_lshrrev_b32 v17, 4, v0
    v_mul_u32_u24 v17, 66048, v17
    v_add_u32 v16, v17, v16
    s_add_u32 s57, s6, 0
    buffer_store_dwordx4 v[12:15], v16, s[40:43], s57 offen sc1
L_skip_12:
    s_cmp_eq_u32 s3, 20
    s_cbranch_scc0 L_skip_13
    s_lshl_b32 s58, s31, 9
    s_add_u32 s58, s58, s8
    s_add_u32 s58, s58, 266240
    v_and_b32 v16, 7, v0
    v_lshlrev_b32 v16, 4, v16
    v_bfe_u32 v60, v0, 3, 1
    v_lshl_add_u32 v16, v60, 13, v16
    v_lshrrev_b32 v60, 4, v0
    v_lshl_add_u32 v16, v60, 28, v16
    buffer_store_dwordx4 v[12:15], v16, s[40:43], s58 offen sc1
L_skip_13:
    s_sub_u32 s58, s3, 20
    s_cmp_lt_u32 s58, 4
    s_cselect_b32 s59, s59, 0x7f000000
    v_and_b32 v16, 7, v0
    v_lshlrev_b32 v16, 4, v16
    v_bfe_u32 v60, v0, 3, 1
    v_lshl_add_u32 v16, v60, 13, v16
    v_lshrrev_b32 v60, 4, v0
    v_lshl_add_u32 v16, v60, 28, v16
    buffer_store_dwordx4 v[12:15], v16, s[40:43], s59 offen sc1
    s_mul_i32 s57, s52, 2208
    s_add_u32 s57, s57, s62
    s_mov_b64 exec, 0x3ff
    buffer_store_dwordx4 v[12:15], v10, s[40:43], s57 offen offset:2048
    s_mov_b64 exec, -1
    buffer_store_dwordx4 v[12:15], v10, s[40:43], s57 offen offset:0
    buffer_store_dwordx4 v[12:15], v10, s[40:43], s57 offen offset:1024
    s_mov_b64 exec, -1
    v_lshlrev_b32 v16, 4, v0
    v_add_u32 v16, 159744, v16
    ds_write_b128 v16, v[12:15]
    v_subrev_u32 v16, 8, v0
    v_cmp_gt_u32 vcc, 40, v16
    v_mov_b32 v16, 0x3f803f80
    s_nop 0
    v_cndmask_b32 v18, 0, v16, vcc
    v_min_u32 v16, 55, v0
    v_lshlrev_b32 v16, 2, v16
    v_add_u32 v16, 160992, v16
    ds_write_b32 v16, v18
    v_and_b32 v3, 7, v0
    v_lshlrev_b32 v3, 5, v3
L_skip_10:
    s_cmp_eq_u32 s30, 7
    s_cbranch_scc0 L_skip_14
    v_and_b32 v60, 31, v0
    v_min_u32 v60, 19, v60
    s_mul_i32 s57, s54, 160
    v_lshrrev_b32 v16, 5, v0
    v_lshlrev_b32 v16, 2, v16
    v_add_u32 v16, s57, v16
    v_lshl_add_u32 v16, v60, 3, v16
    global_load_dword v28, v16, s[4:5]
    global_load_dword v4, v16, s[22:23]
L_skip_14:
    s_sub_u32 s58, s30, 4
    s_cmp_lt_u32 s58, 3
    s_cbranch_scc0 L_skip_15
    s_mul_i32 s57, s31, 3
    s_add_u32 s57, s57, s58
    s_lshl_b32 s57, s57, 7
    v_and_b32 v16, 15, v0
    v_lshlrev_b32 v16, 3, v16
    v_lshrrev_b32 v60, 4, v0
    v_lshl_add_u32 v16, v60, 1, v16
    v_add_u32 v16, s57, v16
    global_load_short_d16_hi v4, v16, s[18:19]
L_skip_15:
    v_bfe_u32 v8, v0, 1, 3
    v_lshrrev_b32 v9, 4, v0
    v_xor_b32 v9, v8, v9
    v_bfe_u32 v8, v0, 2, 1
    v_lshlrev_b32 v8, 10, v8
    v_bfe_u32 v60, v0, 3, 1
    v_lshl_add_u32 v8, v60, 9, v8
    v_and_b32 v60, 3, v0
    v_lshl_add_u32 v8, v60, 7, v8
    v_add_u32 v8, s61, v8
    v_lshl_add_u32 v8, v9, 4, v8
    v_xor_b32 v9, 64, v8
    v_bfe_u32 v1, v0, 1, 1
    v_mul_u32_u24 v1, 43690, v1
    v_add_u32 v1, 17476, v1
    s_waitcnt vmcnt(31)
    s_barrier
    ds_read_b128 v[64:67], v8 offset:0
    ds_read_b128 v[68:71], v9 offset:0
    s_cmp_eq_u32 s30, 6
    s_cbranch_scc0 L_skip_16
    s_mov_b32 s57, 256
    s_mov_b32 s58, 195840
    s_mov_b32 m0, 124928
L_dma_17:
    s_waitcnt vmcnt(22)
L_go_18:
    buffer_load_dwordx4 v5, s[32:35], s57 offen offset:0 nt lds
    buffer_load_dwordx4 v6, s[32:35], s58 offen offset:1024 nt lds
    s_add_u32 s57, s57, 24576
    s_add_u32 s58, s58, 24576
    s_add_u32 m0, m0, 2048
    s_cmp_lg_u32 m0, 141312
    s_cbranch_scc1 L_dma_17
L_skip_16:
    s_waitcnt lgkmcnt(0)
    s_cmp_eq_u32 s30, 5
    s_cbranch_scc0 L_skip_19
    s_cmp_eq_u32 s52, 31
    s_cbranch_scc0 L_skip_20
    s_lshl_b32 s57, s31, 5
    v_mov_b32 v16, s57
    s_add_u32 s57, s63, 1
    v_mov_b32 v12, s57
    s_waitcnt vmcnt(5)
    s_mov_b64 exec, 0x1
    global_store_dword v16, v12, s[26:27] sc1
    s_mov_b64 exec, -1
L_skip_20:
L_skip_19:
    s_waitcnt vmcnt(31)
    s_barrier
    ds_read_b128 v[72:75], v8 offset:16384
    ds_read_b128 v[76:79], v9 offset:16384
    s_cmp_eq_u32 s30, 6
    s_cbranch_scc0 L_skip_21
    s_mov_b32 s57, 493568
    s_mov_b32 s58, 492672
    s_mov_b32 s59, 491776
    s_mov_b32 m0, 15360
L_dma_22:
    s_waitcnt vmcnt(22)
L_go_23:
    buffer_load_dwordx4 v2, s[44:47], s57 offen offset:0 nt lds
    buffer_load_dwordx4 v2, s[44:47], s58 offen offset:1024 nt lds
    buffer_load_dwordx4 v2, s[44:47], s59 offen offset:2048 nt lds
    s_add_u32 s57, s57, 98304
    s_add_u32 s58, s58, 98304
    s_add_u32 s59, s59, 98304
    s_add_u32 m0, m0, 3072
    s_cmp_lg_u32 m0, 30720
    s_cbranch_scc1 L_dma_22
    s_mov_b32 s57, 393216
    s_mov_b32 s58, 588800
    s_mov_b32 m0, 141312
L_dma_24:
    s_waitcnt vmcnt(22)
L_go_25:
    buffer_load_dwordx4 v5, s[32:35], s57 offen offset:0 nt lds
    buffer_load_dwordx4 v6, s[32:35], s58 offen offset:1024 nt lds
    s_add_u32 s57, s57, 24576
    s_add_u32 s58, s58, 24576
    s_add_u32 m0, m0, 2048
    s_cmp_lg_u32 m0, 157696
    s_cbranch_scc1 L_dma_24
L_skip_21:
    s_waitcnt lgkmcnt(0)
    s_cmp_lt_u32 s30, 4
    s_cbranch_scc0 L_skip_26
    s_mov_b64 exec, 0
    s_cmp_eq_u32 s30, 1
    s_cbranch_scc1 L_pad1
    s_cmp_eq_u32 s30, 2
    s_cbranch_scc1 L_pad2
    s_cmp_eq_u32 s30, 3
    s_cbranch_scc1 L_pad3
    s_branch L_pad0
    s_nop 0
    s_nop 0
L_padback:
    s_mov_b64 exec, -1
L_skip_26:
    s_waitcnt vmcnt(31)
    s_barrier
    ds_read_b128 v[80:83], v8 offset:32768
    ds_read_b128 v[84:87], v9 offset:32768
    s_cmp_eq_u32 s30, 6
    s_cbranch_scc0 L_skip_27
    s_cmp_lg_u32 s53, 3
    s_cbranch_scc0 L_wb_28
    s_mul_i32 s57, s31, 983040
    s_lshl_b32 s58, s3, 6
    s_add_u32 s57, s57, s58
    v_bfe_u32 v38, v0, 4, 1
    v_lshlrev_b32 v38, 1, v38
    v_xor_b32 v38, v38, v0
    v_and_b32 v38, 3, v38
    v_lshrrev_b32 v3, 5, v0
    v_mul_u32_u24 v3, 10240, v3
    v_bfe_u32 v39, v0, 4, 1
    v_mul_u32_u24 v39, 2560, v39
    v_add_u32 v3, v39, v3
    v_bfe_u32 v39, v0, 3, 1
    v_mul_u32_u24 v39, 5120, v39
    v_add_u32 v3, v39, v3
    v_bfe_u32 v39, v0, 2, 1
    v_mul_u32_u24 v39, 20480, v39
    v_add_u32 v3, v39, v3
    v_add_u32 v3, s57, v3
    v_lshl_add_u32 v3, v38, 4, v3
    s_mov_b32 s14, 40960
    s_mov_b32 s15, 256
    s_branch L_we_29
    s_nop 0
    s_nop 0
L_wb_28:
    s_mul_i32 s57, s31, 384
    s_mul_i32 s58, s54, 245760
    s_add_u32 s57, s57, s58
    v_lshlrev_b32 v3, 4, v0
    v_add_u32 v3, s57, v3
    v_mov_b32 v38, 2688
    v_cmp_lt_u32 vcc, 23, v0
    s_nop 1
    v_cndmask_b32 v38, 0, v38, vcc
    v_add_u32 v3, v38, v3
    v_mov_b32 v38, 0x7f000000
    v_cmp_lt_u32 vcc, 47, v0
    s_nop 1
    v_cndmask_b32 v3, v3, v38, vcc
    s_mov_b32 s14, 12288
    s_mov_b32 s15, 5120
L_we_29:
    s_mul_i32 s57, s14, 0
    s_mov_b32 m0, 30720
    s_nop 0
    buffer_load_dwordx4 v3, s[48:51], s57 offen offset:0 nt lds
    s_mul_i32 s57, s14, 0
    s_add_u32 s57, s57, s15
    s_mov_b32 m0, 30720
    s_nop 0
    buffer_load_dwordx4 v3, s[48:51], s57 offen offset:1024 nt lds
    s_mov_b32 s57, 393344
    s_mov_b32 s58, 588928
    s_mov_b32 m0, 92160
L_dma_30:
    s_waitcnt vmcnt(22)
L_go_31:
    buffer_load_dwordx4 v5, s[32:35], s57 offen offset:0 nt lds
    buffer_load_dwordx4 v6, s[32:35], s58 offen offset:1024 nt lds
    s_add_u32 s57, s57, 24576
    s_add_u32 s58, s58, 24576
    s_add_u32 m0, m0, 2048
    s_cmp_lg_u32 m0, 108544
    s_cbranch_scc1 L_dma_30
    s_mul_i32 s57, s14, 1
    s_mov_b32 m0, 32768
    s_nop 0
    buffer_load_dwordx4 v3, s[48:51], s57 offen offset:0 nt lds
    s_mul_i32 s57, s14, 1
    s_add_u32 s57, s57, s15
    s_mov_b32 m0, 32768
    s_nop 0
    buffer_load_dwordx4 v3, s[48:51], s57 offen offset:1024 nt lds
    s_mov_b32 s57, 393472
    s_mov_b32 s58, 589056
    s_mov_b32 m0, 108544
L_dma_32:
    s_waitcnt vmcnt(22)
L_go_33:
    buffer_load_dwordx4 v5, s[32:35], s57 offen offset:0 nt lds
    buffer_load_dwordx4 v6, s[32:35], s58 offen offset:1024 nt lds
    s_add_u32 s57, s57, 24576
    s_add_u32 s58, s58, 24576
    s_add_u32 m0, m0, 2048
    s_cmp_lg_u32 m0, 124928
    s_cbranch_scc1 L_dma_32
L_skip_27:
    s_waitcnt lgkmcnt(0)
    s_cmp_lt_u32 s30, 5
    s_cbranch_scc0 L_skip_34
    s_waitcnt vmcnt(0)
L_skip_34:
    s_cmp_eq_u32 s30, 7
    s_cbranch_scc0 L_skip_35
    v_and_b32 v60, 31, v0
    v_cmp_gt_u32 s[64:65], 20, v60
    v_min_u32 v60, 19, v60
    v_lshrrev_b32 v35, 5, v0
    v_lshlrev_b32 v35, 2, v35
    v_add_u32 v35, 160832, v35
    v_lshl_add_u32 v35, v60, 3, v35
    s_mul_i32 s66, s53, 12416
    s_add_u32 s66, s66, s62
    s_add_u32 s66, s66, 70656
    s_add_u32 s67, s66, 12288
    s_lshl_b32 s57, s54, 3
    v_lshrrev_b32 v34, 5, v0
    v_lshlrev_b32 v34, 2, v34
    v_add_u32 v34, s57, v34
    v_and_b32 v60, 31, v0
    v_mov_b32 v61, 0x7f000000
    v_cmp_ne_u32 vcc, 31, v60
    s_nop 1
    v_cndmask_b32 v34, v34, v61, vcc
    v_mov_b32 v61, 0x3f803f80
    s_waitcnt vmcnt(0)
    ds_write_b32 v35, v28
    s_waitcnt lgkmcnt(0)
L_skip_35:
    s_cmp_eq_u32 s30, 5
    s_cbranch_scc0 L_skip_36
    s_waitcnt vmcnt(0)
    s_lshr_b32 s65, s63, 2
    s_sub_u32 s58, s3, 20
    s_cmp_lt_u32 s58, 4
    s_cbranch_scc0 L_skip_37
    s_mov_b32 s67, 0
    s_load_dword s66, s[10:11], 0
    s_load_dword s67, s[10:11], 8192
    s_waitcnt lgkmcnt(1)
    s_sleep 1
    s_mov_b32 s65, s67
L_skip_37:
L_skip_36:
    s_waitcnt vmcnt(36)
    s_barrier
    ds_read_b128 v[88:91], v8 offset:49152
    ds_read_b128 v[92:95], v9 offset:49152
    s_cmp_eq_u32 s30, 6
    s_cbranch_scc0 L_skip_38
    s_mul_i32 s57, s14, 2
    s_mov_b32 m0, 34816
    s_nop 0
    buffer_load_dwordx4 v3, s[48:51], s57 offen offset:0 nt lds
    s_mul_i32 s57, s14, 2
    s_add_u32 s57, s57, s15
    s_mov_b32 m0, 34816
    s_nop 0
    buffer_load_dwordx4 v3, s[48:51], s57 offen offset:1024 nt lds
    s_mov_b32 s57, 786432
    s_mov_b32 s58, 982016
    s_mov_b32 m0, 124928
L_dma_39:
    s_waitcnt vmcnt(22)
L_go_40:
    buffer_load_dwordx4 v5, s[32:35], s57 offen offset:0 nt lds
    buffer_load_dwordx4 v6, s[32:35], s58 offen offset:1024 nt lds
    s_add_u32 s57, s57, 24576
    s_add_u32 s58, s58, 24576
    s_add_u32 m0, m0, 2048
    s_cmp_lg_u32 m0, 141312
    s_cbranch_scc1 L_dma_39
L_skip_38:
    s_waitcnt lgkmcnt(0)
    s_cmp_eq_u32 s30, 7
    s_cbranch_scc0 L_skip_41
    v_cndmask_b32 v29, 0, v28, s[64:65]
    v_dot2_f32_bf16 v33, v29, v61, 0
    v_dot2_f32_bf16 v32, v29, v29, 0
    v_lshlrev_b32 v2, 16, v28
    v_and_b32 v3, 0xffff0000, v28
    s_cmp_eq_u32 s55, 0
    v_permlane32_swap_b32 v33, v32
    v_add_f32 v33, v33, v32
    s_nop 1
    v_add_f32_dpp v33, v33, v33 row_ror:8 row_mask:0xf bank_mask:0xf
    s_nop 1
    v_add_f32_dpp v33, v33, v33 row_ror:4 row_mask:0xf bank_mask:0xf
    s_nop 1
    v_add_f32_dpp v33, v33, v33 row_ror:2 row_mask:0xf bank_mask:0xf
    s_nop 1
    v_add_f32_dpp v33, v33, v33 row_ror:1 row_mask:0xf bank_mask:0xf
    s_nop 1
    v_add_f32_dpp v33, v33, v33 row_bcast:15 row_mask:0xa bank_mask:0xf
    s_cbranch_scc1 L_gs_42
    buffer_store_dword v33, v34, s[40:43], s67 offen
L_gb_43:
    s_waitcnt vmcnt(1)
L_skip_41:
    s_cmp_lt_u32 s30, 6
    s_cbranch_scc0 L_skip_44
    s_lshr_b32 s57, s30, 1
    s_mul_i32 s57, s57, 1024
    s_and_b32 s58, s30, 1
    s_lshl_b32 s58, s58, 6
    s_add_u32 s57, s57, s58
    v_lshrrev_b32 v18, 5, v0
    v_mul_u32_u24 v18, 6144, v18
    v_bfe_u32 v60, v0, 3, 1
    v_mul_u32_u24 v60, 3072, v60
    v_add_u32 v18, v60, v18
    v_bfe_u32 v60, v0, 4, 1
    v_lshl_add_u32 v18, v60, 9, v18
    v_bfe_u32 v60, v0, 2, 1
    v_lshl_add_u32 v18, v60, 7, v18
    v_and_b32 v60, 3, v0
    v_lshl_add_u32 v18, v60, 3, v18
    v_add_u32 v18, s57, v18
    v_bfe_u32 v19, v0, 4, 1
    v_mul_u32_u24 v19, 3072, v19
    v_bfe_u32 v60, v0, 3, 1
    v_lshl_add_u32 v19, v60, 9, v19
    v_bfe_u32 v60, v0, 2, 1
    v_lshl_add_u32 v19, v60, 7, v19
    v_and_b32 v60, 3, v0
    v_lshl_add_u32 v19, v60, 3, v19
    v_add_u32 v19, s57, v19
    v_add_u32 v19, 24576, v19
    ds_read_b64_tr_b16 v[28:29], v18 offset:0
    ds_read_b64_tr_b16 v[30:31], v18 offset:256
    ds_read_b64_tr_b16 v[32:33], v18 offset:12288
    ds_read_b64_tr_b16 v[34:35], v18 offset:12544
    ds_read_b64_tr_b16 v[36:37], v19 offset:0
    ds_read_b64_tr_b16 v[38:39], v19 offset:256
    ds_read_b64_tr_b16 v[40:41], v18 offset:32
    ds_read_b64_tr_b16 v[42:43], v18 offset:288
    ds_read_b64_tr_b16 v[44:45], v18 offset:12320
    ds_read_b64_tr_b16 v[46:47], v18 offset:12576
    ds_read_b64_tr_b16 v[48:49], v19 offset:32
    ds_read_b64_tr_b16 v[50:51], v19 offset:288
    v_lshrrev_b32 v52, 4, v0
    v_lshlrev_b32 v52, 5, v52
    v_bfe_u32 v60, v0, 1, 1
    v_lshl_add_u32 v52, v60, 4, v52
    v_and_b32 v60, 1, v0
    v_mul_u32_u24 v60, 192, v60
    v_add_u32 v52, v60, v52
    v_add_u32 v52, 160832, v52
    v_lshrrev_b32 v53, 4, v0
    v_lshlrev_b32 v53, 4, v53
    v_bfe_u32 v60, v0, 1, 1
    v_lshl_add_u32 v53, v60, 3, v53
    v_and_b32 v60, 1, v0
    v_mul_u32_u24 v60, 192, v60
    v_add_u32 v53, v60, v53
    v_add_u32 v53, 160960, v53
    v_mov_b64 v[20:21], 0
    v_mov_b64 v[22:23], 0
    v_mov_b64 v[24:25], 0
    v_mov_b64 v[26:27], 0
    s_lshr_b32 s57, s30, 1
    s_lshl_b32 s57, s57, 11
    s_lshl_b32 s58, s58, 1
    s_add_u32 s57, s57, s58
    s_lshl_b32 s58, s54, 8
    s_add_u32 s57, s57, s58
    v_and_b32 v54, 31, v0
    v_lshlrev_b32 v54, 2, v54
    v_lshrrev_b32 v60, 5, v0
    v_mul_u32_u24 v60, 6144, v60
    v_add_u32 v54, v60, v54
    v_add_u32 v54, s57, v54
    s_mul_i32 s59, s53, 12416
    s_add_u32 s59, s59, s62
    s_add_u32 s59, s59, 70656
    s_add_u32 s60, s59, 12288
    ds_read_b128 v[12:15], v52
    ds_read_b64 v[16:17], v53
    s_waitcnt lgkmcnt(1)
    v_smfmac_f32_16x16x64_bf16 v[20:23], v[12:15], v[28:35], v1
    v_smfmac_f32_16x16x64_bf16 v[24:27], v[12:15], v[40:47], v1
    s_waitcnt lgkmcnt(0)
    v_smfmac_f32_16x16x32_bf16 v[20:23], v[16:17], v[36:39], v1
    v_smfmac_f32_16x16x32_bf16 v[24:27], v[16:17], v[48:51], v1
    s_cmp_eq_u32 s55, 0
    s_nop 5
    v_add_f32 v12, v20, v22
    s_nop 1
    v_add_f32_dpp v12, v24, v26 quad_perm:[0,1,2,3] row_mask:0x2 bank_mask:0xf
    s_nop 1
    v_add_f32_dpp v12, v21, v23 quad_perm:[0,1,2,3] row_mask:0x4 bank_mask:0xf
    s_nop 1
    v_add_f32_dpp v12, v25, v27 quad_perm:[0,1,2,3] row_mask:0x8 bank_mask:0xf
    s_cbranch_scc1 L_gs_45
    buffer_store_dword v12, v54, s[40:43], s59 offen
L_gb_46:
L_skip_44:
    s_cmp_eq_u32 s30, 5
    s_cbranch_scc0 L_skip_47
    global_load_dword v2, v3, s[26:27] sc1
L_skip_47:
    s_waitcnt vmcnt(36)
    s_barrier
    ds_read_b128 v[96:99], v8 offset:0
    ds_read_b128 v[100:103], v9 offset:0
    s_cmp_eq_u32 s30, 6
    s_cbranch_scc0 L_skip_48
    s_mul_i32 s57, s14, 3
    s_mov_b32 m0, 36864
    s_nop 0
    buffer_load_dwordx4 v3, s[48:51], s57 offen offset:0 nt lds
    s_mul_i32 s57, s14, 3
    s_add_u32 s57, s57, s15
    s_mov_b32 m0, 36864
    s_nop 0
    buffer_load_dwordx4 v3, s[48:51], s57 offen offset:1024 nt lds
    s_mov_b32 s57, 786560
    s_mov_b32 s58, 982144
    s_mov_b32 m0, 141312
L_dma_49:
    s_waitcnt vmcnt(22)
L_go_50:
    buffer_load_dwordx4 v5, s[32:35], s57 offen offset:0 nt lds
    buffer_load_dwordx4 v6, s[32:35], s58 offen offset:1024 nt lds
    s_add_u32 s57, s57, 24576
    s_add_u32 s58, s58, 24576
    s_add_u32 m0, m0, 2048
    s_cmp_lg_u32 m0, 157696
    s_cbranch_scc1 L_dma_49
L_skip_48:
    s_waitcnt lgkmcnt(0)
    s_waitcnt vmcnt(36)
    s_barrier
    ds_read_b128 v[104:107], v8 offset:16384
    ds_read_b128 v[108:111], v9 offset:16384
    s_cmp_eq_u32 s30, 6
    s_cbranch_scc0 L_skip_51
    s_mul_i32 s57, s14, 4
    s_mov_b32 m0, 38912
    s_nop 0
    buffer_load_dwordx4 v3, s[48:51], s57 offen offset:0 nt lds
    s_mul_i32 s57, s14, 4
    s_add_u32 s57, s57, s15
    s_mov_b32 m0, 38912
    s_nop 0
    buffer_load_dwordx4 v3, s[48:51], s57 offen offset:1024 nt lds
    s_mov_b32 s57, 786688
    s_mov_b32 s58, 982272
    s_mov_b32 m0, 92160
L_dma_52:
    s_waitcnt vmcnt(22)
L_go_53:
    buffer_load_dwordx4 v5, s[32:35], s57 offen offset:0 nt lds
    buffer_load_dwordx4 v6, s[32:35], s58 offen offset:1024 nt lds
    s_add_u32 s57, s57, 24576
    s_add_u32 s58, s58, 24576
    s_add_u32 m0, m0, 2048
    s_cmp_lg_u32 m0, 108544
    s_cbranch_scc1 L_dma_52
L_skip_51:
    s_waitcnt lgkmcnt(0)
    s_cmp_lg_u32 s30, 6
    s_cbranch_scc0 L_skip_54
    s_waitcnt vmcnt(0)
L_skip_54:
    s_waitcnt vmcnt(36)
    s_barrier
    ds_read_b128 v[112:115], v8 offset:32768
    ds_read_b128 v[116:119], v9 offset:32768
    s_cmp_eq_u32 s30, 6
    s_cbranch_scc0 L_skip_55
    s_mul_i32 s57, s14, 5
    s_mov_b32 m0, 40960
    s_nop 0
    buffer_load_dwordx4 v3, s[48:51], s57 offen offset:0 nt lds
    s_mul_i32 s57, s14, 5
    s_add_u32 s57, s57, s15
    s_mov_b32 m0, 40960
    s_nop 0
    buffer_load_dwordx4 v3, s[48:51], s57 offen offset:1024 nt lds
    s_mov_b32 s57, 1179648
    s_mov_b32 s58, 1375232
    s_mov_b32 m0, 108544
L_dma_56:
    s_waitcnt vmcnt(22)
L_go_57:
    buffer_load_dwordx4 v5, s[32:35], s57 offen offset:0 nt lds
    buffer_load_dwordx4 v6, s[32:35], s58 offen offset:1024 nt lds
    s_add_u32 s57, s57, 24576
    s_add_u32 s58, s58, 24576
    s_add_u32 m0, m0, 2048
    s_cmp_lg_u32 m0, 124928
    s_cbranch_scc1 L_dma_56
L_skip_55:
    s_waitcnt lgkmcnt(0)
    s_cmp_eq_u32 s30, 5
    s_cbranch_scc0 L_skip_58
L_cw_59:
    v_readlane_b32 s57, v2, s31
    s_cmp_eq_u32 s57, 0
    s_cbranch_scc1 L_cr_60
    s_lshr_b32 s58, s63, 2
    s_xor_b32 s58, s58, s65
    s_and_b32 s58, s58, 1
    v_mov_b32 v25, s58
    s_sub_u32 s57, s57, 1
    s_cmp_eq_u32 s57, s63
    s_cselect_b32 s64, 1, 0
    s_cbranch_scc0 L_far_61
    s_lshl_b32 s57, s52, 2
    s_add_u32 s57, s57, s72
    s_mov_b64 exec, 1
    buffer_store_dword v25, v0, s[40:43], s57 offen offset:0
    s_mov_b64 exec, -1
L_fb_62:
L_skip_58:
    s_waitcnt vmcnt(36)
    s_barrier
    ds_read_b128 v[120:123], v8 offset:49152
    ds_read_b128 v[124:127], v9 offset:49152
    s_cmp_eq_u32 s30, 6
    s_cbranch_scc0 L_skip_63
    s_mul_i32 s57, s14, 6
    s_mov_b32 m0, 43008
    s_nop 0
    buffer_load_dwordx4 v3, s[48:51], s57 offen offset:0 nt lds
    s_mul_i32 s57, s14, 6
    s_add_u32 s57, s57, s15
    s_mov_b32 m0, 43008
    s_nop 0
    buffer_load_dwordx4 v3, s[48:51], s57 offen offset:1024 nt lds
    s_mov_b32 s57, 1179776
    s_mov_b32 s58, 1375360
    s_mov_b32 m0, 124928
L_dma_64:
    s_waitcnt vmcnt(22)
L_go_65:
    buffer_load_dwordx4 v5, s[32:35], s57 offen offset:0 nt lds
    buffer_load_dwordx4 v6, s[32:35], s58 offen offset:1024 nt lds
    s_add_u32 s57, s57, 24576
    s_add_u32 s58, s58, 24576
    s_add_u32 m0, m0, 2048
    s_cmp_lg_u32 m0, 141312
    s_cbranch_scc1 L_dma_64
L_skip_63:
    s_waitcnt lgkmcnt(0)
    s_waitcnt vmcnt(36)
    s_barrier
    ds_read_b128 v[128:131], v8 offset:0
    ds_read_b128 v[132:135], v9 offset:0
    s_cmp_eq_u32 s30, 6
    s_cbranch_scc0 L_skip_66
    s_mul_i32 s57, s14, 7
    s_mov_b32 m0, 45056
    s_nop 0
    buffer_load_dwordx4 v3, s[48:51], s57 offen offset:0 nt lds
    s_mul_i32 s57, s14, 7
    s_add_u32 s57, s57, s15
    s_mov_b32 m0, 45056
    s_nop 0
    buffer_load_dwordx4 v3, s[48:51], s57 offen offset:1024 nt lds
    s_mov_b32 s57, 1179904
    s_mov_b32 s58, 1375488
    s_mov_b32 m0, 141312
L_dma_67:
    s_waitcnt vmcnt(22)
L_go_68:
    buffer_load_dwordx4 v5, s[32:35], s57 offen offset:0 nt lds
    buffer_load_dwordx4 v6, s[32:35], s58 offen offset:1024 nt lds
    s_add_u32 s57, s57, 24576
    s_add_u32 s58, s58, 24576
    s_add_u32 m0, m0, 2048
    s_cmp_lg_u32 m0, 157696
    s_cbranch_scc1 L_dma_67
L_skip_66:
    s_waitcnt lgkmcnt(0)
    s_cmp_eq_u32 s30, 5
    s_cbranch_scc0 L_skip_69
    v_lshlrev_b32 v24, 2, v0
    buffer_load_dword v2, v24, s[40:43], s72 offen sc1
L_skip_69:
    s_waitcnt vmcnt(36)
    s_barrier
    ds_read_b128 v[136:139], v8 offset:16384
    ds_read_b128 v[140:143], v9 offset:16384
    s_cmp_eq_u32 s30, 6
    s_cbranch_scc0 L_skip_70
    s_mul_i32 s57, s14, 8
    s_mov_b32 m0, 47104
    s_nop 0
    buffer_load_dwordx4 v3, s[48:51], s57 offen offset:0 nt lds
    s_mul_i32 s57, s14, 8
    s_add_u32 s57, s57, s15
    s_mov_b32 m0, 47104
    s_nop 0
    buffer_load_dwordx4 v3, s[48:51], s57 offen offset:1024 nt lds
    s_mov_b32 s57, 0
    s_mov_b32 s58, 392192
    s_mov_b32 m0, 92160
L_dma_71:
    s_waitcnt vmcnt(22)
L_go_72:
    buffer_load_dwordx4 v7, s[36:39], s57 offen offset:0 nt lds
    buffer_load_dwordx4 v7, s[36:39], s58 offen offset:1024 nt lds
    s_add_u32 s57, s57, 24576
    s_add_u32 s58, s58, 24576
    s_add_u32 m0, m0, 2048
    s_cmp_lg_u32 m0, 108544
    s_cbranch_scc1 L_dma_71
L_skip_70:
    s_waitcnt lgkmcnt(0)
    s_waitcnt vmcnt(36)
    s_barrier
    ds_read_b128 v[144:147], v8 offset:32768
    ds_read_b128 v[148:151], v9 offset:32768
    s_cmp_eq_u32 s30, 6
    s_cbranch_scc0 L_skip_73
    s_mul_i32 s57, s14, 9
    s_mov_b32 m0, 49152
    s_nop 0
    buffer_load_dwordx4 v3, s[48:51], s57 offen offset:0 nt lds
    s_mul_i32 s57, s14, 9
    s_add_u32 s57, s57, s15
    s_mov_b32 m0, 49152
    s_nop 0
    buffer_load_dwordx4 v3, s[48:51], s57 offen offset:1024 nt lds
    s_mov_b32 s57, 128
    s_mov_b32 s58, 392320
    s_mov_b32 m0, 108544
L_dma_74:
    s_waitcnt vmcnt(22)
L_go_75:
    buffer_load_dwordx4 v7, s[36:39], s57 offen offset:0 nt lds
    buffer_load_dwordx4 v7, s[36:39], s58 offen offset:1024 nt lds
    s_add_u32 s57, s57, 24576
    s_add_u32 s58, s58, 24576
    s_add_u32 m0, m0, 2048
    s_cmp_lg_u32 m0, 124928
    s_cbranch_scc1 L_dma_74
L_skip_73:
    s_waitcnt lgkmcnt(0)
    s_cmp_eq_u32 s30, 5
    s_cbranch_scc0 L_skip_76
L_cw_77:
    s_waitcnt vmcnt(0)
    v_cmp_ne_u32 vcc, -1, v2
    s_mov_b32 s57, 0
    s_mov_b32 s68, 2
    s_cmp_eq_u32 s64, 0
    s_cbranch_scc1 L_cd_79
    s_cmp_lg_u32 vcc_hi, 0
    s_cbranch_scc1 L_cd_79
    s_cmp_lg_u32 vcc_lo, -1
    s_cbranch_scc1 L_cr_78
    v_cmp_eq_u32 vcc, 1, v2
    s_bcnt1_i32_b32 s68, vcc_lo
    s_mov_b32 s57, 1
L_cd_79:
    v_mov_b32 v37, 160768
    v_mov_b32 v38, s57
    ds_write_b32 v37, v38
    s_waitcnt lgkmcnt(0)
L_skip_76:
    s_waitcnt vmcnt(36)
    s_barrier
    ds_read_b128 v[152:155], v8 offset:49152
    ds_read_b128 v[156:159], v9 offset:49152
    s_cmp_eq_u32 s30, 6
    s_cbranch_scc0 L_skip_80
    s_mul_i32 s57, s14, 10
    s_mov_b32 m0, 51200
    s_nop 0
    buffer_load_dwordx4 v3, s[48:51], s57 offen offset:0 nt lds
    s_mul_i32 s57, s14, 10
    s_add_u32 s57, s57, s15
    s_mov_b32 m0, 51200
    s_nop 0
    buffer_load_dwordx4 v3, s[48:51], s57 offen offset:1024 nt lds
    s_mov_b32 s57, 256
    s_mov_b32 s58, 392448
    s_mov_b32 m0, 124928
L_dma_81:
    s_waitcnt vmcnt(22)
L_go_82:
    buffer_load_dwordx4 v7, s[36:39], s57 offen offset:0 nt lds
    buffer_load_dwordx4 v7, s[36:39], s58 offen offset:1024 nt lds
    s_add_u32 s57, s57, 24576
    s_add_u32 s58, s58, 24576
    s_add_u32 m0, m0, 2048
    s_cmp_lg_u32 m0, 141312
    s_cbranch_scc1 L_dma_81
L_skip_80:
    s_waitcnt lgkmcnt(0)
    v_lshrrev_b32 v8, 2, v0
    v_lshlrev_b32 v8, 7, v8
    v_bfe_u32 v60, v0, 3, 2
    v_lshl_add_u32 v8, v60, 5, v8
    v_and_b32 v60, 3, v0
    v_lshl_add_u32 v8, v60, 3, v8
    v_add_u32 v8, s61, v8
    v_xor_b32 v9, 32, v8
    v_xor_b32 v10, 64, v8
    v_xor_b32 v11, 96, v8
    v_mov_b32 v41, 160768
    ds_read_b32 v42, v41
    s_waitcnt lgkmcnt(0)
    v_readfirstlane_b32 s55, v42
    s_cmp_eq_u32 s55, 0
    s_cbranch_scc1 L_spread
L_spread_back:
    s_cmp_eq_u32 s30, 5
    s_cbranch_scc0 L_skip_94
    s_cmp_eq_u32 s52, 31
    s_cbranch_scc0 L_skip_95
    s_lshl_b32 s57, s31, 5
    v_mov_b32 v16, s57
    s_add_u32 s57, s68, 1
    v_mov_b32 v12, s57
    s_mov_b64 exec, 0x1
    global_store_dword v16, v12, s[26:27] offset:4 sc1
    s_mov_b64 exec, -1
L_skip_95:
L_skip_94:
    s_sub_u32 s58, s30, 1
    s_cmp_lt_u32 s58, 3
    s_cbranch_scc0 L_skip_96
    s_mul_i32 s59, s53, 12416
    s_add_u32 s59, s59, s62
    s_add_u32 s59, s59, 70656
    s_add_u32 s60, s59, 12288
    s_lshl_b32 s57, s58, 11
    v_lshlrev_b32 v48, 4, v0
    v_add_u32 v48, s57, v48
    v_and_b32 v49, 7, v0
    v_lshlrev_b32 v49, 3, v49
    s_add_u32 s57, s59, 6144
    buffer_load_dwordx4 v[12:15], v48, s[40:43], s59 offen offset:0 sc1 nt
    buffer_load_dwordx4 v[16:19], v48, s[40:43], s59 offen offset:1024 sc1 nt
    buffer_load_dwordx4 v[28:31], v48, s[40:43], s57 offen offset:0 sc1 nt
    buffer_load_dwordx4 v[32:35], v48, s[40:43], s57 offen offset:1024 sc1 nt
    buffer_load_dwordx2 v[24:25], v49, s[40:43], s60 offen sc1 nt
L_skip_96:
    s_waitcnt vmcnt(36)
    s_barrier
    ds_read_b64_tr_b16 v[160:161], v8 offset:0
    ds_read_b64_tr_b16 v[168:169], v9 offset:0
    ds_read_b64_tr_b16 v[176:177], v10 offset:0
    ds_read_b64_tr_b16 v[184:185], v11 offset:0
    s_cmp_eq_u32 s30, 6
    s_cbranch_scc0 L_skip_97
    s_mul_i32 s57, s14, 11
    s_mov_b32 m0, 53248
    s_nop 0
    buffer_load_dwordx4 v3, s[48:51], s57 offen offset:0 nt lds
    s_mul_i32 s57, s14, 11
    s_add_u32 s57, s57, s15
    s_mov_b32 m0, 53248
    s_nop 0
    buffer_load_dwordx4 v3, s[48:51], s57 offen offset:1024 nt lds
    s_mov_b32 s57, 196608
    s_mov_b32 s58, 588800
    s_mov_b32 m0, 141312
L_dma_98:
    s_waitcnt vmcnt(22)
L_go_99:
    buffer_load_dwordx4 v7, s[36:39], s57 offen offset:0 nt lds
    buffer_load_dwordx4 v7, s[36:39], s58 offen offset:1024 nt lds
    s_add_u32 s57, s57, 24576
    s_add_u32 s58, s58, 24576
    s_add_u32 m0, m0, 2048
    s_cmp_lg_u32 m0, 157696
    s_cbranch_scc1 L_dma_98
L_skip_97:
    s_waitcnt lgkmcnt(0)
    s_waitcnt vmcnt(36)
    s_barrier
    ds_read_b64_tr_b16 v[192:193], v8 offset:16384
    ds_read_b64_tr_b16 v[200:201], v9 offset:16384
    ds_read_b64_tr_b16 v[208:209], v10 offset:16384
    ds_read_b64_tr_b16 v[216:217], v11 offset:16384
    s_cmp_eq_u32 s30, 6
    s_cbranch_scc0 L_skip_100
    s_mov_b32 s57, 196736
    s_mov_b32 s58, 588928
    s_mov_b32 m0, 92160
L_dma_101:
    s_waitcnt vmcnt(22)
L_go_102:
    buffer_load_dwordx4 v7, s[36:39], s57 offen offset:0 nt lds
    buffer_load_dwordx4 v7, s[36:39], s58 offen offset:1024 nt lds
    s_add_u32 s57, s57, 24576
    s_add_u32 s58, s58, 24576
    s_add_u32 m0, m0, 2048
    s_cmp_lg_u32 m0, 108544
    s_cbranch_scc1 L_dma_101
L_skip_100:
    s_waitcnt lgkmcnt(0)
    s_sub_u32 s58, s30, 1
    s_cmp_lt_u32 s58, 3
    s_cbranch_scc0 L_skip_103
    s_lshl_b32 s57, s58, 7
    v_bfe_u32 v51, v0, 2, 2
    v_lshlrev_b32 v51, 5, v51
    v_lshrrev_b32 v60, 5, v0
    v_lshl_add_u32 v51, v60, 4, v51
    v_and_b32 v60, 3, v0
    v_lshl_add_u32 v51, v60, 2, v51
    v_bfe_u32 v60, v0, 4, 1
    v_lshl_add_u32 v51, v60, 1, v51
    v_add_u32 v51, s57, v51
    v_add_u32 v51, 157696, v51
    v_mov_b32 v60, 0x3c75e03e
    v_mov_b32 v61, 0x3a71d1e6
    v_mov_b32 v47, 0x3e13985d
    s_waitcnt vmcnt(0)
    v_pk_add_f32 v[36:37], v[28:29], v[32:33]
    v_pk_add_f32 v[38:39], v[30:31], v[34:35]
    s_nop 1
    v_permlane32_swap_b32 v36, v38
    v_permlane32_swap_b32 v37, v39
    v_pk_add_f32 v[36:37], v[36:37], v[38:39]
    s_nop 1
    v_permlane16_swap_b32 v36, v37
    v_add_f32 v36, v36, v37
    v_mul_f32 v6, 0x3dd53b95, v36
    v_add_f32_dpp v48, v24, v24 row_ror:4 row_mask:0xf bank_mask:0xf
    v_add_f32_dpp v49, v25, v25 row_ror:4 row_mask:0xf bank_mask:0xf
    v_pk_add_f32 v[20:21], v[12:13], v[16:17]
    v_pk_add_f32 v[22:23], v[14:15], v[18:19]
    v_add_f32_dpp v48, v48, v48 row_ror:2 row_mask:0xf bank_mask:0xf
    v_add_f32_dpp v49, v49, v49 row_ror:2 row_mask:0xf bank_mask:0xf
    v_permlane32_swap_b32 v20, v22
    v_permlane32_swap_b32 v21, v23
    v_add_f32_dpp v48, v48, v48 row_ror:1 row_mask:0xf bank_mask:0xf
    v_add_f32_dpp v49, v49, v49 row_ror:1 row_mask:0xf bank_mask:0xf
    v_pk_add_f32 v[20:21], v[20:21], v[22:23]
    v_mul_f32 v48, v48, v60
    v_fma_f32 v49, v49, v47, v61
    v_permlane16_swap_b32 v20, v21
    v_fma_f32 v49, -v48, v48, v49
    v_add_f32 v20, v20, v21
    v_max_f32 v49, v49, v61
    v_mul_f32 v50, v6, v48
    v_rsq_f32 v49, v49
    v_cmp_u_f32 vcc, v20, v20
    v_sub_f32 v20, v20, v50
    v_mul_f32 v20, v20, v49
    v_cvt_pk_bf16_f32 v20, v20, v20
    ds_write_b16 v51, v20
    s_waitcnt lgkmcnt(0)
L_skip_103:
    s_lshl_b32 s57, s30, 7
    s_add_u32 s57, s57, 158720
    v_lshrrev_b32 v58, 4, v0
    v_lshlrev_b32 v58, 5, v58
    v_bfe_u32 v60, v0, 1, 1
    v_lshl_add_u32 v58, v60, 4, v58
    v_bfe_u32 v60, v0, 2, 2
    v_lshl_add_u32 v58, v60, 2, v58
    v_and_b32 v60, 1, v0
    v_lshl_add_u32 v58, v60, 1, v58
    v_add_u32 v58, s57, v58
    v_lshrrev_b32 v61, 4, v0
    v_lshlrev_b32 v61, 5, v61
    v_bfe_u32 v60, v0, 1, 1
    v_lshl_add_u32 v61, v60, 4, v61
    v_add_u32 v61, s57, v61
    v_bfe_u32 v62, v0, 2, 2
    v_lshlrev_b32 v62, 1, v62
    v_and_b32 v60, 1, v0
    v_lshl_add_u32 v62, v60, 0, v62
    v_mov_b32 v60, 160992
    v_cmp_eq_u32 vcc, 0, v62
    s_nop 1
    v_cndmask_b32 v52, v60, v61, vcc
    v_cmp_eq_u32 vcc, 1, v62
    s_nop 1
    v_cndmask_b32 v53, v60, v61, vcc
    v_cmp_eq_u32 vcc, 2, v62
    s_nop 1
    v_cndmask_b32 v54, v60, v61, vcc
    v_cmp_eq_u32 vcc, 3, v62
    s_nop 1
    v_cndmask_b32 v55, v60, v61, vcc
    v_cmp_eq_u32 vcc, 4, v62
    s_nop 1
    v_cndmask_b32 v56, v60, v61, vcc
    v_cmp_eq_u32 vcc, 5, v62
    s_nop 1
    v_cndmask_b32 v57, v60, v61, vcc
    s_lshl_b32 s58, s30, 2
    s_add_u32 s58, s58, 159744
    v_mov_b32 v60, s58
    v_lshlrev_b32 v59, 2, v0
    v_add_u32 v59, 158208, v59
    v_cmp_eq_u32 vcc, 63, v0
    s_nop 1
    v_cndmask_b32 v59, v59, v60, vcc
    v_and_b32 v62, 7, v0
    v_lshlrev_b32 v62, 2, v62
    v_add_u32 v62, 159744, v62
    s_lshl_b32 s57, s30, 11
    v_lshlrev_b32 v63, 4, v0
    v_add_u32 v63, s57, v63
    v_add_u32 v63, 92160, v63
    s_waitcnt vmcnt(34)
    s_barrier
    ds_read_b64_tr_b16 v[224:225], v8 offset:32768
    ds_read_b64_tr_b16 v[232:233], v9 offset:32768
    ds_read_b64_tr_b16 v[240:241], v10 offset:32768
    ds_read_b64_tr_b16 v[248:249], v11 offset:32768
    s_cmp_eq_u32 s30, 6
    s_cbranch_scc0 L_skip_104
    s_mov_b32 s57, 196864
    s_mov_b32 s58, 589056
    s_mov_b32 m0, 108544
L_dma_105:
    s_nop 0
    buffer_load_dwordx4 v7, s[36:39], s57 offen offset:0 nt lds
    buffer_load_dwordx4 v7, s[36:39], s58 offen offset:1024 nt lds
    s_add_u32 s57, s57, 24576
    s_add_u32 s58, s58, 24576
    s_add_u32 m0, m0, 2048
    s_cmp_lg_u32 m0, 124928
    s_cbranch_scc1 L_dma_105
L_skip_104:
    s_waitcnt lgkmcnt(0)
    v_lshrrev_b32 v5, 4, v0
    v_lshlrev_b32 v5, 5, v5
    v_bfe_u32 v60, v0, 1, 1
    v_lshl_add_u32 v5, v60, 4, v5
    v_add_u32 v5, 157696, v5
    ds_read_b128 v[12:15], v5 offset:0
    ds_read_b128 v[16:19], v5 offset:128
    ds_read_b128 v[20:23], v5 offset:256
    v_mov_b64 v[24:25], 0
    v_mov_b64 v[26:27], 0
    v_mov_b64 v[28:29], 0
    v_mov_b64 v[30:31], 0
    v_mov_b64 v[32:33], 0
    v_mov_b64 v[34:35], 0
    v_mov_b64 v[36:37], 0
    v_mov_b64 v[38:39], 0
    v_mov_b64 v[40:41], 0
    v_mov_b64 v[42:43], 0
    v_mov_b64 v[44:45], 0
    v_mov_b64 v[46:47], 0
    s_waitcnt lgkmcnt(0)
    v_smfmac_f32_16x16x64_bf16 v[24:27], v[12:15], v[64:71], v1
    v_smfmac_f32_16x16x64_bf16 v[24:27], v[16:19], v[72:79], v1
    v_smfmac_f32_16x16x64_bf16 v[24:27], v[20:23], v[80:87], v1
    v_smfmac_f32_16x16x64_bf16 v[28:31], v[12:15], v[88:95], v1
    v_smfmac_f32_16x16x64_bf16 v[28:31], v[16:19], v[96:103], v1
    v_smfmac_f32_16x16x64_bf16 v[28:31], v[20:23], v[104:111], v1
    v_smfmac_f32_16x16x64_bf16 v[32:35], v[12:15], v[112:119], v1
    v_smfmac_f32_16x16x64_bf16 v[32:35], v[16:19], v[120:127], v1
    v_smfmac_f32_16x16x64_bf16 v[32:35], v[20:23], v[128:135], v1
    v_smfmac_f32_16x16x64_bf16 v[36:39], v[12:15], v[136:143], v1
    v_smfmac_f32_16x16x64_bf16 v[36:39], v[16:19], v[144:151], v1
    v_smfmac_f32_16x16x64_bf16 v[36:39], v[20:23], v[152:159], v1
    v_add_f32 v24, v24, v26
    s_nop 0
    v_add_f32 v28, v28, v30
    s_nop 1
    v_add_f32 v32, v32, v34
    v_max3_f32 v61, v24, v28, v32
    v_mov_b32_dpp v24, v28 quad_perm:[0,1,2,3] row_mask:0x2 bank_mask:0xf
    v_add_f32 v36, v36, v38
    v_max_f32 v61, v61, v36
    v_mov_b32_dpp v24, v32 quad_perm:[0,1,2,3] row_mask:0x4 bank_mask:0xf
    s_nop 0
    v_max_f32_dpp v61, v61, v61 row_ror:8 row_mask:0xf bank_mask:0xf
    s_nop 0
    v_mov_b32_dpp v24, v36 quad_perm:[0,1,2,3] row_mask:0x8 bank_mask:0xf
    v_max_f32_dpp v61, v61, v61 row_ror:4 row_mask:0xf bank_mask:0xf
    s_nop 1
    v_max_f32_dpp v61, v61, v61 row_ror:2 row_mask:0xf bank_mask:0xf
    s_nop 1
    v_max_f32_dpp v61, v61, v61 row_ror:1 row_mask:0xf bank_mask:0xf
    v_sub_f32 v36, v24, v61
    ds_write_b32 v59, v61
    v_exp_f32 v36, v36
    s_nop 0
    v_cvt_pk_bf16_f32 v39, v36, v36
    ds_write_b16 v58, v39
    ds_read_b128 v[12:15], v52
    ds_read_b128 v[16:19], v53
    ds_read_b128 v[20:23], v54
    ds_read_b128 v[24:27], v55
    ds_read_b128 v[28:31], v56
    ds_read_b128 v[32:35], v57
    v_add_f32_dpp v38, v36, v36 row_ror:8 row_mask:0xf bank_mask:0xf
    s_nop 1
    v_add_f32_dpp v38, v38, v38 row_ror:4 row_mask:0xf bank_mask:0xf
    s_nop 1
    v_add_f32_dpp v38, v38, v38 row_ror:2 row_mask:0xf bank_mask:0xf
    s_nop 1
    v_add_f32_dpp v38, v38, v38 row_ror:1 row_mask:0xf bank_mask:0xf
    s_nop 1
    v_add_f32_dpp v38, v38, v38 row_bcast:15 row_mask:0xa bank_mask:0xf
    s_nop 1
    v_add_f32_dpp v38, v38, v38 row_bcast:31 row_mask:0xc bank_mask:0xf
    s_waitcnt lgkmcnt(0)
    s_waitcnt vmcnt(32)
    s_barrier
    ds_read_b64_tr_b16 v[162:163], v8 offset:49152
    ds_read_b64_tr_b16 v[170:171], v9 offset:49152
    ds_read_b64_tr_b16 v[178:179], v10 offset:49152
    ds_read_b64_tr_b16 v[186:187], v11 offset:49152
    s_cmp_eq_u32 s30, 6
    s_cbranch_scc0 L_skip_106
    s_mov_b32 s57, 786432
    s_mov_b32 s58, 1178624
    s_mov_b32 m0, 124928
L_dma_107:
    s_nop 0
    buffer_load_dwordx4 v7, s[36:39], s57 offen offset:0 nt lds
    buffer_load_dwordx4 v7, s[36:39], s58 offen offset:1024 nt lds
    s_add_u32 s57, s57, 24576
    s_add_u32 s58, s58, 24576
    s_add_u32 m0, m0, 2048
    s_cmp_lg_u32 m0, 141312
    s_cbranch_scc1 L_dma_107
L_skip_106:
    s_waitcnt lgkmcnt(0)
    ds_read_b32 v36, v62
    s_waitcnt lgkmcnt(0)
    v_max_f32_dpp v37, v36, v36 row_ror:4 row_mask:0xf bank_mask:0xf
    s_nop 1
    v_max_f32_dpp v37, v37, v37 row_ror:2 row_mask:0xf bank_mask:0xf
    s_nop 1
    v_max_f32_dpp v37, v37, v37 row_ror:1 row_mask:0xf bank_mask:0xf
    v_sub_f32 v39, v61, v37
    v_exp_f32 v39, v39
    s_cmp_lt_u32 s30, 2
    s_cbranch_scc0 L_skip_108
    s_lshl_b32 s57, s30, 3
    v_lshlrev_b32 v2, 4, v0
    v_add_u32 v2, s57, v2
    v_add_u32 v2, 92160, v2
    v_mov_b32 v60, 94192
    v_cmp_le_u32 vcc, 48, v0
    s_nop 1
    v_cndmask_b32 v2, v2, v60, vcc
    s_lshr_b32 s57, s54, 1
    s_lshl_b32 s57, s57, 2
    s_and_b32 s58, s54, 1
    s_add_u32 s57, s57, s58
    s_lshl_b32 s58, s57, 4
    s_lshl_b32 s57, s57, 3
    v_bfe_u32 v3, v0, 3, 2
    v_lshlrev_b32 v3, 8, v3
    v_bfe_u32 v61, v0, 2, 1
    v_lshl_add_u32 v3, v61, 5, v3
    v_and_b32 v61, 3, v0
    v_lshl_add_u32 v3, v61, 2, v3
    v_add_u32 v3, s58, v3
    v_bfe_u32 v60, v0, 3, 1
    v_lshlrev_b32 v60, 8, v60
    v_bfe_u32 v61, v0, 1, 1
    v_lshl_add_u32 v60, v61, 7, v60
    v_bfe_u32 v61, v0, 2, 1
    v_lshl_add_u32 v60, v61, 4, v60
    v_and_b32 v61, 1, v0
    v_lshl_add_u32 v60, v61, 2, v60
    v_add_u32 v60, s57, v60
    v_add_u32 v60, 1024, v60
    v_cmp_gt_u32 vcc, 32, v0
    s_nop 1
    v_cndmask_b32 v3, v60, v3, vcc
    s_lshl_b32 s57, s53, 1
    s_add_u32 s57, s57, s30
    s_mul_i32 s57, s57, 1664
    s_add_u32 s57, s57, s62
    v_add_u32 v3, s57, v3
    v_mov_b32 v60, 0x7f000000
    v_cmp_le_u32 vcc, 48, v0
    s_nop 1
    v_cndmask_b32 v3, v3, v60, vcc
    s_lshl_b32 s58, s54, 2
    s_add_u32 s57, s57, s58
    s_add_u32 s57, s57, 1536
    v_mov_b32 v4, s57
    v_mov_b32 v60, 0x7f000000
    v_cmp_ne_u32 vcc, 48, v0
    s_nop 1
    v_cndmask_b32 v4, v4, v60, vcc
    s_mov_b32 s58, 0
    s_cmp_eq_u32 s55, 0
    s_cbranch_scc1 L_gs_109
    buffer_store_dword v37, v4, s[40:43], s58 offen
L_gb_110:
L_skip_108:
    s_cmp_eq_u32 s30, 2
    s_cbranch_scc0 L_skip_111
    v_lshlrev_b32 v2, 2, v0
    v_add_u32 v2, 157696, v2
    v_and_b32 v3, 15, v0
    v_lshlrev_b32 v3, 2, v3
    v_lshrrev_b32 v60, 5, v0
    v_lshl_add_u32 v3, v60, 6, v3
    v_bfe_u32 v60, v0, 4, 1
    v_lshl_add_u32 v3, v60, 13, v3
L_skip_111:
    s_waitcnt vmcnt(32)
    s_barrier
    ds_read_b64_tr_b16 v[194:195], v8 offset:0
    ds_read_b64_tr_b16 v[202:203], v9 offset:0
    ds_read_b64_tr_b16 v[210:211], v10 offset:0
    ds_read_b64_tr_b16 v[218:219], v11 offset:0
    s_cmp_eq_u32 s30, 6
    s_cbranch_scc0 L_skip_112
    s_mov_b32 s57, 786560
    s_mov_b32 s58, 1178752
    s_mov_b32 m0, 141312
L_dma_113:
    s_nop 0
    buffer_load_dwordx4 v7, s[36:39], s57 offen offset:0 nt lds
    buffer_load_dwordx4 v7, s[36:39], s58 offen offset:1024 nt lds
    s_add_u32 s57, s57, 24576
    s_add_u32 s58, s58, 24576
    s_add_u32 m0, m0, 2048
    s_cmp_lg_u32 m0, 157696
    s_cbranch_scc1 L_dma_113
L_skip_112:
    s_waitcnt lgkmcnt(0)
    s_waitcnt vmcnt(32)
    s_barrier
    ds_read_b64_tr_b16 v[226:227], v8 offset:16384
    ds_read_b64_tr_b16 v[234:235], v9 offset:16384
    ds_read_b64_tr_b16 v[242:243], v10 offset:16384
    ds_read_b64_tr_b16 v[250:251], v11 offset:16384
    s_cmp_eq_u32 s30, 6
    s_cbranch_scc0 L_skip_114
    s_mov_b32 s57, 786688
    s_mov_b32 s58, 1178880
    s_mov_b32 m0, 92160
L_dma_115:
    s_nop 0
    buffer_load_dwordx4 v7, s[36:39], s57 offen offset:0 nt lds
    buffer_load_dwordx4 v7, s[36:39], s58 offen offset:1024 nt lds
    s_add_u32 s57, s57, 24576
    s_add_u32 s58, s58, 24576
    s_add_u32 m0, m0, 2048
    s_cmp_lg_u32 m0, 108544
    s_cbranch_scc1 L_dma_115
L_skip_114:
    s_waitcnt lgkmcnt(0)
    s_cmp_eq_u32 s30, 5
    s_cbranch_scc0 L_skip_116
    global_load_dword v2, v3, s[26:27] offset:4 sc1
L_skip_116:
    s_waitcnt vmcnt(32)
    s_barrier
    ds_read_b64_tr_b16 v[164:165], v8 offset:32768
    ds_read_b64_tr_b16 v[172:173], v9 offset:32768
    ds_read_b64_tr_b16 v[180:181], v10 offset:32768
    ds_read_b64_tr_b16 v[188:189], v11 offset:32768
    s_cmp_eq_u32 s30, 6
    s_cbranch_scc0 L_skip_117
    s_mov_b32 s57, 983040
    s_mov_b32 s58, 1375232
    s_mov_b32 m0, 108544
L_dma_118:
    s_nop 0
    buffer_load_dwordx4 v7, s[36:39], s57 offen offset:0 nt lds
    buffer_load_dwordx4 v7, s[36:39], s58 offen offset:1024 nt lds
    s_add_u32 s57, s57, 24576
    s_add_u32 s58, s58, 24576
    s_add_u32 m0, m0, 2048
    s_cmp_lg_u32 m0, 124928
    s_cbranch_scc1 L_dma_118
L_skip_117:
    s_waitcnt lgkmcnt(0)
    s_waitcnt vmcnt(32)
    s_barrier
    ds_read_b64_tr_b16 v[196:197], v8 offset:49152
    ds_read_b64_tr_b16 v[204:205], v9 offset:49152
    ds_read_b64_tr_b16 v[212:213], v10 offset:49152
    ds_read_b64_tr_b16 v[220:221], v11 offset:49152
    s_cmp_eq_u32 s30, 6
    s_cbranch_scc0 L_skip_119
    s_mov_b32 s57, 983168
    s_mov_b32 s58, 1375360
    s_mov_b32 m0, 124928
L_dma_120:
    s_nop 0
    buffer_load_dwordx4 v7, s[36:39], s57 offen offset:0 nt lds
    buffer_load_dwordx4 v7, s[36:39], s58 offen offset:1024 nt lds
    s_add_u32 s57, s57, 24576
    s_add_u32 s58, s58, 24576
    s_add_u32 m0, m0, 2048
    s_cmp_lg_u32 m0, 141312
    s_cbranch_scc1 L_dma_120
L_skip_119:
    s_waitcnt lgkmcnt(0)
    s_cmp_eq_u32 s30, 5
    s_cbranch_scc0 L_skip_121
L_cw_122:
    s_waitcnt vmcnt(0)
    v_cmp_eq_u32 vcc, 0, v2
    s_cbranch_vccnz L_cr_123
    v_add_u32_dpp v2, v2, v2 row_ror:4 row_mask:0xf bank_mask:0xf
    s_nop 1
    v_add_u32_dpp v2, v2, v2 row_ror:2 row_mask:0xf bank_mask:0xf
    s_nop 1
    v_add_u32_dpp v2, v2, v2 row_ror:1 row_mask:0xf bank_mask:0xf
    v_mov_b32 v60, 160772
    ds_write_b32 v60, v2
    s_waitcnt lgkmcnt(0)
L_skip_121:
    s_cmp_lt_u32 s3, 20
    s_cbranch_scc0 L_skip_124
    s_mul_i32 s74, s30, 1664
    s_add_u32 s74, s74, s62
    s_add_u32 s74, s74, 0
    v_and_b32 v56, 7, v0
    v_lshlrev_b32 v56, 2, v56
    v_lshrrev_b32 v62, 4, v0
    v_lshlrev_b32 v62, 3, v62
    s_cmp_lg_u32 s30, 6
    s_cbranch_scc0 L_skip_124
    buffer_load_dword v52, v56, s[40:43], s74 offen offset:1536 sc1
    buffer_load_dwordx2 v[54:55], v62, s[40:43], s74 offen offset:1536 sc1
L_skip_124:
    s_cmp_eq_u32 s30, 2
    s_cbranch_scc0 L_skip_125
    s_sub_u32 s57, s3, 20
    s_cmp_lt_u32 s57, 4
    s_cbranch_scc0 L_skip_126
    s_sub_u32 s57, s3, 20
    s_lshl_b32 s57, s57, 6
    v_add_u32 v50, s57, v0
    v_min_u32 v50, 207, v50
    v_lshlrev_b32 v50, 7, v50
    s_add_u32 s57, s62, 0
    buffer_load_dword v50, v50, s[40:43], s57 offen sc1 nt
    s_sub_u32 s57, s3, 20
    s_lshl_b32 s57, s57, 6
    v_add_u32 v51, s57, v0
    v_min_u32 v51, 151, v51
    v_lshlrev_b32 v51, 7, v51
    s_add_u32 s57, s62, 26624
    buffer_load_dword v51, v51, s[40:43], s57 offen sc1 nt
    s_sub_u32 s57, s3, 20
    s_lshl_b32 s57, s57, 6
    v_add_u32 v49, s57, v0
    v_min_u32 v49, 191, v49
    v_lshlrev_b32 v49, 7, v49
    s_add_u32 s57, s62, 46080
    buffer_load_dword v49, v49, s[40:43], s57 offen sc1 nt
L_skip_126:
L_skip_125:
    s_waitcnt vmcnt(32)
    s_barrier
    ds_read_b64_tr_b16 v[228:229], v8 offset:0
    ds_read_b64_tr_b16 v[236:237], v9 offset:0
    ds_read_b64_tr_b16 v[244:245], v10 offset:0
    ds_read_b64_tr_b16 v[252:253], v11 offset:0
    s_cmp_eq_u32 s30, 6
    s_cbranch_scc0 L_skip_127
    s_mov_b32 s57, 983296
    s_mov_b32 s58, 1375488
    s_mov_b32 m0, 141312
L_dma_128:
    s_nop 0
    buffer_load_dwordx4 v7, s[36:39], s57 offen offset:0 nt lds
    buffer_load_dwordx4 v7, s[36:39], s58 offen offset:1024 nt lds
    s_add_u32 s57, s57, 24576
    s_add_u32 s58, s58, 24576
    s_add_u32 m0, m0, 2048
    s_cmp_lg_u32 m0, 157696
    s_cbranch_scc1 L_dma_128
L_skip_127:
    s_waitcnt lgkmcnt(0)
    s_cmp_ge_u32 s30, 6
    s_cbranch_scc0 L_skip_129
    v_mov_b32 v60, 160772
    ds_read_b32 v60, v60
    s_lshr_b32 s58, s63, 2
    s_waitcnt lgkmcnt(0)
    v_readfirstlane_b32 s57, v60
    s_cmp_gt_u32 s57, 24
    s_cselect_b32 s57, 1, 0
    s_xor_b32 s57, s57, s58
    s_lshl_b32 s57, s57, 13
    s_add_u32 s7, s8, s57
L_skip_129:
    s_branch L_tail
.p2align 10
L_tail:
L_pad0:
    s_cbranch_execz L_pad4
    s_waitcnt vmcnt(32)
    s_barrier
    ds_read_b64_tr_b16 v[166:167], v8 offset:16384
    ds_read_b64_tr_b16 v[174:175], v9 offset:16384
    ds_read_b64_tr_b16 v[182:183], v10 offset:16384
    ds_read_b64_tr_b16 v[190:191], v11 offset:16384
    s_waitcnt lgkmcnt(0)
    s_cmp_lt_u32 s30, 5
    s_cbranch_scc0 L_skip_130
    s_waitcnt vmcnt(0)
L_skip_130:
    s_cmp_lt_u32 s3, 20
    s_cbranch_scc0 L_skip_131
    v_lshlrev_b32 v57, 4, v0
    v_lshlrev_b32 v58, 3, v0
    s_mul_i32 s57, s30, 6144
    s_add_u32 s57, s57, 30720
    v_lshrrev_b32 v59, 2, v0
    v_lshlrev_b32 v59, 6, v59
    v_bfe_u32 v53, v0, 4, 1
    v_lshl_add_u32 v59, v53, 5, v59
    v_and_b32 v53, 3, v0
    v_lshl_add_u32 v59, v53, 3, v59
    v_add_u32 v59, s57, v59
    v_xor_b32 v60, 32, v59
    s_lshl_b32 s57, s30, 8
    s_add_u32 s57, s57, 157696
    v_lshl_add_u32 v61, v0, 2, s57
    s_cmp_lg_u32 s30, 6
    s_cbranch_scc0 L_skip_131
L_cw_132:
    s_waitcnt vmcnt(0)
    v_max3_u32 v53, v52, v54, v55
    v_cmp_eq_u32 vcc, -1, v53
    s_cbranch_vccnz L_cr_133
    v_max_f32_dpp v53, v52, v52 row_ror:4 row_mask:0xf bank_mask:0xf
    s_nop 1
    v_max_f32_dpp v53, v53, v53 row_ror:2 row_mask:0xf bank_mask:0xf
    s_nop 1
    v_max_f32_dpp v53, v53, v53 row_ror:1 row_mask:0xf bank_mask:0xf
    v_sub_f32 v52, v52, v53
    v_sub_f32 v54, v54, v53
    v_sub_f32 v55, v55, v53
    v_exp_f32 v52, v52
    v_exp_f32 v54, v54
    v_exp_f32 v55, v55
    s_cmp_eq_u32 s30, 7
    s_cbranch_scc0 L_skip_131
    v_add_u32 v62, 158720, v57
    ds_write_b128 v62, v[52:55]
    s_waitcnt lgkmcnt(0)
L_skip_131:
    v_smfmac_f32_16x16x64_bf16 v[40:43], v[12:15], v[160:167], v1
    v_smfmac_f32_16x16x64_bf16 v[40:43], v[16:19], v[168:175], v1
    v_smfmac_f32_16x16x64_bf16 v[40:43], v[20:23], v[176:183], v1
    v_smfmac_f32_16x16x64_bf16 v[40:43], v[24:27], v[184:191], v1
    s_cmp_eq_u32 s30, 6
    s_cbranch_scc0 L_skip_134
    s_mul_i32 s57, s14, 12
    s_add_u32 s58, s57, s15
    s_mov_b32 m0, 55296
L_dma_135:
    s_nop 0
    buffer_load_dwordx4 v3, s[48:51], s57 offen offset:0 nt lds
    buffer_load_dwordx4 v3, s[48:51], s58 offen offset:1024 nt lds
    s_add_u32 s57, s57, s14
    s_add_u32 s58, s58, s14
    s_add_u32 m0, m0, 2048
    s_cmp_lg_u32 m0, 67584
    s_cbranch_scc1 L_dma_135
    s_mul_i32 s57, s14, 18
    s_add_u32 s58, s57, s15
    s_mov_b32 m0, 67584
L_dma_136:
    s_nop 0
    buffer_load_dwordx4 v3, s[48:51], s57 offen offset:0 nt lds
    buffer_load_dwordx4 v3, s[48:51], s58 offen offset:1024 nt lds
    s_add_u32 s57, s57, s14
    s_add_u32 s58, s58, s14
    s_add_u32 m0, m0, 2048
    s_cmp_lg_u32 m0, 79872
    s_cbranch_scc1 L_dma_136
L_skip_134:
    s_waitcnt vmcnt(40)
    s_barrier
    ds_read_b64_tr_b16 v[198:199], v8 offset:32768
    ds_read_b64_tr_b16 v[206:207], v9 offset:32768
    ds_read_b64_tr_b16 v[214:215], v10 offset:32768
    ds_read_b64_tr_b16 v[222:223], v11 offset:32768
    s_waitcnt lgkmcnt(0)
    s_cmp_lt_u32 s3, 20
    s_cbranch_scc0 L_skip_137
    s_cmp_eq_u32 s30, 6
    s_cbranch_scc0 L_skip_137
    v_add_u32 v62, 158720, v57
    ds_read_b128 v[52:55], v62
L_skip_137:
L_pad1:
    s_cbranch_execz L_pad5
    v_smfmac_f32_16x16x64_bf16 v[40:43], v[28:31], v[192:199], v1
    v_smfmac_f32_16x16x64_bf16 v[40:43], v[32:35], v[200:207], v1
    v_smfmac_f32_16x16x64_bf16 v[44:47], v[12:15], v[208:215], v1
    v_smfmac_f32_16x16x64_bf16 v[44:47], v[16:19], v[216:223], v1
    v_mul_f32 v38, v38, v39
    ds_write_b32 v63, v38 offset:1024
    s_waitcnt vmcnt(24)
    s_barrier
    ds_read_b64_tr_b16 v[230:231], v8 offset:49152
    ds_read_b64_tr_b16 v[238:239], v9 offset:49152
    ds_read_b64_tr_b16 v[246:247], v10 offset:49152
    ds_read_b64_tr_b16 v[254:255], v11 offset:49152
    s_waitcnt lgkmcnt(0)
    v_smfmac_f32_16x16x64_bf16 v[44:47], v[20:23], v[224:231], v1
    v_smfmac_f32_16x16x64_bf16 v[44:47], v[24:27], v[232:239], v1
    v_smfmac_f32_16x16x64_bf16 v[44:47], v[28:31], v[240:247], v1
    v_smfmac_f32_16x16x64_bf16 v[44:47], v[32:35], v[248:255], v1
    s_setprio 0
    s_cmp_lt_u32 s30, 2
    v_pk_add_f32 v[40:41], v[40:41], v[42:43]
    s_nop 4
    v_pk_add_f32 v[42:43], v[44:45], v[46:47]
    v_pk_mul_f32 v[40:41], v[40:41], v[38:39] op_sel:[0,1] op_sel_hi:[1,1]
    v_pk_mul_f32 v[42:43], v[42:43], v[38:39] op_sel:[0,1] op_sel_hi:[1,1]
    ds_write_b128 v63, v[40:43]
    s_cbranch_scc1 L_comb_0
    s_waitcnt lgkmcnt(0)
    s_barrier
L_comb_0b:
    s_cmp_eq_u32 s30, 6
    s_cbranch_scc0 L_skip_142
    s_waitcnt vmcnt(0)
L_skip_142:
    s_barrier
    s_cmp_lt_u32 s3, 20
    s_cbranch_scc0 L_typeB_0
    buffer_load_dwordx4 v[12:15], v57, s[40:43], s74 offen sc1
    buffer_load_dwordx2 v[16:17], v58, s[40:43], s74 offen offset:1024 sc1
    buffer_load_dword v18, v56, s[40:43], s74 offen offset:1568 sc1
    ds_read_b64_tr_b16 v[28:29], v59 offset:0
    ds_read_b64_tr_b16 v[30:31], v59 offset:1024
    ds_read_b64_tr_b16 v[32:33], v59 offset:2048
    ds_read_b64_tr_b16 v[34:35], v59 offset:3072
    ds_read_b64_tr_b16 v[36:37], v59 offset:4096
    ds_read_b64_tr_b16 v[38:39], v59 offset:5120
    ds_read_b64_tr_b16 v[40:41], v60 offset:0
    ds_read_b64_tr_b16 v[42:43], v60 offset:1024
    ds_read_b64_tr_b16 v[44:45], v60 offset:2048
    ds_read_b64_tr_b16 v[46:47], v60 offset:3072
    ds_read_b64_tr_b16 v[48:49], v60 offset:4096
    ds_read_b64_tr_b16 v[50:51], v60 offset:5120
    v_mov_b64 v[20:21], 0
    v_mov_b64 v[22:23], 0
    v_mov_b64 v[24:25], 0
    v_mov_b64 v[26:27], 0
    s_add_u32 s58, s6, 0
    s_waitcnt lgkmcnt(0)
    s_branch L_ow_143
    s_nop 0
    s_nop 0
    s_nop 0
    s_nop 0
    s_nop 0
    s_nop 0
L_or_144:
    buffer_load_dwordx4 v[12:15], v57, s[40:43], s74 offen sc1
    buffer_load_dwordx2 v[16:17], v58, s[40:43], s74 offen offset:1024 sc1
    buffer_load_dword v18, v56, s[40:43], s74 offen offset:1568 sc1
    s_sub_u32 s56, s56, 1
    s_cbranch_scc1 L_done
    v_mov_b64 v[20:21], 0
    v_mov_b64 v[22:23], 0
    v_mov_b64 v[24:25], 0
    v_mov_b64 v[26:27], 0
L_ow_143:
    s_waitcnt vmcnt(2)
    v_smfmac_f32_16x16x64_bf16 v[20:23], v[12:15], v[28:35], v1
    v_max3_u32 v19, v12, v13, v14
    v_smfmac_f32_16x16x64_bf16 v[24:27], v[12:15], v[40:47], v1
    s_waitcnt vmcnt(0)
    v_mul_f32 v53, v52, v18
    v_smfmac_f32_16x16x32_bf16 v[20:23], v[16:17], v[36:39], v1
    v_max3_u32 v62, v15, v16, v17
    v_smfmac_f32_16x16x32_bf16 v[24:27], v[16:17], v[48:51], v1
    v_max3_u32 v19, v19, v62, v18
    v_add_f32_dpp v53, v53, v53 row_ror:4 row_mask:0xf bank_mask:0xf
    v_cmp_eq_u32 vcc, -1, v19
L_pad2:
    s_cbranch_execz L_pad6
    s_cmp_eq_u32 s30, 2
    v_add_f32_dpp v53, v53, v53 row_ror:2 row_mask:0xf bank_mask:0xf
    s_cbranch_vccnz L_or_144
    s_nop 0
    v_add_f32_dpp v53, v53, v53 row_ror:1 row_mask:0xf bank_mask:0xf
    v_rcp_f32 v52, v53
    v_pk_add_f32 v[20:21], v[20:21], v[22:23]
    v_pk_add_f32 v[24:25], v[24:25], v[26:27]
    v_pk_mul_f32 v[54:55], v[54:55], v[52:53] op_sel:[0,0] op_sel_hi:[1,0]
    v_mul_f32 v20, v20, v54
    v_mul_f32 v24, v24, v54
    v_fmac_f32 v20, v21, v55
    v_fmac_f32 v24, v25, v55
    s_nop 1
    v_permlane32_swap_b32 v20, v24
    v_add_f32 v20, v20, v24
    ds_write_b32 v61, v20
    s_waitcnt lgkmcnt(0)
    s_barrier
    s_cbranch_scc0 L_finb_145
    ds_read2st64_b32 v[12:13], v2 offset0:0 offset1:1
    ds_read2st64_b32 v[14:15], v2 offset0:2 offset1:3
    ds_read2st64_b32 v[16:17], v2 offset0:4 offset1:5
    ds_read2st64_b32 v[18:19], v2 offset0:6 offset1:7
    s_waitcnt lgkmcnt(2)
    v_pk_add_f32 v[12:13], v[12:13], v[14:15]
    s_waitcnt lgkmcnt(0)
    v_pk_add_f32 v[16:17], v[16:17], v[18:19]
    v_pk_add_f32 v[12:13], v[12:13], v[16:17]
    v_add_f32 v14, v12, v13
    v_add_f32 v15, v12, v13
    s_nop 1
    v_permlane16_swap_b32 v14, v15
    v_add_f32 v12, v14, v15
    buffer_store_dword v12, v3, s[40:43], s58 offen sc1
L_finb_145:
    s_sub_u32 s57, s30, 4
    s_cmp_lt_u32 s57, 3
    s_cbranch_scc0 L_skip_146
    s_sub_u32 s60, s30, 4
    s_lshl_b32 s57, s60, 11
    v_lshlrev_b32 v11, 4, v0
    v_add_u32 v11, s57, v11
    s_add_u32 s65, s62, 19456
    buffer_load_dwordx4 v[52:55], v11, s[40:43], s65 offen offset:0 sc1
    buffer_load_dwordx4 v[56:59], v11, s[40:43], s65 offen offset:1024 sc1
    s_lshl_b32 s59, s60, 12
    s_add_u32 s59, s59, 79872
    s_mov_b32 s44, s20
    s_mov_b32 s45, s21
    s_mov_b32 s46, 1966080
    s_mov_b32 s47, 0x20000
    s_mul_i32 s57, s31, 3
    s_add_u32 s57, s57, s60
    s_mul_i32 s57, s57, 81920
    s_lshl_b32 s64, s3, 6
    s_add_u32 s57, s57, s64
    v_lshrrev_b32 v5, 2, v0
    v_mul_u32_u24 v5, 1280, v5
    v_and_b32 v60, 3, v0
    v_lshl_add_u32 v5, v60, 4, v5
    v_add_u32 v5, s57, v5
    s_add_u32 m0, s59, 0
    s_mov_b32 s57, 0
    buffer_load_dwordx4 v5, s[44:47], s57 offen nt lds
    s_add_u32 m0, s59, 1024
    s_mov_b32 s57, 20480
    buffer_load_dwordx4 v5, s[44:47], s57 offen nt lds
    s_add_u32 m0, s59, 2048
    s_mov_b32 s57, 40960
    buffer_load_dwordx4 v5, s[44:47], s57 offen nt lds
    s_add_u32 m0, s59, 3072
    s_mov_b32 s57, 61440
    buffer_load_dwordx4 v5, s[44:47], s57 offen nt lds
    v_bfe_u32 v35, v0, 4, 1
    v_lshlrev_b32 v35, 11, v35
    v_bfe_u32 v60, v0, 2, 2
    v_lshl_add_u32 v35, v60, 8, v35
    v_lshrrev_b32 v60, 5, v0
    v_lshl_add_u32 v35, v60, 6, v35
    v_and_b32 v60, 3, v0
    v_lshl_add_u32 v35, v60, 3, v35
    v_add_u32 v35, s59, v35
    v_mov_b32 v9, 0xbdd2d3e8
    v_mov_b32 v10, 0xc0135761
    s_lshl_b32 s57, s60, 7
    s_add_u32 s57, s57, 159872
L_pad3:
    s_cbranch_execz L_pad7
    v_lshlrev_b32 v32, 3, v0
    v_add_u32 v32, s57, v32
    v_lshlrev_b32 v33, 3, v0
    v_add_u32 v33, 129024, v33
    v_cmp_gt_u32 vcc, 16, v0
    s_nop 1
    v_cndmask_b32 v32, v33, v32, vcc
    v_and_b32 v33, 15, v0
    v_lshlrev_b32 v33, 3, v33
    v_lshrrev_b32 v60, 5, v0
    v_lshl_add_u32 v33, v60, 2, v33
    v_add_u32 v33, 159872, v33
    v_and_b32 v34, 15, v0
    v_lshlrev_b32 v34, 2, v34
    v_lshrrev_b32 v60, 5, v0
    v_lshl_add_u32 v34, v60, 6, v34
    v_bfe_u32 v60, v0, 4, 1
    v_lshl_add_u32 v34, v60, 13, v34
    s_add_u32 s60, s6, 66048
    s_add_u32 s58, s62, 13312
    s_add_u32 s57, s62, 25856
    v_and_b32 v7, 7, v0
    v_lshlrev_b32 v7, 3, v7
    v_mov_b32 v60, 0x3acccccd
    v_mov_b32 v61, 0x3727c5ac
    s_waitcnt vmcnt(0)
    buffer_load_dwordx2 v[24:25], v7, s[40:43], s57 offen sc1
    buffer_load_dwordx4 v[12:15], v11, s[40:43], s58 offen offset:0 sc1
    buffer_load_dwordx4 v[16:19], v11, s[40:43], s58 offen offset:1024 sc1
    ds_read_b64_tr_b16 v[36:37], v35 offset:0
    ds_read_b64_tr_b16 v[38:39], v35 offset:1024
    ds_read_b64_tr_b16 v[40:41], v35 offset:128
    ds_read_b64_tr_b16 v[42:43], v35 offset:1152
    ds_read_b64_tr_b16 v[44:45], v35 offset:32
    ds_read_b64_tr_b16 v[46:47], v35 offset:1056
    ds_read_b64_tr_b16 v[48:49], v35 offset:160
    ds_read_b64_tr_b16 v[50:51], v35 offset:1184
L_sw_149:
    v_max3_u32 v20, v52, v53, v54
    v_max3_u32 v20, v20, v55, v56
    v_max3_u32 v20, v20, v57, v58
    v_max_u32 v20, v20, v59
    v_cmp_eq_u32 vcc, -1, v20
    s_cbranch_vccnz L_sr_150
    v_pk_add_f32 v[28:29], v[52:53], v[56:57]
    v_pk_add_f32 v[30:31], v[54:55], v[58:59]
    s_nop 1
    v_permlane32_swap_b32 v28, v30
    v_permlane32_swap_b32 v29, v31
    v_pk_add_f32 v[28:29], v[28:29], v[30:31]
    s_nop 1
    v_permlane16_swap_b32 v28, v29
    v_add_f32 v28, v28, v29
    v_mov_b64 v[52:53], 0
    v_mov_b64 v[54:55], 0
    v_mov_b64 v[56:57], 0
    v_mov_b64 v[58:59], 0
    s_waitcnt lgkmcnt(0)
L_pr_148:
    buffer_load_dwordx2 v[24:25], v7, s[40:43], s57 offen sc1
    buffer_load_dwordx4 v[12:15], v11, s[40:43], s58 offen offset:0 sc1
    buffer_load_dwordx4 v[16:19], v11, s[40:43], s58 offen offset:1024 sc1
    s_sub_u32 s56, s56, 1
    s_cbranch_scc1 L_done
L_pw_147:
    s_waitcnt vmcnt(3)
    v_max_u32 v20, v24, v25
    v_cmp_eq_u32 vcc, -1, v20
    s_cbranch_vccnz L_pr_148
    buffer_load_dwordx4 v[12:15], v11, s[40:43], s58 offen offset:0 sc1
    buffer_load_dwordx4 v[16:19], v11, s[40:43], s58 offen offset:1024 sc1
    v_add_f32_dpp v2, v24, v24 row_ror:4 row_mask:0xf bank_mask:0xf
    v_add_f32_dpp v3, v25, v25 row_ror:4 row_mask:0xf bank_mask:0xf
    v_pk_add_f32 v[20:21], v[12:13], v[16:17]
    v_pk_add_f32 v[22:23], v[14:15], v[18:19]
    v_add_f32_dpp v2, v2, v2 row_ror:2 row_mask:0xf bank_mask:0xf
    v_add_f32_dpp v3, v3, v3 row_ror:2 row_mask:0xf bank_mask:0xf
    v_permlane32_swap_b32 v20, v22
    v_permlane32_swap_b32 v21, v23
    v_add_f32_dpp v2, v2, v2 row_ror:1 row_mask:0xf bank_mask:0xf
    v_add_f32_dpp v3, v3, v3 row_ror:1 row_mask:0xf bank_mask:0xf
    v_pk_add_f32 v[20:21], v[20:21], v[22:23]
    v_mul_f32 v2, v2, v60
    v_fma_f32 v3, v3, v60, v61
    v_permlane16_swap_b32 v20, v21
    v_fma_f32 v3, -v2, v2, v3
L_pad4:
    s_cbranch_execz L_pad8
    v_add_f32 v20, v20, v21
    v_max_f32 v3, v3, v61
    v_mul_f32 v26, v28, v2
    v_rsq_f32 v3, v3
    v_cmp_u_f32 vcc, v20, v20
    v_sub_f32 v20, v20, v26
    s_cbranch_vccnz L_hr_151
L_hk_152:
    v_fma_f32 v20, v20, v3, v4
    v_mul_f32 v21, v20, v20
    v_fma_f32 v21, v21, v9, v10
    v_mul_f32 v21, v21, v20
    v_exp_f32 v21, v21
    s_nop 0
    v_add_f32 v21, 1.0, v21
    v_rcp_f32 v21, v21
    s_nop 0
    v_mul_f32 v20, v20, v21
    s_nop 1
    v_mov_b32_dpp v21, v20 row_shl:1 row_mask:0xf bank_mask:0xf bound_ctrl:0
    v_cvt_pk_bf16_f32 v28, v20, v21
    s_nop 1
    v_mov_b32_dpp v29, v28 row_shl:4 row_mask:0xf bank_mask:0xf bound_ctrl:0
    v_mov_b32_dpp v30, v28 row_shl:8 row_mask:0xf bank_mask:0xf bound_ctrl:0
    v_mov_b32_dpp v31, v28 row_shl:12 row_mask:0xf bank_mask:0xf bound_ctrl:0
    s_nop 1
    v_smfmac_f32_16x16x64_bf16 v[52:55], v[28:31], v[36:43], v1
    v_smfmac_f32_16x16x64_bf16 v[56:59], v[28:31], v[44:51], v1
    s_cmp_eq_u32 s30, 4
    s_nop 5
    v_add_f32 v22, v52, v54
    v_add_f32 v23, v56, v58
    ds_write_b64 v32, v[22:23]
    s_cbranch_scc0 L_skip_154
L_xw_155:
    ds_read2_b32 v[20:21], v33 offset0:0 offset1:32
    ds_read_b32 v22, v33 offset:256
    s_sub_u32 s56, s56, 1
    s_cbranch_scc1 L_done
    s_waitcnt lgkmcnt(0)
    v_max3_u32 v23, v20, v21, v22
    v_add_f32 v20, v20, v21
    v_cmp_eq_u32 vcc, -1, v23
    v_add_f32 v20, v20, v22
    s_cbranch_vccnz L_xw_155
    buffer_store_dword v20, v34, s[40:43], s60 offen sc1
    s_waitcnt vmcnt(1)
    s_branch L_pe_156
    s_nop 0
    s_nop 0
    s_nop 0
L_skip_154:
    s_waitcnt vmcnt(0)
L_pe_156:
L_skip_146:
    s_branch L_p1
    s_nop 0
    s_nop 0
    s_nop 0
    s_nop 0
    s_nop 0
    s_nop 0
L_typeB_0:
    s_cmp_eq_u32 s53, 3
    s_cbranch_scc0 L_typeC_157
    s_cmp_eq_u32 s30, 7
    s_cbranch_scc1 L_w7_167
    s_cmp_lt_u32 s30, 6
    s_cbranch_scc0 L_skip_169
    s_lshr_b32 s57, s30, 1
    s_mul_i32 s57, s57, 128
    s_and_b32 s58, s30, 1
    s_lshl_b32 s58, s58, 6
    s_add_u32 s57, s57, s58
    v_lshrrev_b32 v18, 5, v0
    v_lshlrev_b32 v18, 13, v18
    v_bfe_u32 v60, v0, 3, 1
    v_lshl_add_u32 v18, v60, 12, v18
    v_bfe_u32 v60, v0, 4, 1
    v_lshl_add_u32 v18, v60, 11, v18
    v_bfe_u32 v60, v0, 2, 1
    v_mul_u32_u24 v60, 384, v60
    v_add_u32 v18, v60, v18
    v_and_b32 v60, 3, v0
    v_lshl_add_u32 v18, v60, 3, v18
    v_add_u32 v18, s57, v18
    v_add_u32 v18, 30720, v18
    v_bfe_u32 v19, v0, 4, 1
    v_lshlrev_b32 v19, 12, v19
    v_bfe_u32 v60, v0, 3, 1
    v_lshl_add_u32 v19, v60, 11, v19
    v_bfe_u32 v60, v0, 2, 1
    v_mul_u32_u24 v60, 384, v60
    v_add_u32 v19, v60, v19
    v_and_b32 v60, 3, v0
    v_lshl_add_u32 v19, v60, 3, v19
    v_add_u32 v19, s57, v19
    v_add_u32 v19, 63488, v19
    ds_read_b64_tr_b16 v[28:29], v18 offset:0
    ds_read_b64_tr_b16 v[30:31], v18 offset:1024
    ds_read_b64_tr_b16 v[32:33], v18 offset:16384
L_pad5:
    s_cbranch_execz L_pad9
    ds_read_b64_tr_b16 v[34:35], v18 offset:17408
    ds_read_b64_tr_b16 v[36:37], v19 offset:0
    ds_read_b64_tr_b16 v[38:39], v19 offset:1024
    ds_read_b64_tr_b16 v[40:41], v18 offset:32
    ds_read_b64_tr_b16 v[42:43], v18 offset:1056
    ds_read_b64_tr_b16 v[44:45], v18 offset:16416
    ds_read_b64_tr_b16 v[46:47], v18 offset:17440
    ds_read_b64_tr_b16 v[48:49], v19 offset:32
    ds_read_b64_tr_b16 v[50:51], v19 offset:1056
    v_lshrrev_b32 v9, 4, v0
    v_lshlrev_b32 v9, 5, v9
    v_bfe_u32 v60, v0, 1, 1
    v_lshl_add_u32 v9, v60, 4, v9
    v_and_b32 v60, 1, v0
    v_mul_u32_u24 v60, 192, v60
    v_add_u32 v9, v60, v9
    v_add_u32 v9, 160832, v9
    v_lshrrev_b32 v10, 4, v0
    v_lshlrev_b32 v10, 4, v10
    v_bfe_u32 v60, v0, 1, 1
    v_lshl_add_u32 v10, v60, 3, v10
    v_and_b32 v60, 1, v0
    v_mul_u32_u24 v60, 192, v60
    v_add_u32 v10, v60, v10
    v_add_u32 v10, 160960, v10
    v_mov_b64 v[20:21], 0
    v_mov_b64 v[22:23], 0
    v_mov_b64 v[24:25], 0
    v_mov_b64 v[26:27], 0
    s_lshr_b32 s57, s30, 1
    s_lshl_b32 s57, s57, 11
    s_lshl_b32 s58, s58, 1
    s_add_u32 s57, s57, s58
    s_lshl_b32 s58, s54, 8
    s_add_u32 s57, s57, s58
    v_and_b32 v11, 31, v0
    v_lshlrev_b32 v11, 2, v11
    v_lshrrev_b32 v60, 5, v0
    v_lshl_add_u32 v11, v60, 30, v11
    v_add_u32 v11, s57, v11
    s_add_u32 s59, s62, 13312
    s_add_u32 s60, s62, 25856
    ds_read_b128 v[12:15], v9
    ds_read_b64 v[16:17], v10
    s_waitcnt lgkmcnt(1)
    v_smfmac_f32_16x16x64_bf16 v[20:23], v[12:15], v[28:35], v1
    v_smfmac_f32_16x16x64_bf16 v[24:27], v[12:15], v[40:47], v1
    s_waitcnt lgkmcnt(0)
    v_smfmac_f32_16x16x32_bf16 v[20:23], v[16:17], v[36:39], v1
    v_smfmac_f32_16x16x32_bf16 v[24:27], v[16:17], v[48:51], v1
    s_add_u32 s60, s62, 19456
    s_cmp_eq_u32 s55, 0
    s_nop 4
    v_add_f32 v12, v21, v23
    s_nop 1
    v_add_f32_dpp v12, v25, v27 quad_perm:[0,1,2,3] row_mask:0x2 bank_mask:0xf
    s_cbranch_scc1 L_gs_170
    buffer_store_dword v12, v11, s[40:43], s60 offen
L_gb_171:
    v_mov_b64 v[20:21], 0
    v_mov_b64 v[22:23], 0
    v_mov_b64 v[24:25], 0
    v_mov_b64 v[26:27], 0
L_skip_169:
    s_cmp_lt_u32 s30, 6
    s_barrier
    s_cbranch_scc0 L_se_168
    ds_read_b128 v[12:15], v9
    ds_read_b64 v[16:17], v10
    s_waitcnt lgkmcnt(1)
    v_smfmac_f32_16x16x64_bf16 v[20:23], v[12:15], v[28:35], v1
    v_smfmac_f32_16x16x64_bf16 v[24:27], v[12:15], v[40:47], v1
    s_waitcnt lgkmcnt(0)
    v_smfmac_f32_16x16x32_bf16 v[20:23], v[16:17], v[36:39], v1
    v_smfmac_f32_16x16x32_bf16 v[24:27], v[16:17], v[48:51], v1
    s_cmp_eq_u32 s55, 0
    s_nop 5
    v_add_f32 v12, v20, v22
    s_nop 1
    v_add_f32_dpp v12, v24, v26 quad_perm:[0,1,2,3] row_mask:0x2 bank_mask:0xf
    s_cbranch_scc1 L_gs_172
    buffer_store_dword v12, v11, s[40:43], s59 offen
L_gb_173:
L_se_168:
L_p1:
    s_lshl_b32 s57, s30, 7
    s_add_u32 s57, s57, 158720
    v_lshrrev_b32 v58, 4, v0
    v_lshlrev_b32 v58, 5, v58
    v_bfe_u32 v60, v0, 1, 1
    v_lshl_add_u32 v58, v60, 4, v58
L_pad6:
    s_cbranch_execz L_pad10
    v_bfe_u32 v60, v0, 2, 2
    v_lshl_add_u32 v58, v60, 2, v58
    v_and_b32 v60, 1, v0
    v_lshl_add_u32 v58, v60, 1, v58
    v_add_u32 v58, s57, v58
    v_lshrrev_b32 v61, 4, v0
    v_lshlrev_b32 v61, 5, v61
    v_bfe_u32 v60, v0, 1, 1
    v_lshl_add_u32 v61, v60, 4, v61
    v_add_u32 v61, s57, v61
    v_bfe_u32 v62, v0, 2, 2
    v_lshlrev_b32 v62, 1, v62
    v_and_b32 v60, 1, v0
    v_lshl_add_u32 v62, v60, 0, v62
    v_mov_b32 v60, 160992
    v_cmp_eq_u32 vcc, 0, v62
    s_nop 1
    v_cndmask_b32 v52, v60, v61, vcc
    v_cmp_eq_u32 vcc, 1, v62
    s_nop 1
    v_cndmask_b32 v53, v60, v61, vcc
    v_cmp_eq_u32 vcc, 2, v62
    s_nop 1
    v_cndmask_b32 v54, v60, v61, vcc
    v_cmp_eq_u32 vcc, 3, v62
    s_nop 1
    v_cndmask_b32 v55, v60, v61, vcc
    v_cmp_eq_u32 vcc, 4, v62
    s_nop 1
    v_cndmask_b32 v56, v60, v61, vcc
    v_cmp_eq_u32 vcc, 5, v62
    s_nop 1
    v_cndmask_b32 v57, v60, v61, vcc
    s_lshl_b32 s58, s30, 2
    s_add_u32 s58, s58, 159808
    v_mov_b32 v60, s58
    v_lshlrev_b32 v59, 2, v0
    v_add_u32 v59, 158208, v59
    v_cmp_eq_u32 vcc, 63, v0
    s_nop 1
    v_cndmask_b32 v59, v59, v60, vcc
    v_and_b32 v62, 7, v0
    v_lshlrev_b32 v62, 2, v62
    v_add_u32 v62, 159808, v62
    s_lshl_b32 s57, s30, 11
    v_lshlrev_b32 v63, 4, v0
    v_add_u32 v63, s57, v63
    v_add_u32 v63, 92160, v63
    s_sub_u32 s57, s30, 1
    s_lshl_b32 s58, s57, 11
    v_lshlrev_b32 v7, 4, v0
    v_add_u32 v7, s58, v7
    s_lshl_b32 s58, s57, 7
    v_bfe_u32 v8, v0, 2, 2
    v_lshlrev_b32 v8, 5, v8
    v_lshrrev_b32 v60, 5, v0
    v_lshl_add_u32 v8, v60, 4, v8
    v_and_b32 v60, 3, v0
    v_lshl_add_u32 v8, v60, 2, v8
    v_bfe_u32 v60, v0, 4, 1
    v_lshl_add_u32 v8, v60, 1, v8
    v_add_u32 v8, s58, v8
    v_add_u32 v8, 124928, v8
    s_cmp_eq_u32 s30, 7
    s_cbranch_scc1 L_w7_181
    s_cmp_lt_u32 s30, 6
    s_cbranch_scc0 L_skip_183
    s_lshr_b32 s57, s30, 1
    s_mul_i32 s57, s57, 1024
    s_and_b32 s58, s30, 1
    s_lshl_b32 s58, s58, 6
    s_add_u32 s57, s57, s58
    v_lshrrev_b32 v18, 5, v0
    v_mul_u32_u24 v18, 6144, v18
    v_bfe_u32 v60, v0, 3, 1
    v_mul_u32_u24 v60, 3072, v60
    v_add_u32 v18, v60, v18
    v_bfe_u32 v60, v0, 4, 1
    v_lshl_add_u32 v18, v60, 9, v18
    v_bfe_u32 v60, v0, 2, 1
    v_lshl_add_u32 v18, v60, 7, v18
    v_and_b32 v60, 3, v0
    v_lshl_add_u32 v18, v60, 3, v18
    v_add_u32 v18, s57, v18
    v_bfe_u32 v19, v0, 4, 1
    v_mul_u32_u24 v19, 3072, v19
    v_bfe_u32 v60, v0, 3, 1
    v_lshl_add_u32 v19, v60, 9, v19
    v_bfe_u32 v60, v0, 2, 1
    v_lshl_add_u32 v19, v60, 7, v19
    v_and_b32 v60, 3, v0
    v_lshl_add_u32 v19, v60, 3, v19
    v_add_u32 v19, s57, v19
L_pad7:
    s_cbranch_execz L_pad11
    v_add_u32 v19, 24576, v19
    ds_read_b64_tr_b16 v[28:29], v18 offset:0
    ds_read_b64_tr_b16 v[30:31], v18 offset:256
    ds_read_b64_tr_b16 v[32:33], v18 offset:12288
    ds_read_b64_tr_b16 v[34:35], v18 offset:12544
    ds_read_b64_tr_b16 v[36:37], v19 offset:0
    ds_read_b64_tr_b16 v[38:39], v19 offset:256
    ds_read_b64_tr_b16 v[40:41], v18 offset:32
    ds_read_b64_tr_b16 v[42:43], v18 offset:288
    ds_read_b64_tr_b16 v[44:45], v18 offset:12320
    ds_read_b64_tr_b16 v[46:47], v18 offset:12576
    ds_read_b64_tr_b16 v[48:49], v19 offset:32
    ds_read_b64_tr_b16 v[50:51], v19 offset:288
    v_lshrrev_b32 v9, 4, v0
    v_lshlrev_b32 v9, 5, v9
    v_bfe_u32 v60, v0, 1, 1
    v_lshl_add_u32 v9, v60, 4, v9
    v_and_b32 v60, 1, v0
    v_mul_u32_u24 v60, 192, v60
    v_add_u32 v9, v60, v9
    v_add_u32 v9, 160832, v9
    v_lshrrev_b32 v10, 4, v0
    v_lshlrev_b32 v10, 4, v10
    v_bfe_u32 v60, v0, 1, 1
    v_lshl_add_u32 v10, v60, 3, v10
    v_and_b32 v60, 1, v0
    v_mul_u32_u24 v60, 192, v60
    v_add_u32 v10, v60, v10
    v_add_u32 v10, 160960, v10
    v_mov_b64 v[20:21], 0
    v_mov_b64 v[22:23], 0
    v_mov_b64 v[24:25], 0
    v_mov_b64 v[26:27], 0
    s_lshr_b32 s57, s30, 1
    s_lshl_b32 s57, s57, 11
    s_lshl_b32 s58, s58, 1
    s_add_u32 s57, s57, s58
    s_lshl_b32 s58, s54, 8
    s_add_u32 s57, s57, s58
    v_and_b32 v11, 31, v0
    v_lshlrev_b32 v11, 2, v11
    v_lshrrev_b32 v60, 5, v0
    v_lshl_add_u32 v11, v60, 30, v11
    v_add_u32 v11, s57, v11
    s_mul_i32 s59, s53, 6144
    s_add_u32 s59, s59, s62
    s_add_u32 s59, s59, 46080
    s_lshl_b32 s60, s53, 6
    s_add_u32 s60, s60, s62
    s_add_u32 s60, s60, 25600
L_skip_183:
    s_cmp_lt_u32 s30, 6
    s_barrier
    s_cbranch_scc0 L_se_182
    ds_read_b128 v[12:15], v9
    ds_read_b64 v[16:17], v10
    s_waitcnt lgkmcnt(1)
    v_smfmac_f32_16x16x64_bf16 v[20:23], v[12:15], v[28:35], v1
    v_smfmac_f32_16x16x64_bf16 v[24:27], v[12:15], v[40:47], v1
    s_waitcnt lgkmcnt(0)
    v_smfmac_f32_16x16x32_bf16 v[20:23], v[16:17], v[36:39], v1
    v_smfmac_f32_16x16x32_bf16 v[24:27], v[16:17], v[48:51], v1
    s_cmp_eq_u32 s55, 0
    s_nop 5
    v_add_f32 v12, v20, v22
    s_nop 1
    v_add_f32_dpp v12, v24, v26 quad_perm:[0,1,2,3] row_mask:0x2 bank_mask:0xf
    s_cbranch_scc1 L_gs_184
    buffer_store_dword v12, v11, s[40:43], s59 offen
L_gb_185:
L_se_182:
    s_sub_u32 s57, s30, 1
    s_cmp_lt_u32 s57, 3
    s_cbranch_scc0 L_qo_199
    v_and_b32 v9, 7, v0
    v_lshlrev_b32 v9, 3, v9
    buffer_load_dwordx2 v[10:11], v9, s[40:43], s60 offen sc1
    buffer_load_dwordx4 v[12:15], v7, s[40:43], s59 offen offset:0 sc1
    buffer_load_dwordx4 v[16:19], v7, s[40:43], s59 offen offset:1024 sc1
    v_mov_b64 v[24:25], 0
    v_mov_b64 v[26:27], 0
    v_mov_b64 v[28:29], 0
    v_mov_b64 v[30:31], 0
    v_mov_b64 v[32:33], 0
    v_mov_b64 v[34:35], 0
    v_mov_b64 v[36:37], 0
    v_mov_b64 v[38:39], 0
    v_mov_b64 v[40:41], 0
    v_mov_b64 v[42:43], 0
    v_mov_b64 v[44:45], 0
    v_mov_b64 v[46:47], 0
    v_lshrrev_b32 v5, 4, v0
    v_lshlrev_b32 v5, 5, v5
    v_bfe_u32 v60, v0, 1, 1
L_pad8:
    s_cbranch_execz L_pad12
    v_lshl_add_u32 v5, v60, 4, v5
    v_add_u32 v5, 124928, v5
    v_mov_b32 v60, 0x3c75e03e
    v_mov_b32 v61, 0x3a71d1e6
    v_mov_b32 v51, 0x3e13985d
    s_branch L_pw_201
    s_nop 0
    s_nop 0
    s_nop 0
L_pr_202:
    buffer_load_dwordx2 v[10:11], v9, s[40:43], s60 offen sc1
    buffer_load_dwordx4 v[12:15], v7, s[40:43], s59 offen offset:0 sc1
    buffer_load_dwordx4 v[16:19], v7, s[40:43], s59 offen offset:1024 sc1
    s_sub_u32 s56, s56, 1
    s_cbranch_scc1 L_done
L_pw_201:
    s_waitcnt vmcnt(0)
    v_max_u32 v20, v10, v11
    v_cmp_eq_u32 vcc, -1, v20
    s_cbranch_vccnz L_pr_202
    v_add_f32_dpp v48, v10, v10 row_ror:4 row_mask:0xf bank_mask:0xf
    v_add_f32_dpp v49, v11, v11 row_ror:4 row_mask:0xf bank_mask:0xf
    v_pk_add_f32 v[20:21], v[12:13], v[16:17]
    v_pk_add_f32 v[22:23], v[14:15], v[18:19]
    v_add_f32_dpp v48, v48, v48 row_ror:2 row_mask:0xf bank_mask:0xf
    v_add_f32_dpp v49, v49, v49 row_ror:2 row_mask:0xf bank_mask:0xf
    v_permlane32_swap_b32 v20, v22
    v_permlane32_swap_b32 v21, v23
    v_add_f32_dpp v48, v48, v48 row_ror:1 row_mask:0xf bank_mask:0xf
    v_add_f32_dpp v49, v49, v49 row_ror:1 row_mask:0xf bank_mask:0xf
    v_pk_add_f32 v[20:21], v[20:21], v[22:23]
    v_mul_f32 v48, v48, v60
    v_fma_f32 v49, v49, v51, v61
    v_permlane16_swap_b32 v20, v21
    v_fma_f32 v49, -v48, v48, v49
    v_add_f32 v20, v20, v21
    v_max_f32 v49, v49, v61
    v_mul_f32 v50, v6, v48
    v_rsq_f32 v49, v49
    v_cmp_u_f32 vcc, v20, v20
    v_sub_f32 v20, v20, v50
    s_cbranch_vccnz L_hr_203
L_hk_204:
    v_mul_f32 v20, v20, v49
    v_cvt_pk_bf16_f32 v20, v20, v20
    ds_write_b16 v8, v20
L_qb_200:
    s_waitcnt lgkmcnt(0)
    s_barrier
    ds_read_b128 v[12:15], v5 offset:0
    ds_read_b128 v[16:19], v5 offset:128
    ds_read_b128 v[20:23], v5 offset:256
    s_cmp_lt_u32 s30, 4
    s_waitcnt lgkmcnt(0)
    v_smfmac_f32_16x16x64_bf16 v[24:27], v[12:15], v[64:71], v1
    v_smfmac_f32_16x16x64_bf16 v[24:27], v[16:19], v[72:79], v1
    v_smfmac_f32_16x16x64_bf16 v[24:27], v[20:23], v[80:87], v1
    v_smfmac_f32_16x16x64_bf16 v[28:31], v[12:15], v[88:95], v1
    v_smfmac_f32_16x16x64_bf16 v[28:31], v[16:19], v[96:103], v1
    v_smfmac_f32_16x16x64_bf16 v[28:31], v[20:23], v[104:111], v1
    v_smfmac_f32_16x16x64_bf16 v[32:35], v[12:15], v[112:119], v1
    v_smfmac_f32_16x16x64_bf16 v[32:35], v[16:19], v[120:127], v1
    v_smfmac_f32_16x16x64_bf16 v[32:35], v[20:23], v[128:135], v1
    v_smfmac_f32_16x16x64_bf16 v[36:39], v[12:15], v[136:143], v1
    v_smfmac_f32_16x16x64_bf16 v[36:39], v[16:19], v[144:151], v1
    v_smfmac_f32_16x16x64_bf16 v[36:39], v[20:23], v[152:159], v1
    v_add_f32 v24, v24, v26
    s_nop 0
    v_add_f32 v28, v28, v30
    s_nop 1
    v_add_f32 v32, v32, v34
    v_max3_f32 v61, v24, v28, v32
    v_mov_b32_dpp v24, v28 quad_perm:[0,1,2,3] row_mask:0x2 bank_mask:0xf
    v_add_f32 v36, v36, v38
    v_max_f32 v61, v61, v36
    v_mov_b32_dpp v24, v32 quad_perm:[0,1,2,3] row_mask:0x4 bank_mask:0xf
    s_nop 0
    v_max_f32_dpp v61, v61, v61 row_ror:8 row_mask:0xf bank_mask:0xf
    s_nop 0
    v_mov_b32_dpp v24, v36 quad_perm:[0,1,2,3] row_mask:0x8 bank_mask:0xf
    v_max_f32_dpp v61, v61, v61 row_ror:4 row_mask:0xf bank_mask:0xf
    s_nop 1
    v_max_f32_dpp v61, v61, v61 row_ror:2 row_mask:0xf bank_mask:0xf
    s_nop 1
    v_max_f32_dpp v61, v61, v61 row_ror:1 row_mask:0xf bank_mask:0xf
    v_sub_f32 v36, v24, v61
L_pad9:
    s_cbranch_execz L_pad13
    ds_write_b32 v59, v61
    v_exp_f32 v36, v36
    s_nop 0
    v_cvt_pk_bf16_f32 v39, v36, v36
    ds_write_b16 v58, v39
    ds_read_b128 v[12:15], v52
    ds_read_b128 v[16:19], v53
    ds_read_b128 v[20:23], v54
    ds_read_b128 v[24:27], v55
    ds_read_b128 v[28:31], v56
    ds_read_b128 v[32:35], v57
    v_add_f32_dpp v38, v36, v36 row_ror:8 row_mask:0xf bank_mask:0xf
    s_nop 1
    v_add_f32_dpp v38, v38, v38 row_ror:4 row_mask:0xf bank_mask:0xf
    s_nop 1
    v_add_f32_dpp v38, v38, v38 row_ror:2 row_mask:0xf bank_mask:0xf
    s_cbranch_scc1 L_eo_208
    s_waitcnt lgkmcnt(5)
    v_smfmac_f32_16x16x64_bf16 v[40:43], v[12:15], v[160:167], v1
    v_add_f32_dpp v38, v38, v38 row_ror:1 row_mask:0xf bank_mask:0xf
    v_smfmac_f32_16x16x64_bf16 v[44:47], v[12:15], v[208:215], v1
    ds_read_b32 v36, v62
    s_waitcnt lgkmcnt(5)
    v_smfmac_f32_16x16x64_bf16 v[40:43], v[16:19], v[168:175], v1
    v_add_f32_dpp v38, v38, v38 row_bcast:15 row_mask:0xa bank_mask:0xf
    v_smfmac_f32_16x16x64_bf16 v[44:47], v[16:19], v[216:223], v1
    s_waitcnt lgkmcnt(4)
    v_smfmac_f32_16x16x64_bf16 v[40:43], v[20:23], v[176:183], v1
    v_add_f32_dpp v38, v38, v38 row_bcast:31 row_mask:0xc bank_mask:0xf
    v_smfmac_f32_16x16x64_bf16 v[44:47], v[20:23], v[224:231], v1
    s_waitcnt lgkmcnt(0)
    v_max_f32_dpp v37, v36, v36 row_ror:4 row_mask:0xf bank_mask:0xf
    v_smfmac_f32_16x16x64_bf16 v[40:43], v[24:27], v[184:191], v1
    v_smfmac_f32_16x16x64_bf16 v[44:47], v[24:27], v[232:239], v1
    v_max_f32_dpp v37, v37, v37 row_ror:2 row_mask:0xf bank_mask:0xf
    v_smfmac_f32_16x16x64_bf16 v[40:43], v[28:31], v[192:199], v1
    v_cmp_eq_u32 vcc, -1, v36
    v_smfmac_f32_16x16x64_bf16 v[44:47], v[28:31], v[240:247], v1
    v_max_f32_dpp v37, v37, v37 row_ror:1 row_mask:0xf bank_mask:0xf
    v_smfmac_f32_16x16x64_bf16 v[40:43], v[32:35], v[200:207], v1
    v_sub_f32 v39, v61, v37
    v_smfmac_f32_16x16x64_bf16 v[44:47], v[32:35], v[248:255], v1
    v_exp_f32 v39, v39
    s_cbranch_vccnz L_mr_206
L_mk_207:
    v_mul_f32 v38, v38, v39
    ds_write_b32 v63, v38 offset:1024
    s_cmp_lt_u32 s30, 2
    s_nop 0
    v_pk_add_f32 v[40:41], v[40:41], v[42:43]
    s_nop 0
    v_pk_add_f32 v[42:43], v[44:45], v[46:47]
    v_pk_mul_f32 v[40:41], v[40:41], v[38:39] op_sel:[0,1] op_sel_hi:[1,1]
    v_pk_mul_f32 v[42:43], v[42:43], v[38:39] op_sel:[0,1] op_sel_hi:[1,1]
    ds_write_b128 v63, v[40:43]
    s_cbranch_scc1 L_comb_1
    s_waitcnt lgkmcnt(0)
    s_barrier
L_comb_1b:
    s_cmp_lt_u32 s3, 20
    s_cbranch_scc0 L_typeB_1
    s_mul_i32 s74, s30, 1664
    s_add_u32 s74, s74, s62
    s_add_u32 s74, s74, 26624
    v_and_b32 v56, 7, v0
    v_lshlrev_b32 v56, 2, v56
    v_lshrrev_b32 v62, 4, v0
    v_lshlrev_b32 v62, 3, v62
    buffer_load_dword v52, v56, s[40:43], s74 offen offset:1536 sc1
    buffer_load_dwordx2 v[54:55], v62, s[40:43], s74 offen offset:1536 sc1
    v_lshlrev_b32 v57, 4, v0
    v_lshlrev_b32 v58, 3, v0
    s_mul_i32 s57, s30, 6144
    s_add_u32 s57, s57, 30720
    v_lshrrev_b32 v59, 2, v0
    v_lshlrev_b32 v59, 6, v59
    v_bfe_u32 v53, v0, 4, 1
    v_lshl_add_u32 v59, v53, 5, v59
    v_and_b32 v53, 3, v0
    v_lshl_add_u32 v59, v53, 3, v59
    v_add_u32 v59, s57, v59
    v_xor_b32 v60, 32, v59
    s_lshl_b32 s57, s30, 8
L_pad10:
    s_cbranch_execz L_pad14
    s_add_u32 s57, s57, 157696
    v_lshl_add_u32 v61, v0, 2, s57
    ds_read_b64_tr_b16 v[28:29], v59 offset:0
    ds_read_b64_tr_b16 v[30:31], v59 offset:1024
    ds_read_b64_tr_b16 v[32:33], v59 offset:2048
    ds_read_b64_tr_b16 v[34:35], v59 offset:3072
    ds_read_b64_tr_b16 v[36:37], v59 offset:4096
    ds_read_b64_tr_b16 v[38:39], v59 offset:5120
    ds_read_b64_tr_b16 v[40:41], v60 offset:0
    ds_read_b64_tr_b16 v[42:43], v60 offset:1024
    ds_read_b64_tr_b16 v[44:45], v60 offset:2048
    ds_read_b64_tr_b16 v[46:47], v60 offset:3072
    ds_read_b64_tr_b16 v[48:49], v60 offset:4096
    ds_read_b64_tr_b16 v[50:51], v60 offset:5120
    v_mov_b64 v[20:21], 0
    v_mov_b64 v[22:23], 0
    v_mov_b64 v[24:25], 0
    v_mov_b64 v[26:27], 0
    s_add_u32 s58, s6, 132096
    s_branch L_pw_215
    s_nop 0
    s_nop 0
    s_nop 0
    s_nop 0
L_pr_216:
    buffer_load_dword v52, v56, s[40:43], s74 offen offset:1536 sc1
    buffer_load_dwordx2 v[54:55], v62, s[40:43], s74 offen offset:1536 sc1
    s_sub_u32 s56, s56, 1
    s_cbranch_scc1 L_done
L_pw_215:
    s_waitcnt vmcnt(0)
    v_max3_u32 v53, v52, v54, v55
    v_cmp_eq_u32 vcc, -1, v53
    s_cbranch_vccnz L_pr_216
    buffer_load_dwordx4 v[12:15], v57, s[40:43], s74 offen sc1
    buffer_load_dwordx2 v[16:17], v58, s[40:43], s74 offen offset:1024 sc1
    buffer_load_dword v18, v56, s[40:43], s74 offen offset:1568 sc1
    v_max_f32_dpp v53, v52, v52 row_ror:4 row_mask:0xf bank_mask:0xf
    s_nop 1
    v_max_f32_dpp v53, v53, v53 row_ror:2 row_mask:0xf bank_mask:0xf
    s_nop 1
    v_max_f32_dpp v53, v53, v53 row_ror:1 row_mask:0xf bank_mask:0xf
    v_sub_f32 v52, v52, v53
    v_sub_f32 v54, v54, v53
    v_sub_f32 v55, v55, v53
    v_exp_f32 v52, v52
    v_exp_f32 v54, v54
    v_exp_f32 v55, v55
    s_waitcnt lgkmcnt(0)
    s_branch L_ow_217
    s_nop 0
    s_nop 0
    s_nop 0
    s_nop 0
    s_nop 0
    s_nop 0
    s_nop 0
L_or_218:
    buffer_load_dwordx4 v[12:15], v57, s[40:43], s74 offen sc1
    buffer_load_dwordx2 v[16:17], v58, s[40:43], s74 offen offset:1024 sc1
    buffer_load_dword v18, v56, s[40:43], s74 offen offset:1568 sc1
    s_sub_u32 s56, s56, 1
    s_cbranch_scc1 L_done
    v_mov_b64 v[20:21], 0
    v_mov_b64 v[22:23], 0
    v_mov_b64 v[24:25], 0
    v_mov_b64 v[26:27], 0
L_ow_217:
    s_waitcnt vmcnt(2)
    v_smfmac_f32_16x16x64_bf16 v[20:23], v[12:15], v[28:35], v1
    v_max3_u32 v19, v12, v13, v14
    v_smfmac_f32_16x16x64_bf16 v[24:27], v[12:15], v[40:47], v1
    s_waitcnt vmcnt(0)
    v_mul_f32 v53, v52, v18
    v_smfmac_f32_16x16x32_bf16 v[20:23], v[16:17], v[36:39], v1
    v_max3_u32 v62, v15, v16, v17
    v_smfmac_f32_16x16x32_bf16 v[24:27], v[16:17], v[48:51], v1
    v_max3_u32 v19, v19, v62, v18
    v_add_f32_dpp v53, v53, v53 row_ror:4 row_mask:0xf bank_mask:0xf
    v_cmp_eq_u32 vcc, -1, v19
    s_cmp_eq_u32 s30, 2
    v_add_f32_dpp v53, v53, v53 row_ror:2 row_mask:0xf bank_mask:0xf
    s_cbranch_vccnz L_or_218
    s_nop 0
    v_add_f32_dpp v53, v53, v53 row_ror:1 row_mask:0xf bank_mask:0xf
    v_rcp_f32 v52, v53
    v_pk_add_f32 v[20:21], v[20:21], v[22:23]
    v_pk_add_f32 v[24:25], v[24:25], v[26:27]
    v_pk_mul_f32 v[54:55], v[54:55], v[52:53] op_sel:[0,0] op_sel_hi:[1,0]
    v_mul_f32 v20, v20, v54
    v_mul_f32 v24, v24, v54
L_pad11:
    s_cbranch_execz L_pad15
    v_fmac_f32 v20, v21, v55
    v_fmac_f32 v24, v25, v55
    s_nop 1
    v_permlane32_swap_b32 v20, v24
    v_add_f32 v20, v20, v24
    ds_write_b32 v61, v20
    s_waitcnt lgkmcnt(0)
    s_barrier
    s_cbranch_scc0 L_finb_219
    ds_read2st64_b32 v[12:13], v2 offset0:0 offset1:1
    ds_read2st64_b32 v[14:15], v2 offset0:2 offset1:3
    ds_read2st64_b32 v[16:17], v2 offset0:4 offset1:5
    ds_read2st64_b32 v[18:19], v2 offset0:6 offset1:7
    s_waitcnt lgkmcnt(2)
    v_pk_add_f32 v[12:13], v[12:13], v[14:15]
    s_waitcnt lgkmcnt(0)
    v_pk_add_f32 v[16:17], v[16:17], v[18:19]
    v_pk_add_f32 v[12:13], v[12:13], v[16:17]
    v_add_f32 v14, v12, v13
    v_add_f32 v15, v12, v13
    s_nop 1
    v_permlane16_swap_b32 v14, v15
    v_add_f32 v12, v14, v15
    buffer_store_dword v12, v3, s[40:43], s58 offen sc1
L_finb_219:
    s_sub_u32 s57, s30, 4
    s_cmp_lt_u32 s57, 3
    s_cbranch_scc0 L_skip_220
    s_sub_u32 s60, s30, 4
    s_lshl_b32 s57, s60, 11
    v_lshlrev_b32 v11, 4, v0
    v_add_u32 v11, s57, v11
    s_add_u32 s65, s62, 19456
    buffer_load_dwordx4 v[52:55], v11, s[40:43], s65 offen offset:0 sc1
    buffer_load_dwordx4 v[56:59], v11, s[40:43], s65 offen offset:1024 sc1
    s_lshl_b32 s59, s60, 12
    s_add_u32 s59, s59, 79872
    v_bfe_u32 v35, v0, 4, 1
    v_lshlrev_b32 v35, 11, v35
    v_bfe_u32 v60, v0, 2, 2
    v_lshl_add_u32 v35, v60, 8, v35
    v_lshrrev_b32 v60, 5, v0
    v_lshl_add_u32 v35, v60, 6, v35
    v_and_b32 v60, 3, v0
    v_lshl_add_u32 v35, v60, 3, v35
    v_add_u32 v35, s59, v35
    v_mov_b32 v9, 0xbdd2d3e8
    v_mov_b32 v10, 0xc0135761
    s_lshl_b32 s57, s60, 7
    s_add_u32 s57, s57, 160256
    v_lshlrev_b32 v32, 3, v0
    v_add_u32 v32, s57, v32
    v_lshlrev_b32 v33, 3, v0
    v_add_u32 v33, 129024, v33
    v_cmp_gt_u32 vcc, 16, v0
    s_nop 1
    v_cndmask_b32 v32, v33, v32, vcc
    v_and_b32 v33, 15, v0
    v_lshlrev_b32 v33, 3, v33
    v_lshrrev_b32 v60, 5, v0
    v_lshl_add_u32 v33, v60, 2, v33
    v_add_u32 v33, 160256, v33
    v_and_b32 v34, 15, v0
    v_lshlrev_b32 v34, 2, v34
    v_lshrrev_b32 v60, 5, v0
    v_lshl_add_u32 v34, v60, 6, v34
    v_bfe_u32 v60, v0, 4, 1
    v_lshl_add_u32 v34, v60, 13, v34
    s_add_u32 s60, s6, 198144
    s_add_u32 s58, s62, 39936
    s_add_u32 s57, s62, 25984
    v_and_b32 v7, 7, v0
    v_lshlrev_b32 v7, 3, v7
    v_mov_b32 v60, 0x3acccccd
    v_mov_b32 v61, 0x3727c5ac
    s_waitcnt vmcnt(0)
    buffer_load_dwordx2 v[24:25], v7, s[40:43], s57 offen sc1
    buffer_load_dwordx4 v[12:15], v11, s[40:43], s58 offen offset:0 sc1
    buffer_load_dwordx4 v[16:19], v11, s[40:43], s58 offen offset:1024 sc1
    ds_read_b64_tr_b16 v[36:37], v35 offset:0
    ds_read_b64_tr_b16 v[38:39], v35 offset:1024
    ds_read_b64_tr_b16 v[40:41], v35 offset:128
    ds_read_b64_tr_b16 v[42:43], v35 offset:1152
    ds_read_b64_tr_b16 v[44:45], v35 offset:32
    ds_read_b64_tr_b16 v[46:47], v35 offset:1056
    ds_read_b64_tr_b16 v[48:49], v35 offset:160
L_pad12:
    s_cbranch_execz L_pad16
    ds_read_b64_tr_b16 v[50:51], v35 offset:1184
L_sw_223:
    v_max3_u32 v20, v52, v53, v54
    v_max3_u32 v20, v20, v55, v56
    v_max3_u32 v20, v20, v57, v58
    v_max_u32 v20, v20, v59
    v_cmp_eq_u32 vcc, -1, v20
    s_cbranch_vccnz L_sr_224
    v_pk_add_f32 v[28:29], v[52:53], v[56:57]
    v_pk_add_f32 v[30:31], v[54:55], v[58:59]
    s_nop 1
    v_permlane32_swap_b32 v28, v30
    v_permlane32_swap_b32 v29, v31
    v_pk_add_f32 v[28:29], v[28:29], v[30:31]
    s_nop 1
    v_permlane16_swap_b32 v28, v29
    v_add_f32 v28, v28, v29
    v_mov_b64 v[52:53], 0
    v_mov_b64 v[54:55], 0
    v_mov_b64 v[56:57], 0
    v_mov_b64 v[58:59], 0
    s_waitcnt lgkmcnt(0)
L_pr_222:
    buffer_load_dwordx2 v[24:25], v7, s[40:43], s57 offen sc1
    buffer_load_dwordx4 v[12:15], v11, s[40:43], s58 offen offset:0 sc1
    buffer_load_dwordx4 v[16:19], v11, s[40:43], s58 offen offset:1024 sc1
    s_sub_u32 s56, s56, 1
    s_cbranch_scc1 L_done
L_pw_221:
    s_waitcnt vmcnt(3)
    v_max_u32 v20, v24, v25
    v_cmp_eq_u32 vcc, -1, v20
    s_cbranch_vccnz L_pr_222
    buffer_load_dwordx4 v[12:15], v11, s[40:43], s58 offen offset:0 sc1
    buffer_load_dwordx4 v[16:19], v11, s[40:43], s58 offen offset:1024 sc1
    v_add_f32_dpp v2, v24, v24 row_ror:4 row_mask:0xf bank_mask:0xf
    v_add_f32_dpp v3, v25, v25 row_ror:4 row_mask:0xf bank_mask:0xf
    v_pk_add_f32 v[20:21], v[12:13], v[16:17]
    v_pk_add_f32 v[22:23], v[14:15], v[18:19]
    v_add_f32_dpp v2, v2, v2 row_ror:2 row_mask:0xf bank_mask:0xf
    v_add_f32_dpp v3, v3, v3 row_ror:2 row_mask:0xf bank_mask:0xf
    v_permlane32_swap_b32 v20, v22
    v_permlane32_swap_b32 v21, v23
    v_add_f32_dpp v2, v2, v2 row_ror:1 row_mask:0xf bank_mask:0xf
    v_add_f32_dpp v3, v3, v3 row_ror:1 row_mask:0xf bank_mask:0xf
    v_pk_add_f32 v[20:21], v[20:21], v[22:23]
    v_mul_f32 v2, v2, v60
    v_fma_f32 v3, v3, v60, v61
    v_permlane16_swap_b32 v20, v21
    v_fma_f32 v3, -v2, v2, v3
    v_add_f32 v20, v20, v21
    v_max_f32 v3, v3, v61
    v_mul_f32 v26, v28, v2
    v_rsq_f32 v3, v3
    v_cmp_u_f32 vcc, v20, v20
    v_sub_f32 v20, v20, v26
    s_cbranch_vccnz L_hr_225
L_hk_226:
    v_fma_f32 v20, v20, v3, v4
    v_mul_f32 v21, v20, v20
    v_fma_f32 v21, v21, v9, v10
    v_mul_f32 v21, v21, v20
    v_exp_f32 v21, v21
    s_nop 0
    v_add_f32 v21, 1.0, v21
    v_rcp_f32 v21, v21
    s_nop 0
    v_mul_f32 v20, v20, v21
    s_nop 1
    v_mov_b32_dpp v21, v20 row_shl:1 row_mask:0xf bank_mask:0xf bound_ctrl:0
    v_cvt_pk_bf16_f32 v28, v20, v21
    s_nop 1
    v_mov_b32_dpp v29, v28 row_shl:4 row_mask:0xf bank_mask:0xf bound_ctrl:0
    v_mov_b32_dpp v30, v28 row_shl:8 row_mask:0xf bank_mask:0xf bound_ctrl:0
    v_mov_b32_dpp v31, v28 row_shl:12 row_mask:0xf bank_mask:0xf bound_ctrl:0
    s_nop 1
    v_smfmac_f32_16x16x64_bf16 v[52:55], v[28:31], v[36:43], v1
    v_smfmac_f32_16x16x64_bf16 v[56:59], v[28:31], v[44:51], v1
    s_cmp_eq_u32 s30, 4
    s_nop 5
    v_add_f32 v22, v52, v54
    v_add_f32 v23, v56, v58
    ds_write_b64 v32, v[22:23]
    s_cbranch_scc0 L_skip_228
L_xw_229:
    ds_read2_b32 v[20:21], v33 offset0:0 offset1:32
    ds_read_b32 v22, v33 offset:256
    s_sub_u32 s56, s56, 1
    s_cbranch_scc1 L_done
    s_waitcnt lgkmcnt(0)
    v_max3_u32 v23, v20, v21, v22
    v_add_f32 v20, v20, v21
    v_cmp_eq_u32 vcc, -1, v23
    v_add_f32 v20, v20, v22
    s_cbranch_vccnz L_xw_229
    buffer_store_dword v20, v34, s[40:43], s60 offen sc1
L_skip_228:
L_skip_220:
L_pad13:
    s_cbranch_execz L_pad17
    s_branch L_done
    s_nop 0
    s_nop 0
    s_nop 0
    s_nop 0
    s_nop 0
L_typeB_1:
    s_cmp_eq_u32 s53, 3
    s_cbranch_scc0 L_typeC_230
    s_cmp_eq_u32 s30, 7
    s_cbranch_scc1 L_w7_235
    s_cmp_lt_u32 s30, 6
    s_cbranch_scc0 L_skip_237
    s_lshr_b32 s57, s30, 1
    s_mul_i32 s57, s57, 128
    s_and_b32 s58, s30, 1
    s_lshl_b32 s58, s58, 6
    s_add_u32 s57, s57, s58
    v_lshrrev_b32 v18, 5, v0
    v_lshlrev_b32 v18, 13, v18
    v_bfe_u32 v60, v0, 3, 1
    v_lshl_add_u32 v18, v60, 12, v18
    v_bfe_u32 v60, v0, 4, 1
    v_lshl_add_u32 v18, v60, 11, v18
    v_bfe_u32 v60, v0, 2, 1
    v_mul_u32_u24 v60, 384, v60
    v_add_u32 v18, v60, v18
    v_and_b32 v60, 3, v0
    v_lshl_add_u32 v18, v60, 3, v18
    v_add_u32 v18, s57, v18
    v_add_u32 v18, 30720, v18
    v_bfe_u32 v19, v0, 4, 1
    v_lshlrev_b32 v19, 12, v19
    v_bfe_u32 v60, v0, 3, 1
    v_lshl_add_u32 v19, v60, 11, v19
    v_bfe_u32 v60, v0, 2, 1
    v_mul_u32_u24 v60, 384, v60
    v_add_u32 v19, v60, v19
    v_and_b32 v60, 3, v0
    v_lshl_add_u32 v19, v60, 3, v19
    v_add_u32 v19, s57, v19
    v_add_u32 v19, 63488, v19
    ds_read_b64_tr_b16 v[28:29], v18 offset:0
    ds_read_b64_tr_b16 v[30:31], v18 offset:1024
    ds_read_b64_tr_b16 v[32:33], v18 offset:16384
    ds_read_b64_tr_b16 v[34:35], v18 offset:17408
    ds_read_b64_tr_b16 v[36:37], v19 offset:0
    ds_read_b64_tr_b16 v[38:39], v19 offset:1024
    ds_read_b64_tr_b16 v[40:41], v18 offset:32
    ds_read_b64_tr_b16 v[42:43], v18 offset:1056
    ds_read_b64_tr_b16 v[44:45], v18 offset:16416
    ds_read_b64_tr_b16 v[46:47], v18 offset:17440
    ds_read_b64_tr_b16 v[48:49], v19 offset:32
    ds_read_b64_tr_b16 v[50:51], v19 offset:1056
    v_lshrrev_b32 v9, 4, v0
    v_lshlrev_b32 v9, 5, v9
    v_bfe_u32 v60, v0, 1, 1
    v_lshl_add_u32 v9, v60, 4, v9
    v_and_b32 v60, 1, v0
    v_mul_u32_u24 v60, 192, v60
    v_add_u32 v9, v60, v9
    v_add_u32 v9, 160832, v9
    v_lshrrev_b32 v10, 4, v0
    v_lshlrev_b32 v10, 4, v10
    v_bfe_u32 v60, v0, 1, 1
    v_lshl_add_u32 v10, v60, 3, v10
    v_and_b32 v60, 1, v0
    v_mul_u32_u24 v60, 192, v60
    v_add_u32 v10, v60, v10
    v_add_u32 v10, 160960, v10
    v_mov_b64 v[20:21], 0
    v_mov_b64 v[22:23], 0
    v_mov_b64 v[24:25], 0
    v_mov_b64 v[26:27], 0
    s_lshr_b32 s57, s30, 1
    s_lshl_b32 s57, s57, 11
    s_lshl_b32 s58, s58, 1
    s_add_u32 s57, s57, s58
    s_lshl_b32 s58, s54, 8
    s_add_u32 s57, s57, s58
    v_and_b32 v11, 31, v0
    v_lshlrev_b32 v11, 2, v11
    v_lshrrev_b32 v60, 5, v0
    v_lshl_add_u32 v11, v60, 30, v11
    v_add_u32 v11, s57, v11
    s_add_u32 s59, s62, 39936
    s_add_u32 s60, s62, 25984
L_skip_237:
    s_cmp_lt_u32 s30, 6
L_pad14:
    s_cbranch_execz L_pad18
    s_barrier
    s_cbranch_scc0 L_se_236
    ds_read_b128 v[12:15], v9
    ds_read_b64 v[16:17], v10
    s_waitcnt lgkmcnt(1)
    v_smfmac_f32_16x16x64_bf16 v[20:23], v[12:15], v[28:35], v1
    v_smfmac_f32_16x16x64_bf16 v[24:27], v[12:15], v[40:47], v1
    s_waitcnt lgkmcnt(0)
    v_smfmac_f32_16x16x32_bf16 v[20:23], v[16:17], v[36:39], v1
    v_smfmac_f32_16x16x32_bf16 v[24:27], v[16:17], v[48:51], v1
    s_cmp_eq_u32 s55, 0
    s_nop 5
    v_add_f32 v12, v20, v22
    s_nop 1
    v_add_f32_dpp v12, v24, v26 quad_perm:[0,1,2,3] row_mask:0x2 bank_mask:0xf
    s_cbranch_scc1 L_gs_238
    buffer_store_dword v12, v11, s[40:43], s59 offen
L_gb_239:
L_se_236:
    s_cmp_eq_u32 s30, 7
    s_cbranch_scc0 L_done
    s_cmp_eq_u32 s31, 0
    s_cbranch_scc0 L_done
    v_lshlrev_b32 v60, 16, v4
    v_add_f32 v2, v2, v60
    v_and_b32 v60, 0xffff0000, v4
    v_add_f32 v3, v3, v60
    v_and_b32 v60, 31, v0
    v_min_u32 v60, 19, v60
    s_mul_i32 s57, s54, 160
    v_lshrrev_b32 v7, 5, v0
    v_lshlrev_b32 v7, 2, v7
    v_add_u32 v7, s57, v7
    v_lshl_add_u32 v7, v60, 3, v7
    s_add_u32 s57, s7, 198144
    s_add_u32 s58, s7, 214528
    s_add_u32 s59, s7, 230912
    s_add_u32 s60, s7, 247296
    v_mov_b64 v[36:37], 0
    v_mov_b64 v[38:39], 0
    s_nop 0
    v_mov_b32_dpp v36, v2 quad_perm:[0,1,2,3] row_mask:0x3 bank_mask:0xf
    v_mov_b32_dpp v37, v3 quad_perm:[0,1,2,3] row_mask:0x3 bank_mask:0xf
    v_mov_b32_dpp v38, v2 quad_perm:[0,1,2,3] row_mask:0xc bank_mask:0xf
    v_mov_b32_dpp v39, v3 quad_perm:[0,1,2,3] row_mask:0xc bank_mask:0xf
    s_add_u32 s75, s7, 266252
    v_and_b32 v9, 7, v0
    v_lshlrev_b32 v9, 9, v9
    buffer_load_dword v12, v9, s[40:43], s75 offen sc1
    s_sleep 2
L_pr_251:
    buffer_load_dword v12, v9, s[40:43], s75 offen sc1
    s_sub_u32 s56, s56, 1
    s_cbranch_scc1 L_done
L_pw_250:
    s_waitcnt vmcnt(1)
    v_cmp_eq_u32 vcc, -1, v12
    s_cbranch_vccnz L_pr_251
    s_sleep 2
    buffer_load_dwordx4 v[12:15], v5, s[40:43], s57 offen sc1
    buffer_load_dwordx4 v[16:19], v5, s[40:43], s58 offen sc1
    buffer_load_dwordx4 v[20:23], v5, s[40:43], s59 offen sc1
    buffer_load_dwordx4 v[24:27], v5, s[40:43], s60 offen sc1
    s_sleep 2
L_gw_247:
    buffer_load_dwordx4 v[12:15], v5, s[40:43], s57 offen sc1
    buffer_load_dwordx4 v[16:19], v5, s[40:43], s58 offen sc1
    buffer_load_dwordx4 v[20:23], v5, s[40:43], s59 offen sc1
    buffer_load_dwordx4 v[24:27], v5, s[40:43], s60 offen sc1
    s_sub_u32 s56, s56, 1
    s_cbranch_scc1 L_done
    s_and_b32 s74, s56, 31
    s_waitcnt vmcnt(7)
    v_pk_add_f32 v[28:29], v[12:13], v[36:37]
    v_pk_add_f32 v[30:31], v[14:15], v[38:39]
    s_waitcnt vmcnt(6)
    v_pk_add_f32 v[28:29], v[28:29], v[16:17]
    v_pk_add_f32 v[30:31], v[30:31], v[18:19]
    s_waitcnt vmcnt(5)
    v_pk_add_f32 v[28:29], v[28:29], v[20:21]
    v_pk_add_f32 v[30:31], v[30:31], v[22:23]
    s_waitcnt vmcnt(4)
    v_pk_add_f32 v[28:29], v[28:29], v[24:25]
    v_pk_add_f32 v[30:31], v[30:31], v[26:27]
    v_pk_add_f32 v[32:33], v[28:29], v[30:31]
    v_cmp_u_f32 vcc, v32, v33
    v_permlane32_swap_b32 v28, v30
    v_permlane32_swap_b32 v29, v31
    s_cbranch_vccnz L_gr_248
L_gk_249:
    v_pk_add_f32 v[28:29], v[28:29], v[30:31]
    v_cvt_pk_bf16_f32 v28, v28, v29
L_pad15:
    s_cbranch_execz L_pad19
    global_store_dword v7, v28, s[24:25]
    s_branch L_done
    s_nop 0
    s_nop 0
    s_nop 0
    s_nop 0
L_gs_42:
    buffer_store_dword v33, v34, s[40:43], s67 offen sc1
    s_branch L_gb_43
    s_nop 0
    s_nop 0
    s_nop 0
    s_nop 0
    s_nop 0
L_gs_45:
    buffer_store_dword v12, v54, s[40:43], s59 offen sc1
    s_branch L_gb_46
    s_nop 0
    s_nop 0
    s_nop 0
    s_nop 0
    s_nop 0
L_cr_60:
    s_sub_u32 s56, s56, 1
    s_cbranch_scc1 L_done
    global_load_dword v2, v3, s[26:27] sc1
    s_waitcnt vmcnt(0)
    s_branch L_cw_59
    s_nop 0
    s_nop 0
L_far_61:
    s_lshl_b32 s57, s52, 2
    s_add_u32 s57, s57, s72
    s_mov_b64 exec, 1
    buffer_store_dword v25, v0, s[40:43], s57 offen offset:128 sc1
    s_mov_b64 exec, -1
    s_branch L_fb_62
    s_nop 0
L_cr_78:
    s_sub_u32 s56, s56, 1
    s_cbranch_scc1 L_done
    buffer_load_dword v2, v24, s[40:43], s72 offen sc1
    s_branch L_cw_77
    s_nop 0
    s_nop 0
    s_nop 0
L_gs_86:
    buffer_store_dword v33, v34, s[40:43], s67 offen sc1
    s_branch L_gb_87
    s_nop 0
    s_nop 0
    s_nop 0
    s_nop 0
    s_nop 0
L_gs_89:
    buffer_store_dword v12, v54, s[40:43], s59 offen sc1
    s_branch L_gb_90
    s_nop 0
    s_nop 0
    s_nop 0
    s_nop 0
    s_nop 0
L_gs_109:
    buffer_store_dword v37, v4, s[40:43], s58 offen sc1
    s_branch L_gb_110
    s_nop 0
    s_nop 0
    s_nop 0
    s_nop 0
    s_nop 0
L_cr_123:
    s_sub_u32 s56, s56, 1
    s_cbranch_scc1 L_done
    global_load_dword v2, v3, s[26:27] offset:4 sc1
    s_branch L_cw_122
    s_nop 0
    s_nop 0
    s_nop 0
L_cr_133:
    buffer_load_dword v52, v56, s[40:43], s74 offen offset:1536 sc1
    buffer_load_dwordx2 v[54:55], v62, s[40:43], s74 offen offset:1536 sc1
    s_sub_u32 s56, s56, 1
    s_cbranch_scc1 L_done
    s_branch L_cw_132
    s_nop 0
L_gs_138:
    buffer_store_dword v14, v3, s[40:43], s57 offen sc1
    s_branch L_gb_139
    s_nop 0
    s_nop 0
    s_nop 0
    s_nop 0
    s_nop 0
L_gs_140:
    buffer_store_dword v12, v4, s[40:43], s57 offen offset:32 sc1
    s_branch L_gb_141
    s_nop 0
    s_nop 0
    s_nop 0
    s_nop 0
    s_nop 0
L_comb_0:
    s_mov_b32 s57, 0
    s_cmp_eq_u32 s55, 0
    s_waitcnt lgkmcnt(0)
    s_barrier
    ds_read2st64_b64 v[12:15], v2 offset0:0 offset1:4
    ds_read2st64_b64 v[16:19], v2 offset0:8 offset1:12
    ds_read2st64_b64 v[20:23], v2 offset0:16 offset1:20
    ds_read2st64_b64 v[24:27], v2 offset0:24 offset1:28
    s_waitcnt lgkmcnt(2)
    v_pk_add_f32 v[12:13], v[12:13], v[14:15]
    v_pk_add_f32 v[16:17], v[16:17], v[18:19]
    v_pk_add_f32 v[12:13], v[12:13], v[16:17]
    s_waitcnt lgkmcnt(0)
    v_pk_add_f32 v[20:21], v[20:21], v[22:23]
    v_pk_add_f32 v[24:25], v[24:25], v[26:27]
L_pad16:
    s_cbranch_execz L_pad20
    v_pk_add_f32 v[12:13], v[12:13], v[20:21]
    v_pk_add_f32 v[12:13], v[12:13], v[24:25]
    v_cvt_pk_bf16_f32 v14, v12, v13
    v_min_u32 v14, -2, v14
    s_cbranch_scc1 L_gs_138
    buffer_store_dword v14, v3, s[40:43], s57 offen
L_gb_139:
    s_cbranch_scc1 L_gs_140
    buffer_store_dword v12, v4, s[40:43], s57 offen offset:32
L_gb_141:
    s_branch L_comb_0b
    s_nop 0
L_sr_150:
    buffer_load_dwordx4 v[52:55], v11, s[40:43], s65 offen offset:0 sc1
    buffer_load_dwordx4 v[56:59], v11, s[40:43], s65 offen offset:1024 sc1
    s_sub_u32 s56, s56, 1
    s_cbranch_scc1 L_done
    s_waitcnt vmcnt(0)
    s_branch L_sw_149
L_hr_151:
    buffer_load_dwordx4 v[12:15], v11, s[40:43], s58 offen offset:0 sc1
    buffer_load_dwordx4 v[16:19], v11, s[40:43], s58 offen offset:1024 sc1
    s_sub_u32 s56, s56, 1
    s_cbranch_scc1 L_done
    s_and_b32 s64, s56, 31
    s_cbranch_scc0 L_hx_153
    s_waitcnt vmcnt(2)
    v_pk_add_f32 v[20:21], v[12:13], v[16:17]
    v_pk_add_f32 v[22:23], v[14:15], v[18:19]
    s_nop 1
    v_permlane32_swap_b32 v20, v22
    v_permlane32_swap_b32 v21, v23
    v_pk_add_f32 v[20:21], v[20:21], v[22:23]
    s_nop 1
    v_permlane16_swap_b32 v20, v21
    v_add_f32 v20, v20, v21
    v_cmp_u_f32 vcc, v20, v20
    v_sub_f32 v20, v20, v26
    s_cbranch_vccnz L_hr_151
    s_branch L_hk_152
    s_nop 0
    s_nop 0
    s_nop 0
    s_nop 0
    s_nop 0
    s_nop 0
    s_nop 0
L_hx_153:
    s_waitcnt vmcnt(0)
    v_max3_u32 v20, v12, v13, v14
    v_max3_u32 v20, v20, v15, v16
    v_max3_u32 v20, v20, v17, v18
    v_max_u32 v20, v20, v19
    v_cmp_eq_u32 vcc, -1, v20
    s_cbranch_vccnz L_hr_151
    v_pk_add_f32 v[20:21], v[12:13], v[16:17]
    v_pk_add_f32 v[22:23], v[14:15], v[18:19]
    s_nop 1
    v_permlane32_swap_b32 v20, v22
    v_permlane32_swap_b32 v21, v23
    v_pk_add_f32 v[20:21], v[20:21], v[22:23]
    s_nop 1
    v_permlane16_swap_b32 v20, v21
    v_add_f32 v20, v20, v21
    v_sub_f32 v20, v20, v26
    s_branch L_hk_152
L_gs_161:
    buffer_store_dword v0, v11, s[40:43], s58 offen sc1
    s_branch L_gb_162
    s_nop 0
    s_nop 0
    s_nop 0
    s_nop 0
    s_nop 0
L_typeC_157:
    s_cmp_eq_u32 s30, 6
    s_cbranch_scc0 L_p1
    s_cmp_eq_u32 s3, 21
    s_cbranch_scc0 L_skip_158
    v_and_b32 v11, 3, v0
    v_lshlrev_b32 v11, 7, v11
    v_lshrrev_b32 v60, 2, v0
    v_lshl_add_u32 v11, v60, 24, v11
    s_add_u32 s58, s62, 26116
    s_add_u32 s75, s7, 266244
    v_and_b32 v9, 7, v0
    v_lshlrev_b32 v9, 9, v9
    buffer_load_dword v12, v9, s[40:43], s75 offen sc1
    s_sleep 2
L_pr_160:
    buffer_load_dword v12, v9, s[40:43], s75 offen sc1
    s_sub_u32 s56, s56, 1
    s_cbranch_scc1 L_done
L_pw_159:
    s_waitcnt vmcnt(1)
    v_cmp_eq_u32 vcc, -1, v12
    s_cbranch_vccnz L_pr_160
    s_cmp_eq_u32 s55, 0
    s_cbranch_scc1 L_gs_161
    buffer_store_dword v0, v11, s[40:43], s58 offen
L_gb_162:
    s_waitcnt vmcnt(1)
    s_branch L_p1
    s_nop 0
L_skip_158:
    s_cmp_eq_u32 s3, 20
    s_cbranch_scc0 L_p1
    s_lshl_b32 s59, s31, 9
    s_add_u32 s59, s59, s8
    s_add_u32 s59, s59, 266240
    v_and_b32 v10, 1, v0
    v_lshlrev_b32 v10, 13, v10
L_pad17:
    s_cbranch_execz L_pad21
    v_lshrrev_b32 v60, 1, v0
    v_lshl_add_u32 v10, v60, 24, v10
    s_add_u32 s58, s62, 1568
    v_lshrrev_b32 v9, 3, v0
    v_mul_u32_u24 v9, 1664, v9
    v_and_b32 v60, 7, v0
    v_lshl_add_u32 v9, v60, 2, v9
    buffer_load_dword v12, v9, s[40:43], s58 offen sc1
    s_sleep 2
L_pr_164:
    buffer_load_dword v12, v9, s[40:43], s58 offen sc1
    s_sub_u32 s56, s56, 1
    s_cbranch_scc1 L_done
L_pw_163:
    s_waitcnt vmcnt(1)
    v_cmp_eq_u32 vcc, -1, v12
    s_cbranch_vccnz L_pr_164
    buffer_store_dword v0, v10, s[40:43], s59 offen offset:0 sc1
    s_add_u32 s58, s62, 25856
    v_and_b32 v9, 15, v0
    v_lshlrev_b32 v9, 2, v9
    buffer_load_dword v13, v9, s[40:43], s58 offen sc1
    s_sleep 2
L_pr_166:
    buffer_load_dword v13, v9, s[40:43], s58 offen sc1
    s_sub_u32 s56, s56, 1
    s_cbranch_scc1 L_done
L_pw_165:
    s_waitcnt vmcnt(1)
    v_cmp_eq_u32 vcc, -1, v13
    s_cbranch_vccnz L_pr_166
    buffer_store_dword v0, v10, s[40:43], s59 offen offset:4 sc1
    s_waitcnt vmcnt(1)
    s_branch L_p1
    s_nop 0
    s_nop 0
    s_nop 0
    s_nop 0
    s_nop 0
    s_nop 0
L_gs_170:
    buffer_store_dword v12, v11, s[40:43], s60 offen sc1
    s_branch L_gb_171
    s_nop 0
    s_nop 0
    s_nop 0
    s_nop 0
    s_nop 0
L_gs_172:
    buffer_store_dword v12, v11, s[40:43], s59 offen sc1
    s_branch L_gb_173
    s_nop 0
    s_nop 0
    s_nop 0
    s_nop 0
    s_nop 0
L_gr_175:
    s_cbranch_scc1 L_gw_174
    s_waitcnt vmcnt(0)
    v_max3_u32 v32, v12, v13, v14
    v_max3_u32 v32, v32, v15, v16
    v_max3_u32 v32, v32, v17, v18
    v_max3_u32 v32, v32, v19, v20
    v_max3_u32 v32, v32, v21, v22
    v_max3_u32 v32, v32, v23, v24
    v_max3_u32 v32, v32, v25, v26
    v_max_u32 v32, v32, v27
    v_cmp_eq_u32 vcc, -1, v32
    s_cbranch_vccnz L_gw_174
    v_pk_add_f32 v[28:29], v[12:13], v[36:37]
    v_pk_add_f32 v[30:31], v[14:15], v[38:39]
    v_pk_add_f32 v[28:29], v[28:29], v[16:17]
    v_pk_add_f32 v[30:31], v[30:31], v[18:19]
    v_pk_add_f32 v[28:29], v[28:29], v[20:21]
    v_pk_add_f32 v[30:31], v[30:31], v[22:23]
    v_pk_add_f32 v[28:29], v[28:29], v[24:25]
    v_pk_add_f32 v[30:31], v[30:31], v[26:27]
    s_nop 1
    v_permlane32_swap_b32 v28, v30
    v_permlane32_swap_b32 v29, v31
    s_branch L_gk_176
    s_nop 0
L_gs_179:
    buffer_store_dword v33, v34, s[40:43], s67 offen sc1
    s_branch L_gb_180
    s_nop 0
    s_nop 0
    s_nop 0
    s_nop 0
    s_nop 0
L_w7_167:
    v_and_b32 v60, 31, v0
    v_min_u32 v60, 19, v60
    s_mul_i32 s57, s54, 320
    v_lshrrev_b32 v5, 5, v0
    v_lshlrev_b32 v5, 12, v5
    v_add_u32 v5, s57, v5
    v_lshl_add_u32 v5, v60, 4, v5
    v_and_b32 v60, 31, v0
    v_cmp_gt_u32 s[64:65], 20, v60
    v_min_u32 v60, 19, v60
    v_lshrrev_b32 v35, 5, v0
    v_lshlrev_b32 v35, 2, v35
    v_add_u32 v35, 160832, v35
L_pad18:
    s_cbranch_execz L_pad22
    v_lshl_add_u32 v35, v60, 3, v35
    s_add_u32 s66, s62, 13312
    s_add_u32 s67, s62, 25856
    s_lshl_b32 s57, s54, 3
    v_lshrrev_b32 v34, 5, v0
    v_lshlrev_b32 v34, 2, v34
    v_add_u32 v34, s57, v34
    v_and_b32 v60, 31, v0
    v_mov_b32 v61, 0x7f000000
    v_cmp_ne_u32 vcc, 31, v60
    s_nop 1
    v_cndmask_b32 v34, v34, v61, vcc
    v_mov_b32 v61, 0x3f803f80
    s_add_u32 s57, s7, 0
    s_add_u32 s58, s7, 16384
    s_add_u32 s59, s7, 32768
    s_add_u32 s60, s7, 49152
    v_mov_b64 v[36:37], 0
    v_mov_b64 v[38:39], 0
    s_nop 0
    v_mov_b32_dpp v36, v2 quad_perm:[0,1,2,3] row_mask:0x3 bank_mask:0xf
    v_mov_b32_dpp v37, v3 quad_perm:[0,1,2,3] row_mask:0x3 bank_mask:0xf
    v_mov_b32_dpp v38, v2 quad_perm:[0,1,2,3] row_mask:0xc bank_mask:0xf
    v_mov_b32_dpp v39, v3 quad_perm:[0,1,2,3] row_mask:0xc bank_mask:0xf
    s_add_u32 s75, s7, 266240
    v_and_b32 v9, 7, v0
    v_lshlrev_b32 v9, 9, v9
    buffer_load_dword v12, v9, s[40:43], s75 offen sc1
    s_sleep 2
L_pr_178:
    buffer_load_dword v12, v9, s[40:43], s75 offen sc1
    s_sub_u32 s56, s56, 1
    s_cbranch_scc1 L_done
L_pw_177:
    s_waitcnt vmcnt(1)
    v_cmp_eq_u32 vcc, -1, v12
    s_cbranch_vccnz L_pr_178
    s_sleep 1
    buffer_load_dwordx4 v[12:15], v5, s[40:43], s57 offen sc1
    buffer_load_dwordx4 v[16:19], v5, s[40:43], s58 offen sc1
    buffer_load_dwordx4 v[20:23], v5, s[40:43], s59 offen sc1
    buffer_load_dwordx4 v[24:27], v5, s[40:43], s60 offen sc1
    s_sleep 2
L_gw_174:
    buffer_load_dwordx4 v[12:15], v5, s[40:43], s57 offen sc1
    buffer_load_dwordx4 v[16:19], v5, s[40:43], s58 offen sc1
    buffer_load_dwordx4 v[20:23], v5, s[40:43], s59 offen sc1
    buffer_load_dwordx4 v[24:27], v5, s[40:43], s60 offen sc1
    s_sub_u32 s56, s56, 1
    s_cbranch_scc1 L_done
    s_and_b32 s74, s56, 31
    s_waitcnt vmcnt(7)
    v_pk_add_f32 v[28:29], v[12:13], v[36:37]
    v_pk_add_f32 v[30:31], v[14:15], v[38:39]
    s_waitcnt vmcnt(6)
    v_pk_add_f32 v[28:29], v[28:29], v[16:17]
    v_pk_add_f32 v[30:31], v[30:31], v[18:19]
    s_waitcnt vmcnt(5)
    v_pk_add_f32 v[28:29], v[28:29], v[20:21]
    v_pk_add_f32 v[30:31], v[30:31], v[22:23]
    s_waitcnt vmcnt(4)
    v_pk_add_f32 v[28:29], v[28:29], v[24:25]
    v_pk_add_f32 v[30:31], v[30:31], v[26:27]
    v_pk_add_f32 v[32:33], v[28:29], v[30:31]
    v_cmp_u_f32 vcc, v32, v33
    v_permlane32_swap_b32 v28, v30
    v_permlane32_swap_b32 v29, v31
    s_cbranch_vccnz L_gr_175
L_gk_176:
    v_pk_add_f32 v[28:29], v[28:29], v[30:31]
    v_cvt_pk_bf16_f32 v28, v28, v29
    ds_write_b32 v35, v28
    s_waitcnt lgkmcnt(0)
    s_barrier
    v_cndmask_b32 v29, 0, v28, s[64:65]
    v_dot2_f32_bf16 v33, v29, v61, 0
    v_dot2_f32_bf16 v32, v29, v29, 0
    v_lshlrev_b32 v2, 16, v28
    v_and_b32 v3, 0xffff0000, v28
    s_cmp_eq_u32 s55, 0
    v_permlane32_swap_b32 v33, v32
    v_add_f32 v33, v33, v32
    s_nop 1
    v_add_f32_dpp v33, v33, v33 row_ror:8 row_mask:0xf bank_mask:0xf
    s_nop 1
    v_add_f32_dpp v33, v33, v33 row_ror:4 row_mask:0xf bank_mask:0xf
    s_nop 1
    v_add_f32_dpp v33, v33, v33 row_ror:2 row_mask:0xf bank_mask:0xf
L_pad19:
    s_cbranch_execz L_pad23
    s_nop 1
    v_add_f32_dpp v33, v33, v33 row_ror:1 row_mask:0xf bank_mask:0xf
    s_nop 1
    v_add_f32_dpp v33, v33, v33 row_bcast:15 row_mask:0xa bank_mask:0xf
    s_cbranch_scc1 L_gs_179
    buffer_store_dword v33, v34, s[40:43], s67 offen
L_gb_180:
    s_waitcnt vmcnt(1)
    s_branch L_se_168
    s_nop 0
    s_nop 0
    s_nop 0
    s_nop 0
L_gs_184:
    buffer_store_dword v12, v11, s[40:43], s59 offen sc1
    s_branch L_gb_185
    s_nop 0
    s_nop 0
    s_nop 0
    s_nop 0
    s_nop 0
L_gr_190:
    s_cbranch_scc1 L_gw_189
    s_waitcnt vmcnt(0)
    v_max3_u32 v32, v12, v13, v14
    v_max3_u32 v32, v32, v15, v16
    v_max3_u32 v32, v32, v17, v18
    v_max3_u32 v32, v32, v19, v20
    v_max3_u32 v32, v32, v21, v22
    v_max3_u32 v32, v32, v23, v24
    v_max3_u32 v32, v32, v25, v26
    v_max_u32 v32, v32, v27
    v_cmp_eq_u32 vcc, -1, v32
    s_cbranch_vccnz L_gw_189
    v_pk_add_f32 v[28:29], v[12:13], v[36:37]
    v_pk_add_f32 v[30:31], v[14:15], v[38:39]
    v_pk_add_f32 v[28:29], v[28:29], v[16:17]
    v_pk_add_f32 v[30:31], v[30:31], v[18:19]
    v_pk_add_f32 v[28:29], v[28:29], v[20:21]
    v_pk_add_f32 v[30:31], v[30:31], v[22:23]
    v_pk_add_f32 v[28:29], v[28:29], v[24:25]
    v_pk_add_f32 v[30:31], v[30:31], v[26:27]
    s_nop 1
    v_permlane32_swap_b32 v28, v30
    v_permlane32_swap_b32 v29, v31
    s_branch L_gk_191
    s_nop 0
L_gr_193:
    s_cbranch_scc1 L_gw_192
    s_waitcnt vmcnt(0)
    v_max3_u32 v32, v12, v13, v14
    v_max3_u32 v32, v32, v15, v16
    v_max3_u32 v32, v32, v17, v18
    v_max3_u32 v32, v32, v19, v20
    v_max3_u32 v32, v32, v21, v22
    v_max3_u32 v32, v32, v23, v24
    v_max3_u32 v32, v32, v25, v26
    v_max_u32 v32, v32, v27
    v_cmp_eq_u32 vcc, -1, v32
    s_cbranch_vccnz L_gw_192
    v_pk_add_f32 v[28:29], v[12:13], v[36:37]
    v_pk_add_f32 v[30:31], v[14:15], v[38:39]
    v_pk_add_f32 v[28:29], v[28:29], v[16:17]
    v_pk_add_f32 v[30:31], v[30:31], v[18:19]
    v_pk_add_f32 v[28:29], v[28:29], v[20:21]
    v_pk_add_f32 v[30:31], v[30:31], v[22:23]
    v_pk_add_f32 v[28:29], v[28:29], v[24:25]
    v_pk_add_f32 v[30:31], v[30:31], v[26:27]
    s_nop 1
    v_permlane32_swap_b32 v28, v30
    v_permlane32_swap_b32 v29, v31
    s_branch L_gk_194
    s_nop 0
L_gs_197:
    buffer_store_dword v33, v34, s[40:43], s67 offen sc1
    s_branch L_gb_198
    s_nop 0
    s_nop 0
    s_nop 0
    s_nop 0
    s_nop 0
L_w7_181:
    v_and_b32 v60, 31, v0
    v_min_u32 v60, 19, v60
    s_mul_i32 s57, s54, 320
    v_lshrrev_b32 v5, 5, v0
    v_lshlrev_b32 v5, 12, v5
    v_add_u32 v5, s57, v5
    v_lshl_add_u32 v5, v60, 4, v5
    v_and_b32 v60, 31, v0
    v_cmp_gt_u32 s[64:65], 20, v60
    v_min_u32 v60, 19, v60
    v_lshrrev_b32 v35, 5, v0
    v_lshlrev_b32 v35, 2, v35
    v_add_u32 v35, 160832, v35
L_pad20:
    s_cbranch_execz L_pad24
    v_lshl_add_u32 v35, v60, 3, v35
    s_mul_i32 s66, s53, 6144
    s_add_u32 s66, s66, s62
    s_add_u32 s66, s66, 46080
    s_lshl_b32 s67, s53, 6
    s_add_u32 s67, s67, s62
    s_add_u32 s67, s67, 25600
    s_lshl_b32 s57, s54, 3
    v_lshrrev_b32 v34, 5, v0
    v_lshlrev_b32 v34, 2, v34
    v_add_u32 v34, s57, v34
    v_and_b32 v60, 31, v0
    v_mov_b32 v61, 0x7f000000
    v_cmp_ne_u32 vcc, 31, v60
    s_nop 1
    v_cndmask_b32 v34, v34, v61, vcc
    v_mov_b32 v61, 0x3f803f80
    s_cmp_lg_u32 s53, 3
    s_cbranch_scc0 L_skip_186
    s_add_u32 s57, s62, 25856
    v_mov_b32 v9, 0
L_pr_188:
    buffer_load_dword v12, v9, s[40:43], s57 offen sc1
    s_sub_u32 s56, s56, 1
    s_cbranch_scc1 L_done
L_pw_187:
    s_waitcnt vmcnt(0)
    v_cmp_eq_u32 vcc, -1, v12
    s_cbranch_vccnz L_pr_188
    s_add_u32 s57, s7, 0
    s_add_u32 s58, s7, 16384
    s_add_u32 s59, s7, 32768
    s_add_u32 s60, s7, 49152
    v_mov_b64 v[36:37], 0
    v_mov_b64 v[38:39], 0
    s_nop 0
    v_mov_b32_dpp v36, v2 quad_perm:[0,1,2,3] row_mask:0x3 bank_mask:0xf
    v_mov_b32_dpp v37, v3 quad_perm:[0,1,2,3] row_mask:0x3 bank_mask:0xf
    v_mov_b32_dpp v38, v2 quad_perm:[0,1,2,3] row_mask:0xc bank_mask:0xf
    v_mov_b32_dpp v39, v3 quad_perm:[0,1,2,3] row_mask:0xc bank_mask:0xf
L_gw_189:
    buffer_load_dwordx4 v[12:15], v5, s[40:43], s57 offen sc1
    buffer_load_dwordx4 v[16:19], v5, s[40:43], s58 offen sc1
    buffer_load_dwordx4 v[20:23], v5, s[40:43], s59 offen sc1
    buffer_load_dwordx4 v[24:27], v5, s[40:43], s60 offen sc1
    s_sub_u32 s56, s56, 1
    s_cbranch_scc1 L_done
    s_and_b32 s74, s56, 31
    s_waitcnt vmcnt(3)
    v_pk_add_f32 v[28:29], v[12:13], v[36:37]
    v_pk_add_f32 v[30:31], v[14:15], v[38:39]
    s_waitcnt vmcnt(2)
    v_pk_add_f32 v[28:29], v[28:29], v[16:17]
    v_pk_add_f32 v[30:31], v[30:31], v[18:19]
    s_waitcnt vmcnt(1)
    v_pk_add_f32 v[28:29], v[28:29], v[20:21]
    v_pk_add_f32 v[30:31], v[30:31], v[22:23]
    s_waitcnt vmcnt(0)
    v_pk_add_f32 v[28:29], v[28:29], v[24:25]
    v_pk_add_f32 v[30:31], v[30:31], v[26:27]
    v_pk_add_f32 v[32:33], v[28:29], v[30:31]
    v_cmp_u_f32 vcc, v32, v33
    v_permlane32_swap_b32 v28, v30
    v_permlane32_swap_b32 v29, v31
    s_cbranch_vccnz L_gr_190
L_gk_191:
    v_pk_add_f32 v[28:29], v[28:29], v[30:31]
    v_cvt_pk_bf16_f32 v28, v28, v29
    v_lshlrev_b32 v2, 16, v28
    v_and_b32 v3, 0xffff0000, v28
L_skip_186:
    v_lshlrev_b32 v60, 16, v4
    v_add_f32 v2, v2, v60
    v_and_b32 v60, 0xffff0000, v4
    v_add_f32 v3, v3, v60
    s_add_u32 s57, s7, 66048
    s_add_u32 s58, s7, 82432
    s_add_u32 s59, s7, 98816
    s_add_u32 s60, s7, 115200
    v_mov_b64 v[36:37], 0
    v_mov_b64 v[38:39], 0
    s_nop 0
    v_mov_b32_dpp v36, v2 quad_perm:[0,1,2,3] row_mask:0x3 bank_mask:0xf
    v_mov_b32_dpp v37, v3 quad_perm:[0,1,2,3] row_mask:0x3 bank_mask:0xf
    v_mov_b32_dpp v38, v2 quad_perm:[0,1,2,3] row_mask:0xc bank_mask:0xf
    v_mov_b32_dpp v39, v3 quad_perm:[0,1,2,3] row_mask:0xc bank_mask:0xf
    s_lshl_b32 s74, s53, 7
    s_add_u32 s75, s62, s74
    s_add_u32 s75, s75, 26116
    v_mov_b32 v9, 0
L_pad21:
    s_cbranch_execz L_pad25
    buffer_load_dword v12, v9, s[40:43], s75 offen sc1
    s_sleep 2
L_pr_196:
    buffer_load_dword v12, v9, s[40:43], s75 offen sc1
    s_sub_u32 s56, s56, 1
    s_cbranch_scc1 L_done
L_pw_195:
    s_waitcnt vmcnt(1)
    v_cmp_eq_u32 vcc, -1, v12
    s_cbranch_vccnz L_pr_196
    buffer_load_dwordx4 v[12:15], v5, s[40:43], s57 offen sc1
    buffer_load_dwordx4 v[16:19], v5, s[40:43], s58 offen sc1
    buffer_load_dwordx4 v[20:23], v5, s[40:43], s59 offen sc1
    buffer_load_dwordx4 v[24:27], v5, s[40:43], s60 offen sc1
    s_sleep 2
L_gw_192:
    buffer_load_dwordx4 v[12:15], v5, s[40:43], s57 offen sc1
    buffer_load_dwordx4 v[16:19], v5, s[40:43], s58 offen sc1
    buffer_load_dwordx4 v[20:23], v5, s[40:43], s59 offen sc1
    buffer_load_dwordx4 v[24:27], v5, s[40:43], s60 offen sc1
    s_sub_u32 s56, s56, 1
    s_cbranch_scc1 L_done
    s_and_b32 s74, s56, 31
    s_waitcnt vmcnt(7)
    v_pk_add_f32 v[28:29], v[12:13], v[36:37]
    v_pk_add_f32 v[30:31], v[14:15], v[38:39]
    s_waitcnt vmcnt(6)
    v_pk_add_f32 v[28:29], v[28:29], v[16:17]
    v_pk_add_f32 v[30:31], v[30:31], v[18:19]
    s_waitcnt vmcnt(5)
    v_pk_add_f32 v[28:29], v[28:29], v[20:21]
    v_pk_add_f32 v[30:31], v[30:31], v[22:23]
    s_waitcnt vmcnt(4)
    v_pk_add_f32 v[28:29], v[28:29], v[24:25]
    v_pk_add_f32 v[30:31], v[30:31], v[26:27]
    v_pk_add_f32 v[32:33], v[28:29], v[30:31]
    v_cmp_u_f32 vcc, v32, v33
    v_permlane32_swap_b32 v28, v30
    v_permlane32_swap_b32 v29, v31
    s_cbranch_vccnz L_gr_193
L_gk_194:
    v_pk_add_f32 v[28:29], v[28:29], v[30:31]
    v_cvt_pk_bf16_f32 v28, v28, v29
    ds_write_b32 v35, v28
    s_waitcnt lgkmcnt(0)
    s_barrier
    v_cndmask_b32 v29, 0, v28, s[64:65]
    v_dot2_f32_bf16 v33, v29, v61, 0
    v_dot2_f32_bf16 v32, v29, v29, 0
    v_lshlrev_b32 v2, 16, v28
    v_and_b32 v3, 0xffff0000, v28
    s_cmp_eq_u32 s55, 0
    v_permlane32_swap_b32 v33, v32
    v_add_f32 v33, v33, v32
    s_nop 1
    v_add_f32_dpp v33, v33, v33 row_ror:8 row_mask:0xf bank_mask:0xf
    s_nop 1
    v_add_f32_dpp v33, v33, v33 row_ror:4 row_mask:0xf bank_mask:0xf
    s_nop 1
    v_add_f32_dpp v33, v33, v33 row_ror:2 row_mask:0xf bank_mask:0xf
    s_nop 1
    v_add_f32_dpp v33, v33, v33 row_ror:1 row_mask:0xf bank_mask:0xf
    s_nop 1
    v_add_f32_dpp v33, v33, v33 row_bcast:15 row_mask:0xa bank_mask:0xf
    s_cbranch_scc1 L_gs_197
    buffer_store_dword v33, v34, s[40:43], s67 offen
L_gb_198:
    s_waitcnt vmcnt(1)
    s_branch L_se_182
    s_nop 0
    s_nop 0
    s_nop 0
    s_nop 0
    s_nop 0
    s_nop 0
    s_nop 0
L_hr_203:
    buffer_load_dwordx4 v[12:15], v7, s[40:43], s59 offen offset:0 sc1
    buffer_load_dwordx4 v[16:19], v7, s[40:43], s59 offen offset:1024 sc1
    s_sub_u32 s56, s56, 1
    s_cbranch_scc1 L_done
    s_and_b32 s64, s56, 31
    s_cbranch_scc0 L_hx_205
    s_waitcnt vmcnt(0)
    v_pk_add_f32 v[20:21], v[12:13], v[16:17]
    v_pk_add_f32 v[22:23], v[14:15], v[18:19]
    s_nop 1
    v_permlane32_swap_b32 v20, v22
    v_permlane32_swap_b32 v21, v23
    v_pk_add_f32 v[20:21], v[20:21], v[22:23]
    s_nop 1
    v_permlane16_swap_b32 v20, v21
    v_add_f32 v20, v20, v21
    v_cmp_u_f32 vcc, v20, v20
    v_sub_f32 v20, v20, v50
    s_cbranch_vccnz L_hr_203
L_pad22:
    s_cbranch_execz L_pad26
    s_branch L_hk_204
    s_nop 0
    s_nop 0
    s_nop 0
    s_nop 0
    s_nop 0
    s_nop 0
L_hx_205:
    s_waitcnt vmcnt(0)
    v_max3_u32 v20, v12, v13, v14
    v_max3_u32 v20, v20, v15, v16
    v_max3_u32 v20, v20, v17, v18
    v_max_u32 v20, v20, v19
    v_cmp_eq_u32 vcc, -1, v20
    s_cbranch_vccnz L_hr_203
    v_pk_add_f32 v[20:21], v[12:13], v[16:17]
    v_pk_add_f32 v[22:23], v[14:15], v[18:19]
    s_nop 1
    v_permlane32_swap_b32 v20, v22
    v_permlane32_swap_b32 v21, v23
    v_pk_add_f32 v[20:21], v[20:21], v[22:23]
    s_nop 1
    v_permlane16_swap_b32 v20, v21
    v_add_f32 v20, v20, v21
    v_sub_f32 v20, v20, v50
    s_branch L_hk_204
L_qo_199:
    v_mov_b64 v[24:25], 0
    v_mov_b64 v[26:27], 0
    v_mov_b64 v[28:29], 0
    v_mov_b64 v[30:31], 0
    v_mov_b64 v[32:33], 0
    v_mov_b64 v[34:35], 0
    v_mov_b64 v[36:37], 0
    v_mov_b64 v[38:39], 0
    v_mov_b64 v[40:41], 0
    v_mov_b64 v[42:43], 0
    v_mov_b64 v[44:45], 0
    v_mov_b64 v[46:47], 0
    v_lshrrev_b32 v5, 4, v0
    v_lshlrev_b32 v5, 5, v5
    v_bfe_u32 v60, v0, 1, 1
    v_lshl_add_u32 v5, v60, 4, v5
    v_add_u32 v5, 124928, v5
    s_branch L_qb_200
    s_nop 0
    s_nop 0
    s_nop 0
L_eo_208:
    s_waitcnt lgkmcnt(5)
    v_smfmac_f32_16x16x64_bf16 v[40:43], v[12:15], v[160:167], v1
    v_add_f32_dpp v38, v38, v38 row_ror:1 row_mask:0xf bank_mask:0xf
    v_smfmac_f32_16x16x64_bf16 v[44:47], v[12:15], v[208:215], v1
    s_waitcnt lgkmcnt(4)
    v_smfmac_f32_16x16x64_bf16 v[40:43], v[16:19], v[168:175], v1
    v_add_f32_dpp v38, v38, v38 row_bcast:15 row_mask:0xa bank_mask:0xf
    v_smfmac_f32_16x16x64_bf16 v[44:47], v[16:19], v[216:223], v1
    s_waitcnt lgkmcnt(3)
    v_smfmac_f32_16x16x64_bf16 v[40:43], v[20:23], v[176:183], v1
    v_add_f32_dpp v38, v38, v38 row_bcast:31 row_mask:0xc bank_mask:0xf
    v_smfmac_f32_16x16x64_bf16 v[44:47], v[20:23], v[224:231], v1
    s_waitcnt lgkmcnt(0)
    v_smfmac_f32_16x16x64_bf16 v[40:43], v[24:27], v[184:191], v1
    v_smfmac_f32_16x16x64_bf16 v[44:47], v[24:27], v[232:239], v1
    v_smfmac_f32_16x16x64_bf16 v[40:43], v[28:31], v[192:199], v1
    v_smfmac_f32_16x16x64_bf16 v[44:47], v[28:31], v[240:247], v1
    v_smfmac_f32_16x16x64_bf16 v[40:43], v[32:35], v[200:207], v1
    v_smfmac_f32_16x16x64_bf16 v[44:47], v[32:35], v[248:255], v1
L_mr_206:
    ds_read_b32 v36, v62
    s_sub_u32 s56, s56, 1
    s_cbranch_scc1 L_done
    s_waitcnt lgkmcnt(0)
    v_cmp_eq_u32 vcc, -1, v36
    s_cbranch_vccnz L_mr_206
    v_max_f32_dpp v37, v36, v36 row_ror:4 row_mask:0xf bank_mask:0xf
    s_nop 1
    v_max_f32_dpp v37, v37, v37 row_ror:2 row_mask:0xf bank_mask:0xf
    s_nop 1
    v_max_f32_dpp v37, v37, v37 row_ror:1 row_mask:0xf bank_mask:0xf
    v_sub_f32 v39, v61, v37
    v_exp_f32 v39, v39
    s_branch L_mk_207
    s_nop 0
    s_nop 0
    s_nop 0
    s_nop 0
L_gs_209:
    buffer_store_dword v37, v4, s[40:43], s58 offen sc1
    s_branch L_gb_210
    s_nop 0
    s_nop 0
    s_nop 0
    s_nop 0
    s_nop 0
L_gs_211:
    buffer_store_dword v14, v3, s[40:43], s57 offen sc1
    s_branch L_gb_212
    s_nop 0
    s_nop 0
    s_nop 0
    s_nop 0
    s_nop 0
L_gs_213:
L_pad23:
    s_cbranch_execz L_padback
    buffer_store_dword v12, v4, s[40:43], s57 offen offset:32 sc1
    s_branch L_gb_214
    s_nop 0
    s_nop 0
    s_nop 0
    s_nop 0
L_comb_1:
    s_mov_b32 s58, 26624
    s_cmp_eq_u32 s55, 0
    s_cbranch_scc1 L_gs_209
    buffer_store_dword v37, v4, s[40:43], s58 offen
L_gb_210:
    s_mov_b32 s57, 26624
    s_cmp_eq_u32 s55, 0
    s_waitcnt lgkmcnt(0)
    s_barrier
    ds_read2st64_b64 v[12:15], v2 offset0:0 offset1:4
    ds_read2st64_b64 v[16:19], v2 offset0:8 offset1:12
    ds_read2st64_b64 v[20:23], v2 offset0:16 offset1:20
    ds_read2st64_b64 v[24:27], v2 offset0:24 offset1:28
    s_waitcnt lgkmcnt(2)
    v_pk_add_f32 v[12:13], v[12:13], v[14:15]
    v_pk_add_f32 v[16:17], v[16:17], v[18:19]
    v_pk_add_f32 v[12:13], v[12:13], v[16:17]
    s_waitcnt lgkmcnt(0)
    v_pk_add_f32 v[20:21], v[20:21], v[22:23]
    v_pk_add_f32 v[24:25], v[24:25], v[26:27]
    v_pk_add_f32 v[12:13], v[12:13], v[20:21]
    v_pk_add_f32 v[12:13], v[12:13], v[24:25]
    v_cvt_pk_bf16_f32 v14, v12, v13
    v_min_u32 v14, -2, v14
    s_cbranch_scc1 L_gs_211
    buffer_store_dword v14, v3, s[40:43], s57 offen
L_gb_212:
    s_cbranch_scc1 L_gs_213
    buffer_store_dword v12, v4, s[40:43], s57 offen offset:32
L_gb_214:
    s_branch L_comb_1b
    s_nop 0
    s_nop 0
    s_nop 0
L_sr_224:
    buffer_load_dwordx4 v[52:55], v11, s[40:43], s65 offen offset:0 sc1
    buffer_load_dwordx4 v[56:59], v11, s[40:43], s65 offen offset:1024 sc1
    s_sub_u32 s56, s56, 1
    s_cbranch_scc1 L_done
    s_waitcnt vmcnt(0)
    s_branch L_sw_223
L_hr_225:
    buffer_load_dwordx4 v[12:15], v11, s[40:43], s58 offen offset:0 sc1
    buffer_load_dwordx4 v[16:19], v11, s[40:43], s58 offen offset:1024 sc1
    s_sub_u32 s56, s56, 1
    s_cbranch_scc1 L_done
    s_and_b32 s64, s56, 31
    s_cbranch_scc0 L_hx_227
    s_waitcnt vmcnt(2)
    v_pk_add_f32 v[20:21], v[12:13], v[16:17]
    v_pk_add_f32 v[22:23], v[14:15], v[18:19]
    s_nop 1
    v_permlane32_swap_b32 v20, v22
    v_permlane32_swap_b32 v21, v23
    v_pk_add_f32 v[20:21], v[20:21], v[22:23]
    s_nop 1
    v_permlane16_swap_b32 v20, v21
    v_add_f32 v20, v20, v21
    v_cmp_u_f32 vcc, v20, v20
    v_sub_f32 v20, v20, v26
    s_cbranch_vccnz L_hr_225
    s_branch L_hk_226
    s_nop 0
    s_nop 0
    s_nop 0
    s_nop 0
    s_nop 0
    s_nop 0
    s_nop 0
L_hx_227:
    s_waitcnt vmcnt(0)
    v_max3_u32 v20, v12, v13, v14
    v_max3_u32 v20, v20, v15, v16
    v_max3_u32 v20, v20, v17, v18
    v_max_u32 v20, v20, v19
    v_cmp_eq_u32 vcc, -1, v20
    s_cbranch_vccnz L_hr_225
    v_pk_add_f32 v[20:21], v[12:13], v[16:17]
    v_pk_add_f32 v[22:23], v[14:15], v[18:19]
    s_nop 1
    v_permlane32_swap_b32 v20, v22
    v_permlane32_swap_b32 v21, v23
    v_pk_add_f32 v[20:21], v[20:21], v[22:23]
    s_nop 1
    v_permlane16_swap_b32 v20, v21
    v_add_f32 v20, v20, v21
    v_sub_f32 v20, v20, v26
    s_branch L_hk_226
L_typeC_230:
    s_cmp_eq_u32 s30, 6
    s_cbranch_scc0 L_done
    s_cmp_eq_u32 s3, 20
    s_cbranch_scc0 L_done
    s_lshl_b32 s59, s31, 9
    s_add_u32 s59, s59, s8
    s_add_u32 s59, s59, 266240
L_pad24:
    s_cbranch_execz L_padback
    v_and_b32 v10, 1, v0
    v_lshlrev_b32 v10, 13, v10
    v_lshrrev_b32 v60, 1, v0
    v_lshl_add_u32 v10, v60, 24, v10
    s_add_u32 s58, s62, 28192
    v_lshrrev_b32 v9, 3, v0
    v_mul_u32_u24 v9, 1664, v9
    v_and_b32 v60, 7, v0
    v_lshl_add_u32 v9, v60, 2, v9
    buffer_load_dword v12, v9, s[40:43], s58 offen sc1
    s_sleep 2
L_pr_232:
    buffer_load_dword v12, v9, s[40:43], s58 offen sc1
    s_sub_u32 s56, s56, 1
    s_cbranch_scc1 L_done
L_pw_231:
    s_waitcnt vmcnt(1)
    v_cmp_eq_u32 vcc, -1, v12
    s_cbranch_vccnz L_pr_232
    buffer_store_dword v0, v10, s[40:43], s59 offen offset:8 sc1
    s_add_u32 s58, s62, 25984
    v_and_b32 v9, 15, v0
    v_lshlrev_b32 v9, 2, v9
    buffer_load_dword v13, v9, s[40:43], s58 offen sc1
    s_sleep 2
L_pr_234:
    buffer_load_dword v13, v9, s[40:43], s58 offen sc1
    s_sub_u32 s56, s56, 1
    s_cbranch_scc1 L_done
L_pw_233:
    s_waitcnt vmcnt(1)
    v_cmp_eq_u32 vcc, -1, v13
    s_cbranch_vccnz L_pr_234
    buffer_store_dword v0, v10, s[40:43], s59 offen offset:12 sc1
    s_waitcnt vmcnt(1)
    s_branch L_done
    s_nop 0
    s_nop 0
    s_nop 0
    s_nop 0
L_gs_238:
    buffer_store_dword v12, v11, s[40:43], s59 offen sc1
    s_branch L_gb_239
    s_nop 0
    s_nop 0
    s_nop 0
    s_nop 0
    s_nop 0
L_gr_241:
    s_cbranch_scc1 L_gw_240
    s_waitcnt vmcnt(0)
    v_max3_u32 v32, v12, v13, v14
    v_max3_u32 v32, v32, v15, v16
    v_max3_u32 v32, v32, v17, v18
    v_max3_u32 v32, v32, v19, v20
    v_max3_u32 v32, v32, v21, v22
    v_max3_u32 v32, v32, v23, v24
    v_max3_u32 v32, v32, v25, v26
    v_max_u32 v32, v32, v27
    v_cmp_eq_u32 vcc, -1, v32
    s_cbranch_vccnz L_gw_240
    v_pk_add_f32 v[28:29], v[12:13], v[36:37]
    v_pk_add_f32 v[30:31], v[14:15], v[38:39]
    v_pk_add_f32 v[28:29], v[28:29], v[16:17]
    v_pk_add_f32 v[30:31], v[30:31], v[18:19]
    v_pk_add_f32 v[28:29], v[28:29], v[20:21]
    v_pk_add_f32 v[30:31], v[30:31], v[22:23]
    v_pk_add_f32 v[28:29], v[28:29], v[24:25]
    v_pk_add_f32 v[30:31], v[30:31], v[26:27]
    s_nop 1
    v_permlane32_swap_b32 v28, v30
    v_permlane32_swap_b32 v29, v31
    s_branch L_gk_242
    s_nop 0
L_gs_245:
    buffer_store_dword v33, v34, s[40:43], s67 offen sc1
    s_branch L_gb_246
    s_nop 0
    s_nop 0
    s_nop 0
    s_nop 0
    s_nop 0
L_w7_235:
    v_and_b32 v60, 31, v0
    v_min_u32 v60, 19, v60
    s_mul_i32 s57, s54, 320
    v_lshrrev_b32 v5, 5, v0
    v_lshlrev_b32 v5, 12, v5
    v_add_u32 v5, s57, v5
    v_lshl_add_u32 v5, v60, 4, v5
    v_and_b32 v60, 31, v0
    v_cmp_gt_u32 s[64:65], 20, v60
    v_min_u32 v60, 19, v60
    v_lshrrev_b32 v35, 5, v0
    v_lshlrev_b32 v35, 2, v35
    v_add_u32 v35, 160832, v35
    v_lshl_add_u32 v35, v60, 3, v35
    s_add_u32 s66, s62, 39936
    s_add_u32 s67, s62, 25984
    s_lshl_b32 s57, s54, 3
L_pad25:
    s_cbranch_execz L_padback
    v_lshrrev_b32 v34, 5, v0
    v_lshlrev_b32 v34, 2, v34
    v_add_u32 v34, s57, v34
    v_and_b32 v60, 31, v0
    v_mov_b32 v61, 0x7f000000
    v_cmp_ne_u32 vcc, 31, v60
    s_nop 1
    v_cndmask_b32 v34, v34, v61, vcc
    v_mov_b32 v61, 0x3f803f80
    s_add_u32 s57, s7, 132096
    s_add_u32 s58, s7, 148480
    s_add_u32 s59, s7, 164864
    s_add_u32 s60, s7, 181248
    v_mov_b64 v[36:37], 0
    v_mov_b64 v[38:39], 0
    s_nop 0
    v_mov_b32_dpp v36, v2 quad_perm:[0,1,2,3] row_mask:0x3 bank_mask:0xf
    v_mov_b32_dpp v37, v3 quad_perm:[0,1,2,3] row_mask:0x3 bank_mask:0xf
    v_mov_b32_dpp v38, v2 quad_perm:[0,1,2,3] row_mask:0xc bank_mask:0xf
    v_mov_b32_dpp v39, v3 quad_perm:[0,1,2,3] row_mask:0xc bank_mask:0xf
    s_add_u32 s75, s7, 266248
    v_and_b32 v9, 7, v0
    v_lshlrev_b32 v9, 9, v9
    buffer_load_dword v12, v9, s[40:43], s75 offen sc1
    s_sleep 2
L_pr_244:
    buffer_load_dword v12, v9, s[40:43], s75 offen sc1
    s_sub_u32 s56, s56, 1
    s_cbranch_scc1 L_done
L_pw_243:
    s_waitcnt vmcnt(1)
    v_cmp_eq_u32 vcc, -1, v12
    s_cbranch_vccnz L_pr_244
    s_sleep 2
    buffer_load_dwordx4 v[12:15], v5, s[40:43], s57 offen sc1
    buffer_load_dwordx4 v[16:19], v5, s[40:43], s58 offen sc1
    buffer_load_dwordx4 v[20:23], v5, s[40:43], s59 offen sc1
    buffer_load_dwordx4 v[24:27], v5, s[40:43], s60 offen sc1
    s_sleep 2
L_gw_240:
    buffer_load_dwordx4 v[12:15], v5, s[40:43], s57 offen sc1
    buffer_load_dwordx4 v[16:19], v5, s[40:43], s58 offen sc1
    buffer_load_dwordx4 v[20:23], v5, s[40:43], s59 offen sc1
    buffer_load_dwordx4 v[24:27], v5, s[40:43], s60 offen sc1
    s_sub_u32 s56, s56, 1
    s_cbranch_scc1 L_done
    s_and_b32 s74, s56, 31
    s_waitcnt vmcnt(7)
    v_pk_add_f32 v[28:29], v[12:13], v[36:37]
    v_pk_add_f32 v[30:31], v[14:15], v[38:39]
    s_waitcnt vmcnt(6)
    v_pk_add_f32 v[28:29], v[28:29], v[16:17]
    v_pk_add_f32 v[30:31], v[30:31], v[18:19]
    s_waitcnt vmcnt(5)
    v_pk_add_f32 v[28:29], v[28:29], v[20:21]
    v_pk_add_f32 v[30:31], v[30:31], v[22:23]
    s_waitcnt vmcnt(4)
    v_pk_add_f32 v[28:29], v[28:29], v[24:25]
    v_pk_add_f32 v[30:31], v[30:31], v[26:27]
    v_pk_add_f32 v[32:33], v[28:29], v[30:31]
    v_cmp_u_f32 vcc, v32, v33
    v_permlane32_swap_b32 v28, v30
    v_permlane32_swap_b32 v29, v31
    s_cbranch_vccnz L_gr_241
L_gk_242:
    v_pk_add_f32 v[28:29], v[28:29], v[30:31]
    v_cvt_pk_bf16_f32 v28, v28, v29
    ds_write_b32 v35, v28
    s_waitcnt lgkmcnt(0)
    s_barrier
    v_cndmask_b32 v29, 0, v28, s[64:65]
    v_dot2_f32_bf16 v33, v29, v61, 0
    v_dot2_f32_bf16 v32, v29, v29, 0
    v_lshlrev_b32 v2, 16, v28
    v_and_b32 v3, 0xffff0000, v28
    s_cmp_eq_u32 s55, 0
    v_permlane32_swap_b32 v33, v32
    v_add_f32 v33, v33, v32
    s_nop 1
    v_add_f32_dpp v33, v33, v33 row_ror:8 row_mask:0xf bank_mask:0xf
    s_nop 1
    v_add_f32_dpp v33, v33, v33 row_ror:4 row_mask:0xf bank_mask:0xf
    s_nop 1
    v_add_f32_dpp v33, v33, v33 row_ror:2 row_mask:0xf bank_mask:0xf
    s_nop 1
    v_add_f32_dpp v33, v33, v33 row_ror:1 row_mask:0xf bank_mask:0xf
    s_nop 1
    v_add_f32_dpp v33, v33, v33 row_bcast:15 row_mask:0xa bank_mask:0xf
    s_cbranch_scc1 L_gs_245
L_pad26:
    s_cbranch_execz L_padback
    buffer_store_dword v33, v34, s[40:43], s67 offen
L_gb_246:
    s_waitcnt vmcnt(1)
    s_branch L_se_236
    s_nop 0
    s_nop 0
    s_nop 0
L_gr_248:
    s_cbranch_scc1 L_gw_247
    s_waitcnt vmcnt(0)
    v_max3_u32 v32, v12, v13, v14
    v_max3_u32 v32, v32, v15, v16
    v_max3_u32 v32, v32, v17, v18
    v_max3_u32 v32, v32, v19, v20
    v_max3_u32 v32, v32, v21, v22
    v_max3_u32 v32, v32, v23, v24
    v_max3_u32 v32, v32, v25, v26
    v_max_u32 v32, v32, v27
    v_cmp_eq_u32 vcc, -1, v32
    s_cbranch_vccnz L_gw_247
    v_pk_add_f32 v[28:29], v[12:13], v[36:37]
    v_pk_add_f32 v[30:31], v[14:15], v[38:39]
    v_pk_add_f32 v[28:29], v[28:29], v[16:17]
    v_pk_add_f32 v[30:31], v[30:31], v[18:19]
    v_pk_add_f32 v[28:29], v[28:29], v[20:21]
    v_pk_add_f32 v[30:31], v[30:31], v[22:23]
    v_pk_add_f32 v[28:29], v[28:29], v[24:25]
    v_pk_add_f32 v[30:31], v[30:31], v[26:27]
    s_nop 1
    v_permlane32_swap_b32 v28, v30
    v_permlane32_swap_b32 v29, v31
    s_branch L_gk_249
L_tail_end:
    s_nop 0
L_spread:
    s_add_u32 s62, s62, 966656
    s_cmp_eq_u32 s30, 5
    s_cbranch_scc0 L_skip_83
    v_mov_b64 v[12:13], -1
    v_mov_b64 v[14:15], -1
    v_lshlrev_b32 v16, 4, v0
    s_mul_i32 s57, s52, 2208
    s_add_u32 s57, s57, s62
    s_mov_b64 exec, 0x3ff
    buffer_store_dwordx4 v[12:15], v16, s[40:43], s57 offen offset:2048 sc1
    s_mov_b64 exec, -1
    buffer_store_dwordx4 v[12:15], v16, s[40:43], s57 offen offset:0 sc1
    buffer_store_dwordx4 v[12:15], v16, s[40:43], s57 offen offset:1024 sc1
L_skip_83:
    s_cmp_eq_u32 s30, 7
    s_cbranch_scc0 L_skip_84
    v_and_b32 v60, 31, v0
    v_cmp_gt_u32 s[64:65], 20, v60
    v_min_u32 v60, 19, v60
    v_lshrrev_b32 v35, 5, v0
    v_lshlrev_b32 v35, 2, v35
    v_add_u32 v35, 160832, v35
    v_lshl_add_u32 v35, v60, 3, v35
    s_mul_i32 s66, s53, 12416
    s_add_u32 s66, s66, s62
    s_add_u32 s66, s66, 70656
    s_add_u32 s67, s66, 12288
    s_lshl_b32 s57, s54, 3
    v_lshrrev_b32 v34, 5, v0
    v_lshlrev_b32 v34, 2, v34
    v_add_u32 v34, s57, v34
    v_and_b32 v60, 31, v0
    v_mov_b32 v61, 0x7f000000
    v_cmp_ne_u32 vcc, 31, v60
    s_nop 1
    v_cndmask_b32 v34, v34, v61, vcc
    v_mov_b32 v61, 0x3f803f80
    v_cvt_pk_bf16_f32 v28, v2, v3
L_skip_84:
    s_cmp_eq_u32 s30, 7
    s_cbranch_scc0 L_skip_85
    v_cndmask_b32 v29, 0, v28, s[64:65]
    v_dot2_f32_bf16 v33, v29, v61, 0
    v_dot2_f32_bf16 v32, v29, v29, 0
    v_lshlrev_b32 v2, 16, v28
    v_and_b32 v3, 0xffff0000, v28
    s_cmp_eq_u32 s55, 0
    v_permlane32_swap_b32 v33, v32
    v_add_f32 v33, v33, v32
    s_nop 1
    v_add_f32_dpp v33, v33, v33 row_ror:8 row_mask:0xf bank_mask:0xf
    s_nop 1
    v_add_f32_dpp v33, v33, v33 row_ror:4 row_mask:0xf bank_mask:0xf
    s_nop 1
    v_add_f32_dpp v33, v33, v33 row_ror:2 row_mask:0xf bank_mask:0xf
    s_nop 1
    v_add_f32_dpp v33, v33, v33 row_ror:1 row_mask:0xf bank_mask:0xf
    s_nop 1
    v_add_f32_dpp v33, v33, v33 row_bcast:15 row_mask:0xa bank_mask:0xf
    s_cbranch_scc1 L_gs_86
    buffer_store_dword v33, v34, s[40:43], s67 offen
L_gb_87:
    s_waitcnt vmcnt(1)
L_skip_85:
    s_cmp_lt_u32 s30, 6
    s_cbranch_scc0 L_skip_88
    s_lshr_b32 s57, s30, 1
    s_mul_i32 s57, s57, 1024
    s_and_b32 s58, s30, 1
    s_lshl_b32 s58, s58, 6
    s_add_u32 s57, s57, s58
    v_lshrrev_b32 v18, 5, v0
    v_mul_u32_u24 v18, 6144, v18
    v_bfe_u32 v60, v0, 3, 1
    v_mul_u32_u24 v60, 3072, v60
    v_add_u32 v18, v60, v18
    v_bfe_u32 v60, v0, 4, 1
    v_lshl_add_u32 v18, v60, 9, v18
    v_bfe_u32 v60, v0, 2, 1
    v_lshl_add_u32 v18, v60, 7, v18
    v_and_b32 v60, 3, v0
    v_lshl_add_u32 v18, v60, 3, v18
    v_add_u32 v18, s57, v18
    v_bfe_u32 v19, v0, 4, 1
    v_mul_u32_u24 v19, 3072, v19
    v_bfe_u32 v60, v0, 3, 1
    v_lshl_add_u32 v19, v60, 9, v19
    v_bfe_u32 v60, v0, 2, 1
    v_lshl_add_u32 v19, v60, 7, v19
    v_and_b32 v60, 3, v0
    v_lshl_add_u32 v19, v60, 3, v19
    v_add_u32 v19, s57, v19
    v_add_u32 v19, 24576, v19
    ds_read_b64_tr_b16 v[28:29], v18 offset:0
    ds_read_b64_tr_b16 v[30:31], v18 offset:256
    ds_read_b64_tr_b16 v[32:33], v18 offset:12288
    ds_read_b64_tr_b16 v[34:35], v18 offset:12544
    ds_read_b64_tr_b16 v[36:37], v19 offset:0
    ds_read_b64_tr_b16 v[38:39], v19 offset:256
    ds_read_b64_tr_b16 v[40:41], v18 offset:32
    ds_read_b64_tr_b16 v[42:43], v18 offset:288
    ds_read_b64_tr_b16 v[44:45], v18 offset:12320
    ds_read_b64_tr_b16 v[46:47], v18 offset:12576
    ds_read_b64_tr_b16 v[48:49], v19 offset:32
    ds_read_b64_tr_b16 v[50:51], v19 offset:288
    v_lshrrev_b32 v52, 4, v0
    v_lshlrev_b32 v52, 5, v52
    v_bfe_u32 v60, v0, 1, 1
    v_lshl_add_u32 v52, v60, 4, v52
    v_and_b32 v60, 1, v0
    v_mul_u32_u24 v60, 192, v60
    v_add_u32 v52, v60, v52
    v_add_u32 v52, 160832, v52
    v_lshrrev_b32 v53, 4, v0
    v_lshlrev_b32 v53, 4, v53
    v_bfe_u32 v60, v0, 1, 1
    v_lshl_add_u32 v53, v60, 3, v53
    v_and_b32 v60, 1, v0
    v_mul_u32_u24 v60, 192, v60
    v_add_u32 v53, v60, v53
    v_add_u32 v53, 160960, v53
    v_mov_b64 v[20:21], 0
    v_mov_b64 v[22:23], 0
    v_mov_b64 v[24:25], 0
    v_mov_b64 v[26:27], 0
    s_lshr_b32 s57, s30, 1
    s_lshl_b32 s57, s57, 11
    s_lshl_b32 s58, s58, 1
    s_add_u32 s57, s57, s58
    s_lshl_b32 s58, s54, 8
    s_add_u32 s57, s57, s58
    v_and_b32 v54, 31, v0
    v_lshlrev_b32 v54, 2, v54
    v_lshrrev_b32 v60, 5, v0
    v_mul_u32_u24 v60, 6144, v60
    v_add_u32 v54, v60, v54
    v_add_u32 v54, s57, v54
    s_mul_i32 s59, s53, 12416
    s_add_u32 s59, s59, s62
    s_add_u32 s59, s59, 70656
    s_add_u32 s60, s59, 12288
    ds_read_b128 v[12:15], v52
    ds_read_b64 v[16:17], v53
    s_waitcnt lgkmcnt(1)
    v_smfmac_f32_16x16x64_bf16 v[20:23], v[12:15], v[28:35], v1
    v_smfmac_f32_16x16x64_bf16 v[24:27], v[12:15], v[40:47], v1
    s_waitcnt lgkmcnt(0)
    v_smfmac_f32_16x16x32_bf16 v[20:23], v[16:17], v[36:39], v1
    v_smfmac_f32_16x16x32_bf16 v[24:27], v[16:17], v[48:51], v1
    s_cmp_eq_u32 s55, 0
    s_nop 5
    v_add_f32 v12, v20, v22
    s_nop 1
    v_add_f32_dpp v12, v24, v26 quad_perm:[0,1,2,3] row_mask:0x2 bank_mask:0xf
    s_nop 1
    v_add_f32_dpp v12, v21, v23 quad_perm:[0,1,2,3] row_mask:0x4 bank_mask:0xf
    s_nop 1
    v_add_f32_dpp v12, v25, v27 quad_perm:[0,1,2,3] row_mask:0x8 bank_mask:0xf
    s_cbranch_scc1 L_gs_89
    buffer_store_dword v12, v54, s[40:43], s59 offen
L_gb_90:
L_skip_88:
    s_waitcnt vmcnt(0)
    s_barrier
    s_cmp_eq_u32 s30, 5
    s_cbranch_scc0 L_skip_91
    v_mov_b32 v25, 0
    s_lshl_b32 s57, s52, 2
    s_add_u32 s57, s57, s72
    s_mov_b64 exec, 1
    buffer_store_dword v25, v0, s[40:43], s57 offen offset:256 sc1
    s_mov_b64 exec, -1
    v_and_b32 v16, 31, v0
    v_lshlrev_b32 v16, 2, v16
L_pr_93:
    buffer_load_dword v17, v16, s[40:43], s72 offen offset:256 sc1
    s_sub_u32 s56, s56, 1
    s_cbranch_scc1 L_done
L_pw_92:
    s_waitcnt vmcnt(0)
    v_cmp_eq_u32 vcc, -1, v17
    s_cbranch_vccnz L_pr_93
L_skip_91:
    s_barrier
    s_branch L_spread_back
    s_nop 0
    s_nop 0
L_done:
L_exit:
    s_endpgm
.section .rodata,"a"
.p2align 6
.amdhsa_kernel interleave_layers__sliding_block_cached__dense_activation_gelu__decode_kernel
  .amdhsa_next_free_vgpr 256
  .amdhsa_next_free_sgpr 102
  .amdhsa_accum_offset 256
  .amdhsa_group_segment_fixed_size 0
  .amdhsa_kernarg_size 104
  .amdhsa_user_sgpr_count 2
  .amdhsa_user_sgpr_kernarg_segment_ptr 1
  .amdhsa_system_sgpr_workgroup_id_x 1
  .amdhsa_float_denorm_mode_32 3
.end_amdhsa_kernel
```

```asm
; @launch grid=(256,1,1) block=(512,1,1) lds=161216
.amdgcn_target "amdgcn-amd-amdhsa--gfx950"
.text
.fill 64, 4, 0xbf800000
.globl interleave_layers__sliding_block_cached__dense_activation_gelu__decode_kernel
.p2align 8
.type interleave_layers__sliding_block_cached__dense_activation_gelu__decode_kernel,@function
interleave_layers__sliding_block_cached__dense_activation_gelu__decode_kernel:
    s_load_dwordx16 s[4:19], s[0:1], 0
    s_cmp_ge_u32 s2, 256
    s_cbranch_scc1 L_exit
    v_lshrrev_b32 v5, 6, v0
    v_lshlrev_b32 v62, 6, v0
    v_readfirstlane_b32 s30, v5
    v_and_b32 v0, 63, v0
    s_getpc_b64 s[74:75]
L_pc:
    v_min_u32 v62, L_exit-L_pc, v62
    global_load_dword v63, v62, s[74:75]
    s_cmp_eq_u32 s30, 6
    s_cbranch_scc0 L_skip_1
    s_setprio 3
L_skip_1:
    s_and_b32 s31, s2, 7
    s_lshr_b32 s52, s2, 3
    s_and_b32 s53, s52, 3
    s_lshr_b32 s54, s52, 2
    s_lshl_b32 s73, s31, 2
    s_add_u32 s73, s73, s53
    v_lshrrev_b32 v8, 5, v0
    v_lshlrev_b32 v8, 2, v8
    v_bfe_u32 v60, v0, 4, 1
    v_lshl_add_u32 v8, v60, 0, v8
    v_and_b32 v9, 7, v0
    v_xor_b32 v8, v8, v9
    v_lshrrev_b32 v10, 3, v0
    v_mul_u32_u24 v10, 384, v10
    v_lshl_add_u32 v5, v8, 4, v10
    v_xor_b32 v6, 32, v5
    s_mul_i32 s64, s73, 12582912
    s_mul_i32 s58, s54, 3072
    s_add_u32 s64, s64, s58
    s_add_u32 s64, s64, 11010048
    s_sub_u32 s34, 1572864, s58
    s_mov_b32 s35, 0x20000
    s_mov_b32 s57, 0
    s_mov_b32 s58, 195584
    s_mov_b32 m0, 92160
    s_cmp_eq_u32 s30, 6
    s_cselect_b64 vcc, -1, 0
    s_waitcnt lgkmcnt(0)
    s_add_u32 s32, s6, s64
    s_addc_u32 s33, s7, 0
    s_load_dwordx8 s[20:27], s[0:1], 64
    s_load_dwordx2 s[28:29], s[0:1], 96
    s_cbranch_vccz L_skip_3
L_dma_2:
    buffer_load_dwordx4 v5, s[32:35], s57 offen offset:0 nt lds
    buffer_load_dwordx4 v6, s[32:35], s58 offen offset:1024 nt lds
    s_add_u32 s57, s57, 24576
    s_add_u32 s58, s58, 24576
    s_add_u32 m0, m0, 2048
    s_cmp_lg_u32 m0, 108544
    s_cbranch_scc1 L_dma_2
    s_mov_b32 s57, 128
    s_mov_b32 s58, 195712
    s_mov_b32 m0, 108544
L_dma_4:
    s_nop 0
    buffer_load_dwordx4 v5, s[32:35], s57 offen offset:0 nt lds
    buffer_load_dwordx4 v6, s[32:35], s58 offen offset:1024 nt lds
    s_add_u32 s57, s57, 24576
    s_add_u32 s58, s58, 24576
    s_add_u32 m0, m0, 2048
    s_cmp_lg_u32 m0, 116736
    s_cbranch_scc1 L_dma_4
L_skip_3:
    s_mul_i32 s3, s54, 3
    s_add_u32 s3, s3, s53
    s_cmp_eq_u32 s53, 3
    s_cselect_b32 s3, 31, s3
    v_lshrrev_b32 v8, 4, v0
    v_lshlrev_b32 v8, 1, v8
    v_xor_b32 v8, v8, v9
    v_lshl_add_u32 v7, v8, 4, v10
    v_lshrrev_b32 v2, 3, v0
    v_mul_u32_u24 v2, 12288, v2
    v_and_b32 v60, 7, v0
    v_lshl_add_u32 v2, v60, 4, v2
    s_mul_i32 s59, s73, 384
    s_mul_i32 s60, s54, 983040
    s_add_u32 s59, s59, s60
    s_sub_u32 s60, 7866368, s59
    s_lshl_b32 s61, s30, 11
    s_add_u32 s61, s61, 92160
    s_mul_i32 s62, s31, 120832
    s_add_u32 s62, s62, 299008
    s_lshl_b32 s72, s31, 9
    s_add_u32 s72, s72, 294912
    s_mov_b32 s56, 65536
    s_mov_b32 s55, 1
    s_getreg_b32 s63, hwreg(20, 0, 3)
    v_mov_b32 v3, 0
    v_mov_b32 v4, 0
    v_mov_b32 v11, 0
    v_mov_b32 v24, 0
    v_mov_b32 v34, 0
    v_mov_b64 v[12:13], -1
    v_mov_b64 v[14:15], -1
    v_lshlrev_b32 v10, 4, v0
    s_waitcnt lgkmcnt(0)
    s_add_u32 s36, s8, s64
    s_addc_u32 s37, s9, 0
    s_mov_b32 s38, s34
    s_mov_b32 s39, 0x20000
    s_mov_b32 s40, s28
    s_mov_b32 s41, s29
    s_mov_b32 s42, 2232320
    s_mov_b32 s43, 0x20000
    s_add_u32 s44, s10, s59
    s_addc_u32 s45, s11, 0
    s_mov_b32 s46, s60
    s_mov_b32 s47, 0x20000
    s_sub_u32 s44, s44, 2048
    s_subb_u32 s45, s45, 0
    s_cmp_eq_u32 s30, 6
    s_cbranch_scc0 L_skip_5
    s_mov_b32 s57, 98432
    s_mov_b32 s58, 294016
    s_mov_b32 m0, 116736
L_dma_6:
    s_waitcnt vmcnt(22)
    buffer_load_dwordx4 v5, s[32:35], s57 offen offset:0 nt lds
    buffer_load_dwordx4 v6, s[32:35], s58 offen offset:1024 nt lds
    s_add_u32 s57, s57, 24576
    s_add_u32 s58, s58, 24576
    s_add_u32 m0, m0, 2048
    s_cmp_lg_u32 m0, 124928
    s_cbranch_scc1 L_dma_6
    s_mov_b32 s57, 2048
    s_mov_b32 s58, 1152
    s_mov_b32 s59, 256
    s_mov_b32 m0, 0
L_dma_7:
    s_waitcnt vmcnt(22)
    buffer_load_dwordx4 v2, s[44:47], s57 offen offset:0 nt lds
    buffer_load_dwordx4 v2, s[44:47], s58 offen offset:1024 nt lds
    buffer_load_dwordx4 v2, s[44:47], s59 offen offset:2048 nt lds
    s_add_u32 s57, s57, 98304
    s_add_u32 s58, s58, 98304
    s_add_u32 s59, s59, 98304
    s_add_u32 m0, m0, 3072
    s_cmp_lg_u32 m0, 15360
    s_cbranch_scc1 L_dma_7
L_skip_5:
    s_cmp_lt_u32 s3, 20
    s_cselect_b32 s57, 7864320, 0
    s_add_u32 s58, s54, 1
    s_mul_i32 s58, s58, 245760
    s_cmp_lg_u32 s53, 3
    s_cselect_b64 s[48:49], s[12:13], s[16:17]
    s_cselect_b32 s50, s57, s58
    s_mov_b32 s51, 0x20000
    s_add_u32 s57, s28, 0
    s_sub_u32 s57, 0, s57
    s_and_b32 s57, s57, 0x3fff
    s_add_u32 s57, s57, 0
    s_lshr_b32 s58, s31, 1
    s_lshl_b32 s58, s58, 14
    s_add_u32 s6, s57, s58
    s_and_b32 s58, s31, 1
    s_lshl_b32 s58, s58, 12
    s_add_u32 s6, s6, s58
    s_lshl_b32 s58, s3, 7
    s_add_u32 s6, s6, s58
    s_mov_b32 s8, s57
    s_and_b32 s59, s3, 3
    s_lshl_b32 s58, s31, 2
    s_add_u32 s59, s59, s58
    s_lshl_b32 s59, s59, 7
    s_add_u32 s59, s59, s57
    s_add_u32 s59, s59, 262144
    s_add_u32 s10, s28, s59
    s_addc_u32 s11, s29, 0
    s_lshr_b32 s58, s63, 2
    s_xor_b32 s58, s58, 0
    s_mul_i32 s58, s58, 8192
    s_add_u32 s7, s57, s58
    s_cmp_eq_u32 s30, 5
    s_cbranch_scc0 L_skip_8
    s_cmp_eq_u32 s52, 31
    s_cbranch_scc0 L_skip_9
    s_mov_b64 exec, 0xffffff
    buffer_store_dwordx4 v[12:15], v10, s[40:43], s72 offen sc1
    s_mov_b64 exec, -1
L_skip_9:
    s_cmp_lt_u32 s3, 20
    s_cbranch_scc0 L_skip_10
    v_and_b32 v16, 7, v0
    v_lshlrev_b32 v16, 4, v16
    v_bfe_u32 v17, v0, 3, 1
    v_lshl_add_u32 v16, v17, 13, v16
    v_lshrrev_b32 v17, 4, v0
    v_mul_u32_u24 v17, 66048, v17
    v_add_u32 v16, v17, v16
    s_add_u32 s57, s6, 0
    buffer_store_dwordx4 v[12:15], v16, s[40:43], s57 offen sc1
L_skip_10:
    s_cmp_eq_u32 s3, 20
    s_cbranch_scc0 L_skip_11
    s_lshl_b32 s58, s31, 9
    s_add_u32 s58, s58, s8
    s_add_u32 s58, s58, 266240
    v_and_b32 v16, 7, v0
    v_lshlrev_b32 v16, 4, v16
    v_bfe_u32 v60, v0, 3, 1
    v_lshl_add_u32 v16, v60, 13, v16
    v_lshrrev_b32 v60, 4, v0
    v_lshl_add_u32 v16, v60, 28, v16
    buffer_store_dwordx4 v[12:15], v16, s[40:43], s58 offen sc1
L_skip_11:
    s_sub_u32 s58, s3, 20
    s_cmp_lt_u32 s58, 4
    s_cselect_b32 s59, s59, 0x7f000000
    v_and_b32 v16, 7, v0
    v_lshlrev_b32 v16, 4, v16
    v_bfe_u32 v60, v0, 3, 1
    v_lshl_add_u32 v16, v60, 13, v16
    v_lshrrev_b32 v60, 4, v0
    v_lshl_add_u32 v16, v60, 28, v16
    buffer_store_dwordx4 v[12:15], v16, s[40:43], s59 offen sc1
    s_mul_i32 s57, s52, 2208
    s_add_u32 s57, s57, s62
    s_mov_b64 exec, 0x3ff
    buffer_store_dwordx4 v[12:15], v10, s[40:43], s57 offen offset:2048
    s_mov_b64 exec, -1
    buffer_store_dwordx4 v[12:15], v10, s[40:43], s57 offen offset:0
    buffer_store_dwordx4 v[12:15], v10, s[40:43], s57 offen offset:1024
    s_mov_b64 exec, -1
    v_lshlrev_b32 v16, 4, v0
    v_add_u32 v16, 159744, v16
    ds_write_b128 v16, v[12:15]
    v_subrev_u32 v16, 8, v0
    v_cmp_gt_u32 vcc, 40, v16
    v_mov_b32 v16, 0x3f803f80
    s_nop 0
    v_cndmask_b32 v18, 0, v16, vcc
    v_min_u32 v16, 55, v0
    v_lshlrev_b32 v16, 2, v16
    v_add_u32 v16, 160992, v16
    ds_write_b32 v16, v18
    v_and_b32 v3, 7, v0
    v_lshlrev_b32 v3, 5, v3
L_skip_8:
    s_cmp_eq_u32 s30, 7
    s_cbranch_scc0 L_skip_12
    v_and_b32 v60, 31, v0
    v_min_u32 v60, 19, v60
    s_mul_i32 s57, s54, 160
    v_lshrrev_b32 v16, 5, v0
    v_lshlrev_b32 v16, 2, v16
    v_add_u32 v16, s57, v16
    v_lshl_add_u32 v16, v60, 3, v16
    global_load_dword v28, v16, s[4:5]
    global_load_dword v4, v16, s[22:23]
L_skip_12:
    s_sub_u32 s58, s30, 4
    s_cmp_lt_u32 s58, 3
    s_cbranch_scc0 L_skip_13
    s_mul_i32 s57, s31, 3
    s_add_u32 s57, s57, s58
    s_lshl_b32 s57, s57, 7
    v_and_b32 v16, 15, v0
    v_lshlrev_b32 v16, 3, v16
    v_lshrrev_b32 v60, 4, v0
    v_lshl_add_u32 v16, v60, 1, v16
    v_add_u32 v16, s57, v16
    global_load_short_d16_hi v4, v16, s[18:19]
L_skip_13:
    v_bfe_u32 v8, v0, 1, 3
    v_lshrrev_b32 v9, 4, v0
    v_xor_b32 v9, v8, v9
    v_bfe_u32 v8, v0, 2, 1
    v_lshlrev_b32 v8, 10, v8
    v_bfe_u32 v60, v0, 3, 1
    v_lshl_add_u32 v8, v60, 9, v8
    v_and_b32 v60, 3, v0
    v_lshl_add_u32 v8, v60, 7, v8
    v_add_u32 v8, s61, v8
    v_lshl_add_u32 v8, v9, 4, v8
    v_xor_b32 v9, 64, v8
    v_bfe_u32 v1, v0, 1, 1
    v_mul_u32_u24 v1, 43690, v1
    v_add_u32 v1, 17476, v1
    s_waitcnt vmcnt(31)
    s_barrier
    ds_read_b128 v[64:67], v8 offset:0
    ds_read_b128 v[68:71], v9 offset:0
    s_cmp_eq_u32 s30, 6
    s_cbranch_scc0 L_skip_14
    s_mov_b32 s57, 256
    s_mov_b32 s58, 195840
    s_mov_b32 m0, 124928
L_dma_15:
    s_waitcnt vmcnt(22)
    buffer_load_dwordx4 v5, s[32:35], s57 offen offset:0 nt lds
    buffer_load_dwordx4 v6, s[32:35], s58 offen offset:1024 nt lds
    s_add_u32 s57, s57, 24576
    s_add_u32 s58, s58, 24576
    s_add_u32 m0, m0, 2048
    s_cmp_lg_u32 m0, 141312
    s_cbranch_scc1 L_dma_15
L_skip_14:
    s_waitcnt lgkmcnt(0)
    s_cmp_eq_u32 s30, 5
    s_cbranch_scc0 L_skip_16
    s_cmp_eq_u32 s52, 31
    s_cbranch_scc0 L_skip_17
    s_lshl_b32 s57, s31, 5
    v_mov_b32 v16, s57
    s_add_u32 s57, s63, 1
    v_mov_b32 v12, s57
    s_waitcnt vmcnt(5)
    s_mov_b64 exec, 0x1
    global_store_dword v16, v12, s[26:27] sc1
    s_mov_b64 exec, -1
L_skip_17:
L_skip_16:
    s_waitcnt vmcnt(31)
    s_barrier
    ds_read_b128 v[72:75], v8 offset:16384
    ds_read_b128 v[76:79], v9 offset:16384
    s_cmp_eq_u32 s30, 6
    s_cbranch_scc0 L_skip_18
    s_mov_b32 s57, 493568
    s_mov_b32 s58, 492672
    s_mov_b32 s59, 491776
    s_mov_b32 m0, 15360
L_dma_19:
    s_waitcnt vmcnt(22)
    buffer_load_dwordx4 v2, s[44:47], s57 offen offset:0 nt lds
    buffer_load_dwordx4 v2, s[44:47], s58 offen offset:1024 nt lds
    buffer_load_dwordx4 v2, s[44:47], s59 offen offset:2048 nt lds
    s_add_u32 s57, s57, 98304
    s_add_u32 s58, s58, 98304
    s_add_u32 s59, s59, 98304
    s_add_u32 m0, m0, 3072
    s_cmp_lg_u32 m0, 30720
    s_cbranch_scc1 L_dma_19
    s_mov_b32 s57, 393216
    s_mov_b32 s58, 588800
    s_mov_b32 m0, 141312
L_dma_20:
    s_waitcnt vmcnt(22)
    buffer_load_dwordx4 v5, s[32:35], s57 offen offset:0 nt lds
    buffer_load_dwordx4 v6, s[32:35], s58 offen offset:1024 nt lds
    s_add_u32 s57, s57, 24576
    s_add_u32 s58, s58, 24576
    s_add_u32 m0, m0, 2048
    s_cmp_lg_u32 m0, 157696
    s_cbranch_scc1 L_dma_20
L_skip_18:
    s_waitcnt lgkmcnt(0)
    s_cmp_lt_u32 s30, 4
    s_cbranch_scc0 L_skip_21
    s_mov_b64 exec, 0
    s_cmp_eq_u32 s30, 1
    s_cbranch_scc1 L_pad1
    s_cmp_eq_u32 s30, 2
    s_cbranch_scc1 L_pad2
    s_cmp_eq_u32 s30, 3
    s_cbranch_scc1 L_pad3
    s_branch L_pad0
    s_nop 0
    s_nop 0
L_padback:
    s_mov_b64 exec, -1
L_skip_21:
    s_waitcnt vmcnt(31)
    s_barrier
    ds_read_b128 v[80:83], v8 offset:32768
    ds_read_b128 v[84:87], v9 offset:32768
    s_cmp_eq_u32 s30, 6
    s_cbranch_scc0 L_skip_22
    s_cmp_lg_u32 s53, 3
    s_cbranch_scc0 L_wb_23
    s_mul_i32 s57, s31, 983040
    s_lshl_b32 s58, s3, 6
    s_add_u32 s57, s57, s58
    v_bfe_u32 v38, v0, 4, 1
    v_lshlrev_b32 v38, 1, v38
    v_xor_b32 v38, v38, v0
    v_and_b32 v38, 3, v38
    v_lshrrev_b32 v3, 5, v0
    v_mul_u32_u24 v3, 10240, v3
    v_bfe_u32 v39, v0, 4, 1
    v_mul_u32_u24 v39, 2560, v39
    v_add_u32 v3, v39, v3
    v_bfe_u32 v39, v0, 3, 1
    v_mul_u32_u24 v39, 5120, v39
    v_add_u32 v3, v39, v3
    v_bfe_u32 v39, v0, 2, 1
    v_mul_u32_u24 v39, 20480, v39
    v_add_u32 v3, v39, v3
    v_add_u32 v3, s57, v3
    v_lshl_add_u32 v3, v38, 4, v3
    s_mov_b32 s14, 40960
    s_mov_b32 s15, 256
    s_branch L_we_24
    s_nop 0
    s_nop 0
L_wb_23:
    s_mul_i32 s57, s31, 384
    s_mul_i32 s58, s54, 245760
    s_add_u32 s57, s57, s58
    v_lshlrev_b32 v3, 4, v0
    v_add_u32 v3, s57, v3
    v_mov_b32 v38, 2688
    v_cmp_lt_u32 vcc, 23, v0
    s_nop 1
    v_cndmask_b32 v38, 0, v38, vcc
    v_add_u32 v3, v38, v3
    v_mov_b32 v38, 0x7f000000
    v_cmp_lt_u32 vcc, 47, v0
    s_nop 1
    v_cndmask_b32 v3, v3, v38, vcc
    s_mov_b32 s14, 12288
    s_mov_b32 s15, 5120
L_we_24:
    s_mul_i32 s57, s14, 0
    s_mov_b32 m0, 30720
    s_nop 0
    buffer_load_dwordx4 v3, s[48:51], s57 offen offset:0 nt lds
    s_mul_i32 s57, s14, 0
    s_add_u32 s57, s57, s15
    s_mov_b32 m0, 30720
    s_nop 0
    buffer_load_dwordx4 v3, s[48:51], s57 offen offset:1024 nt lds
    s_mov_b32 s57, 393344
    s_mov_b32 s58, 588928
    s_mov_b32 m0, 92160
L_dma_25:
    s_waitcnt vmcnt(22)
    buffer_load_dwordx4 v5, s[32:35], s57 offen offset:0 nt lds
    buffer_load_dwordx4 v6, s[32:35], s58 offen offset:1024 nt lds
    s_add_u32 s57, s57, 24576
    s_add_u32 s58, s58, 24576
    s_add_u32 m0, m0, 2048
    s_cmp_lg_u32 m0, 108544
    s_cbranch_scc1 L_dma_25
    s_mul_i32 s57, s14, 1
    s_mov_b32 m0, 32768
    s_nop 0
    buffer_load_dwordx4 v3, s[48:51], s57 offen offset:0 nt lds
    s_mul_i32 s57, s14, 1
    s_add_u32 s57, s57, s15
    s_mov_b32 m0, 32768
    s_nop 0
    buffer_load_dwordx4 v3, s[48:51], s57 offen offset:1024 nt lds
    s_mov_b32 s57, 393472
    s_mov_b32 s58, 589056
    s_mov_b32 m0, 108544
L_dma_26:
    s_waitcnt vmcnt(22)
    buffer_load_dwordx4 v5, s[32:35], s57 offen offset:0 nt lds
    buffer_load_dwordx4 v6, s[32:35], s58 offen offset:1024 nt lds
    s_add_u32 s57, s57, 24576
    s_add_u32 s58, s58, 24576
    s_add_u32 m0, m0, 2048
    s_cmp_lg_u32 m0, 124928
    s_cbranch_scc1 L_dma_26
L_skip_22:
    s_waitcnt lgkmcnt(0)
    s_cmp_lt_u32 s30, 5
    s_cbranch_scc0 L_skip_27
    s_waitcnt vmcnt(0)
L_skip_27:
    s_cmp_eq_u32 s30, 7
    s_cbranch_scc0 L_skip_28
    v_and_b32 v60, 31, v0
    v_cmp_gt_u32 s[64:65], 20, v60
    v_min_u32 v60, 19, v60
    v_lshrrev_b32 v35, 5, v0
    v_lshlrev_b32 v35, 2, v35
    v_add_u32 v35, 160832, v35
    v_lshl_add_u32 v35, v60, 3, v35
    s_mul_i32 s66, s53, 12416
    s_add_u32 s66, s66, s62
    s_add_u32 s66, s66, 70656
    s_add_u32 s67, s66, 12288
    s_lshl_b32 s57, s54, 3
    v_lshrrev_b32 v34, 5, v0
    v_lshlrev_b32 v34, 2, v34
    v_add_u32 v34, s57, v34
    v_and_b32 v60, 31, v0
    v_mov_b32 v61, 0x7f000000
    v_cmp_ne_u32 vcc, 31, v60
    s_nop 1
    v_cndmask_b32 v34, v34, v61, vcc
    v_mov_b32 v61, 0x3f803f80
    s_waitcnt vmcnt(0)
    ds_write_b32 v35, v28
    s_waitcnt lgkmcnt(0)
L_skip_28:
    s_cmp_eq_u32 s30, 5
    s_cbranch_scc0 L_skip_29
    s_waitcnt vmcnt(0)
    s_lshr_b32 s65, s63, 2
    s_sub_u32 s58, s3, 20
    s_cmp_lt_u32 s58, 4
    s_cbranch_scc0 L_skip_30
    s_mov_b32 s67, 0
    s_load_dword s66, s[10:11], 0
    s_load_dword s67, s[10:11], 8192
    s_waitcnt lgkmcnt(1)
    s_sleep 1
    s_mov_b32 s65, s67
L_skip_30:
L_skip_29:
    s_waitcnt vmcnt(36)
    s_barrier
    ds_read_b128 v[88:91], v8 offset:49152
    ds_read_b128 v[92:95], v9 offset:49152
    s_cmp_eq_u32 s30, 6
    s_cbranch_scc0 L_skip_31
    s_mul_i32 s57, s14, 2
    s_mov_b32 m0, 34816
    s_nop 0
    buffer_load_dwordx4 v3, s[48:51], s57 offen offset:0 nt lds
    s_mul_i32 s57, s14, 2
    s_add_u32 s57, s57, s15
    s_mov_b32 m0, 34816
    s_nop 0
    buffer_load_dwordx4 v3, s[48:51], s57 offen offset:1024 nt lds
    s_mov_b32 s57, 786432
    s_mov_b32 s58, 982016
    s_mov_b32 m0, 124928
L_dma_32:
    s_waitcnt vmcnt(22)
    buffer_load_dwordx4 v5, s[32:35], s57 offen offset:0 nt lds
    buffer_load_dwordx4 v6, s[32:35], s58 offen offset:1024 nt lds
    s_add_u32 s57, s57, 24576
    s_add_u32 s58, s58, 24576
    s_add_u32 m0, m0, 2048
    s_cmp_lg_u32 m0, 141312
    s_cbranch_scc1 L_dma_32
L_skip_31:
    s_waitcnt lgkmcnt(0)
    s_cmp_eq_u32 s30, 7
    s_cbranch_scc0 L_skip_33
    v_cndmask_b32 v29, 0, v28, s[64:65]
    v_dot2_f32_bf16 v33, v29, v61, 0
    v_dot2_f32_bf16 v32, v29, v29, 0
    v_lshlrev_b32 v2, 16, v28
    v_and_b32 v3, 0xffff0000, v28
    s_cmp_eq_u32 s55, 0
    v_permlane32_swap_b32 v33, v32
    v_add_f32 v33, v33, v32
    s_nop 1
    v_add_f32_dpp v33, v33, v33 row_ror:8 row_mask:0xf bank_mask:0xf
    s_nop 1
    v_add_f32_dpp v33, v33, v33 row_ror:4 row_mask:0xf bank_mask:0xf
    s_nop 1
    v_add_f32_dpp v33, v33, v33 row_ror:2 row_mask:0xf bank_mask:0xf
    s_nop 1
    v_add_f32_dpp v33, v33, v33 row_ror:1 row_mask:0xf bank_mask:0xf
    s_nop 1
    v_add_f32_dpp v33, v33, v33 row_bcast:15 row_mask:0xa bank_mask:0xf
    s_cbranch_scc1 L_gs_34
    buffer_store_dword v33, v34, s[40:43], s67 offen
L_gb_35:
    s_waitcnt vmcnt(1)
L_skip_33:
    s_cmp_lt_u32 s30, 6
    s_cbranch_scc0 L_skip_36
    s_lshr_b32 s57, s30, 1
    s_mul_i32 s57, s57, 1024
    s_and_b32 s58, s30, 1
    s_lshl_b32 s58, s58, 6
    s_add_u32 s57, s57, s58
    v_lshrrev_b32 v18, 5, v0
    v_mul_u32_u24 v18, 6144, v18
    v_bfe_u32 v60, v0, 3, 1
    v_mul_u32_u24 v60, 3072, v60
    v_add_u32 v18, v60, v18
    v_bfe_u32 v60, v0, 4, 1
    v_lshl_add_u32 v18, v60, 9, v18
    v_bfe_u32 v60, v0, 2, 1
    v_lshl_add_u32 v18, v60, 7, v18
    v_and_b32 v60, 3, v0
    v_lshl_add_u32 v18, v60, 3, v18
    v_add_u32 v18, s57, v18
    v_bfe_u32 v19, v0, 4, 1
    v_mul_u32_u24 v19, 3072, v19
    v_bfe_u32 v60, v0, 3, 1
    v_lshl_add_u32 v19, v60, 9, v19
    v_bfe_u32 v60, v0, 2, 1
    v_lshl_add_u32 v19, v60, 7, v19
    v_and_b32 v60, 3, v0
    v_lshl_add_u32 v19, v60, 3, v19
    v_add_u32 v19, s57, v19
    v_add_u32 v19, 24576, v19
    ds_read_b64_tr_b16 v[28:29], v18 offset:0
    ds_read_b64_tr_b16 v[30:31], v18 offset:256
    ds_read_b64_tr_b16 v[32:33], v18 offset:12288
    ds_read_b64_tr_b16 v[34:35], v18 offset:12544
    ds_read_b64_tr_b16 v[36:37], v19 offset:0
    ds_read_b64_tr_b16 v[38:39], v19 offset:256
    ds_read_b64_tr_b16 v[40:41], v18 offset:32
    ds_read_b64_tr_b16 v[42:43], v18 offset:288
    ds_read_b64_tr_b16 v[44:45], v18 offset:12320
    ds_read_b64_tr_b16 v[46:47], v18 offset:12576
    ds_read_b64_tr_b16 v[48:49], v19 offset:32
    ds_read_b64_tr_b16 v[50:51], v19 offset:288
    v_lshrrev_b32 v52, 4, v0
    v_lshlrev_b32 v52, 5, v52
    v_bfe_u32 v60, v0, 1, 1
    v_lshl_add_u32 v52, v60, 4, v52
    v_and_b32 v60, 1, v0
    v_mul_u32_u24 v60, 192, v60
    v_add_u32 v52, v60, v52
    v_add_u32 v52, 160832, v52
    v_lshrrev_b32 v53, 4, v0
    v_lshlrev_b32 v53, 4, v53
    v_bfe_u32 v60, v0, 1, 1
    v_lshl_add_u32 v53, v60, 3, v53
    v_and_b32 v60, 1, v0
    v_mul_u32_u24 v60, 192, v60
    v_add_u32 v53, v60, v53
    v_add_u32 v53, 160960, v53
    v_mov_b64 v[20:21], 0
    v_mov_b64 v[22:23], 0
    v_mov_b64 v[24:25], 0
    v_mov_b64 v[26:27], 0
    s_lshr_b32 s57, s30, 1
    s_lshl_b32 s57, s57, 11
    s_lshl_b32 s58, s58, 1
    s_add_u32 s57, s57, s58
    s_lshl_b32 s58, s54, 8
    s_add_u32 s57, s57, s58
    v_and_b32 v54, 31, v0
    v_lshlrev_b32 v54, 2, v54
    v_lshrrev_b32 v60, 5, v0
    v_mul_u32_u24 v60, 6144, v60
    v_add_u32 v54, v60, v54
    v_add_u32 v54, s57, v54
    s_mul_i32 s59, s53, 12416
    s_add_u32 s59, s59, s62
    s_add_u32 s59, s59, 70656
    s_add_u32 s60, s59, 12288
    ds_read_b128 v[12:15], v52
    ds_read_b64 v[16:17], v53
    s_waitcnt lgkmcnt(1)
    v_smfmac_f32_16x16x64_bf16 v[20:23], v[12:15], v[28:35], v1
    v_smfmac_f32_16x16x64_bf16 v[24:27], v[12:15], v[40:47], v1
    s_waitcnt lgkmcnt(0)
    v_smfmac_f32_16x16x32_bf16 v[20:23], v[16:17], v[36:39], v1
    v_smfmac_f32_16x16x32_bf16 v[24:27], v[16:17], v[48:51], v1
    s_cmp_eq_u32 s55, 0
    s_nop 5
    v_add_f32 v12, v20, v22
    s_nop 1
    v_add_f32_dpp v12, v24, v26 quad_perm:[0,1,2,3] row_mask:0x2 bank_mask:0xf
    s_nop 1
    v_add_f32_dpp v12, v21, v23 quad_perm:[0,1,2,3] row_mask:0x4 bank_mask:0xf
    s_nop 1
    v_add_f32_dpp v12, v25, v27 quad_perm:[0,1,2,3] row_mask:0x8 bank_mask:0xf
    s_cbranch_scc1 L_gs_37
    buffer_store_dword v12, v54, s[40:43], s59 offen
L_gb_38:
L_skip_36:
    s_cmp_eq_u32 s30, 5
    s_cbranch_scc0 L_skip_39
    global_load_dword v2, v3, s[26:27] sc1
L_skip_39:
    s_waitcnt vmcnt(36)
    s_barrier
    ds_read_b128 v[96:99], v8 offset:0
    ds_read_b128 v[100:103], v9 offset:0
    s_cmp_eq_u32 s30, 6
    s_cbranch_scc0 L_skip_40
    s_mul_i32 s57, s14, 3
    s_mov_b32 m0, 36864
    s_nop 0
    buffer_load_dwordx4 v3, s[48:51], s57 offen offset:0 nt lds
    s_mul_i32 s57, s14, 3
    s_add_u32 s57, s57, s15
    s_mov_b32 m0, 36864
    s_nop 0
    buffer_load_dwordx4 v3, s[48:51], s57 offen offset:1024 nt lds
    s_mov_b32 s57, 786560
    s_mov_b32 s58, 982144
    s_mov_b32 m0, 141312
L_dma_41:
    s_waitcnt vmcnt(22)
    buffer_load_dwordx4 v5, s[32:35], s57 offen offset:0 nt lds
    buffer_load_dwordx4 v6, s[32:35], s58 offen offset:1024 nt lds
    s_add_u32 s57, s57, 24576
    s_add_u32 s58, s58, 24576
    s_add_u32 m0, m0, 2048
    s_cmp_lg_u32 m0, 157696
    s_cbranch_scc1 L_dma_41
L_skip_40:
    s_waitcnt lgkmcnt(0)
    s_waitcnt vmcnt(36)
    s_barrier
    ds_read_b128 v[104:107], v8 offset:16384
    ds_read_b128 v[108:111], v9 offset:16384
    s_cmp_eq_u32 s30, 6
    s_cbranch_scc0 L_skip_42
    s_mul_i32 s57, s14, 4
    s_mov_b32 m0, 38912
    s_nop 0
    buffer_load_dwordx4 v3, s[48:51], s57 offen offset:0 nt lds
    s_mul_i32 s57, s14, 4
    s_add_u32 s57, s57, s15
    s_mov_b32 m0, 38912
    s_nop 0
    buffer_load_dwordx4 v3, s[48:51], s57 offen offset:1024 nt lds
    s_mov_b32 s57, 786688
    s_mov_b32 s58, 982272
    s_mov_b32 m0, 92160
L_dma_43:
    s_waitcnt vmcnt(22)
    buffer_load_dwordx4 v5, s[32:35], s57 offen offset:0 nt lds
    buffer_load_dwordx4 v6, s[32:35], s58 offen offset:1024 nt lds
    s_add_u32 s57, s57, 24576
    s_add_u32 s58, s58, 24576
    s_add_u32 m0, m0, 2048
    s_cmp_lg_u32 m0, 108544
    s_cbranch_scc1 L_dma_43
L_skip_42:
    s_waitcnt lgkmcnt(0)
    s_cmp_lg_u32 s30, 6
    s_cbranch_scc0 L_skip_44
    s_waitcnt vmcnt(0)
L_skip_44:
    s_waitcnt vmcnt(36)
    s_barrier
    ds_read_b128 v[112:115], v8 offset:32768
    ds_read_b128 v[116:119], v9 offset:32768
    s_cmp_eq_u32 s30, 6
    s_cbranch_scc0 L_skip_45
    s_mul_i32 s57, s14, 5
    s_mov_b32 m0, 40960
    s_nop 0
    buffer_load_dwordx4 v3, s[48:51], s57 offen offset:0 nt lds
    s_mul_i32 s57, s14, 5
    s_add_u32 s57, s57, s15
    s_mov_b32 m0, 40960
    s_nop 0
    buffer_load_dwordx4 v3, s[48:51], s57 offen offset:1024 nt lds
    s_mov_b32 s57, 1179648
    s_mov_b32 s58, 1375232
    s_mov_b32 m0, 108544
L_dma_46:
    s_waitcnt vmcnt(22)
    buffer_load_dwordx4 v5, s[32:35], s57 offen offset:0 nt lds
    buffer_load_dwordx4 v6, s[32:35], s58 offen offset:1024 nt lds
    s_add_u32 s57, s57, 24576
    s_add_u32 s58, s58, 24576
    s_add_u32 m0, m0, 2048
    s_cmp_lg_u32 m0, 124928
    s_cbranch_scc1 L_dma_46
L_skip_45:
    s_waitcnt lgkmcnt(0)
    s_cmp_eq_u32 s30, 5
    s_cbranch_scc0 L_skip_47
L_cw_48:
    v_readlane_b32 s57, v2, s31
    s_cmp_eq_u32 s57, 0
    s_cbranch_scc1 L_cr_49
    s_lshr_b32 s58, s63, 2
    s_xor_b32 s58, s58, s65
    s_and_b32 s58, s58, 1
    v_mov_b32 v25, s58
    s_sub_u32 s57, s57, 1
    s_cmp_eq_u32 s57, s63
    s_cselect_b32 s64, 1, 0
    s_cbranch_scc0 L_far_50
    s_lshl_b32 s57, s52, 2
    s_add_u32 s57, s57, s72
    s_mov_b64 exec, 1
    buffer_store_dword v25, v0, s[40:43], s57 offen offset:0
    s_mov_b64 exec, -1
L_fb_51:
L_skip_47:
    s_waitcnt vmcnt(36)
    s_barrier
    ds_read_b128 v[120:123], v8 offset:49152
    ds_read_b128 v[124:127], v9 offset:49152
    s_cmp_eq_u32 s30, 6
    s_cbranch_scc0 L_skip_52
    s_mul_i32 s57, s14, 6
    s_mov_b32 m0, 43008
    s_nop 0
    buffer_load_dwordx4 v3, s[48:51], s57 offen offset:0 nt lds
    s_mul_i32 s57, s14, 6
    s_add_u32 s57, s57, s15
    s_mov_b32 m0, 43008
    s_nop 0
    buffer_load_dwordx4 v3, s[48:51], s57 offen offset:1024 nt lds
    s_mov_b32 s57, 1179776
    s_mov_b32 s58, 1375360
    s_mov_b32 m0, 124928
L_dma_53:
    s_waitcnt vmcnt(22)
    buffer_load_dwordx4 v5, s[32:35], s57 offen offset:0 nt lds
    buffer_load_dwordx4 v6, s[32:35], s58 offen offset:1024 nt lds
    s_add_u32 s57, s57, 24576
    s_add_u32 s58, s58, 24576
    s_add_u32 m0, m0, 2048
    s_cmp_lg_u32 m0, 141312
    s_cbranch_scc1 L_dma_53
L_skip_52:
    s_waitcnt lgkmcnt(0)
    s_waitcnt vmcnt(36)
    s_barrier
    ds_read_b128 v[128:131], v8 offset:0
    ds_read_b128 v[132:135], v9 offset:0
    s_cmp_eq_u32 s30, 6
    s_cbranch_scc0 L_skip_54
    s_mul_i32 s57, s14, 7
    s_mov_b32 m0, 45056
    s_nop 0
    buffer_load_dwordx4 v3, s[48:51], s57 offen offset:0 nt lds
    s_mul_i32 s57, s14, 7
    s_add_u32 s57, s57, s15
    s_mov_b32 m0, 45056
    s_nop 0
    buffer_load_dwordx4 v3, s[48:51], s57 offen offset:1024 nt lds
    s_mov_b32 s57, 1179904
    s_mov_b32 s58, 1375488
    s_mov_b32 m0, 141312
L_dma_55:
    s_waitcnt vmcnt(22)
    buffer_load_dwordx4 v5, s[32:35], s57 offen offset:0 nt lds
    buffer_load_dwordx4 v6, s[32:35], s58 offen offset:1024 nt lds
    s_add_u32 s57, s57, 24576
    s_add_u32 s58, s58, 24576
    s_add_u32 m0, m0, 2048
    s_cmp_lg_u32 m0, 157696
    s_cbranch_scc1 L_dma_55
L_skip_54:
    s_waitcnt lgkmcnt(0)
    s_cmp_eq_u32 s30, 5
    s_cbranch_scc0 L_skip_56
    v_lshlrev_b32 v24, 2, v0
    buffer_load_dword v2, v24, s[40:43], s72 offen sc1
L_skip_56:
    s_waitcnt vmcnt(36)
    s_barrier
    ds_read_b128 v[136:139], v8 offset:16384
    ds_read_b128 v[140:143], v9 offset:16384
    s_cmp_eq_u32 s30, 6
    s_cbranch_scc0 L_skip_57
    s_mul_i32 s57, s14, 8
    s_mov_b32 m0, 47104
    s_nop 0
    buffer_load_dwordx4 v3, s[48:51], s57 offen offset:0 nt lds
    s_mul_i32 s57, s14, 8
    s_add_u32 s57, s57, s15
    s_mov_b32 m0, 47104
    s_nop 0
    buffer_load_dwordx4 v3, s[48:51], s57 offen offset:1024 nt lds
    s_mov_b32 s57, 0
    s_mov_b32 s58, 392192
    s_mov_b32 m0, 92160
L_dma_58:
    s_waitcnt vmcnt(22)
    buffer_load_dwordx4 v7, s[36:39], s57 offen offset:0 nt lds
    buffer_load_dwordx4 v7, s[36:39], s58 offen offset:1024 nt lds
    s_add_u32 s57, s57, 24576
    s_add_u32 s58, s58, 24576
    s_add_u32 m0, m0, 2048
    s_cmp_lg_u32 m0, 108544
    s_cbranch_scc1 L_dma_58
L_skip_57:
    s_waitcnt lgkmcnt(0)
    s_waitcnt vmcnt(36)
    s_barrier
    ds_read_b128 v[144:147], v8 offset:32768
    ds_read_b128 v[148:151], v9 offset:32768
    s_cmp_eq_u32 s30, 6
    s_cbranch_scc0 L_skip_59
    s_mul_i32 s57, s14, 9
    s_mov_b32 m0, 49152
    s_nop 0
    buffer_load_dwordx4 v3, s[48:51], s57 offen offset:0 nt lds
    s_mul_i32 s57, s14, 9
    s_add_u32 s57, s57, s15
    s_mov_b32 m0, 49152
    s_nop 0
    buffer_load_dwordx4 v3, s[48:51], s57 offen offset:1024 nt lds
    s_mov_b32 s57, 128
    s_mov_b32 s58, 392320
    s_mov_b32 m0, 108544
L_dma_60:
    s_waitcnt vmcnt(22)
    buffer_load_dwordx4 v7, s[36:39], s57 offen offset:0 nt lds
    buffer_load_dwordx4 v7, s[36:39], s58 offen offset:1024 nt lds
    s_add_u32 s57, s57, 24576
    s_add_u32 s58, s58, 24576
    s_add_u32 m0, m0, 2048
    s_cmp_lg_u32 m0, 124928
    s_cbranch_scc1 L_dma_60
L_skip_59:
    s_waitcnt lgkmcnt(0)
    s_cmp_eq_u32 s30, 5
    s_cbranch_scc0 L_skip_61
L_cw_62:
    s_waitcnt vmcnt(0)
    v_cmp_ne_u32 vcc, -1, v2
    s_mov_b32 s57, 0
    s_mov_b32 s68, 2
    s_cmp_eq_u32 s64, 0
    s_cbranch_scc1 L_cd_64
    s_cmp_lg_u32 vcc_hi, 0
    s_cbranch_scc1 L_cd_64
    s_cmp_lg_u32 vcc_lo, -1
    s_cbranch_scc1 L_cr_63
    v_cmp_eq_u32 vcc, 1, v2
    s_bcnt1_i32_b32 s68, vcc_lo
    s_mov_b32 s57, 1
L_cd_64:
    v_mov_b32 v37, 160768
    v_mov_b32 v38, s57
    ds_write_b32 v37, v38
    s_waitcnt lgkmcnt(0)
L_skip_61:
    s_waitcnt vmcnt(36)
    s_barrier
    ds_read_b128 v[152:155], v8 offset:49152
    ds_read_b128 v[156:159], v9 offset:49152
    s_cmp_eq_u32 s30, 6
    s_cbranch_scc0 L_skip_65
    s_mul_i32 s57, s14, 10
    s_mov_b32 m0, 51200
    s_nop 0
    buffer_load_dwordx4 v3, s[48:51], s57 offen offset:0 nt lds
    s_mul_i32 s57, s14, 10
    s_add_u32 s57, s57, s15
    s_mov_b32 m0, 51200
    s_nop 0
    buffer_load_dwordx4 v3, s[48:51], s57 offen offset:1024 nt lds
    s_mov_b32 s57, 256
    s_mov_b32 s58, 392448
    s_mov_b32 m0, 124928
L_dma_66:
    s_waitcnt vmcnt(22)
    buffer_load_dwordx4 v7, s[36:39], s57 offen offset:0 nt lds
    buffer_load_dwordx4 v7, s[36:39], s58 offen offset:1024 nt lds
    s_add_u32 s57, s57, 24576
    s_add_u32 s58, s58, 24576
    s_add_u32 m0, m0, 2048
    s_cmp_lg_u32 m0, 141312
    s_cbranch_scc1 L_dma_66
L_skip_65:
    s_waitcnt lgkmcnt(0)
    v_lshrrev_b32 v8, 2, v0
    v_lshlrev_b32 v8, 7, v8
    v_bfe_u32 v60, v0, 3, 2
    v_lshl_add_u32 v8, v60, 5, v8
    v_and_b32 v60, 3, v0
    v_lshl_add_u32 v8, v60, 3, v8
    v_add_u32 v8, s61, v8
    v_xor_b32 v9, 32, v8
    v_xor_b32 v10, 64, v8
    v_xor_b32 v11, 96, v8
    v_mov_b32 v41, 160768
    ds_read_b32 v42, v41
    s_waitcnt lgkmcnt(0)
    v_readfirstlane_b32 s55, v42
    s_cmp_eq_u32 s55, 0
    s_cbranch_scc1 L_spread
L_spread_back:
    s_cmp_eq_u32 s30, 5
    s_cbranch_scc0 L_skip_78
    s_cmp_eq_u32 s52, 31
    s_cbranch_scc0 L_skip_79
    s_lshl_b32 s57, s31, 5
    v_mov_b32 v16, s57
    s_add_u32 s57, s68, 1
    v_mov_b32 v12, s57
    s_mov_b64 exec, 0x1
    global_store_dword v16, v12, s[26:27] offset:4 sc1
    s_mov_b64 exec, -1
L_skip_79:
L_skip_78:
    s_sub_u32 s58, s30, 1
    s_cmp_lt_u32 s58, 3
    s_cbranch_scc0 L_skip_80
    s_mul_i32 s59, s53, 12416
    s_add_u32 s59, s59, s62
    s_add_u32 s59, s59, 70656
    s_add_u32 s60, s59, 12288
    s_lshl_b32 s57, s58, 11
    v_lshlrev_b32 v48, 4, v0
    v_add_u32 v48, s57, v48
    v_and_b32 v49, 7, v0
    v_lshlrev_b32 v49, 3, v49
    s_add_u32 s57, s59, 6144
    buffer_load_dwordx4 v[12:15], v48, s[40:43], s59 offen offset:0 sc1 nt
    buffer_load_dwordx4 v[16:19], v48, s[40:43], s59 offen offset:1024 sc1 nt
    buffer_load_dwordx4 v[28:31], v48, s[40:43], s57 offen offset:0 sc1 nt
    buffer_load_dwordx4 v[32:35], v48, s[40:43], s57 offen offset:1024 sc1 nt
    buffer_load_dwordx2 v[24:25], v49, s[40:43], s60 offen sc1 nt
L_skip_80:
    s_waitcnt vmcnt(36)
    s_barrier
    ds_read_b64_tr_b16 v[160:161], v8 offset:0
    ds_read_b64_tr_b16 v[168:169], v9 offset:0
    ds_read_b64_tr_b16 v[176:177], v10 offset:0
    ds_read_b64_tr_b16 v[184:185], v11 offset:0
    s_cmp_eq_u32 s30, 6
    s_cbranch_scc0 L_skip_81
    s_mul_i32 s57, s14, 11
    s_mov_b32 m0, 53248
    s_nop 0
    buffer_load_dwordx4 v3, s[48:51], s57 offen offset:0 nt lds
    s_mul_i32 s57, s14, 11
    s_add_u32 s57, s57, s15
    s_mov_b32 m0, 53248
    s_nop 0
    buffer_load_dwordx4 v3, s[48:51], s57 offen offset:1024 nt lds
    s_mov_b32 s57, 196608
    s_mov_b32 s58, 588800
    s_mov_b32 m0, 141312
L_dma_82:
    s_waitcnt vmcnt(22)
    buffer_load_dwordx4 v7, s[36:39], s57 offen offset:0 nt lds
    buffer_load_dwordx4 v7, s[36:39], s58 offen offset:1024 nt lds
    s_add_u32 s57, s57, 24576
    s_add_u32 s58, s58, 24576
    s_add_u32 m0, m0, 2048
    s_cmp_lg_u32 m0, 157696
    s_cbranch_scc1 L_dma_82
L_skip_81:
    s_waitcnt lgkmcnt(0)
    s_waitcnt vmcnt(36)
    s_barrier
    ds_read_b64_tr_b16 v[192:193], v8 offset:16384
    ds_read_b64_tr_b16 v[200:201], v9 offset:16384
    ds_read_b64_tr_b16 v[208:209], v10 offset:16384
    ds_read_b64_tr_b16 v[216:217], v11 offset:16384
    s_cmp_eq_u32 s30, 6
    s_cbranch_scc0 L_skip_83
    s_mov_b32 s57, 196736
    s_mov_b32 s58, 588928
    s_mov_b32 m0, 92160
L_dma_84:
    s_waitcnt vmcnt(22)
    buffer_load_dwordx4 v7, s[36:39], s57 offen offset:0 nt lds
    buffer_load_dwordx4 v7, s[36:39], s58 offen offset:1024 nt lds
    s_add_u32 s57, s57, 24576
    s_add_u32 s58, s58, 24576
    s_add_u32 m0, m0, 2048
    s_cmp_lg_u32 m0, 108544
    s_cbranch_scc1 L_dma_84
L_skip_83:
    s_waitcnt lgkmcnt(0)
    s_sub_u32 s58, s30, 1
    s_cmp_lt_u32 s58, 3
    s_cbranch_scc0 L_skip_85
    s_lshl_b32 s57, s58, 7
    v_bfe_u32 v51, v0, 2, 2
    v_lshlrev_b32 v51, 5, v51
    v_lshrrev_b32 v60, 5, v0
    v_lshl_add_u32 v51, v60, 4, v51
    v_and_b32 v60, 3, v0
    v_lshl_add_u32 v51, v60, 2, v51
    v_bfe_u32 v60, v0, 4, 1
    v_lshl_add_u32 v51, v60, 1, v51
    v_add_u32 v51, s57, v51
    v_add_u32 v51, 157696, v51
    v_mov_b32 v60, 0x3c75e03e
    v_mov_b32 v61, 0x3a71d1e6
    v_mov_b32 v47, 0x3e13985d
    s_waitcnt vmcnt(0)
    v_pk_add_f32 v[36:37], v[28:29], v[32:33]
    v_pk_add_f32 v[38:39], v[30:31], v[34:35]
    s_nop 1
    v_permlane32_swap_b32 v36, v38
    v_permlane32_swap_b32 v37, v39
    v_pk_add_f32 v[36:37], v[36:37], v[38:39]
    s_nop 1
    v_permlane16_swap_b32 v36, v37
    v_add_f32 v36, v36, v37
    v_mul_f32 v6, 0x3dd53b95, v36
    v_add_f32_dpp v48, v24, v24 row_ror:4 row_mask:0xf bank_mask:0xf
    v_add_f32_dpp v49, v25, v25 row_ror:4 row_mask:0xf bank_mask:0xf
    v_pk_add_f32 v[20:21], v[12:13], v[16:17]
    v_pk_add_f32 v[22:23], v[14:15], v[18:19]
    v_add_f32_dpp v48, v48, v48 row_ror:2 row_mask:0xf bank_mask:0xf
    v_add_f32_dpp v49, v49, v49 row_ror:2 row_mask:0xf bank_mask:0xf
    v_permlane32_swap_b32 v20, v22
    v_permlane32_swap_b32 v21, v23
    v_add_f32_dpp v48, v48, v48 row_ror:1 row_mask:0xf bank_mask:0xf
    v_add_f32_dpp v49, v49, v49 row_ror:1 row_mask:0xf bank_mask:0xf
    v_pk_add_f32 v[20:21], v[20:21], v[22:23]
    v_mul_f32 v48, v48, v60
    v_fma_f32 v49, v49, v47, v61
    v_permlane16_swap_b32 v20, v21
    v_fma_f32 v49, -v48, v48, v49
    v_add_f32 v20, v20, v21
    v_max_f32 v49, v49, v61
    v_mul_f32 v50, v6, v48
    v_rsq_f32 v49, v49
    v_cmp_u_f32 vcc, v20, v20
    v_sub_f32 v20, v20, v50
    v_mul_f32 v20, v20, v49
    v_cvt_pk_bf16_f32 v20, v20, v20
    ds_write_b16 v51, v20
    s_waitcnt lgkmcnt(0)
L_skip_85:
    s_lshl_b32 s57, s30, 7
    s_add_u32 s57, s57, 158720
    v_lshrrev_b32 v58, 4, v0
    v_lshlrev_b32 v58, 5, v58
    v_bfe_u32 v60, v0, 1, 1
    v_lshl_add_u32 v58, v60, 4, v58
    v_bfe_u32 v60, v0, 2, 2
    v_lshl_add_u32 v58, v60, 2, v58
    v_and_b32 v60, 1, v0
    v_lshl_add_u32 v58, v60, 1, v58
    v_add_u32 v58, s57, v58
    v_lshrrev_b32 v61, 4, v0
    v_lshlrev_b32 v61, 5, v61
    v_bfe_u32 v60, v0, 1, 1
    v_lshl_add_u32 v61, v60, 4, v61
    v_add_u32 v61, s57, v61
    v_bfe_u32 v62, v0, 2, 2
    v_lshlrev_b32 v62, 1, v62
    v_and_b32 v60, 1, v0
    v_lshl_add_u32 v62, v60, 0, v62
    v_mov_b32 v60, 160992
    v_cmp_eq_u32 vcc, 0, v62
    s_nop 1
    v_cndmask_b32 v52, v60, v61, vcc
    v_cmp_eq_u32 vcc, 1, v62
    s_nop 1
    v_cndmask_b32 v53, v60, v61, vcc
    v_cmp_eq_u32 vcc, 2, v62
    s_nop 1
    v_cndmask_b32 v54, v60, v61, vcc
    v_cmp_eq_u32 vcc, 3, v62
    s_nop 1
    v_cndmask_b32 v55, v60, v61, vcc
    v_cmp_eq_u32 vcc, 4, v62
    s_nop 1
    v_cndmask_b32 v56, v60, v61, vcc
    v_cmp_eq_u32 vcc, 5, v62
    s_nop 1
    v_cndmask_b32 v57, v60, v61, vcc
    s_lshl_b32 s58, s30, 2
    s_add_u32 s58, s58, 159744
    v_mov_b32 v60, s58
    v_lshlrev_b32 v59, 2, v0
    v_add_u32 v59, 158208, v59
    v_cmp_eq_u32 vcc, 63, v0
    s_nop 1
    v_cndmask_b32 v59, v59, v60, vcc
    v_and_b32 v62, 7, v0
    v_lshlrev_b32 v62, 2, v62
    v_add_u32 v62, 159744, v62
    s_lshl_b32 s57, s30, 11
    v_lshlrev_b32 v63, 4, v0
    v_add_u32 v63, s57, v63
    v_add_u32 v63, 92160, v63
    s_waitcnt vmcnt(34)
    s_barrier
    ds_read_b64_tr_b16 v[224:225], v8 offset:32768
    ds_read_b64_tr_b16 v[232:233], v9 offset:32768
    ds_read_b64_tr_b16 v[240:241], v10 offset:32768
    ds_read_b64_tr_b16 v[248:249], v11 offset:32768
    s_cmp_eq_u32 s30, 6
    s_cbranch_scc0 L_skip_86
    s_mov_b32 s57, 196864
    s_mov_b32 s58, 589056
    s_mov_b32 m0, 108544
L_dma_87:
    s_nop 0
    buffer_load_dwordx4 v7, s[36:39], s57 offen offset:0 nt lds
    buffer_load_dwordx4 v7, s[36:39], s58 offen offset:1024 nt lds
    s_add_u32 s57, s57, 24576
    s_add_u32 s58, s58, 24576
    s_add_u32 m0, m0, 2048
    s_cmp_lg_u32 m0, 124928
    s_cbranch_scc1 L_dma_87
L_skip_86:
    s_waitcnt lgkmcnt(0)
    v_lshrrev_b32 v5, 4, v0
    v_lshlrev_b32 v5, 5, v5
    v_bfe_u32 v60, v0, 1, 1
    v_lshl_add_u32 v5, v60, 4, v5
    v_add_u32 v5, 157696, v5
    ds_read_b128 v[12:15], v5 offset:0
    ds_read_b128 v[16:19], v5 offset:128
    ds_read_b128 v[20:23], v5 offset:256
    v_mov_b64 v[24:25], 0
    v_mov_b64 v[26:27], 0
    v_mov_b64 v[28:29], 0
    v_mov_b64 v[30:31], 0
    v_mov_b64 v[32:33], 0
    v_mov_b64 v[34:35], 0
    v_mov_b64 v[36:37], 0
    v_mov_b64 v[38:39], 0
    v_mov_b64 v[40:41], 0
    v_mov_b64 v[42:43], 0
    v_mov_b64 v[44:45], 0
    v_mov_b64 v[46:47], 0
    s_waitcnt lgkmcnt(0)
    v_smfmac_f32_16x16x64_bf16 v[24:27], v[12:15], v[64:71], v1
    v_smfmac_f32_16x16x64_bf16 v[24:27], v[16:19], v[72:79], v1
    v_smfmac_f32_16x16x64_bf16 v[24:27], v[20:23], v[80:87], v1
    v_smfmac_f32_16x16x64_bf16 v[28:31], v[12:15], v[88:95], v1
    v_smfmac_f32_16x16x64_bf16 v[28:31], v[16:19], v[96:103], v1
    v_smfmac_f32_16x16x64_bf16 v[28:31], v[20:23], v[104:111], v1
    v_smfmac_f32_16x16x64_bf16 v[32:35], v[12:15], v[112:119], v1
    v_smfmac_f32_16x16x64_bf16 v[32:35], v[16:19], v[120:127], v1
    v_smfmac_f32_16x16x64_bf16 v[32:35], v[20:23], v[128:135], v1
    v_smfmac_f32_16x16x64_bf16 v[36:39], v[12:15], v[136:143], v1
    v_smfmac_f32_16x16x64_bf16 v[36:39], v[16:19], v[144:151], v1
    v_smfmac_f32_16x16x64_bf16 v[36:39], v[20:23], v[152:159], v1
    v_add_f32 v24, v24, v26
    s_nop 0
    v_add_f32 v28, v28, v30
    s_nop 1
    v_add_f32 v32, v32, v34
    v_max3_f32 v61, v24, v28, v32
    v_mov_b32_dpp v24, v28 quad_perm:[0,1,2,3] row_mask:0x2 bank_mask:0xf
    v_add_f32 v36, v36, v38
    v_max_f32 v61, v61, v36
    v_mov_b32_dpp v24, v32 quad_perm:[0,1,2,3] row_mask:0x4 bank_mask:0xf
    s_nop 0
    v_max_f32_dpp v61, v61, v61 row_ror:8 row_mask:0xf bank_mask:0xf
    s_nop 0
    v_mov_b32_dpp v24, v36 quad_perm:[0,1,2,3] row_mask:0x8 bank_mask:0xf
    v_max_f32_dpp v61, v61, v61 row_ror:4 row_mask:0xf bank_mask:0xf
    s_nop 1
    v_max_f32_dpp v61, v61, v61 row_ror:2 row_mask:0xf bank_mask:0xf
    s_nop 1
    v_max_f32_dpp v61, v61, v61 row_ror:1 row_mask:0xf bank_mask:0xf
    v_sub_f32 v36, v24, v61
    ds_write_b32 v59, v61
    v_exp_f32 v36, v36
    s_nop 0
    v_cvt_pk_bf16_f32 v39, v36, v36
    ds_write_b16 v58, v39
    ds_read_b128 v[12:15], v52
    ds_read_b128 v[16:19], v53
    ds_read_b128 v[20:23], v54
    ds_read_b128 v[24:27], v55
    ds_read_b128 v[28:31], v56
    ds_read_b128 v[32:35], v57
    v_add_f32_dpp v38, v36, v36 row_ror:8 row_mask:0xf bank_mask:0xf
    s_nop 1
    v_add_f32_dpp v38, v38, v38 row_ror:4 row_mask:0xf bank_mask:0xf
    s_nop 1
    v_add_f32_dpp v38, v38, v38 row_ror:2 row_mask:0xf bank_mask:0xf
    s_nop 1
    v_add_f32_dpp v38, v38, v38 row_ror:1 row_mask:0xf bank_mask:0xf
    s_nop 1
    v_add_f32_dpp v38, v38, v38 row_bcast:15 row_mask:0xa bank_mask:0xf
    s_nop 1
    v_add_f32_dpp v38, v38, v38 row_bcast:31 row_mask:0xc bank_mask:0xf
    s_waitcnt lgkmcnt(0)
    s_waitcnt vmcnt(32)
    s_barrier
    ds_read_b64_tr_b16 v[162:163], v8 offset:49152
    ds_read_b64_tr_b16 v[170:171], v9 offset:49152
    ds_read_b64_tr_b16 v[178:179], v10 offset:49152
    ds_read_b64_tr_b16 v[186:187], v11 offset:49152
    s_cmp_eq_u32 s30, 6
    s_cbranch_scc0 L_skip_88
    s_mov_b32 s57, 786432
    s_mov_b32 s58, 1178624
    s_mov_b32 m0, 124928
L_dma_89:
    s_nop 0
    buffer_load_dwordx4 v7, s[36:39], s57 offen offset:0 nt lds
    buffer_load_dwordx4 v7, s[36:39], s58 offen offset:1024 nt lds
    s_add_u32 s57, s57, 24576
    s_add_u32 s58, s58, 24576
    s_add_u32 m0, m0, 2048
    s_cmp_lg_u32 m0, 141312
    s_cbranch_scc1 L_dma_89
L_skip_88:
    s_waitcnt lgkmcnt(0)
    ds_read_b32 v36, v62
    s_waitcnt lgkmcnt(0)
    v_max_f32_dpp v37, v36, v36 row_ror:4 row_mask:0xf bank_mask:0xf
    s_nop 1
    v_max_f32_dpp v37, v37, v37 row_ror:2 row_mask:0xf bank_mask:0xf
    s_nop 1
    v_max_f32_dpp v37, v37, v37 row_ror:1 row_mask:0xf bank_mask:0xf
    v_sub_f32 v39, v61, v37
    v_exp_f32 v39, v39
    s_cmp_lt_u32 s30, 2
    s_cbranch_scc0 L_skip_90
    s_lshl_b32 s57, s30, 3
    v_lshlrev_b32 v2, 4, v0
    v_add_u32 v2, s57, v2
    v_add_u32 v2, 92160, v2
    v_mov_b32 v60, 94192
    v_cmp_le_u32 vcc, 48, v0
    s_nop 1
    v_cndmask_b32 v2, v2, v60, vcc
    s_lshr_b32 s57, s54, 1
    s_lshl_b32 s57, s57, 2
    s_and_b32 s58, s54, 1
    s_add_u32 s57, s57, s58
    s_lshl_b32 s58, s57, 4
    s_lshl_b32 s57, s57, 3
    v_bfe_u32 v3, v0, 3, 2
    v_lshlrev_b32 v3, 8, v3
    v_bfe_u32 v61, v0, 2, 1
    v_lshl_add_u32 v3, v61, 5, v3
    v_and_b32 v61, 3, v0
    v_lshl_add_u32 v3, v61, 2, v3
    v_add_u32 v3, s58, v3
    v_bfe_u32 v60, v0, 3, 1
    v_lshlrev_b32 v60, 8, v60
    v_bfe_u32 v61, v0, 1, 1
    v_lshl_add_u32 v60, v61, 7, v60
    v_bfe_u32 v61, v0, 2, 1
    v_lshl_add_u32 v60, v61, 4, v60
    v_and_b32 v61, 1, v0
    v_lshl_add_u32 v60, v61, 2, v60
    v_add_u32 v60, s57, v60
    v_add_u32 v60, 1024, v60
    v_cmp_gt_u32 vcc, 32, v0
    s_nop 1
    v_cndmask_b32 v3, v60, v3, vcc
    s_lshl_b32 s57, s53, 1
    s_add_u32 s57, s57, s30
    s_mul_i32 s57, s57, 1664
    s_add_u32 s57, s57, s62
    v_add_u32 v3, s57, v3
    v_mov_b32 v60, 0x7f000000
    v_cmp_le_u32 vcc, 48, v0
    s_nop 1
    v_cndmask_b32 v3, v3, v60, vcc
    s_lshl_b32 s58, s54, 2
    s_add_u32 s57, s57, s58
    s_add_u32 s57, s57, 1536
    v_mov_b32 v4, s57
    v_mov_b32 v60, 0x7f000000
    v_cmp_ne_u32 vcc, 48, v0
    s_nop 1
    v_cndmask_b32 v4, v4, v60, vcc
    s_mov_b32 s58, 0
    s_cmp_eq_u32 s55, 0
    s_cbranch_scc1 L_gs_91
    buffer_store_dword v37, v4, s[40:43], s58 offen
L_gb_92:
L_skip_90:
    s_cmp_eq_u32 s30, 2
    s_cbranch_scc0 L_skip_93
    v_lshlrev_b32 v2, 2, v0
    v_add_u32 v2, 157696, v2
    v_and_b32 v3, 15, v0
    v_lshlrev_b32 v3, 2, v3
    v_lshrrev_b32 v60, 5, v0
    v_lshl_add_u32 v3, v60, 6, v3
    v_bfe_u32 v60, v0, 4, 1
    v_lshl_add_u32 v3, v60, 13, v3
L_skip_93:
    s_waitcnt vmcnt(32)
    s_barrier
    ds_read_b64_tr_b16 v[194:195], v8 offset:0
    ds_read_b64_tr_b16 v[202:203], v9 offset:0
    ds_read_b64_tr_b16 v[210:211], v10 offset:0
    ds_read_b64_tr_b16 v[218:219], v11 offset:0
    s_cmp_eq_u32 s30, 6
    s_cbranch_scc0 L_skip_94
    s_mov_b32 s57, 786560
    s_mov_b32 s58, 1178752
    s_mov_b32 m0, 141312
L_dma_95:
    s_nop 0
    buffer_load_dwordx4 v7, s[36:39], s57 offen offset:0 nt lds
    buffer_load_dwordx4 v7, s[36:39], s58 offen offset:1024 nt lds
    s_add_u32 s57, s57, 24576
    s_add_u32 s58, s58, 24576
    s_add_u32 m0, m0, 2048
    s_cmp_lg_u32 m0, 157696
    s_cbranch_scc1 L_dma_95
L_skip_94:
    s_waitcnt lgkmcnt(0)
    s_waitcnt vmcnt(32)
    s_barrier
    ds_read_b64_tr_b16 v[226:227], v8 offset:16384
    ds_read_b64_tr_b16 v[234:235], v9 offset:16384
    ds_read_b64_tr_b16 v[242:243], v10 offset:16384
    ds_read_b64_tr_b16 v[250:251], v11 offset:16384
    s_cmp_eq_u32 s30, 6
    s_cbranch_scc0 L_skip_96
    s_mov_b32 s57, 786688
    s_mov_b32 s58, 1178880
    s_mov_b32 m0, 92160
L_dma_97:
    s_nop 0
    buffer_load_dwordx4 v7, s[36:39], s57 offen offset:0 nt lds
    buffer_load_dwordx4 v7, s[36:39], s58 offen offset:1024 nt lds
    s_add_u32 s57, s57, 24576
    s_add_u32 s58, s58, 24576
    s_add_u32 m0, m0, 2048
    s_cmp_lg_u32 m0, 108544
    s_cbranch_scc1 L_dma_97
L_skip_96:
    s_waitcnt lgkmcnt(0)
    s_cmp_eq_u32 s30, 5
    s_cbranch_scc0 L_skip_98
    global_load_dword v2, v3, s[26:27] offset:4 sc1
L_skip_98:
    s_waitcnt vmcnt(32)
    s_barrier
    ds_read_b64_tr_b16 v[164:165], v8 offset:32768
    ds_read_b64_tr_b16 v[172:173], v9 offset:32768
    ds_read_b64_tr_b16 v[180:181], v10 offset:32768
    ds_read_b64_tr_b16 v[188:189], v11 offset:32768
    s_cmp_eq_u32 s30, 6
    s_cbranch_scc0 L_skip_99
    s_mov_b32 s57, 983040
    s_mov_b32 s58, 1375232
    s_mov_b32 m0, 108544
L_dma_100:
    s_nop 0
    buffer_load_dwordx4 v7, s[36:39], s57 offen offset:0 nt lds
    buffer_load_dwordx4 v7, s[36:39], s58 offen offset:1024 nt lds
    s_add_u32 s57, s57, 24576
    s_add_u32 s58, s58, 24576
    s_add_u32 m0, m0, 2048
    s_cmp_lg_u32 m0, 124928
    s_cbranch_scc1 L_dma_100
L_skip_99:
    s_waitcnt lgkmcnt(0)
    s_waitcnt vmcnt(32)
    s_barrier
    ds_read_b64_tr_b16 v[196:197], v8 offset:49152
    ds_read_b64_tr_b16 v[204:205], v9 offset:49152
    ds_read_b64_tr_b16 v[212:213], v10 offset:49152
    ds_read_b64_tr_b16 v[220:221], v11 offset:49152
    s_cmp_eq_u32 s30, 6
    s_cbranch_scc0 L_skip_101
    s_mov_b32 s57, 983168
    s_mov_b32 s58, 1375360
    s_mov_b32 m0, 124928
L_dma_102:
    s_nop 0
    buffer_load_dwordx4 v7, s[36:39], s57 offen offset:0 nt lds
    buffer_load_dwordx4 v7, s[36:39], s58 offen offset:1024 nt lds
    s_add_u32 s57, s57, 24576
    s_add_u32 s58, s58, 24576
    s_add_u32 m0, m0, 2048
    s_cmp_lg_u32 m0, 141312
    s_cbranch_scc1 L_dma_102
L_skip_101:
    s_waitcnt lgkmcnt(0)
    s_cmp_eq_u32 s30, 5
    s_cbranch_scc0 L_skip_103
L_cw_104:
    s_waitcnt vmcnt(0)
    v_cmp_eq_u32 vcc, 0, v2
    s_cbranch_vccnz L_cr_105
    v_add_u32_dpp v2, v2, v2 row_ror:4 row_mask:0xf bank_mask:0xf
    s_nop 1
    v_add_u32_dpp v2, v2, v2 row_ror:2 row_mask:0xf bank_mask:0xf
    s_nop 1
    v_add_u32_dpp v2, v2, v2 row_ror:1 row_mask:0xf bank_mask:0xf
    v_mov_b32 v60, 160772
    ds_write_b32 v60, v2
    s_waitcnt lgkmcnt(0)
L_skip_103:
    s_cmp_lt_u32 s3, 20
    s_cbranch_scc0 L_skip_106
    s_mul_i32 s74, s30, 1664
    s_add_u32 s74, s74, s62
    s_add_u32 s74, s74, 0
    v_and_b32 v56, 7, v0
    v_lshlrev_b32 v56, 2, v56
    v_lshrrev_b32 v62, 4, v0
    v_lshlrev_b32 v62, 3, v62
    s_cmp_lg_u32 s30, 6
    s_cbranch_scc0 L_skip_106
    buffer_load_dword v52, v56, s[40:43], s74 offen offset:1536 sc1
    buffer_load_dwordx2 v[54:55], v62, s[40:43], s74 offen offset:1536 sc1
L_skip_106:
    s_cmp_eq_u32 s30, 2
    s_cbranch_scc0 L_skip_107
    s_sub_u32 s57, s3, 20
    s_cmp_lt_u32 s57, 4
    s_cbranch_scc0 L_skip_108
    s_sub_u32 s57, s3, 20
    s_lshl_b32 s57, s57, 6
    v_add_u32 v50, s57, v0
    v_min_u32 v50, 207, v50
    v_lshlrev_b32 v50, 7, v50
    s_add_u32 s57, s62, 0
    buffer_load_dword v50, v50, s[40:43], s57 offen sc1 nt
    s_sub_u32 s57, s3, 20
    s_lshl_b32 s57, s57, 6
    v_add_u32 v51, s57, v0
    v_min_u32 v51, 151, v51
    v_lshlrev_b32 v51, 7, v51
    s_add_u32 s57, s62, 26624
    buffer_load_dword v51, v51, s[40:43], s57 offen sc1 nt
    s_sub_u32 s57, s3, 20
    s_lshl_b32 s57, s57, 6
    v_add_u32 v49, s57, v0
    v_min_u32 v49, 191, v49
    v_lshlrev_b32 v49, 7, v49
    s_add_u32 s57, s62, 46080
    buffer_load_dword v49, v49, s[40:43], s57 offen sc1 nt
L_skip_108:
L_skip_107:
    s_waitcnt vmcnt(32)
    s_barrier
    ds_read_b64_tr_b16 v[228:229], v8 offset:0
    ds_read_b64_tr_b16 v[236:237], v9 offset:0
    ds_read_b64_tr_b16 v[244:245], v10 offset:0
    ds_read_b64_tr_b16 v[252:253], v11 offset:0
    s_cmp_eq_u32 s30, 6
    s_cbranch_scc0 L_skip_109
    s_mov_b32 s57, 983296
    s_mov_b32 s58, 1375488
    s_mov_b32 m0, 141312
L_dma_110:
    s_nop 0
    buffer_load_dwordx4 v7, s[36:39], s57 offen offset:0 nt lds
    buffer_load_dwordx4 v7, s[36:39], s58 offen offset:1024 nt lds
    s_add_u32 s57, s57, 24576
    s_add_u32 s58, s58, 24576
    s_add_u32 m0, m0, 2048
    s_cmp_lg_u32 m0, 157696
    s_cbranch_scc1 L_dma_110
L_skip_109:
    s_waitcnt lgkmcnt(0)
    s_cmp_ge_u32 s30, 6
    s_cbranch_scc0 L_skip_111
    v_mov_b32 v60, 160772
    ds_read_b32 v60, v60
    s_lshr_b32 s58, s63, 2
    s_waitcnt lgkmcnt(0)
    v_readfirstlane_b32 s57, v60
    s_cmp_gt_u32 s57, 24
    s_cselect_b32 s57, 1, 0
    s_xor_b32 s57, s57, s58
    s_lshl_b32 s57, s57, 13
    s_add_u32 s7, s8, s57
L_skip_111:
    s_branch L_tail
.p2align 10
L_tail:
L_pad0:
    s_cbranch_execz L_pad4
    s_waitcnt vmcnt(32)
    s_barrier
    ds_read_b64_tr_b16 v[166:167], v8 offset:16384
    ds_read_b64_tr_b16 v[174:175], v9 offset:16384
    ds_read_b64_tr_b16 v[182:183], v10 offset:16384
    ds_read_b64_tr_b16 v[190:191], v11 offset:16384
    s_waitcnt lgkmcnt(0)
    s_cmp_lt_u32 s30, 5
    s_cbranch_scc0 L_skip_112
    s_waitcnt vmcnt(0)
L_skip_112:
    s_cmp_lt_u32 s3, 20
    s_cbranch_scc0 L_skip_113
    v_lshlrev_b32 v57, 4, v0
    v_lshlrev_b32 v58, 3, v0
    s_mul_i32 s57, s30, 6144
    s_add_u32 s57, s57, 30720
    v_lshrrev_b32 v59, 2, v0
    v_lshlrev_b32 v59, 6, v59
    v_bfe_u32 v53, v0, 4, 1
    v_lshl_add_u32 v59, v53, 5, v59
    v_and_b32 v53, 3, v0
    v_lshl_add_u32 v59, v53, 3, v59
    v_add_u32 v59, s57, v59
    v_xor_b32 v60, 32, v59
    s_lshl_b32 s57, s30, 8
    s_add_u32 s57, s57, 157696
    v_lshl_add_u32 v61, v0, 2, s57
    s_cmp_lg_u32 s30, 6
    s_cbranch_scc0 L_skip_113
L_cw_114:
    s_waitcnt vmcnt(0)
    v_max3_u32 v53, v52, v54, v55
    v_cmp_eq_u32 vcc, -1, v53
    s_cbranch_vccnz L_cr_115
    v_max_f32_dpp v53, v52, v52 row_ror:4 row_mask:0xf bank_mask:0xf
    s_nop 1
    v_max_f32_dpp v53, v53, v53 row_ror:2 row_mask:0xf bank_mask:0xf
    s_nop 1
    v_max_f32_dpp v53, v53, v53 row_ror:1 row_mask:0xf bank_mask:0xf
    v_sub_f32 v52, v52, v53
    v_sub_f32 v54, v54, v53
    v_sub_f32 v55, v55, v53
    v_exp_f32 v52, v52
    v_exp_f32 v54, v54
    v_exp_f32 v55, v55
    s_cmp_eq_u32 s30, 7
    s_cbranch_scc0 L_skip_113
    v_add_u32 v62, 158720, v57
    ds_write_b128 v62, v[52:55]
    s_waitcnt lgkmcnt(0)
L_skip_113:
    v_smfmac_f32_16x16x64_bf16 v[40:43], v[12:15], v[160:167], v1
    v_smfmac_f32_16x16x64_bf16 v[40:43], v[16:19], v[168:175], v1
    v_smfmac_f32_16x16x64_bf16 v[40:43], v[20:23], v[176:183], v1
    v_smfmac_f32_16x16x64_bf16 v[40:43], v[24:27], v[184:191], v1
    s_cmp_eq_u32 s30, 6
    s_cbranch_scc0 L_skip_116
    s_mul_i32 s57, s14, 12
    s_add_u32 s58, s57, s15
    s_mov_b32 m0, 55296
L_dma_117:
    s_nop 0
    buffer_load_dwordx4 v3, s[48:51], s57 offen offset:0 nt lds
    buffer_load_dwordx4 v3, s[48:51], s58 offen offset:1024 nt lds
    s_add_u32 s57, s57, s14
    s_add_u32 s58, s58, s14
    s_add_u32 m0, m0, 2048
    s_cmp_lg_u32 m0, 67584
    s_cbranch_scc1 L_dma_117
    s_mul_i32 s57, s14, 18
    s_add_u32 s58, s57, s15
    s_mov_b32 m0, 67584
L_dma_118:
    s_nop 0
    buffer_load_dwordx4 v3, s[48:51], s57 offen offset:0 nt lds
    buffer_load_dwordx4 v3, s[48:51], s58 offen offset:1024 nt lds
    s_add_u32 s57, s57, s14
    s_add_u32 s58, s58, s14
    s_add_u32 m0, m0, 2048
    s_cmp_lg_u32 m0, 79872
    s_cbranch_scc1 L_dma_118
L_skip_116:
    s_waitcnt vmcnt(40)
    s_barrier
    ds_read_b64_tr_b16 v[198:199], v8 offset:32768
    ds_read_b64_tr_b16 v[206:207], v9 offset:32768
    ds_read_b64_tr_b16 v[214:215], v10 offset:32768
    ds_read_b64_tr_b16 v[222:223], v11 offset:32768
    s_waitcnt lgkmcnt(0)
    s_cmp_lt_u32 s3, 20
    s_cbranch_scc0 L_skip_119
    s_cmp_eq_u32 s30, 6
    s_cbranch_scc0 L_skip_119
    v_add_u32 v62, 158720, v57
    ds_read_b128 v[52:55], v62
L_skip_119:
L_pad1:
    s_cbranch_execz L_pad5
    v_smfmac_f32_16x16x64_bf16 v[40:43], v[28:31], v[192:199], v1
    v_smfmac_f32_16x16x64_bf16 v[40:43], v[32:35], v[200:207], v1
    v_smfmac_f32_16x16x64_bf16 v[44:47], v[12:15], v[208:215], v1
    v_smfmac_f32_16x16x64_bf16 v[44:47], v[16:19], v[216:223], v1
    v_mul_f32 v38, v38, v39
    ds_write_b32 v63, v38 offset:1024
    s_waitcnt vmcnt(24)
    s_barrier
    ds_read_b64_tr_b16 v[230:231], v8 offset:49152
    ds_read_b64_tr_b16 v[238:239], v9 offset:49152
    ds_read_b64_tr_b16 v[246:247], v10 offset:49152
    ds_read_b64_tr_b16 v[254:255], v11 offset:49152
    s_waitcnt lgkmcnt(0)
    v_smfmac_f32_16x16x64_bf16 v[44:47], v[20:23], v[224:231], v1
    v_smfmac_f32_16x16x64_bf16 v[44:47], v[24:27], v[232:239], v1
    v_smfmac_f32_16x16x64_bf16 v[44:47], v[28:31], v[240:247], v1
    v_smfmac_f32_16x16x64_bf16 v[44:47], v[32:35], v[248:255], v1
    s_setprio 0
    s_cmp_lt_u32 s30, 2
    v_pk_add_f32 v[40:41], v[40:41], v[42:43]
    s_nop 4
    v_pk_add_f32 v[42:43], v[44:45], v[46:47]
    v_pk_mul_f32 v[40:41], v[40:41], v[38:39] op_sel:[0,1] op_sel_hi:[1,1]
    v_pk_mul_f32 v[42:43], v[42:43], v[38:39] op_sel:[0,1] op_sel_hi:[1,1]
    ds_write_b128 v63, v[40:43]
    s_cbranch_scc1 L_comb_0
    s_waitcnt lgkmcnt(0)
    s_barrier
L_comb_0b:
    s_cmp_eq_u32 s30, 6
    s_cbranch_scc0 L_skip_124
    s_waitcnt vmcnt(0)
L_skip_124:
    s_barrier
    s_cmp_lt_u32 s3, 20
    s_cbranch_scc0 L_typeB_0
    buffer_load_dwordx4 v[12:15], v57, s[40:43], s74 offen sc1
    buffer_load_dwordx2 v[16:17], v58, s[40:43], s74 offen offset:1024 sc1
    buffer_load_dword v18, v56, s[40:43], s74 offen offset:1568 sc1
    ds_read_b64_tr_b16 v[28:29], v59 offset:0
    ds_read_b64_tr_b16 v[30:31], v59 offset:1024
    ds_read_b64_tr_b16 v[32:33], v59 offset:2048
    ds_read_b64_tr_b16 v[34:35], v59 offset:3072
    ds_read_b64_tr_b16 v[36:37], v59 offset:4096
    ds_read_b64_tr_b16 v[38:39], v59 offset:5120
    ds_read_b64_tr_b16 v[40:41], v60 offset:0
    ds_read_b64_tr_b16 v[42:43], v60 offset:1024
    ds_read_b64_tr_b16 v[44:45], v60 offset:2048
    ds_read_b64_tr_b16 v[46:47], v60 offset:3072
    ds_read_b64_tr_b16 v[48:49], v60 offset:4096
    ds_read_b64_tr_b16 v[50:51], v60 offset:5120
    v_mov_b64 v[20:21], 0
    v_mov_b64 v[22:23], 0
    v_mov_b64 v[24:25], 0
    v_mov_b64 v[26:27], 0
    s_add_u32 s58, s6, 0
    s_waitcnt lgkmcnt(0)
    s_branch L_ow_125
    s_nop 0
    s_nop 0
    s_nop 0
    s_nop 0
    s_nop 0
    s_nop 0
L_or_126:
    buffer_load_dwordx4 v[12:15], v57, s[40:43], s74 offen sc1
    buffer_load_dwordx2 v[16:17], v58, s[40:43], s74 offen offset:1024 sc1
    buffer_load_dword v18, v56, s[40:43], s74 offen offset:1568 sc1
    s_sub_u32 s56, s56, 1
    s_cbranch_scc1 L_done
    v_mov_b64 v[20:21], 0
    v_mov_b64 v[22:23], 0
    v_mov_b64 v[24:25], 0
    v_mov_b64 v[26:27], 0
L_ow_125:
    s_waitcnt vmcnt(2)
    v_smfmac_f32_16x16x64_bf16 v[20:23], v[12:15], v[28:35], v1
    v_max3_u32 v19, v12, v13, v14
    v_smfmac_f32_16x16x64_bf16 v[24:27], v[12:15], v[40:47], v1
    s_waitcnt vmcnt(0)
    v_mul_f32 v53, v52, v18
    v_smfmac_f32_16x16x32_bf16 v[20:23], v[16:17], v[36:39], v1
    v_max3_u32 v62, v15, v16, v17
    v_smfmac_f32_16x16x32_bf16 v[24:27], v[16:17], v[48:51], v1
    v_max3_u32 v19, v19, v62, v18
    v_add_f32_dpp v53, v53, v53 row_ror:4 row_mask:0xf bank_mask:0xf
    v_cmp_eq_u32 vcc, -1, v19
L_pad2:
    s_cbranch_execz L_pad6
    s_cmp_eq_u32 s30, 2
    v_add_f32_dpp v53, v53, v53 row_ror:2 row_mask:0xf bank_mask:0xf
    s_cbranch_vccnz L_or_126
    s_nop 0
    v_add_f32_dpp v53, v53, v53 row_ror:1 row_mask:0xf bank_mask:0xf
    v_rcp_f32 v52, v53
    v_pk_add_f32 v[20:21], v[20:21], v[22:23]
    v_pk_add_f32 v[24:25], v[24:25], v[26:27]
    v_pk_mul_f32 v[54:55], v[54:55], v[52:53] op_sel:[0,0] op_sel_hi:[1,0]
    v_mul_f32 v20, v20, v54
    v_mul_f32 v24, v24, v54
    v_fmac_f32 v20, v21, v55
    v_fmac_f32 v24, v25, v55
    s_nop 1
    v_permlane32_swap_b32 v20, v24
    v_add_f32 v20, v20, v24
    ds_write_b32 v61, v20
    s_waitcnt lgkmcnt(0)
    s_barrier
    s_cbranch_scc0 L_finb_127
    ds_read2st64_b32 v[12:13], v2 offset0:0 offset1:1
    ds_read2st64_b32 v[14:15], v2 offset0:2 offset1:3
    ds_read2st64_b32 v[16:17], v2 offset0:4 offset1:5
    ds_read2st64_b32 v[18:19], v2 offset0:6 offset1:7
    s_waitcnt lgkmcnt(2)
    v_pk_add_f32 v[12:13], v[12:13], v[14:15]
    s_waitcnt lgkmcnt(0)
    v_pk_add_f32 v[16:17], v[16:17], v[18:19]
    v_pk_add_f32 v[12:13], v[12:13], v[16:17]
    v_add_f32 v14, v12, v13
    v_add_f32 v15, v12, v13
    s_nop 1
    v_permlane16_swap_b32 v14, v15
    v_add_f32 v12, v14, v15
    buffer_store_dword v12, v3, s[40:43], s58 offen sc1
L_finb_127:
    s_sub_u32 s57, s30, 4
    s_cmp_lt_u32 s57, 3
    s_cbranch_scc0 L_skip_128
    s_sub_u32 s60, s30, 4
    s_lshl_b32 s57, s60, 11
    v_lshlrev_b32 v11, 4, v0
    v_add_u32 v11, s57, v11
    s_add_u32 s65, s62, 19456
    buffer_load_dwordx4 v[52:55], v11, s[40:43], s65 offen offset:0 sc1
    buffer_load_dwordx4 v[56:59], v11, s[40:43], s65 offen offset:1024 sc1
    s_lshl_b32 s59, s60, 12
    s_add_u32 s59, s59, 79872
    s_mov_b32 s44, s20
    s_mov_b32 s45, s21
    s_mov_b32 s46, 1966080
    s_mov_b32 s47, 0x20000
    s_mul_i32 s57, s31, 3
    s_add_u32 s57, s57, s60
    s_mul_i32 s57, s57, 81920
    s_lshl_b32 s64, s3, 6
    s_add_u32 s57, s57, s64
    v_lshrrev_b32 v5, 2, v0
    v_mul_u32_u24 v5, 1280, v5
    v_and_b32 v60, 3, v0
    v_lshl_add_u32 v5, v60, 4, v5
    v_add_u32 v5, s57, v5
    s_add_u32 m0, s59, 0
    s_mov_b32 s57, 0
    buffer_load_dwordx4 v5, s[44:47], s57 offen nt lds
    s_add_u32 m0, s59, 1024
    s_mov_b32 s57, 20480
    buffer_load_dwordx4 v5, s[44:47], s57 offen nt lds
    s_add_u32 m0, s59, 2048
    s_mov_b32 s57, 40960
    buffer_load_dwordx4 v5, s[44:47], s57 offen nt lds
    s_add_u32 m0, s59, 3072
    s_mov_b32 s57, 61440
    buffer_load_dwordx4 v5, s[44:47], s57 offen nt lds
    v_bfe_u32 v35, v0, 4, 1
    v_lshlrev_b32 v35, 11, v35
    v_bfe_u32 v60, v0, 2, 2
    v_lshl_add_u32 v35, v60, 8, v35
    v_lshrrev_b32 v60, 5, v0
    v_lshl_add_u32 v35, v60, 6, v35
    v_and_b32 v60, 3, v0
    v_lshl_add_u32 v35, v60, 3, v35
    v_add_u32 v35, s59, v35
    v_mov_b32 v9, 0xbdd2d3e8
    v_mov_b32 v10, 0xc0135761
    s_lshl_b32 s57, s60, 7
    s_add_u32 s57, s57, 159872
L_pad3:
    s_cbranch_execz L_pad7
    v_lshlrev_b32 v32, 3, v0
    v_add_u32 v32, s57, v32
    v_lshlrev_b32 v33, 3, v0
    v_add_u32 v33, 129024, v33
    v_cmp_gt_u32 vcc, 16, v0
    s_nop 1
    v_cndmask_b32 v32, v33, v32, vcc
    v_and_b32 v33, 15, v0
    v_lshlrev_b32 v33, 3, v33
    v_lshrrev_b32 v60, 5, v0
    v_lshl_add_u32 v33, v60, 2, v33
    v_add_u32 v33, 159872, v33
    v_and_b32 v34, 15, v0
    v_lshlrev_b32 v34, 2, v34
    v_lshrrev_b32 v60, 5, v0
    v_lshl_add_u32 v34, v60, 6, v34
    v_bfe_u32 v60, v0, 4, 1
    v_lshl_add_u32 v34, v60, 13, v34
    s_add_u32 s60, s6, 66048
    s_add_u32 s58, s62, 13312
    s_add_u32 s57, s62, 25856
    v_and_b32 v7, 7, v0
    v_lshlrev_b32 v7, 3, v7
    v_mov_b32 v60, 0x3acccccd
    v_mov_b32 v61, 0x3727c5ac
    s_waitcnt vmcnt(0)
    buffer_load_dwordx2 v[24:25], v7, s[40:43], s57 offen sc1
    buffer_load_dwordx4 v[12:15], v11, s[40:43], s58 offen offset:0 sc1
    buffer_load_dwordx4 v[16:19], v11, s[40:43], s58 offen offset:1024 sc1
    ds_read_b64_tr_b16 v[36:37], v35 offset:0
    ds_read_b64_tr_b16 v[38:39], v35 offset:1024
    ds_read_b64_tr_b16 v[40:41], v35 offset:128
    ds_read_b64_tr_b16 v[42:43], v35 offset:1152
    ds_read_b64_tr_b16 v[44:45], v35 offset:32
    ds_read_b64_tr_b16 v[46:47], v35 offset:1056
    ds_read_b64_tr_b16 v[48:49], v35 offset:160
    ds_read_b64_tr_b16 v[50:51], v35 offset:1184
L_sw_131:
    v_max3_u32 v20, v52, v53, v54
    v_max3_u32 v20, v20, v55, v56
    v_max3_u32 v20, v20, v57, v58
    v_max_u32 v20, v20, v59
    v_cmp_eq_u32 vcc, -1, v20
    s_cbranch_vccnz L_sr_132
    v_pk_add_f32 v[28:29], v[52:53], v[56:57]
    v_pk_add_f32 v[30:31], v[54:55], v[58:59]
    s_nop 1
    v_permlane32_swap_b32 v28, v30
    v_permlane32_swap_b32 v29, v31
    v_pk_add_f32 v[28:29], v[28:29], v[30:31]
    s_nop 1
    v_permlane16_swap_b32 v28, v29
    v_add_f32 v28, v28, v29
    v_mov_b64 v[52:53], 0
    v_mov_b64 v[54:55], 0
    v_mov_b64 v[56:57], 0
    v_mov_b64 v[58:59], 0
    s_waitcnt lgkmcnt(0)
L_pr_130:
    buffer_load_dwordx2 v[24:25], v7, s[40:43], s57 offen sc1
    buffer_load_dwordx4 v[12:15], v11, s[40:43], s58 offen offset:0 sc1
    buffer_load_dwordx4 v[16:19], v11, s[40:43], s58 offen offset:1024 sc1
    s_sub_u32 s56, s56, 1
    s_cbranch_scc1 L_done
L_pw_129:
    s_waitcnt vmcnt(3)
    v_max_u32 v20, v24, v25
    v_cmp_eq_u32 vcc, -1, v20
    s_cbranch_vccnz L_pr_130
    buffer_load_dwordx4 v[12:15], v11, s[40:43], s58 offen offset:0 sc1
    buffer_load_dwordx4 v[16:19], v11, s[40:43], s58 offen offset:1024 sc1
    v_add_f32_dpp v2, v24, v24 row_ror:4 row_mask:0xf bank_mask:0xf
    v_add_f32_dpp v3, v25, v25 row_ror:4 row_mask:0xf bank_mask:0xf
    v_pk_add_f32 v[20:21], v[12:13], v[16:17]
    v_pk_add_f32 v[22:23], v[14:15], v[18:19]
    v_add_f32_dpp v2, v2, v2 row_ror:2 row_mask:0xf bank_mask:0xf
    v_add_f32_dpp v3, v3, v3 row_ror:2 row_mask:0xf bank_mask:0xf
    v_permlane32_swap_b32 v20, v22
    v_permlane32_swap_b32 v21, v23
    v_add_f32_dpp v2, v2, v2 row_ror:1 row_mask:0xf bank_mask:0xf
    v_add_f32_dpp v3, v3, v3 row_ror:1 row_mask:0xf bank_mask:0xf
    v_pk_add_f32 v[20:21], v[20:21], v[22:23]
    v_mul_f32 v2, v2, v60
    v_fma_f32 v3, v3, v60, v61
    v_permlane16_swap_b32 v20, v21
    v_fma_f32 v3, -v2, v2, v3
L_pad4:
    s_cbranch_execz L_pad8
    v_add_f32 v20, v20, v21
    v_max_f32 v3, v3, v61
    v_mul_f32 v26, v28, v2
    v_rsq_f32 v3, v3
    v_cmp_u_f32 vcc, v20, v20
    v_sub_f32 v20, v20, v26
    s_cbranch_vccnz L_hr_133
L_hk_134:
    v_fma_f32 v20, v20, v3, v4
    v_mul_f32 v21, v20, v20
    v_fma_f32 v21, v21, v9, v10
    v_mul_f32 v21, v21, v20
    v_exp_f32 v21, v21
    s_nop 0
    v_add_f32 v21, 1.0, v21
    v_rcp_f32 v21, v21
    s_nop 0
    v_mul_f32 v20, v20, v21
    s_nop 1
    v_mov_b32_dpp v21, v20 row_shl:1 row_mask:0xf bank_mask:0xf bound_ctrl:0
    v_cvt_pk_bf16_f32 v28, v20, v21
    s_nop 1
    v_mov_b32_dpp v29, v28 row_shl:4 row_mask:0xf bank_mask:0xf bound_ctrl:0
    v_mov_b32_dpp v30, v28 row_shl:8 row_mask:0xf bank_mask:0xf bound_ctrl:0
    v_mov_b32_dpp v31, v28 row_shl:12 row_mask:0xf bank_mask:0xf bound_ctrl:0
    s_nop 1
    v_smfmac_f32_16x16x64_bf16 v[52:55], v[28:31], v[36:43], v1
    v_smfmac_f32_16x16x64_bf16 v[56:59], v[28:31], v[44:51], v1
    s_cmp_eq_u32 s30, 4
    s_nop 5
    v_add_f32 v22, v52, v54
    v_add_f32 v23, v56, v58
    ds_write_b64 v32, v[22:23]
    s_cbranch_scc0 L_skip_136
L_xw_137:
    ds_read2_b32 v[20:21], v33 offset0:0 offset1:32
    ds_read_b32 v22, v33 offset:256
    s_sub_u32 s56, s56, 1
    s_cbranch_scc1 L_done
    s_waitcnt lgkmcnt(0)
    v_max3_u32 v23, v20, v21, v22
    v_add_f32 v20, v20, v21
    v_cmp_eq_u32 vcc, -1, v23
    v_add_f32 v20, v20, v22
    s_cbranch_vccnz L_xw_137
    buffer_store_dword v20, v34, s[40:43], s60 offen sc1
    s_waitcnt vmcnt(1)
    s_branch L_pe_138
    s_nop 0
    s_nop 0
    s_nop 0
L_skip_136:
    s_waitcnt vmcnt(0)
L_pe_138:
L_skip_128:
    s_branch L_p1
    s_nop 0
    s_nop 0
    s_nop 0
    s_nop 0
    s_nop 0
    s_nop 0
L_typeB_0:
    s_cmp_eq_u32 s53, 3
    s_cbranch_scc0 L_typeC_139
    s_cmp_eq_u32 s30, 7
    s_cbranch_scc1 L_w7_149
    s_cmp_lt_u32 s30, 6
    s_cbranch_scc0 L_skip_151
    s_lshr_b32 s57, s30, 1
    s_mul_i32 s57, s57, 128
    s_and_b32 s58, s30, 1
    s_lshl_b32 s58, s58, 6
    s_add_u32 s57, s57, s58
    v_lshrrev_b32 v18, 5, v0
    v_lshlrev_b32 v18, 13, v18
    v_bfe_u32 v60, v0, 3, 1
    v_lshl_add_u32 v18, v60, 12, v18
    v_bfe_u32 v60, v0, 4, 1
    v_lshl_add_u32 v18, v60, 11, v18
    v_bfe_u32 v60, v0, 2, 1
    v_mul_u32_u24 v60, 384, v60
    v_add_u32 v18, v60, v18
    v_and_b32 v60, 3, v0
    v_lshl_add_u32 v18, v60, 3, v18
    v_add_u32 v18, s57, v18
    v_add_u32 v18, 30720, v18
    v_bfe_u32 v19, v0, 4, 1
    v_lshlrev_b32 v19, 12, v19
    v_bfe_u32 v60, v0, 3, 1
    v_lshl_add_u32 v19, v60, 11, v19
    v_bfe_u32 v60, v0, 2, 1
    v_mul_u32_u24 v60, 384, v60
    v_add_u32 v19, v60, v19
    v_and_b32 v60, 3, v0
    v_lshl_add_u32 v19, v60, 3, v19
    v_add_u32 v19, s57, v19
    v_add_u32 v19, 63488, v19
    ds_read_b64_tr_b16 v[28:29], v18 offset:0
    ds_read_b64_tr_b16 v[30:31], v18 offset:1024
    ds_read_b64_tr_b16 v[32:33], v18 offset:16384
L_pad5:
    s_cbranch_execz L_pad9
    ds_read_b64_tr_b16 v[34:35], v18 offset:17408
    ds_read_b64_tr_b16 v[36:37], v19 offset:0
    ds_read_b64_tr_b16 v[38:39], v19 offset:1024
    ds_read_b64_tr_b16 v[40:41], v18 offset:32
    ds_read_b64_tr_b16 v[42:43], v18 offset:1056
    ds_read_b64_tr_b16 v[44:45], v18 offset:16416
    ds_read_b64_tr_b16 v[46:47], v18 offset:17440
    ds_read_b64_tr_b16 v[48:49], v19 offset:32
    ds_read_b64_tr_b16 v[50:51], v19 offset:1056
    v_lshrrev_b32 v9, 4, v0
    v_lshlrev_b32 v9, 5, v9
    v_bfe_u32 v60, v0, 1, 1
    v_lshl_add_u32 v9, v60, 4, v9
    v_and_b32 v60, 1, v0
    v_mul_u32_u24 v60, 192, v60
    v_add_u32 v9, v60, v9
    v_add_u32 v9, 160832, v9
    v_lshrrev_b32 v10, 4, v0
    v_lshlrev_b32 v10, 4, v10
    v_bfe_u32 v60, v0, 1, 1
    v_lshl_add_u32 v10, v60, 3, v10
    v_and_b32 v60, 1, v0
    v_mul_u32_u24 v60, 192, v60
    v_add_u32 v10, v60, v10
    v_add_u32 v10, 160960, v10
    v_mov_b64 v[20:21], 0
    v_mov_b64 v[22:23], 0
    v_mov_b64 v[24:25], 0
    v_mov_b64 v[26:27], 0
    s_lshr_b32 s57, s30, 1
    s_lshl_b32 s57, s57, 11
    s_lshl_b32 s58, s58, 1
    s_add_u32 s57, s57, s58
    s_lshl_b32 s58, s54, 8
    s_add_u32 s57, s57, s58
    v_and_b32 v11, 31, v0
    v_lshlrev_b32 v11, 2, v11
    v_lshrrev_b32 v60, 5, v0
    v_lshl_add_u32 v11, v60, 30, v11
    v_add_u32 v11, s57, v11
    s_add_u32 s59, s62, 13312
    s_add_u32 s60, s62, 25856
    ds_read_b128 v[12:15], v9
    ds_read_b64 v[16:17], v10
    s_waitcnt lgkmcnt(1)
    v_smfmac_f32_16x16x64_bf16 v[20:23], v[12:15], v[28:35], v1
    v_smfmac_f32_16x16x64_bf16 v[24:27], v[12:15], v[40:47], v1
    s_waitcnt lgkmcnt(0)
    v_smfmac_f32_16x16x32_bf16 v[20:23], v[16:17], v[36:39], v1
    v_smfmac_f32_16x16x32_bf16 v[24:27], v[16:17], v[48:51], v1
    s_add_u32 s60, s62, 19456
    s_cmp_eq_u32 s55, 0
    s_nop 4
    v_add_f32 v12, v21, v23
    s_nop 1
    v_add_f32_dpp v12, v25, v27 quad_perm:[0,1,2,3] row_mask:0x2 bank_mask:0xf
    s_cbranch_scc1 L_gs_152
    buffer_store_dword v12, v11, s[40:43], s60 offen
L_gb_153:
    v_mov_b64 v[20:21], 0
    v_mov_b64 v[22:23], 0
    v_mov_b64 v[24:25], 0
    v_mov_b64 v[26:27], 0
L_skip_151:
    s_cmp_lt_u32 s30, 6
    s_barrier
    s_cbranch_scc0 L_se_150
    ds_read_b128 v[12:15], v9
    ds_read_b64 v[16:17], v10
    s_waitcnt lgkmcnt(1)
    v_smfmac_f32_16x16x64_bf16 v[20:23], v[12:15], v[28:35], v1
    v_smfmac_f32_16x16x64_bf16 v[24:27], v[12:15], v[40:47], v1
    s_waitcnt lgkmcnt(0)
    v_smfmac_f32_16x16x32_bf16 v[20:23], v[16:17], v[36:39], v1
    v_smfmac_f32_16x16x32_bf16 v[24:27], v[16:17], v[48:51], v1
    s_cmp_eq_u32 s55, 0
    s_nop 5
    v_add_f32 v12, v20, v22
    s_nop 1
    v_add_f32_dpp v12, v24, v26 quad_perm:[0,1,2,3] row_mask:0x2 bank_mask:0xf
    s_cbranch_scc1 L_gs_154
    buffer_store_dword v12, v11, s[40:43], s59 offen
L_gb_155:
L_se_150:
L_p1:
    s_lshl_b32 s57, s30, 7
    s_add_u32 s57, s57, 158720
    v_lshrrev_b32 v58, 4, v0
    v_lshlrev_b32 v58, 5, v58
    v_bfe_u32 v60, v0, 1, 1
    v_lshl_add_u32 v58, v60, 4, v58
L_pad6:
    s_cbranch_execz L_pad10
    v_bfe_u32 v60, v0, 2, 2
    v_lshl_add_u32 v58, v60, 2, v58
    v_and_b32 v60, 1, v0
    v_lshl_add_u32 v58, v60, 1, v58
    v_add_u32 v58, s57, v58
    v_lshrrev_b32 v61, 4, v0
    v_lshlrev_b32 v61, 5, v61
    v_bfe_u32 v60, v0, 1, 1
    v_lshl_add_u32 v61, v60, 4, v61
    v_add_u32 v61, s57, v61
    v_bfe_u32 v62, v0, 2, 2
    v_lshlrev_b32 v62, 1, v62
    v_and_b32 v60, 1, v0
    v_lshl_add_u32 v62, v60, 0, v62
    v_mov_b32 v60, 160992
    v_cmp_eq_u32 vcc, 0, v62
    s_nop 1
    v_cndmask_b32 v52, v60, v61, vcc
    v_cmp_eq_u32 vcc, 1, v62
    s_nop 1
    v_cndmask_b32 v53, v60, v61, vcc
    v_cmp_eq_u32 vcc, 2, v62
    s_nop 1
    v_cndmask_b32 v54, v60, v61, vcc
    v_cmp_eq_u32 vcc, 3, v62
    s_nop 1
    v_cndmask_b32 v55, v60, v61, vcc
    v_cmp_eq_u32 vcc, 4, v62
    s_nop 1
    v_cndmask_b32 v56, v60, v61, vcc
    v_cmp_eq_u32 vcc, 5, v62
    s_nop 1
    v_cndmask_b32 v57, v60, v61, vcc
    s_lshl_b32 s58, s30, 2
    s_add_u32 s58, s58, 159808
    v_mov_b32 v60, s58
    v_lshlrev_b32 v59, 2, v0
    v_add_u32 v59, 158208, v59
    v_cmp_eq_u32 vcc, 63, v0
    s_nop 1
    v_cndmask_b32 v59, v59, v60, vcc
    v_and_b32 v62, 7, v0
    v_lshlrev_b32 v62, 2, v62
    v_add_u32 v62, 159808, v62
    s_lshl_b32 s57, s30, 11
    v_lshlrev_b32 v63, 4, v0
    v_add_u32 v63, s57, v63
    v_add_u32 v63, 92160, v63
    s_sub_u32 s57, s30, 1
    s_lshl_b32 s58, s57, 11
    v_lshlrev_b32 v7, 4, v0
    v_add_u32 v7, s58, v7
    s_lshl_b32 s58, s57, 7
    v_bfe_u32 v8, v0, 2, 2
    v_lshlrev_b32 v8, 5, v8
    v_lshrrev_b32 v60, 5, v0
    v_lshl_add_u32 v8, v60, 4, v8
    v_and_b32 v60, 3, v0
    v_lshl_add_u32 v8, v60, 2, v8
    v_bfe_u32 v60, v0, 4, 1
    v_lshl_add_u32 v8, v60, 1, v8
    v_add_u32 v8, s58, v8
    v_add_u32 v8, 124928, v8
    s_cmp_eq_u32 s30, 7
    s_cbranch_scc1 L_w7_163
    s_cmp_lt_u32 s30, 6
    s_cbranch_scc0 L_skip_165
    s_lshr_b32 s57, s30, 1
    s_mul_i32 s57, s57, 1024
    s_and_b32 s58, s30, 1
    s_lshl_b32 s58, s58, 6
    s_add_u32 s57, s57, s58
    v_lshrrev_b32 v18, 5, v0
    v_mul_u32_u24 v18, 6144, v18
    v_bfe_u32 v60, v0, 3, 1
    v_mul_u32_u24 v60, 3072, v60
    v_add_u32 v18, v60, v18
    v_bfe_u32 v60, v0, 4, 1
    v_lshl_add_u32 v18, v60, 9, v18
    v_bfe_u32 v60, v0, 2, 1
    v_lshl_add_u32 v18, v60, 7, v18
    v_and_b32 v60, 3, v0
    v_lshl_add_u32 v18, v60, 3, v18
    v_add_u32 v18, s57, v18
    v_bfe_u32 v19, v0, 4, 1
    v_mul_u32_u24 v19, 3072, v19
    v_bfe_u32 v60, v0, 3, 1
    v_lshl_add_u32 v19, v60, 9, v19
    v_bfe_u32 v60, v0, 2, 1
    v_lshl_add_u32 v19, v60, 7, v19
    v_and_b32 v60, 3, v0
    v_lshl_add_u32 v19, v60, 3, v19
    v_add_u32 v19, s57, v19
L_pad7:
    s_cbranch_execz L_pad11
    v_add_u32 v19, 24576, v19
    ds_read_b64_tr_b16 v[28:29], v18 offset:0
    ds_read_b64_tr_b16 v[30:31], v18 offset:256
    ds_read_b64_tr_b16 v[32:33], v18 offset:12288
    ds_read_b64_tr_b16 v[34:35], v18 offset:12544
    ds_read_b64_tr_b16 v[36:37], v19 offset:0
    ds_read_b64_tr_b16 v[38:39], v19 offset:256
    ds_read_b64_tr_b16 v[40:41], v18 offset:32
    ds_read_b64_tr_b16 v[42:43], v18 offset:288
    ds_read_b64_tr_b16 v[44:45], v18 offset:12320
    ds_read_b64_tr_b16 v[46:47], v18 offset:12576
    ds_read_b64_tr_b16 v[48:49], v19 offset:32
    ds_read_b64_tr_b16 v[50:51], v19 offset:288
    v_lshrrev_b32 v9, 4, v0
    v_lshlrev_b32 v9, 5, v9
    v_bfe_u32 v60, v0, 1, 1
    v_lshl_add_u32 v9, v60, 4, v9
    v_and_b32 v60, 1, v0
    v_mul_u32_u24 v60, 192, v60
    v_add_u32 v9, v60, v9
    v_add_u32 v9, 160832, v9
    v_lshrrev_b32 v10, 4, v0
    v_lshlrev_b32 v10, 4, v10
    v_bfe_u32 v60, v0, 1, 1
    v_lshl_add_u32 v10, v60, 3, v10
    v_and_b32 v60, 1, v0
    v_mul_u32_u24 v60, 192, v60
    v_add_u32 v10, v60, v10
    v_add_u32 v10, 160960, v10
    v_mov_b64 v[20:21], 0
    v_mov_b64 v[22:23], 0
    v_mov_b64 v[24:25], 0
    v_mov_b64 v[26:27], 0
    s_lshr_b32 s57, s30, 1
    s_lshl_b32 s57, s57, 11
    s_lshl_b32 s58, s58, 1
    s_add_u32 s57, s57, s58
    s_lshl_b32 s58, s54, 8
    s_add_u32 s57, s57, s58
    v_and_b32 v11, 31, v0
    v_lshlrev_b32 v11, 2, v11
    v_lshrrev_b32 v60, 5, v0
    v_lshl_add_u32 v11, v60, 30, v11
    v_add_u32 v11, s57, v11
    s_mul_i32 s59, s53, 6144
    s_add_u32 s59, s59, s62
    s_add_u32 s59, s59, 46080
    s_lshl_b32 s60, s53, 6
    s_add_u32 s60, s60, s62
    s_add_u32 s60, s60, 25600
L_skip_165:
    s_cmp_lt_u32 s30, 6
    s_barrier
    s_cbranch_scc0 L_se_164
    ds_read_b128 v[12:15], v9
    ds_read_b64 v[16:17], v10
    s_waitcnt lgkmcnt(1)
    v_smfmac_f32_16x16x64_bf16 v[20:23], v[12:15], v[28:35], v1
    v_smfmac_f32_16x16x64_bf16 v[24:27], v[12:15], v[40:47], v1
    s_waitcnt lgkmcnt(0)
    v_smfmac_f32_16x16x32_bf16 v[20:23], v[16:17], v[36:39], v1
    v_smfmac_f32_16x16x32_bf16 v[24:27], v[16:17], v[48:51], v1
    s_cmp_eq_u32 s55, 0
    s_nop 5
    v_add_f32 v12, v20, v22
    s_nop 1
    v_add_f32_dpp v12, v24, v26 quad_perm:[0,1,2,3] row_mask:0x2 bank_mask:0xf
    s_cbranch_scc1 L_gs_166
    buffer_store_dword v12, v11, s[40:43], s59 offen
L_gb_167:
L_se_164:
    s_sub_u32 s57, s30, 1
    s_cmp_lt_u32 s57, 3
    s_cbranch_scc0 L_qo_181
    v_and_b32 v9, 7, v0
    v_lshlrev_b32 v9, 3, v9
    buffer_load_dwordx2 v[10:11], v9, s[40:43], s60 offen sc1
    buffer_load_dwordx4 v[12:15], v7, s[40:43], s59 offen offset:0 sc1
    buffer_load_dwordx4 v[16:19], v7, s[40:43], s59 offen offset:1024 sc1
    v_mov_b64 v[24:25], 0
    v_mov_b64 v[26:27], 0
    v_mov_b64 v[28:29], 0
    v_mov_b64 v[30:31], 0
    v_mov_b64 v[32:33], 0
    v_mov_b64 v[34:35], 0
    v_mov_b64 v[36:37], 0
    v_mov_b64 v[38:39], 0
    v_mov_b64 v[40:41], 0
    v_mov_b64 v[42:43], 0
    v_mov_b64 v[44:45], 0
    v_mov_b64 v[46:47], 0
    v_lshrrev_b32 v5, 4, v0
    v_lshlrev_b32 v5, 5, v5
    v_bfe_u32 v60, v0, 1, 1
L_pad8:
    s_cbranch_execz L_pad12
    v_lshl_add_u32 v5, v60, 4, v5
    v_add_u32 v5, 124928, v5
    v_mov_b32 v60, 0x3c75e03e
    v_mov_b32 v61, 0x3a71d1e6
    v_mov_b32 v51, 0x3e13985d
    s_branch L_pw_183
    s_nop 0
    s_nop 0
    s_nop 0
L_pr_184:
    buffer_load_dwordx2 v[10:11], v9, s[40:43], s60 offen sc1
    buffer_load_dwordx4 v[12:15], v7, s[40:43], s59 offen offset:0 sc1
    buffer_load_dwordx4 v[16:19], v7, s[40:43], s59 offen offset:1024 sc1
    s_sub_u32 s56, s56, 1
    s_cbranch_scc1 L_done
L_pw_183:
    s_waitcnt vmcnt(0)
    v_max_u32 v20, v10, v11
    v_cmp_eq_u32 vcc, -1, v20
    s_cbranch_vccnz L_pr_184
    v_add_f32_dpp v48, v10, v10 row_ror:4 row_mask:0xf bank_mask:0xf
    v_add_f32_dpp v49, v11, v11 row_ror:4 row_mask:0xf bank_mask:0xf
    v_pk_add_f32 v[20:21], v[12:13], v[16:17]
    v_pk_add_f32 v[22:23], v[14:15], v[18:19]
    v_add_f32_dpp v48, v48, v48 row_ror:2 row_mask:0xf bank_mask:0xf
    v_add_f32_dpp v49, v49, v49 row_ror:2 row_mask:0xf bank_mask:0xf
    v_permlane32_swap_b32 v20, v22
    v_permlane32_swap_b32 v21, v23
    v_add_f32_dpp v48, v48, v48 row_ror:1 row_mask:0xf bank_mask:0xf
    v_add_f32_dpp v49, v49, v49 row_ror:1 row_mask:0xf bank_mask:0xf
    v_pk_add_f32 v[20:21], v[20:21], v[22:23]
    v_mul_f32 v48, v48, v60
    v_fma_f32 v49, v49, v51, v61
    v_permlane16_swap_b32 v20, v21
    v_fma_f32 v49, -v48, v48, v49
    v_add_f32 v20, v20, v21
    v_max_f32 v49, v49, v61
    v_mul_f32 v50, v6, v48
    v_rsq_f32 v49, v49
    v_cmp_u_f32 vcc, v20, v20
    v_sub_f32 v20, v20, v50
    s_cbranch_vccnz L_hr_185
L_hk_186:
    v_mul_f32 v20, v20, v49
    v_cvt_pk_bf16_f32 v20, v20, v20
    ds_write_b16 v8, v20
L_qb_182:
    s_waitcnt lgkmcnt(0)
    s_barrier
    ds_read_b128 v[12:15], v5 offset:0
    ds_read_b128 v[16:19], v5 offset:128
    ds_read_b128 v[20:23], v5 offset:256
    s_cmp_lt_u32 s30, 4
    s_waitcnt lgkmcnt(0)
    v_smfmac_f32_16x16x64_bf16 v[24:27], v[12:15], v[64:71], v1
    v_smfmac_f32_16x16x64_bf16 v[24:27], v[16:19], v[72:79], v1
    v_smfmac_f32_16x16x64_bf16 v[24:27], v[20:23], v[80:87], v1
    v_smfmac_f32_16x16x64_bf16 v[28:31], v[12:15], v[88:95], v1
    v_smfmac_f32_16x16x64_bf16 v[28:31], v[16:19], v[96:103], v1
    v_smfmac_f32_16x16x64_bf16 v[28:31], v[20:23], v[104:111], v1
    v_smfmac_f32_16x16x64_bf16 v[32:35], v[12:15], v[112:119], v1
    v_smfmac_f32_16x16x64_bf16 v[32:35], v[16:19], v[120:127], v1
    v_smfmac_f32_16x16x64_bf16 v[32:35], v[20:23], v[128:135], v1
    v_smfmac_f32_16x16x64_bf16 v[36:39], v[12:15], v[136:143], v1
    v_smfmac_f32_16x16x64_bf16 v[36:39], v[16:19], v[144:151], v1
    v_smfmac_f32_16x16x64_bf16 v[36:39], v[20:23], v[152:159], v1
    v_add_f32 v24, v24, v26
    s_nop 0
    v_add_f32 v28, v28, v30
    s_nop 1
    v_add_f32 v32, v32, v34
    v_max3_f32 v61, v24, v28, v32
    v_mov_b32_dpp v24, v28 quad_perm:[0,1,2,3] row_mask:0x2 bank_mask:0xf
    v_add_f32 v36, v36, v38
    v_max_f32 v61, v61, v36
    v_mov_b32_dpp v24, v32 quad_perm:[0,1,2,3] row_mask:0x4 bank_mask:0xf
    s_nop 0
    v_max_f32_dpp v61, v61, v61 row_ror:8 row_mask:0xf bank_mask:0xf
    s_nop 0
    v_mov_b32_dpp v24, v36 quad_perm:[0,1,2,3] row_mask:0x8 bank_mask:0xf
    v_max_f32_dpp v61, v61, v61 row_ror:4 row_mask:0xf bank_mask:0xf
    s_nop 1
    v_max_f32_dpp v61, v61, v61 row_ror:2 row_mask:0xf bank_mask:0xf
    s_nop 1
    v_max_f32_dpp v61, v61, v61 row_ror:1 row_mask:0xf bank_mask:0xf
    v_sub_f32 v36, v24, v61
L_pad9:
    s_cbranch_execz L_pad13
    ds_write_b32 v59, v61
    v_exp_f32 v36, v36
    s_nop 0
    v_cvt_pk_bf16_f32 v39, v36, v36
    ds_write_b16 v58, v39
    ds_read_b128 v[12:15], v52
    ds_read_b128 v[16:19], v53
    ds_read_b128 v[20:23], v54
    ds_read_b128 v[24:27], v55
    ds_read_b128 v[28:31], v56
    ds_read_b128 v[32:35], v57
    v_add_f32_dpp v38, v36, v36 row_ror:8 row_mask:0xf bank_mask:0xf
    s_nop 1
    v_add_f32_dpp v38, v38, v38 row_ror:4 row_mask:0xf bank_mask:0xf
    s_nop 1
    v_add_f32_dpp v38, v38, v38 row_ror:2 row_mask:0xf bank_mask:0xf
    s_cbranch_scc1 L_eo_190
    s_waitcnt lgkmcnt(5)
    v_smfmac_f32_16x16x64_bf16 v[40:43], v[12:15], v[160:167], v1
    v_add_f32_dpp v38, v38, v38 row_ror:1 row_mask:0xf bank_mask:0xf
    v_smfmac_f32_16x16x64_bf16 v[44:47], v[12:15], v[208:215], v1
    ds_read_b32 v36, v62
    s_waitcnt lgkmcnt(5)
    v_smfmac_f32_16x16x64_bf16 v[40:43], v[16:19], v[168:175], v1
    v_add_f32_dpp v38, v38, v38 row_bcast:15 row_mask:0xa bank_mask:0xf
    v_smfmac_f32_16x16x64_bf16 v[44:47], v[16:19], v[216:223], v1
    s_waitcnt lgkmcnt(4)
    v_smfmac_f32_16x16x64_bf16 v[40:43], v[20:23], v[176:183], v1
    v_add_f32_dpp v38, v38, v38 row_bcast:31 row_mask:0xc bank_mask:0xf
    v_smfmac_f32_16x16x64_bf16 v[44:47], v[20:23], v[224:231], v1
    s_waitcnt lgkmcnt(0)
    v_max_f32_dpp v37, v36, v36 row_ror:4 row_mask:0xf bank_mask:0xf
    v_smfmac_f32_16x16x64_bf16 v[40:43], v[24:27], v[184:191], v1
    v_smfmac_f32_16x16x64_bf16 v[44:47], v[24:27], v[232:239], v1
    v_max_f32_dpp v37, v37, v37 row_ror:2 row_mask:0xf bank_mask:0xf
    v_smfmac_f32_16x16x64_bf16 v[40:43], v[28:31], v[192:199], v1
    v_cmp_eq_u32 vcc, -1, v36
    v_smfmac_f32_16x16x64_bf16 v[44:47], v[28:31], v[240:247], v1
    v_max_f32_dpp v37, v37, v37 row_ror:1 row_mask:0xf bank_mask:0xf
    v_smfmac_f32_16x16x64_bf16 v[40:43], v[32:35], v[200:207], v1
    v_sub_f32 v39, v61, v37
    v_smfmac_f32_16x16x64_bf16 v[44:47], v[32:35], v[248:255], v1
    v_exp_f32 v39, v39
    s_cbranch_vccnz L_mr_188
L_mk_189:
    v_mul_f32 v38, v38, v39
    ds_write_b32 v63, v38 offset:1024
    s_cmp_lt_u32 s30, 2
    s_nop 0
    v_pk_add_f32 v[40:41], v[40:41], v[42:43]
    s_nop 0
    v_pk_add_f32 v[42:43], v[44:45], v[46:47]
    v_pk_mul_f32 v[40:41], v[40:41], v[38:39] op_sel:[0,1] op_sel_hi:[1,1]
    v_pk_mul_f32 v[42:43], v[42:43], v[38:39] op_sel:[0,1] op_sel_hi:[1,1]
    ds_write_b128 v63, v[40:43]
    s_cbranch_scc1 L_comb_1
    s_waitcnt lgkmcnt(0)
    s_barrier
L_comb_1b:
    s_cmp_lt_u32 s3, 20
    s_cbranch_scc0 L_typeB_1
    s_mul_i32 s74, s30, 1664
    s_add_u32 s74, s74, s62
    s_add_u32 s74, s74, 26624
    v_and_b32 v56, 7, v0
    v_lshlrev_b32 v56, 2, v56
    v_lshrrev_b32 v62, 4, v0
    v_lshlrev_b32 v62, 3, v62
    buffer_load_dword v52, v56, s[40:43], s74 offen offset:1536 sc1
    buffer_load_dwordx2 v[54:55], v62, s[40:43], s74 offen offset:1536 sc1
    v_lshlrev_b32 v57, 4, v0
    v_lshlrev_b32 v58, 3, v0
    s_mul_i32 s57, s30, 6144
    s_add_u32 s57, s57, 30720
    v_lshrrev_b32 v59, 2, v0
    v_lshlrev_b32 v59, 6, v59
    v_bfe_u32 v53, v0, 4, 1
    v_lshl_add_u32 v59, v53, 5, v59
    v_and_b32 v53, 3, v0
    v_lshl_add_u32 v59, v53, 3, v59
    v_add_u32 v59, s57, v59
    v_xor_b32 v60, 32, v59
    s_lshl_b32 s57, s30, 8
L_pad10:
    s_cbranch_execz L_pad14
    s_add_u32 s57, s57, 157696
    v_lshl_add_u32 v61, v0, 2, s57
    ds_read_b64_tr_b16 v[28:29], v59 offset:0
    ds_read_b64_tr_b16 v[30:31], v59 offset:1024
    ds_read_b64_tr_b16 v[32:33], v59 offset:2048
    ds_read_b64_tr_b16 v[34:35], v59 offset:3072
    ds_read_b64_tr_b16 v[36:37], v59 offset:4096
    ds_read_b64_tr_b16 v[38:39], v59 offset:5120
    ds_read_b64_tr_b16 v[40:41], v60 offset:0
    ds_read_b64_tr_b16 v[42:43], v60 offset:1024
    ds_read_b64_tr_b16 v[44:45], v60 offset:2048
    ds_read_b64_tr_b16 v[46:47], v60 offset:3072
    ds_read_b64_tr_b16 v[48:49], v60 offset:4096
    ds_read_b64_tr_b16 v[50:51], v60 offset:5120
    v_mov_b64 v[20:21], 0
    v_mov_b64 v[22:23], 0
    v_mov_b64 v[24:25], 0
    v_mov_b64 v[26:27], 0
    s_add_u32 s58, s6, 132096
    s_branch L_pw_197
    s_nop 0
    s_nop 0
    s_nop 0
    s_nop 0
L_pr_198:
    buffer_load_dword v52, v56, s[40:43], s74 offen offset:1536 sc1
    buffer_load_dwordx2 v[54:55], v62, s[40:43], s74 offen offset:1536 sc1
    s_sub_u32 s56, s56, 1
    s_cbranch_scc1 L_done
L_pw_197:
    s_waitcnt vmcnt(0)
    v_max3_u32 v53, v52, v54, v55
    v_cmp_eq_u32 vcc, -1, v53
    s_cbranch_vccnz L_pr_198
    buffer_load_dwordx4 v[12:15], v57, s[40:43], s74 offen sc1
    buffer_load_dwordx2 v[16:17], v58, s[40:43], s74 offen offset:1024 sc1
    buffer_load_dword v18, v56, s[40:43], s74 offen offset:1568 sc1
    v_max_f32_dpp v53, v52, v52 row_ror:4 row_mask:0xf bank_mask:0xf
    s_nop 1
    v_max_f32_dpp v53, v53, v53 row_ror:2 row_mask:0xf bank_mask:0xf
    s_nop 1
    v_max_f32_dpp v53, v53, v53 row_ror:1 row_mask:0xf bank_mask:0xf
    v_sub_f32 v52, v52, v53
    v_sub_f32 v54, v54, v53
    v_sub_f32 v55, v55, v53
    v_exp_f32 v52, v52
    v_exp_f32 v54, v54
    v_exp_f32 v55, v55
    s_waitcnt lgkmcnt(0)
    s_branch L_ow_199
    s_nop 0
    s_nop 0
    s_nop 0
    s_nop 0
    s_nop 0
    s_nop 0
    s_nop 0
L_or_200:
    buffer_load_dwordx4 v[12:15], v57, s[40:43], s74 offen sc1
    buffer_load_dwordx2 v[16:17], v58, s[40:43], s74 offen offset:1024 sc1
    buffer_load_dword v18, v56, s[40:43], s74 offen offset:1568 sc1
    s_sub_u32 s56, s56, 1
    s_cbranch_scc1 L_done
    v_mov_b64 v[20:21], 0
    v_mov_b64 v[22:23], 0
    v_mov_b64 v[24:25], 0
    v_mov_b64 v[26:27], 0
L_ow_199:
    s_waitcnt vmcnt(2)
    v_smfmac_f32_16x16x64_bf16 v[20:23], v[12:15], v[28:35], v1
    v_max3_u32 v19, v12, v13, v14
    v_smfmac_f32_16x16x64_bf16 v[24:27], v[12:15], v[40:47], v1
    s_waitcnt vmcnt(0)
    v_mul_f32 v53, v52, v18
    v_smfmac_f32_16x16x32_bf16 v[20:23], v[16:17], v[36:39], v1
    v_max3_u32 v62, v15, v16, v17
    v_smfmac_f32_16x16x32_bf16 v[24:27], v[16:17], v[48:51], v1
    v_max3_u32 v19, v19, v62, v18
    v_add_f32_dpp v53, v53, v53 row_ror:4 row_mask:0xf bank_mask:0xf
    v_cmp_eq_u32 vcc, -1, v19
    s_cmp_eq_u32 s30, 2
    v_add_f32_dpp v53, v53, v53 row_ror:2 row_mask:0xf bank_mask:0xf
    s_cbranch_vccnz L_or_200
    s_nop 0
    v_add_f32_dpp v53, v53, v53 row_ror:1 row_mask:0xf bank_mask:0xf
    v_rcp_f32 v52, v53
    v_pk_add_f32 v[20:21], v[20:21], v[22:23]
    v_pk_add_f32 v[24:25], v[24:25], v[26:27]
    v_pk_mul_f32 v[54:55], v[54:55], v[52:53] op_sel:[0,0] op_sel_hi:[1,0]
    v_mul_f32 v20, v20, v54
    v_mul_f32 v24, v24, v54
L_pad11:
    s_cbranch_execz L_pad15
    v_fmac_f32 v20, v21, v55
    v_fmac_f32 v24, v25, v55
    s_nop 1
    v_permlane32_swap_b32 v20, v24
    v_add_f32 v20, v20, v24
    ds_write_b32 v61, v20
    s_waitcnt lgkmcnt(0)
    s_barrier
    s_cbranch_scc0 L_finb_201
    ds_read2st64_b32 v[12:13], v2 offset0:0 offset1:1
    ds_read2st64_b32 v[14:15], v2 offset0:2 offset1:3
    ds_read2st64_b32 v[16:17], v2 offset0:4 offset1:5
    ds_read2st64_b32 v[18:19], v2 offset0:6 offset1:7
    s_waitcnt lgkmcnt(2)
    v_pk_add_f32 v[12:13], v[12:13], v[14:15]
    s_waitcnt lgkmcnt(0)
    v_pk_add_f32 v[16:17], v[16:17], v[18:19]
    v_pk_add_f32 v[12:13], v[12:13], v[16:17]
    v_add_f32 v14, v12, v13
    v_add_f32 v15, v12, v13
    s_nop 1
    v_permlane16_swap_b32 v14, v15
    v_add_f32 v12, v14, v15
    buffer_store_dword v12, v3, s[40:43], s58 offen sc1
L_finb_201:
    s_sub_u32 s57, s30, 4
    s_cmp_lt_u32 s57, 3
    s_cbranch_scc0 L_skip_202
    s_sub_u32 s60, s30, 4
    s_lshl_b32 s57, s60, 11
    v_lshlrev_b32 v11, 4, v0
    v_add_u32 v11, s57, v11
    s_add_u32 s65, s62, 19456
    buffer_load_dwordx4 v[52:55], v11, s[40:43], s65 offen offset:0 sc1
    buffer_load_dwordx4 v[56:59], v11, s[40:43], s65 offen offset:1024 sc1
    s_lshl_b32 s59, s60, 12
    s_add_u32 s59, s59, 79872
    v_bfe_u32 v35, v0, 4, 1
    v_lshlrev_b32 v35, 11, v35
    v_bfe_u32 v60, v0, 2, 2
    v_lshl_add_u32 v35, v60, 8, v35
    v_lshrrev_b32 v60, 5, v0
    v_lshl_add_u32 v35, v60, 6, v35
    v_and_b32 v60, 3, v0
    v_lshl_add_u32 v35, v60, 3, v35
    v_add_u32 v35, s59, v35
    v_mov_b32 v9, 0xbdd2d3e8
    v_mov_b32 v10, 0xc0135761
    s_lshl_b32 s57, s60, 7
    s_add_u32 s57, s57, 160256
    v_lshlrev_b32 v32, 3, v0
    v_add_u32 v32, s57, v32
    v_lshlrev_b32 v33, 3, v0
    v_add_u32 v33, 129024, v33
    v_cmp_gt_u32 vcc, 16, v0
    s_nop 1
    v_cndmask_b32 v32, v33, v32, vcc
    v_and_b32 v33, 15, v0
    v_lshlrev_b32 v33, 3, v33
    v_lshrrev_b32 v60, 5, v0
    v_lshl_add_u32 v33, v60, 2, v33
    v_add_u32 v33, 160256, v33
    v_and_b32 v34, 15, v0
    v_lshlrev_b32 v34, 2, v34
    v_lshrrev_b32 v60, 5, v0
    v_lshl_add_u32 v34, v60, 6, v34
    v_bfe_u32 v60, v0, 4, 1
    v_lshl_add_u32 v34, v60, 13, v34
    s_add_u32 s60, s6, 198144
    s_add_u32 s58, s62, 39936
    s_add_u32 s57, s62, 25984
    v_and_b32 v7, 7, v0
    v_lshlrev_b32 v7, 3, v7
    v_mov_b32 v60, 0x3acccccd
    v_mov_b32 v61, 0x3727c5ac
    s_waitcnt vmcnt(0)
    buffer_load_dwordx2 v[24:25], v7, s[40:43], s57 offen sc1
    buffer_load_dwordx4 v[12:15], v11, s[40:43], s58 offen offset:0 sc1
    buffer_load_dwordx4 v[16:19], v11, s[40:43], s58 offen offset:1024 sc1
    ds_read_b64_tr_b16 v[36:37], v35 offset:0
    ds_read_b64_tr_b16 v[38:39], v35 offset:1024
    ds_read_b64_tr_b16 v[40:41], v35 offset:128
    ds_read_b64_tr_b16 v[42:43], v35 offset:1152
    ds_read_b64_tr_b16 v[44:45], v35 offset:32
    ds_read_b64_tr_b16 v[46:47], v35 offset:1056
    ds_read_b64_tr_b16 v[48:49], v35 offset:160
L_pad12:
    s_cbranch_execz L_pad16
    ds_read_b64_tr_b16 v[50:51], v35 offset:1184
L_sw_205:
    v_max3_u32 v20, v52, v53, v54
    v_max3_u32 v20, v20, v55, v56
    v_max3_u32 v20, v20, v57, v58
    v_max_u32 v20, v20, v59
    v_cmp_eq_u32 vcc, -1, v20
    s_cbranch_vccnz L_sr_206
    v_pk_add_f32 v[28:29], v[52:53], v[56:57]
    v_pk_add_f32 v[30:31], v[54:55], v[58:59]
    s_nop 1
    v_permlane32_swap_b32 v28, v30
    v_permlane32_swap_b32 v29, v31
    v_pk_add_f32 v[28:29], v[28:29], v[30:31]
    s_nop 1
    v_permlane16_swap_b32 v28, v29
    v_add_f32 v28, v28, v29
    v_mov_b64 v[52:53], 0
    v_mov_b64 v[54:55], 0
    v_mov_b64 v[56:57], 0
    v_mov_b64 v[58:59], 0
    s_waitcnt lgkmcnt(0)
L_pr_204:
    buffer_load_dwordx2 v[24:25], v7, s[40:43], s57 offen sc1
    buffer_load_dwordx4 v[12:15], v11, s[40:43], s58 offen offset:0 sc1
    buffer_load_dwordx4 v[16:19], v11, s[40:43], s58 offen offset:1024 sc1
    s_sub_u32 s56, s56, 1
    s_cbranch_scc1 L_done
L_pw_203:
    s_waitcnt vmcnt(3)
    v_max_u32 v20, v24, v25
    v_cmp_eq_u32 vcc, -1, v20
    s_cbranch_vccnz L_pr_204
    buffer_load_dwordx4 v[12:15], v11, s[40:43], s58 offen offset:0 sc1
    buffer_load_dwordx4 v[16:19], v11, s[40:43], s58 offen offset:1024 sc1
    v_add_f32_dpp v2, v24, v24 row_ror:4 row_mask:0xf bank_mask:0xf
    v_add_f32_dpp v3, v25, v25 row_ror:4 row_mask:0xf bank_mask:0xf
    v_pk_add_f32 v[20:21], v[12:13], v[16:17]
    v_pk_add_f32 v[22:23], v[14:15], v[18:19]
    v_add_f32_dpp v2, v2, v2 row_ror:2 row_mask:0xf bank_mask:0xf
    v_add_f32_dpp v3, v3, v3 row_ror:2 row_mask:0xf bank_mask:0xf
    v_permlane32_swap_b32 v20, v22
    v_permlane32_swap_b32 v21, v23
    v_add_f32_dpp v2, v2, v2 row_ror:1 row_mask:0xf bank_mask:0xf
    v_add_f32_dpp v3, v3, v3 row_ror:1 row_mask:0xf bank_mask:0xf
    v_pk_add_f32 v[20:21], v[20:21], v[22:23]
    v_mul_f32 v2, v2, v60
    v_fma_f32 v3, v3, v60, v61
    v_permlane16_swap_b32 v20, v21
    v_fma_f32 v3, -v2, v2, v3
    v_add_f32 v20, v20, v21
    v_max_f32 v3, v3, v61
    v_mul_f32 v26, v28, v2
    v_rsq_f32 v3, v3
    v_cmp_u_f32 vcc, v20, v20
    v_sub_f32 v20, v20, v26
    s_cbranch_vccnz L_hr_207
L_hk_208:
    v_fma_f32 v20, v20, v3, v4
    v_mul_f32 v21, v20, v20
    v_fma_f32 v21, v21, v9, v10
    v_mul_f32 v21, v21, v20
    v_exp_f32 v21, v21
    s_nop 0
    v_add_f32 v21, 1.0, v21
    v_rcp_f32 v21, v21
    s_nop 0
    v_mul_f32 v20, v20, v21
    s_nop 1
    v_mov_b32_dpp v21, v20 row_shl:1 row_mask:0xf bank_mask:0xf bound_ctrl:0
    v_cvt_pk_bf16_f32 v28, v20, v21
    s_nop 1
    v_mov_b32_dpp v29, v28 row_shl:4 row_mask:0xf bank_mask:0xf bound_ctrl:0
    v_mov_b32_dpp v30, v28 row_shl:8 row_mask:0xf bank_mask:0xf bound_ctrl:0
    v_mov_b32_dpp v31, v28 row_shl:12 row_mask:0xf bank_mask:0xf bound_ctrl:0
    s_nop 1
    v_smfmac_f32_16x16x64_bf16 v[52:55], v[28:31], v[36:43], v1
    v_smfmac_f32_16x16x64_bf16 v[56:59], v[28:31], v[44:51], v1
    s_cmp_eq_u32 s30, 4
    s_nop 5
    v_add_f32 v22, v52, v54
    v_add_f32 v23, v56, v58
    ds_write_b64 v32, v[22:23]
    s_cbranch_scc0 L_skip_210
L_xw_211:
    ds_read2_b32 v[20:21], v33 offset0:0 offset1:32
    ds_read_b32 v22, v33 offset:256
    s_sub_u32 s56, s56, 1
    s_cbranch_scc1 L_done
    s_waitcnt lgkmcnt(0)
    v_max3_u32 v23, v20, v21, v22
    v_add_f32 v20, v20, v21
    v_cmp_eq_u32 vcc, -1, v23
    v_add_f32 v20, v20, v22
    s_cbranch_vccnz L_xw_211
    buffer_store_dword v20, v34, s[40:43], s60 offen sc1
L_skip_210:
L_skip_202:
L_pad13:
    s_cbranch_execz L_pad17
    s_branch L_done
    s_nop 0
    s_nop 0
    s_nop 0
    s_nop 0
    s_nop 0
L_typeB_1:
    s_cmp_eq_u32 s53, 3
    s_cbranch_scc0 L_typeC_212
    s_cmp_eq_u32 s30, 7
    s_cbranch_scc1 L_w7_217
    s_cmp_lt_u32 s30, 6
    s_cbranch_scc0 L_skip_219
    s_lshr_b32 s57, s30, 1
    s_mul_i32 s57, s57, 128
    s_and_b32 s58, s30, 1
    s_lshl_b32 s58, s58, 6
    s_add_u32 s57, s57, s58
    v_lshrrev_b32 v18, 5, v0
    v_lshlrev_b32 v18, 13, v18
    v_bfe_u32 v60, v0, 3, 1
    v_lshl_add_u32 v18, v60, 12, v18
    v_bfe_u32 v60, v0, 4, 1
    v_lshl_add_u32 v18, v60, 11, v18
    v_bfe_u32 v60, v0, 2, 1
    v_mul_u32_u24 v60, 384, v60
    v_add_u32 v18, v60, v18
    v_and_b32 v60, 3, v0
    v_lshl_add_u32 v18, v60, 3, v18
    v_add_u32 v18, s57, v18
    v_add_u32 v18, 30720, v18
    v_bfe_u32 v19, v0, 4, 1
    v_lshlrev_b32 v19, 12, v19
    v_bfe_u32 v60, v0, 3, 1
    v_lshl_add_u32 v19, v60, 11, v19
    v_bfe_u32 v60, v0, 2, 1
    v_mul_u32_u24 v60, 384, v60
    v_add_u32 v19, v60, v19
    v_and_b32 v60, 3, v0
    v_lshl_add_u32 v19, v60, 3, v19
    v_add_u32 v19, s57, v19
    v_add_u32 v19, 63488, v19
    ds_read_b64_tr_b16 v[28:29], v18 offset:0
    ds_read_b64_tr_b16 v[30:31], v18 offset:1024
    ds_read_b64_tr_b16 v[32:33], v18 offset:16384
    ds_read_b64_tr_b16 v[34:35], v18 offset:17408
    ds_read_b64_tr_b16 v[36:37], v19 offset:0
    ds_read_b64_tr_b16 v[38:39], v19 offset:1024
    ds_read_b64_tr_b16 v[40:41], v18 offset:32
    ds_read_b64_tr_b16 v[42:43], v18 offset:1056
    ds_read_b64_tr_b16 v[44:45], v18 offset:16416
    ds_read_b64_tr_b16 v[46:47], v18 offset:17440
    ds_read_b64_tr_b16 v[48:49], v19 offset:32
    ds_read_b64_tr_b16 v[50:51], v19 offset:1056
    v_lshrrev_b32 v9, 4, v0
    v_lshlrev_b32 v9, 5, v9
    v_bfe_u32 v60, v0, 1, 1
    v_lshl_add_u32 v9, v60, 4, v9
    v_and_b32 v60, 1, v0
    v_mul_u32_u24 v60, 192, v60
    v_add_u32 v9, v60, v9
    v_add_u32 v9, 160832, v9
    v_lshrrev_b32 v10, 4, v0
    v_lshlrev_b32 v10, 4, v10
    v_bfe_u32 v60, v0, 1, 1
    v_lshl_add_u32 v10, v60, 3, v10
    v_and_b32 v60, 1, v0
    v_mul_u32_u24 v60, 192, v60
    v_add_u32 v10, v60, v10
    v_add_u32 v10, 160960, v10
    v_mov_b64 v[20:21], 0
    v_mov_b64 v[22:23], 0
    v_mov_b64 v[24:25], 0
    v_mov_b64 v[26:27], 0
    s_lshr_b32 s57, s30, 1
    s_lshl_b32 s57, s57, 11
    s_lshl_b32 s58, s58, 1
    s_add_u32 s57, s57, s58
    s_lshl_b32 s58, s54, 8
    s_add_u32 s57, s57, s58
    v_and_b32 v11, 31, v0
    v_lshlrev_b32 v11, 2, v11
    v_lshrrev_b32 v60, 5, v0
    v_lshl_add_u32 v11, v60, 30, v11
    v_add_u32 v11, s57, v11
    s_add_u32 s59, s62, 39936
    s_add_u32 s60, s62, 25984
L_skip_219:
    s_cmp_lt_u32 s30, 6
L_pad14:
    s_cbranch_execz L_pad18
    s_barrier
    s_cbranch_scc0 L_se_218
    ds_read_b128 v[12:15], v9
    ds_read_b64 v[16:17], v10
    s_waitcnt lgkmcnt(1)
    v_smfmac_f32_16x16x64_bf16 v[20:23], v[12:15], v[28:35], v1
    v_smfmac_f32_16x16x64_bf16 v[24:27], v[12:15], v[40:47], v1
    s_waitcnt lgkmcnt(0)
    v_smfmac_f32_16x16x32_bf16 v[20:23], v[16:17], v[36:39], v1
    v_smfmac_f32_16x16x32_bf16 v[24:27], v[16:17], v[48:51], v1
    s_cmp_eq_u32 s55, 0
    s_nop 5
    v_add_f32 v12, v20, v22
    s_nop 1
    v_add_f32_dpp v12, v24, v26 quad_perm:[0,1,2,3] row_mask:0x2 bank_mask:0xf
    s_cbranch_scc1 L_gs_220
    buffer_store_dword v12, v11, s[40:43], s59 offen
L_gb_221:
L_se_218:
    s_cmp_eq_u32 s30, 7
    s_cbranch_scc0 L_done
    s_cmp_eq_u32 s31, 0
    s_cbranch_scc0 L_done
    v_lshlrev_b32 v60, 16, v4
    v_add_f32 v2, v2, v60
    v_and_b32 v60, 0xffff0000, v4
    v_add_f32 v3, v3, v60
    v_and_b32 v60, 31, v0
    v_min_u32 v60, 19, v60
    s_mul_i32 s57, s54, 160
    v_lshrrev_b32 v7, 5, v0
    v_lshlrev_b32 v7, 2, v7
    v_add_u32 v7, s57, v7
    v_lshl_add_u32 v7, v60, 3, v7
    s_add_u32 s57, s7, 198144
    s_add_u32 s58, s7, 214528
    s_add_u32 s59, s7, 230912
    s_add_u32 s60, s7, 247296
    v_mov_b64 v[36:37], 0
    v_mov_b64 v[38:39], 0
    s_nop 0
    v_mov_b32_dpp v36, v2 quad_perm:[0,1,2,3] row_mask:0x3 bank_mask:0xf
    v_mov_b32_dpp v37, v3 quad_perm:[0,1,2,3] row_mask:0x3 bank_mask:0xf
    v_mov_b32_dpp v38, v2 quad_perm:[0,1,2,3] row_mask:0xc bank_mask:0xf
    v_mov_b32_dpp v39, v3 quad_perm:[0,1,2,3] row_mask:0xc bank_mask:0xf
    s_add_u32 s75, s7, 266252
    v_and_b32 v9, 7, v0
    v_lshlrev_b32 v9, 9, v9
    buffer_load_dword v12, v9, s[40:43], s75 offen sc1
    s_sleep 2
L_pr_233:
    buffer_load_dword v12, v9, s[40:43], s75 offen sc1
    s_sub_u32 s56, s56, 1
    s_cbranch_scc1 L_done
L_pw_232:
    s_waitcnt vmcnt(1)
    v_cmp_eq_u32 vcc, -1, v12
    s_cbranch_vccnz L_pr_233
    s_sleep 2
    buffer_load_dwordx4 v[12:15], v5, s[40:43], s57 offen sc1
    buffer_load_dwordx4 v[16:19], v5, s[40:43], s58 offen sc1
    buffer_load_dwordx4 v[20:23], v5, s[40:43], s59 offen sc1
    buffer_load_dwordx4 v[24:27], v5, s[40:43], s60 offen sc1
    s_sleep 2
L_gw_229:
    buffer_load_dwordx4 v[12:15], v5, s[40:43], s57 offen sc1
    buffer_load_dwordx4 v[16:19], v5, s[40:43], s58 offen sc1
    buffer_load_dwordx4 v[20:23], v5, s[40:43], s59 offen sc1
    buffer_load_dwordx4 v[24:27], v5, s[40:43], s60 offen sc1
    s_sub_u32 s56, s56, 1
    s_cbranch_scc1 L_done
    s_and_b32 s74, s56, 31
    s_waitcnt vmcnt(7)
    v_pk_add_f32 v[28:29], v[12:13], v[36:37]
    v_pk_add_f32 v[30:31], v[14:15], v[38:39]
    s_waitcnt vmcnt(6)
    v_pk_add_f32 v[28:29], v[28:29], v[16:17]
    v_pk_add_f32 v[30:31], v[30:31], v[18:19]
    s_waitcnt vmcnt(5)
    v_pk_add_f32 v[28:29], v[28:29], v[20:21]
    v_pk_add_f32 v[30:31], v[30:31], v[22:23]
    s_waitcnt vmcnt(4)
    v_pk_add_f32 v[28:29], v[28:29], v[24:25]
    v_pk_add_f32 v[30:31], v[30:31], v[26:27]
    v_pk_add_f32 v[32:33], v[28:29], v[30:31]
    v_cmp_u_f32 vcc, v32, v33
    v_permlane32_swap_b32 v28, v30
    v_permlane32_swap_b32 v29, v31
    s_cbranch_vccnz L_gr_230
L_gk_231:
    v_pk_add_f32 v[28:29], v[28:29], v[30:31]
    v_cvt_pk_bf16_f32 v28, v28, v29
L_pad15:
    s_cbranch_execz L_pad19
    global_store_dword v7, v28, s[24:25]
    s_branch L_done
    s_nop 0
    s_nop 0
    s_nop 0
    s_nop 0
L_gs_34:
    buffer_store_dword v33, v34, s[40:43], s67 offen sc1
    s_branch L_gb_35
    s_nop 0
    s_nop 0
    s_nop 0
    s_nop 0
    s_nop 0
L_gs_37:
    buffer_store_dword v12, v54, s[40:43], s59 offen sc1
    s_branch L_gb_38
    s_nop 0
    s_nop 0
    s_nop 0
    s_nop 0
    s_nop 0
L_cr_49:
    s_sub_u32 s56, s56, 1
    s_cbranch_scc1 L_done
    global_load_dword v2, v3, s[26:27] sc1
    s_waitcnt vmcnt(0)
    s_branch L_cw_48
    s_nop 0
    s_nop 0
L_far_50:
    s_lshl_b32 s57, s52, 2
    s_add_u32 s57, s57, s72
    s_mov_b64 exec, 1
    buffer_store_dword v25, v0, s[40:43], s57 offen offset:128 sc1
    s_mov_b64 exec, -1
    s_branch L_fb_51
    s_nop 0
L_cr_63:
    s_sub_u32 s56, s56, 1
    s_cbranch_scc1 L_done
    buffer_load_dword v2, v24, s[40:43], s72 offen sc1
    s_branch L_cw_62
    s_nop 0
    s_nop 0
    s_nop 0
L_gs_70:
    buffer_store_dword v33, v34, s[40:43], s67 offen sc1
    s_branch L_gb_71
    s_nop 0
    s_nop 0
    s_nop 0
    s_nop 0
    s_nop 0
L_gs_73:
    buffer_store_dword v12, v54, s[40:43], s59 offen sc1
    s_branch L_gb_74
    s_nop 0
    s_nop 0
    s_nop 0
    s_nop 0
    s_nop 0
L_gs_91:
    buffer_store_dword v37, v4, s[40:43], s58 offen sc1
    s_branch L_gb_92
    s_nop 0
    s_nop 0
    s_nop 0
    s_nop 0
    s_nop 0
L_cr_105:
    s_sub_u32 s56, s56, 1
    s_cbranch_scc1 L_done
    global_load_dword v2, v3, s[26:27] offset:4 sc1
    s_branch L_cw_104
    s_nop 0
    s_nop 0
    s_nop 0
L_cr_115:
    buffer_load_dword v52, v56, s[40:43], s74 offen offset:1536 sc1
    buffer_load_dwordx2 v[54:55], v62, s[40:43], s74 offen offset:1536 sc1
    s_sub_u32 s56, s56, 1
    s_cbranch_scc1 L_done
    s_branch L_cw_114
    s_nop 0
L_gs_120:
    buffer_store_dword v14, v3, s[40:43], s57 offen sc1
    s_branch L_gb_121
    s_nop 0
    s_nop 0
    s_nop 0
    s_nop 0
    s_nop 0
L_gs_122:
    buffer_store_dword v12, v4, s[40:43], s57 offen offset:32 sc1
    s_branch L_gb_123
    s_nop 0
    s_nop 0
    s_nop 0
    s_nop 0
    s_nop 0
L_comb_0:
    s_mov_b32 s57, 0
    s_cmp_eq_u32 s55, 0
    s_waitcnt lgkmcnt(0)
    s_barrier
    ds_read2st64_b64 v[12:15], v2 offset0:0 offset1:4
    ds_read2st64_b64 v[16:19], v2 offset0:8 offset1:12
    ds_read2st64_b64 v[20:23], v2 offset0:16 offset1:20
    ds_read2st64_b64 v[24:27], v2 offset0:24 offset1:28
    s_waitcnt lgkmcnt(2)
    v_pk_add_f32 v[12:13], v[12:13], v[14:15]
    v_pk_add_f32 v[16:17], v[16:17], v[18:19]
    v_pk_add_f32 v[12:13], v[12:13], v[16:17]
    s_waitcnt lgkmcnt(0)
    v_pk_add_f32 v[20:21], v[20:21], v[22:23]
    v_pk_add_f32 v[24:25], v[24:25], v[26:27]
L_pad16:
    s_cbranch_execz L_pad20
    v_pk_add_f32 v[12:13], v[12:13], v[20:21]
    v_pk_add_f32 v[12:13], v[12:13], v[24:25]
    v_cvt_pk_bf16_f32 v14, v12, v13
    v_min_u32 v14, -2, v14
    s_cbranch_scc1 L_gs_120
    buffer_store_dword v14, v3, s[40:43], s57 offen
L_gb_121:
    s_cbranch_scc1 L_gs_122
    buffer_store_dword v12, v4, s[40:43], s57 offen offset:32
L_gb_123:
    s_branch L_comb_0b
    s_nop 0
L_sr_132:
    buffer_load_dwordx4 v[52:55], v11, s[40:43], s65 offen offset:0 sc1
    buffer_load_dwordx4 v[56:59], v11, s[40:43], s65 offen offset:1024 sc1
    s_sub_u32 s56, s56, 1
    s_cbranch_scc1 L_done
    s_waitcnt vmcnt(0)
    s_branch L_sw_131
L_hr_133:
    buffer_load_dwordx4 v[12:15], v11, s[40:43], s58 offen offset:0 sc1
    buffer_load_dwordx4 v[16:19], v11, s[40:43], s58 offen offset:1024 sc1
    s_sub_u32 s56, s56, 1
    s_cbranch_scc1 L_done
    s_and_b32 s64, s56, 31
    s_cbranch_scc0 L_hx_135
    s_waitcnt vmcnt(2)
    v_pk_add_f32 v[20:21], v[12:13], v[16:17]
    v_pk_add_f32 v[22:23], v[14:15], v[18:19]
    s_nop 1
    v_permlane32_swap_b32 v20, v22
    v_permlane32_swap_b32 v21, v23
    v_pk_add_f32 v[20:21], v[20:21], v[22:23]
    s_nop 1
    v_permlane16_swap_b32 v20, v21
    v_add_f32 v20, v20, v21
    v_cmp_u_f32 vcc, v20, v20
    v_sub_f32 v20, v20, v26
    s_cbranch_vccnz L_hr_133
    s_branch L_hk_134
    s_nop 0
    s_nop 0
    s_nop 0
    s_nop 0
    s_nop 0
    s_nop 0
    s_nop 0
L_hx_135:
    s_waitcnt vmcnt(0)
    v_max3_u32 v20, v12, v13, v14
    v_max3_u32 v20, v20, v15, v16
    v_max3_u32 v20, v20, v17, v18
    v_max_u32 v20, v20, v19
    v_cmp_eq_u32 vcc, -1, v20
    s_cbranch_vccnz L_hr_133
    v_pk_add_f32 v[20:21], v[12:13], v[16:17]
    v_pk_add_f32 v[22:23], v[14:15], v[18:19]
    s_nop 1
    v_permlane32_swap_b32 v20, v22
    v_permlane32_swap_b32 v21, v23
    v_pk_add_f32 v[20:21], v[20:21], v[22:23]
    s_nop 1
    v_permlane16_swap_b32 v20, v21
    v_add_f32 v20, v20, v21
    v_sub_f32 v20, v20, v26
    s_branch L_hk_134
L_gs_143:
    buffer_store_dword v0, v11, s[40:43], s58 offen sc1
    s_branch L_gb_144
    s_nop 0
    s_nop 0
    s_nop 0
    s_nop 0
    s_nop 0
L_typeC_139:
    s_cmp_eq_u32 s30, 6
    s_cbranch_scc0 L_p1
    s_cmp_eq_u32 s3, 21
    s_cbranch_scc0 L_skip_140
    v_and_b32 v11, 3, v0
    v_lshlrev_b32 v11, 7, v11
    v_lshrrev_b32 v60, 2, v0
    v_lshl_add_u32 v11, v60, 24, v11
    s_add_u32 s58, s62, 26116
    s_add_u32 s75, s7, 266244
    v_and_b32 v9, 7, v0
    v_lshlrev_b32 v9, 9, v9
    buffer_load_dword v12, v9, s[40:43], s75 offen sc1
    s_sleep 2
L_pr_142:
    buffer_load_dword v12, v9, s[40:43], s75 offen sc1
    s_sub_u32 s56, s56, 1
    s_cbranch_scc1 L_done
L_pw_141:
    s_waitcnt vmcnt(1)
    v_cmp_eq_u32 vcc, -1, v12
    s_cbranch_vccnz L_pr_142
    s_cmp_eq_u32 s55, 0
    s_cbranch_scc1 L_gs_143
    buffer_store_dword v0, v11, s[40:43], s58 offen
L_gb_144:
    s_waitcnt vmcnt(1)
    s_branch L_p1
    s_nop 0
L_skip_140:
    s_cmp_eq_u32 s3, 20
    s_cbranch_scc0 L_p1
    s_lshl_b32 s59, s31, 9
    s_add_u32 s59, s59, s8
    s_add_u32 s59, s59, 266240
    v_and_b32 v10, 1, v0
    v_lshlrev_b32 v10, 13, v10
L_pad17:
    s_cbranch_execz L_pad21
    v_lshrrev_b32 v60, 1, v0
    v_lshl_add_u32 v10, v60, 24, v10
    s_add_u32 s58, s62, 1568
    v_lshrrev_b32 v9, 3, v0
    v_mul_u32_u24 v9, 1664, v9
    v_and_b32 v60, 7, v0
    v_lshl_add_u32 v9, v60, 2, v9
    buffer_load_dword v12, v9, s[40:43], s58 offen sc1
    s_sleep 2
L_pr_146:
    buffer_load_dword v12, v9, s[40:43], s58 offen sc1
    s_sub_u32 s56, s56, 1
    s_cbranch_scc1 L_done
L_pw_145:
    s_waitcnt vmcnt(1)
    v_cmp_eq_u32 vcc, -1, v12
    s_cbranch_vccnz L_pr_146
    buffer_store_dword v0, v10, s[40:43], s59 offen offset:0 sc1
    s_add_u32 s58, s62, 25856
    v_and_b32 v9, 15, v0
    v_lshlrev_b32 v9, 2, v9
    buffer_load_dword v13, v9, s[40:43], s58 offen sc1
    s_sleep 2
L_pr_148:
    buffer_load_dword v13, v9, s[40:43], s58 offen sc1
    s_sub_u32 s56, s56, 1
    s_cbranch_scc1 L_done
L_pw_147:
    s_waitcnt vmcnt(1)
    v_cmp_eq_u32 vcc, -1, v13
    s_cbranch_vccnz L_pr_148
    buffer_store_dword v0, v10, s[40:43], s59 offen offset:4 sc1
    s_waitcnt vmcnt(1)
    s_branch L_p1
    s_nop 0
    s_nop 0
    s_nop 0
    s_nop 0
    s_nop 0
    s_nop 0
L_gs_152:
    buffer_store_dword v12, v11, s[40:43], s60 offen sc1
    s_branch L_gb_153
    s_nop 0
    s_nop 0
    s_nop 0
    s_nop 0
    s_nop 0
L_gs_154:
    buffer_store_dword v12, v11, s[40:43], s59 offen sc1
    s_branch L_gb_155
    s_nop 0
    s_nop 0
    s_nop 0
    s_nop 0
    s_nop 0
L_gr_157:
    s_cbranch_scc1 L_gw_156
    s_waitcnt vmcnt(0)
    v_max3_u32 v32, v12, v13, v14
    v_max3_u32 v32, v32, v15, v16
    v_max3_u32 v32, v32, v17, v18
    v_max3_u32 v32, v32, v19, v20
    v_max3_u32 v32, v32, v21, v22
    v_max3_u32 v32, v32, v23, v24
    v_max3_u32 v32, v32, v25, v26
    v_max_u32 v32, v32, v27
    v_cmp_eq_u32 vcc, -1, v32
    s_cbranch_vccnz L_gw_156
    v_pk_add_f32 v[28:29], v[12:13], v[36:37]
    v_pk_add_f32 v[30:31], v[14:15], v[38:39]
    v_pk_add_f32 v[28:29], v[28:29], v[16:17]
    v_pk_add_f32 v[30:31], v[30:31], v[18:19]
    v_pk_add_f32 v[28:29], v[28:29], v[20:21]
    v_pk_add_f32 v[30:31], v[30:31], v[22:23]
    v_pk_add_f32 v[28:29], v[28:29], v[24:25]
    v_pk_add_f32 v[30:31], v[30:31], v[26:27]
    s_nop 1
    v_permlane32_swap_b32 v28, v30
    v_permlane32_swap_b32 v29, v31
    s_branch L_gk_158
    s_nop 0
L_gs_161:
    buffer_store_dword v33, v34, s[40:43], s67 offen sc1
    s_branch L_gb_162
    s_nop 0
    s_nop 0
    s_nop 0
    s_nop 0
    s_nop 0
L_w7_149:
    v_and_b32 v60, 31, v0
    v_min_u32 v60, 19, v60
    s_mul_i32 s57, s54, 320
    v_lshrrev_b32 v5, 5, v0
    v_lshlrev_b32 v5, 12, v5
    v_add_u32 v5, s57, v5
    v_lshl_add_u32 v5, v60, 4, v5
    v_and_b32 v60, 31, v0
    v_cmp_gt_u32 s[64:65], 20, v60
    v_min_u32 v60, 19, v60
    v_lshrrev_b32 v35, 5, v0
    v_lshlrev_b32 v35, 2, v35
    v_add_u32 v35, 160832, v35
L_pad18:
    s_cbranch_execz L_pad22
    v_lshl_add_u32 v35, v60, 3, v35
    s_add_u32 s66, s62, 13312
    s_add_u32 s67, s62, 25856
    s_lshl_b32 s57, s54, 3
    v_lshrrev_b32 v34, 5, v0
    v_lshlrev_b32 v34, 2, v34
    v_add_u32 v34, s57, v34
    v_and_b32 v60, 31, v0
    v_mov_b32 v61, 0x7f000000
    v_cmp_ne_u32 vcc, 31, v60
    s_nop 1
    v_cndmask_b32 v34, v34, v61, vcc
    v_mov_b32 v61, 0x3f803f80
    s_add_u32 s57, s7, 0
    s_add_u32 s58, s7, 16384
    s_add_u32 s59, s7, 32768
    s_add_u32 s60, s7, 49152
    v_mov_b64 v[36:37], 0
    v_mov_b64 v[38:39], 0
    s_nop 0
    v_mov_b32_dpp v36, v2 quad_perm:[0,1,2,3] row_mask:0x3 bank_mask:0xf
    v_mov_b32_dpp v37, v3 quad_perm:[0,1,2,3] row_mask:0x3 bank_mask:0xf
    v_mov_b32_dpp v38, v2 quad_perm:[0,1,2,3] row_mask:0xc bank_mask:0xf
    v_mov_b32_dpp v39, v3 quad_perm:[0,1,2,3] row_mask:0xc bank_mask:0xf
    s_add_u32 s75, s7, 266240
    v_and_b32 v9, 7, v0
    v_lshlrev_b32 v9, 9, v9
    buffer_load_dword v12, v9, s[40:43], s75 offen sc1
    s_sleep 2
L_pr_160:
    buffer_load_dword v12, v9, s[40:43], s75 offen sc1
    s_sub_u32 s56, s56, 1
    s_cbranch_scc1 L_done
L_pw_159:
    s_waitcnt vmcnt(1)
    v_cmp_eq_u32 vcc, -1, v12
    s_cbranch_vccnz L_pr_160
    s_sleep 1
    buffer_load_dwordx4 v[12:15], v5, s[40:43], s57 offen sc1
    buffer_load_dwordx4 v[16:19], v5, s[40:43], s58 offen sc1
    buffer_load_dwordx4 v[20:23], v5, s[40:43], s59 offen sc1
    buffer_load_dwordx4 v[24:27], v5, s[40:43], s60 offen sc1
    s_sleep 2
L_gw_156:
    buffer_load_dwordx4 v[12:15], v5, s[40:43], s57 offen sc1
    buffer_load_dwordx4 v[16:19], v5, s[40:43], s58 offen sc1
    buffer_load_dwordx4 v[20:23], v5, s[40:43], s59 offen sc1
    buffer_load_dwordx4 v[24:27], v5, s[40:43], s60 offen sc1
    s_sub_u32 s56, s56, 1
    s_cbranch_scc1 L_done
    s_and_b32 s74, s56, 31
    s_waitcnt vmcnt(7)
    v_pk_add_f32 v[28:29], v[12:13], v[36:37]
    v_pk_add_f32 v[30:31], v[14:15], v[38:39]
    s_waitcnt vmcnt(6)
    v_pk_add_f32 v[28:29], v[28:29], v[16:17]
    v_pk_add_f32 v[30:31], v[30:31], v[18:19]
    s_waitcnt vmcnt(5)
    v_pk_add_f32 v[28:29], v[28:29], v[20:21]
    v_pk_add_f32 v[30:31], v[30:31], v[22:23]
    s_waitcnt vmcnt(4)
    v_pk_add_f32 v[28:29], v[28:29], v[24:25]
    v_pk_add_f32 v[30:31], v[30:31], v[26:27]
    v_pk_add_f32 v[32:33], v[28:29], v[30:31]
    v_cmp_u_f32 vcc, v32, v33
    v_permlane32_swap_b32 v28, v30
    v_permlane32_swap_b32 v29, v31
    s_cbranch_vccnz L_gr_157
L_gk_158:
    v_pk_add_f32 v[28:29], v[28:29], v[30:31]
    v_cvt_pk_bf16_f32 v28, v28, v29
    ds_write_b32 v35, v28
    s_waitcnt lgkmcnt(0)
    s_barrier
    v_cndmask_b32 v29, 0, v28, s[64:65]
    v_dot2_f32_bf16 v33, v29, v61, 0
    v_dot2_f32_bf16 v32, v29, v29, 0
    v_lshlrev_b32 v2, 16, v28
    v_and_b32 v3, 0xffff0000, v28
    s_cmp_eq_u32 s55, 0
    v_permlane32_swap_b32 v33, v32
    v_add_f32 v33, v33, v32
    s_nop 1
    v_add_f32_dpp v33, v33, v33 row_ror:8 row_mask:0xf bank_mask:0xf
    s_nop 1
    v_add_f32_dpp v33, v33, v33 row_ror:4 row_mask:0xf bank_mask:0xf
    s_nop 1
    v_add_f32_dpp v33, v33, v33 row_ror:2 row_mask:0xf bank_mask:0xf
L_pad19:
    s_cbranch_execz L_pad23
    s_nop 1
    v_add_f32_dpp v33, v33, v33 row_ror:1 row_mask:0xf bank_mask:0xf
    s_nop 1
    v_add_f32_dpp v33, v33, v33 row_bcast:15 row_mask:0xa bank_mask:0xf
    s_cbranch_scc1 L_gs_161
    buffer_store_dword v33, v34, s[40:43], s67 offen
L_gb_162:
    s_waitcnt vmcnt(1)
    s_branch L_se_150
    s_nop 0
    s_nop 0
    s_nop 0
    s_nop 0
L_gs_166:
    buffer_store_dword v12, v11, s[40:43], s59 offen sc1
    s_branch L_gb_167
    s_nop 0
    s_nop 0
    s_nop 0
    s_nop 0
    s_nop 0
L_gr_172:
    s_cbranch_scc1 L_gw_171
    s_waitcnt vmcnt(0)
    v_max3_u32 v32, v12, v13, v14
    v_max3_u32 v32, v32, v15, v16
    v_max3_u32 v32, v32, v17, v18
    v_max3_u32 v32, v32, v19, v20
    v_max3_u32 v32, v32, v21, v22
    v_max3_u32 v32, v32, v23, v24
    v_max3_u32 v32, v32, v25, v26
    v_max_u32 v32, v32, v27
    v_cmp_eq_u32 vcc, -1, v32
    s_cbranch_vccnz L_gw_171
    v_pk_add_f32 v[28:29], v[12:13], v[36:37]
    v_pk_add_f32 v[30:31], v[14:15], v[38:39]
    v_pk_add_f32 v[28:29], v[28:29], v[16:17]
    v_pk_add_f32 v[30:31], v[30:31], v[18:19]
    v_pk_add_f32 v[28:29], v[28:29], v[20:21]
    v_pk_add_f32 v[30:31], v[30:31], v[22:23]
    v_pk_add_f32 v[28:29], v[28:29], v[24:25]
    v_pk_add_f32 v[30:31], v[30:31], v[26:27]
    s_nop 1
    v_permlane32_swap_b32 v28, v30
    v_permlane32_swap_b32 v29, v31
    s_branch L_gk_173
    s_nop 0
L_gr_175:
    s_cbranch_scc1 L_gw_174
    s_waitcnt vmcnt(0)
    v_max3_u32 v32, v12, v13, v14
    v_max3_u32 v32, v32, v15, v16
    v_max3_u32 v32, v32, v17, v18
    v_max3_u32 v32, v32, v19, v20
    v_max3_u32 v32, v32, v21, v22
    v_max3_u32 v32, v32, v23, v24
    v_max3_u32 v32, v32, v25, v26
    v_max_u32 v32, v32, v27
    v_cmp_eq_u32 vcc, -1, v32
    s_cbranch_vccnz L_gw_174
    v_pk_add_f32 v[28:29], v[12:13], v[36:37]
    v_pk_add_f32 v[30:31], v[14:15], v[38:39]
    v_pk_add_f32 v[28:29], v[28:29], v[16:17]
    v_pk_add_f32 v[30:31], v[30:31], v[18:19]
    v_pk_add_f32 v[28:29], v[28:29], v[20:21]
    v_pk_add_f32 v[30:31], v[30:31], v[22:23]
    v_pk_add_f32 v[28:29], v[28:29], v[24:25]
    v_pk_add_f32 v[30:31], v[30:31], v[26:27]
    s_nop 1
    v_permlane32_swap_b32 v28, v30
    v_permlane32_swap_b32 v29, v31
    s_branch L_gk_176
    s_nop 0
L_gs_179:
    buffer_store_dword v33, v34, s[40:43], s67 offen sc1
    s_branch L_gb_180
    s_nop 0
    s_nop 0
    s_nop 0
    s_nop 0
    s_nop 0
L_w7_163:
    v_and_b32 v60, 31, v0
    v_min_u32 v60, 19, v60
    s_mul_i32 s57, s54, 320
    v_lshrrev_b32 v5, 5, v0
    v_lshlrev_b32 v5, 12, v5
    v_add_u32 v5, s57, v5
    v_lshl_add_u32 v5, v60, 4, v5
    v_and_b32 v60, 31, v0
    v_cmp_gt_u32 s[64:65], 20, v60
    v_min_u32 v60, 19, v60
    v_lshrrev_b32 v35, 5, v0
    v_lshlrev_b32 v35, 2, v35
    v_add_u32 v35, 160832, v35
L_pad20:
    s_cbranch_execz L_pad24
    v_lshl_add_u32 v35, v60, 3, v35
    s_mul_i32 s66, s53, 6144
    s_add_u32 s66, s66, s62
    s_add_u32 s66, s66, 46080
    s_lshl_b32 s67, s53, 6
    s_add_u32 s67, s67, s62
    s_add_u32 s67, s67, 25600
    s_lshl_b32 s57, s54, 3
    v_lshrrev_b32 v34, 5, v0
    v_lshlrev_b32 v34, 2, v34
    v_add_u32 v34, s57, v34
    v_and_b32 v60, 31, v0
    v_mov_b32 v61, 0x7f000000
    v_cmp_ne_u32 vcc, 31, v60
    s_nop 1
    v_cndmask_b32 v34, v34, v61, vcc
    v_mov_b32 v61, 0x3f803f80
    s_cmp_lg_u32 s53, 3
    s_cbranch_scc0 L_skip_168
    s_add_u32 s57, s62, 25856
    v_mov_b32 v9, 0
L_pr_170:
    buffer_load_dword v12, v9, s[40:43], s57 offen sc1
    s_sub_u32 s56, s56, 1
    s_cbranch_scc1 L_done
L_pw_169:
    s_waitcnt vmcnt(0)
    v_cmp_eq_u32 vcc, -1, v12
    s_cbranch_vccnz L_pr_170
    s_add_u32 s57, s7, 0
    s_add_u32 s58, s7, 16384
    s_add_u32 s59, s7, 32768
    s_add_u32 s60, s7, 49152
    v_mov_b64 v[36:37], 0
    v_mov_b64 v[38:39], 0
    s_nop 0
    v_mov_b32_dpp v36, v2 quad_perm:[0,1,2,3] row_mask:0x3 bank_mask:0xf
    v_mov_b32_dpp v37, v3 quad_perm:[0,1,2,3] row_mask:0x3 bank_mask:0xf
    v_mov_b32_dpp v38, v2 quad_perm:[0,1,2,3] row_mask:0xc bank_mask:0xf
    v_mov_b32_dpp v39, v3 quad_perm:[0,1,2,3] row_mask:0xc bank_mask:0xf
L_gw_171:
    buffer_load_dwordx4 v[12:15], v5, s[40:43], s57 offen sc1
    buffer_load_dwordx4 v[16:19], v5, s[40:43], s58 offen sc1
    buffer_load_dwordx4 v[20:23], v5, s[40:43], s59 offen sc1
    buffer_load_dwordx4 v[24:27], v5, s[40:43], s60 offen sc1
    s_sub_u32 s56, s56, 1
    s_cbranch_scc1 L_done
    s_and_b32 s74, s56, 31
    s_waitcnt vmcnt(3)
    v_pk_add_f32 v[28:29], v[12:13], v[36:37]
    v_pk_add_f32 v[30:31], v[14:15], v[38:39]
    s_waitcnt vmcnt(2)
    v_pk_add_f32 v[28:29], v[28:29], v[16:17]
    v_pk_add_f32 v[30:31], v[30:31], v[18:19]
    s_waitcnt vmcnt(1)
    v_pk_add_f32 v[28:29], v[28:29], v[20:21]
    v_pk_add_f32 v[30:31], v[30:31], v[22:23]
    s_waitcnt vmcnt(0)
    v_pk_add_f32 v[28:29], v[28:29], v[24:25]
    v_pk_add_f32 v[30:31], v[30:31], v[26:27]
    v_pk_add_f32 v[32:33], v[28:29], v[30:31]
    v_cmp_u_f32 vcc, v32, v33
    v_permlane32_swap_b32 v28, v30
    v_permlane32_swap_b32 v29, v31
    s_cbranch_vccnz L_gr_172
L_gk_173:
    v_pk_add_f32 v[28:29], v[28:29], v[30:31]
    v_cvt_pk_bf16_f32 v28, v28, v29
    v_lshlrev_b32 v2, 16, v28
    v_and_b32 v3, 0xffff0000, v28
L_skip_168:
    v_lshlrev_b32 v60, 16, v4
    v_add_f32 v2, v2, v60
    v_and_b32 v60, 0xffff0000, v4
    v_add_f32 v3, v3, v60
    s_add_u32 s57, s7, 66048
    s_add_u32 s58, s7, 82432
    s_add_u32 s59, s7, 98816
    s_add_u32 s60, s7, 115200
    v_mov_b64 v[36:37], 0
    v_mov_b64 v[38:39], 0
    s_nop 0
    v_mov_b32_dpp v36, v2 quad_perm:[0,1,2,3] row_mask:0x3 bank_mask:0xf
    v_mov_b32_dpp v37, v3 quad_perm:[0,1,2,3] row_mask:0x3 bank_mask:0xf
    v_mov_b32_dpp v38, v2 quad_perm:[0,1,2,3] row_mask:0xc bank_mask:0xf
    v_mov_b32_dpp v39, v3 quad_perm:[0,1,2,3] row_mask:0xc bank_mask:0xf
    s_lshl_b32 s74, s53, 7
    s_add_u32 s75, s62, s74
    s_add_u32 s75, s75, 26116
    v_mov_b32 v9, 0
L_pad21:
    s_cbranch_execz L_pad25
    buffer_load_dword v12, v9, s[40:43], s75 offen sc1
    s_sleep 2
L_pr_178:
    buffer_load_dword v12, v9, s[40:43], s75 offen sc1
    s_sub_u32 s56, s56, 1
    s_cbranch_scc1 L_done
L_pw_177:
    s_waitcnt vmcnt(1)
    v_cmp_eq_u32 vcc, -1, v12
    s_cbranch_vccnz L_pr_178
    buffer_load_dwordx4 v[12:15], v5, s[40:43], s57 offen sc1
    buffer_load_dwordx4 v[16:19], v5, s[40:43], s58 offen sc1
    buffer_load_dwordx4 v[20:23], v5, s[40:43], s59 offen sc1
    buffer_load_dwordx4 v[24:27], v5, s[40:43], s60 offen sc1
    s_sleep 2
L_gw_174:
    buffer_load_dwordx4 v[12:15], v5, s[40:43], s57 offen sc1
    buffer_load_dwordx4 v[16:19], v5, s[40:43], s58 offen sc1
    buffer_load_dwordx4 v[20:23], v5, s[40:43], s59 offen sc1
    buffer_load_dwordx4 v[24:27], v5, s[40:43], s60 offen sc1
    s_sub_u32 s56, s56, 1
    s_cbranch_scc1 L_done
    s_and_b32 s74, s56, 31
    s_waitcnt vmcnt(7)
    v_pk_add_f32 v[28:29], v[12:13], v[36:37]
    v_pk_add_f32 v[30:31], v[14:15], v[38:39]
    s_waitcnt vmcnt(6)
    v_pk_add_f32 v[28:29], v[28:29], v[16:17]
    v_pk_add_f32 v[30:31], v[30:31], v[18:19]
    s_waitcnt vmcnt(5)
    v_pk_add_f32 v[28:29], v[28:29], v[20:21]
    v_pk_add_f32 v[30:31], v[30:31], v[22:23]
    s_waitcnt vmcnt(4)
    v_pk_add_f32 v[28:29], v[28:29], v[24:25]
    v_pk_add_f32 v[30:31], v[30:31], v[26:27]
    v_pk_add_f32 v[32:33], v[28:29], v[30:31]
    v_cmp_u_f32 vcc, v32, v33
    v_permlane32_swap_b32 v28, v30
    v_permlane32_swap_b32 v29, v31
    s_cbranch_vccnz L_gr_175
L_gk_176:
    v_pk_add_f32 v[28:29], v[28:29], v[30:31]
    v_cvt_pk_bf16_f32 v28, v28, v29
    ds_write_b32 v35, v28
    s_waitcnt lgkmcnt(0)
    s_barrier
    v_cndmask_b32 v29, 0, v28, s[64:65]
    v_dot2_f32_bf16 v33, v29, v61, 0
    v_dot2_f32_bf16 v32, v29, v29, 0
    v_lshlrev_b32 v2, 16, v28
    v_and_b32 v3, 0xffff0000, v28
    s_cmp_eq_u32 s55, 0
    v_permlane32_swap_b32 v33, v32
    v_add_f32 v33, v33, v32
    s_nop 1
    v_add_f32_dpp v33, v33, v33 row_ror:8 row_mask:0xf bank_mask:0xf
    s_nop 1
    v_add_f32_dpp v33, v33, v33 row_ror:4 row_mask:0xf bank_mask:0xf
    s_nop 1
    v_add_f32_dpp v33, v33, v33 row_ror:2 row_mask:0xf bank_mask:0xf
    s_nop 1
    v_add_f32_dpp v33, v33, v33 row_ror:1 row_mask:0xf bank_mask:0xf
    s_nop 1
    v_add_f32_dpp v33, v33, v33 row_bcast:15 row_mask:0xa bank_mask:0xf
    s_cbranch_scc1 L_gs_179
    buffer_store_dword v33, v34, s[40:43], s67 offen
L_gb_180:
    s_waitcnt vmcnt(1)
    s_branch L_se_164
    s_nop 0
    s_nop 0
    s_nop 0
    s_nop 0
    s_nop 0
    s_nop 0
    s_nop 0
L_hr_185:
    buffer_load_dwordx4 v[12:15], v7, s[40:43], s59 offen offset:0 sc1
    buffer_load_dwordx4 v[16:19], v7, s[40:43], s59 offen offset:1024 sc1
    s_sub_u32 s56, s56, 1
    s_cbranch_scc1 L_done
    s_and_b32 s64, s56, 31
    s_cbranch_scc0 L_hx_187
    s_waitcnt vmcnt(0)
    v_pk_add_f32 v[20:21], v[12:13], v[16:17]
    v_pk_add_f32 v[22:23], v[14:15], v[18:19]
    s_nop 1
    v_permlane32_swap_b32 v20, v22
    v_permlane32_swap_b32 v21, v23
    v_pk_add_f32 v[20:21], v[20:21], v[22:23]
    s_nop 1
    v_permlane16_swap_b32 v20, v21
    v_add_f32 v20, v20, v21
    v_cmp_u_f32 vcc, v20, v20
    v_sub_f32 v20, v20, v50
    s_cbranch_vccnz L_hr_185
L_pad22:
    s_cbranch_execz L_pad26
    s_branch L_hk_186
    s_nop 0
    s_nop 0
    s_nop 0
    s_nop 0
    s_nop 0
    s_nop 0
L_hx_187:
    s_waitcnt vmcnt(0)
    v_max3_u32 v20, v12, v13, v14
    v_max3_u32 v20, v20, v15, v16
    v_max3_u32 v20, v20, v17, v18
    v_max_u32 v20, v20, v19
    v_cmp_eq_u32 vcc, -1, v20
    s_cbranch_vccnz L_hr_185
    v_pk_add_f32 v[20:21], v[12:13], v[16:17]
    v_pk_add_f32 v[22:23], v[14:15], v[18:19]
    s_nop 1
    v_permlane32_swap_b32 v20, v22
    v_permlane32_swap_b32 v21, v23
    v_pk_add_f32 v[20:21], v[20:21], v[22:23]
    s_nop 1
    v_permlane16_swap_b32 v20, v21
    v_add_f32 v20, v20, v21
    v_sub_f32 v20, v20, v50
    s_branch L_hk_186
L_qo_181:
    v_mov_b64 v[24:25], 0
    v_mov_b64 v[26:27], 0
    v_mov_b64 v[28:29], 0
    v_mov_b64 v[30:31], 0
    v_mov_b64 v[32:33], 0
    v_mov_b64 v[34:35], 0
    v_mov_b64 v[36:37], 0
    v_mov_b64 v[38:39], 0
    v_mov_b64 v[40:41], 0
    v_mov_b64 v[42:43], 0
    v_mov_b64 v[44:45], 0
    v_mov_b64 v[46:47], 0
    v_lshrrev_b32 v5, 4, v0
    v_lshlrev_b32 v5, 5, v5
    v_bfe_u32 v60, v0, 1, 1
    v_lshl_add_u32 v5, v60, 4, v5
    v_add_u32 v5, 124928, v5
    s_branch L_qb_182
    s_nop 0
    s_nop 0
    s_nop 0
L_eo_190:
    s_waitcnt lgkmcnt(5)
    v_smfmac_f32_16x16x64_bf16 v[40:43], v[12:15], v[160:167], v1
    v_add_f32_dpp v38, v38, v38 row_ror:1 row_mask:0xf bank_mask:0xf
    v_smfmac_f32_16x16x64_bf16 v[44:47], v[12:15], v[208:215], v1
    s_waitcnt lgkmcnt(4)
    v_smfmac_f32_16x16x64_bf16 v[40:43], v[16:19], v[168:175], v1
    v_add_f32_dpp v38, v38, v38 row_bcast:15 row_mask:0xa bank_mask:0xf
    v_smfmac_f32_16x16x64_bf16 v[44:47], v[16:19], v[216:223], v1
    s_waitcnt lgkmcnt(3)
    v_smfmac_f32_16x16x64_bf16 v[40:43], v[20:23], v[176:183], v1
    v_add_f32_dpp v38, v38, v38 row_bcast:31 row_mask:0xc bank_mask:0xf
    v_smfmac_f32_16x16x64_bf16 v[44:47], v[20:23], v[224:231], v1
    s_waitcnt lgkmcnt(0)
    v_smfmac_f32_16x16x64_bf16 v[40:43], v[24:27], v[184:191], v1
    v_smfmac_f32_16x16x64_bf16 v[44:47], v[24:27], v[232:239], v1
    v_smfmac_f32_16x16x64_bf16 v[40:43], v[28:31], v[192:199], v1
    v_smfmac_f32_16x16x64_bf16 v[44:47], v[28:31], v[240:247], v1
    v_smfmac_f32_16x16x64_bf16 v[40:43], v[32:35], v[200:207], v1
    v_smfmac_f32_16x16x64_bf16 v[44:47], v[32:35], v[248:255], v1
L_mr_188:
    ds_read_b32 v36, v62
    s_sub_u32 s56, s56, 1
    s_cbranch_scc1 L_done
    s_waitcnt lgkmcnt(0)
    v_cmp_eq_u32 vcc, -1, v36
    s_cbranch_vccnz L_mr_188
    v_max_f32_dpp v37, v36, v36 row_ror:4 row_mask:0xf bank_mask:0xf
    s_nop 1
    v_max_f32_dpp v37, v37, v37 row_ror:2 row_mask:0xf bank_mask:0xf
    s_nop 1
    v_max_f32_dpp v37, v37, v37 row_ror:1 row_mask:0xf bank_mask:0xf
    v_sub_f32 v39, v61, v37
    v_exp_f32 v39, v39
    s_branch L_mk_189
    s_nop 0
    s_nop 0
    s_nop 0
    s_nop 0
L_gs_191:
    buffer_store_dword v37, v4, s[40:43], s58 offen sc1
    s_branch L_gb_192
    s_nop 0
    s_nop 0
    s_nop 0
    s_nop 0
    s_nop 0
L_gs_193:
    buffer_store_dword v14, v3, s[40:43], s57 offen sc1
    s_branch L_gb_194
    s_nop 0
    s_nop 0
    s_nop 0
    s_nop 0
    s_nop 0
L_gs_195:
L_pad23:
    s_cbranch_execz L_padback
    buffer_store_dword v12, v4, s[40:43], s57 offen offset:32 sc1
    s_branch L_gb_196
    s_nop 0
    s_nop 0
    s_nop 0
    s_nop 0
L_comb_1:
    s_mov_b32 s58, 26624
    s_cmp_eq_u32 s55, 0
    s_cbranch_scc1 L_gs_191
    buffer_store_dword v37, v4, s[40:43], s58 offen
L_gb_192:
    s_mov_b32 s57, 26624
    s_cmp_eq_u32 s55, 0
    s_waitcnt lgkmcnt(0)
    s_barrier
    ds_read2st64_b64 v[12:15], v2 offset0:0 offset1:4
    ds_read2st64_b64 v[16:19], v2 offset0:8 offset1:12
    ds_read2st64_b64 v[20:23], v2 offset0:16 offset1:20
    ds_read2st64_b64 v[24:27], v2 offset0:24 offset1:28
    s_waitcnt lgkmcnt(2)
    v_pk_add_f32 v[12:13], v[12:13], v[14:15]
    v_pk_add_f32 v[16:17], v[16:17], v[18:19]
    v_pk_add_f32 v[12:13], v[12:13], v[16:17]
    s_waitcnt lgkmcnt(0)
    v_pk_add_f32 v[20:21], v[20:21], v[22:23]
    v_pk_add_f32 v[24:25], v[24:25], v[26:27]
    v_pk_add_f32 v[12:13], v[12:13], v[20:21]
    v_pk_add_f32 v[12:13], v[12:13], v[24:25]
    v_cvt_pk_bf16_f32 v14, v12, v13
    v_min_u32 v14, -2, v14
    s_cbranch_scc1 L_gs_193
    buffer_store_dword v14, v3, s[40:43], s57 offen
L_gb_194:
    s_cbranch_scc1 L_gs_195
    buffer_store_dword v12, v4, s[40:43], s57 offen offset:32
L_gb_196:
    s_branch L_comb_1b
    s_nop 0
    s_nop 0
    s_nop 0
L_sr_206:
    buffer_load_dwordx4 v[52:55], v11, s[40:43], s65 offen offset:0 sc1
    buffer_load_dwordx4 v[56:59], v11, s[40:43], s65 offen offset:1024 sc1
    s_sub_u32 s56, s56, 1
    s_cbranch_scc1 L_done
    s_waitcnt vmcnt(0)
    s_branch L_sw_205
L_hr_207:
    buffer_load_dwordx4 v[12:15], v11, s[40:43], s58 offen offset:0 sc1
    buffer_load_dwordx4 v[16:19], v11, s[40:43], s58 offen offset:1024 sc1
    s_sub_u32 s56, s56, 1
    s_cbranch_scc1 L_done
    s_and_b32 s64, s56, 31
    s_cbranch_scc0 L_hx_209
    s_waitcnt vmcnt(2)
    v_pk_add_f32 v[20:21], v[12:13], v[16:17]
    v_pk_add_f32 v[22:23], v[14:15], v[18:19]
    s_nop 1
    v_permlane32_swap_b32 v20, v22
    v_permlane32_swap_b32 v21, v23
    v_pk_add_f32 v[20:21], v[20:21], v[22:23]
    s_nop 1
    v_permlane16_swap_b32 v20, v21
    v_add_f32 v20, v20, v21
    v_cmp_u_f32 vcc, v20, v20
    v_sub_f32 v20, v20, v26
    s_cbranch_vccnz L_hr_207
    s_branch L_hk_208
    s_nop 0
    s_nop 0
    s_nop 0
    s_nop 0
    s_nop 0
    s_nop 0
    s_nop 0
L_hx_209:
    s_waitcnt vmcnt(0)
    v_max3_u32 v20, v12, v13, v14
    v_max3_u32 v20, v20, v15, v16
    v_max3_u32 v20, v20, v17, v18
    v_max_u32 v20, v20, v19
    v_cmp_eq_u32 vcc, -1, v20
    s_cbranch_vccnz L_hr_207
    v_pk_add_f32 v[20:21], v[12:13], v[16:17]
    v_pk_add_f32 v[22:23], v[14:15], v[18:19]
    s_nop 1
    v_permlane32_swap_b32 v20, v22
    v_permlane32_swap_b32 v21, v23
    v_pk_add_f32 v[20:21], v[20:21], v[22:23]
    s_nop 1
    v_permlane16_swap_b32 v20, v21
    v_add_f32 v20, v20, v21
    v_sub_f32 v20, v20, v26
    s_branch L_hk_208
L_typeC_212:
    s_cmp_eq_u32 s30, 6
    s_cbranch_scc0 L_done
    s_cmp_eq_u32 s3, 20
    s_cbranch_scc0 L_done
    s_lshl_b32 s59, s31, 9
    s_add_u32 s59, s59, s8
    s_add_u32 s59, s59, 266240
L_pad24:
    s_cbranch_execz L_padback
    v_and_b32 v10, 1, v0
    v_lshlrev_b32 v10, 13, v10
    v_lshrrev_b32 v60, 1, v0
    v_lshl_add_u32 v10, v60, 24, v10
    s_add_u32 s58, s62, 28192
    v_lshrrev_b32 v9, 3, v0
    v_mul_u32_u24 v9, 1664, v9
    v_and_b32 v60, 7, v0
    v_lshl_add_u32 v9, v60, 2, v9
    buffer_load_dword v12, v9, s[40:43], s58 offen sc1
    s_sleep 2
L_pr_214:
    buffer_load_dword v12, v9, s[40:43], s58 offen sc1
    s_sub_u32 s56, s56, 1
    s_cbranch_scc1 L_done
L_pw_213:
    s_waitcnt vmcnt(1)
    v_cmp_eq_u32 vcc, -1, v12
    s_cbranch_vccnz L_pr_214
    buffer_store_dword v0, v10, s[40:43], s59 offen offset:8 sc1
    s_add_u32 s58, s62, 25984
    v_and_b32 v9, 15, v0
    v_lshlrev_b32 v9, 2, v9
    buffer_load_dword v13, v9, s[40:43], s58 offen sc1
    s_sleep 2
L_pr_216:
    buffer_load_dword v13, v9, s[40:43], s58 offen sc1
    s_sub_u32 s56, s56, 1
    s_cbranch_scc1 L_done
L_pw_215:
    s_waitcnt vmcnt(1)
    v_cmp_eq_u32 vcc, -1, v13
    s_cbranch_vccnz L_pr_216
    buffer_store_dword v0, v10, s[40:43], s59 offen offset:12 sc1
    s_waitcnt vmcnt(1)
    s_branch L_done
    s_nop 0
    s_nop 0
    s_nop 0
    s_nop 0
L_gs_220:
    buffer_store_dword v12, v11, s[40:43], s59 offen sc1
    s_branch L_gb_221
    s_nop 0
    s_nop 0
    s_nop 0
    s_nop 0
    s_nop 0
L_gr_223:
    s_cbranch_scc1 L_gw_222
    s_waitcnt vmcnt(0)
    v_max3_u32 v32, v12, v13, v14
    v_max3_u32 v32, v32, v15, v16
    v_max3_u32 v32, v32, v17, v18
    v_max3_u32 v32, v32, v19, v20
    v_max3_u32 v32, v32, v21, v22
    v_max3_u32 v32, v32, v23, v24
    v_max3_u32 v32, v32, v25, v26
    v_max_u32 v32, v32, v27
    v_cmp_eq_u32 vcc, -1, v32
    s_cbranch_vccnz L_gw_222
    v_pk_add_f32 v[28:29], v[12:13], v[36:37]
    v_pk_add_f32 v[30:31], v[14:15], v[38:39]
    v_pk_add_f32 v[28:29], v[28:29], v[16:17]
    v_pk_add_f32 v[30:31], v[30:31], v[18:19]
    v_pk_add_f32 v[28:29], v[28:29], v[20:21]
    v_pk_add_f32 v[30:31], v[30:31], v[22:23]
    v_pk_add_f32 v[28:29], v[28:29], v[24:25]
    v_pk_add_f32 v[30:31], v[30:31], v[26:27]
    s_nop 1
    v_permlane32_swap_b32 v28, v30
    v_permlane32_swap_b32 v29, v31
    s_branch L_gk_224
    s_nop 0
L_gs_227:
    buffer_store_dword v33, v34, s[40:43], s67 offen sc1
    s_branch L_gb_228
    s_nop 0
    s_nop 0
    s_nop 0
    s_nop 0
    s_nop 0
L_w7_217:
    v_and_b32 v60, 31, v0
    v_min_u32 v60, 19, v60
    s_mul_i32 s57, s54, 320
    v_lshrrev_b32 v5, 5, v0
    v_lshlrev_b32 v5, 12, v5
    v_add_u32 v5, s57, v5
    v_lshl_add_u32 v5, v60, 4, v5
    v_and_b32 v60, 31, v0
    v_cmp_gt_u32 s[64:65], 20, v60
    v_min_u32 v60, 19, v60
    v_lshrrev_b32 v35, 5, v0
    v_lshlrev_b32 v35, 2, v35
    v_add_u32 v35, 160832, v35
    v_lshl_add_u32 v35, v60, 3, v35
    s_add_u32 s66, s62, 39936
    s_add_u32 s67, s62, 25984
    s_lshl_b32 s57, s54, 3
L_pad25:
    s_cbranch_execz L_padback
    v_lshrrev_b32 v34, 5, v0
    v_lshlrev_b32 v34, 2, v34
    v_add_u32 v34, s57, v34
    v_and_b32 v60, 31, v0
    v_mov_b32 v61, 0x7f000000
    v_cmp_ne_u32 vcc, 31, v60
    s_nop 1
    v_cndmask_b32 v34, v34, v61, vcc
    v_mov_b32 v61, 0x3f803f80
    s_add_u32 s57, s7, 132096
    s_add_u32 s58, s7, 148480
    s_add_u32 s59, s7, 164864
    s_add_u32 s60, s7, 181248
    v_mov_b64 v[36:37], 0
    v_mov_b64 v[38:39], 0
    s_nop 0
    v_mov_b32_dpp v36, v2 quad_perm:[0,1,2,3] row_mask:0x3 bank_mask:0xf
    v_mov_b32_dpp v37, v3 quad_perm:[0,1,2,3] row_mask:0x3 bank_mask:0xf
    v_mov_b32_dpp v38, v2 quad_perm:[0,1,2,3] row_mask:0xc bank_mask:0xf
    v_mov_b32_dpp v39, v3 quad_perm:[0,1,2,3] row_mask:0xc bank_mask:0xf
    s_add_u32 s75, s7, 266248
    v_and_b32 v9, 7, v0
    v_lshlrev_b32 v9, 9, v9
    buffer_load_dword v12, v9, s[40:43], s75 offen sc1
    s_sleep 2
L_pr_226:
    buffer_load_dword v12, v9, s[40:43], s75 offen sc1
    s_sub_u32 s56, s56, 1
    s_cbranch_scc1 L_done
L_pw_225:
    s_waitcnt vmcnt(1)
    v_cmp_eq_u32 vcc, -1, v12
    s_cbranch_vccnz L_pr_226
    s_sleep 2
    buffer_load_dwordx4 v[12:15], v5, s[40:43], s57 offen sc1
    buffer_load_dwordx4 v[16:19], v5, s[40:43], s58 offen sc1
    buffer_load_dwordx4 v[20:23], v5, s[40:43], s59 offen sc1
    buffer_load_dwordx4 v[24:27], v5, s[40:43], s60 offen sc1
    s_sleep 2
L_gw_222:
    buffer_load_dwordx4 v[12:15], v5, s[40:43], s57 offen sc1
    buffer_load_dwordx4 v[16:19], v5, s[40:43], s58 offen sc1
    buffer_load_dwordx4 v[20:23], v5, s[40:43], s59 offen sc1
    buffer_load_dwordx4 v[24:27], v5, s[40:43], s60 offen sc1
    s_sub_u32 s56, s56, 1
    s_cbranch_scc1 L_done
    s_and_b32 s74, s56, 31
    s_waitcnt vmcnt(7)
    v_pk_add_f32 v[28:29], v[12:13], v[36:37]
    v_pk_add_f32 v[30:31], v[14:15], v[38:39]
    s_waitcnt vmcnt(6)
    v_pk_add_f32 v[28:29], v[28:29], v[16:17]
    v_pk_add_f32 v[30:31], v[30:31], v[18:19]
    s_waitcnt vmcnt(5)
    v_pk_add_f32 v[28:29], v[28:29], v[20:21]
    v_pk_add_f32 v[30:31], v[30:31], v[22:23]
    s_waitcnt vmcnt(4)
    v_pk_add_f32 v[28:29], v[28:29], v[24:25]
    v_pk_add_f32 v[30:31], v[30:31], v[26:27]
    v_pk_add_f32 v[32:33], v[28:29], v[30:31]
    v_cmp_u_f32 vcc, v32, v33
    v_permlane32_swap_b32 v28, v30
    v_permlane32_swap_b32 v29, v31
    s_cbranch_vccnz L_gr_223
L_gk_224:
    v_pk_add_f32 v[28:29], v[28:29], v[30:31]
    v_cvt_pk_bf16_f32 v28, v28, v29
    ds_write_b32 v35, v28
    s_waitcnt lgkmcnt(0)
    s_barrier
    v_cndmask_b32 v29, 0, v28, s[64:65]
    v_dot2_f32_bf16 v33, v29, v61, 0
    v_dot2_f32_bf16 v32, v29, v29, 0
    v_lshlrev_b32 v2, 16, v28
    v_and_b32 v3, 0xffff0000, v28
    s_cmp_eq_u32 s55, 0
    v_permlane32_swap_b32 v33, v32
    v_add_f32 v33, v33, v32
    s_nop 1
    v_add_f32_dpp v33, v33, v33 row_ror:8 row_mask:0xf bank_mask:0xf
    s_nop 1
    v_add_f32_dpp v33, v33, v33 row_ror:4 row_mask:0xf bank_mask:0xf
    s_nop 1
    v_add_f32_dpp v33, v33, v33 row_ror:2 row_mask:0xf bank_mask:0xf
    s_nop 1
    v_add_f32_dpp v33, v33, v33 row_ror:1 row_mask:0xf bank_mask:0xf
    s_nop 1
    v_add_f32_dpp v33, v33, v33 row_bcast:15 row_mask:0xa bank_mask:0xf
    s_cbranch_scc1 L_gs_227
L_pad26:
    s_cbranch_execz L_padback
    buffer_store_dword v33, v34, s[40:43], s67 offen
L_gb_228:
    s_waitcnt vmcnt(1)
    s_branch L_se_218
    s_nop 0
    s_nop 0
    s_nop 0
L_gr_230:
    s_cbranch_scc1 L_gw_229
    s_waitcnt vmcnt(0)
    v_max3_u32 v32, v12, v13, v14
    v_max3_u32 v32, v32, v15, v16
    v_max3_u32 v32, v32, v17, v18
    v_max3_u32 v32, v32, v19, v20
    v_max3_u32 v32, v32, v21, v22
    v_max3_u32 v32, v32, v23, v24
    v_max3_u32 v32, v32, v25, v26
    v_max_u32 v32, v32, v27
    v_cmp_eq_u32 vcc, -1, v32
    s_cbranch_vccnz L_gw_229
    v_pk_add_f32 v[28:29], v[12:13], v[36:37]
    v_pk_add_f32 v[30:31], v[14:15], v[38:39]
    v_pk_add_f32 v[28:29], v[28:29], v[16:17]
    v_pk_add_f32 v[30:31], v[30:31], v[18:19]
    v_pk_add_f32 v[28:29], v[28:29], v[20:21]
    v_pk_add_f32 v[30:31], v[30:31], v[22:23]
    v_pk_add_f32 v[28:29], v[28:29], v[24:25]
    v_pk_add_f32 v[30:31], v[30:31], v[26:27]
    s_nop 1
    v_permlane32_swap_b32 v28, v30
    v_permlane32_swap_b32 v29, v31
    s_branch L_gk_231
L_tail_end:
    s_nop 0
L_spread:
    s_add_u32 s62, s62, 966656
    s_cmp_eq_u32 s30, 5
    s_cbranch_scc0 L_skip_67
    v_mov_b64 v[12:13], -1
    v_mov_b64 v[14:15], -1
    v_lshlrev_b32 v16, 4, v0
    s_mul_i32 s57, s52, 2208
    s_add_u32 s57, s57, s62
    s_mov_b64 exec, 0x3ff
    buffer_store_dwordx4 v[12:15], v16, s[40:43], s57 offen offset:2048 sc1
    s_mov_b64 exec, -1
    buffer_store_dwordx4 v[12:15], v16, s[40:43], s57 offen offset:0 sc1
    buffer_store_dwordx4 v[12:15], v16, s[40:43], s57 offen offset:1024 sc1
L_skip_67:
    s_cmp_eq_u32 s30, 7
    s_cbranch_scc0 L_skip_68
    v_and_b32 v60, 31, v0
    v_cmp_gt_u32 s[64:65], 20, v60
    v_min_u32 v60, 19, v60
    v_lshrrev_b32 v35, 5, v0
    v_lshlrev_b32 v35, 2, v35
    v_add_u32 v35, 160832, v35
    v_lshl_add_u32 v35, v60, 3, v35
    s_mul_i32 s66, s53, 12416
    s_add_u32 s66, s66, s62
    s_add_u32 s66, s66, 70656
    s_add_u32 s67, s66, 12288
    s_lshl_b32 s57, s54, 3
    v_lshrrev_b32 v34, 5, v0
    v_lshlrev_b32 v34, 2, v34
    v_add_u32 v34, s57, v34
    v_and_b32 v60, 31, v0
    v_mov_b32 v61, 0x7f000000
    v_cmp_ne_u32 vcc, 31, v60
    s_nop 1
    v_cndmask_b32 v34, v34, v61, vcc
    v_mov_b32 v61, 0x3f803f80
    v_cvt_pk_bf16_f32 v28, v2, v3
L_skip_68:
    s_cmp_eq_u32 s30, 7
    s_cbranch_scc0 L_skip_69
    v_cndmask_b32 v29, 0, v28, s[64:65]
    v_dot2_f32_bf16 v33, v29, v61, 0
    v_dot2_f32_bf16 v32, v29, v29, 0
    v_lshlrev_b32 v2, 16, v28
    v_and_b32 v3, 0xffff0000, v28
    s_cmp_eq_u32 s55, 0
    v_permlane32_swap_b32 v33, v32
    v_add_f32 v33, v33, v32
    s_nop 1
    v_add_f32_dpp v33, v33, v33 row_ror:8 row_mask:0xf bank_mask:0xf
    s_nop 1
    v_add_f32_dpp v33, v33, v33 row_ror:4 row_mask:0xf bank_mask:0xf
    s_nop 1
    v_add_f32_dpp v33, v33, v33 row_ror:2 row_mask:0xf bank_mask:0xf
    s_nop 1
    v_add_f32_dpp v33, v33, v33 row_ror:1 row_mask:0xf bank_mask:0xf
    s_nop 1
    v_add_f32_dpp v33, v33, v33 row_bcast:15 row_mask:0xa bank_mask:0xf
    s_cbranch_scc1 L_gs_70
    buffer_store_dword v33, v34, s[40:43], s67 offen
L_gb_71:
    s_waitcnt vmcnt(1)
L_skip_69:
    s_cmp_lt_u32 s30, 6
    s_cbranch_scc0 L_skip_72
    s_lshr_b32 s57, s30, 1
    s_mul_i32 s57, s57, 1024
    s_and_b32 s58, s30, 1
    s_lshl_b32 s58, s58, 6
    s_add_u32 s57, s57, s58
    v_lshrrev_b32 v18, 5, v0
    v_mul_u32_u24 v18, 6144, v18
    v_bfe_u32 v60, v0, 3, 1
    v_mul_u32_u24 v60, 3072, v60
    v_add_u32 v18, v60, v18
    v_bfe_u32 v60, v0, 4, 1
    v_lshl_add_u32 v18, v60, 9, v18
    v_bfe_u32 v60, v0, 2, 1
    v_lshl_add_u32 v18, v60, 7, v18
    v_and_b32 v60, 3, v0
    v_lshl_add_u32 v18, v60, 3, v18
    v_add_u32 v18, s57, v18
    v_bfe_u32 v19, v0, 4, 1
    v_mul_u32_u24 v19, 3072, v19
    v_bfe_u32 v60, v0, 3, 1
    v_lshl_add_u32 v19, v60, 9, v19
    v_bfe_u32 v60, v0, 2, 1
    v_lshl_add_u32 v19, v60, 7, v19
    v_and_b32 v60, 3, v0
    v_lshl_add_u32 v19, v60, 3, v19
    v_add_u32 v19, s57, v19
    v_add_u32 v19, 24576, v19
    ds_read_b64_tr_b16 v[28:29], v18 offset:0
    ds_read_b64_tr_b16 v[30:31], v18 offset:256
    ds_read_b64_tr_b16 v[32:33], v18 offset:12288
    ds_read_b64_tr_b16 v[34:35], v18 offset:12544
    ds_read_b64_tr_b16 v[36:37], v19 offset:0
    ds_read_b64_tr_b16 v[38:39], v19 offset:256
    ds_read_b64_tr_b16 v[40:41], v18 offset:32
    ds_read_b64_tr_b16 v[42:43], v18 offset:288
    ds_read_b64_tr_b16 v[44:45], v18 offset:12320
    ds_read_b64_tr_b16 v[46:47], v18 offset:12576
    ds_read_b64_tr_b16 v[48:49], v19 offset:32
    ds_read_b64_tr_b16 v[50:51], v19 offset:288
    v_lshrrev_b32 v52, 4, v0
    v_lshlrev_b32 v52, 5, v52
    v_bfe_u32 v60, v0, 1, 1
    v_lshl_add_u32 v52, v60, 4, v52
    v_and_b32 v60, 1, v0
    v_mul_u32_u24 v60, 192, v60
    v_add_u32 v52, v60, v52
    v_add_u32 v52, 160832, v52
    v_lshrrev_b32 v53, 4, v0
    v_lshlrev_b32 v53, 4, v53
    v_bfe_u32 v60, v0, 1, 1
    v_lshl_add_u32 v53, v60, 3, v53
    v_and_b32 v60, 1, v0
    v_mul_u32_u24 v60, 192, v60
    v_add_u32 v53, v60, v53
    v_add_u32 v53, 160960, v53
    v_mov_b64 v[20:21], 0
    v_mov_b64 v[22:23], 0
    v_mov_b64 v[24:25], 0
    v_mov_b64 v[26:27], 0
    s_lshr_b32 s57, s30, 1
    s_lshl_b32 s57, s57, 11
    s_lshl_b32 s58, s58, 1
    s_add_u32 s57, s57, s58
    s_lshl_b32 s58, s54, 8
    s_add_u32 s57, s57, s58
    v_and_b32 v54, 31, v0
    v_lshlrev_b32 v54, 2, v54
    v_lshrrev_b32 v60, 5, v0
    v_mul_u32_u24 v60, 6144, v60
    v_add_u32 v54, v60, v54
    v_add_u32 v54, s57, v54
    s_mul_i32 s59, s53, 12416
    s_add_u32 s59, s59, s62
    s_add_u32 s59, s59, 70656
    s_add_u32 s60, s59, 12288
    ds_read_b128 v[12:15], v52
    ds_read_b64 v[16:17], v53
    s_waitcnt lgkmcnt(1)
    v_smfmac_f32_16x16x64_bf16 v[20:23], v[12:15], v[28:35], v1
    v_smfmac_f32_16x16x64_bf16 v[24:27], v[12:15], v[40:47], v1
    s_waitcnt lgkmcnt(0)
    v_smfmac_f32_16x16x32_bf16 v[20:23], v[16:17], v[36:39], v1
    v_smfmac_f32_16x16x32_bf16 v[24:27], v[16:17], v[48:51], v1
    s_cmp_eq_u32 s55, 0
    s_nop 5
    v_add_f32 v12, v20, v22
    s_nop 1
    v_add_f32_dpp v12, v24, v26 quad_perm:[0,1,2,3] row_mask:0x2 bank_mask:0xf
    s_nop 1
    v_add_f32_dpp v12, v21, v23 quad_perm:[0,1,2,3] row_mask:0x4 bank_mask:0xf
    s_nop 1
    v_add_f32_dpp v12, v25, v27 quad_perm:[0,1,2,3] row_mask:0x8 bank_mask:0xf
    s_cbranch_scc1 L_gs_73
    buffer_store_dword v12, v54, s[40:43], s59 offen
L_gb_74:
L_skip_72:
    s_waitcnt vmcnt(0)
    s_barrier
    s_cmp_eq_u32 s30, 5
    s_cbranch_scc0 L_skip_75
    v_mov_b32 v25, 0
    s_lshl_b32 s57, s52, 2
    s_add_u32 s57, s57, s72
    s_mov_b64 exec, 1
    buffer_store_dword v25, v0, s[40:43], s57 offen offset:256 sc1
    s_mov_b64 exec, -1
    v_and_b32 v16, 31, v0
    v_lshlrev_b32 v16, 2, v16
L_pr_77:
    buffer_load_dword v17, v16, s[40:43], s72 offen offset:256 sc1
    s_sub_u32 s56, s56, 1
    s_cbranch_scc1 L_done
L_pw_76:
    s_waitcnt vmcnt(0)
    v_cmp_eq_u32 vcc, -1, v17
    s_cbranch_vccnz L_pr_77
L_skip_75:
    s_barrier
    s_branch L_spread_back
    s_nop 0
    s_nop 0
L_done:
L_exit:
    s_endpgm
.section .rodata,"a"
.p2align 6
.amdhsa_kernel interleave_layers__sliding_block_cached__dense_activation_gelu__decode_kernel
  .amdhsa_next_free_vgpr 256
  .amdhsa_next_free_sgpr 102
  .amdhsa_accum_offset 256
  .amdhsa_group_segment_fixed_size 0
  .amdhsa_kernarg_size 104
  .amdhsa_user_sgpr_count 2
  .amdhsa_user_sgpr_kernarg_segment_ptr 1
  .amdhsa_system_sgpr_workgroup_id_x 1
  .amdhsa_float_denorm_mode_32 3
.end_amdhsa_kernel
```

```asm
; @launch grid=(256,1,1) block=(512,1,1) lds=161216
.amdgcn_target "amdgcn-amd-amdhsa--gfx950"
.text
.fill 64, 4, 0xbf800000
.globl interleave_layers__sliding_block_cached__dense_activation_gelu__decode_kernel
.p2align 8
.type interleave_layers__sliding_block_cached__dense_activation_gelu__decode_kernel,@function
interleave_layers__sliding_block_cached__dense_activation_gelu__decode_kernel:
    s_load_dwordx16 s[4:19], s[0:1], 0
    s_cmp_ge_u32 s2, 256
    s_cbranch_scc1 L_exit
    v_lshrrev_b32 v5, 6, v0
    v_lshlrev_b32 v62, 6, v0
    v_readfirstlane_b32 s30, v5
    v_and_b32 v0, 63, v0
    s_getpc_b64 s[74:75]
L_pc:
    v_min_u32 v62, L_exit-L_pc, v62
    global_load_dword v63, v62, s[74:75]
    s_cmp_eq_u32 s30, 6
    s_cbranch_scc0 L_skip_1
    s_setprio 3
L_skip_1:
    s_and_b32 s31, s2, 7
    s_lshr_b32 s52, s2, 3
    s_and_b32 s53, s52, 3
    s_lshr_b32 s54, s52, 2
    s_lshl_b32 s73, s31, 2
    s_add_u32 s73, s73, s53
    v_lshrrev_b32 v8, 5, v0
    v_lshlrev_b32 v8, 2, v8
    v_bfe_u32 v60, v0, 4, 1
    v_lshl_add_u32 v8, v60, 0, v8
    v_and_b32 v9, 7, v0
    v_xor_b32 v8, v8, v9
    v_lshrrev_b32 v10, 3, v0
    v_mul_u32_u24 v10, 384, v10
    v_lshl_add_u32 v5, v8, 4, v10
    v_xor_b32 v6, 32, v5
    s_mul_i32 s64, s73, 12582912
    s_mul_i32 s58, s54, 3072
    s_add_u32 s64, s64, s58
    s_add_u32 s64, s64, 11010048
    s_sub_u32 s34, 1572864, s58
    s_mov_b32 s35, 0x20000
    s_mov_b32 s57, 0
    s_mov_b32 s58, 195584
    s_mov_b32 m0, 92160
    s_cmp_eq_u32 s30, 6
    s_cselect_b64 vcc, -1, 0
    s_waitcnt lgkmcnt(0)
    s_add_u32 s32, s6, s64
    s_addc_u32 s33, s7, 0
    s_load_dwordx8 s[20:27], s[0:1], 64
    s_load_dwordx2 s[28:29], s[0:1], 96
    s_cbranch_vccz L_skip_3
L_dma_2:
    buffer_load_dwordx4 v5, s[32:35], s57 offen offset:0 nt lds
    buffer_load_dwordx4 v6, s[32:35], s58 offen offset:1024 nt lds
    s_add_u32 s57, s57, 24576
    s_add_u32 s58, s58, 24576
    s_add_u32 m0, m0, 2048
    s_cmp_lg_u32 m0, 108544
    s_cbranch_scc1 L_dma_2
    s_mov_b32 s57, 128
    s_mov_b32 s58, 195712
    s_mov_b32 m0, 108544
L_dma_4:
    s_nop 0
    buffer_load_dwordx4 v5, s[32:35], s57 offen offset:0 nt lds
    buffer_load_dwordx4 v6, s[32:35], s58 offen offset:1024 nt lds
    s_add_u32 s57, s57, 24576
    s_add_u32 s58, s58, 24576
    s_add_u32 m0, m0, 2048
    s_cmp_lg_u32 m0, 116736
    s_cbranch_scc1 L_dma_4
L_skip_3:
    s_mul_i32 s3, s54, 3
    s_add_u32 s3, s3, s53
    s_cmp_eq_u32 s53, 3
    s_cselect_b32 s3, 31, s3
    v_lshrrev_b32 v8, 4, v0
    v_lshlrev_b32 v8, 1, v8
    v_xor_b32 v8, v8, v9
    v_lshl_add_u32 v7, v8, 4, v10
    v_lshrrev_b32 v2, 3, v0
    v_mul_u32_u24 v2, 12288, v2
    v_and_b32 v60, 7, v0
    v_lshl_add_u32 v2, v60, 4, v2
    s_mul_i32 s59, s73, 384
    s_mul_i32 s60, s54, 983040
    s_add_u32 s59, s59, s60
    s_sub_u32 s60, 7866368, s59
    s_lshl_b32 s61, s30, 11
    s_add_u32 s61, s61, 92160
    s_mul_i32 s62, s31, 120832
    s_add_u32 s62, s62, 299008
    s_lshl_b32 s72, s31, 9
    s_add_u32 s72, s72, 294912
    s_mov_b32 s56, 65536
    s_mov_b32 s55, 1
    s_getreg_b32 s63, hwreg(20, 0, 3)
    v_mov_b32 v3, 0
    v_mov_b32 v4, 0
    v_mov_b32 v11, 0
    v_mov_b32 v24, 0
    v_mov_b32 v34, 0
    v_mov_b64 v[12:13], -1
    v_mov_b64 v[14:15], -1
    v_lshlrev_b32 v10, 4, v0
    s_waitcnt lgkmcnt(0)
    s_add_u32 s36, s8, s64
    s_addc_u32 s37, s9, 0
    s_mov_b32 s38, s34
    s_mov_b32 s39, 0x20000
    s_mov_b32 s40, s28
    s_mov_b32 s41, s29
    s_mov_b32 s42, 2232320
    s_mov_b32 s43, 0x20000
    s_add_u32 s44, s10, s59
    s_addc_u32 s45, s11, 0
    s_mov_b32 s46, s60
    s_mov_b32 s47, 0x20000
    s_sub_u32 s44, s44, 2048
    s_subb_u32 s45, s45, 0
    s_cmp_eq_u32 s30, 6
    s_cbranch_scc0 L_skip_5
    s_mov_b32 s57, 98432
    s_mov_b32 s58, 294016
    s_mov_b32 m0, 116736
L_dma_6:
    s_waitcnt vmcnt(22)
    buffer_load_dwordx4 v5, s[32:35], s57 offen offset:0 nt lds
    buffer_load_dwordx4 v6, s[32:35], s58 offen offset:1024 nt lds
    s_add_u32 s57, s57, 24576
    s_add_u32 s58, s58, 24576
    s_add_u32 m0, m0, 2048
    s_cmp_lg_u32 m0, 124928
    s_cbranch_scc1 L_dma_6
    s_mov_b32 s57, 2048
    s_mov_b32 s58, 1152
    s_mov_b32 s59, 256
    s_mov_b32 m0, 0
L_dma_7:
    s_waitcnt vmcnt(22)
    buffer_load_dwordx4 v2, s[44:47], s57 offen offset:0 nt lds
    buffer_load_dwordx4 v2, s[44:47], s58 offen offset:1024 nt lds
    buffer_load_dwordx4 v2, s[44:47], s59 offen offset:2048 nt lds
    s_add_u32 s57, s57, 98304
    s_add_u32 s58, s58, 98304
    s_add_u32 s59, s59, 98304
    s_add_u32 m0, m0, 3072
    s_cmp_lg_u32 m0, 15360
    s_cbranch_scc1 L_dma_7
L_skip_5:
    s_cmp_lt_u32 s3, 20
    s_cselect_b32 s57, 7864320, 0
    s_add_u32 s58, s54, 1
    s_mul_i32 s58, s58, 245760
    s_cmp_lg_u32 s53, 3
    s_cselect_b64 s[48:49], s[12:13], s[16:17]
    s_cselect_b32 s50, s57, s58
    s_mov_b32 s51, 0x20000
    s_add_u32 s57, s28, 0
    s_sub_u32 s57, 0, s57
    s_and_b32 s57, s57, 0x3fff
    s_add_u32 s57, s57, 0
    s_lshr_b32 s58, s31, 1
    s_lshl_b32 s58, s58, 14
    s_add_u32 s6, s57, s58
    s_and_b32 s58, s31, 1
    s_lshl_b32 s58, s58, 12
    s_add_u32 s6, s6, s58
    s_lshl_b32 s58, s3, 7
    s_add_u32 s6, s6, s58
    s_mov_b32 s8, s57
    s_and_b32 s59, s3, 3
    s_lshl_b32 s58, s31, 2
    s_add_u32 s59, s59, s58
    s_lshl_b32 s59, s59, 7
    s_add_u32 s59, s59, s57
    s_add_u32 s59, s59, 262144
    s_add_u32 s10, s28, s59
    s_addc_u32 s11, s29, 0
    s_lshr_b32 s58, s63, 2
    s_xor_b32 s58, s58, 0
    s_mul_i32 s58, s58, 8192
    s_add_u32 s7, s57, s58
    s_cmp_eq_u32 s30, 5
    s_cbranch_scc0 L_skip_8
    s_cmp_eq_u32 s52, 31
    s_cbranch_scc0 L_skip_9
    s_mov_b64 exec, 0xffffff
    buffer_store_dwordx4 v[12:15], v10, s[40:43], s72 offen sc1
    s_mov_b64 exec, -1
L_skip_9:
    s_cmp_lt_u32 s3, 20
    s_cbranch_scc0 L_skip_10
    v_and_b32 v16, 7, v0
    v_lshlrev_b32 v16, 4, v16
    v_bfe_u32 v17, v0, 3, 1
    v_lshl_add_u32 v16, v17, 13, v16
    v_lshrrev_b32 v17, 4, v0
    v_mul_u32_u24 v17, 66048, v17
    v_add_u32 v16, v17, v16
    s_add_u32 s57, s6, 0
    buffer_store_dwordx4 v[12:15], v16, s[40:43], s57 offen sc1
L_skip_10:
    s_cmp_eq_u32 s3, 20
    s_cbranch_scc0 L_skip_11
    s_lshl_b32 s58, s31, 9
    s_add_u32 s58, s58, s8
    s_add_u32 s58, s58, 266240
    v_and_b32 v16, 7, v0
    v_lshlrev_b32 v16, 4, v16
    v_bfe_u32 v60, v0, 3, 1
    v_lshl_add_u32 v16, v60, 13, v16
    v_lshrrev_b32 v60, 4, v0
    v_lshl_add_u32 v16, v60, 28, v16
    buffer_store_dwordx4 v[12:15], v16, s[40:43], s58 offen sc1
L_skip_11:
    s_sub_u32 s58, s3, 20
    s_cmp_lt_u32 s58, 4
    s_cselect_b32 s59, s59, 0x7f000000
    v_and_b32 v16, 7, v0
    v_lshlrev_b32 v16, 4, v16
    v_bfe_u32 v60, v0, 3, 1
    v_lshl_add_u32 v16, v60, 13, v16
    v_lshrrev_b32 v60, 4, v0
    v_lshl_add_u32 v16, v60, 28, v16
    buffer_store_dwordx4 v[12:15], v16, s[40:43], s59 offen sc1
    s_mul_i32 s57, s52, 2208
    s_add_u32 s57, s57, s62
    s_mov_b64 exec, 0x3ff
    buffer_store_dwordx4 v[12:15], v10, s[40:43], s57 offen offset:2048
    s_mov_b64 exec, -1
    buffer_store_dwordx4 v[12:15], v10, s[40:43], s57 offen offset:0
    buffer_store_dwordx4 v[12:15], v10, s[40:43], s57 offen offset:1024
    s_mov_b64 exec, -1
    v_lshlrev_b32 v16, 4, v0
    v_add_u32 v16, 159744, v16
    ds_write_b128 v16, v[12:15]
    v_and_b32 v3, 7, v0
    v_lshlrev_b32 v3, 5, v3
L_skip_8:
    s_cmp_eq_u32 s30, 7
    s_cbranch_scc0 L_skip_12
    v_and_b32 v60, 31, v0
    v_min_u32 v60, 19, v60
    s_mul_i32 s57, s54, 160
    v_lshrrev_b32 v16, 5, v0
    v_lshlrev_b32 v16, 2, v16
    v_add_u32 v16, s57, v16
    v_lshl_add_u32 v16, v60, 3, v16
    global_load_dword v28, v16, s[4:5]
    global_load_dword v4, v16, s[22:23]
L_skip_12:
    s_sub_u32 s58, s30, 4
    s_cmp_lt_u32 s58, 3
    s_cbranch_scc0 L_skip_13
    s_mul_i32 s57, s31, 3
    s_add_u32 s57, s57, s58
    s_lshl_b32 s57, s57, 7
    v_and_b32 v16, 15, v0
    v_lshlrev_b32 v16, 3, v16
    v_lshrrev_b32 v60, 4, v0
    v_lshl_add_u32 v16, v60, 1, v16
    v_add_u32 v16, s57, v16
    global_load_short_d16_hi v4, v16, s[18:19]
L_skip_13:
    v_bfe_u32 v8, v0, 1, 3
    v_lshrrev_b32 v9, 4, v0
    v_xor_b32 v9, v8, v9
    v_bfe_u32 v8, v0, 2, 1
    v_lshlrev_b32 v8, 10, v8
    v_bfe_u32 v60, v0, 3, 1
    v_lshl_add_u32 v8, v60, 9, v8
    v_and_b32 v60, 3, v0
    v_lshl_add_u32 v8, v60, 7, v8
    v_add_u32 v8, s61, v8
    v_lshl_add_u32 v8, v9, 4, v8
    v_xor_b32 v9, 64, v8
    v_bfe_u32 v1, v0, 1, 1
    v_mul_u32_u24 v1, 43690, v1
    v_add_u32 v1, 17476, v1
    s_waitcnt vmcnt(31)
    s_barrier
    ds_read_b128 v[64:67], v8 offset:0
    ds_read_b128 v[68:71], v9 offset:0
    s_cmp_eq_u32 s30, 6
    s_cbranch_scc0 L_skip_14
    s_mov_b32 s57, 256
    s_mov_b32 s58, 195840
    s_mov_b32 m0, 124928
L_dma_15:
    s_waitcnt vmcnt(22)
    buffer_load_dwordx4 v5, s[32:35], s57 offen offset:0 nt lds
    buffer_load_dwordx4 v6, s[32:35], s58 offen offset:1024 nt lds
    s_add_u32 s57, s57, 24576
    s_add_u32 s58, s58, 24576
    s_add_u32 m0, m0, 2048
    s_cmp_lg_u32 m0, 141312
    s_cbranch_scc1 L_dma_15
L_skip_14:
    s_waitcnt lgkmcnt(0)
    s_cmp_eq_u32 s30, 5
    s_cbranch_scc0 L_skip_16
    s_cmp_eq_u32 s52, 31
    s_cbranch_scc0 L_skip_17
    s_lshl_b32 s57, s31, 5
    v_mov_b32 v16, s57
    s_add_u32 s57, s63, 1
    v_mov_b32 v12, s57
    s_waitcnt vmcnt(5)
    s_mov_b64 exec, 0x1
    global_store_dword v16, v12, s[26:27] sc1
    s_mov_b64 exec, -1
L_skip_17:
L_skip_16:
    s_waitcnt vmcnt(31)
    s_barrier
    ds_read_b128 v[72:75], v8 offset:16384
    ds_read_b128 v[76:79], v9 offset:16384
    s_cmp_eq_u32 s30, 6
    s_cbranch_scc0 L_skip_18
    s_mov_b32 s57, 493568
    s_mov_b32 s58, 492672
    s_mov_b32 s59, 491776
    s_mov_b32 m0, 15360
L_dma_19:
    s_waitcnt vmcnt(22)
    buffer_load_dwordx4 v2, s[44:47], s57 offen offset:0 nt lds
    buffer_load_dwordx4 v2, s[44:47], s58 offen offset:1024 nt lds
    buffer_load_dwordx4 v2, s[44:47], s59 offen offset:2048 nt lds
    s_add_u32 s57, s57, 98304
    s_add_u32 s58, s58, 98304
    s_add_u32 s59, s59, 98304
    s_add_u32 m0, m0, 3072
    s_cmp_lg_u32 m0, 30720
    s_cbranch_scc1 L_dma_19
    s_mov_b32 s57, 393216
    s_mov_b32 s58, 588800
    s_mov_b32 m0, 141312
L_dma_20:
    s_waitcnt vmcnt(22)
    buffer_load_dwordx4 v5, s[32:35], s57 offen offset:0 nt lds
    buffer_load_dwordx4 v6, s[32:35], s58 offen offset:1024 nt lds
    s_add_u32 s57, s57, 24576
    s_add_u32 s58, s58, 24576
    s_add_u32 m0, m0, 2048
    s_cmp_lg_u32 m0, 157696
    s_cbranch_scc1 L_dma_20
L_skip_18:
    s_waitcnt lgkmcnt(0)
    s_cmp_lt_u32 s30, 4
    s_cbranch_scc0 L_skip_21
    s_mov_b64 exec, 0
    s_cmp_eq_u32 s30, 1
    s_cbranch_scc1 L_pad1
    s_cmp_eq_u32 s30, 2
    s_cbranch_scc1 L_pad2
    s_cmp_eq_u32 s30, 3
    s_cbranch_scc1 L_pad3
    s_branch L_pad0
.p2align 5
L_padback:
    s_mov_b64 exec, -1
L_skip_21:
    s_waitcnt vmcnt(31)
    s_barrier
    ds_read_b128 v[80:83], v8 offset:32768
    ds_read_b128 v[84:87], v9 offset:32768
    s_cmp_eq_u32 s30, 6
    s_cbranch_scc0 L_skip_22
    s_cmp_lg_u32 s53, 3
    s_cbranch_scc0 L_wb_23
    s_mul_i32 s57, s31, 983040
    s_lshl_b32 s58, s3, 6
    s_add_u32 s57, s57, s58
    v_bfe_u32 v38, v0, 4, 1
    v_lshlrev_b32 v38, 1, v38
    v_xor_b32 v38, v38, v0
    v_and_b32 v38, 3, v38
    v_lshrrev_b32 v3, 5, v0
    v_mul_u32_u24 v3, 10240, v3
    v_bfe_u32 v39, v0, 4, 1
    v_mul_u32_u24 v39, 2560, v39
    v_add_u32 v3, v39, v3
    v_bfe_u32 v39, v0, 3, 1
    v_mul_u32_u24 v39, 5120, v39
    v_add_u32 v3, v39, v3
    v_bfe_u32 v39, v0, 2, 1
    v_mul_u32_u24 v39, 20480, v39
    v_add_u32 v3, v39, v3
    v_add_u32 v3, s57, v3
    v_lshl_add_u32 v3, v38, 4, v3
    s_mov_b32 s14, 40960
    s_mov_b32 s15, 256
    s_branch L_we_24
.p2align 5
L_wb_23:
    s_mul_i32 s57, s31, 384
    s_mul_i32 s58, s54, 245760
    s_add_u32 s57, s57, s58
    v_lshlrev_b32 v3, 4, v0
    v_add_u32 v3, s57, v3
    v_mov_b32 v38, 2688
    v_cmp_lt_u32 vcc, 23, v0
    s_nop 1
    v_cndmask_b32 v38, 0, v38, vcc
    v_add_u32 v3, v38, v3
    v_mov_b32 v38, 0x7f000000
    v_cmp_lt_u32 vcc, 47, v0
    s_nop 1
    v_cndmask_b32 v3, v3, v38, vcc
    s_mov_b32 s14, 12288
    s_mov_b32 s15, 5120
L_we_24:
    s_mul_i32 s57, s14, 0
    s_mov_b32 m0, 30720
    s_nop 0
    buffer_load_dwordx4 v3, s[48:51], s57 offen offset:0 nt lds
    s_mul_i32 s57, s14, 0
    s_add_u32 s57, s57, s15
    s_mov_b32 m0, 30720
    s_nop 0
    buffer_load_dwordx4 v3, s[48:51], s57 offen offset:1024 nt lds
    s_mov_b32 s57, 393344
    s_mov_b32 s58, 588928
    s_mov_b32 m0, 92160
L_dma_25:
    s_waitcnt vmcnt(22)
    buffer_load_dwordx4 v5, s[32:35], s57 offen offset:0 nt lds
    buffer_load_dwordx4 v6, s[32:35], s58 offen offset:1024 nt lds
    s_add_u32 s57, s57, 24576
    s_add_u32 s58, s58, 24576
    s_add_u32 m0, m0, 2048
    s_cmp_lg_u32 m0, 108544
    s_cbranch_scc1 L_dma_25
    s_mul_i32 s57, s14, 1
    s_mov_b32 m0, 32768
    s_nop 0
    buffer_load_dwordx4 v3, s[48:51], s57 offen offset:0 nt lds
    s_mul_i32 s57, s14, 1
    s_add_u32 s57, s57, s15
    s_mov_b32 m0, 32768
    s_nop 0
    buffer_load_dwordx4 v3, s[48:51], s57 offen offset:1024 nt lds
    s_mov_b32 s57, 393472
    s_mov_b32 s58, 589056
    s_mov_b32 m0, 108544
L_dma_26:
    s_waitcnt vmcnt(22)
    buffer_load_dwordx4 v5, s[32:35], s57 offen offset:0 nt lds
    buffer_load_dwordx4 v6, s[32:35], s58 offen offset:1024 nt lds
    s_add_u32 s57, s57, 24576
    s_add_u32 s58, s58, 24576
    s_add_u32 m0, m0, 2048
    s_cmp_lg_u32 m0, 124928
    s_cbranch_scc1 L_dma_26
L_skip_22:
    s_waitcnt lgkmcnt(0)
    s_cmp_lt_u32 s30, 5
    s_cbranch_scc0 L_skip_27
    s_waitcnt vmcnt(0)
L_skip_27:
    s_cmp_eq_u32 s30, 7
    s_cbranch_scc0 L_skip_28
    v_and_b32 v60, 31, v0
    v_cmp_gt_u32 s[64:65], 20, v60
    v_min_u32 v60, 19, v60
    v_lshrrev_b32 v35, 5, v0
    v_lshlrev_b32 v35, 2, v35
    v_add_u32 v35, 160832, v35
    v_lshl_add_u32 v35, v60, 3, v35
    s_mul_i32 s66, s53, 12416
    s_add_u32 s66, s66, s62
    s_add_u32 s66, s66, 70656
    s_add_u32 s67, s66, 12288
    s_lshl_b32 s57, s54, 3
    v_lshrrev_b32 v34, 5, v0
    v_lshlrev_b32 v34, 2, v34
    v_add_u32 v34, s57, v34
    v_and_b32 v60, 31, v0
    v_mov_b32 v61, 0x7f000000
    v_cmp_ne_u32 vcc, 31, v60
    s_nop 1
    v_cndmask_b32 v34, v34, v61, vcc
    v_mov_b32 v61, 0x3f803f80
    s_waitcnt vmcnt(0)
    ds_write_b32 v35, v28
    s_waitcnt lgkmcnt(0)
L_skip_28:
    s_cmp_eq_u32 s30, 5
    s_cbranch_scc0 L_skip_29
    s_waitcnt vmcnt(0)
    s_lshr_b32 s67, s63, 2
    s_sub_u32 s58, s3, 20
    s_cmp_lt_u32 s58, 4
    s_cbranch_scc0 L_skip_30
    s_mov_b32 s67, 0
    s_load_dword s66, s[10:11], 0
    s_load_dword s67, s[10:11], 8192
    s_waitcnt lgkmcnt(1)
L_skip_30:
    v_subrev_u32 v16, 8, v0
    v_cmp_gt_u32 vcc, 40, v16
    v_mov_b32 v16, 0x3f803f80
    s_nop 0
    v_cndmask_b32 v18, 0, v16, vcc
    v_min_u32 v16, 55, v0
    v_lshlrev_b32 v16, 2, v16
    v_add_u32 v16, 160992, v16
    ds_write_b32 v16, v18
    s_mov_b32 s65, s67
    s_waitcnt lgkmcnt(0)
L_skip_29:
    s_waitcnt vmcnt(36)
    s_barrier
    ds_read_b128 v[88:91], v8 offset:49152
    ds_read_b128 v[92:95], v9 offset:49152
    s_cmp_eq_u32 s30, 6
    s_cbranch_scc0 L_skip_31
    s_mul_i32 s57, s14, 2
    s_mov_b32 m0, 34816
    s_nop 0
    buffer_load_dwordx4 v3, s[48:51], s57 offen offset:0 nt lds
    s_mul_i32 s57, s14, 2
    s_add_u32 s57, s57, s15
    s_mov_b32 m0, 34816
    s_nop 0
    buffer_load_dwordx4 v3, s[48:51], s57 offen offset:1024 nt lds
    s_mov_b32 s57, 786432
    s_mov_b32 s58, 982016
    s_mov_b32 m0, 124928
L_dma_32:
    s_waitcnt vmcnt(22)
    buffer_load_dwordx4 v5, s[32:35], s57 offen offset:0 nt lds
    buffer_load_dwordx4 v6, s[32:35], s58 offen offset:1024 nt lds
    s_add_u32 s57, s57, 24576
    s_add_u32 s58, s58, 24576
    s_add_u32 m0, m0, 2048
    s_cmp_lg_u32 m0, 141312
    s_cbranch_scc1 L_dma_32
L_skip_31:
    s_waitcnt lgkmcnt(0)
    s_cmp_eq_u32 s30, 7
    s_cbranch_scc0 L_skip_33
    v_cndmask_b32 v29, 0, v28, s[64:65]
    v_dot2_f32_bf16 v33, v29, v61, 0
    v_dot2_f32_bf16 v32, v29, v29, 0
    v_lshlrev_b32 v2, 16, v28
    v_and_b32 v3, 0xffff0000, v28
    s_cmp_eq_u32 s55, 0
    v_permlane32_swap_b32 v33, v32
    v_add_f32 v33, v33, v32
    s_nop 1
    v_add_f32_dpp v33, v33, v33 row_ror:8 row_mask:0xf bank_mask:0xf
    s_nop 1
    v_add_f32_dpp v33, v33, v33 row_ror:4 row_mask:0xf bank_mask:0xf
    s_nop 1
    v_add_f32_dpp v33, v33, v33 row_ror:2 row_mask:0xf bank_mask:0xf
    s_nop 1
    v_add_f32_dpp v33, v33, v33 row_ror:1 row_mask:0xf bank_mask:0xf
    s_nop 1
    v_add_f32_dpp v33, v33, v33 row_bcast:15 row_mask:0xa bank_mask:0xf
    s_cbranch_scc1 L_gs_34
    buffer_store_dword v33, v34, s[40:43], s67 offen
L_gb_35:
    s_waitcnt vmcnt(1)
L_skip_33:
    s_cmp_lt_u32 s30, 6
    s_cbranch_scc0 L_skip_36
    s_lshr_b32 s57, s30, 1
    s_mul_i32 s57, s57, 1024
    s_and_b32 s58, s30, 1
    s_lshl_b32 s58, s58, 6
    s_add_u32 s57, s57, s58
    v_lshrrev_b32 v18, 5, v0
    v_mul_u32_u24 v18, 6144, v18
    v_bfe_u32 v60, v0, 3, 1
    v_mul_u32_u24 v60, 3072, v60
    v_add_u32 v18, v60, v18
    v_bfe_u32 v60, v0, 4, 1
    v_lshl_add_u32 v18, v60, 9, v18
    v_bfe_u32 v60, v0, 2, 1
    v_lshl_add_u32 v18, v60, 7, v18
    v_and_b32 v60, 3, v0
    v_lshl_add_u32 v18, v60, 3, v18
    v_add_u32 v18, s57, v18
    v_bfe_u32 v19, v0, 4, 1
    v_mul_u32_u24 v19, 3072, v19
    v_bfe_u32 v60, v0, 3, 1
    v_lshl_add_u32 v19, v60, 9, v19
    v_bfe_u32 v60, v0, 2, 1
    v_lshl_add_u32 v19, v60, 7, v19
    v_and_b32 v60, 3, v0
    v_lshl_add_u32 v19, v60, 3, v19
    v_add_u32 v19, s57, v19
    v_add_u32 v19, 24576, v19
    ds_read_b64_tr_b16 v[28:29], v18 offset:0
    ds_read_b64_tr_b16 v[30:31], v18 offset:256
    ds_read_b64_tr_b16 v[32:33], v18 offset:12288
    ds_read_b64_tr_b16 v[34:35], v18 offset:12544
    ds_read_b64_tr_b16 v[36:37], v19 offset:0
    ds_read_b64_tr_b16 v[38:39], v19 offset:256
    ds_read_b64_tr_b16 v[40:41], v18 offset:32
    ds_read_b64_tr_b16 v[42:43], v18 offset:288
    ds_read_b64_tr_b16 v[44:45], v18 offset:12320
    ds_read_b64_tr_b16 v[46:47], v18 offset:12576
    ds_read_b64_tr_b16 v[48:49], v19 offset:32
    ds_read_b64_tr_b16 v[50:51], v19 offset:288
    v_lshrrev_b32 v52, 4, v0
    v_lshlrev_b32 v52, 5, v52
    v_bfe_u32 v60, v0, 1, 1
    v_lshl_add_u32 v52, v60, 4, v52
    v_and_b32 v60, 1, v0
    v_mul_u32_u24 v60, 192, v60
    v_add_u32 v52, v60, v52
    v_add_u32 v52, 160832, v52
    v_lshrrev_b32 v53, 4, v0
    v_lshlrev_b32 v53, 4, v53
    v_bfe_u32 v60, v0, 1, 1
    v_lshl_add_u32 v53, v60, 3, v53
    v_and_b32 v60, 1, v0
    v_mul_u32_u24 v60, 192, v60
    v_add_u32 v53, v60, v53
    v_add_u32 v53, 160960, v53
    v_mov_b64 v[20:21], 0
    v_mov_b64 v[22:23], 0
    v_mov_b64 v[24:25], 0
    v_mov_b64 v[26:27], 0
    s_lshr_b32 s57, s30, 1
    s_lshl_b32 s57, s57, 11
    s_lshl_b32 s58, s58, 1
    s_add_u32 s57, s57, s58
    s_lshl_b32 s58, s54, 8
    s_add_u32 s57, s57, s58
    v_and_b32 v54, 31, v0
    v_lshlrev_b32 v54, 2, v54
    v_lshrrev_b32 v60, 5, v0
    v_mul_u32_u24 v60, 6144, v60
    v_add_u32 v54, v60, v54
    v_add_u32 v54, s57, v54
    s_mul_i32 s59, s53, 12416
    s_add_u32 s59, s59, s62
    s_add_u32 s59, s59, 70656
    s_add_u32 s60, s59, 12288
    ds_read_b128 v[12:15], v52
    ds_read_b64 v[16:17], v53
    s_waitcnt lgkmcnt(1)
    v_smfmac_f32_16x16x64_bf16 v[20:23], v[12:15], v[28:35], v1
    v_smfmac_f32_16x16x64_bf16 v[24:27], v[12:15], v[40:47], v1
    s_waitcnt lgkmcnt(0)
    v_smfmac_f32_16x16x32_bf16 v[20:23], v[16:17], v[36:39], v1
    v_smfmac_f32_16x16x32_bf16 v[24:27], v[16:17], v[48:51], v1
    s_cmp_eq_u32 s55, 0
    s_nop 5
    v_add_f32 v12, v20, v22
    s_nop 1
    v_add_f32_dpp v12, v24, v26 quad_perm:[0,1,2,3] row_mask:0x2 bank_mask:0xf
    s_nop 1
    v_add_f32_dpp v12, v21, v23 quad_perm:[0,1,2,3] row_mask:0x4 bank_mask:0xf
    s_nop 1
    v_add_f32_dpp v12, v25, v27 quad_perm:[0,1,2,3] row_mask:0x8 bank_mask:0xf
    s_cbranch_scc1 L_gs_37
    buffer_store_dword v12, v54, s[40:43], s59 offen
L_gb_38:
L_skip_36:
    s_cmp_eq_u32 s30, 5
    s_cbranch_scc0 L_skip_39
    global_load_dword v2, v3, s[26:27] sc1
L_skip_39:
    s_waitcnt vmcnt(36)
    s_barrier
    ds_read_b128 v[96:99], v8 offset:0
    ds_read_b128 v[100:103], v9 offset:0
    s_cmp_eq_u32 s30, 6
    s_cbranch_scc0 L_skip_40
    s_mul_i32 s57, s14, 3
    s_mov_b32 m0, 36864
    s_nop 0
    buffer_load_dwordx4 v3, s[48:51], s57 offen offset:0 nt lds
    s_mul_i32 s57, s14, 3
    s_add_u32 s57, s57, s15
    s_mov_b32 m0, 36864
    s_nop 0
    buffer_load_dwordx4 v3, s[48:51], s57 offen offset:1024 nt lds
    s_mov_b32 s57, 786560
    s_mov_b32 s58, 982144
    s_mov_b32 m0, 141312
L_dma_41:
    s_waitcnt vmcnt(22)
    buffer_load_dwordx4 v5, s[32:35], s57 offen offset:0 nt lds
    buffer_load_dwordx4 v6, s[32:35], s58 offen offset:1024 nt lds
    s_add_u32 s57, s57, 24576
    s_add_u32 s58, s58, 24576
    s_add_u32 m0, m0, 2048
    s_cmp_lg_u32 m0, 157696
    s_cbranch_scc1 L_dma_41
L_skip_40:
    s_waitcnt lgkmcnt(0)
    s_waitcnt vmcnt(36)
    s_barrier
    ds_read_b128 v[104:107], v8 offset:16384
    ds_read_b128 v[108:111], v9 offset:16384
    s_cmp_eq_u32 s30, 6
    s_cbranch_scc0 L_skip_42
    s_mul_i32 s57, s14, 4
    s_mov_b32 m0, 38912
    s_nop 0
    buffer_load_dwordx4 v3, s[48:51], s57 offen offset:0 nt lds
    s_mul_i32 s57, s14, 4
    s_add_u32 s57, s57, s15
    s_mov_b32 m0, 38912
    s_nop 0
    buffer_load_dwordx4 v3, s[48:51], s57 offen offset:1024 nt lds
    s_mov_b32 s57, 786688
    s_mov_b32 s58, 982272
    s_mov_b32 m0, 92160
L_dma_43:
    s_waitcnt vmcnt(22)
    buffer_load_dwordx4 v5, s[32:35], s57 offen offset:0 nt lds
    buffer_load_dwordx4 v6, s[32:35], s58 offen offset:1024 nt lds
    s_add_u32 s57, s57, 24576
    s_add_u32 s58, s58, 24576
    s_add_u32 m0, m0, 2048
    s_cmp_lg_u32 m0, 108544
    s_cbranch_scc1 L_dma_43
L_skip_42:
    s_waitcnt lgkmcnt(0)
    s_cmp_lg_u32 s30, 6
    s_cbranch_scc0 L_skip_44
    s_waitcnt vmcnt(0)
L_skip_44:
    s_waitcnt vmcnt(36)
    s_barrier
    ds_read_b128 v[112:115], v8 offset:32768
    ds_read_b128 v[116:119], v9 offset:32768
    s_cmp_eq_u32 s30, 6
    s_cbranch_scc0 L_skip_45
    s_mul_i32 s57, s14, 5
    s_mov_b32 m0, 40960
    s_nop 0
    buffer_load_dwordx4 v3, s[48:51], s57 offen offset:0 nt lds
    s_mul_i32 s57, s14, 5
    s_add_u32 s57, s57, s15
    s_mov_b32 m0, 40960
    s_nop 0
    buffer_load_dwordx4 v3, s[48:51], s57 offen offset:1024 nt lds
    s_mov_b32 s57, 1179648
    s_mov_b32 s58, 1375232
    s_mov_b32 m0, 108544
L_dma_46:
    s_waitcnt vmcnt(22)
    buffer_load_dwordx4 v5, s[32:35], s57 offen offset:0 nt lds
    buffer_load_dwordx4 v6, s[32:35], s58 offen offset:1024 nt lds
    s_add_u32 s57, s57, 24576
    s_add_u32 s58, s58, 24576
    s_add_u32 m0, m0, 2048
    s_cmp_lg_u32 m0, 124928
    s_cbranch_scc1 L_dma_46
L_skip_45:
    s_waitcnt lgkmcnt(0)
    s_cmp_eq_u32 s30, 5
    s_cbranch_scc0 L_skip_47
L_cw_48:
    v_readlane_b32 s57, v2, s31
    s_cmp_eq_u32 s57, 0
    s_cbranch_scc1 L_cr_49
    s_lshr_b32 s58, s63, 2
    s_xor_b32 s58, s58, s65
    s_and_b32 s58, s58, 1
    v_mov_b32 v25, s58
    s_sub_u32 s57, s57, 1
    s_cmp_eq_u32 s57, s63
    s_cselect_b32 s64, 1, 0
    s_cbranch_scc0 L_far_50
    s_lshl_b32 s57, s52, 2
    s_add_u32 s57, s57, s72
    s_mov_b64 exec, 1
    buffer_store_dword v25, v0, s[40:43], s57 offen offset:0
    s_mov_b64 exec, -1
L_fb_51:
L_skip_47:
    s_waitcnt vmcnt(36)
    s_barrier
    ds_read_b128 v[120:123], v8 offset:49152
    ds_read_b128 v[124:127], v9 offset:49152
    s_cmp_eq_u32 s30, 6
    s_cbranch_scc0 L_skip_52
    s_mul_i32 s57, s14, 6
    s_mov_b32 m0, 43008
    s_nop 0
    buffer_load_dwordx4 v3, s[48:51], s57 offen offset:0 nt lds
    s_mul_i32 s57, s14, 6
    s_add_u32 s57, s57, s15
    s_mov_b32 m0, 43008
    s_nop 0
    buffer_load_dwordx4 v3, s[48:51], s57 offen offset:1024 nt lds
    s_mov_b32 s57, 1179776
    s_mov_b32 s58, 1375360
    s_mov_b32 m0, 124928
L_dma_53:
    s_waitcnt vmcnt(22)
    buffer_load_dwordx4 v5, s[32:35], s57 offen offset:0 nt lds
    buffer_load_dwordx4 v6, s[32:35], s58 offen offset:1024 nt lds
    s_add_u32 s57, s57, 24576
    s_add_u32 s58, s58, 24576
    s_add_u32 m0, m0, 2048
    s_cmp_lg_u32 m0, 141312
    s_cbranch_scc1 L_dma_53
L_skip_52:
    s_waitcnt lgkmcnt(0)
    s_waitcnt vmcnt(36)
    s_barrier
    ds_read_b128 v[128:131], v8 offset:0
    ds_read_b128 v[132:135], v9 offset:0
    s_cmp_eq_u32 s30, 6
    s_cbranch_scc0 L_skip_54
    s_mul_i32 s57, s14, 7
    s_mov_b32 m0, 45056
    s_nop 0
    buffer_load_dwordx4 v3, s[48:51], s57 offen offset:0 nt lds
    s_mul_i32 s57, s14, 7
    s_add_u32 s57, s57, s15
    s_mov_b32 m0, 45056
    s_nop 0
    buffer_load_dwordx4 v3, s[48:51], s57 offen offset:1024 nt lds
    s_mov_b32 s57, 1179904
    s_mov_b32 s58, 1375488
    s_mov_b32 m0, 141312
L_dma_55:
    s_waitcnt vmcnt(22)
    buffer_load_dwordx4 v5, s[32:35], s57 offen offset:0 nt lds
    buffer_load_dwordx4 v6, s[32:35], s58 offen offset:1024 nt lds
    s_add_u32 s57, s57, 24576
    s_add_u32 s58, s58, 24576
    s_add_u32 m0, m0, 2048
    s_cmp_lg_u32 m0, 157696
    s_cbranch_scc1 L_dma_55
L_skip_54:
    s_waitcnt lgkmcnt(0)
    s_cmp_eq_u32 s30, 5
    s_cbranch_scc0 L_skip_56
    v_lshlrev_b32 v24, 2, v0
    buffer_load_dword v2, v24, s[40:43], s72 offen sc1
L_skip_56:
    s_waitcnt vmcnt(36)
    s_barrier
    ds_read_b128 v[136:139], v8 offset:16384
    ds_read_b128 v[140:143], v9 offset:16384
    s_cmp_eq_u32 s30, 6
    s_cbranch_scc0 L_skip_57
    s_mul_i32 s57, s14, 8
    s_mov_b32 m0, 47104
    s_nop 0
    buffer_load_dwordx4 v3, s[48:51], s57 offen offset:0 nt lds
    s_mul_i32 s57, s14, 8
    s_add_u32 s57, s57, s15
    s_mov_b32 m0, 47104
    s_nop 0
    buffer_load_dwordx4 v3, s[48:51], s57 offen offset:1024 nt lds
    s_mov_b32 s57, 0
    s_mov_b32 s58, 392192
    s_mov_b32 m0, 92160
L_dma_58:
    s_waitcnt vmcnt(22)
    buffer_load_dwordx4 v7, s[36:39], s57 offen offset:0 nt lds
    buffer_load_dwordx4 v7, s[36:39], s58 offen offset:1024 nt lds
    s_add_u32 s57, s57, 24576
    s_add_u32 s58, s58, 24576
    s_add_u32 m0, m0, 2048
    s_cmp_lg_u32 m0, 108544
    s_cbranch_scc1 L_dma_58
L_skip_57:
    s_waitcnt lgkmcnt(0)
    s_waitcnt vmcnt(36)
    s_barrier
    ds_read_b128 v[144:147], v8 offset:32768
    ds_read_b128 v[148:151], v9 offset:32768
    s_cmp_eq_u32 s30, 6
    s_cbranch_scc0 L_skip_59
    s_mul_i32 s57, s14, 9
    s_mov_b32 m0, 49152
    s_nop 0
    buffer_load_dwordx4 v3, s[48:51], s57 offen offset:0 nt lds
    s_mul_i32 s57, s14, 9
    s_add_u32 s57, s57, s15
    s_mov_b32 m0, 49152
    s_nop 0
    buffer_load_dwordx4 v3, s[48:51], s57 offen offset:1024 nt lds
    s_mov_b32 s57, 128
    s_mov_b32 s58, 392320
    s_mov_b32 m0, 108544
L_dma_60:
    s_waitcnt vmcnt(22)
    buffer_load_dwordx4 v7, s[36:39], s57 offen offset:0 nt lds
    buffer_load_dwordx4 v7, s[36:39], s58 offen offset:1024 nt lds
    s_add_u32 s57, s57, 24576
    s_add_u32 s58, s58, 24576
    s_add_u32 m0, m0, 2048
    s_cmp_lg_u32 m0, 124928
    s_cbranch_scc1 L_dma_60
L_skip_59:
    s_waitcnt lgkmcnt(0)
    s_cmp_eq_u32 s30, 5
    s_cbranch_scc0 L_skip_61
L_cw_62:
    s_waitcnt vmcnt(0)
    v_cmp_ne_u32 vcc, -1, v2
    s_mov_b32 s57, 0
    s_mov_b32 s68, 2
    s_cmp_eq_u32 s64, 0
    s_cbranch_scc1 L_cd_64
    s_cmp_lg_u32 vcc_hi, 0
    s_cbranch_scc1 L_cd_64
    s_cmp_lg_u32 vcc_lo, -1
    s_cbranch_scc1 L_cr_63
    v_cmp_eq_u32 vcc, 1, v2
    s_bcnt1_i32_b32 s68, vcc_lo
    s_mov_b32 s57, 1
L_cd_64:
    v_mov_b32 v37, 160768
    v_mov_b32 v38, s57
    ds_write_b32 v37, v38
    s_waitcnt lgkmcnt(0)
L_skip_61:
    s_waitcnt vmcnt(36)
    s_barrier
    ds_read_b128 v[152:155], v8 offset:49152
    ds_read_b128 v[156:159], v9 offset:49152
    s_cmp_eq_u32 s30, 6
    s_cbranch_scc0 L_skip_65
    s_mul_i32 s57, s14, 10
    s_mov_b32 m0, 51200
    s_nop 0
    buffer_load_dwordx4 v3, s[48:51], s57 offen offset:0 nt lds
    s_mul_i32 s57, s14, 10
    s_add_u32 s57, s57, s15
    s_mov_b32 m0, 51200
    s_nop 0
    buffer_load_dwordx4 v3, s[48:51], s57 offen offset:1024 nt lds
    s_mov_b32 s57, 256
    s_mov_b32 s58, 392448
    s_mov_b32 m0, 124928
L_dma_66:
    s_waitcnt vmcnt(22)
    buffer_load_dwordx4 v7, s[36:39], s57 offen offset:0 nt lds
    buffer_load_dwordx4 v7, s[36:39], s58 offen offset:1024 nt lds
    s_add_u32 s57, s57, 24576
    s_add_u32 s58, s58, 24576
    s_add_u32 m0, m0, 2048
    s_cmp_lg_u32 m0, 141312
    s_cbranch_scc1 L_dma_66
L_skip_65:
    s_waitcnt lgkmcnt(0)
    v_lshrrev_b32 v8, 2, v0
    v_lshlrev_b32 v8, 7, v8
    v_bfe_u32 v60, v0, 3, 2
    v_lshl_add_u32 v8, v60, 5, v8
    v_and_b32 v60, 3, v0
    v_lshl_add_u32 v8, v60, 3, v8
    v_add_u32 v8, s61, v8
    v_xor_b32 v9, 32, v8
    v_xor_b32 v10, 64, v8
    v_xor_b32 v11, 96, v8
    v_mov_b32 v41, 160768
    ds_read_b32 v42, v41
    s_waitcnt lgkmcnt(0)
    v_readfirstlane_b32 s55, v42
    s_cmp_eq_u32 s55, 0
    s_cbranch_scc1 L_spread
L_spread_back:
    s_cmp_eq_u32 s30, 5
    s_cbranch_scc0 L_skip_78
    s_cmp_eq_u32 s52, 31
    s_cbranch_scc0 L_skip_79
    s_lshl_b32 s57, s31, 5
    v_mov_b32 v16, s57
    s_add_u32 s57, s68, 1
    v_mov_b32 v12, s57
    s_mov_b64 exec, 0x1
    global_store_dword v16, v12, s[26:27] offset:4 sc1
    s_mov_b64 exec, -1
L_skip_79:
L_skip_78:
    s_sub_u32 s58, s30, 1
    s_cmp_lt_u32 s58, 3
    s_cbranch_scc0 L_skip_80
    s_mul_i32 s59, s53, 12416
    s_add_u32 s59, s59, s62
    s_add_u32 s59, s59, 70656
    s_add_u32 s60, s59, 12288
    s_lshl_b32 s57, s58, 11
    v_lshlrev_b32 v48, 4, v0
    v_add_u32 v48, s57, v48
    v_and_b32 v49, 7, v0
    v_lshlrev_b32 v49, 3, v49
    s_add_u32 s57, s59, 6144
    buffer_load_dwordx4 v[12:15], v48, s[40:43], s59 offen offset:0 sc1 nt
    buffer_load_dwordx4 v[16:19], v48, s[40:43], s59 offen offset:1024 sc1 nt
    buffer_load_dwordx4 v[28:31], v48, s[40:43], s57 offen offset:0 sc1 nt
    buffer_load_dwordx4 v[32:35], v48, s[40:43], s57 offen offset:1024 sc1 nt
    buffer_load_dwordx2 v[24:25], v49, s[40:43], s60 offen sc1 nt
L_skip_80:
    s_waitcnt vmcnt(36)
    s_barrier
    ds_read_b64_tr_b16 v[160:161], v8 offset:0
    ds_read_b64_tr_b16 v[168:169], v9 offset:0
    ds_read_b64_tr_b16 v[176:177], v10 offset:0
    ds_read_b64_tr_b16 v[184:185], v11 offset:0
    s_cmp_eq_u32 s30, 6
    s_cbranch_scc0 L_skip_81
    s_mul_i32 s57, s14, 11
    s_mov_b32 m0, 53248
    s_nop 0
    buffer_load_dwordx4 v3, s[48:51], s57 offen offset:0 nt lds
    s_mul_i32 s57, s14, 11
    s_add_u32 s57, s57, s15
    s_mov_b32 m0, 53248
    s_nop 0
    buffer_load_dwordx4 v3, s[48:51], s57 offen offset:1024 nt lds
    s_mov_b32 s57, 196608
    s_mov_b32 s58, 588800
    s_mov_b32 m0, 141312
L_dma_82:
    s_waitcnt vmcnt(22)
    buffer_load_dwordx4 v7, s[36:39], s57 offen offset:0 nt lds
    buffer_load_dwordx4 v7, s[36:39], s58 offen offset:1024 nt lds
    s_add_u32 s57, s57, 24576
    s_add_u32 s58, s58, 24576
    s_add_u32 m0, m0, 2048
    s_cmp_lg_u32 m0, 157696
    s_cbranch_scc1 L_dma_82
L_skip_81:
    s_waitcnt lgkmcnt(0)
    s_waitcnt vmcnt(36)
    s_barrier
    ds_read_b64_tr_b16 v[192:193], v8 offset:16384
    ds_read_b64_tr_b16 v[200:201], v9 offset:16384
    ds_read_b64_tr_b16 v[208:209], v10 offset:16384
    ds_read_b64_tr_b16 v[216:217], v11 offset:16384
    s_cmp_eq_u32 s30, 6
    s_cbranch_scc0 L_skip_83
    s_mov_b32 s57, 196736
    s_mov_b32 s58, 588928
    s_mov_b32 m0, 92160
L_dma_84:
    s_waitcnt vmcnt(22)
    buffer_load_dwordx4 v7, s[36:39], s57 offen offset:0 nt lds
    buffer_load_dwordx4 v7, s[36:39], s58 offen offset:1024 nt lds
    s_add_u32 s57, s57, 24576
    s_add_u32 s58, s58, 24576
    s_add_u32 m0, m0, 2048
    s_cmp_lg_u32 m0, 108544
    s_cbranch_scc1 L_dma_84
L_skip_83:
    s_waitcnt lgkmcnt(0)
    s_sub_u32 s58, s30, 1
    s_cmp_lt_u32 s58, 3
    s_cbranch_scc0 L_skip_85
    s_lshl_b32 s57, s58, 7
    v_bfe_u32 v51, v0, 2, 2
    v_lshlrev_b32 v51, 5, v51
    v_lshrrev_b32 v60, 5, v0
    v_lshl_add_u32 v51, v60, 4, v51
    v_and_b32 v60, 3, v0
    v_lshl_add_u32 v51, v60, 2, v51
    v_bfe_u32 v60, v0, 4, 1
    v_lshl_add_u32 v51, v60, 1, v51
    v_add_u32 v51, s57, v51
    v_add_u32 v51, 157696, v51
    v_mov_b32 v60, 0x3c75e03e
    v_mov_b32 v61, 0x3a71d1e6
    v_mov_b32 v47, 0x3e13985d
    s_waitcnt vmcnt(0)
    v_pk_add_f32 v[36:37], v[28:29], v[32:33]
    v_pk_add_f32 v[38:39], v[30:31], v[34:35]
    s_nop 1
    v_permlane32_swap_b32 v36, v38
    v_permlane32_swap_b32 v37, v39
    v_pk_add_f32 v[36:37], v[36:37], v[38:39]
    s_nop 1
    v_permlane16_swap_b32 v36, v37
    v_add_f32 v36, v36, v37
    v_mul_f32 v6, 0x3dd53b95, v36
    v_add_f32_dpp v48, v24, v24 row_ror:4 row_mask:0xf bank_mask:0xf
    v_add_f32_dpp v49, v25, v25 row_ror:4 row_mask:0xf bank_mask:0xf
    v_pk_add_f32 v[20:21], v[12:13], v[16:17]
    v_pk_add_f32 v[22:23], v[14:15], v[18:19]
    v_add_f32_dpp v48, v48, v48 row_ror:2 row_mask:0xf bank_mask:0xf
    v_add_f32_dpp v49, v49, v49 row_ror:2 row_mask:0xf bank_mask:0xf
    v_permlane32_swap_b32 v20, v22
    v_permlane32_swap_b32 v21, v23
    v_add_f32_dpp v48, v48, v48 row_ror:1 row_mask:0xf bank_mask:0xf
    v_add_f32_dpp v49, v49, v49 row_ror:1 row_mask:0xf bank_mask:0xf
    v_pk_add_f32 v[20:21], v[20:21], v[22:23]
    v_mul_f32 v48, v48, v60
    v_fma_f32 v49, v49, v47, v61
    v_permlane16_swap_b32 v20, v21
    v_fma_f32 v49, -v48, v48, v49
    v_add_f32 v20, v20, v21
    v_max_f32 v49, v49, v61
    v_mul_f32 v50, v6, v48
    v_rsq_f32 v49, v49
    v_cmp_u_f32 vcc, v20, v20
    v_sub_f32 v20, v20, v50
    v_mul_f32 v20, v20, v49
    v_cvt_pk_bf16_f32 v20, v20, v20
    ds_write_b16 v51, v20
    s_waitcnt lgkmcnt(0)
L_skip_85:
    s_lshl_b32 s57, s30, 7
    s_add_u32 s57, s57, 158720
    v_lshrrev_b32 v58, 4, v0
    v_lshlrev_b32 v58, 5, v58
    v_bfe_u32 v60, v0, 1, 1
    v_lshl_add_u32 v58, v60, 4, v58
    v_bfe_u32 v60, v0, 2, 2
    v_lshl_add_u32 v58, v60, 2, v58
    v_and_b32 v60, 1, v0
    v_lshl_add_u32 v58, v60, 1, v58
    v_add_u32 v58, s57, v58
    v_lshrrev_b32 v61, 4, v0
    v_lshlrev_b32 v61, 5, v61
    v_bfe_u32 v60, v0, 1, 1
    v_lshl_add_u32 v61, v60, 4, v61
    v_add_u32 v61, s57, v61
    v_bfe_u32 v62, v0, 2, 2
    v_lshlrev_b32 v62, 1, v62
    v_and_b32 v60, 1, v0
    v_lshl_add_u32 v62, v60, 0, v62
    v_mov_b32 v60, 160992
    v_cmp_eq_u32 vcc, 0, v62
    s_nop 1
    v_cndmask_b32 v52, v60, v61, vcc
    v_cmp_eq_u32 vcc, 1, v62
    s_nop 1
    v_cndmask_b32 v53, v60, v61, vcc
    v_cmp_eq_u32 vcc, 2, v62
    s_nop 1
    v_cndmask_b32 v54, v60, v61, vcc
    v_cmp_eq_u32 vcc, 3, v62
    s_nop 1
    v_cndmask_b32 v55, v60, v61, vcc
    v_cmp_eq_u32 vcc, 4, v62
    s_nop 1
    v_cndmask_b32 v56, v60, v61, vcc
    v_cmp_eq_u32 vcc, 5, v62
    s_nop 1
    v_cndmask_b32 v57, v60, v61, vcc
    s_lshl_b32 s58, s30, 2
    s_add_u32 s58, s58, 159744
    v_mov_b32 v60, s58
    v_lshlrev_b32 v59, 2, v0
    v_add_u32 v59, 158208, v59
    v_cmp_eq_u32 vcc, 63, v0
    s_nop 1
    v_cndmask_b32 v59, v59, v60, vcc
    v_and_b32 v62, 7, v0
    v_lshlrev_b32 v62, 2, v62
    v_add_u32 v62, 159744, v62
    s_lshl_b32 s57, s30, 11
    v_lshlrev_b32 v63, 4, v0
    v_add_u32 v63, s57, v63
    v_add_u32 v63, 92160, v63
    s_waitcnt vmcnt(34)
    s_barrier
    ds_read_b64_tr_b16 v[224:225], v8 offset:32768
    ds_read_b64_tr_b16 v[232:233], v9 offset:32768
    ds_read_b64_tr_b16 v[240:241], v10 offset:32768
    ds_read_b64_tr_b16 v[248:249], v11 offset:32768
    s_cmp_eq_u32 s30, 6
    s_cbranch_scc0 L_skip_86
    s_mov_b32 s57, 196864
    s_mov_b32 s58, 589056
    s_mov_b32 m0, 108544
L_dma_87:
    s_nop 0
    buffer_load_dwordx4 v7, s[36:39], s57 offen offset:0 nt lds
    buffer_load_dwordx4 v7, s[36:39], s58 offen offset:1024 nt lds
    s_add_u32 s57, s57, 24576
    s_add_u32 s58, s58, 24576
    s_add_u32 m0, m0, 2048
    s_cmp_lg_u32 m0, 124928
    s_cbranch_scc1 L_dma_87
L_skip_86:
    s_waitcnt lgkmcnt(0)
    v_lshrrev_b32 v5, 4, v0
    v_lshlrev_b32 v5, 5, v5
    v_bfe_u32 v60, v0, 1, 1
    v_lshl_add_u32 v5, v60, 4, v5
    v_add_u32 v5, 157696, v5
    ds_read_b128 v[12:15], v5 offset:0
    ds_read_b128 v[16:19], v5 offset:128
    ds_read_b128 v[20:23], v5 offset:256
    v_mov_b64 v[24:25], 0
    v_mov_b64 v[26:27], 0
    v_mov_b64 v[28:29], 0
    v_mov_b64 v[30:31], 0
    v_mov_b64 v[32:33], 0
    v_mov_b64 v[34:35], 0
    v_mov_b64 v[36:37], 0
    v_mov_b64 v[38:39], 0
    v_mov_b64 v[40:41], 0
    v_mov_b64 v[42:43], 0
    v_mov_b64 v[44:45], 0
    v_mov_b64 v[46:47], 0
    s_waitcnt lgkmcnt(0)
    v_smfmac_f32_16x16x64_bf16 v[24:27], v[12:15], v[64:71], v1
    v_smfmac_f32_16x16x64_bf16 v[24:27], v[16:19], v[72:79], v1
    v_smfmac_f32_16x16x64_bf16 v[24:27], v[20:23], v[80:87], v1
    v_smfmac_f32_16x16x64_bf16 v[28:31], v[12:15], v[88:95], v1
    v_smfmac_f32_16x16x64_bf16 v[28:31], v[16:19], v[96:103], v1
    v_smfmac_f32_16x16x64_bf16 v[28:31], v[20:23], v[104:111], v1
    v_smfmac_f32_16x16x64_bf16 v[32:35], v[12:15], v[112:119], v1
    v_smfmac_f32_16x16x64_bf16 v[32:35], v[16:19], v[120:127], v1
    v_smfmac_f32_16x16x64_bf16 v[32:35], v[20:23], v[128:135], v1
    v_smfmac_f32_16x16x64_bf16 v[36:39], v[12:15], v[136:143], v1
    v_smfmac_f32_16x16x64_bf16 v[36:39], v[16:19], v[144:151], v1
    v_smfmac_f32_16x16x64_bf16 v[36:39], v[20:23], v[152:159], v1
    v_add_f32 v24, v24, v26
    s_nop 0
    v_add_f32 v28, v28, v30
    s_nop 1
    v_add_f32 v32, v32, v34
    v_max3_f32 v61, v24, v28, v32
    v_mov_b32_dpp v24, v28 quad_perm:[0,1,2,3] row_mask:0x2 bank_mask:0xf
    v_add_f32 v36, v36, v38
    v_max_f32 v61, v61, v36
    v_mov_b32_dpp v24, v32 quad_perm:[0,1,2,3] row_mask:0x4 bank_mask:0xf
    s_nop 0
    v_max_f32_dpp v61, v61, v61 row_ror:8 row_mask:0xf bank_mask:0xf
    s_nop 0
    v_mov_b32_dpp v24, v36 quad_perm:[0,1,2,3] row_mask:0x8 bank_mask:0xf
    v_max_f32_dpp v61, v61, v61 row_ror:4 row_mask:0xf bank_mask:0xf
    s_nop 1
    v_max_f32_dpp v61, v61, v61 row_ror:2 row_mask:0xf bank_mask:0xf
    s_nop 1
    v_max_f32_dpp v61, v61, v61 row_ror:1 row_mask:0xf bank_mask:0xf
    v_sub_f32 v36, v24, v61
    ds_write_b32 v59, v61
    v_exp_f32 v36, v36
    s_nop 0
    v_cvt_pk_bf16_f32 v39, v36, v36
    ds_write_b16 v58, v39
    ds_read_b128 v[12:15], v52
    ds_read_b128 v[16:19], v53
    ds_read_b128 v[20:23], v54
    ds_read_b128 v[24:27], v55
    ds_read_b128 v[28:31], v56
    ds_read_b128 v[32:35], v57
    v_add_f32_dpp v38, v36, v36 row_ror:8 row_mask:0xf bank_mask:0xf
    s_nop 1
    v_add_f32_dpp v38, v38, v38 row_ror:4 row_mask:0xf bank_mask:0xf
    s_nop 1
    v_add_f32_dpp v38, v38, v38 row_ror:2 row_mask:0xf bank_mask:0xf
    s_nop 1
    v_add_f32_dpp v38, v38, v38 row_ror:1 row_mask:0xf bank_mask:0xf
    s_nop 1
    v_add_f32_dpp v38, v38, v38 row_bcast:15 row_mask:0xa bank_mask:0xf
    s_nop 1
    v_add_f32_dpp v38, v38, v38 row_bcast:31 row_mask:0xc bank_mask:0xf
    s_waitcnt lgkmcnt(0)
    s_waitcnt vmcnt(32)
    s_barrier
    ds_read_b64_tr_b16 v[162:163], v8 offset:49152
    ds_read_b64_tr_b16 v[170:171], v9 offset:49152
    ds_read_b64_tr_b16 v[178:179], v10 offset:49152
    ds_read_b64_tr_b16 v[186:187], v11 offset:49152
    s_cmp_eq_u32 s30, 6
    s_cbranch_scc0 L_skip_88
    s_mov_b32 s57, 786432
    s_mov_b32 s58, 1178624
    s_mov_b32 m0, 124928
L_dma_89:
    s_nop 0
    buffer_load_dwordx4 v7, s[36:39], s57 offen offset:0 nt lds
    buffer_load_dwordx4 v7, s[36:39], s58 offen offset:1024 nt lds
    s_add_u32 s57, s57, 24576
    s_add_u32 s58, s58, 24576
    s_add_u32 m0, m0, 2048
    s_cmp_lg_u32 m0, 141312
    s_cbranch_scc1 L_dma_89
L_skip_88:
    s_waitcnt lgkmcnt(0)
    ds_read_b32 v36, v62
    s_waitcnt lgkmcnt(0)
    v_max_f32_dpp v37, v36, v36 row_ror:4 row_mask:0xf bank_mask:0xf
    s_nop 1
    v_max_f32_dpp v37, v37, v37 row_ror:2 row_mask:0xf bank_mask:0xf
    s_nop 1
    v_max_f32_dpp v37, v37, v37 row_ror:1 row_mask:0xf bank_mask:0xf
    v_sub_f32 v39, v61, v37
    v_exp_f32 v39, v39
    s_cmp_lt_u32 s30, 2
    s_cbranch_scc0 L_skip_90
    s_lshl_b32 s57, s30, 3
    v_lshlrev_b32 v2, 4, v0
    v_add_u32 v2, s57, v2
    v_add_u32 v2, 92160, v2
    v_mov_b32 v60, 94192
    v_cmp_le_u32 vcc, 48, v0
    s_nop 1
    v_cndmask_b32 v2, v2, v60, vcc
    s_lshr_b32 s57, s54, 1
    s_lshl_b32 s57, s57, 2
    s_and_b32 s58, s54, 1
    s_add_u32 s57, s57, s58
    s_lshl_b32 s58, s57, 4
    s_lshl_b32 s57, s57, 3
    v_bfe_u32 v3, v0, 3, 2
    v_lshlrev_b32 v3, 8, v3
    v_bfe_u32 v61, v0, 2, 1
    v_lshl_add_u32 v3, v61, 5, v3
    v_and_b32 v61, 3, v0
    v_lshl_add_u32 v3, v61, 2, v3
    v_add_u32 v3, s58, v3
    v_bfe_u32 v60, v0, 3, 1
    v_lshlrev_b32 v60, 8, v60
    v_bfe_u32 v61, v0, 1, 1
    v_lshl_add_u32 v60, v61, 7, v60
    v_bfe_u32 v61, v0, 2, 1
    v_lshl_add_u32 v60, v61, 4, v60
    v_and_b32 v61, 1, v0
    v_lshl_add_u32 v60, v61, 2, v60
    v_add_u32 v60, s57, v60
    v_add_u32 v60, 1024, v60
    v_cmp_gt_u32 vcc, 32, v0
    s_nop 1
    v_cndmask_b32 v3, v60, v3, vcc
    s_lshl_b32 s57, s53, 1
    s_add_u32 s57, s57, s30
    s_mul_i32 s57, s57, 1664
    s_add_u32 s57, s57, s62
    v_add_u32 v3, s57, v3
    v_mov_b32 v60, 0x7f000000
    v_cmp_le_u32 vcc, 48, v0
    s_nop 1
    v_cndmask_b32 v3, v3, v60, vcc
    s_lshl_b32 s58, s54, 2
    s_add_u32 s57, s57, s58
    s_add_u32 s57, s57, 1536
    v_mov_b32 v4, s57
    v_mov_b32 v60, 0x7f000000
    v_cmp_ne_u32 vcc, 48, v0
    s_nop 1
    v_cndmask_b32 v4, v4, v60, vcc
    s_mov_b32 s58, 0
    s_cmp_eq_u32 s55, 0
    s_cbranch_scc1 L_gs_91
    buffer_store_dword v37, v4, s[40:43], s58 offen
L_gb_92:
L_skip_90:
    s_cmp_eq_u32 s30, 2
    s_cbranch_scc0 L_skip_93
    v_lshlrev_b32 v2, 2, v0
    v_add_u32 v2, 157696, v2
    v_and_b32 v3, 15, v0
    v_lshlrev_b32 v3, 2, v3
    v_lshrrev_b32 v60, 5, v0
    v_lshl_add_u32 v3, v60, 6, v3
    v_bfe_u32 v60, v0, 4, 1
    v_lshl_add_u32 v3, v60, 13, v3
L_skip_93:
    s_waitcnt vmcnt(32)
    s_barrier
    ds_read_b64_tr_b16 v[194:195], v8 offset:0
    ds_read_b64_tr_b16 v[202:203], v9 offset:0
    ds_read_b64_tr_b16 v[210:211], v10 offset:0
    ds_read_b64_tr_b16 v[218:219], v11 offset:0
    s_cmp_eq_u32 s30, 6
    s_cbranch_scc0 L_skip_94
    s_mov_b32 s57, 786560
    s_mov_b32 s58, 1178752
    s_mov_b32 m0, 141312
L_dma_95:
    s_nop 0
    buffer_load_dwordx4 v7, s[36:39], s57 offen offset:0 nt lds
    buffer_load_dwordx4 v7, s[36:39], s58 offen offset:1024 nt lds
    s_add_u32 s57, s57, 24576
    s_add_u32 s58, s58, 24576
    s_add_u32 m0, m0, 2048
    s_cmp_lg_u32 m0, 157696
    s_cbranch_scc1 L_dma_95
L_skip_94:
    s_waitcnt lgkmcnt(0)
    s_waitcnt vmcnt(32)
    s_barrier
    ds_read_b64_tr_b16 v[226:227], v8 offset:16384
    ds_read_b64_tr_b16 v[234:235], v9 offset:16384
    ds_read_b64_tr_b16 v[242:243], v10 offset:16384
    ds_read_b64_tr_b16 v[250:251], v11 offset:16384
    s_cmp_eq_u32 s30, 6
    s_cbranch_scc0 L_skip_96
    s_mov_b32 s57, 786688
    s_mov_b32 s58, 1178880
    s_mov_b32 m0, 92160
L_dma_97:
    s_nop 0
    buffer_load_dwordx4 v7, s[36:39], s57 offen offset:0 nt lds
    buffer_load_dwordx4 v7, s[36:39], s58 offen offset:1024 nt lds
    s_add_u32 s57, s57, 24576
    s_add_u32 s58, s58, 24576
    s_add_u32 m0, m0, 2048
    s_cmp_lg_u32 m0, 108544
    s_cbranch_scc1 L_dma_97
L_skip_96:
    s_waitcnt lgkmcnt(0)
    s_cmp_eq_u32 s30, 5
    s_cbranch_scc0 L_skip_98
    global_load_dword v2, v3, s[26:27] offset:4 sc1
L_skip_98:
    s_waitcnt vmcnt(32)
    s_barrier
    ds_read_b64_tr_b16 v[164:165], v8 offset:32768
    ds_read_b64_tr_b16 v[172:173], v9 offset:32768
    ds_read_b64_tr_b16 v[180:181], v10 offset:32768
    ds_read_b64_tr_b16 v[188:189], v11 offset:32768
    s_cmp_eq_u32 s30, 6
    s_cbranch_scc0 L_skip_99
    s_mov_b32 s57, 983040
    s_mov_b32 s58, 1375232
    s_mov_b32 m0, 108544
L_dma_100:
    s_nop 0
    buffer_load_dwordx4 v7, s[36:39], s57 offen offset:0 nt lds
    buffer_load_dwordx4 v7, s[36:39], s58 offen offset:1024 nt lds
    s_add_u32 s57, s57, 24576
    s_add_u32 s58, s58, 24576
    s_add_u32 m0, m0, 2048
    s_cmp_lg_u32 m0, 124928
    s_cbranch_scc1 L_dma_100
L_skip_99:
    s_waitcnt lgkmcnt(0)
    s_waitcnt vmcnt(32)
    s_barrier
    ds_read_b64_tr_b16 v[196:197], v8 offset:49152
    ds_read_b64_tr_b16 v[204:205], v9 offset:49152
    ds_read_b64_tr_b16 v[212:213], v10 offset:49152
    ds_read_b64_tr_b16 v[220:221], v11 offset:49152
    s_cmp_eq_u32 s30, 6
    s_cbranch_scc0 L_skip_101
    s_mov_b32 s57, 983168
    s_mov_b32 s58, 1375360
    s_mov_b32 m0, 124928
L_dma_102:
    s_nop 0
    buffer_load_dwordx4 v7, s[36:39], s57 offen offset:0 nt lds
    buffer_load_dwordx4 v7, s[36:39], s58 offen offset:1024 nt lds
    s_add_u32 s57, s57, 24576
    s_add_u32 s58, s58, 24576
    s_add_u32 m0, m0, 2048
    s_cmp_lg_u32 m0, 141312
    s_cbranch_scc1 L_dma_102
L_skip_101:
    s_waitcnt lgkmcnt(0)
    s_cmp_eq_u32 s30, 5
    s_cbranch_scc0 L_skip_103
L_cw_104:
    s_waitcnt vmcnt(0)
    v_cmp_eq_u32 vcc, 0, v2
    s_cbranch_vccnz L_cr_105
    v_add_u32_dpp v2, v2, v2 row_ror:4 row_mask:0xf bank_mask:0xf
    s_nop 1
    v_add_u32_dpp v2, v2, v2 row_ror:2 row_mask:0xf bank_mask:0xf
    s_nop 1
    v_add_u32_dpp v2, v2, v2 row_ror:1 row_mask:0xf bank_mask:0xf
    v_mov_b32 v60, 160772
    ds_write_b32 v60, v2
    s_waitcnt lgkmcnt(0)
L_skip_103:
    s_cmp_lt_u32 s3, 20
    s_cbranch_scc0 L_skip_106
    s_mul_i32 s74, s30, 1664
    s_add_u32 s74, s74, s62
    s_add_u32 s74, s74, 0
    v_and_b32 v56, 7, v0
    v_lshlrev_b32 v56, 2, v56
    v_lshrrev_b32 v62, 4, v0
    v_lshlrev_b32 v62, 3, v62
    s_cmp_lg_u32 s30, 6
    s_cbranch_scc0 L_skip_106
    buffer_load_dword v52, v56, s[40:43], s74 offen offset:1536 sc1
    buffer_load_dwordx2 v[54:55], v62, s[40:43], s74 offen offset:1536 sc1
L_skip_106:
    s_cmp_eq_u32 s30, 2
    s_cbranch_scc0 L_skip_107
    s_sub_u32 s57, s3, 20
    s_cmp_lt_u32 s57, 4
    s_cbranch_scc0 L_skip_108
    s_sub_u32 s57, s3, 20
    s_lshl_b32 s57, s57, 6
    v_add_u32 v50, s57, v0
    v_min_u32 v50, 207, v50
    v_lshlrev_b32 v50, 7, v50
    s_add_u32 s57, s62, 0
    buffer_load_dword v50, v50, s[40:43], s57 offen sc1 nt
    s_sub_u32 s57, s3, 20
    s_lshl_b32 s57, s57, 6
    v_add_u32 v51, s57, v0
    v_min_u32 v51, 151, v51
    v_lshlrev_b32 v51, 7, v51
    s_add_u32 s57, s62, 26624
    buffer_load_dword v51, v51, s[40:43], s57 offen sc1 nt
    s_sub_u32 s57, s3, 20
    s_lshl_b32 s57, s57, 6
    v_add_u32 v49, s57, v0
    v_min_u32 v49, 191, v49
    v_lshlrev_b32 v49, 7, v49
    s_add_u32 s57, s62, 46080
    buffer_load_dword v49, v49, s[40:43], s57 offen sc1 nt
L_skip_108:
L_skip_107:
    s_waitcnt vmcnt(32)
    s_barrier
    ds_read_b64_tr_b16 v[228:229], v8 offset:0
    ds_read_b64_tr_b16 v[236:237], v9 offset:0
    ds_read_b64_tr_b16 v[244:245], v10 offset:0
    ds_read_b64_tr_b16 v[252:253], v11 offset:0
    s_cmp_eq_u32 s30, 6
    s_cbranch_scc0 L_skip_109
    s_mov_b32 s57, 983296
    s_mov_b32 s58, 1375488
    s_mov_b32 m0, 141312
L_dma_110:
    s_nop 0
    buffer_load_dwordx4 v7, s[36:39], s57 offen offset:0 nt lds
    buffer_load_dwordx4 v7, s[36:39], s58 offen offset:1024 nt lds
    s_add_u32 s57, s57, 24576
    s_add_u32 s58, s58, 24576
    s_add_u32 m0, m0, 2048
    s_cmp_lg_u32 m0, 157696
    s_cbranch_scc1 L_dma_110
L_skip_109:
    s_waitcnt lgkmcnt(0)
    s_cmp_ge_u32 s30, 6
    s_cbranch_scc0 L_skip_111
    v_mov_b32 v60, 160772
    ds_read_b32 v60, v60
    s_lshr_b32 s58, s63, 2
    s_waitcnt lgkmcnt(0)
    v_readfirstlane_b32 s57, v60
    s_cmp_gt_u32 s57, 24
    s_cselect_b32 s57, 1, 0
    s_xor_b32 s57, s57, s58
    s_lshl_b32 s57, s57, 13
    s_add_u32 s7, s8, s57
L_skip_111:
    s_branch L_tail
.p2align 10
L_tail:
L_pad0:
    s_cbranch_execz L_pad4
    s_waitcnt vmcnt(32)
    s_barrier
    ds_read_b64_tr_b16 v[166:167], v8 offset:16384
    ds_read_b64_tr_b16 v[174:175], v9 offset:16384
    ds_read_b64_tr_b16 v[182:183], v10 offset:16384
    ds_read_b64_tr_b16 v[190:191], v11 offset:16384
    s_waitcnt lgkmcnt(0)
    s_cmp_lt_u32 s30, 5
    s_cbranch_scc0 L_skip_112
    s_waitcnt vmcnt(0)
L_skip_112:
    s_cmp_lt_u32 s3, 20
    s_cbranch_scc0 L_skip_113
    v_lshlrev_b32 v57, 4, v0
    v_lshlrev_b32 v58, 3, v0
    s_mul_i32 s57, s30, 6144
    s_add_u32 s57, s57, 30720
    v_lshrrev_b32 v59, 2, v0
    v_lshlrev_b32 v59, 6, v59
    v_bfe_u32 v53, v0, 4, 1
    v_lshl_add_u32 v59, v53, 5, v59
    v_and_b32 v53, 3, v0
    v_lshl_add_u32 v59, v53, 3, v59
    v_add_u32 v59, s57, v59
    v_xor_b32 v60, 32, v59
    s_lshl_b32 s57, s30, 8
    s_add_u32 s57, s57, 157696
    v_lshl_add_u32 v61, v0, 2, s57
    s_cmp_lg_u32 s30, 6
    s_cbranch_scc0 L_skip_113
L_cw_114:
    s_waitcnt vmcnt(0)
    v_max3_u32 v53, v52, v54, v55
    v_cmp_eq_u32 vcc, -1, v53
    s_cbranch_vccnz L_cr_115
    v_max_f32_dpp v53, v52, v52 row_ror:4 row_mask:0xf bank_mask:0xf
    s_nop 1
    v_max_f32_dpp v53, v53, v53 row_ror:2 row_mask:0xf bank_mask:0xf
    s_nop 1
    v_max_f32_dpp v53, v53, v53 row_ror:1 row_mask:0xf bank_mask:0xf
    v_sub_f32 v52, v52, v53
    v_sub_f32 v54, v54, v53
    v_sub_f32 v55, v55, v53
    v_exp_f32 v52, v52
    v_exp_f32 v54, v54
    v_exp_f32 v55, v55
    s_cmp_eq_u32 s30, 7
    s_cbranch_scc0 L_skip_113
    v_add_u32 v62, 158720, v57
    ds_write_b128 v62, v[52:55]
    s_waitcnt lgkmcnt(0)
L_skip_113:
    v_smfmac_f32_16x16x64_bf16 v[40:43], v[12:15], v[160:167], v1
    v_smfmac_f32_16x16x64_bf16 v[40:43], v[16:19], v[168:175], v1
    v_smfmac_f32_16x16x64_bf16 v[40:43], v[20:23], v[176:183], v1
    v_smfmac_f32_16x16x64_bf16 v[40:43], v[24:27], v[184:191], v1
    s_cmp_eq_u32 s30, 6
    s_cbranch_scc0 L_skip_116
    s_mul_i32 s57, s14, 12
    s_add_u32 s58, s57, s15
    s_mov_b32 m0, 55296
L_dma_117:
    s_nop 0
    buffer_load_dwordx4 v3, s[48:51], s57 offen offset:0 nt lds
    buffer_load_dwordx4 v3, s[48:51], s58 offen offset:1024 nt lds
    s_add_u32 s57, s57, s14
    s_add_u32 s58, s58, s14
    s_add_u32 m0, m0, 2048
    s_cmp_lg_u32 m0, 67584
    s_cbranch_scc1 L_dma_117
    s_mul_i32 s57, s14, 18
    s_add_u32 s58, s57, s15
    s_mov_b32 m0, 67584
L_dma_118:
    s_nop 0
    buffer_load_dwordx4 v3, s[48:51], s57 offen offset:0 nt lds
    buffer_load_dwordx4 v3, s[48:51], s58 offen offset:1024 nt lds
    s_add_u32 s57, s57, s14
    s_add_u32 s58, s58, s14
    s_add_u32 m0, m0, 2048
    s_cmp_lg_u32 m0, 79872
    s_cbranch_scc1 L_dma_118
L_skip_116:
    s_waitcnt vmcnt(40)
    s_barrier
    ds_read_b64_tr_b16 v[198:199], v8 offset:32768
    ds_read_b64_tr_b16 v[206:207], v9 offset:32768
    ds_read_b64_tr_b16 v[214:215], v10 offset:32768
    ds_read_b64_tr_b16 v[222:223], v11 offset:32768
    s_waitcnt lgkmcnt(0)
    s_cmp_lt_u32 s3, 20
    s_cbranch_scc0 L_skip_119
    s_cmp_eq_u32 s30, 6
    s_cbranch_scc0 L_skip_119
    v_add_u32 v62, 158720, v57
    ds_read_b128 v[52:55], v62
L_skip_119:
L_pad1:
    s_cbranch_execz L_pad5
    v_smfmac_f32_16x16x64_bf16 v[40:43], v[28:31], v[192:199], v1
    v_smfmac_f32_16x16x64_bf16 v[40:43], v[32:35], v[200:207], v1
    v_smfmac_f32_16x16x64_bf16 v[44:47], v[12:15], v[208:215], v1
    v_smfmac_f32_16x16x64_bf16 v[44:47], v[16:19], v[216:223], v1
    v_mul_f32 v38, v38, v39
    ds_write_b32 v63, v38 offset:1024
    s_waitcnt vmcnt(24)
    s_barrier
    ds_read_b64_tr_b16 v[230:231], v8 offset:49152
    ds_read_b64_tr_b16 v[238:239], v9 offset:49152
    ds_read_b64_tr_b16 v[246:247], v10 offset:49152
    ds_read_b64_tr_b16 v[254:255], v11 offset:49152
    s_waitcnt lgkmcnt(0)
    v_smfmac_f32_16x16x64_bf16 v[44:47], v[20:23], v[224:231], v1
    v_smfmac_f32_16x16x64_bf16 v[44:47], v[24:27], v[232:239], v1
    v_smfmac_f32_16x16x64_bf16 v[44:47], v[28:31], v[240:247], v1
    v_smfmac_f32_16x16x64_bf16 v[44:47], v[32:35], v[248:255], v1
    s_setprio 0
    s_cmp_lt_u32 s30, 2
    v_pk_add_f32 v[40:41], v[40:41], v[42:43]
    s_nop 4
    v_pk_add_f32 v[42:43], v[44:45], v[46:47]
    v_pk_mul_f32 v[40:41], v[40:41], v[38:39] op_sel:[0,1] op_sel_hi:[1,1]
    v_pk_mul_f32 v[42:43], v[42:43], v[38:39] op_sel:[0,1] op_sel_hi:[1,1]
    ds_write_b128 v63, v[40:43]
    s_cbranch_scc1 L_comb_0
    s_waitcnt lgkmcnt(0)
    s_barrier
L_comb_0b:
    s_cmp_eq_u32 s30, 6
    s_cbranch_scc0 L_skip_124
    s_waitcnt vmcnt(0)
L_skip_124:
    s_barrier
    s_cmp_lt_u32 s3, 20
    s_cbranch_scc0 L_typeB_0
    buffer_load_dwordx4 v[12:15], v57, s[40:43], s74 offen sc1
    buffer_load_dwordx2 v[16:17], v58, s[40:43], s74 offen offset:1024 sc1
    buffer_load_dword v18, v56, s[40:43], s74 offen offset:1568 sc1
    ds_read_b64_tr_b16 v[28:29], v59 offset:0
    ds_read_b64_tr_b16 v[30:31], v59 offset:1024
    ds_read_b64_tr_b16 v[32:33], v59 offset:2048
    ds_read_b64_tr_b16 v[34:35], v59 offset:3072
    ds_read_b64_tr_b16 v[36:37], v59 offset:4096
    ds_read_b64_tr_b16 v[38:39], v59 offset:5120
    ds_read_b64_tr_b16 v[40:41], v60 offset:0
    ds_read_b64_tr_b16 v[42:43], v60 offset:1024
    ds_read_b64_tr_b16 v[44:45], v60 offset:2048
    ds_read_b64_tr_b16 v[46:47], v60 offset:3072
    ds_read_b64_tr_b16 v[48:49], v60 offset:4096
    ds_read_b64_tr_b16 v[50:51], v60 offset:5120
    v_mov_b64 v[20:21], 0
    v_mov_b64 v[22:23], 0
    v_mov_b64 v[24:25], 0
    v_mov_b64 v[26:27], 0
    s_add_u32 s58, s6, 0
    s_waitcnt lgkmcnt(0)
    s_branch L_ow_125
.p2align 5
L_or_126:
    buffer_load_dwordx4 v[12:15], v57, s[40:43], s74 offen sc1
    buffer_load_dwordx2 v[16:17], v58, s[40:43], s74 offen offset:1024 sc1
    buffer_load_dword v18, v56, s[40:43], s74 offen offset:1568 sc1
    s_sub_u32 s56, s56, 1
    s_cbranch_scc1 L_done
    v_mov_b64 v[20:21], 0
    v_mov_b64 v[22:23], 0
    v_mov_b64 v[24:25], 0
    v_mov_b64 v[26:27], 0
L_ow_125:
    s_waitcnt vmcnt(2)
    v_smfmac_f32_16x16x64_bf16 v[20:23], v[12:15], v[28:35], v1
    v_max3_u32 v19, v12, v13, v14
    v_smfmac_f32_16x16x64_bf16 v[24:27], v[12:15], v[40:47], v1
    s_waitcnt vmcnt(0)
    v_mul_f32 v53, v52, v18
    v_smfmac_f32_16x16x32_bf16 v[20:23], v[16:17], v[36:39], v1
    v_max3_u32 v62, v15, v16, v17
    v_smfmac_f32_16x16x32_bf16 v[24:27], v[16:17], v[48:51], v1
    v_max3_u32 v19, v19, v62, v18
    v_add_f32_dpp v53, v53, v53 row_ror:4 row_mask:0xf bank_mask:0xf
    v_cmp_eq_u32 vcc, -1, v19
L_pad2:
    s_cbranch_execz L_pad6
    s_cmp_eq_u32 s30, 2
    v_add_f32_dpp v53, v53, v53 row_ror:2 row_mask:0xf bank_mask:0xf
    s_cbranch_vccnz L_or_126
    s_nop 0
    v_add_f32_dpp v53, v53, v53 row_ror:1 row_mask:0xf bank_mask:0xf
    v_rcp_f32 v52, v53
    v_pk_add_f32 v[20:21], v[20:21], v[22:23]
    v_pk_add_f32 v[24:25], v[24:25], v[26:27]
    v_pk_mul_f32 v[54:55], v[54:55], v[52:53] op_sel:[0,0] op_sel_hi:[1,0]
    v_mul_f32 v20, v20, v54
    v_mul_f32 v24, v24, v54
    v_fmac_f32 v20, v21, v55
    v_fmac_f32 v24, v25, v55
    s_nop 1
    v_permlane32_swap_b32 v20, v24
    v_add_f32 v20, v20, v24
    ds_write_b32 v61, v20
    s_waitcnt lgkmcnt(0)
    s_barrier
    s_cbranch_scc0 L_finb_127
    ds_read2st64_b32 v[12:13], v2 offset0:0 offset1:1
    ds_read2st64_b32 v[14:15], v2 offset0:2 offset1:3
    ds_read2st64_b32 v[16:17], v2 offset0:4 offset1:5
    ds_read2st64_b32 v[18:19], v2 offset0:6 offset1:7
    s_waitcnt lgkmcnt(2)
    v_pk_add_f32 v[12:13], v[12:13], v[14:15]
    s_waitcnt lgkmcnt(0)
    v_pk_add_f32 v[16:17], v[16:17], v[18:19]
    v_pk_add_f32 v[12:13], v[12:13], v[16:17]
    v_add_f32 v14, v12, v13
    v_add_f32 v15, v12, v13
    s_nop 1
    v_permlane16_swap_b32 v14, v15
    v_add_f32 v12, v14, v15
    buffer_store_dword v12, v3, s[40:43], s58 offen sc1
L_finb_127:
    s_sub_u32 s57, s30, 4
    s_cmp_lt_u32 s57, 3
    s_cbranch_scc0 L_skip_128
    s_sub_u32 s60, s30, 4
    s_lshl_b32 s57, s60, 11
    v_lshlrev_b32 v11, 4, v0
    v_add_u32 v11, s57, v11
    s_add_u32 s65, s62, 19456
    buffer_load_dwordx4 v[52:55], v11, s[40:43], s65 offen offset:0 sc1
    buffer_load_dwordx4 v[56:59], v11, s[40:43], s65 offen offset:1024 sc1
    s_lshl_b32 s59, s60, 12
    s_add_u32 s59, s59, 79872
    s_mov_b32 s44, s20
    s_mov_b32 s45, s21
    s_mov_b32 s46, 1966080
    s_mov_b32 s47, 0x20000
    s_mul_i32 s57, s31, 3
    s_add_u32 s57, s57, s60
    s_mul_i32 s57, s57, 81920
    s_lshl_b32 s64, s3, 6
    s_add_u32 s57, s57, s64
    v_lshrrev_b32 v5, 2, v0
    v_mul_u32_u24 v5, 1280, v5
    v_and_b32 v60, 3, v0
    v_lshl_add_u32 v5, v60, 4, v5
    v_add_u32 v5, s57, v5
    s_add_u32 m0, s59, 0
    s_mov_b32 s57, 0
    buffer_load_dwordx4 v5, s[44:47], s57 offen nt lds
    s_add_u32 m0, s59, 1024
    s_mov_b32 s57, 20480
    buffer_load_dwordx4 v5, s[44:47], s57 offen nt lds
    s_add_u32 m0, s59, 2048
    s_mov_b32 s57, 40960
    buffer_load_dwordx4 v5, s[44:47], s57 offen nt lds
    s_add_u32 m0, s59, 3072
    s_mov_b32 s57, 61440
    buffer_load_dwordx4 v5, s[44:47], s57 offen nt lds
    v_bfe_u32 v35, v0, 4, 1
    v_lshlrev_b32 v35, 11, v35
    v_bfe_u32 v60, v0, 2, 2
    v_lshl_add_u32 v35, v60, 8, v35
    v_lshrrev_b32 v60, 5, v0
    v_lshl_add_u32 v35, v60, 6, v35
    v_and_b32 v60, 3, v0
    v_lshl_add_u32 v35, v60, 3, v35
    v_add_u32 v35, s59, v35
    v_mov_b32 v9, 0xbdd2d3e8
    v_mov_b32 v10, 0xc0135761
    s_lshl_b32 s57, s60, 7
    s_add_u32 s57, s57, 159872
L_pad3:
    s_cbranch_execz L_pad7
    v_lshlrev_b32 v32, 3, v0
    v_add_u32 v32, s57, v32
    v_lshlrev_b32 v33, 3, v0
    v_add_u32 v33, 129024, v33
    v_cmp_gt_u32 vcc, 16, v0
    s_nop 1
    v_cndmask_b32 v32, v33, v32, vcc
    v_and_b32 v33, 15, v0
    v_lshlrev_b32 v33, 3, v33
    v_lshrrev_b32 v60, 5, v0
    v_lshl_add_u32 v33, v60, 2, v33
    v_add_u32 v33, 159872, v33
    v_and_b32 v34, 15, v0
    v_lshlrev_b32 v34, 2, v34
    v_lshrrev_b32 v60, 5, v0
    v_lshl_add_u32 v34, v60, 6, v34
    v_bfe_u32 v60, v0, 4, 1
    v_lshl_add_u32 v34, v60, 13, v34
    s_add_u32 s60, s6, 66048
    s_add_u32 s58, s62, 13312
    s_add_u32 s57, s62, 25856
    v_and_b32 v7, 7, v0
    v_lshlrev_b32 v7, 3, v7
    v_mov_b32 v60, 0x3acccccd
    v_mov_b32 v61, 0x3727c5ac
    s_waitcnt vmcnt(0)
    buffer_load_dwordx2 v[24:25], v7, s[40:43], s57 offen sc1
    buffer_load_dwordx4 v[12:15], v11, s[40:43], s58 offen offset:0 sc1
    buffer_load_dwordx4 v[16:19], v11, s[40:43], s58 offen offset:1024 sc1
    ds_read_b64_tr_b16 v[36:37], v35 offset:0
    ds_read_b64_tr_b16 v[38:39], v35 offset:1024
    ds_read_b64_tr_b16 v[40:41], v35 offset:128
    ds_read_b64_tr_b16 v[42:43], v35 offset:1152
    ds_read_b64_tr_b16 v[44:45], v35 offset:32
    ds_read_b64_tr_b16 v[46:47], v35 offset:1056
    ds_read_b64_tr_b16 v[48:49], v35 offset:160
    ds_read_b64_tr_b16 v[50:51], v35 offset:1184
L_sw_131:
    v_max3_u32 v20, v52, v53, v54
    v_max3_u32 v20, v20, v55, v56
    v_max3_u32 v20, v20, v57, v58
    v_max_u32 v20, v20, v59
    v_cmp_eq_u32 vcc, -1, v20
    s_cbranch_vccnz L_sr_132
    v_pk_add_f32 v[28:29], v[52:53], v[56:57]
    v_pk_add_f32 v[30:31], v[54:55], v[58:59]
    s_nop 1
    v_permlane32_swap_b32 v28, v30
    v_permlane32_swap_b32 v29, v31
    v_pk_add_f32 v[28:29], v[28:29], v[30:31]
    s_nop 1
    v_permlane16_swap_b32 v28, v29
    v_add_f32 v28, v28, v29
    v_mov_b64 v[52:53], 0
    v_mov_b64 v[54:55], 0
    v_mov_b64 v[56:57], 0
    v_mov_b64 v[58:59], 0
    s_waitcnt lgkmcnt(0)
    s_branch L_pw_129
.p2align 5
L_pr_130:
    buffer_load_dwordx2 v[24:25], v7, s[40:43], s57 offen sc1
    buffer_load_dwordx4 v[12:15], v11, s[40:43], s58 offen offset:0 sc1
    buffer_load_dwordx4 v[16:19], v11, s[40:43], s58 offen offset:1024 sc1
    s_sub_u32 s56, s56, 1
    s_cbranch_scc1 L_done
L_pw_129:
    s_waitcnt vmcnt(0)
    v_max_u32 v20, v24, v25
    v_cmp_eq_u32 vcc, -1, v20
    s_cbranch_vccnz L_pr_130
    buffer_load_dwordx4 v[12:15], v11, s[40:43], s58 offen offset:0 sc1
    buffer_load_dwordx4 v[16:19], v11, s[40:43], s58 offen offset:1024 sc1
    v_add_f32_dpp v2, v24, v24 row_ror:4 row_mask:0xf bank_mask:0xf
    v_add_f32_dpp v3, v25, v25 row_ror:4 row_mask:0xf bank_mask:0xf
    v_pk_add_f32 v[20:21], v[12:13], v[16:17]
    v_pk_add_f32 v[22:23], v[14:15], v[18:19]
    v_add_f32_dpp v2, v2, v2 row_ror:2 row_mask:0xf bank_mask:0xf
    v_add_f32_dpp v3, v3, v3 row_ror:2 row_mask:0xf bank_mask:0xf
    v_permlane32_swap_b32 v20, v22
    v_permlane32_swap_b32 v21, v23
    v_add_f32_dpp v2, v2, v2 row_ror:1 row_mask:0xf bank_mask:0xf
    v_add_f32_dpp v3, v3, v3 row_ror:1 row_mask:0xf bank_mask:0xf
    v_pk_add_f32 v[20:21], v[20:21], v[22:23]
    v_mul_f32 v2, v2, v60
    v_fma_f32 v3, v3, v60, v61
    v_permlane16_swap_b32 v20, v21
L_pad4:
    s_cbranch_execz L_pad8
    v_fma_f32 v3, -v2, v2, v3
    v_add_f32 v20, v20, v21
    v_max_f32 v3, v3, v61
    v_mul_f32 v26, v28, v2
    v_rsq_f32 v3, v3
    v_cmp_u_f32 vcc, v20, v20
    v_sub_f32 v20, v20, v26
    s_cbranch_vccnz L_hr_133
L_hk_134:
    v_fma_f32 v20, v20, v3, v4
    v_mul_f32 v21, v20, v20
    v_fma_f32 v21, v21, v9, v10
    v_mul_f32 v21, v21, v20
    v_exp_f32 v21, v21
    s_nop 0
    v_add_f32 v21, 1.0, v21
    v_rcp_f32 v21, v21
    s_nop 0
    v_mul_f32 v20, v20, v21
    s_nop 1
    v_mov_b32_dpp v21, v20 row_shl:1 row_mask:0xf bank_mask:0xf bound_ctrl:0
    v_cvt_pk_bf16_f32 v28, v20, v21
    s_nop 1
    v_mov_b32_dpp v29, v28 row_shl:4 row_mask:0xf bank_mask:0xf bound_ctrl:0
    v_mov_b32_dpp v30, v28 row_shl:8 row_mask:0xf bank_mask:0xf bound_ctrl:0
    v_mov_b32_dpp v31, v28 row_shl:12 row_mask:0xf bank_mask:0xf bound_ctrl:0
    s_nop 1
    v_smfmac_f32_16x16x64_bf16 v[52:55], v[28:31], v[36:43], v1
    v_smfmac_f32_16x16x64_bf16 v[56:59], v[28:31], v[44:51], v1
    s_cmp_eq_u32 s30, 4
    s_nop 5
    v_add_f32 v22, v52, v54
    v_add_f32 v23, v56, v58
    ds_write_b64 v32, v[22:23]
    s_cbranch_scc0 L_skip_136
L_xw_137:
    ds_read2_b32 v[20:21], v33 offset0:0 offset1:32
    ds_read_b32 v22, v33 offset:256
    s_sub_u32 s56, s56, 1
    s_cbranch_scc1 L_done
    s_waitcnt lgkmcnt(0)
    v_max3_u32 v23, v20, v21, v22
    v_add_f32 v20, v20, v21
    v_cmp_eq_u32 vcc, -1, v23
    v_add_f32 v20, v20, v22
    s_cbranch_vccnz L_xw_137
    buffer_store_dword v20, v34, s[40:43], s60 offen sc1
    s_waitcnt vmcnt(1)
    s_branch L_pe_138
.p2align 5
L_skip_136:
    s_waitcnt vmcnt(0)
L_pe_138:
L_skip_128:
    s_branch L_p1
.p2align 5
L_typeB_0:
    s_cmp_eq_u32 s53, 3
    s_cbranch_scc0 L_typeC_139
    s_cmp_eq_u32 s30, 7
    s_cbranch_scc1 L_w7_150
    s_cmp_lt_u32 s30, 6
    s_cbranch_scc0 L_skip_152
    s_lshr_b32 s57, s30, 1
    s_mul_i32 s57, s57, 128
    s_and_b32 s58, s30, 1
    s_lshl_b32 s58, s58, 6
    s_add_u32 s57, s57, s58
    v_lshrrev_b32 v18, 5, v0
    v_lshlrev_b32 v18, 13, v18
    v_bfe_u32 v60, v0, 3, 1
    v_lshl_add_u32 v18, v60, 12, v18
    v_bfe_u32 v60, v0, 4, 1
    v_lshl_add_u32 v18, v60, 11, v18
    v_bfe_u32 v60, v0, 2, 1
    v_mul_u32_u24 v60, 384, v60
    v_add_u32 v18, v60, v18
    v_and_b32 v60, 3, v0
    v_lshl_add_u32 v18, v60, 3, v18
    v_add_u32 v18, s57, v18
    v_add_u32 v18, 30720, v18
    v_bfe_u32 v19, v0, 4, 1
    v_lshlrev_b32 v19, 12, v19
    v_bfe_u32 v60, v0, 3, 1
    v_lshl_add_u32 v19, v60, 11, v19
    v_bfe_u32 v60, v0, 2, 1
    v_mul_u32_u24 v60, 384, v60
    v_add_u32 v19, v60, v19
    v_and_b32 v60, 3, v0
    v_lshl_add_u32 v19, v60, 3, v19
    v_add_u32 v19, s57, v19
    v_add_u32 v19, 63488, v19
    ds_read_b64_tr_b16 v[28:29], v18 offset:0
    ds_read_b64_tr_b16 v[30:31], v18 offset:1024
    ds_read_b64_tr_b16 v[32:33], v18 offset:16384
L_pad5:
    s_cbranch_execz L_pad9
    ds_read_b64_tr_b16 v[34:35], v18 offset:17408
    ds_read_b64_tr_b16 v[36:37], v19 offset:0
    ds_read_b64_tr_b16 v[38:39], v19 offset:1024
    ds_read_b64_tr_b16 v[40:41], v18 offset:32
    ds_read_b64_tr_b16 v[42:43], v18 offset:1056
    ds_read_b64_tr_b16 v[44:45], v18 offset:16416
    ds_read_b64_tr_b16 v[46:47], v18 offset:17440
    ds_read_b64_tr_b16 v[48:49], v19 offset:32
    ds_read_b64_tr_b16 v[50:51], v19 offset:1056
    v_lshrrev_b32 v9, 4, v0
    v_lshlrev_b32 v9, 5, v9
    v_bfe_u32 v60, v0, 1, 1
    v_lshl_add_u32 v9, v60, 4, v9
    v_and_b32 v60, 1, v0
    v_mul_u32_u24 v60, 192, v60
    v_add_u32 v9, v60, v9
    v_add_u32 v9, 160832, v9
    v_lshrrev_b32 v10, 4, v0
    v_lshlrev_b32 v10, 4, v10
    v_bfe_u32 v60, v0, 1, 1
    v_lshl_add_u32 v10, v60, 3, v10
    v_and_b32 v60, 1, v0
    v_mul_u32_u24 v60, 192, v60
    v_add_u32 v10, v60, v10
    v_add_u32 v10, 160960, v10
    v_mov_b64 v[20:21], 0
    v_mov_b64 v[22:23], 0
    v_mov_b64 v[24:25], 0
    v_mov_b64 v[26:27], 0
    s_lshr_b32 s57, s30, 1
    s_lshl_b32 s57, s57, 11
    s_lshl_b32 s58, s58, 1
    s_add_u32 s57, s57, s58
    s_lshl_b32 s58, s54, 8
    s_add_u32 s57, s57, s58
    v_and_b32 v11, 31, v0
    v_lshlrev_b32 v11, 2, v11
    v_lshrrev_b32 v60, 5, v0
    v_lshl_add_u32 v11, v60, 30, v11
    v_add_u32 v11, s57, v11
    s_add_u32 s59, s62, 13312
    s_add_u32 s60, s62, 25856
    ds_read_b128 v[12:15], v9
    ds_read_b64 v[16:17], v10
    s_waitcnt lgkmcnt(1)
    v_smfmac_f32_16x16x64_bf16 v[20:23], v[12:15], v[28:35], v1
    v_smfmac_f32_16x16x64_bf16 v[24:27], v[12:15], v[40:47], v1
    s_waitcnt lgkmcnt(0)
    v_smfmac_f32_16x16x32_bf16 v[20:23], v[16:17], v[36:39], v1
    v_smfmac_f32_16x16x32_bf16 v[24:27], v[16:17], v[48:51], v1
    s_add_u32 s60, s62, 19456
    s_cmp_eq_u32 s55, 0
    s_nop 4
    v_add_f32 v12, v21, v23
    s_nop 1
    v_add_f32_dpp v12, v25, v27 quad_perm:[0,1,2,3] row_mask:0x2 bank_mask:0xf
    s_cbranch_scc1 L_gs_153
    buffer_store_dword v12, v11, s[40:43], s60 offen
L_gb_154:
    v_mov_b64 v[20:21], 0
    v_mov_b64 v[22:23], 0
    v_mov_b64 v[24:25], 0
    v_mov_b64 v[26:27], 0
L_skip_152:
    s_cmp_lt_u32 s30, 6
    s_barrier
    s_cbranch_scc0 L_se_151
    ds_read_b128 v[12:15], v9
    ds_read_b64 v[16:17], v10
    s_waitcnt lgkmcnt(1)
    v_smfmac_f32_16x16x64_bf16 v[20:23], v[12:15], v[28:35], v1
    v_smfmac_f32_16x16x64_bf16 v[24:27], v[12:15], v[40:47], v1
    s_waitcnt lgkmcnt(0)
    v_smfmac_f32_16x16x32_bf16 v[20:23], v[16:17], v[36:39], v1
    v_smfmac_f32_16x16x32_bf16 v[24:27], v[16:17], v[48:51], v1
    s_cmp_eq_u32 s55, 0
    s_nop 5
    v_add_f32 v12, v20, v22
    s_nop 1
    v_add_f32_dpp v12, v24, v26 quad_perm:[0,1,2,3] row_mask:0x2 bank_mask:0xf
    s_cbranch_scc1 L_gs_155
    buffer_store_dword v12, v11, s[40:43], s59 offen
L_gb_156:
L_se_151:
L_p1:
    s_lshl_b32 s57, s30, 7
    s_add_u32 s57, s57, 158720
    v_lshrrev_b32 v58, 4, v0
    v_lshlrev_b32 v58, 5, v58
    v_bfe_u32 v60, v0, 1, 1
    v_lshl_add_u32 v58, v60, 4, v58
L_pad6:
    s_cbranch_execz L_pad10
    v_bfe_u32 v60, v0, 2, 2
    v_lshl_add_u32 v58, v60, 2, v58
    v_and_b32 v60, 1, v0
    v_lshl_add_u32 v58, v60, 1, v58
    v_add_u32 v58, s57, v58
    v_lshrrev_b32 v61, 4, v0
    v_lshlrev_b32 v61, 5, v61
    v_bfe_u32 v60, v0, 1, 1
    v_lshl_add_u32 v61, v60, 4, v61
    v_add_u32 v61, s57, v61
    v_bfe_u32 v62, v0, 2, 2
    v_lshlrev_b32 v62, 1, v62
    v_and_b32 v60, 1, v0
    v_lshl_add_u32 v62, v60, 0, v62
    v_mov_b32 v60, 160992
    v_cmp_eq_u32 vcc, 0, v62
    s_nop 1
    v_cndmask_b32 v52, v60, v61, vcc
    v_cmp_eq_u32 vcc, 1, v62
    s_nop 1
    v_cndmask_b32 v53, v60, v61, vcc
    v_cmp_eq_u32 vcc, 2, v62
    s_nop 1
    v_cndmask_b32 v54, v60, v61, vcc
    v_cmp_eq_u32 vcc, 3, v62
    s_nop 1
    v_cndmask_b32 v55, v60, v61, vcc
    v_cmp_eq_u32 vcc, 4, v62
    s_nop 1
    v_cndmask_b32 v56, v60, v61, vcc
    v_cmp_eq_u32 vcc, 5, v62
    s_nop 1
    v_cndmask_b32 v57, v60, v61, vcc
    s_lshl_b32 s58, s30, 2
    s_add_u32 s58, s58, 159808
    v_mov_b32 v60, s58
    v_lshlrev_b32 v59, 2, v0
    v_add_u32 v59, 158208, v59
    v_cmp_eq_u32 vcc, 63, v0
    s_nop 1
    v_cndmask_b32 v59, v59, v60, vcc
    v_and_b32 v62, 7, v0
    v_lshlrev_b32 v62, 2, v62
    v_add_u32 v62, 159808, v62
    s_lshl_b32 s57, s30, 11
    v_lshlrev_b32 v63, 4, v0
    v_add_u32 v63, s57, v63
    v_add_u32 v63, 92160, v63
    s_sub_u32 s57, s30, 1
    s_lshl_b32 s58, s57, 11
    v_lshlrev_b32 v7, 4, v0
    v_add_u32 v7, s58, v7
    s_lshl_b32 s58, s57, 7
    v_bfe_u32 v8, v0, 2, 2
    v_lshlrev_b32 v8, 5, v8
    v_lshrrev_b32 v60, 5, v0
    v_lshl_add_u32 v8, v60, 4, v8
    v_and_b32 v60, 3, v0
    v_lshl_add_u32 v8, v60, 2, v8
    v_bfe_u32 v60, v0, 4, 1
    v_lshl_add_u32 v8, v60, 1, v8
    v_add_u32 v8, s58, v8
    v_add_u32 v8, 124928, v8
    s_cmp_eq_u32 s30, 7
    s_cbranch_scc1 L_w7_164
    s_cmp_lt_u32 s30, 6
    s_cbranch_scc0 L_skip_166
    s_lshr_b32 s57, s30, 1
    s_mul_i32 s57, s57, 1024
    s_and_b32 s58, s30, 1
    s_lshl_b32 s58, s58, 6
    s_add_u32 s57, s57, s58
    v_lshrrev_b32 v18, 5, v0
    v_mul_u32_u24 v18, 6144, v18
    v_bfe_u32 v60, v0, 3, 1
    v_mul_u32_u24 v60, 3072, v60
    v_add_u32 v18, v60, v18
    v_bfe_u32 v60, v0, 4, 1
    v_lshl_add_u32 v18, v60, 9, v18
    v_bfe_u32 v60, v0, 2, 1
    v_lshl_add_u32 v18, v60, 7, v18
    v_and_b32 v60, 3, v0
    v_lshl_add_u32 v18, v60, 3, v18
    v_add_u32 v18, s57, v18
    v_bfe_u32 v19, v0, 4, 1
    v_mul_u32_u24 v19, 3072, v19
    v_bfe_u32 v60, v0, 3, 1
    v_lshl_add_u32 v19, v60, 9, v19
    v_bfe_u32 v60, v0, 2, 1
    v_lshl_add_u32 v19, v60, 7, v19
    v_and_b32 v60, 3, v0
    v_lshl_add_u32 v19, v60, 3, v19
    v_add_u32 v19, s57, v19
L_pad7:
    s_cbranch_execz L_pad11
    v_add_u32 v19, 24576, v19
    ds_read_b64_tr_b16 v[28:29], v18 offset:0
    ds_read_b64_tr_b16 v[30:31], v18 offset:256
    ds_read_b64_tr_b16 v[32:33], v18 offset:12288
    ds_read_b64_tr_b16 v[34:35], v18 offset:12544
    ds_read_b64_tr_b16 v[36:37], v19 offset:0
    ds_read_b64_tr_b16 v[38:39], v19 offset:256
    ds_read_b64_tr_b16 v[40:41], v18 offset:32
    ds_read_b64_tr_b16 v[42:43], v18 offset:288
    ds_read_b64_tr_b16 v[44:45], v18 offset:12320
    ds_read_b64_tr_b16 v[46:47], v18 offset:12576
    ds_read_b64_tr_b16 v[48:49], v19 offset:32
    ds_read_b64_tr_b16 v[50:51], v19 offset:288
    v_lshrrev_b32 v9, 4, v0
    v_lshlrev_b32 v9, 5, v9
    v_bfe_u32 v60, v0, 1, 1
    v_lshl_add_u32 v9, v60, 4, v9
    v_and_b32 v60, 1, v0
    v_mul_u32_u24 v60, 192, v60
    v_add_u32 v9, v60, v9
    v_add_u32 v9, 160832, v9
    v_lshrrev_b32 v10, 4, v0
    v_lshlrev_b32 v10, 4, v10
    v_bfe_u32 v60, v0, 1, 1
    v_lshl_add_u32 v10, v60, 3, v10
    v_and_b32 v60, 1, v0
    v_mul_u32_u24 v60, 192, v60
    v_add_u32 v10, v60, v10
    v_add_u32 v10, 160960, v10
    v_mov_b64 v[20:21], 0
    v_mov_b64 v[22:23], 0
    v_mov_b64 v[24:25], 0
    v_mov_b64 v[26:27], 0
    s_lshr_b32 s57, s30, 1
    s_lshl_b32 s57, s57, 11
    s_lshl_b32 s58, s58, 1
    s_add_u32 s57, s57, s58
    s_lshl_b32 s58, s54, 8
    s_add_u32 s57, s57, s58
    v_and_b32 v11, 31, v0
    v_lshlrev_b32 v11, 2, v11
    v_lshrrev_b32 v60, 5, v0
    v_lshl_add_u32 v11, v60, 30, v11
    v_add_u32 v11, s57, v11
    s_mul_i32 s59, s53, 6144
    s_add_u32 s59, s59, s62
    s_add_u32 s59, s59, 46080
    s_lshl_b32 s60, s53, 6
    s_add_u32 s60, s60, s62
    s_add_u32 s60, s60, 25600
L_skip_166:
    s_cmp_lt_u32 s30, 6
    s_barrier
    s_cbranch_scc0 L_se_165
    ds_read_b128 v[12:15], v9
    ds_read_b64 v[16:17], v10
    s_waitcnt lgkmcnt(1)
    v_smfmac_f32_16x16x64_bf16 v[20:23], v[12:15], v[28:35], v1
    v_smfmac_f32_16x16x64_bf16 v[24:27], v[12:15], v[40:47], v1
    s_waitcnt lgkmcnt(0)
    v_smfmac_f32_16x16x32_bf16 v[20:23], v[16:17], v[36:39], v1
    v_smfmac_f32_16x16x32_bf16 v[24:27], v[16:17], v[48:51], v1
    s_cmp_eq_u32 s55, 0
    s_nop 5
    v_add_f32 v12, v20, v22
    s_nop 1
    v_add_f32_dpp v12, v24, v26 quad_perm:[0,1,2,3] row_mask:0x2 bank_mask:0xf
    s_cbranch_scc1 L_gs_167
    buffer_store_dword v12, v11, s[40:43], s59 offen
L_gb_168:
L_se_165:
    s_sub_u32 s57, s30, 1
    s_cmp_lt_u32 s57, 3
    s_cbranch_scc0 L_qo_182
    v_and_b32 v9, 7, v0
    v_lshlrev_b32 v9, 3, v9
    buffer_load_dwordx2 v[10:11], v9, s[40:43], s60 offen sc1
    buffer_load_dwordx4 v[12:15], v7, s[40:43], s59 offen offset:0 sc1
    buffer_load_dwordx4 v[16:19], v7, s[40:43], s59 offen offset:1024 sc1
    v_mov_b64 v[24:25], 0
    v_mov_b64 v[26:27], 0
    v_mov_b64 v[28:29], 0
    v_mov_b64 v[30:31], 0
    v_mov_b64 v[32:33], 0
    v_mov_b64 v[34:35], 0
    v_mov_b64 v[36:37], 0
    v_mov_b64 v[38:39], 0
    v_mov_b64 v[40:41], 0
    v_mov_b64 v[42:43], 0
    v_mov_b64 v[44:45], 0
    v_mov_b64 v[46:47], 0
    v_lshrrev_b32 v5, 4, v0
    v_lshlrev_b32 v5, 5, v5
    v_bfe_u32 v60, v0, 1, 1
L_pad8:
    s_cbranch_execz L_pad12
    v_lshl_add_u32 v5, v60, 4, v5
    v_add_u32 v5, 124928, v5
    v_mov_b32 v60, 0x3c75e03e
    v_mov_b32 v61, 0x3a71d1e6
    v_mov_b32 v51, 0x3e13985d
    s_branch L_pw_184
.p2align 5
L_pr_185:
    buffer_load_dwordx2 v[10:11], v9, s[40:43], s60 offen sc1
    buffer_load_dwordx4 v[12:15], v7, s[40:43], s59 offen offset:0 sc1
    buffer_load_dwordx4 v[16:19], v7, s[40:43], s59 offen offset:1024 sc1
    s_sub_u32 s56, s56, 1
    s_cbranch_scc1 L_done
L_pw_184:
    s_waitcnt vmcnt(0)
    v_max_u32 v20, v10, v11
    v_cmp_eq_u32 vcc, -1, v20
    s_cbranch_vccnz L_pr_185
    v_add_f32_dpp v48, v10, v10 row_ror:4 row_mask:0xf bank_mask:0xf
    v_add_f32_dpp v49, v11, v11 row_ror:4 row_mask:0xf bank_mask:0xf
    v_pk_add_f32 v[20:21], v[12:13], v[16:17]
    v_pk_add_f32 v[22:23], v[14:15], v[18:19]
    v_add_f32_dpp v48, v48, v48 row_ror:2 row_mask:0xf bank_mask:0xf
    v_add_f32_dpp v49, v49, v49 row_ror:2 row_mask:0xf bank_mask:0xf
    v_permlane32_swap_b32 v20, v22
    v_permlane32_swap_b32 v21, v23
    v_add_f32_dpp v48, v48, v48 row_ror:1 row_mask:0xf bank_mask:0xf
    v_add_f32_dpp v49, v49, v49 row_ror:1 row_mask:0xf bank_mask:0xf
    v_pk_add_f32 v[20:21], v[20:21], v[22:23]
    v_mul_f32 v48, v48, v60
    v_fma_f32 v49, v49, v51, v61
    v_permlane16_swap_b32 v20, v21
    v_fma_f32 v49, -v48, v48, v49
    v_add_f32 v20, v20, v21
    v_max_f32 v49, v49, v61
    v_mul_f32 v50, v6, v48
    v_rsq_f32 v49, v49
    v_cmp_u_f32 vcc, v20, v20
    v_sub_f32 v20, v20, v50
    s_cbranch_vccnz L_hr_186
L_hk_187:
    v_mul_f32 v20, v20, v49
    v_cvt_pk_bf16_f32 v20, v20, v20
    ds_write_b16 v8, v20
L_qb_183:
    s_waitcnt lgkmcnt(0)
    s_barrier
    ds_read_b128 v[12:15], v5 offset:0
    ds_read_b128 v[16:19], v5 offset:128
    ds_read_b128 v[20:23], v5 offset:256
    s_cmp_lt_u32 s30, 4
    s_waitcnt lgkmcnt(0)
    v_smfmac_f32_16x16x64_bf16 v[24:27], v[12:15], v[64:71], v1
    v_smfmac_f32_16x16x64_bf16 v[24:27], v[16:19], v[72:79], v1
    v_smfmac_f32_16x16x64_bf16 v[24:27], v[20:23], v[80:87], v1
    v_smfmac_f32_16x16x64_bf16 v[28:31], v[12:15], v[88:95], v1
    v_smfmac_f32_16x16x64_bf16 v[28:31], v[16:19], v[96:103], v1
    v_smfmac_f32_16x16x64_bf16 v[28:31], v[20:23], v[104:111], v1
    v_smfmac_f32_16x16x64_bf16 v[32:35], v[12:15], v[112:119], v1
    v_smfmac_f32_16x16x64_bf16 v[32:35], v[16:19], v[120:127], v1
    v_smfmac_f32_16x16x64_bf16 v[32:35], v[20:23], v[128:135], v1
    v_smfmac_f32_16x16x64_bf16 v[36:39], v[12:15], v[136:143], v1
    v_smfmac_f32_16x16x64_bf16 v[36:39], v[16:19], v[144:151], v1
    v_smfmac_f32_16x16x64_bf16 v[36:39], v[20:23], v[152:159], v1
    v_add_f32 v24, v24, v26
    s_nop 0
    v_add_f32 v28, v28, v30
    s_nop 1
    v_add_f32 v32, v32, v34
    v_max3_f32 v61, v24, v28, v32
    v_mov_b32_dpp v24, v28 quad_perm:[0,1,2,3] row_mask:0x2 bank_mask:0xf
    v_add_f32 v36, v36, v38
    v_max_f32 v61, v61, v36
    v_mov_b32_dpp v24, v32 quad_perm:[0,1,2,3] row_mask:0x4 bank_mask:0xf
    s_nop 0
    v_max_f32_dpp v61, v61, v61 row_ror:8 row_mask:0xf bank_mask:0xf
    s_nop 0
    v_mov_b32_dpp v24, v36 quad_perm:[0,1,2,3] row_mask:0x8 bank_mask:0xf
    v_max_f32_dpp v61, v61, v61 row_ror:4 row_mask:0xf bank_mask:0xf
    s_nop 1
    v_max_f32_dpp v61, v61, v61 row_ror:2 row_mask:0xf bank_mask:0xf
    s_nop 1
    v_max_f32_dpp v61, v61, v61 row_ror:1 row_mask:0xf bank_mask:0xf
    v_sub_f32 v36, v24, v61
L_pad9:
    s_cbranch_execz L_pad13
    ds_write_b32 v59, v61
    v_exp_f32 v36, v36
    s_nop 0
    v_cvt_pk_bf16_f32 v39, v36, v36
    ds_write_b16 v58, v39
    ds_read_b128 v[12:15], v52
    ds_read_b128 v[16:19], v53
    ds_read_b128 v[20:23], v54
    ds_read_b128 v[24:27], v55
    ds_read_b128 v[28:31], v56
    ds_read_b128 v[32:35], v57
    v_add_f32_dpp v38, v36, v36 row_ror:8 row_mask:0xf bank_mask:0xf
    s_nop 1
    v_add_f32_dpp v38, v38, v38 row_ror:4 row_mask:0xf bank_mask:0xf
    s_nop 1
    v_add_f32_dpp v38, v38, v38 row_ror:2 row_mask:0xf bank_mask:0xf
    s_cbranch_scc1 L_eo_191
    s_waitcnt lgkmcnt(5)
    v_smfmac_f32_16x16x64_bf16 v[40:43], v[12:15], v[160:167], v1
    v_add_f32_dpp v38, v38, v38 row_ror:1 row_mask:0xf bank_mask:0xf
    v_smfmac_f32_16x16x64_bf16 v[44:47], v[12:15], v[208:215], v1
    ds_read_b32 v36, v62
    s_waitcnt lgkmcnt(5)
    v_smfmac_f32_16x16x64_bf16 v[40:43], v[16:19], v[168:175], v1
    v_add_f32_dpp v38, v38, v38 row_bcast:15 row_mask:0xa bank_mask:0xf
    v_smfmac_f32_16x16x64_bf16 v[44:47], v[16:19], v[216:223], v1
    s_waitcnt lgkmcnt(4)
    v_smfmac_f32_16x16x64_bf16 v[40:43], v[20:23], v[176:183], v1
    v_add_f32_dpp v38, v38, v38 row_bcast:31 row_mask:0xc bank_mask:0xf
    v_smfmac_f32_16x16x64_bf16 v[44:47], v[20:23], v[224:231], v1
    s_waitcnt lgkmcnt(0)
    v_max_f32_dpp v37, v36, v36 row_ror:4 row_mask:0xf bank_mask:0xf
    v_smfmac_f32_16x16x64_bf16 v[40:43], v[24:27], v[184:191], v1
    v_smfmac_f32_16x16x64_bf16 v[44:47], v[24:27], v[232:239], v1
    v_max_f32_dpp v37, v37, v37 row_ror:2 row_mask:0xf bank_mask:0xf
    v_smfmac_f32_16x16x64_bf16 v[40:43], v[28:31], v[192:199], v1
    v_cmp_eq_u32 vcc, -1, v36
    v_smfmac_f32_16x16x64_bf16 v[44:47], v[28:31], v[240:247], v1
    v_max_f32_dpp v37, v37, v37 row_ror:1 row_mask:0xf bank_mask:0xf
    v_smfmac_f32_16x16x64_bf16 v[40:43], v[32:35], v[200:207], v1
    v_sub_f32 v39, v61, v37
    v_smfmac_f32_16x16x64_bf16 v[44:47], v[32:35], v[248:255], v1
    v_exp_f32 v39, v39
    s_cbranch_vccnz L_mr_189
L_mk_190:
    v_mul_f32 v38, v38, v39
    ds_write_b32 v63, v38 offset:1024
    s_cmp_lt_u32 s30, 2
    s_nop 0
    v_pk_add_f32 v[40:41], v[40:41], v[42:43]
    s_nop 0
    v_pk_add_f32 v[42:43], v[44:45], v[46:47]
    v_pk_mul_f32 v[40:41], v[40:41], v[38:39] op_sel:[0,1] op_sel_hi:[1,1]
    v_pk_mul_f32 v[42:43], v[42:43], v[38:39] op_sel:[0,1] op_sel_hi:[1,1]
    ds_write_b128 v63, v[40:43]
    s_cbranch_scc1 L_comb_1
    s_waitcnt lgkmcnt(0)
    s_barrier
L_comb_1b:
    s_cmp_lt_u32 s3, 20
    s_cbranch_scc0 L_typeB_1
    s_mul_i32 s74, s30, 1664
    s_add_u32 s74, s74, s62
    s_add_u32 s74, s74, 26624
    v_and_b32 v56, 7, v0
    v_lshlrev_b32 v56, 2, v56
    v_lshrrev_b32 v62, 4, v0
    v_lshlrev_b32 v62, 3, v62
    buffer_load_dword v52, v56, s[40:43], s74 offen offset:1536 sc1
    buffer_load_dwordx2 v[54:55], v62, s[40:43], s74 offen offset:1536 sc1
    v_lshlrev_b32 v57, 4, v0
    v_lshlrev_b32 v58, 3, v0
    s_mul_i32 s57, s30, 6144
    s_add_u32 s57, s57, 30720
    v_lshrrev_b32 v59, 2, v0
    v_lshlrev_b32 v59, 6, v59
    v_bfe_u32 v53, v0, 4, 1
    v_lshl_add_u32 v59, v53, 5, v59
    v_and_b32 v53, 3, v0
    v_lshl_add_u32 v59, v53, 3, v59
    v_add_u32 v59, s57, v59
    v_xor_b32 v60, 32, v59
    s_lshl_b32 s57, s30, 8
L_pad10:
    s_cbranch_execz L_pad14
    s_add_u32 s57, s57, 157696
    v_lshl_add_u32 v61, v0, 2, s57
    ds_read_b64_tr_b16 v[28:29], v59 offset:0
    ds_read_b64_tr_b16 v[30:31], v59 offset:1024
    ds_read_b64_tr_b16 v[32:33], v59 offset:2048
    ds_read_b64_tr_b16 v[34:35], v59 offset:3072
    ds_read_b64_tr_b16 v[36:37], v59 offset:4096
    ds_read_b64_tr_b16 v[38:39], v59 offset:5120
    ds_read_b64_tr_b16 v[40:41], v60 offset:0
    ds_read_b64_tr_b16 v[42:43], v60 offset:1024
    ds_read_b64_tr_b16 v[44:45], v60 offset:2048
    ds_read_b64_tr_b16 v[46:47], v60 offset:3072
    ds_read_b64_tr_b16 v[48:49], v60 offset:4096
    ds_read_b64_tr_b16 v[50:51], v60 offset:5120
    v_mov_b64 v[20:21], 0
    v_mov_b64 v[22:23], 0
    v_mov_b64 v[24:25], 0
    v_mov_b64 v[26:27], 0
    s_add_u32 s58, s6, 132096
    s_branch L_pw_198
.p2align 5
L_pr_199:
    buffer_load_dword v52, v56, s[40:43], s74 offen offset:1536 sc1
    buffer_load_dwordx2 v[54:55], v62, s[40:43], s74 offen offset:1536 sc1
    s_sub_u32 s56, s56, 1
    s_cbranch_scc1 L_done
L_pw_198:
    s_waitcnt vmcnt(0)
    v_max3_u32 v53, v52, v54, v55
    v_cmp_eq_u32 vcc, -1, v53
    s_cbranch_vccnz L_pr_199
    buffer_load_dwordx4 v[12:15], v57, s[40:43], s74 offen sc1
    buffer_load_dwordx2 v[16:17], v58, s[40:43], s74 offen offset:1024 sc1
    buffer_load_dword v18, v56, s[40:43], s74 offen offset:1568 sc1
    v_max_f32_dpp v53, v52, v52 row_ror:4 row_mask:0xf bank_mask:0xf
    s_nop 1
    v_max_f32_dpp v53, v53, v53 row_ror:2 row_mask:0xf bank_mask:0xf
    s_nop 1
    v_max_f32_dpp v53, v53, v53 row_ror:1 row_mask:0xf bank_mask:0xf
    v_sub_f32 v52, v52, v53
    v_sub_f32 v54, v54, v53
    v_sub_f32 v55, v55, v53
    v_exp_f32 v52, v52
    v_exp_f32 v54, v54
    v_exp_f32 v55, v55
    s_waitcnt lgkmcnt(0)
    s_branch L_ow_200
.p2align 5
L_or_201:
    buffer_load_dwordx4 v[12:15], v57, s[40:43], s74 offen sc1
    buffer_load_dwordx2 v[16:17], v58, s[40:43], s74 offen offset:1024 sc1
    buffer_load_dword v18, v56, s[40:43], s74 offen offset:1568 sc1
    s_sub_u32 s56, s56, 1
    s_cbranch_scc1 L_done
    v_mov_b64 v[20:21], 0
    v_mov_b64 v[22:23], 0
    v_mov_b64 v[24:25], 0
    v_mov_b64 v[26:27], 0
L_ow_200:
    s_waitcnt vmcnt(2)
    v_smfmac_f32_16x16x64_bf16 v[20:23], v[12:15], v[28:35], v1
    v_max3_u32 v19, v12, v13, v14
    v_smfmac_f32_16x16x64_bf16 v[24:27], v[12:15], v[40:47], v1
    s_waitcnt vmcnt(0)
    v_mul_f32 v53, v52, v18
    v_smfmac_f32_16x16x32_bf16 v[20:23], v[16:17], v[36:39], v1
    v_max3_u32 v62, v15, v16, v17
    v_smfmac_f32_16x16x32_bf16 v[24:27], v[16:17], v[48:51], v1
    v_max3_u32 v19, v19, v62, v18
    v_add_f32_dpp v53, v53, v53 row_ror:4 row_mask:0xf bank_mask:0xf
    v_cmp_eq_u32 vcc, -1, v19
    s_cmp_eq_u32 s30, 2
    v_add_f32_dpp v53, v53, v53 row_ror:2 row_mask:0xf bank_mask:0xf
    s_cbranch_vccnz L_or_201
    s_nop 0
    v_add_f32_dpp v53, v53, v53 row_ror:1 row_mask:0xf bank_mask:0xf
    v_rcp_f32 v52, v53
    v_pk_add_f32 v[20:21], v[20:21], v[22:23]
    v_pk_add_f32 v[24:25], v[24:25], v[26:27]
    v_pk_mul_f32 v[54:55], v[54:55], v[52:53] op_sel:[0,0] op_sel_hi:[1,0]
    v_mul_f32 v20, v20, v54
    v_mul_f32 v24, v24, v54
L_pad11:
    s_cbranch_execz L_pad15
    v_fmac_f32 v20, v21, v55
    v_fmac_f32 v24, v25, v55
    s_nop 1
    v_permlane32_swap_b32 v20, v24
    v_add_f32 v20, v20, v24
    ds_write_b32 v61, v20
    s_waitcnt lgkmcnt(0)
    s_barrier
    s_cbranch_scc0 L_finb_202
    ds_read2st64_b32 v[12:13], v2 offset0:0 offset1:1
    ds_read2st64_b32 v[14:15], v2 offset0:2 offset1:3
    ds_read2st64_b32 v[16:17], v2 offset0:4 offset1:5
    ds_read2st64_b32 v[18:19], v2 offset0:6 offset1:7
    s_waitcnt lgkmcnt(2)
    v_pk_add_f32 v[12:13], v[12:13], v[14:15]
    s_waitcnt lgkmcnt(0)
    v_pk_add_f32 v[16:17], v[16:17], v[18:19]
    v_pk_add_f32 v[12:13], v[12:13], v[16:17]
    v_add_f32 v14, v12, v13
    v_add_f32 v15, v12, v13
    s_nop 1
    v_permlane16_swap_b32 v14, v15
    v_add_f32 v12, v14, v15
    buffer_store_dword v12, v3, s[40:43], s58 offen sc1
L_finb_202:
    s_sub_u32 s57, s30, 4
    s_cmp_lt_u32 s57, 3
    s_cbranch_scc0 L_skip_203
    s_sub_u32 s60, s30, 4
    s_lshl_b32 s57, s60, 11
    v_lshlrev_b32 v11, 4, v0
    v_add_u32 v11, s57, v11
    s_add_u32 s65, s62, 19456
    buffer_load_dwordx4 v[52:55], v11, s[40:43], s65 offen offset:0 sc1
    buffer_load_dwordx4 v[56:59], v11, s[40:43], s65 offen offset:1024 sc1
    s_lshl_b32 s59, s60, 12
    s_add_u32 s59, s59, 79872
    v_bfe_u32 v35, v0, 4, 1
    v_lshlrev_b32 v35, 11, v35
    v_bfe_u32 v60, v0, 2, 2
    v_lshl_add_u32 v35, v60, 8, v35
    v_lshrrev_b32 v60, 5, v0
    v_lshl_add_u32 v35, v60, 6, v35
    v_and_b32 v60, 3, v0
    v_lshl_add_u32 v35, v60, 3, v35
    v_add_u32 v35, s59, v35
    v_mov_b32 v9, 0xbdd2d3e8
    v_mov_b32 v10, 0xc0135761
    s_lshl_b32 s57, s60, 7
    s_add_u32 s57, s57, 160256
    v_lshlrev_b32 v32, 3, v0
    v_add_u32 v32, s57, v32
    v_lshlrev_b32 v33, 3, v0
    v_add_u32 v33, 129024, v33
    v_cmp_gt_u32 vcc, 16, v0
    s_nop 1
    v_cndmask_b32 v32, v33, v32, vcc
    v_and_b32 v33, 15, v0
    v_lshlrev_b32 v33, 3, v33
    v_lshrrev_b32 v60, 5, v0
    v_lshl_add_u32 v33, v60, 2, v33
    v_add_u32 v33, 160256, v33
    v_and_b32 v34, 15, v0
    v_lshlrev_b32 v34, 2, v34
    v_lshrrev_b32 v60, 5, v0
    v_lshl_add_u32 v34, v60, 6, v34
    v_bfe_u32 v60, v0, 4, 1
    v_lshl_add_u32 v34, v60, 13, v34
    s_add_u32 s60, s6, 198144
    s_add_u32 s58, s62, 39936
    s_add_u32 s57, s62, 25984
    v_and_b32 v7, 7, v0
    v_lshlrev_b32 v7, 3, v7
    v_mov_b32 v60, 0x3acccccd
    v_mov_b32 v61, 0x3727c5ac
    s_waitcnt vmcnt(0)
    buffer_load_dwordx2 v[24:25], v7, s[40:43], s57 offen sc1
    buffer_load_dwordx4 v[12:15], v11, s[40:43], s58 offen offset:0 sc1
    buffer_load_dwordx4 v[16:19], v11, s[40:43], s58 offen offset:1024 sc1
    ds_read_b64_tr_b16 v[36:37], v35 offset:0
    ds_read_b64_tr_b16 v[38:39], v35 offset:1024
    ds_read_b64_tr_b16 v[40:41], v35 offset:128
    ds_read_b64_tr_b16 v[42:43], v35 offset:1152
    ds_read_b64_tr_b16 v[44:45], v35 offset:32
    ds_read_b64_tr_b16 v[46:47], v35 offset:1056
    ds_read_b64_tr_b16 v[48:49], v35 offset:160
L_pad12:
    s_cbranch_execz L_pad16
    ds_read_b64_tr_b16 v[50:51], v35 offset:1184
L_sw_206:
    v_max3_u32 v20, v52, v53, v54
    v_max3_u32 v20, v20, v55, v56
    v_max3_u32 v20, v20, v57, v58
    v_max_u32 v20, v20, v59
    v_cmp_eq_u32 vcc, -1, v20
    s_cbranch_vccnz L_sr_207
    v_pk_add_f32 v[28:29], v[52:53], v[56:57]
    v_pk_add_f32 v[30:31], v[54:55], v[58:59]
    s_nop 1
    v_permlane32_swap_b32 v28, v30
    v_permlane32_swap_b32 v29, v31
    v_pk_add_f32 v[28:29], v[28:29], v[30:31]
    s_nop 1
    v_permlane16_swap_b32 v28, v29
    v_add_f32 v28, v28, v29
    v_mov_b64 v[52:53], 0
    v_mov_b64 v[54:55], 0
    v_mov_b64 v[56:57], 0
    v_mov_b64 v[58:59], 0
    s_waitcnt lgkmcnt(0)
    s_branch L_pw_204
.p2align 5
L_pr_205:
    buffer_load_dwordx2 v[24:25], v7, s[40:43], s57 offen sc1
    buffer_load_dwordx4 v[12:15], v11, s[40:43], s58 offen offset:0 sc1
    buffer_load_dwordx4 v[16:19], v11, s[40:43], s58 offen offset:1024 sc1
    s_sub_u32 s56, s56, 1
    s_cbranch_scc1 L_done
L_pw_204:
    s_waitcnt vmcnt(0)
    v_max_u32 v20, v24, v25
    v_cmp_eq_u32 vcc, -1, v20
    s_cbranch_vccnz L_pr_205
    buffer_load_dwordx4 v[12:15], v11, s[40:43], s58 offen offset:0 sc1
    buffer_load_dwordx4 v[16:19], v11, s[40:43], s58 offen offset:1024 sc1
    v_add_f32_dpp v2, v24, v24 row_ror:4 row_mask:0xf bank_mask:0xf
    v_add_f32_dpp v3, v25, v25 row_ror:4 row_mask:0xf bank_mask:0xf
    v_pk_add_f32 v[20:21], v[12:13], v[16:17]
    v_pk_add_f32 v[22:23], v[14:15], v[18:19]
    v_add_f32_dpp v2, v2, v2 row_ror:2 row_mask:0xf bank_mask:0xf
    v_add_f32_dpp v3, v3, v3 row_ror:2 row_mask:0xf bank_mask:0xf
    v_permlane32_swap_b32 v20, v22
    v_permlane32_swap_b32 v21, v23
    v_add_f32_dpp v2, v2, v2 row_ror:1 row_mask:0xf bank_mask:0xf
    v_add_f32_dpp v3, v3, v3 row_ror:1 row_mask:0xf bank_mask:0xf
    v_pk_add_f32 v[20:21], v[20:21], v[22:23]
    v_mul_f32 v2, v2, v60
    v_fma_f32 v3, v3, v60, v61
    v_permlane16_swap_b32 v20, v21
    v_fma_f32 v3, -v2, v2, v3
    v_add_f32 v20, v20, v21
    v_max_f32 v3, v3, v61
    v_mul_f32 v26, v28, v2
    v_rsq_f32 v3, v3
    v_cmp_u_f32 vcc, v20, v20
    v_sub_f32 v20, v20, v26
    s_cbranch_vccnz L_hr_208
L_hk_209:
    v_fma_f32 v20, v20, v3, v4
    v_mul_f32 v21, v20, v20
    v_fma_f32 v21, v21, v9, v10
    v_mul_f32 v21, v21, v20
    v_exp_f32 v21, v21
    s_nop 0
    v_add_f32 v21, 1.0, v21
    v_rcp_f32 v21, v21
    s_nop 0
    v_mul_f32 v20, v20, v21
    s_nop 1
    v_mov_b32_dpp v21, v20 row_shl:1 row_mask:0xf bank_mask:0xf bound_ctrl:0
    v_cvt_pk_bf16_f32 v28, v20, v21
    s_nop 1
    v_mov_b32_dpp v29, v28 row_shl:4 row_mask:0xf bank_mask:0xf bound_ctrl:0
    v_mov_b32_dpp v30, v28 row_shl:8 row_mask:0xf bank_mask:0xf bound_ctrl:0
    v_mov_b32_dpp v31, v28 row_shl:12 row_mask:0xf bank_mask:0xf bound_ctrl:0
    s_nop 1
    v_smfmac_f32_16x16x64_bf16 v[52:55], v[28:31], v[36:43], v1
    v_smfmac_f32_16x16x64_bf16 v[56:59], v[28:31], v[44:51], v1
    s_cmp_eq_u32 s30, 4
    s_nop 5
    v_add_f32 v22, v52, v54
    v_add_f32 v23, v56, v58
    ds_write_b64 v32, v[22:23]
    s_cbranch_scc0 L_skip_211
L_xw_212:
    ds_read2_b32 v[20:21], v33 offset0:0 offset1:32
    ds_read_b32 v22, v33 offset:256
    s_sub_u32 s56, s56, 1
    s_cbranch_scc1 L_done
    s_waitcnt lgkmcnt(0)
    v_max3_u32 v23, v20, v21, v22
    v_add_f32 v20, v20, v21
    v_cmp_eq_u32 vcc, -1, v23
L_pad13:
    s_cbranch_execz L_pad17
    v_add_f32 v20, v20, v22
    s_cbranch_vccnz L_xw_212
    buffer_store_dword v20, v34, s[40:43], s60 offen sc1
L_skip_211:
L_skip_203:
    s_branch L_done
.p2align 5
L_typeB_1:
    s_cmp_eq_u32 s53, 3
    s_cbranch_scc0 L_typeC_213
    s_cmp_eq_u32 s30, 7
    s_cbranch_scc1 L_w7_218
    s_cmp_lt_u32 s30, 6
    s_cbranch_scc0 L_skip_220
    s_lshr_b32 s57, s30, 1
    s_mul_i32 s57, s57, 128
    s_and_b32 s58, s30, 1
    s_lshl_b32 s58, s58, 6
    s_add_u32 s57, s57, s58
    v_lshrrev_b32 v18, 5, v0
    v_lshlrev_b32 v18, 13, v18
    v_bfe_u32 v60, v0, 3, 1
    v_lshl_add_u32 v18, v60, 12, v18
    v_bfe_u32 v60, v0, 4, 1
    v_lshl_add_u32 v18, v60, 11, v18
    v_bfe_u32 v60, v0, 2, 1
    v_mul_u32_u24 v60, 384, v60
    v_add_u32 v18, v60, v18
    v_and_b32 v60, 3, v0
    v_lshl_add_u32 v18, v60, 3, v18
    v_add_u32 v18, s57, v18
    v_add_u32 v18, 30720, v18
    v_bfe_u32 v19, v0, 4, 1
    v_lshlrev_b32 v19, 12, v19
    v_bfe_u32 v60, v0, 3, 1
    v_lshl_add_u32 v19, v60, 11, v19
    v_bfe_u32 v60, v0, 2, 1
    v_mul_u32_u24 v60, 384, v60
    v_add_u32 v19, v60, v19
    v_and_b32 v60, 3, v0
    v_lshl_add_u32 v19, v60, 3, v19
    v_add_u32 v19, s57, v19
    v_add_u32 v19, 63488, v19
    ds_read_b64_tr_b16 v[28:29], v18 offset:0
    ds_read_b64_tr_b16 v[30:31], v18 offset:1024
    ds_read_b64_tr_b16 v[32:33], v18 offset:16384
    ds_read_b64_tr_b16 v[34:35], v18 offset:17408
    ds_read_b64_tr_b16 v[36:37], v19 offset:0
    ds_read_b64_tr_b16 v[38:39], v19 offset:1024
    ds_read_b64_tr_b16 v[40:41], v18 offset:32
    ds_read_b64_tr_b16 v[42:43], v18 offset:1056
    ds_read_b64_tr_b16 v[44:45], v18 offset:16416
    ds_read_b64_tr_b16 v[46:47], v18 offset:17440
    ds_read_b64_tr_b16 v[48:49], v19 offset:32
    ds_read_b64_tr_b16 v[50:51], v19 offset:1056
    v_lshrrev_b32 v9, 4, v0
    v_lshlrev_b32 v9, 5, v9
    v_bfe_u32 v60, v0, 1, 1
    v_lshl_add_u32 v9, v60, 4, v9
    v_and_b32 v60, 1, v0
    v_mul_u32_u24 v60, 192, v60
    v_add_u32 v9, v60, v9
    v_add_u32 v9, 160832, v9
    v_lshrrev_b32 v10, 4, v0
    v_lshlrev_b32 v10, 4, v10
    v_bfe_u32 v60, v0, 1, 1
    v_lshl_add_u32 v10, v60, 3, v10
    v_and_b32 v60, 1, v0
    v_mul_u32_u24 v60, 192, v60
    v_add_u32 v10, v60, v10
    v_add_u32 v10, 160960, v10
    v_mov_b64 v[20:21], 0
    v_mov_b64 v[22:23], 0
    v_mov_b64 v[24:25], 0
    v_mov_b64 v[26:27], 0
    s_lshr_b32 s57, s30, 1
    s_lshl_b32 s57, s57, 11
    s_lshl_b32 s58, s58, 1
    s_add_u32 s57, s57, s58
    s_lshl_b32 s58, s54, 8
    s_add_u32 s57, s57, s58
    v_and_b32 v11, 31, v0
    v_lshlrev_b32 v11, 2, v11
    v_lshrrev_b32 v60, 5, v0
    v_lshl_add_u32 v11, v60, 30, v11
    v_add_u32 v11, s57, v11
    s_add_u32 s59, s62, 39936
    s_add_u32 s60, s62, 25984
L_skip_220:
    s_cmp_lt_u32 s30, 6
L_pad14:
    s_cbranch_execz L_pad18
    s_barrier
    s_cbranch_scc0 L_se_219
    ds_read_b128 v[12:15], v9
    ds_read_b64 v[16:17], v10
    s_waitcnt lgkmcnt(1)
    v_smfmac_f32_16x16x64_bf16 v[20:23], v[12:15], v[28:35], v1
    v_smfmac_f32_16x16x64_bf16 v[24:27], v[12:15], v[40:47], v1
    s_waitcnt lgkmcnt(0)
    v_smfmac_f32_16x16x32_bf16 v[20:23], v[16:17], v[36:39], v1
    v_smfmac_f32_16x16x32_bf16 v[24:27], v[16:17], v[48:51], v1
    s_cmp_eq_u32 s55, 0
    s_nop 5
    v_add_f32 v12, v20, v22
    s_nop 1
    v_add_f32_dpp v12, v24, v26 quad_perm:[0,1,2,3] row_mask:0x2 bank_mask:0xf
    s_cbranch_scc1 L_gs_221
    buffer_store_dword v12, v11, s[40:43], s59 offen
L_gb_222:
L_se_219:
    s_cmp_eq_u32 s30, 7
    s_cbranch_scc0 L_done
    s_cmp_eq_u32 s31, 0
    s_cbranch_scc0 L_done
    v_lshlrev_b32 v60, 16, v4
    v_add_f32 v2, v2, v60
    v_and_b32 v60, 0xffff0000, v4
    v_add_f32 v3, v3, v60
    v_and_b32 v60, 31, v0
    v_min_u32 v60, 19, v60
    s_mul_i32 s57, s54, 160
    v_lshrrev_b32 v7, 5, v0
    v_lshlrev_b32 v7, 2, v7
    v_add_u32 v7, s57, v7
    v_lshl_add_u32 v7, v60, 3, v7
    s_add_u32 s57, s7, 198144
    s_add_u32 s58, s7, 214528
    s_add_u32 s59, s7, 230912
    s_add_u32 s60, s7, 247296
    v_mov_b64 v[36:37], 0
    v_mov_b64 v[38:39], 0
    s_nop 0
    v_mov_b32_dpp v36, v2 quad_perm:[0,1,2,3] row_mask:0x3 bank_mask:0xf
    v_mov_b32_dpp v37, v3 quad_perm:[0,1,2,3] row_mask:0x3 bank_mask:0xf
    v_mov_b32_dpp v38, v2 quad_perm:[0,1,2,3] row_mask:0xc bank_mask:0xf
    v_mov_b32_dpp v39, v3 quad_perm:[0,1,2,3] row_mask:0xc bank_mask:0xf
    s_add_u32 s75, s7, 266252
    v_and_b32 v9, 7, v0
    v_lshlrev_b32 v9, 9, v9
L_pr_234:
    buffer_load_dword v12, v9, s[40:43], s75 offen sc1
    s_sub_u32 s56, s56, 1
    s_cbranch_scc1 L_done
L_pw_233:
    s_waitcnt vmcnt(0)
    v_cmp_eq_u32 vcc, -1, v12
    s_cbranch_vccnz L_pr_234
L_gw_230:
    buffer_load_dwordx4 v[12:15], v5, s[40:43], s57 offen sc1
    buffer_load_dwordx4 v[16:19], v5, s[40:43], s58 offen sc1
    buffer_load_dwordx4 v[20:23], v5, s[40:43], s59 offen sc1
    buffer_load_dwordx4 v[24:27], v5, s[40:43], s60 offen sc1
    s_sub_u32 s56, s56, 1
    s_cbranch_scc1 L_done
    s_and_b32 s74, s56, 31
    s_waitcnt vmcnt(3)
    v_pk_add_f32 v[28:29], v[12:13], v[36:37]
    v_pk_add_f32 v[30:31], v[14:15], v[38:39]
    s_waitcnt vmcnt(2)
    v_pk_add_f32 v[28:29], v[28:29], v[16:17]
    v_pk_add_f32 v[30:31], v[30:31], v[18:19]
    s_waitcnt vmcnt(1)
    v_pk_add_f32 v[28:29], v[28:29], v[20:21]
    v_pk_add_f32 v[30:31], v[30:31], v[22:23]
    s_waitcnt vmcnt(0)
    v_pk_add_f32 v[28:29], v[28:29], v[24:25]
    v_pk_add_f32 v[30:31], v[30:31], v[26:27]
    v_pk_add_f32 v[32:33], v[28:29], v[30:31]
    v_cmp_u_f32 vcc, v32, v33
    v_permlane32_swap_b32 v28, v30
    v_permlane32_swap_b32 v29, v31
    s_cbranch_vccnz L_gr_231
L_gk_232:
    v_pk_add_f32 v[28:29], v[28:29], v[30:31]
    v_cvt_pk_bf16_f32 v28, v28, v29
    global_store_dword v7, v28, s[24:25]
    s_branch L_done
.p2align 5
L_gs_34:
    buffer_store_dword v33, v34, s[40:43], s67 offen sc1
    s_branch L_gb_35
.p2align 5
L_gs_37:
L_pad15:
    s_cbranch_execz L_pad19
    buffer_store_dword v12, v54, s[40:43], s59 offen sc1
    s_branch L_gb_38
.p2align 5
L_cr_49:
    s_sub_u32 s56, s56, 1
    s_cbranch_scc1 L_done
    global_load_dword v2, v3, s[26:27] sc1
    s_waitcnt vmcnt(0)
    s_branch L_cw_48
.p2align 5
L_far_50:
    s_lshl_b32 s57, s52, 2
    s_add_u32 s57, s57, s72
    s_mov_b64 exec, 1
    buffer_store_dword v25, v0, s[40:43], s57 offen offset:128 sc1
    s_mov_b64 exec, -1
    s_branch L_fb_51
.p2align 5
L_cr_63:
    s_sub_u32 s56, s56, 1
    s_cbranch_scc1 L_done
    buffer_load_dword v2, v24, s[40:43], s72 offen sc1
    s_branch L_cw_62
.p2align 5
L_gs_70:
    buffer_store_dword v33, v34, s[40:43], s67 offen sc1
    s_branch L_gb_71
.p2align 5
L_gs_73:
    buffer_store_dword v12, v54, s[40:43], s59 offen sc1
    s_branch L_gb_74
.p2align 5
L_gs_91:
    buffer_store_dword v37, v4, s[40:43], s58 offen sc1
    s_branch L_gb_92
.p2align 5
L_cr_105:
    s_sub_u32 s56, s56, 1
    s_cbranch_scc1 L_done
    global_load_dword v2, v3, s[26:27] offset:4 sc1
    s_branch L_cw_104
.p2align 5
L_cr_115:
    buffer_load_dword v52, v56, s[40:43], s74 offen offset:1536 sc1
    buffer_load_dwordx2 v[54:55], v62, s[40:43], s74 offen offset:1536 sc1
    s_sub_u32 s56, s56, 1
    s_cbranch_scc1 L_done
    s_branch L_cw_114
.p2align 5
L_gs_120:
    buffer_store_dword v14, v3, s[40:43], s57 offen sc1
    s_branch L_gb_121
.p2align 5
L_gs_122:
    buffer_store_dword v12, v4, s[40:43], s57 offen offset:32 sc1
    s_branch L_gb_123
.p2align 5
L_comb_0:
    s_mov_b32 s57, 0
    s_cmp_eq_u32 s55, 0
    s_waitcnt lgkmcnt(0)
    s_barrier
    ds_read2st64_b64 v[12:15], v2 offset0:0 offset1:4
    ds_read2st64_b64 v[16:19], v2 offset0:8 offset1:12
    ds_read2st64_b64 v[20:23], v2 offset0:16 offset1:20
    ds_read2st64_b64 v[24:27], v2 offset0:24 offset1:28
    s_waitcnt lgkmcnt(2)
    v_pk_add_f32 v[12:13], v[12:13], v[14:15]
    v_pk_add_f32 v[16:17], v[16:17], v[18:19]
    v_pk_add_f32 v[12:13], v[12:13], v[16:17]
    s_waitcnt lgkmcnt(0)
    v_pk_add_f32 v[20:21], v[20:21], v[22:23]
    v_pk_add_f32 v[24:25], v[24:25], v[26:27]
    v_pk_add_f32 v[12:13], v[12:13], v[20:21]
    v_pk_add_f32 v[12:13], v[12:13], v[24:25]
    v_cvt_pk_bf16_f32 v14, v12, v13
    v_min_u32 v14, -2, v14
    s_cbranch_scc1 L_gs_120
    buffer_store_dword v14, v3, s[40:43], s57 offen
L_gb_121:
    s_cbranch_scc1 L_gs_122
    buffer_store_dword v12, v4, s[40:43], s57 offen offset:32
L_gb_123:
    s_branch L_comb_0b
.p2align 5
L_sr_132:
L_pad16:
    s_cbranch_execz L_pad20
    buffer_load_dwordx4 v[52:55], v11, s[40:43], s65 offen offset:0 sc1
    buffer_load_dwordx4 v[56:59], v11, s[40:43], s65 offen offset:1024 sc1
    s_sub_u32 s56, s56, 1
    s_cbranch_scc1 L_done
    s_waitcnt vmcnt(0)
    s_branch L_sw_131
.p2align 5
L_hr_133:
    buffer_load_dwordx4 v[12:15], v11, s[40:43], s58 offen offset:0 sc1
    buffer_load_dwordx4 v[16:19], v11, s[40:43], s58 offen offset:1024 sc1
    s_sub_u32 s56, s56, 1
    s_cbranch_scc1 L_done
    s_and_b32 s64, s56, 31
    s_cbranch_scc0 L_hx_135
    s_waitcnt vmcnt(2)
    v_pk_add_f32 v[20:21], v[12:13], v[16:17]
    v_pk_add_f32 v[22:23], v[14:15], v[18:19]
    s_nop 1
    v_permlane32_swap_b32 v20, v22
    v_permlane32_swap_b32 v21, v23
    v_pk_add_f32 v[20:21], v[20:21], v[22:23]
    s_nop 1
    v_permlane16_swap_b32 v20, v21
    v_add_f32 v20, v20, v21
    v_cmp_u_f32 vcc, v20, v20
    v_sub_f32 v20, v20, v26
    s_cbranch_vccnz L_hr_133
    s_branch L_hk_134
.p2align 5
L_hx_135:
    s_waitcnt vmcnt(0)
    v_max3_u32 v20, v12, v13, v14
    v_max3_u32 v20, v20, v15, v16
    v_max3_u32 v20, v20, v17, v18
    v_max_u32 v20, v20, v19
    v_cmp_eq_u32 vcc, -1, v20
    s_cbranch_vccnz L_hr_133
    v_pk_add_f32 v[20:21], v[12:13], v[16:17]
    v_pk_add_f32 v[22:23], v[14:15], v[18:19]
    s_nop 1
    v_permlane32_swap_b32 v20, v22
    v_permlane32_swap_b32 v21, v23
    v_pk_add_f32 v[20:21], v[20:21], v[22:23]
    s_nop 1
    v_permlane16_swap_b32 v20, v21
    v_add_f32 v20, v20, v21
    v_sub_f32 v20, v20, v26
    s_branch L_hk_134
L_gs_143:
    buffer_store_dword v0, v11, s[40:43], s58 offen sc1
    s_branch L_gb_144
.p2align 5
L_typeC_139:
    s_cmp_eq_u32 s30, 6
    s_cbranch_scc0 L_p1
    s_bitcmp1_b32 s3, 0
    s_cbranch_scc0 L_skip_140
    v_and_b32 v11, 3, v0
    v_lshlrev_b32 v11, 7, v11
    v_lshrrev_b32 v60, 2, v0
    v_lshl_add_u32 v11, v60, 24, v11
    s_add_u32 s58, s62, 26116
    s_add_u32 s75, s7, 266244
    v_and_b32 v9, 7, v0
    v_lshlrev_b32 v9, 9, v9
L_pr_142:
    buffer_load_dword v12, v9, s[40:43], s75 offen sc1
    s_sub_u32 s56, s56, 1
    s_cbranch_scc1 L_done
L_pw_141:
    s_waitcnt vmcnt(0)
    v_cmp_eq_u32 vcc, -1, v12
    s_cbranch_vccnz L_pr_142
    s_cmp_eq_u32 s55, 0
    s_cbranch_scc1 L_gs_143
    buffer_store_dword v0, v11, s[40:43], s58 offen
L_gb_144:
    s_waitcnt vmcnt(1)
    s_branch L_p1
.p2align 5
L_skip_140:
    s_lshl_b32 s59, s31, 9
    s_add_u32 s59, s59, s8
    s_add_u32 s59, s59, 266240
    v_and_b32 v10, 1, v0
    v_lshlrev_b32 v10, 13, v10
    v_lshrrev_b32 v60, 1, v0
    v_lshl_add_u32 v10, v60, 24, v10
    s_cmp_eq_u32 s3, 20
    s_cbranch_scc0 L_skip_145
    s_add_u32 s58, s62, 1568
    v_lshrrev_b32 v9, 3, v0
    v_mul_u32_u24 v9, 1664, v9
L_pad17:
    s_cbranch_execz L_pad21
    v_and_b32 v60, 7, v0
    v_lshl_add_u32 v9, v60, 2, v9
L_pr_147:
    buffer_load_dword v12, v9, s[40:43], s58 offen sc1
    s_sub_u32 s56, s56, 1
    s_cbranch_scc1 L_done
L_pw_146:
    s_waitcnt vmcnt(0)
    v_cmp_eq_u32 vcc, -1, v12
    s_cbranch_vccnz L_pr_147
    buffer_store_dword v0, v10, s[40:43], s59 offen offset:0 sc1
L_skip_145:
    s_add_u32 s58, s62, 25856
    v_and_b32 v9, 15, v0
    v_lshlrev_b32 v9, 2, v9
L_pr_149:
    buffer_load_dword v13, v9, s[40:43], s58 offen sc1
    s_sub_u32 s56, s56, 1
    s_cbranch_scc1 L_done
L_pw_148:
    s_waitcnt vmcnt(0)
    v_cmp_eq_u32 vcc, -1, v13
    s_cbranch_vccnz L_pr_149
    buffer_store_dword v0, v10, s[40:43], s59 offen offset:4 sc1
    s_waitcnt vmcnt(1)
    s_branch L_p1
.p2align 5
L_gs_153:
    buffer_store_dword v12, v11, s[40:43], s60 offen sc1
    s_branch L_gb_154
.p2align 5
L_gs_155:
    buffer_store_dword v12, v11, s[40:43], s59 offen sc1
    s_branch L_gb_156
.p2align 5
L_gr_158:
    s_cbranch_scc1 L_gw_157
    s_waitcnt vmcnt(0)
    v_max3_u32 v32, v12, v13, v14
    v_max3_u32 v32, v32, v15, v16
    v_max3_u32 v32, v32, v17, v18
    v_max3_u32 v32, v32, v19, v20
    v_max3_u32 v32, v32, v21, v22
    v_max3_u32 v32, v32, v23, v24
    v_max3_u32 v32, v32, v25, v26
    v_max_u32 v32, v32, v27
    v_cmp_eq_u32 vcc, -1, v32
    s_cbranch_vccnz L_gw_157
    v_pk_add_f32 v[28:29], v[12:13], v[36:37]
    v_pk_add_f32 v[30:31], v[14:15], v[38:39]
    v_pk_add_f32 v[28:29], v[28:29], v[16:17]
    v_pk_add_f32 v[30:31], v[30:31], v[18:19]
    v_pk_add_f32 v[28:29], v[28:29], v[20:21]
    v_pk_add_f32 v[30:31], v[30:31], v[22:23]
    v_pk_add_f32 v[28:29], v[28:29], v[24:25]
    v_pk_add_f32 v[30:31], v[30:31], v[26:27]
    s_nop 1
    v_permlane32_swap_b32 v28, v30
    v_permlane32_swap_b32 v29, v31
    s_branch L_gk_159
.p2align 5
L_gs_162:
    buffer_store_dword v33, v34, s[40:43], s67 offen sc1
    s_branch L_gb_163
.p2align 5
L_w7_150:
    v_and_b32 v60, 31, v0
    v_min_u32 v60, 19, v60
    s_mul_i32 s57, s54, 320
    v_lshrrev_b32 v5, 5, v0
    v_lshlrev_b32 v5, 12, v5
    v_add_u32 v5, s57, v5
    v_lshl_add_u32 v5, v60, 4, v5
    v_and_b32 v60, 31, v0
    v_cmp_gt_u32 s[64:65], 20, v60
    v_min_u32 v60, 19, v60
    v_lshrrev_b32 v35, 5, v0
    v_lshlrev_b32 v35, 2, v35
    v_add_u32 v35, 160832, v35
    v_lshl_add_u32 v35, v60, 3, v35
    s_add_u32 s66, s62, 13312
    s_add_u32 s67, s62, 25856
    s_lshl_b32 s57, s54, 3
    v_lshrrev_b32 v34, 5, v0
    v_lshlrev_b32 v34, 2, v34
    v_add_u32 v34, s57, v34
    v_and_b32 v60, 31, v0
    v_mov_b32 v61, 0x7f000000
    v_cmp_ne_u32 vcc, 31, v60
    s_nop 1
L_pad18:
    s_cbranch_execz L_pad22
    v_cndmask_b32 v34, v34, v61, vcc
    v_mov_b32 v61, 0x3f803f80
    s_add_u32 s57, s7, 0
    s_add_u32 s58, s7, 16384
    s_add_u32 s59, s7, 32768
    s_add_u32 s60, s7, 49152
    v_mov_b64 v[36:37], 0
    v_mov_b64 v[38:39], 0
    s_nop 0
    v_mov_b32_dpp v36, v2 quad_perm:[0,1,2,3] row_mask:0x3 bank_mask:0xf
    v_mov_b32_dpp v37, v3 quad_perm:[0,1,2,3] row_mask:0x3 bank_mask:0xf
    v_mov_b32_dpp v38, v2 quad_perm:[0,1,2,3] row_mask:0xc bank_mask:0xf
    v_mov_b32_dpp v39, v3 quad_perm:[0,1,2,3] row_mask:0xc bank_mask:0xf
    s_add_u32 s75, s7, 266240
    v_and_b32 v9, 7, v0
    v_lshlrev_b32 v9, 9, v9
L_pr_161:
    buffer_load_dword v12, v9, s[40:43], s75 offen sc1
    s_sub_u32 s56, s56, 1
    s_cbranch_scc1 L_done
L_pw_160:
    s_waitcnt vmcnt(0)
    v_cmp_eq_u32 vcc, -1, v12
    s_cbranch_vccnz L_pr_161
L_gw_157:
    buffer_load_dwordx4 v[12:15], v5, s[40:43], s57 offen sc1
    buffer_load_dwordx4 v[16:19], v5, s[40:43], s58 offen sc1
    buffer_load_dwordx4 v[20:23], v5, s[40:43], s59 offen sc1
    buffer_load_dwordx4 v[24:27], v5, s[40:43], s60 offen sc1
    s_sub_u32 s56, s56, 1
    s_cbranch_scc1 L_done
    s_and_b32 s74, s56, 31
    s_waitcnt vmcnt(3)
    v_pk_add_f32 v[28:29], v[12:13], v[36:37]
    v_pk_add_f32 v[30:31], v[14:15], v[38:39]
    s_waitcnt vmcnt(2)
    v_pk_add_f32 v[28:29], v[28:29], v[16:17]
    v_pk_add_f32 v[30:31], v[30:31], v[18:19]
    s_waitcnt vmcnt(1)
    v_pk_add_f32 v[28:29], v[28:29], v[20:21]
    v_pk_add_f32 v[30:31], v[30:31], v[22:23]
    s_waitcnt vmcnt(0)
    v_pk_add_f32 v[28:29], v[28:29], v[24:25]
    v_pk_add_f32 v[30:31], v[30:31], v[26:27]
    v_pk_add_f32 v[32:33], v[28:29], v[30:31]
    v_cmp_u_f32 vcc, v32, v33
    v_permlane32_swap_b32 v28, v30
    v_permlane32_swap_b32 v29, v31
    s_cbranch_vccnz L_gr_158
L_gk_159:
    v_pk_add_f32 v[28:29], v[28:29], v[30:31]
    v_cvt_pk_bf16_f32 v28, v28, v29
    ds_write_b32 v35, v28
    s_waitcnt lgkmcnt(0)
    s_barrier
    v_cndmask_b32 v29, 0, v28, s[64:65]
    v_dot2_f32_bf16 v33, v29, v61, 0
    v_dot2_f32_bf16 v32, v29, v29, 0
    v_lshlrev_b32 v2, 16, v28
    v_and_b32 v3, 0xffff0000, v28
    s_cmp_eq_u32 s55, 0
    v_permlane32_swap_b32 v33, v32
    v_add_f32 v33, v33, v32
    s_nop 1
    v_add_f32_dpp v33, v33, v33 row_ror:8 row_mask:0xf bank_mask:0xf
    s_nop 1
    v_add_f32_dpp v33, v33, v33 row_ror:4 row_mask:0xf bank_mask:0xf
    s_nop 1
    v_add_f32_dpp v33, v33, v33 row_ror:2 row_mask:0xf bank_mask:0xf
    s_nop 1
    v_add_f32_dpp v33, v33, v33 row_ror:1 row_mask:0xf bank_mask:0xf
    s_nop 1
    v_add_f32_dpp v33, v33, v33 row_bcast:15 row_mask:0xa bank_mask:0xf
    s_cbranch_scc1 L_gs_162
    buffer_store_dword v33, v34, s[40:43], s67 offen
L_gb_163:
    s_waitcnt vmcnt(1)
    s_branch L_se_151
.p2align 5
L_gs_167:
    buffer_store_dword v12, v11, s[40:43], s59 offen sc1
    s_branch L_gb_168
.p2align 5
L_gr_173:
    s_cbranch_scc1 L_gw_172
    s_waitcnt vmcnt(0)
    v_max3_u32 v32, v12, v13, v14
    v_max3_u32 v32, v32, v15, v16
    v_max3_u32 v32, v32, v17, v18
L_pad19:
    s_cbranch_execz L_pad23
    v_max3_u32 v32, v32, v19, v20
    v_max3_u32 v32, v32, v21, v22
    v_max3_u32 v32, v32, v23, v24
    v_max3_u32 v32, v32, v25, v26
    v_max_u32 v32, v32, v27
    v_cmp_eq_u32 vcc, -1, v32
    s_cbranch_vccnz L_gw_172
    v_pk_add_f32 v[28:29], v[12:13], v[36:37]
    v_pk_add_f32 v[30:31], v[14:15], v[38:39]
    v_pk_add_f32 v[28:29], v[28:29], v[16:17]
    v_pk_add_f32 v[30:31], v[30:31], v[18:19]
    v_pk_add_f32 v[28:29], v[28:29], v[20:21]
    v_pk_add_f32 v[30:31], v[30:31], v[22:23]
    v_pk_add_f32 v[28:29], v[28:29], v[24:25]
    v_pk_add_f32 v[30:31], v[30:31], v[26:27]
    s_nop 1
    v_permlane32_swap_b32 v28, v30
    v_permlane32_swap_b32 v29, v31
    s_branch L_gk_174
L_gr_176:
    s_cbranch_scc1 L_gw_175
    s_waitcnt vmcnt(0)
    v_max3_u32 v32, v12, v13, v14
    v_max3_u32 v32, v32, v15, v16
    v_max3_u32 v32, v32, v17, v18
    v_max3_u32 v32, v32, v19, v20
    v_max3_u32 v32, v32, v21, v22
    v_max3_u32 v32, v32, v23, v24
    v_max3_u32 v32, v32, v25, v26
    v_max_u32 v32, v32, v27
    v_cmp_eq_u32 vcc, -1, v32
    s_cbranch_vccnz L_gw_175
    v_pk_add_f32 v[28:29], v[12:13], v[36:37]
    v_pk_add_f32 v[30:31], v[14:15], v[38:39]
    v_pk_add_f32 v[28:29], v[28:29], v[16:17]
    v_pk_add_f32 v[30:31], v[30:31], v[18:19]
    v_pk_add_f32 v[28:29], v[28:29], v[20:21]
    v_pk_add_f32 v[30:31], v[30:31], v[22:23]
    v_pk_add_f32 v[28:29], v[28:29], v[24:25]
    v_pk_add_f32 v[30:31], v[30:31], v[26:27]
    s_nop 1
    v_permlane32_swap_b32 v28, v30
    v_permlane32_swap_b32 v29, v31
    s_branch L_gk_177
.p2align 5
L_gs_180:
    buffer_store_dword v33, v34, s[40:43], s67 offen sc1
    s_branch L_gb_181
.p2align 5
L_w7_164:
    v_and_b32 v60, 31, v0
    v_min_u32 v60, 19, v60
    s_mul_i32 s57, s54, 320
    v_lshrrev_b32 v5, 5, v0
    v_lshlrev_b32 v5, 12, v5
    v_add_u32 v5, s57, v5
    v_lshl_add_u32 v5, v60, 4, v5
    v_and_b32 v60, 31, v0
    v_cmp_gt_u32 s[64:65], 20, v60
    v_min_u32 v60, 19, v60
    v_lshrrev_b32 v35, 5, v0
    v_lshlrev_b32 v35, 2, v35
    v_add_u32 v35, 160832, v35
    v_lshl_add_u32 v35, v60, 3, v35
    s_mul_i32 s66, s53, 6144
    s_add_u32 s66, s66, s62
    s_add_u32 s66, s66, 46080
    s_lshl_b32 s67, s53, 6
    s_add_u32 s67, s67, s62
    s_add_u32 s67, s67, 25600
    s_lshl_b32 s57, s54, 3
    v_lshrrev_b32 v34, 5, v0
    v_lshlrev_b32 v34, 2, v34
    v_add_u32 v34, s57, v34
    v_and_b32 v60, 31, v0
    v_mov_b32 v61, 0x7f000000
    v_cmp_ne_u32 vcc, 31, v60
    s_nop 1
    v_cndmask_b32 v34, v34, v61, vcc
    v_mov_b32 v61, 0x3f803f80
    s_cmp_lg_u32 s53, 3
    s_cbranch_scc0 L_skip_169
    s_add_u32 s57, s62, 25856
    v_mov_b32 v9, 0
L_pr_171:
    buffer_load_dword v12, v9, s[40:43], s57 offen sc1
    s_sub_u32 s56, s56, 1
L_pad20:
    s_cbranch_execz L_pad24
    s_cbranch_scc1 L_done
L_pw_170:
    s_waitcnt vmcnt(0)
    v_cmp_eq_u32 vcc, -1, v12
    s_cbranch_vccnz L_pr_171
    s_add_u32 s57, s7, 0
    s_add_u32 s58, s7, 16384
    s_add_u32 s59, s7, 32768
    s_add_u32 s60, s7, 49152
    v_mov_b64 v[36:37], 0
    v_mov_b64 v[38:39], 0
    s_nop 0
    v_mov_b32_dpp v36, v2 quad_perm:[0,1,2,3] row_mask:0x3 bank_mask:0xf
    v_mov_b32_dpp v37, v3 quad_perm:[0,1,2,3] row_mask:0x3 bank_mask:0xf
    v_mov_b32_dpp v38, v2 quad_perm:[0,1,2,3] row_mask:0xc bank_mask:0xf
    v_mov_b32_dpp v39, v3 quad_perm:[0,1,2,3] row_mask:0xc bank_mask:0xf
L_gw_172:
    buffer_load_dwordx4 v[12:15], v5, s[40:43], s57 offen sc1
    buffer_load_dwordx4 v[16:19], v5, s[40:43], s58 offen sc1
    buffer_load_dwordx4 v[20:23], v5, s[40:43], s59 offen sc1
    buffer_load_dwordx4 v[24:27], v5, s[40:43], s60 offen sc1
    s_sub_u32 s56, s56, 1
    s_cbranch_scc1 L_done
    s_and_b32 s74, s56, 31
    s_waitcnt vmcnt(3)
    v_pk_add_f32 v[28:29], v[12:13], v[36:37]
    v_pk_add_f32 v[30:31], v[14:15], v[38:39]
    s_waitcnt vmcnt(2)
    v_pk_add_f32 v[28:29], v[28:29], v[16:17]
    v_pk_add_f32 v[30:31], v[30:31], v[18:19]
    s_waitcnt vmcnt(1)
    v_pk_add_f32 v[28:29], v[28:29], v[20:21]
    v_pk_add_f32 v[30:31], v[30:31], v[22:23]
    s_waitcnt vmcnt(0)
    v_pk_add_f32 v[28:29], v[28:29], v[24:25]
    v_pk_add_f32 v[30:31], v[30:31], v[26:27]
    v_pk_add_f32 v[32:33], v[28:29], v[30:31]
    v_cmp_u_f32 vcc, v32, v33
    v_permlane32_swap_b32 v28, v30
    v_permlane32_swap_b32 v29, v31
    s_cbranch_vccnz L_gr_173
L_gk_174:
    v_pk_add_f32 v[28:29], v[28:29], v[30:31]
    v_cvt_pk_bf16_f32 v28, v28, v29
    v_lshlrev_b32 v2, 16, v28
    v_and_b32 v3, 0xffff0000, v28
L_skip_169:
    v_lshlrev_b32 v60, 16, v4
    v_add_f32 v2, v2, v60
    v_and_b32 v60, 0xffff0000, v4
    v_add_f32 v3, v3, v60
    s_add_u32 s57, s7, 66048
    s_add_u32 s58, s7, 82432
    s_add_u32 s59, s7, 98816
    s_add_u32 s60, s7, 115200
    v_mov_b64 v[36:37], 0
    v_mov_b64 v[38:39], 0
    s_nop 0
    v_mov_b32_dpp v36, v2 quad_perm:[0,1,2,3] row_mask:0x3 bank_mask:0xf
    v_mov_b32_dpp v37, v3 quad_perm:[0,1,2,3] row_mask:0x3 bank_mask:0xf
    v_mov_b32_dpp v38, v2 quad_perm:[0,1,2,3] row_mask:0xc bank_mask:0xf
    v_mov_b32_dpp v39, v3 quad_perm:[0,1,2,3] row_mask:0xc bank_mask:0xf
    s_lshl_b32 s74, s53, 7
    s_add_u32 s75, s62, s74
    s_add_u32 s75, s75, 26116
    v_mov_b32 v9, 0
L_pr_179:
    buffer_load_dword v12, v9, s[40:43], s75 offen sc1
    s_sub_u32 s56, s56, 1
    s_cbranch_scc1 L_done
L_pw_178:
    s_waitcnt vmcnt(0)
    v_cmp_eq_u32 vcc, -1, v12
    s_cbranch_vccnz L_pr_179
L_gw_175:
    buffer_load_dwordx4 v[12:15], v5, s[40:43], s57 offen sc1
    buffer_load_dwordx4 v[16:19], v5, s[40:43], s58 offen sc1
    buffer_load_dwordx4 v[20:23], v5, s[40:43], s59 offen sc1
    buffer_load_dwordx4 v[24:27], v5, s[40:43], s60 offen sc1
    s_sub_u32 s56, s56, 1
    s_cbranch_scc1 L_done
    s_and_b32 s74, s56, 31
    s_waitcnt vmcnt(3)
    v_pk_add_f32 v[28:29], v[12:13], v[36:37]
    v_pk_add_f32 v[30:31], v[14:15], v[38:39]
    s_waitcnt vmcnt(2)
    v_pk_add_f32 v[28:29], v[28:29], v[16:17]
    v_pk_add_f32 v[30:31], v[30:31], v[18:19]
    s_waitcnt vmcnt(1)
    v_pk_add_f32 v[28:29], v[28:29], v[20:21]
    v_pk_add_f32 v[30:31], v[30:31], v[22:23]
L_pad21:
    s_cbranch_execz L_pad25
    s_waitcnt vmcnt(0)
    v_pk_add_f32 v[28:29], v[28:29], v[24:25]
    v_pk_add_f32 v[30:31], v[30:31], v[26:27]
    v_pk_add_f32 v[32:33], v[28:29], v[30:31]
    v_cmp_u_f32 vcc, v32, v33
    v_permlane32_swap_b32 v28, v30
    v_permlane32_swap_b32 v29, v31
    s_cbranch_vccnz L_gr_176
L_gk_177:
    v_pk_add_f32 v[28:29], v[28:29], v[30:31]
    v_cvt_pk_bf16_f32 v28, v28, v29
    ds_write_b32 v35, v28
    s_waitcnt lgkmcnt(0)
    s_barrier
    v_cndmask_b32 v29, 0, v28, s[64:65]
    v_dot2_f32_bf16 v33, v29, v61, 0
    v_dot2_f32_bf16 v32, v29, v29, 0
    v_lshlrev_b32 v2, 16, v28
    v_and_b32 v3, 0xffff0000, v28
    s_cmp_eq_u32 s55, 0
    v_permlane32_swap_b32 v33, v32
    v_add_f32 v33, v33, v32
    s_nop 1
    v_add_f32_dpp v33, v33, v33 row_ror:8 row_mask:0xf bank_mask:0xf
    s_nop 1
    v_add_f32_dpp v33, v33, v33 row_ror:4 row_mask:0xf bank_mask:0xf
    s_nop 1
    v_add_f32_dpp v33, v33, v33 row_ror:2 row_mask:0xf bank_mask:0xf
    s_nop 1
    v_add_f32_dpp v33, v33, v33 row_ror:1 row_mask:0xf bank_mask:0xf
    s_nop 1
    v_add_f32_dpp v33, v33, v33 row_bcast:15 row_mask:0xa bank_mask:0xf
    s_cbranch_scc1 L_gs_180
    buffer_store_dword v33, v34, s[40:43], s67 offen
L_gb_181:
    s_waitcnt vmcnt(1)
    s_branch L_se_165
.p2align 5
L_hr_186:
    buffer_load_dwordx4 v[12:15], v7, s[40:43], s59 offen offset:0 sc1
    buffer_load_dwordx4 v[16:19], v7, s[40:43], s59 offen offset:1024 sc1
    s_sub_u32 s56, s56, 1
    s_cbranch_scc1 L_done
    s_and_b32 s64, s56, 31
    s_cbranch_scc0 L_hx_188
    s_waitcnt vmcnt(0)
    v_pk_add_f32 v[20:21], v[12:13], v[16:17]
    v_pk_add_f32 v[22:23], v[14:15], v[18:19]
    s_nop 1
    v_permlane32_swap_b32 v20, v22
    v_permlane32_swap_b32 v21, v23
    v_pk_add_f32 v[20:21], v[20:21], v[22:23]
    s_nop 1
    v_permlane16_swap_b32 v20, v21
    v_add_f32 v20, v20, v21
    v_cmp_u_f32 vcc, v20, v20
    v_sub_f32 v20, v20, v50
    s_cbranch_vccnz L_hr_186
    s_branch L_hk_187
.p2align 5
L_hx_188:
    s_waitcnt vmcnt(0)
    v_max3_u32 v20, v12, v13, v14
    v_max3_u32 v20, v20, v15, v16
    v_max3_u32 v20, v20, v17, v18
    v_max_u32 v20, v20, v19
    v_cmp_eq_u32 vcc, -1, v20
    s_cbranch_vccnz L_hr_186
    v_pk_add_f32 v[20:21], v[12:13], v[16:17]
    v_pk_add_f32 v[22:23], v[14:15], v[18:19]
    s_nop 1
    v_permlane32_swap_b32 v20, v22
    v_permlane32_swap_b32 v21, v23
    v_pk_add_f32 v[20:21], v[20:21], v[22:23]
    s_nop 1
    v_permlane16_swap_b32 v20, v21
    v_add_f32 v20, v20, v21
    v_sub_f32 v20, v20, v50
    s_branch L_hk_187
L_qo_182:
    v_mov_b64 v[24:25], 0
    v_mov_b64 v[26:27], 0
    v_mov_b64 v[28:29], 0
    v_mov_b64 v[30:31], 0
    v_mov_b64 v[32:33], 0
    v_mov_b64 v[34:35], 0
    v_mov_b64 v[36:37], 0
    v_mov_b64 v[38:39], 0
    v_mov_b64 v[40:41], 0
    v_mov_b64 v[42:43], 0
    v_mov_b64 v[44:45], 0
    v_mov_b64 v[46:47], 0
    v_lshrrev_b32 v5, 4, v0
    v_lshlrev_b32 v5, 5, v5
    v_bfe_u32 v60, v0, 1, 1
L_pad22:
    s_cbranch_execz L_padback
    v_lshl_add_u32 v5, v60, 4, v5
    v_add_u32 v5, 124928, v5
    s_branch L_qb_183
.p2align 5
L_eo_191:
    s_waitcnt lgkmcnt(5)
    v_smfmac_f32_16x16x64_bf16 v[40:43], v[12:15], v[160:167], v1
    v_add_f32_dpp v38, v38, v38 row_ror:1 row_mask:0xf bank_mask:0xf
    v_smfmac_f32_16x16x64_bf16 v[44:47], v[12:15], v[208:215], v1
    s_waitcnt lgkmcnt(4)
    v_smfmac_f32_16x16x64_bf16 v[40:43], v[16:19], v[168:175], v1
    v_add_f32_dpp v38, v38, v38 row_bcast:15 row_mask:0xa bank_mask:0xf
    v_smfmac_f32_16x16x64_bf16 v[44:47], v[16:19], v[216:223], v1
    s_waitcnt lgkmcnt(3)
    v_smfmac_f32_16x16x64_bf16 v[40:43], v[20:23], v[176:183], v1
    v_add_f32_dpp v38, v38, v38 row_bcast:31 row_mask:0xc bank_mask:0xf
    v_smfmac_f32_16x16x64_bf16 v[44:47], v[20:23], v[224:231], v1
    s_waitcnt lgkmcnt(0)
    v_smfmac_f32_16x16x64_bf16 v[40:43], v[24:27], v[184:191], v1
    v_smfmac_f32_16x16x64_bf16 v[44:47], v[24:27], v[232:239], v1
    v_smfmac_f32_16x16x64_bf16 v[40:43], v[28:31], v[192:199], v1
    v_smfmac_f32_16x16x64_bf16 v[44:47], v[28:31], v[240:247], v1
    v_smfmac_f32_16x16x64_bf16 v[40:43], v[32:35], v[200:207], v1
    v_smfmac_f32_16x16x64_bf16 v[44:47], v[32:35], v[248:255], v1
L_mr_189:
    ds_read_b32 v36, v62
    s_sub_u32 s56, s56, 1
    s_cbranch_scc1 L_done
    s_waitcnt lgkmcnt(0)
    v_cmp_eq_u32 vcc, -1, v36
    s_cbranch_vccnz L_mr_189
    v_max_f32_dpp v37, v36, v36 row_ror:4 row_mask:0xf bank_mask:0xf
    s_nop 1
    v_max_f32_dpp v37, v37, v37 row_ror:2 row_mask:0xf bank_mask:0xf
    s_nop 1
    v_max_f32_dpp v37, v37, v37 row_ror:1 row_mask:0xf bank_mask:0xf
    v_sub_f32 v39, v61, v37
    v_exp_f32 v39, v39
    s_branch L_mk_190
.p2align 5
L_gs_192:
    buffer_store_dword v37, v4, s[40:43], s58 offen sc1
    s_branch L_gb_193
.p2align 5
L_gs_194:
    buffer_store_dword v14, v3, s[40:43], s57 offen sc1
    s_branch L_gb_195
.p2align 5
L_gs_196:
    buffer_store_dword v12, v4, s[40:43], s57 offen offset:32 sc1
    s_branch L_gb_197
.p2align 5
L_comb_1:
    s_mov_b32 s58, 26624
    s_cmp_eq_u32 s55, 0
    s_cbranch_scc1 L_gs_192
    buffer_store_dword v37, v4, s[40:43], s58 offen
L_gb_193:
    s_mov_b32 s57, 26624
    s_cmp_eq_u32 s55, 0
    s_waitcnt lgkmcnt(0)
    s_barrier
    ds_read2st64_b64 v[12:15], v2 offset0:0 offset1:4
    ds_read2st64_b64 v[16:19], v2 offset0:8 offset1:12
    ds_read2st64_b64 v[20:23], v2 offset0:16 offset1:20
    ds_read2st64_b64 v[24:27], v2 offset0:24 offset1:28
    s_waitcnt lgkmcnt(2)
    v_pk_add_f32 v[12:13], v[12:13], v[14:15]
    v_pk_add_f32 v[16:17], v[16:17], v[18:19]
    v_pk_add_f32 v[12:13], v[12:13], v[16:17]
    s_waitcnt lgkmcnt(0)
    v_pk_add_f32 v[20:21], v[20:21], v[22:23]
    v_pk_add_f32 v[24:25], v[24:25], v[26:27]
    v_pk_add_f32 v[12:13], v[12:13], v[20:21]
    v_pk_add_f32 v[12:13], v[12:13], v[24:25]
    v_cvt_pk_bf16_f32 v14, v12, v13
    v_min_u32 v14, -2, v14
    s_cbranch_scc1 L_gs_194
    buffer_store_dword v14, v3, s[40:43], s57 offen
L_gb_195:
L_pad23:
    s_cbranch_execz L_padback
    s_cbranch_scc1 L_gs_196
    buffer_store_dword v12, v4, s[40:43], s57 offen offset:32
L_gb_197:
    s_branch L_comb_1b
.p2align 5
L_sr_207:
    buffer_load_dwordx4 v[52:55], v11, s[40:43], s65 offen offset:0 sc1
    buffer_load_dwordx4 v[56:59], v11, s[40:43], s65 offen offset:1024 sc1
    s_sub_u32 s56, s56, 1
    s_cbranch_scc1 L_done
    s_waitcnt vmcnt(0)
    s_branch L_sw_206
L_hr_208:
    buffer_load_dwordx4 v[12:15], v11, s[40:43], s58 offen offset:0 sc1
    buffer_load_dwordx4 v[16:19], v11, s[40:43], s58 offen offset:1024 sc1
    s_sub_u32 s56, s56, 1
    s_cbranch_scc1 L_done
    s_and_b32 s64, s56, 31
    s_cbranch_scc0 L_hx_210
    s_waitcnt vmcnt(2)
    v_pk_add_f32 v[20:21], v[12:13], v[16:17]
    v_pk_add_f32 v[22:23], v[14:15], v[18:19]
    s_nop 1
    v_permlane32_swap_b32 v20, v22
    v_permlane32_swap_b32 v21, v23
    v_pk_add_f32 v[20:21], v[20:21], v[22:23]
    s_nop 1
    v_permlane16_swap_b32 v20, v21
    v_add_f32 v20, v20, v21
    v_cmp_u_f32 vcc, v20, v20
    v_sub_f32 v20, v20, v26
    s_cbranch_vccnz L_hr_208
    s_branch L_hk_209
.p2align 5
L_hx_210:
    s_waitcnt vmcnt(0)
    v_max3_u32 v20, v12, v13, v14
    v_max3_u32 v20, v20, v15, v16
    v_max3_u32 v20, v20, v17, v18
    v_max_u32 v20, v20, v19
    v_cmp_eq_u32 vcc, -1, v20
    s_cbranch_vccnz L_hr_208
    v_pk_add_f32 v[20:21], v[12:13], v[16:17]
    v_pk_add_f32 v[22:23], v[14:15], v[18:19]
    s_nop 1
    v_permlane32_swap_b32 v20, v22
    v_permlane32_swap_b32 v21, v23
    v_pk_add_f32 v[20:21], v[20:21], v[22:23]
    s_nop 1
    v_permlane16_swap_b32 v20, v21
    v_add_f32 v20, v20, v21
    v_sub_f32 v20, v20, v26
    s_branch L_hk_209
L_typeC_213:
    s_cmp_eq_u32 s30, 6
    s_cbranch_scc0 L_done
    s_cmp_eq_u32 s3, 20
    s_cbranch_scc0 L_done
    s_lshl_b32 s59, s31, 9
    s_add_u32 s59, s59, s8
    s_add_u32 s59, s59, 266240
    v_and_b32 v10, 1, v0
    v_lshlrev_b32 v10, 13, v10
    v_lshrrev_b32 v60, 1, v0
    v_lshl_add_u32 v10, v60, 24, v10
    s_add_u32 s58, s62, 28192
    v_lshrrev_b32 v9, 3, v0
    v_mul_u32_u24 v9, 1664, v9
    v_and_b32 v60, 7, v0
    v_lshl_add_u32 v9, v60, 2, v9
L_pr_215:
    buffer_load_dword v12, v9, s[40:43], s58 offen sc1
    s_sub_u32 s56, s56, 1
    s_cbranch_scc1 L_done
L_pw_214:
    s_waitcnt vmcnt(0)
    v_cmp_eq_u32 vcc, -1, v12
    s_cbranch_vccnz L_pr_215
    buffer_store_dword v0, v10, s[40:43], s59 offen offset:8 sc1
    s_add_u32 s58, s62, 25984
    v_and_b32 v9, 15, v0
    v_lshlrev_b32 v9, 2, v9
L_pr_217:
    buffer_load_dword v13, v9, s[40:43], s58 offen sc1
    s_sub_u32 s56, s56, 1
    s_cbranch_scc1 L_done
L_pw_216:
    s_waitcnt vmcnt(0)
    v_cmp_eq_u32 vcc, -1, v13
    s_cbranch_vccnz L_pr_217
    buffer_store_dword v0, v10, s[40:43], s59 offen offset:12 sc1
    s_waitcnt vmcnt(1)
    s_branch L_done
.p2align 5
L_gs_221:
    buffer_store_dword v12, v11, s[40:43], s59 offen sc1
    s_branch L_gb_222
.p2align 5
L_gr_224:
L_pad24:
    s_cbranch_execz L_padback
    s_cbranch_scc1 L_gw_223
    s_waitcnt vmcnt(0)
    v_max3_u32 v32, v12, v13, v14
    v_max3_u32 v32, v32, v15, v16
    v_max3_u32 v32, v32, v17, v18
    v_max3_u32 v32, v32, v19, v20
    v_max3_u32 v32, v32, v21, v22
    v_max3_u32 v32, v32, v23, v24
    v_max3_u32 v32, v32, v25, v26
    v_max_u32 v32, v32, v27
    v_cmp_eq_u32 vcc, -1, v32
    s_cbranch_vccnz L_gw_223
    v_pk_add_f32 v[28:29], v[12:13], v[36:37]
    v_pk_add_f32 v[30:31], v[14:15], v[38:39]
    v_pk_add_f32 v[28:29], v[28:29], v[16:17]
    v_pk_add_f32 v[30:31], v[30:31], v[18:19]
    v_pk_add_f32 v[28:29], v[28:29], v[20:21]
    v_pk_add_f32 v[30:31], v[30:31], v[22:23]
    v_pk_add_f32 v[28:29], v[28:29], v[24:25]
    v_pk_add_f32 v[30:31], v[30:31], v[26:27]
    s_nop 1
    v_permlane32_swap_b32 v28, v30
    v_permlane32_swap_b32 v29, v31
    s_branch L_gk_225
L_gs_228:
    buffer_store_dword v33, v34, s[40:43], s67 offen sc1
    s_branch L_gb_229
.p2align 5
L_w7_218:
    v_and_b32 v60, 31, v0
    v_min_u32 v60, 19, v60
    s_mul_i32 s57, s54, 320
    v_lshrrev_b32 v5, 5, v0
    v_lshlrev_b32 v5, 12, v5
    v_add_u32 v5, s57, v5
    v_lshl_add_u32 v5, v60, 4, v5
    v_and_b32 v60, 31, v0
    v_cmp_gt_u32 s[64:65], 20, v60
    v_min_u32 v60, 19, v60
    v_lshrrev_b32 v35, 5, v0
    v_lshlrev_b32 v35, 2, v35
    v_add_u32 v35, 160832, v35
    v_lshl_add_u32 v35, v60, 3, v35
    s_add_u32 s66, s62, 39936
    s_add_u32 s67, s62, 25984
    s_lshl_b32 s57, s54, 3
    v_lshrrev_b32 v34, 5, v0
    v_lshlrev_b32 v34, 2, v34
    v_add_u32 v34, s57, v34
    v_and_b32 v60, 31, v0
    v_mov_b32 v61, 0x7f000000
    v_cmp_ne_u32 vcc, 31, v60
    s_nop 1
    v_cndmask_b32 v34, v34, v61, vcc
    v_mov_b32 v61, 0x3f803f80
    s_add_u32 s57, s7, 132096
    s_add_u32 s58, s7, 148480
    s_add_u32 s59, s7, 164864
    s_add_u32 s60, s7, 181248
    v_mov_b64 v[36:37], 0
    v_mov_b64 v[38:39], 0
    s_nop 0
    v_mov_b32_dpp v36, v2 quad_perm:[0,1,2,3] row_mask:0x3 bank_mask:0xf
    v_mov_b32_dpp v37, v3 quad_perm:[0,1,2,3] row_mask:0x3 bank_mask:0xf
    v_mov_b32_dpp v38, v2 quad_perm:[0,1,2,3] row_mask:0xc bank_mask:0xf
    v_mov_b32_dpp v39, v3 quad_perm:[0,1,2,3] row_mask:0xc bank_mask:0xf
    s_add_u32 s75, s7, 266248
    v_and_b32 v9, 7, v0
    v_lshlrev_b32 v9, 9, v9
L_pr_227:
    buffer_load_dword v12, v9, s[40:43], s75 offen sc1
    s_sub_u32 s56, s56, 1
    s_cbranch_scc1 L_done
L_pw_226:
    s_waitcnt vmcnt(0)
    v_cmp_eq_u32 vcc, -1, v12
    s_cbranch_vccnz L_pr_227
L_gw_223:
    buffer_load_dwordx4 v[12:15], v5, s[40:43], s57 offen sc1
    buffer_load_dwordx4 v[16:19], v5, s[40:43], s58 offen sc1
    buffer_load_dwordx4 v[20:23], v5, s[40:43], s59 offen sc1
    buffer_load_dwordx4 v[24:27], v5, s[40:43], s60 offen sc1
    s_sub_u32 s56, s56, 1
    s_cbranch_scc1 L_done
    s_and_b32 s74, s56, 31
    s_waitcnt vmcnt(3)
    v_pk_add_f32 v[28:29], v[12:13], v[36:37]
    v_pk_add_f32 v[30:31], v[14:15], v[38:39]
L_pad25:
    s_cbranch_execz L_padback
    s_waitcnt vmcnt(2)
    v_pk_add_f32 v[28:29], v[28:29], v[16:17]
    v_pk_add_f32 v[30:31], v[30:31], v[18:19]
    s_waitcnt vmcnt(1)
    v_pk_add_f32 v[28:29], v[28:29], v[20:21]
    v_pk_add_f32 v[30:31], v[30:31], v[22:23]
    s_waitcnt vmcnt(0)
    v_pk_add_f32 v[28:29], v[28:29], v[24:25]
    v_pk_add_f32 v[30:31], v[30:31], v[26:27]
    v_pk_add_f32 v[32:33], v[28:29], v[30:31]
    v_cmp_u_f32 vcc, v32, v33
    v_permlane32_swap_b32 v28, v30
    v_permlane32_swap_b32 v29, v31
    s_cbranch_vccnz L_gr_224
L_gk_225:
    v_pk_add_f32 v[28:29], v[28:29], v[30:31]
    v_cvt_pk_bf16_f32 v28, v28, v29
    ds_write_b32 v35, v28
    s_waitcnt lgkmcnt(0)
    s_barrier
    v_cndmask_b32 v29, 0, v28, s[64:65]
    v_dot2_f32_bf16 v33, v29, v61, 0
    v_dot2_f32_bf16 v32, v29, v29, 0
    v_lshlrev_b32 v2, 16, v28
    v_and_b32 v3, 0xffff0000, v28
    s_cmp_eq_u32 s55, 0
    v_permlane32_swap_b32 v33, v32
    v_add_f32 v33, v33, v32
    s_nop 1
    v_add_f32_dpp v33, v33, v33 row_ror:8 row_mask:0xf bank_mask:0xf
    s_nop 1
    v_add_f32_dpp v33, v33, v33 row_ror:4 row_mask:0xf bank_mask:0xf
    s_nop 1
    v_add_f32_dpp v33, v33, v33 row_ror:2 row_mask:0xf bank_mask:0xf
    s_nop 1
    v_add_f32_dpp v33, v33, v33 row_ror:1 row_mask:0xf bank_mask:0xf
    s_nop 1
    v_add_f32_dpp v33, v33, v33 row_bcast:15 row_mask:0xa bank_mask:0xf
    s_cbranch_scc1 L_gs_228
    buffer_store_dword v33, v34, s[40:43], s67 offen
L_gb_229:
    s_waitcnt vmcnt(1)
    s_branch L_se_219
.p2align 5
L_gr_231:
    s_cbranch_scc1 L_gw_230
    s_waitcnt vmcnt(0)
    v_max3_u32 v32, v12, v13, v14
    v_max3_u32 v32, v32, v15, v16
    v_max3_u32 v32, v32, v17, v18
    v_max3_u32 v32, v32, v19, v20
    v_max3_u32 v32, v32, v21, v22
    v_max3_u32 v32, v32, v23, v24
    v_max3_u32 v32, v32, v25, v26
    v_max_u32 v32, v32, v27
    v_cmp_eq_u32 vcc, -1, v32
    s_cbranch_vccnz L_gw_230
    v_pk_add_f32 v[28:29], v[12:13], v[36:37]
    v_pk_add_f32 v[30:31], v[14:15], v[38:39]
    v_pk_add_f32 v[28:29], v[28:29], v[16:17]
    v_pk_add_f32 v[30:31], v[30:31], v[18:19]
    v_pk_add_f32 v[28:29], v[28:29], v[20:21]
    v_pk_add_f32 v[30:31], v[30:31], v[22:23]
    v_pk_add_f32 v[28:29], v[28:29], v[24:25]
    v_pk_add_f32 v[30:31], v[30:31], v[26:27]
    s_nop 1
    v_permlane32_swap_b32 v28, v30
    v_permlane32_swap_b32 v29, v31
    s_branch L_gk_232
L_tail_end:
.p2align 5
L_spread:
    s_add_u32 s62, s62, 966656
    s_cmp_eq_u32 s30, 5
    s_cbranch_scc0 L_skip_67
    v_mov_b64 v[12:13], -1
    v_mov_b64 v[14:15], -1
    v_lshlrev_b32 v16, 4, v0
    s_mul_i32 s57, s52, 2208
    s_add_u32 s57, s57, s62
    s_mov_b64 exec, 0x3ff
    buffer_store_dwordx4 v[12:15], v16, s[40:43], s57 offen offset:2048 sc1
    s_mov_b64 exec, -1
    buffer_store_dwordx4 v[12:15], v16, s[40:43], s57 offen offset:0 sc1
    buffer_store_dwordx4 v[12:15], v16, s[40:43], s57 offen offset:1024 sc1
L_skip_67:
    s_cmp_eq_u32 s30, 7
    s_cbranch_scc0 L_skip_68
    v_and_b32 v60, 31, v0
    v_cmp_gt_u32 s[64:65], 20, v60
    v_min_u32 v60, 19, v60
    v_lshrrev_b32 v35, 5, v0
    v_lshlrev_b32 v35, 2, v35
    v_add_u32 v35, 160832, v35
    v_lshl_add_u32 v35, v60, 3, v35
    s_mul_i32 s66, s53, 12416
    s_add_u32 s66, s66, s62
    s_add_u32 s66, s66, 70656
    s_add_u32 s67, s66, 12288
    s_lshl_b32 s57, s54, 3
    v_lshrrev_b32 v34, 5, v0
    v_lshlrev_b32 v34, 2, v34
    v_add_u32 v34, s57, v34
    v_and_b32 v60, 31, v0
    v_mov_b32 v61, 0x7f000000
    v_cmp_ne_u32 vcc, 31, v60
    s_nop 1
    v_cndmask_b32 v34, v34, v61, vcc
    v_mov_b32 v61, 0x3f803f80
    v_cvt_pk_bf16_f32 v28, v2, v3
L_skip_68:
    s_cmp_eq_u32 s30, 7
    s_cbranch_scc0 L_skip_69
    v_cndmask_b32 v29, 0, v28, s[64:65]
    v_dot2_f32_bf16 v33, v29, v61, 0
    v_dot2_f32_bf16 v32, v29, v29, 0
    v_lshlrev_b32 v2, 16, v28
    v_and_b32 v3, 0xffff0000, v28
    s_cmp_eq_u32 s55, 0
    v_permlane32_swap_b32 v33, v32
    v_add_f32 v33, v33, v32
    s_nop 1
    v_add_f32_dpp v33, v33, v33 row_ror:8 row_mask:0xf bank_mask:0xf
    s_nop 1
    v_add_f32_dpp v33, v33, v33 row_ror:4 row_mask:0xf bank_mask:0xf
    s_nop 1
    v_add_f32_dpp v33, v33, v33 row_ror:2 row_mask:0xf bank_mask:0xf
    s_nop 1
    v_add_f32_dpp v33, v33, v33 row_ror:1 row_mask:0xf bank_mask:0xf
    s_nop 1
    v_add_f32_dpp v33, v33, v33 row_bcast:15 row_mask:0xa bank_mask:0xf
    s_cbranch_scc1 L_gs_70
    buffer_store_dword v33, v34, s[40:43], s67 offen
L_gb_71:
    s_waitcnt vmcnt(1)
L_skip_69:
    s_cmp_lt_u32 s30, 6
    s_cbranch_scc0 L_skip_72
    s_lshr_b32 s57, s30, 1
    s_mul_i32 s57, s57, 1024
    s_and_b32 s58, s30, 1
    s_lshl_b32 s58, s58, 6
    s_add_u32 s57, s57, s58
    v_lshrrev_b32 v18, 5, v0
    v_mul_u32_u24 v18, 6144, v18
    v_bfe_u32 v60, v0, 3, 1
    v_mul_u32_u24 v60, 3072, v60
    v_add_u32 v18, v60, v18
    v_bfe_u32 v60, v0, 4, 1
    v_lshl_add_u32 v18, v60, 9, v18
    v_bfe_u32 v60, v0, 2, 1
    v_lshl_add_u32 v18, v60, 7, v18
    v_and_b32 v60, 3, v0
    v_lshl_add_u32 v18, v60, 3, v18
    v_add_u32 v18, s57, v18
    v_bfe_u32 v19, v0, 4, 1
    v_mul_u32_u24 v19, 3072, v19
    v_bfe_u32 v60, v0, 3, 1
    v_lshl_add_u32 v19, v60, 9, v19
    v_bfe_u32 v60, v0, 2, 1
    v_lshl_add_u32 v19, v60, 7, v19
    v_and_b32 v60, 3, v0
    v_lshl_add_u32 v19, v60, 3, v19
    v_add_u32 v19, s57, v19
    v_add_u32 v19, 24576, v19
    ds_read_b64_tr_b16 v[28:29], v18 offset:0
    ds_read_b64_tr_b16 v[30:31], v18 offset:256
    ds_read_b64_tr_b16 v[32:33], v18 offset:12288
    ds_read_b64_tr_b16 v[34:35], v18 offset:12544
    ds_read_b64_tr_b16 v[36:37], v19 offset:0
    ds_read_b64_tr_b16 v[38:39], v19 offset:256
    ds_read_b64_tr_b16 v[40:41], v18 offset:32
    ds_read_b64_tr_b16 v[42:43], v18 offset:288
    ds_read_b64_tr_b16 v[44:45], v18 offset:12320
    ds_read_b64_tr_b16 v[46:47], v18 offset:12576
    ds_read_b64_tr_b16 v[48:49], v19 offset:32
    ds_read_b64_tr_b16 v[50:51], v19 offset:288
    v_lshrrev_b32 v52, 4, v0
    v_lshlrev_b32 v52, 5, v52
    v_bfe_u32 v60, v0, 1, 1
    v_lshl_add_u32 v52, v60, 4, v52
    v_and_b32 v60, 1, v0
    v_mul_u32_u24 v60, 192, v60
    v_add_u32 v52, v60, v52
    v_add_u32 v52, 160832, v52
    v_lshrrev_b32 v53, 4, v0
    v_lshlrev_b32 v53, 4, v53
    v_bfe_u32 v60, v0, 1, 1
    v_lshl_add_u32 v53, v60, 3, v53
    v_and_b32 v60, 1, v0
    v_mul_u32_u24 v60, 192, v60
    v_add_u32 v53, v60, v53
    v_add_u32 v53, 160960, v53
    v_mov_b64 v[20:21], 0
    v_mov_b64 v[22:23], 0
    v_mov_b64 v[24:25], 0
    v_mov_b64 v[26:27], 0
    s_lshr_b32 s57, s30, 1
    s_lshl_b32 s57, s57, 11
    s_lshl_b32 s58, s58, 1
    s_add_u32 s57, s57, s58
    s_lshl_b32 s58, s54, 8
    s_add_u32 s57, s57, s58
    v_and_b32 v54, 31, v0
    v_lshlrev_b32 v54, 2, v54
    v_lshrrev_b32 v60, 5, v0
    v_mul_u32_u24 v60, 6144, v60
    v_add_u32 v54, v60, v54
    v_add_u32 v54, s57, v54
    s_mul_i32 s59, s53, 12416
    s_add_u32 s59, s59, s62
    s_add_u32 s59, s59, 70656
    s_add_u32 s60, s59, 12288
    ds_read_b128 v[12:15], v52
    ds_read_b64 v[16:17], v53
    s_waitcnt lgkmcnt(1)
    v_smfmac_f32_16x16x64_bf16 v[20:23], v[12:15], v[28:35], v1
    v_smfmac_f32_16x16x64_bf16 v[24:27], v[12:15], v[40:47], v1
    s_waitcnt lgkmcnt(0)
    v_smfmac_f32_16x16x32_bf16 v[20:23], v[16:17], v[36:39], v1
    v_smfmac_f32_16x16x32_bf16 v[24:27], v[16:17], v[48:51], v1
    s_cmp_eq_u32 s55, 0
    s_nop 5
    v_add_f32 v12, v20, v22
    s_nop 1
    v_add_f32_dpp v12, v24, v26 quad_perm:[0,1,2,3] row_mask:0x2 bank_mask:0xf
    s_nop 1
    v_add_f32_dpp v12, v21, v23 quad_perm:[0,1,2,3] row_mask:0x4 bank_mask:0xf
    s_nop 1
    v_add_f32_dpp v12, v25, v27 quad_perm:[0,1,2,3] row_mask:0x8 bank_mask:0xf
    s_cbranch_scc1 L_gs_73
    buffer_store_dword v12, v54, s[40:43], s59 offen
L_gb_74:
L_skip_72:
    s_waitcnt vmcnt(0)
    s_barrier
    s_cmp_eq_u32 s30, 5
    s_cbranch_scc0 L_skip_75
    v_mov_b32 v25, 0
    s_lshl_b32 s57, s52, 2
    s_add_u32 s57, s57, s72
    s_mov_b64 exec, 1
    buffer_store_dword v25, v0, s[40:43], s57 offen offset:256 sc1
    s_mov_b64 exec, -1
    v_and_b32 v16, 31, v0
    v_lshlrev_b32 v16, 2, v16
L_pr_77:
    buffer_load_dword v17, v16, s[40:43], s72 offen offset:256 sc1
    s_sub_u32 s56, s56, 1
    s_cbranch_scc1 L_done
L_pw_76:
    s_waitcnt vmcnt(0)
    v_cmp_eq_u32 vcc, -1, v17
    s_cbranch_vccnz L_pr_77
L_skip_75:
    s_barrier
    s_branch L_spread_back
.p2align 5
L_done:
L_exit:
    s_endpgm
.section .rodata,"a"
.p2align 6
.amdhsa_kernel interleave_layers__sliding_block_cached__dense_activation_gelu__decode_kernel
  .amdhsa_next_free_vgpr 256
  .amdhsa_next_free_sgpr 102
  .amdhsa_accum_offset 256
  .amdhsa_group_segment_fixed_size 0
  .amdhsa_kernarg_size 104
  .amdhsa_user_sgpr_count 2
  .amdhsa_user_sgpr_kernarg_segment_ptr 1
  .amdhsa_system_sgpr_workgroup_id_x 1
  .amdhsa_float_denorm_mode_32 3
.end_amdhsa_kernel
```

```asm
; @launch grid=(256,1,1) block=(512,1,1) lds=161216
.amdgcn_target "amdgcn-amd-amdhsa--gfx950"
.text
.fill 64, 4, 0xbf800000
.globl interleave_layers__sliding_block_cached__dense_activation_gelu__decode_kernel
.p2align 8
.type interleave_layers__sliding_block_cached__dense_activation_gelu__decode_kernel,@function
interleave_layers__sliding_block_cached__dense_activation_gelu__decode_kernel:
    s_load_dwordx16 s[4:19], s[0:1], 0
    s_cmp_ge_u32 s2, 256
    s_cbranch_scc1 L_exit
    v_lshrrev_b32 v5, 6, v0
    v_lshlrev_b32 v62, 6, v0
    v_readfirstlane_b32 s30, v5
    v_and_b32 v0, 63, v0
    s_getpc_b64 s[74:75]
L_pc:
    v_min_u32 v62, L_exit-L_pc, v62
    global_load_dword v63, v62, s[74:75]
    s_cmp_eq_u32 s30, 6
    s_cbranch_scc0 L_skip_1
    s_setprio 3
L_skip_1:
    s_and_b32 s31, s2, 7
    s_lshr_b32 s52, s2, 3
    s_and_b32 s53, s52, 3
    s_lshr_b32 s54, s52, 2
    s_lshl_b32 s73, s31, 2
    s_add_u32 s73, s73, s53
    v_lshrrev_b32 v8, 5, v0
    v_lshlrev_b32 v8, 2, v8
    v_bfe_u32 v60, v0, 4, 1
    v_lshl_add_u32 v8, v60, 0, v8
    v_and_b32 v9, 7, v0
    v_xor_b32 v8, v8, v9
    v_lshrrev_b32 v10, 3, v0
    v_mul_u32_u24 v10, 384, v10
    v_lshl_add_u32 v5, v8, 4, v10
    v_xor_b32 v6, 32, v5
    s_mul_i32 s64, s73, 12582912
    s_mul_i32 s58, s54, 3072
    s_add_u32 s64, s64, s58
    s_add_u32 s64, s64, 11010048
    s_sub_u32 s34, 1572864, s58
    s_mov_b32 s35, 0x20000
    s_mov_b32 s57, 0
    s_mov_b32 s58, 195584
    s_mov_b32 m0, 92160
    s_cmp_eq_u32 s30, 6
    s_cselect_b64 vcc, -1, 0
    s_waitcnt lgkmcnt(0)
    s_add_u32 s32, s6, s64
    s_addc_u32 s33, s7, 0
    s_load_dwordx8 s[20:27], s[0:1], 64
    s_load_dwordx2 s[28:29], s[0:1], 96
    s_cbranch_vccz L_skip_3
L_dma_2:
    buffer_load_dwordx4 v5, s[32:35], s57 offen offset:0 nt lds
    buffer_load_dwordx4 v6, s[32:35], s58 offen offset:1024 nt lds
    s_add_u32 s57, s57, 24576
    s_add_u32 s58, s58, 24576
    s_add_u32 m0, m0, 2048
    s_cmp_lg_u32 m0, 108544
    s_cbranch_scc1 L_dma_2
    s_mov_b32 s57, 128
    s_mov_b32 s58, 195712
    s_mov_b32 m0, 108544
L_dma_4:
    s_nop 0
    buffer_load_dwordx4 v5, s[32:35], s57 offen offset:0 nt lds
    buffer_load_dwordx4 v6, s[32:35], s58 offen offset:1024 nt lds
    s_add_u32 s57, s57, 24576
    s_add_u32 s58, s58, 24576
    s_add_u32 m0, m0, 2048
    s_cmp_lg_u32 m0, 116736
    s_cbranch_scc1 L_dma_4
L_skip_3:
    s_mul_i32 s3, s54, 3
    s_add_u32 s3, s3, s53
    s_cmp_eq_u32 s53, 3
    s_cselect_b32 s3, 31, s3
    v_lshrrev_b32 v8, 4, v0
    v_lshlrev_b32 v8, 1, v8
    v_xor_b32 v8, v8, v9
    v_lshl_add_u32 v7, v8, 4, v10
    v_lshrrev_b32 v2, 3, v0
    v_mul_u32_u24 v2, 12288, v2
    v_and_b32 v60, 7, v0
    v_lshl_add_u32 v2, v60, 4, v2
    s_mul_i32 s59, s73, 384
    s_mul_i32 s60, s54, 983040
    s_add_u32 s59, s59, s60
    s_sub_u32 s60, 7866368, s59
    s_lshl_b32 s61, s30, 11
    s_add_u32 s61, s61, 92160
    s_mul_i32 s62, s31, 120832
    s_add_u32 s62, s62, 299008
    s_lshl_b32 s72, s31, 9
    s_add_u32 s72, s72, 294912
    s_mov_b32 s56, 65536
    s_mov_b32 s55, 1
    s_getreg_b32 s63, hwreg(20, 0, 3)
    v_mov_b32 v3, 0
    v_mov_b32 v4, 0
    v_mov_b32 v11, 0
    v_mov_b32 v24, 0
    v_mov_b32 v34, 0
    v_mov_b64 v[12:13], -1
    v_mov_b64 v[14:15], -1
    v_lshlrev_b32 v10, 4, v0
    s_waitcnt lgkmcnt(0)
    s_add_u32 s36, s8, s64
    s_addc_u32 s37, s9, 0
    s_mov_b32 s38, s34
    s_mov_b32 s39, 0x20000
    s_mov_b32 s40, s28
    s_mov_b32 s41, s29
    s_mov_b32 s42, 2232320
    s_mov_b32 s43, 0x20000
    s_add_u32 s44, s10, s59
    s_addc_u32 s45, s11, 0
    s_mov_b32 s46, s60
    s_mov_b32 s47, 0x20000
    s_sub_u32 s44, s44, 2048
    s_subb_u32 s45, s45, 0
    s_cmp_eq_u32 s30, 6
    s_cbranch_scc0 L_skip_5
    s_mov_b32 s57, 98432
    s_mov_b32 s58, 294016
    s_mov_b32 m0, 116736
L_dma_6:
    s_waitcnt vmcnt(22)
    buffer_load_dwordx4 v5, s[32:35], s57 offen offset:0 nt lds
    buffer_load_dwordx4 v6, s[32:35], s58 offen offset:1024 nt lds
    s_add_u32 s57, s57, 24576
    s_add_u32 s58, s58, 24576
    s_add_u32 m0, m0, 2048
    s_cmp_lg_u32 m0, 124928
    s_cbranch_scc1 L_dma_6
    s_mov_b32 s57, 2048
    s_mov_b32 s58, 1152
    s_mov_b32 s59, 256
    s_mov_b32 m0, 0
L_dma_7:
    s_waitcnt vmcnt(22)
    buffer_load_dwordx4 v2, s[44:47], s57 offen offset:0 nt lds
    buffer_load_dwordx4 v2, s[44:47], s58 offen offset:1024 nt lds
    buffer_load_dwordx4 v2, s[44:47], s59 offen offset:2048 nt lds
    s_add_u32 s57, s57, 98304
    s_add_u32 s58, s58, 98304
    s_add_u32 s59, s59, 98304
    s_add_u32 m0, m0, 3072
    s_cmp_lg_u32 m0, 15360
    s_cbranch_scc1 L_dma_7
L_skip_5:
    s_cmp_lt_u32 s3, 20
    s_cselect_b32 s57, 7864320, 0
    s_add_u32 s58, s54, 1
    s_mul_i32 s58, s58, 245760
    s_cmp_lg_u32 s53, 3
    s_cselect_b64 s[48:49], s[12:13], s[16:17]
    s_cselect_b32 s50, s57, s58
    s_mov_b32 s51, 0x20000
    s_add_u32 s57, s28, 0
    s_sub_u32 s57, 0, s57
    s_and_b32 s57, s57, 0x3fff
    s_add_u32 s57, s57, 0
    s_lshr_b32 s58, s31, 1
    s_lshl_b32 s58, s58, 14
    s_add_u32 s6, s57, s58
    s_and_b32 s58, s31, 1
    s_lshl_b32 s58, s58, 12
    s_add_u32 s6, s6, s58
    s_lshl_b32 s58, s3, 7
    s_add_u32 s6, s6, s58
    s_mov_b32 s8, s57
    s_and_b32 s59, s3, 3
    s_lshl_b32 s58, s31, 2
    s_add_u32 s59, s59, s58
    s_lshl_b32 s59, s59, 7
    s_add_u32 s59, s59, s57
    s_add_u32 s59, s59, 262144
    s_add_u32 s10, s28, s59
    s_addc_u32 s11, s29, 0
    s_lshr_b32 s58, s63, 2
    s_xor_b32 s58, s58, 0
    s_mul_i32 s58, s58, 8192
    s_add_u32 s7, s57, s58
    s_cmp_eq_u32 s30, 5
    s_cbranch_scc0 L_skip_8
    s_cmp_eq_u32 s52, 31
    s_cbranch_scc0 L_skip_9
    s_mov_b64 exec, 0xffffff
    buffer_store_dwordx4 v[12:15], v10, s[40:43], s72 offen sc1
    s_mov_b64 exec, -1
L_skip_9:
    s_cmp_lt_u32 s3, 20
    s_cbranch_scc0 L_skip_10
    v_and_b32 v16, 7, v0
    v_lshlrev_b32 v16, 4, v16
    v_bfe_u32 v17, v0, 3, 1
    v_lshl_add_u32 v16, v17, 13, v16
    v_lshrrev_b32 v17, 4, v0
    v_mul_u32_u24 v17, 66048, v17
    v_add_u32 v16, v17, v16
    s_add_u32 s57, s6, 0
    buffer_store_dwordx4 v[12:15], v16, s[40:43], s57 offen sc1
L_skip_10:
    s_cmp_eq_u32 s3, 20
    s_cbranch_scc0 L_skip_11
    s_lshl_b32 s58, s31, 9
    s_add_u32 s58, s58, s8
    s_add_u32 s58, s58, 266240
    v_and_b32 v16, 7, v0
    v_lshlrev_b32 v16, 4, v16
    v_bfe_u32 v60, v0, 3, 1
    v_lshl_add_u32 v16, v60, 13, v16
    v_lshrrev_b32 v60, 4, v0
    v_lshl_add_u32 v16, v60, 28, v16
    buffer_store_dwordx4 v[12:15], v16, s[40:43], s58 offen sc1
L_skip_11:
    s_sub_u32 s58, s3, 20
    s_cmp_lt_u32 s58, 4
    s_cselect_b32 s59, s59, 0x7f000000
    v_and_b32 v16, 7, v0
    v_lshlrev_b32 v16, 4, v16
    v_bfe_u32 v60, v0, 3, 1
    v_lshl_add_u32 v16, v60, 13, v16
    v_lshrrev_b32 v60, 4, v0
    v_lshl_add_u32 v16, v60, 28, v16
    buffer_store_dwordx4 v[12:15], v16, s[40:43], s59 offen sc1
    s_mul_i32 s57, s52, 2208
    s_add_u32 s57, s57, s62
    s_mov_b64 exec, 0x3ff
    buffer_store_dwordx4 v[12:15], v10, s[40:43], s57 offen offset:2048
    s_mov_b64 exec, -1
    buffer_store_dwordx4 v[12:15], v10, s[40:43], s57 offen offset:0
    buffer_store_dwordx4 v[12:15], v10, s[40:43], s57 offen offset:1024
    s_mov_b64 exec, -1
    v_lshlrev_b32 v16, 4, v0
    v_add_u32 v16, 159744, v16
    ds_write_b128 v16, v[12:15]
    v_and_b32 v3, 7, v0
    v_lshlrev_b32 v3, 5, v3
L_skip_8:
    s_cmp_eq_u32 s30, 7
    s_cbranch_scc0 L_skip_12
    v_and_b32 v60, 31, v0
    v_min_u32 v60, 19, v60
    s_mul_i32 s57, s54, 160
    v_lshrrev_b32 v16, 5, v0
    v_lshlrev_b32 v16, 2, v16
    v_add_u32 v16, s57, v16
    v_lshl_add_u32 v16, v60, 3, v16
    global_load_dword v28, v16, s[4:5]
    global_load_dword v4, v16, s[22:23]
L_skip_12:
    s_sub_u32 s58, s30, 4
    s_cmp_lt_u32 s58, 3
    s_cbranch_scc0 L_skip_13
    s_mul_i32 s57, s31, 3
    s_add_u32 s57, s57, s58
    s_lshl_b32 s57, s57, 7
    v_and_b32 v16, 15, v0
    v_lshlrev_b32 v16, 3, v16
    v_lshrrev_b32 v60, 4, v0
    v_lshl_add_u32 v16, v60, 1, v16
    v_add_u32 v16, s57, v16
    global_load_short_d16_hi v4, v16, s[18:19]
L_skip_13:
    v_bfe_u32 v8, v0, 1, 3
    v_lshrrev_b32 v9, 4, v0
    v_xor_b32 v9, v8, v9
    v_bfe_u32 v8, v0, 2, 1
    v_lshlrev_b32 v8, 10, v8
    v_bfe_u32 v60, v0, 3, 1
    v_lshl_add_u32 v8, v60, 9, v8
    v_and_b32 v60, 3, v0
    v_lshl_add_u32 v8, v60, 7, v8
    v_add_u32 v8, s61, v8
    v_lshl_add_u32 v8, v9, 4, v8
    v_xor_b32 v9, 64, v8
    v_bfe_u32 v1, v0, 1, 1
    v_mul_u32_u24 v1, 43690, v1
    v_add_u32 v1, 17476, v1
    s_waitcnt vmcnt(31)
    s_barrier
    ds_read_b128 v[64:67], v8 offset:0
    ds_read_b128 v[68:71], v9 offset:0
    s_cmp_eq_u32 s30, 6
    s_cbranch_scc0 L_skip_14
    s_mov_b32 s57, 256
    s_mov_b32 s58, 195840
    s_mov_b32 m0, 124928
L_dma_15:
    s_waitcnt vmcnt(22)
    buffer_load_dwordx4 v5, s[32:35], s57 offen offset:0 nt lds
    buffer_load_dwordx4 v6, s[32:35], s58 offen offset:1024 nt lds
    s_add_u32 s57, s57, 24576
    s_add_u32 s58, s58, 24576
    s_add_u32 m0, m0, 2048
    s_cmp_lg_u32 m0, 141312
    s_cbranch_scc1 L_dma_15
L_skip_14:
    s_waitcnt lgkmcnt(0)
    s_cmp_eq_u32 s30, 5
    s_cbranch_scc0 L_skip_16
    s_cmp_eq_u32 s52, 31
    s_cbranch_scc0 L_skip_17
    s_lshl_b32 s57, s31, 5
    v_mov_b32 v16, s57
    s_add_u32 s57, s63, 1
    v_mov_b32 v12, s57
    s_waitcnt vmcnt(5)
    s_mov_b64 exec, 0x1
    global_store_dword v16, v12, s[26:27] sc1
    s_mov_b64 exec, -1
L_skip_17:
L_skip_16:
    s_waitcnt vmcnt(31)
    s_barrier
    ds_read_b128 v[72:75], v8 offset:16384
    ds_read_b128 v[76:79], v9 offset:16384
    s_cmp_eq_u32 s30, 6
    s_cbranch_scc0 L_skip_18
    s_mov_b32 s57, 493568
    s_mov_b32 s58, 492672
    s_mov_b32 s59, 491776
    s_mov_b32 m0, 15360
L_dma_19:
    s_waitcnt vmcnt(22)
    buffer_load_dwordx4 v2, s[44:47], s57 offen offset:0 nt lds
    buffer_load_dwordx4 v2, s[44:47], s58 offen offset:1024 nt lds
    buffer_load_dwordx4 v2, s[44:47], s59 offen offset:2048 nt lds
    s_add_u32 s57, s57, 98304
    s_add_u32 s58, s58, 98304
    s_add_u32 s59, s59, 98304
    s_add_u32 m0, m0, 3072
    s_cmp_lg_u32 m0, 30720
    s_cbranch_scc1 L_dma_19
    s_mov_b32 s57, 393216
    s_mov_b32 s58, 588800
    s_mov_b32 m0, 141312
L_dma_20:
    s_waitcnt vmcnt(22)
    buffer_load_dwordx4 v5, s[32:35], s57 offen offset:0 nt lds
    buffer_load_dwordx4 v6, s[32:35], s58 offen offset:1024 nt lds
    s_add_u32 s57, s57, 24576
    s_add_u32 s58, s58, 24576
    s_add_u32 m0, m0, 2048
    s_cmp_lg_u32 m0, 157696
    s_cbranch_scc1 L_dma_20
L_skip_18:
    s_waitcnt lgkmcnt(0)
    s_cmp_lt_u32 s30, 4
    s_cbranch_scc0 L_skip_21
    s_mov_b64 exec, 0
    s_cmp_eq_u32 s30, 1
    s_cbranch_scc1 L_pad1
    s_cmp_eq_u32 s30, 2
    s_cbranch_scc1 L_pad2
    s_cmp_eq_u32 s30, 3
    s_cbranch_scc1 L_pad3
    s_branch L_pad0
.p2align 5
L_padback:
    s_mov_b64 exec, -1
L_skip_21:
    s_waitcnt vmcnt(31)
    s_barrier
    ds_read_b128 v[80:83], v8 offset:32768
    ds_read_b128 v[84:87], v9 offset:32768
    s_cmp_eq_u32 s30, 6
    s_cbranch_scc0 L_skip_22
    s_cmp_lg_u32 s53, 3
    s_cbranch_scc0 L_wb_23
    s_mul_i32 s57, s31, 983040
    s_lshl_b32 s58, s3, 6
    s_add_u32 s57, s57, s58
    v_bfe_u32 v38, v0, 4, 1
    v_lshlrev_b32 v38, 1, v38
    v_xor_b32 v38, v38, v0
    v_and_b32 v38, 3, v38
    v_lshrrev_b32 v3, 5, v0
    v_mul_u32_u24 v3, 10240, v3
    v_bfe_u32 v39, v0, 4, 1
    v_mul_u32_u24 v39, 2560, v39
    v_add_u32 v3, v39, v3
    v_bfe_u32 v39, v0, 3, 1
    v_mul_u32_u24 v39, 5120, v39
    v_add_u32 v3, v39, v3
    v_bfe_u32 v39, v0, 2, 1
    v_mul_u32_u24 v39, 20480, v39
    v_add_u32 v3, v39, v3
    v_add_u32 v3, s57, v3
    v_lshl_add_u32 v3, v38, 4, v3
    s_mov_b32 s14, 40960
    s_mov_b32 s15, 256
    s_branch L_we_24
.p2align 5
L_wb_23:
    s_mul_i32 s57, s31, 384
    s_mul_i32 s58, s54, 245760
    s_add_u32 s57, s57, s58
    v_lshlrev_b32 v3, 4, v0
    v_add_u32 v3, s57, v3
    v_mov_b32 v38, 2688
    v_cmp_lt_u32 vcc, 23, v0
    s_nop 1
    v_cndmask_b32 v38, 0, v38, vcc
    v_add_u32 v3, v38, v3
    v_mov_b32 v38, 0x7f000000
    v_cmp_lt_u32 vcc, 47, v0
    s_nop 1
    v_cndmask_b32 v3, v3, v38, vcc
    s_mov_b32 s14, 12288
    s_mov_b32 s15, 5120
L_we_24:
    s_mul_i32 s57, s14, 0
    s_mov_b32 m0, 30720
    s_nop 0
    buffer_load_dwordx4 v3, s[48:51], s57 offen offset:0 nt lds
    s_mul_i32 s57, s14, 0
    s_add_u32 s57, s57, s15
    s_mov_b32 m0, 30720
    s_nop 0
    buffer_load_dwordx4 v3, s[48:51], s57 offen offset:1024 nt lds
    s_mov_b32 s57, 393344
    s_mov_b32 s58, 588928
    s_mov_b32 m0, 92160
L_dma_25:
    s_waitcnt vmcnt(22)
    buffer_load_dwordx4 v5, s[32:35], s57 offen offset:0 nt lds
    buffer_load_dwordx4 v6, s[32:35], s58 offen offset:1024 nt lds
    s_add_u32 s57, s57, 24576
    s_add_u32 s58, s58, 24576
    s_add_u32 m0, m0, 2048
    s_cmp_lg_u32 m0, 108544
    s_cbranch_scc1 L_dma_25
    s_mul_i32 s57, s14, 1
    s_mov_b32 m0, 32768
    s_nop 0
    buffer_load_dwordx4 v3, s[48:51], s57 offen offset:0 nt lds
    s_mul_i32 s57, s14, 1
    s_add_u32 s57, s57, s15
    s_mov_b32 m0, 32768
    s_nop 0
    buffer_load_dwordx4 v3, s[48:51], s57 offen offset:1024 nt lds
    s_mov_b32 s57, 393472
    s_mov_b32 s58, 589056
    s_mov_b32 m0, 108544
L_dma_26:
    s_waitcnt vmcnt(22)
    buffer_load_dwordx4 v5, s[32:35], s57 offen offset:0 nt lds
    buffer_load_dwordx4 v6, s[32:35], s58 offen offset:1024 nt lds
    s_add_u32 s57, s57, 24576
    s_add_u32 s58, s58, 24576
    s_add_u32 m0, m0, 2048
    s_cmp_lg_u32 m0, 124928
    s_cbranch_scc1 L_dma_26
L_skip_22:
    s_waitcnt lgkmcnt(0)
    s_cmp_lt_u32 s30, 5
    s_cbranch_scc0 L_skip_27
    s_waitcnt vmcnt(0)
L_skip_27:
    s_cmp_eq_u32 s30, 7
    s_cbranch_scc0 L_skip_28
    v_and_b32 v60, 31, v0
    v_cmp_gt_u32 s[64:65], 20, v60
    v_min_u32 v60, 19, v60
    v_lshrrev_b32 v35, 5, v0
    v_lshlrev_b32 v35, 2, v35
    v_add_u32 v35, 160832, v35
    v_lshl_add_u32 v35, v60, 3, v35
    s_mul_i32 s66, s53, 12416
    s_add_u32 s66, s66, s62
    s_add_u32 s66, s66, 70656
    s_add_u32 s67, s66, 12288
    s_lshl_b32 s57, s54, 3
    v_lshrrev_b32 v34, 5, v0
    v_lshlrev_b32 v34, 2, v34
    v_add_u32 v34, s57, v34
    v_and_b32 v60, 31, v0
    v_mov_b32 v61, 0x7f000000
    v_cmp_ne_u32 vcc, 31, v60
    s_nop 1
    v_cndmask_b32 v34, v34, v61, vcc
    v_mov_b32 v61, 0x3f803f80
    s_waitcnt vmcnt(0)
    ds_write_b32 v35, v28
    s_waitcnt lgkmcnt(0)
L_skip_28:
    s_cmp_eq_u32 s30, 5
    s_cbranch_scc0 L_skip_29
    s_waitcnt vmcnt(0)
    s_lshr_b32 s67, s63, 2
    s_sub_u32 s58, s3, 20
    s_cmp_lt_u32 s58, 4
    s_cbranch_scc0 L_skip_30
    s_mov_b32 s67, 0
    s_load_dword s66, s[10:11], 0
    s_load_dword s67, s[10:11], 8192
    s_waitcnt lgkmcnt(1)
L_skip_30:
    v_subrev_u32 v16, 8, v0
    v_cmp_gt_u32 vcc, 40, v16
    v_mov_b32 v16, 0x3f803f80
    s_nop 0
    v_cndmask_b32 v18, 0, v16, vcc
    v_min_u32 v16, 55, v0
    v_lshlrev_b32 v16, 2, v16
    v_add_u32 v16, 160992, v16
    ds_write_b32 v16, v18
    s_mov_b32 s65, s67
    s_waitcnt lgkmcnt(0)
L_skip_29:
    s_waitcnt vmcnt(36)
    s_barrier
    ds_read_b128 v[88:91], v8 offset:49152
    ds_read_b128 v[92:95], v9 offset:49152
    s_cmp_eq_u32 s30, 6
    s_cbranch_scc0 L_skip_31
    s_mul_i32 s57, s14, 2
    s_mov_b32 m0, 34816
    s_nop 0
    buffer_load_dwordx4 v3, s[48:51], s57 offen offset:0 nt lds
    s_mul_i32 s57, s14, 2
    s_add_u32 s57, s57, s15
    s_mov_b32 m0, 34816
    s_nop 0
    buffer_load_dwordx4 v3, s[48:51], s57 offen offset:1024 nt lds
    s_mov_b32 s57, 786432
    s_mov_b32 s58, 982016
    s_mov_b32 m0, 124928
L_dma_32:
    s_waitcnt vmcnt(22)
    buffer_load_dwordx4 v5, s[32:35], s57 offen offset:0 nt lds
    buffer_load_dwordx4 v6, s[32:35], s58 offen offset:1024 nt lds
    s_add_u32 s57, s57, 24576
    s_add_u32 s58, s58, 24576
    s_add_u32 m0, m0, 2048
    s_cmp_lg_u32 m0, 141312
    s_cbranch_scc1 L_dma_32
L_skip_31:
    s_waitcnt lgkmcnt(0)
    s_cmp_eq_u32 s30, 7
    s_cbranch_scc0 L_skip_33
    v_cndmask_b32 v29, 0, v28, s[64:65]
    v_dot2_f32_bf16 v33, v29, v61, 0
    v_dot2_f32_bf16 v32, v29, v29, 0
    v_lshlrev_b32 v2, 16, v28
    v_and_b32 v3, 0xffff0000, v28
    s_cmp_eq_u32 s55, 0
    v_permlane32_swap_b32 v33, v32
    v_add_f32 v33, v33, v32
    s_nop 1
    v_add_f32_dpp v33, v33, v33 row_ror:8 row_mask:0xf bank_mask:0xf
    s_nop 1
    v_add_f32_dpp v33, v33, v33 row_ror:4 row_mask:0xf bank_mask:0xf
    s_nop 1
    v_add_f32_dpp v33, v33, v33 row_ror:2 row_mask:0xf bank_mask:0xf
    s_nop 1
    v_add_f32_dpp v33, v33, v33 row_ror:1 row_mask:0xf bank_mask:0xf
    s_nop 1
    v_add_f32_dpp v33, v33, v33 row_bcast:15 row_mask:0xa bank_mask:0xf
    s_cbranch_scc1 L_gs_34
    buffer_store_dword v33, v34, s[40:43], s67 offen
L_gb_35:
    s_waitcnt vmcnt(1)
L_skip_33:
    s_cmp_lt_u32 s30, 6
    s_cbranch_scc0 L_skip_36
    s_lshr_b32 s57, s30, 1
    s_mul_i32 s57, s57, 1024
    s_and_b32 s58, s30, 1
    s_lshl_b32 s58, s58, 6
    s_add_u32 s57, s57, s58
    v_lshrrev_b32 v18, 5, v0
    v_mul_u32_u24 v18, 6144, v18
    v_bfe_u32 v60, v0, 3, 1
    v_mul_u32_u24 v60, 3072, v60
    v_add_u32 v18, v60, v18
    v_bfe_u32 v60, v0, 4, 1
    v_lshl_add_u32 v18, v60, 9, v18
    v_bfe_u32 v60, v0, 2, 1
    v_lshl_add_u32 v18, v60, 7, v18
    v_and_b32 v60, 3, v0
    v_lshl_add_u32 v18, v60, 3, v18
    v_add_u32 v18, s57, v18
    v_bfe_u32 v19, v0, 4, 1
    v_mul_u32_u24 v19, 3072, v19
    v_bfe_u32 v60, v0, 3, 1
    v_lshl_add_u32 v19, v60, 9, v19
    v_bfe_u32 v60, v0, 2, 1
    v_lshl_add_u32 v19, v60, 7, v19
    v_and_b32 v60, 3, v0
    v_lshl_add_u32 v19, v60, 3, v19
    v_add_u32 v19, s57, v19
    v_add_u32 v19, 24576, v19
    ds_read_b64_tr_b16 v[28:29], v18 offset:0
    ds_read_b64_tr_b16 v[30:31], v18 offset:256
    ds_read_b64_tr_b16 v[32:33], v18 offset:12288
    ds_read_b64_tr_b16 v[34:35], v18 offset:12544
    ds_read_b64_tr_b16 v[36:37], v19 offset:0
    ds_read_b64_tr_b16 v[38:39], v19 offset:256
    ds_read_b64_tr_b16 v[40:41], v18 offset:32
    ds_read_b64_tr_b16 v[42:43], v18 offset:288
    ds_read_b64_tr_b16 v[44:45], v18 offset:12320
    ds_read_b64_tr_b16 v[46:47], v18 offset:12576
    ds_read_b64_tr_b16 v[48:49], v19 offset:32
    ds_read_b64_tr_b16 v[50:51], v19 offset:288
    v_lshrrev_b32 v52, 4, v0
    v_lshlrev_b32 v52, 5, v52
    v_bfe_u32 v60, v0, 1, 1
    v_lshl_add_u32 v52, v60, 4, v52
    v_and_b32 v60, 1, v0
    v_mul_u32_u24 v60, 192, v60
    v_add_u32 v52, v60, v52
    v_add_u32 v52, 160832, v52
    v_lshrrev_b32 v53, 4, v0
    v_lshlrev_b32 v53, 4, v53
    v_bfe_u32 v60, v0, 1, 1
    v_lshl_add_u32 v53, v60, 3, v53
    v_and_b32 v60, 1, v0
    v_mul_u32_u24 v60, 192, v60
    v_add_u32 v53, v60, v53
    v_add_u32 v53, 160960, v53
    v_mov_b64 v[20:21], 0
    v_mov_b64 v[22:23], 0
    v_mov_b64 v[24:25], 0
    v_mov_b64 v[26:27], 0
    s_lshr_b32 s57, s30, 1
    s_lshl_b32 s57, s57, 11
    s_lshl_b32 s58, s58, 1
    s_add_u32 s57, s57, s58
    s_lshl_b32 s58, s54, 8
    s_add_u32 s57, s57, s58
    v_and_b32 v54, 31, v0
    v_lshlrev_b32 v54, 2, v54
    v_lshrrev_b32 v60, 5, v0
    v_mul_u32_u24 v60, 6144, v60
    v_add_u32 v54, v60, v54
    v_add_u32 v54, s57, v54
    s_mul_i32 s59, s53, 12416
    s_add_u32 s59, s59, s62
    s_add_u32 s59, s59, 70656
    s_add_u32 s60, s59, 12288
    ds_read_b128 v[12:15], v52
    ds_read_b64 v[16:17], v53
    s_waitcnt lgkmcnt(1)
    v_smfmac_f32_16x16x64_bf16 v[20:23], v[12:15], v[28:35], v1
    v_smfmac_f32_16x16x64_bf16 v[24:27], v[12:15], v[40:47], v1
    s_waitcnt lgkmcnt(0)
    v_smfmac_f32_16x16x32_bf16 v[20:23], v[16:17], v[36:39], v1
    v_smfmac_f32_16x16x32_bf16 v[24:27], v[16:17], v[48:51], v1
    s_cmp_eq_u32 s55, 0
    s_nop 5
    v_add_f32 v12, v20, v22
    s_nop 1
    v_add_f32_dpp v12, v24, v26 quad_perm:[0,1,2,3] row_mask:0x2 bank_mask:0xf
    s_nop 1
    v_add_f32_dpp v12, v21, v23 quad_perm:[0,1,2,3] row_mask:0x4 bank_mask:0xf
    s_nop 1
    v_add_f32_dpp v12, v25, v27 quad_perm:[0,1,2,3] row_mask:0x8 bank_mask:0xf
    s_cbranch_scc1 L_gs_37
    buffer_store_dword v12, v54, s[40:43], s59 offen
L_gb_38:
L_skip_36:
    s_cmp_eq_u32 s30, 5
    s_cbranch_scc0 L_skip_39
    global_load_dword v2, v3, s[26:27] sc1
L_skip_39:
    s_waitcnt vmcnt(36)
    s_barrier
    ds_read_b128 v[96:99], v8 offset:0
    ds_read_b128 v[100:103], v9 offset:0
    s_cmp_eq_u32 s30, 6
    s_cbranch_scc0 L_skip_40
    s_mul_i32 s57, s14, 3
    s_mov_b32 m0, 36864
    s_nop 0
    buffer_load_dwordx4 v3, s[48:51], s57 offen offset:0 nt lds
    s_mul_i32 s57, s14, 3
    s_add_u32 s57, s57, s15
    s_mov_b32 m0, 36864
    s_nop 0
    buffer_load_dwordx4 v3, s[48:51], s57 offen offset:1024 nt lds
    s_mov_b32 s57, 786560
    s_mov_b32 s58, 982144
    s_mov_b32 m0, 141312
L_dma_41:
    s_waitcnt vmcnt(22)
    buffer_load_dwordx4 v5, s[32:35], s57 offen offset:0 nt lds
    buffer_load_dwordx4 v6, s[32:35], s58 offen offset:1024 nt lds
    s_add_u32 s57, s57, 24576
    s_add_u32 s58, s58, 24576
    s_add_u32 m0, m0, 2048
    s_cmp_lg_u32 m0, 157696
    s_cbranch_scc1 L_dma_41
L_skip_40:
    s_waitcnt lgkmcnt(0)
    s_waitcnt vmcnt(36)
    s_barrier
    ds_read_b128 v[104:107], v8 offset:16384
    ds_read_b128 v[108:111], v9 offset:16384
    s_cmp_eq_u32 s30, 6
    s_cbranch_scc0 L_skip_42
    s_mul_i32 s57, s14, 4
    s_mov_b32 m0, 38912
    s_nop 0
    buffer_load_dwordx4 v3, s[48:51], s57 offen offset:0 nt lds
    s_mul_i32 s57, s14, 4
    s_add_u32 s57, s57, s15
    s_mov_b32 m0, 38912
    s_nop 0
    buffer_load_dwordx4 v3, s[48:51], s57 offen offset:1024 nt lds
    s_mov_b32 s57, 786688
    s_mov_b32 s58, 982272
    s_mov_b32 m0, 92160
L_dma_43:
    s_waitcnt vmcnt(22)
    buffer_load_dwordx4 v5, s[32:35], s57 offen offset:0 nt lds
    buffer_load_dwordx4 v6, s[32:35], s58 offen offset:1024 nt lds
    s_add_u32 s57, s57, 24576
    s_add_u32 s58, s58, 24576
    s_add_u32 m0, m0, 2048
    s_cmp_lg_u32 m0, 108544
    s_cbranch_scc1 L_dma_43
L_skip_42:
    s_waitcnt lgkmcnt(0)
    s_cmp_lg_u32 s30, 6
    s_cbranch_scc0 L_skip_44
    s_waitcnt vmcnt(0)
L_skip_44:
    s_waitcnt vmcnt(36)
    s_barrier
    ds_read_b128 v[112:115], v8 offset:32768
    ds_read_b128 v[116:119], v9 offset:32768
    s_cmp_eq_u32 s30, 6
    s_cbranch_scc0 L_skip_45
    s_mul_i32 s57, s14, 5
    s_mov_b32 m0, 40960
    s_nop 0
    buffer_load_dwordx4 v3, s[48:51], s57 offen offset:0 nt lds
    s_mul_i32 s57, s14, 5
    s_add_u32 s57, s57, s15
    s_mov_b32 m0, 40960
    s_nop 0
    buffer_load_dwordx4 v3, s[48:51], s57 offen offset:1024 nt lds
    s_mov_b32 s57, 1179648
    s_mov_b32 s58, 1375232
    s_mov_b32 m0, 108544
L_dma_46:
    s_waitcnt vmcnt(22)
    buffer_load_dwordx4 v5, s[32:35], s57 offen offset:0 nt lds
    buffer_load_dwordx4 v6, s[32:35], s58 offen offset:1024 nt lds
    s_add_u32 s57, s57, 24576
    s_add_u32 s58, s58, 24576
    s_add_u32 m0, m0, 2048
    s_cmp_lg_u32 m0, 124928
    s_cbranch_scc1 L_dma_46
L_skip_45:
    s_waitcnt lgkmcnt(0)
    s_cmp_eq_u32 s30, 5
    s_cbranch_scc0 L_skip_47
L_cw_48:
    v_readlane_b32 s57, v2, s31
    s_cmp_eq_u32 s57, 0
    s_cbranch_scc1 L_cr_49
    s_lshr_b32 s58, s63, 2
    s_xor_b32 s58, s58, s65
    s_and_b32 s58, s58, 1
    v_mov_b32 v25, s58
    s_sub_u32 s57, s57, 1
    s_cmp_eq_u32 s57, s63
    s_cselect_b32 s64, 1, 0
    s_cbranch_scc0 L_far_50
    s_lshl_b32 s57, s52, 2
    s_add_u32 s57, s57, s72
    s_mov_b64 exec, 1
    buffer_store_dword v25, v0, s[40:43], s57 offen offset:0
    s_mov_b64 exec, -1
L_fb_51:
L_skip_47:
    s_waitcnt vmcnt(36)
    s_barrier
    ds_read_b128 v[120:123], v8 offset:49152
    ds_read_b128 v[124:127], v9 offset:49152
    s_cmp_eq_u32 s30, 6
    s_cbranch_scc0 L_skip_52
    s_mul_i32 s57, s14, 6
    s_mov_b32 m0, 43008
    s_nop 0
    buffer_load_dwordx4 v3, s[48:51], s57 offen offset:0 nt lds
    s_mul_i32 s57, s14, 6
    s_add_u32 s57, s57, s15
    s_mov_b32 m0, 43008
    s_nop 0
    buffer_load_dwordx4 v3, s[48:51], s57 offen offset:1024 nt lds
    s_mov_b32 s57, 1179776
    s_mov_b32 s58, 1375360
    s_mov_b32 m0, 124928
L_dma_53:
    s_waitcnt vmcnt(22)
    buffer_load_dwordx4 v5, s[32:35], s57 offen offset:0 nt lds
    buffer_load_dwordx4 v6, s[32:35], s58 offen offset:1024 nt lds
    s_add_u32 s57, s57, 24576
    s_add_u32 s58, s58, 24576
    s_add_u32 m0, m0, 2048
    s_cmp_lg_u32 m0, 141312
    s_cbranch_scc1 L_dma_53
L_skip_52:
    s_waitcnt lgkmcnt(0)
    s_waitcnt vmcnt(36)
    s_barrier
    ds_read_b128 v[128:131], v8 offset:0
    ds_read_b128 v[132:135], v9 offset:0
    s_cmp_eq_u32 s30, 6
    s_cbranch_scc0 L_skip_54
    s_mul_i32 s57, s14, 7
    s_mov_b32 m0, 45056
    s_nop 0
    buffer_load_dwordx4 v3, s[48:51], s57 offen offset:0 nt lds
    s_mul_i32 s57, s14, 7
    s_add_u32 s57, s57, s15
    s_mov_b32 m0, 45056
    s_nop 0
    buffer_load_dwordx4 v3, s[48:51], s57 offen offset:1024 nt lds
    s_mov_b32 s57, 1179904
    s_mov_b32 s58, 1375488
    s_mov_b32 m0, 141312
L_dma_55:
    s_waitcnt vmcnt(22)
    buffer_load_dwordx4 v5, s[32:35], s57 offen offset:0 nt lds
    buffer_load_dwordx4 v6, s[32:35], s58 offen offset:1024 nt lds
    s_add_u32 s57, s57, 24576
    s_add_u32 s58, s58, 24576
    s_add_u32 m0, m0, 2048
    s_cmp_lg_u32 m0, 157696
    s_cbranch_scc1 L_dma_55
L_skip_54:
    s_waitcnt lgkmcnt(0)
    s_cmp_eq_u32 s30, 5
    s_cbranch_scc0 L_skip_56
    v_lshlrev_b32 v24, 2, v0
    buffer_load_dword v2, v24, s[40:43], s72 offen sc1
L_skip_56:
    s_waitcnt vmcnt(36)
    s_barrier
    ds_read_b128 v[136:139], v8 offset:16384
    ds_read_b128 v[140:143], v9 offset:16384
    s_cmp_eq_u32 s30, 6
    s_cbranch_scc0 L_skip_57
    s_mul_i32 s57, s14, 8
    s_mov_b32 m0, 47104
    s_nop 0
    buffer_load_dwordx4 v3, s[48:51], s57 offen offset:0 nt lds
    s_mul_i32 s57, s14, 8
    s_add_u32 s57, s57, s15
    s_mov_b32 m0, 47104
    s_nop 0
    buffer_load_dwordx4 v3, s[48:51], s57 offen offset:1024 nt lds
    s_mov_b32 s57, 0
    s_mov_b32 s58, 392192
    s_mov_b32 m0, 92160
L_dma_58:
    s_waitcnt vmcnt(22)
    buffer_load_dwordx4 v7, s[36:39], s57 offen offset:0 nt lds
    buffer_load_dwordx4 v7, s[36:39], s58 offen offset:1024 nt lds
    s_add_u32 s57, s57, 24576
    s_add_u32 s58, s58, 24576
    s_add_u32 m0, m0, 2048
    s_cmp_lg_u32 m0, 108544
    s_cbranch_scc1 L_dma_58
L_skip_57:
    s_waitcnt lgkmcnt(0)
    s_waitcnt vmcnt(36)
    s_barrier
    ds_read_b128 v[144:147], v8 offset:32768
    ds_read_b128 v[148:151], v9 offset:32768
    s_cmp_eq_u32 s30, 6
    s_cbranch_scc0 L_skip_59
    s_mul_i32 s57, s14, 9
    s_mov_b32 m0, 49152
    s_nop 0
    buffer_load_dwordx4 v3, s[48:51], s57 offen offset:0 nt lds
    s_mul_i32 s57, s14, 9
    s_add_u32 s57, s57, s15
    s_mov_b32 m0, 49152
    s_nop 0
    buffer_load_dwordx4 v3, s[48:51], s57 offen offset:1024 nt lds
    s_mov_b32 s57, 128
    s_mov_b32 s58, 392320
    s_mov_b32 m0, 108544
L_dma_60:
    s_waitcnt vmcnt(22)
    buffer_load_dwordx4 v7, s[36:39], s57 offen offset:0 nt lds
    buffer_load_dwordx4 v7, s[36:39], s58 offen offset:1024 nt lds
    s_add_u32 s57, s57, 24576
    s_add_u32 s58, s58, 24576
    s_add_u32 m0, m0, 2048
    s_cmp_lg_u32 m0, 124928
    s_cbranch_scc1 L_dma_60
L_skip_59:
    s_waitcnt lgkmcnt(0)
    s_cmp_eq_u32 s30, 5
    s_cbranch_scc0 L_skip_61
L_cw_62:
    s_waitcnt vmcnt(0)
    v_cmp_ne_u32 vcc, -1, v2
    s_mov_b32 s57, 0
    s_mov_b32 s68, 2
    s_cmp_eq_u32 s64, 0
    s_cbranch_scc1 L_cd_64
    s_cmp_lg_u32 vcc_hi, 0
    s_cbranch_scc1 L_cd_64
    s_cmp_lg_u32 vcc_lo, -1
    s_cbranch_scc1 L_cr_63
    v_cmp_eq_u32 vcc, 1, v2
    s_bcnt1_i32_b32 s68, vcc_lo
    s_mov_b32 s57, 1
L_cd_64:
    v_mov_b32 v37, 160768
    v_mov_b32 v38, s57
    ds_write_b32 v37, v38
    s_waitcnt lgkmcnt(0)
L_skip_61:
    s_waitcnt vmcnt(36)
    s_barrier
    ds_read_b128 v[152:155], v8 offset:49152
    ds_read_b128 v[156:159], v9 offset:49152
    s_cmp_eq_u32 s30, 6
    s_cbranch_scc0 L_skip_65
    s_mul_i32 s57, s14, 10
    s_mov_b32 m0, 51200
    s_nop 0
    buffer_load_dwordx4 v3, s[48:51], s57 offen offset:0 nt lds
    s_mul_i32 s57, s14, 10
    s_add_u32 s57, s57, s15
    s_mov_b32 m0, 51200
    s_nop 0
    buffer_load_dwordx4 v3, s[48:51], s57 offen offset:1024 nt lds
    s_mov_b32 s57, 256
    s_mov_b32 s58, 392448
    s_mov_b32 m0, 124928
L_dma_66:
    s_waitcnt vmcnt(22)
    buffer_load_dwordx4 v7, s[36:39], s57 offen offset:0 nt lds
    buffer_load_dwordx4 v7, s[36:39], s58 offen offset:1024 nt lds
    s_add_u32 s57, s57, 24576
    s_add_u32 s58, s58, 24576
    s_add_u32 m0, m0, 2048
    s_cmp_lg_u32 m0, 141312
    s_cbranch_scc1 L_dma_66
L_skip_65:
    s_waitcnt lgkmcnt(0)
    v_lshrrev_b32 v8, 2, v0
    v_lshlrev_b32 v8, 7, v8
    v_bfe_u32 v60, v0, 3, 2
    v_lshl_add_u32 v8, v60, 5, v8
    v_and_b32 v60, 3, v0
    v_lshl_add_u32 v8, v60, 3, v8
    v_add_u32 v8, s61, v8
    v_xor_b32 v9, 32, v8
    v_xor_b32 v10, 64, v8
    v_xor_b32 v11, 96, v8
    v_mov_b32 v41, 160768
    ds_read_b32 v42, v41
    s_waitcnt lgkmcnt(0)
    v_readfirstlane_b32 s55, v42
    s_cmp_eq_u32 s55, 0
    s_cbranch_scc1 L_spread
L_spread_back:
    s_cmp_eq_u32 s30, 5
    s_cbranch_scc0 L_skip_78
    s_cmp_eq_u32 s52, 31
    s_cbranch_scc0 L_skip_79
    s_lshl_b32 s57, s31, 5
    v_mov_b32 v16, s57
    s_add_u32 s57, s68, 1
    v_mov_b32 v12, s57
    s_mov_b64 exec, 0x1
    global_store_dword v16, v12, s[26:27] offset:4 sc1
    s_mov_b64 exec, -1
L_skip_79:
L_skip_78:
    s_sub_u32 s58, s30, 1
    s_cmp_lt_u32 s58, 3
    s_cbranch_scc0 L_skip_80
    s_mul_i32 s59, s53, 12416
    s_add_u32 s59, s59, s62
    s_add_u32 s59, s59, 70656
    s_add_u32 s60, s59, 12288
    s_lshl_b32 s57, s58, 11
    v_lshlrev_b32 v48, 4, v0
    v_add_u32 v48, s57, v48
    v_and_b32 v49, 7, v0
    v_lshlrev_b32 v49, 3, v49
    s_add_u32 s57, s59, 6144
    buffer_load_dwordx4 v[12:15], v48, s[40:43], s59 offen offset:0 sc1 nt
    buffer_load_dwordx4 v[16:19], v48, s[40:43], s59 offen offset:1024 sc1 nt
    buffer_load_dwordx4 v[28:31], v48, s[40:43], s57 offen offset:0 sc1 nt
    buffer_load_dwordx4 v[32:35], v48, s[40:43], s57 offen offset:1024 sc1 nt
    buffer_load_dwordx2 v[24:25], v49, s[40:43], s60 offen sc1 nt
L_skip_80:
    s_waitcnt vmcnt(36)
    s_barrier
    ds_read_b64_tr_b16 v[160:161], v8 offset:0
    ds_read_b64_tr_b16 v[168:169], v9 offset:0
    ds_read_b64_tr_b16 v[176:177], v10 offset:0
    ds_read_b64_tr_b16 v[184:185], v11 offset:0
    s_cmp_eq_u32 s30, 6
    s_cbranch_scc0 L_skip_81
    s_mul_i32 s57, s14, 11
    s_mov_b32 m0, 53248
    s_nop 0
    buffer_load_dwordx4 v3, s[48:51], s57 offen offset:0 nt lds
    s_mul_i32 s57, s14, 11
    s_add_u32 s57, s57, s15
    s_mov_b32 m0, 53248
    s_nop 0
    buffer_load_dwordx4 v3, s[48:51], s57 offen offset:1024 nt lds
    s_mov_b32 s57, 196608
    s_mov_b32 s58, 588800
    s_mov_b32 m0, 141312
L_dma_82:
    s_waitcnt vmcnt(22)
    buffer_load_dwordx4 v7, s[36:39], s57 offen offset:0 nt lds
    buffer_load_dwordx4 v7, s[36:39], s58 offen offset:1024 nt lds
    s_add_u32 s57, s57, 24576
    s_add_u32 s58, s58, 24576
    s_add_u32 m0, m0, 2048
    s_cmp_lg_u32 m0, 157696
    s_cbranch_scc1 L_dma_82
L_skip_81:
    s_waitcnt lgkmcnt(0)
    s_waitcnt vmcnt(36)
    s_barrier
    ds_read_b64_tr_b16 v[192:193], v8 offset:16384
    ds_read_b64_tr_b16 v[200:201], v9 offset:16384
    ds_read_b64_tr_b16 v[208:209], v10 offset:16384
    ds_read_b64_tr_b16 v[216:217], v11 offset:16384
    s_cmp_eq_u32 s30, 6
    s_cbranch_scc0 L_skip_83
    s_mov_b32 s57, 196736
    s_mov_b32 s58, 588928
    s_mov_b32 m0, 92160
L_dma_84:
    s_waitcnt vmcnt(22)
    buffer_load_dwordx4 v7, s[36:39], s57 offen offset:0 nt lds
    buffer_load_dwordx4 v7, s[36:39], s58 offen offset:1024 nt lds
    s_add_u32 s57, s57, 24576
    s_add_u32 s58, s58, 24576
    s_add_u32 m0, m0, 2048
    s_cmp_lg_u32 m0, 108544
    s_cbranch_scc1 L_dma_84
L_skip_83:
    s_waitcnt lgkmcnt(0)
    s_sub_u32 s58, s30, 1
    s_cmp_lt_u32 s58, 3
    s_cbranch_scc0 L_skip_85
    s_lshl_b32 s57, s58, 7
    v_bfe_u32 v51, v0, 2, 2
    v_lshlrev_b32 v51, 5, v51
    v_lshrrev_b32 v60, 5, v0
    v_lshl_add_u32 v51, v60, 4, v51
    v_and_b32 v60, 3, v0
    v_lshl_add_u32 v51, v60, 2, v51
    v_bfe_u32 v60, v0, 4, 1
    v_lshl_add_u32 v51, v60, 1, v51
    v_add_u32 v51, s57, v51
    v_add_u32 v51, 157696, v51
    v_mov_b32 v60, 0x3c75e03e
    v_mov_b32 v61, 0x3a71d1e6
    v_mov_b32 v47, 0x3e13985d
    s_waitcnt vmcnt(0)
    v_pk_add_f32 v[36:37], v[28:29], v[32:33]
    v_pk_add_f32 v[38:39], v[30:31], v[34:35]
    s_nop 1
    v_permlane32_swap_b32 v36, v38
    v_permlane32_swap_b32 v37, v39
    v_pk_add_f32 v[36:37], v[36:37], v[38:39]
    s_nop 1
    v_permlane16_swap_b32 v36, v37
    v_add_f32 v36, v36, v37
    v_mul_f32 v6, 0x3dd53b95, v36
    v_add_f32_dpp v48, v24, v24 row_ror:4 row_mask:0xf bank_mask:0xf
    v_add_f32_dpp v49, v25, v25 row_ror:4 row_mask:0xf bank_mask:0xf
    v_pk_add_f32 v[20:21], v[12:13], v[16:17]
    v_pk_add_f32 v[22:23], v[14:15], v[18:19]
    v_add_f32_dpp v48, v48, v48 row_ror:2 row_mask:0xf bank_mask:0xf
    v_add_f32_dpp v49, v49, v49 row_ror:2 row_mask:0xf bank_mask:0xf
    v_permlane32_swap_b32 v20, v22
    v_permlane32_swap_b32 v21, v23
    v_add_f32_dpp v48, v48, v48 row_ror:1 row_mask:0xf bank_mask:0xf
    v_add_f32_dpp v49, v49, v49 row_ror:1 row_mask:0xf bank_mask:0xf
    v_pk_add_f32 v[20:21], v[20:21], v[22:23]
    v_mul_f32 v48, v48, v60
    v_fma_f32 v49, v49, v47, v61
    v_permlane16_swap_b32 v20, v21
    v_fma_f32 v49, -v48, v48, v49
    v_add_f32 v20, v20, v21
    v_max_f32 v49, v49, v61
    v_mul_f32 v50, v6, v48
    v_rsq_f32 v49, v49
    v_cmp_u_f32 vcc, v20, v20
    v_sub_f32 v20, v20, v50
    v_mul_f32 v20, v20, v49
    v_cvt_pk_bf16_f32 v20, v20, v20
    ds_write_b16 v51, v20
    s_waitcnt lgkmcnt(0)
L_skip_85:
    s_lshl_b32 s57, s30, 7
    s_add_u32 s57, s57, 158720
    v_lshrrev_b32 v58, 4, v0
    v_lshlrev_b32 v58, 5, v58
    v_bfe_u32 v60, v0, 1, 1
    v_lshl_add_u32 v58, v60, 4, v58
    v_bfe_u32 v60, v0, 2, 2
    v_lshl_add_u32 v58, v60, 2, v58
    v_and_b32 v60, 1, v0
    v_lshl_add_u32 v58, v60, 1, v58
    v_add_u32 v58, s57, v58
    v_lshrrev_b32 v61, 4, v0
    v_lshlrev_b32 v61, 5, v61
    v_bfe_u32 v60, v0, 1, 1
    v_lshl_add_u32 v61, v60, 4, v61
    v_add_u32 v61, s57, v61
    v_bfe_u32 v62, v0, 2, 2
    v_lshlrev_b32 v62, 1, v62
    v_and_b32 v60, 1, v0
    v_lshl_add_u32 v62, v60, 0, v62
    v_mov_b32 v60, 160992
    v_cmp_eq_u32 vcc, 0, v62
    s_nop 1
    v_cndmask_b32 v52, v60, v61, vcc
    v_cmp_eq_u32 vcc, 1, v62
    s_nop 1
    v_cndmask_b32 v53, v60, v61, vcc
    v_cmp_eq_u32 vcc, 2, v62
    s_nop 1
    v_cndmask_b32 v54, v60, v61, vcc
    v_cmp_eq_u32 vcc, 3, v62
    s_nop 1
    v_cndmask_b32 v55, v60, v61, vcc
    v_cmp_eq_u32 vcc, 4, v62
    s_nop 1
    v_cndmask_b32 v56, v60, v61, vcc
    v_cmp_eq_u32 vcc, 5, v62
    s_nop 1
    v_cndmask_b32 v57, v60, v61, vcc
    s_lshl_b32 s58, s30, 2
    s_add_u32 s58, s58, 159744
    v_mov_b32 v60, s58
    v_lshlrev_b32 v59, 2, v0
    v_add_u32 v59, 158208, v59
    v_cmp_eq_u32 vcc, 63, v0
    s_nop 1
    v_cndmask_b32 v59, v59, v60, vcc
    v_and_b32 v62, 7, v0
    v_lshlrev_b32 v62, 2, v62
    v_add_u32 v62, 159744, v62
    s_lshl_b32 s57, s30, 11
    v_lshlrev_b32 v63, 4, v0
    v_add_u32 v63, s57, v63
    v_add_u32 v63, 92160, v63
    s_waitcnt vmcnt(34)
    s_barrier
    ds_read_b64_tr_b16 v[224:225], v8 offset:32768
    ds_read_b64_tr_b16 v[232:233], v9 offset:32768
    ds_read_b64_tr_b16 v[240:241], v10 offset:32768
    ds_read_b64_tr_b16 v[248:249], v11 offset:32768
    s_cmp_eq_u32 s30, 6
    s_cbranch_scc0 L_skip_86
    s_mov_b32 s57, 196864
    s_mov_b32 s58, 589056
    s_mov_b32 m0, 108544
L_dma_87:
    s_nop 0
    buffer_load_dwordx4 v7, s[36:39], s57 offen offset:0 nt lds
    buffer_load_dwordx4 v7, s[36:39], s58 offen offset:1024 nt lds
    s_add_u32 s57, s57, 24576
    s_add_u32 s58, s58, 24576
    s_add_u32 m0, m0, 2048
    s_cmp_lg_u32 m0, 124928
    s_cbranch_scc1 L_dma_87
L_skip_86:
    s_waitcnt lgkmcnt(0)
    v_lshrrev_b32 v5, 4, v0
    v_lshlrev_b32 v5, 5, v5
    v_bfe_u32 v60, v0, 1, 1
    v_lshl_add_u32 v5, v60, 4, v5
    v_add_u32 v5, 157696, v5
    ds_read_b128 v[12:15], v5 offset:0
    ds_read_b128 v[16:19], v5 offset:128
    ds_read_b128 v[20:23], v5 offset:256
    v_mov_b64 v[24:25], 0
    v_mov_b64 v[26:27], 0
    v_mov_b64 v[28:29], 0
    v_mov_b64 v[30:31], 0
    v_mov_b64 v[32:33], 0
    v_mov_b64 v[34:35], 0
    v_mov_b64 v[36:37], 0
    v_mov_b64 v[38:39], 0
    v_mov_b64 v[40:41], 0
    v_mov_b64 v[42:43], 0
    v_mov_b64 v[44:45], 0
    v_mov_b64 v[46:47], 0
    s_waitcnt lgkmcnt(0)
    v_smfmac_f32_16x16x64_bf16 v[24:27], v[12:15], v[64:71], v1
    v_smfmac_f32_16x16x64_bf16 v[24:27], v[16:19], v[72:79], v1
    v_smfmac_f32_16x16x64_bf16 v[24:27], v[20:23], v[80:87], v1
    v_smfmac_f32_16x16x64_bf16 v[28:31], v[12:15], v[88:95], v1
    v_smfmac_f32_16x16x64_bf16 v[28:31], v[16:19], v[96:103], v1
    v_smfmac_f32_16x16x64_bf16 v[28:31], v[20:23], v[104:111], v1
    v_smfmac_f32_16x16x64_bf16 v[32:35], v[12:15], v[112:119], v1
    v_smfmac_f32_16x16x64_bf16 v[32:35], v[16:19], v[120:127], v1
    v_smfmac_f32_16x16x64_bf16 v[32:35], v[20:23], v[128:135], v1
    v_smfmac_f32_16x16x64_bf16 v[36:39], v[12:15], v[136:143], v1
    v_smfmac_f32_16x16x64_bf16 v[36:39], v[16:19], v[144:151], v1
    v_smfmac_f32_16x16x64_bf16 v[36:39], v[20:23], v[152:159], v1
    v_add_f32 v24, v24, v26
    s_nop 0
    v_add_f32 v28, v28, v30
    s_nop 1
    v_add_f32 v32, v32, v34
    v_max3_f32 v61, v24, v28, v32
    v_mov_b32_dpp v24, v28 quad_perm:[0,1,2,3] row_mask:0x2 bank_mask:0xf
    v_add_f32 v36, v36, v38
    v_max_f32 v61, v61, v36
    v_mov_b32_dpp v24, v32 quad_perm:[0,1,2,3] row_mask:0x4 bank_mask:0xf
    s_nop 0
    v_max_f32_dpp v61, v61, v61 row_ror:8 row_mask:0xf bank_mask:0xf
    s_nop 0
    v_mov_b32_dpp v24, v36 quad_perm:[0,1,2,3] row_mask:0x8 bank_mask:0xf
    v_max_f32_dpp v61, v61, v61 row_ror:4 row_mask:0xf bank_mask:0xf
    s_nop 1
    v_max_f32_dpp v61, v61, v61 row_ror:2 row_mask:0xf bank_mask:0xf
    s_nop 1
    v_max_f32_dpp v61, v61, v61 row_ror:1 row_mask:0xf bank_mask:0xf
    v_sub_f32 v36, v24, v61
    ds_write_b32 v59, v61
    v_exp_f32 v36, v36
    s_nop 0
    v_cvt_pk_bf16_f32 v39, v36, v36
    ds_write_b16 v58, v39
    ds_read_b128 v[12:15], v52
    ds_read_b128 v[16:19], v53
    ds_read_b128 v[20:23], v54
    ds_read_b128 v[24:27], v55
    ds_read_b128 v[28:31], v56
    ds_read_b128 v[32:35], v57
    v_add_f32_dpp v38, v36, v36 row_ror:8 row_mask:0xf bank_mask:0xf
    s_nop 1
    v_add_f32_dpp v38, v38, v38 row_ror:4 row_mask:0xf bank_mask:0xf
    s_nop 1
    v_add_f32_dpp v38, v38, v38 row_ror:2 row_mask:0xf bank_mask:0xf
    s_nop 1
    v_add_f32_dpp v38, v38, v38 row_ror:1 row_mask:0xf bank_mask:0xf
    s_nop 1
    v_add_f32_dpp v38, v38, v38 row_bcast:15 row_mask:0xa bank_mask:0xf
    s_nop 1
    v_add_f32_dpp v38, v38, v38 row_bcast:31 row_mask:0xc bank_mask:0xf
    s_waitcnt lgkmcnt(0)
    s_waitcnt vmcnt(32)
    s_barrier
    ds_read_b64_tr_b16 v[162:163], v8 offset:49152
    ds_read_b64_tr_b16 v[170:171], v9 offset:49152
    ds_read_b64_tr_b16 v[178:179], v10 offset:49152
    ds_read_b64_tr_b16 v[186:187], v11 offset:49152
    s_cmp_eq_u32 s30, 6
    s_cbranch_scc0 L_skip_88
    s_mov_b32 s57, 786432
    s_mov_b32 s58, 1178624
    s_mov_b32 m0, 124928
L_dma_89:
    s_nop 0
    buffer_load_dwordx4 v7, s[36:39], s57 offen offset:0 nt lds
    buffer_load_dwordx4 v7, s[36:39], s58 offen offset:1024 nt lds
    s_add_u32 s57, s57, 24576
    s_add_u32 s58, s58, 24576
    s_add_u32 m0, m0, 2048
    s_cmp_lg_u32 m0, 141312
    s_cbranch_scc1 L_dma_89
L_skip_88:
    s_waitcnt lgkmcnt(0)
    ds_read_b32 v36, v62
    s_waitcnt lgkmcnt(0)
    v_max_f32_dpp v37, v36, v36 row_ror:4 row_mask:0xf bank_mask:0xf
    s_nop 1
    v_max_f32_dpp v37, v37, v37 row_ror:2 row_mask:0xf bank_mask:0xf
    s_nop 1
    v_max_f32_dpp v37, v37, v37 row_ror:1 row_mask:0xf bank_mask:0xf
    v_sub_f32 v39, v61, v37
    v_exp_f32 v39, v39
    s_cmp_lt_u32 s30, 2
    s_cbranch_scc0 L_skip_90
    s_lshl_b32 s57, s30, 3
    v_lshlrev_b32 v2, 4, v0
    v_add_u32 v2, s57, v2
    v_add_u32 v2, 92160, v2
    v_mov_b32 v60, 94192
    v_cmp_le_u32 vcc, 48, v0
    s_nop 1
    v_cndmask_b32 v2, v2, v60, vcc
    s_lshr_b32 s57, s54, 1
    s_lshl_b32 s57, s57, 2
    s_and_b32 s58, s54, 1
    s_add_u32 s57, s57, s58
    s_lshl_b32 s58, s57, 4
    s_lshl_b32 s57, s57, 3
    v_bfe_u32 v3, v0, 3, 2
    v_lshlrev_b32 v3, 8, v3
    v_bfe_u32 v61, v0, 2, 1
    v_lshl_add_u32 v3, v61, 5, v3
    v_and_b32 v61, 3, v0
    v_lshl_add_u32 v3, v61, 2, v3
    v_add_u32 v3, s58, v3
    v_bfe_u32 v60, v0, 3, 1
    v_lshlrev_b32 v60, 8, v60
    v_bfe_u32 v61, v0, 1, 1
    v_lshl_add_u32 v60, v61, 7, v60
    v_bfe_u32 v61, v0, 2, 1
    v_lshl_add_u32 v60, v61, 4, v60
    v_and_b32 v61, 1, v0
    v_lshl_add_u32 v60, v61, 2, v60
    v_add_u32 v60, s57, v60
    v_add_u32 v60, 1024, v60
    v_cmp_gt_u32 vcc, 32, v0
    s_nop 1
    v_cndmask_b32 v3, v60, v3, vcc
    s_lshl_b32 s57, s53, 1
    s_add_u32 s57, s57, s30
    s_mul_i32 s57, s57, 1664
    s_add_u32 s57, s57, s62
    v_add_u32 v3, s57, v3
    v_mov_b32 v60, 0x7f000000
    v_cmp_le_u32 vcc, 48, v0
    s_nop 1
    v_cndmask_b32 v3, v3, v60, vcc
    s_lshl_b32 s58, s54, 2
    s_add_u32 s57, s57, s58
    s_add_u32 s57, s57, 1536
    v_mov_b32 v4, s57
    v_mov_b32 v60, 0x7f000000
    v_cmp_ne_u32 vcc, 48, v0
    s_nop 1
    v_cndmask_b32 v4, v4, v60, vcc
    s_mov_b32 s58, 0
    s_cmp_eq_u32 s55, 0
    s_cbranch_scc1 L_gs_91
    buffer_store_dword v37, v4, s[40:43], s58 offen
L_gb_92:
L_skip_90:
    s_cmp_eq_u32 s30, 2
    s_cbranch_scc0 L_skip_93
    v_lshlrev_b32 v2, 2, v0
    v_add_u32 v2, 157696, v2
    v_and_b32 v3, 15, v0
    v_lshlrev_b32 v3, 2, v3
    v_lshrrev_b32 v60, 5, v0
    v_lshl_add_u32 v3, v60, 6, v3
    v_bfe_u32 v60, v0, 4, 1
    v_lshl_add_u32 v3, v60, 13, v3
L_skip_93:
    s_waitcnt vmcnt(32)
    s_barrier
    ds_read_b64_tr_b16 v[194:195], v8 offset:0
    ds_read_b64_tr_b16 v[202:203], v9 offset:0
    ds_read_b64_tr_b16 v[210:211], v10 offset:0
    ds_read_b64_tr_b16 v[218:219], v11 offset:0
    s_cmp_eq_u32 s30, 6
    s_cbranch_scc0 L_skip_94
    s_mov_b32 s57, 786560
    s_mov_b32 s58, 1178752
    s_mov_b32 m0, 141312
L_dma_95:
    s_nop 0
    buffer_load_dwordx4 v7, s[36:39], s57 offen offset:0 nt lds
    buffer_load_dwordx4 v7, s[36:39], s58 offen offset:1024 nt lds
    s_add_u32 s57, s57, 24576
    s_add_u32 s58, s58, 24576
    s_add_u32 m0, m0, 2048
    s_cmp_lg_u32 m0, 157696
    s_cbranch_scc1 L_dma_95
L_skip_94:
    s_waitcnt lgkmcnt(0)
    s_waitcnt vmcnt(32)
    s_barrier
    ds_read_b64_tr_b16 v[226:227], v8 offset:16384
    ds_read_b64_tr_b16 v[234:235], v9 offset:16384
    ds_read_b64_tr_b16 v[242:243], v10 offset:16384
    ds_read_b64_tr_b16 v[250:251], v11 offset:16384
    s_cmp_eq_u32 s30, 6
    s_cbranch_scc0 L_skip_96
    s_mov_b32 s57, 786688
    s_mov_b32 s58, 1178880
    s_mov_b32 m0, 92160
L_dma_97:
    s_nop 0
    buffer_load_dwordx4 v7, s[36:39], s57 offen offset:0 nt lds
    buffer_load_dwordx4 v7, s[36:39], s58 offen offset:1024 nt lds
    s_add_u32 s57, s57, 24576
    s_add_u32 s58, s58, 24576
    s_add_u32 m0, m0, 2048
    s_cmp_lg_u32 m0, 108544
    s_cbranch_scc1 L_dma_97
L_skip_96:
    s_waitcnt lgkmcnt(0)
    s_cmp_eq_u32 s30, 5
    s_cbranch_scc0 L_skip_98
    global_load_dword v2, v3, s[26:27] offset:4 sc1
L_skip_98:
    s_waitcnt vmcnt(32)
    s_barrier
    ds_read_b64_tr_b16 v[164:165], v8 offset:32768
    ds_read_b64_tr_b16 v[172:173], v9 offset:32768
    ds_read_b64_tr_b16 v[180:181], v10 offset:32768
    ds_read_b64_tr_b16 v[188:189], v11 offset:32768
    s_cmp_eq_u32 s30, 6
    s_cbranch_scc0 L_skip_99
    s_mov_b32 s57, 983040
    s_mov_b32 s58, 1375232
    s_mov_b32 m0, 108544
L_dma_100:
    s_nop 0
    buffer_load_dwordx4 v7, s[36:39], s57 offen offset:0 nt lds
    buffer_load_dwordx4 v7, s[36:39], s58 offen offset:1024 nt lds
    s_add_u32 s57, s57, 24576
    s_add_u32 s58, s58, 24576
    s_add_u32 m0, m0, 2048
    s_cmp_lg_u32 m0, 124928
    s_cbranch_scc1 L_dma_100
L_skip_99:
    s_waitcnt lgkmcnt(0)
    s_waitcnt vmcnt(32)
    s_barrier
    ds_read_b64_tr_b16 v[196:197], v8 offset:49152
    ds_read_b64_tr_b16 v[204:205], v9 offset:49152
    ds_read_b64_tr_b16 v[212:213], v10 offset:49152
    ds_read_b64_tr_b16 v[220:221], v11 offset:49152
    s_cmp_eq_u32 s30, 6
    s_cbranch_scc0 L_skip_101
    s_mov_b32 s57, 983168
    s_mov_b32 s58, 1375360
    s_mov_b32 m0, 124928
L_dma_102:
    s_nop 0
    buffer_load_dwordx4 v7, s[36:39], s57 offen offset:0 nt lds
    buffer_load_dwordx4 v7, s[36:39], s58 offen offset:1024 nt lds
    s_add_u32 s57, s57, 24576
    s_add_u32 s58, s58, 24576
    s_add_u32 m0, m0, 2048
    s_cmp_lg_u32 m0, 141312
    s_cbranch_scc1 L_dma_102
L_skip_101:
    s_waitcnt lgkmcnt(0)
    s_cmp_eq_u32 s30, 5
    s_cbranch_scc0 L_skip_103
L_cw_104:
    s_waitcnt vmcnt(0)
    v_cmp_eq_u32 vcc, 0, v2
    s_cbranch_vccnz L_cr_105
    v_add_u32_dpp v2, v2, v2 row_ror:4 row_mask:0xf bank_mask:0xf
    s_nop 1
    v_add_u32_dpp v2, v2, v2 row_ror:2 row_mask:0xf bank_mask:0xf
    s_nop 1
    v_add_u32_dpp v2, v2, v2 row_ror:1 row_mask:0xf bank_mask:0xf
    v_mov_b32 v60, 160772
    ds_write_b32 v60, v2
    s_waitcnt lgkmcnt(0)
L_skip_103:
    s_cmp_lt_u32 s3, 20
    s_cbranch_scc0 L_skip_106
    s_mul_i32 s74, s30, 1664
    s_add_u32 s74, s74, s62
    s_add_u32 s74, s74, 0
    v_and_b32 v56, 7, v0
    v_lshlrev_b32 v56, 2, v56
    v_lshrrev_b32 v62, 4, v0
    v_lshlrev_b32 v62, 3, v62
    s_cmp_lg_u32 s30, 6
    s_cbranch_scc0 L_skip_106
    buffer_load_dword v52, v56, s[40:43], s74 offen offset:1536 sc1
    buffer_load_dwordx2 v[54:55], v62, s[40:43], s74 offen offset:1536 sc1
L_skip_106:
    s_cmp_eq_u32 s30, 2
    s_cbranch_scc0 L_skip_107
    s_sub_u32 s57, s3, 20
    s_cmp_lt_u32 s57, 4
    s_cbranch_scc0 L_skip_108
    s_sub_u32 s57, s3, 20
    s_lshl_b32 s57, s57, 6
    v_add_u32 v50, s57, v0
    v_min_u32 v50, 207, v50
    v_lshlrev_b32 v50, 7, v50
    s_add_u32 s57, s62, 0
    buffer_load_dword v50, v50, s[40:43], s57 offen sc1 nt
    s_sub_u32 s57, s3, 20
    s_lshl_b32 s57, s57, 6
    v_add_u32 v51, s57, v0
    v_min_u32 v51, 151, v51
    v_lshlrev_b32 v51, 7, v51
    s_add_u32 s57, s62, 26624
    buffer_load_dword v51, v51, s[40:43], s57 offen sc1 nt
    s_sub_u32 s57, s3, 20
    s_lshl_b32 s57, s57, 6
    v_add_u32 v49, s57, v0
    v_min_u32 v49, 191, v49
    v_lshlrev_b32 v49, 7, v49
    s_add_u32 s57, s62, 46080
    buffer_load_dword v49, v49, s[40:43], s57 offen sc1 nt
L_skip_108:
L_skip_107:
    s_waitcnt vmcnt(32)
    s_barrier
    ds_read_b64_tr_b16 v[228:229], v8 offset:0
    ds_read_b64_tr_b16 v[236:237], v9 offset:0
    ds_read_b64_tr_b16 v[244:245], v10 offset:0
    ds_read_b64_tr_b16 v[252:253], v11 offset:0
    s_cmp_eq_u32 s30, 6
    s_cbranch_scc0 L_skip_109
    s_mov_b32 s57, 983296
    s_mov_b32 s58, 1375488
    s_mov_b32 m0, 141312
L_dma_110:
    s_nop 0
    buffer_load_dwordx4 v7, s[36:39], s57 offen offset:0 nt lds
    buffer_load_dwordx4 v7, s[36:39], s58 offen offset:1024 nt lds
    s_add_u32 s57, s57, 24576
    s_add_u32 s58, s58, 24576
    s_add_u32 m0, m0, 2048
    s_cmp_lg_u32 m0, 157696
    s_cbranch_scc1 L_dma_110
L_skip_109:
    s_waitcnt lgkmcnt(0)
    s_cmp_ge_u32 s30, 6
    s_cbranch_scc0 L_skip_111
    v_mov_b32 v60, 160772
    ds_read_b32 v60, v60
    s_lshr_b32 s58, s63, 2
    s_waitcnt lgkmcnt(0)
    v_readfirstlane_b32 s57, v60
    s_cmp_gt_u32 s57, 24
    s_cselect_b32 s57, 1, 0
    s_xor_b32 s57, s57, s58
    s_lshl_b32 s57, s57, 13
    s_add_u32 s7, s8, s57
L_skip_111:
    s_branch L_tail
.p2align 10
L_tail:
L_pad0:
    s_cbranch_execz L_pad4
    s_waitcnt vmcnt(32)
    s_barrier
    ds_read_b64_tr_b16 v[166:167], v8 offset:16384
    ds_read_b64_tr_b16 v[174:175], v9 offset:16384
    ds_read_b64_tr_b16 v[182:183], v10 offset:16384
    ds_read_b64_tr_b16 v[190:191], v11 offset:16384
    s_waitcnt lgkmcnt(0)
    s_cmp_lt_u32 s30, 5
    s_cbranch_scc0 L_skip_112
    s_waitcnt vmcnt(0)
L_skip_112:
    s_cmp_lt_u32 s3, 20
    s_cbranch_scc0 L_skip_113
    v_lshlrev_b32 v57, 4, v0
    v_lshlrev_b32 v58, 3, v0
    s_mul_i32 s57, s30, 6144
    s_add_u32 s57, s57, 30720
    v_lshrrev_b32 v59, 2, v0
    v_lshlrev_b32 v59, 6, v59
    v_bfe_u32 v53, v0, 4, 1
    v_lshl_add_u32 v59, v53, 5, v59
    v_and_b32 v53, 3, v0
    v_lshl_add_u32 v59, v53, 3, v59
    v_add_u32 v59, s57, v59
    v_xor_b32 v60, 32, v59
    s_lshl_b32 s57, s30, 8
    s_add_u32 s57, s57, 157696
    v_lshl_add_u32 v61, v0, 2, s57
    s_cmp_lg_u32 s30, 6
    s_cbranch_scc0 L_skip_113
L_cw_114:
    s_waitcnt vmcnt(0)
    v_max3_u32 v53, v52, v54, v55
    v_cmp_eq_u32 vcc, -1, v53
    s_cbranch_vccnz L_cr_115
    v_max_f32_dpp v53, v52, v52 row_ror:4 row_mask:0xf bank_mask:0xf
    s_nop 1
    v_max_f32_dpp v53, v53, v53 row_ror:2 row_mask:0xf bank_mask:0xf
    s_nop 1
    v_max_f32_dpp v53, v53, v53 row_ror:1 row_mask:0xf bank_mask:0xf
    v_sub_f32 v52, v52, v53
    v_sub_f32 v54, v54, v53
    v_sub_f32 v55, v55, v53
    v_exp_f32 v52, v52
    v_exp_f32 v54, v54
    v_exp_f32 v55, v55
    s_cmp_eq_u32 s30, 7
    s_cbranch_scc0 L_skip_113
    v_add_u32 v62, 158720, v57
    ds_write_b128 v62, v[52:55]
    s_waitcnt lgkmcnt(0)
L_skip_113:
    v_smfmac_f32_16x16x64_bf16 v[40:43], v[12:15], v[160:167], v1
    v_smfmac_f32_16x16x64_bf16 v[40:43], v[16:19], v[168:175], v1
    v_smfmac_f32_16x16x64_bf16 v[40:43], v[20:23], v[176:183], v1
    v_smfmac_f32_16x16x64_bf16 v[40:43], v[24:27], v[184:191], v1
    s_cmp_eq_u32 s30, 6
    s_cbranch_scc0 L_skip_116
    s_mul_i32 s57, s14, 12
    s_add_u32 s58, s57, s15
    s_mov_b32 m0, 55296
L_dma_117:
    s_nop 0
    buffer_load_dwordx4 v3, s[48:51], s57 offen offset:0 nt lds
    buffer_load_dwordx4 v3, s[48:51], s58 offen offset:1024 nt lds
    s_add_u32 s57, s57, s14
    s_add_u32 s58, s58, s14
    s_add_u32 m0, m0, 2048
    s_cmp_lg_u32 m0, 67584
    s_cbranch_scc1 L_dma_117
    s_mul_i32 s57, s14, 18
    s_add_u32 s58, s57, s15
    s_mov_b32 m0, 67584
L_dma_118:
    s_nop 0
    buffer_load_dwordx4 v3, s[48:51], s57 offen offset:0 nt lds
    buffer_load_dwordx4 v3, s[48:51], s58 offen offset:1024 nt lds
    s_add_u32 s57, s57, s14
    s_add_u32 s58, s58, s14
    s_add_u32 m0, m0, 2048
    s_cmp_lg_u32 m0, 79872
    s_cbranch_scc1 L_dma_118
L_skip_116:
    s_waitcnt vmcnt(40)
    s_barrier
    ds_read_b64_tr_b16 v[198:199], v8 offset:32768
    ds_read_b64_tr_b16 v[206:207], v9 offset:32768
    ds_read_b64_tr_b16 v[214:215], v10 offset:32768
    ds_read_b64_tr_b16 v[222:223], v11 offset:32768
    s_waitcnt lgkmcnt(0)
    s_cmp_lt_u32 s3, 20
    s_cbranch_scc0 L_skip_119
    s_cmp_eq_u32 s30, 6
    s_cbranch_scc0 L_skip_119
    v_add_u32 v62, 158720, v57
    ds_read_b128 v[52:55], v62
L_skip_119:
L_pad1:
    s_cbranch_execz L_pad5
    v_smfmac_f32_16x16x64_bf16 v[40:43], v[28:31], v[192:199], v1
    v_smfmac_f32_16x16x64_bf16 v[40:43], v[32:35], v[200:207], v1
    v_smfmac_f32_16x16x64_bf16 v[44:47], v[12:15], v[208:215], v1
    v_smfmac_f32_16x16x64_bf16 v[44:47], v[16:19], v[216:223], v1
    v_mul_f32 v38, v38, v39
    ds_write_b32 v63, v38 offset:1024
    s_waitcnt vmcnt(24)
    s_barrier
    ds_read_b64_tr_b16 v[230:231], v8 offset:49152
    ds_read_b64_tr_b16 v[238:239], v9 offset:49152
    ds_read_b64_tr_b16 v[246:247], v10 offset:49152
    ds_read_b64_tr_b16 v[254:255], v11 offset:49152
    s_waitcnt lgkmcnt(0)
    v_smfmac_f32_16x16x64_bf16 v[44:47], v[20:23], v[224:231], v1
    v_smfmac_f32_16x16x64_bf16 v[44:47], v[24:27], v[232:239], v1
    v_smfmac_f32_16x16x64_bf16 v[44:47], v[28:31], v[240:247], v1
    v_smfmac_f32_16x16x64_bf16 v[44:47], v[32:35], v[248:255], v1
    s_setprio 0
    s_cmp_lt_u32 s30, 2
    v_pk_add_f32 v[40:41], v[40:41], v[42:43]
    s_nop 4
    v_pk_add_f32 v[42:43], v[44:45], v[46:47]
    v_pk_mul_f32 v[40:41], v[40:41], v[38:39] op_sel:[0,1] op_sel_hi:[1,1]
    v_pk_mul_f32 v[42:43], v[42:43], v[38:39] op_sel:[0,1] op_sel_hi:[1,1]
    ds_write_b128 v63, v[40:43]
    s_cbranch_scc1 L_comb_0
    s_waitcnt lgkmcnt(0)
    s_barrier
L_comb_0b:
    s_cmp_eq_u32 s30, 6
    s_cbranch_scc0 L_skip_124
    s_waitcnt vmcnt(0)
L_skip_124:
    s_barrier
    s_cmp_lt_u32 s3, 20
    s_cbranch_scc0 L_typeB_0
    buffer_load_dwordx4 v[12:15], v57, s[40:43], s74 offen sc1
    buffer_load_dwordx2 v[16:17], v58, s[40:43], s74 offen offset:1024 sc1
    buffer_load_dword v18, v56, s[40:43], s74 offen offset:1568 sc1
    ds_read_b64_tr_b16 v[28:29], v59 offset:0
    ds_read_b64_tr_b16 v[30:31], v59 offset:1024
    ds_read_b64_tr_b16 v[32:33], v59 offset:2048
    ds_read_b64_tr_b16 v[34:35], v59 offset:3072
    ds_read_b64_tr_b16 v[36:37], v59 offset:4096
    ds_read_b64_tr_b16 v[38:39], v59 offset:5120
    ds_read_b64_tr_b16 v[40:41], v60 offset:0
    ds_read_b64_tr_b16 v[42:43], v60 offset:1024
    ds_read_b64_tr_b16 v[44:45], v60 offset:2048
    ds_read_b64_tr_b16 v[46:47], v60 offset:3072
    ds_read_b64_tr_b16 v[48:49], v60 offset:4096
    ds_read_b64_tr_b16 v[50:51], v60 offset:5120
    v_mov_b64 v[20:21], 0
    v_mov_b64 v[22:23], 0
    v_mov_b64 v[24:25], 0
    v_mov_b64 v[26:27], 0
    s_add_u32 s58, s6, 0
    s_waitcnt lgkmcnt(0)
    s_branch L_ow_125
.p2align 5
L_or_126:
    buffer_load_dwordx4 v[12:15], v57, s[40:43], s74 offen sc1
    buffer_load_dwordx2 v[16:17], v58, s[40:43], s74 offen offset:1024 sc1
    buffer_load_dword v18, v56, s[40:43], s74 offen offset:1568 sc1
    s_sub_u32 s56, s56, 1
    s_cbranch_scc1 L_done
    v_mov_b64 v[20:21], 0
    v_mov_b64 v[22:23], 0
    v_mov_b64 v[24:25], 0
    v_mov_b64 v[26:27], 0
L_ow_125:
    s_waitcnt vmcnt(2)
    v_smfmac_f32_16x16x64_bf16 v[20:23], v[12:15], v[28:35], v1
    v_max3_u32 v19, v12, v13, v14
    v_smfmac_f32_16x16x64_bf16 v[24:27], v[12:15], v[40:47], v1
    s_waitcnt vmcnt(0)
    v_mul_f32 v53, v52, v18
    v_smfmac_f32_16x16x32_bf16 v[20:23], v[16:17], v[36:39], v1
    v_max3_u32 v62, v15, v16, v17
    v_smfmac_f32_16x16x32_bf16 v[24:27], v[16:17], v[48:51], v1
    v_max3_u32 v19, v19, v62, v18
    v_add_f32_dpp v53, v53, v53 row_ror:4 row_mask:0xf bank_mask:0xf
    v_cmp_eq_u32 vcc, -1, v19
L_pad2:
    s_cbranch_execz L_pad6
    s_cmp_eq_u32 s30, 2
    v_add_f32_dpp v53, v53, v53 row_ror:2 row_mask:0xf bank_mask:0xf
    s_cbranch_vccnz L_or_126
    s_nop 0
    v_add_f32_dpp v53, v53, v53 row_ror:1 row_mask:0xf bank_mask:0xf
    v_rcp_f32 v52, v53
    v_pk_add_f32 v[20:21], v[20:21], v[22:23]
    v_pk_add_f32 v[24:25], v[24:25], v[26:27]
    v_pk_mul_f32 v[54:55], v[54:55], v[52:53] op_sel:[0,0] op_sel_hi:[1,0]
    v_mul_f32 v20, v20, v54
    v_mul_f32 v24, v24, v54
    v_fmac_f32 v20, v21, v55
    v_fmac_f32 v24, v25, v55
    s_nop 1
    v_permlane32_swap_b32 v20, v24
    v_add_f32 v20, v20, v24
    ds_write_b32 v61, v20
    s_waitcnt lgkmcnt(0)
    s_barrier
    s_cbranch_scc0 L_finb_127
    ds_read2st64_b32 v[12:13], v2 offset0:0 offset1:1
    ds_read2st64_b32 v[14:15], v2 offset0:2 offset1:3
    ds_read2st64_b32 v[16:17], v2 offset0:4 offset1:5
    ds_read2st64_b32 v[18:19], v2 offset0:6 offset1:7
    s_waitcnt lgkmcnt(2)
    v_pk_add_f32 v[12:13], v[12:13], v[14:15]
    s_waitcnt lgkmcnt(0)
    v_pk_add_f32 v[16:17], v[16:17], v[18:19]
    v_pk_add_f32 v[12:13], v[12:13], v[16:17]
    v_add_f32 v14, v12, v13
    v_add_f32 v15, v12, v13
    s_nop 1
    v_permlane16_swap_b32 v14, v15
    v_add_f32 v12, v14, v15
    buffer_store_dword v12, v3, s[40:43], s58 offen sc1
L_finb_127:
    s_sub_u32 s57, s30, 4
    s_cmp_lt_u32 s57, 3
    s_cbranch_scc0 L_skip_128
    s_sub_u32 s60, s30, 4
    s_lshl_b32 s57, s60, 11
    v_lshlrev_b32 v11, 4, v0
    v_add_u32 v11, s57, v11
    s_add_u32 s65, s62, 19456
    buffer_load_dwordx4 v[52:55], v11, s[40:43], s65 offen offset:0 sc1
    buffer_load_dwordx4 v[56:59], v11, s[40:43], s65 offen offset:1024 sc1
    s_lshl_b32 s59, s60, 12
    s_add_u32 s59, s59, 79872
    s_mov_b32 s44, s20
    s_mov_b32 s45, s21
    s_mov_b32 s46, 1966080
    s_mov_b32 s47, 0x20000
    s_mul_i32 s57, s31, 3
    s_add_u32 s57, s57, s60
    s_mul_i32 s57, s57, 81920
    s_lshl_b32 s64, s3, 6
    s_add_u32 s57, s57, s64
    v_lshrrev_b32 v5, 2, v0
    v_mul_u32_u24 v5, 1280, v5
    v_and_b32 v60, 3, v0
    v_lshl_add_u32 v5, v60, 4, v5
    v_add_u32 v5, s57, v5
    s_add_u32 m0, s59, 0
    s_mov_b32 s57, 0
    buffer_load_dwordx4 v5, s[44:47], s57 offen nt lds
    s_add_u32 m0, s59, 1024
    s_mov_b32 s57, 20480
    buffer_load_dwordx4 v5, s[44:47], s57 offen nt lds
    s_add_u32 m0, s59, 2048
    s_mov_b32 s57, 40960
    buffer_load_dwordx4 v5, s[44:47], s57 offen nt lds
    s_add_u32 m0, s59, 3072
    s_mov_b32 s57, 61440
    buffer_load_dwordx4 v5, s[44:47], s57 offen nt lds
    v_bfe_u32 v35, v0, 4, 1
    v_lshlrev_b32 v35, 11, v35
    v_bfe_u32 v60, v0, 2, 2
    v_lshl_add_u32 v35, v60, 8, v35
    v_lshrrev_b32 v60, 5, v0
    v_lshl_add_u32 v35, v60, 6, v35
    v_and_b32 v60, 3, v0
    v_lshl_add_u32 v35, v60, 3, v35
    v_add_u32 v35, s59, v35
    v_mov_b32 v9, 0xbdd2d3e8
    v_mov_b32 v10, 0xc0135761
    s_lshl_b32 s57, s60, 7
    s_add_u32 s57, s57, 159872
L_pad3:
    s_cbranch_execz L_pad7
    v_lshlrev_b32 v32, 3, v0
    v_add_u32 v32, s57, v32
    v_lshlrev_b32 v33, 3, v0
    v_add_u32 v33, 129024, v33
    v_cmp_gt_u32 vcc, 16, v0
    s_nop 1
    v_cndmask_b32 v32, v33, v32, vcc
    v_and_b32 v33, 15, v0
    v_lshlrev_b32 v33, 3, v33
    v_lshrrev_b32 v60, 5, v0
    v_lshl_add_u32 v33, v60, 2, v33
    v_add_u32 v33, 159872, v33
    v_and_b32 v34, 15, v0
    v_lshlrev_b32 v34, 2, v34
    v_lshrrev_b32 v60, 5, v0
    v_lshl_add_u32 v34, v60, 6, v34
    v_bfe_u32 v60, v0, 4, 1
    v_lshl_add_u32 v34, v60, 13, v34
    s_add_u32 s60, s6, 66048
    s_add_u32 s58, s62, 13312
    s_add_u32 s57, s62, 25856
    v_and_b32 v7, 7, v0
    v_lshlrev_b32 v7, 3, v7
    v_mov_b32 v60, 0x3acccccd
    v_mov_b32 v61, 0x3727c5ac
    s_waitcnt vmcnt(0)
    buffer_load_dwordx2 v[24:25], v7, s[40:43], s57 offen sc1
    buffer_load_dwordx4 v[12:15], v11, s[40:43], s58 offen offset:0 sc1
    buffer_load_dwordx4 v[16:19], v11, s[40:43], s58 offen offset:1024 sc1
    ds_read_b64_tr_b16 v[36:37], v35 offset:0
    ds_read_b64_tr_b16 v[38:39], v35 offset:1024
    ds_read_b64_tr_b16 v[40:41], v35 offset:128
    ds_read_b64_tr_b16 v[42:43], v35 offset:1152
    ds_read_b64_tr_b16 v[44:45], v35 offset:32
    ds_read_b64_tr_b16 v[46:47], v35 offset:1056
    ds_read_b64_tr_b16 v[48:49], v35 offset:160
    ds_read_b64_tr_b16 v[50:51], v35 offset:1184
L_sw_131:
    v_max3_u32 v20, v52, v53, v54
    v_max3_u32 v20, v20, v55, v56
    v_max3_u32 v20, v20, v57, v58
    v_max_u32 v20, v20, v59
    v_cmp_eq_u32 vcc, -1, v20
    s_cbranch_vccnz L_sr_132
    v_pk_add_f32 v[28:29], v[52:53], v[56:57]
    v_pk_add_f32 v[30:31], v[54:55], v[58:59]
    s_nop 1
    v_permlane32_swap_b32 v28, v30
    v_permlane32_swap_b32 v29, v31
    v_pk_add_f32 v[28:29], v[28:29], v[30:31]
    s_nop 1
    v_permlane16_swap_b32 v28, v29
    v_add_f32 v28, v28, v29
    v_mov_b64 v[52:53], 0
    v_mov_b64 v[54:55], 0
    v_mov_b64 v[56:57], 0
    v_mov_b64 v[58:59], 0
    s_waitcnt lgkmcnt(0)
    s_branch L_pw_129
.p2align 5
L_pr_130:
    buffer_load_dwordx2 v[24:25], v7, s[40:43], s57 offen sc1
    buffer_load_dwordx4 v[12:15], v11, s[40:43], s58 offen offset:0 sc1
    buffer_load_dwordx4 v[16:19], v11, s[40:43], s58 offen offset:1024 sc1
    s_sub_u32 s56, s56, 1
    s_cbranch_scc1 L_done
L_pw_129:
    s_waitcnt vmcnt(0)
    v_max_u32 v20, v24, v25
    v_cmp_eq_u32 vcc, -1, v20
    s_cbranch_vccnz L_pr_130
    buffer_load_dwordx4 v[12:15], v11, s[40:43], s58 offen offset:0 sc1
    buffer_load_dwordx4 v[16:19], v11, s[40:43], s58 offen offset:1024 sc1
    v_add_f32_dpp v2, v24, v24 row_ror:4 row_mask:0xf bank_mask:0xf
    v_add_f32_dpp v3, v25, v25 row_ror:4 row_mask:0xf bank_mask:0xf
    v_pk_add_f32 v[20:21], v[12:13], v[16:17]
    v_pk_add_f32 v[22:23], v[14:15], v[18:19]
    v_add_f32_dpp v2, v2, v2 row_ror:2 row_mask:0xf bank_mask:0xf
    v_add_f32_dpp v3, v3, v3 row_ror:2 row_mask:0xf bank_mask:0xf
    v_permlane32_swap_b32 v20, v22
    v_permlane32_swap_b32 v21, v23
    v_add_f32_dpp v2, v2, v2 row_ror:1 row_mask:0xf bank_mask:0xf
    v_add_f32_dpp v3, v3, v3 row_ror:1 row_mask:0xf bank_mask:0xf
    v_pk_add_f32 v[20:21], v[20:21], v[22:23]
    v_mul_f32 v2, v2, v60
    v_fma_f32 v3, v3, v60, v61
    v_permlane16_swap_b32 v20, v21
L_pad4:
    s_cbranch_execz L_pad8
    v_fma_f32 v3, -v2, v2, v3
    v_add_f32 v20, v20, v21
    v_max_f32 v3, v3, v61
    v_mul_f32 v26, v28, v2
    v_rsq_f32 v3, v3
    v_cmp_u_f32 vcc, v20, v20
    v_sub_f32 v20, v20, v26
    s_cbranch_vccnz L_hr_133
L_hk_134:
    v_fma_f32 v20, v20, v3, v4
    v_mul_f32 v21, v20, v20
    v_fma_f32 v21, v21, v9, v10
    v_mul_f32 v21, v21, v20
    v_exp_f32 v21, v21
    s_nop 0
    v_add_f32 v21, 1.0, v21
    v_rcp_f32 v21, v21
    s_nop 0
    v_mul_f32 v20, v20, v21
    s_nop 1
    v_mov_b32_dpp v21, v20 row_shl:1 row_mask:0xf bank_mask:0xf bound_ctrl:0
    v_cvt_pk_bf16_f32 v28, v20, v21
    s_nop 1
    v_mov_b32_dpp v29, v28 row_shl:4 row_mask:0xf bank_mask:0xf bound_ctrl:0
    v_mov_b32_dpp v30, v28 row_shl:8 row_mask:0xf bank_mask:0xf bound_ctrl:0
    v_mov_b32_dpp v31, v28 row_shl:12 row_mask:0xf bank_mask:0xf bound_ctrl:0
    s_nop 1
    v_smfmac_f32_16x16x64_bf16 v[52:55], v[28:31], v[36:43], v1
    v_smfmac_f32_16x16x64_bf16 v[56:59], v[28:31], v[44:51], v1
    s_cmp_eq_u32 s30, 4
    s_nop 5
    v_add_f32 v22, v52, v54
    v_add_f32 v23, v56, v58
    ds_write_b64 v32, v[22:23]
    s_cbranch_scc0 L_skip_136
L_xw_137:
    ds_read2_b32 v[20:21], v33 offset0:0 offset1:32
    ds_read_b32 v22, v33 offset:256
    s_sub_u32 s56, s56, 1
    s_cbranch_scc1 L_done
    s_waitcnt lgkmcnt(0)
    v_max3_u32 v23, v20, v21, v22
    v_add_f32 v20, v20, v21
    v_cmp_eq_u32 vcc, -1, v23
    v_add_f32 v20, v20, v22
    s_cbranch_vccnz L_xw_137
    buffer_store_dword v20, v34, s[40:43], s60 offen sc1
    s_waitcnt vmcnt(1)
    s_branch L_pe_138
.p2align 5
L_skip_136:
    s_waitcnt vmcnt(0)
L_pe_138:
L_skip_128:
    s_branch L_p1
.p2align 5
L_typeB_0:
    s_cmp_eq_u32 s53, 3
    s_cbranch_scc0 L_typeC_139
    s_cmp_eq_u32 s30, 7
    s_cbranch_scc1 L_w7_150
    s_cmp_lt_u32 s30, 6
    s_cbranch_scc0 L_skip_152
    s_lshr_b32 s57, s30, 1
    s_mul_i32 s57, s57, 128
    s_and_b32 s58, s30, 1
    s_lshl_b32 s58, s58, 6
    s_add_u32 s57, s57, s58
    v_lshrrev_b32 v18, 5, v0
    v_lshlrev_b32 v18, 13, v18
    v_bfe_u32 v60, v0, 3, 1
    v_lshl_add_u32 v18, v60, 12, v18
    v_bfe_u32 v60, v0, 4, 1
    v_lshl_add_u32 v18, v60, 11, v18
    v_bfe_u32 v60, v0, 2, 1
    v_mul_u32_u24 v60, 384, v60
    v_add_u32 v18, v60, v18
    v_and_b32 v60, 3, v0
    v_lshl_add_u32 v18, v60, 3, v18
    v_add_u32 v18, s57, v18
    v_add_u32 v18, 30720, v18
    v_bfe_u32 v19, v0, 4, 1
    v_lshlrev_b32 v19, 12, v19
    v_bfe_u32 v60, v0, 3, 1
    v_lshl_add_u32 v19, v60, 11, v19
    v_bfe_u32 v60, v0, 2, 1
    v_mul_u32_u24 v60, 384, v60
    v_add_u32 v19, v60, v19
    v_and_b32 v60, 3, v0
    v_lshl_add_u32 v19, v60, 3, v19
    v_add_u32 v19, s57, v19
    v_add_u32 v19, 63488, v19
    ds_read_b64_tr_b16 v[28:29], v18 offset:0
    ds_read_b64_tr_b16 v[30:31], v18 offset:1024
    ds_read_b64_tr_b16 v[32:33], v18 offset:16384
L_pad5:
    s_cbranch_execz L_pad9
    ds_read_b64_tr_b16 v[34:35], v18 offset:17408
    ds_read_b64_tr_b16 v[36:37], v19 offset:0
    ds_read_b64_tr_b16 v[38:39], v19 offset:1024
    ds_read_b64_tr_b16 v[40:41], v18 offset:32
    ds_read_b64_tr_b16 v[42:43], v18 offset:1056
    ds_read_b64_tr_b16 v[44:45], v18 offset:16416
    ds_read_b64_tr_b16 v[46:47], v18 offset:17440
    ds_read_b64_tr_b16 v[48:49], v19 offset:32
    ds_read_b64_tr_b16 v[50:51], v19 offset:1056
    v_lshrrev_b32 v9, 4, v0
    v_lshlrev_b32 v9, 5, v9
    v_bfe_u32 v60, v0, 1, 1
    v_lshl_add_u32 v9, v60, 4, v9
    v_and_b32 v60, 1, v0
    v_mul_u32_u24 v60, 192, v60
    v_add_u32 v9, v60, v9
    v_add_u32 v9, 160832, v9
    v_lshrrev_b32 v10, 4, v0
    v_lshlrev_b32 v10, 4, v10
    v_bfe_u32 v60, v0, 1, 1
    v_lshl_add_u32 v10, v60, 3, v10
    v_and_b32 v60, 1, v0
    v_mul_u32_u24 v60, 192, v60
    v_add_u32 v10, v60, v10
    v_add_u32 v10, 160960, v10
    v_mov_b64 v[20:21], 0
    v_mov_b64 v[22:23], 0
    v_mov_b64 v[24:25], 0
    v_mov_b64 v[26:27], 0
    s_lshr_b32 s57, s30, 1
    s_lshl_b32 s57, s57, 11
    s_lshl_b32 s58, s58, 1
    s_add_u32 s57, s57, s58
    s_lshl_b32 s58, s54, 8
    s_add_u32 s57, s57, s58
    v_and_b32 v11, 31, v0
    v_lshlrev_b32 v11, 2, v11
    v_lshrrev_b32 v60, 5, v0
    v_lshl_add_u32 v11, v60, 30, v11
    v_add_u32 v11, s57, v11
    s_add_u32 s59, s62, 13312
    s_add_u32 s60, s62, 25856
    ds_read_b128 v[12:15], v9
    ds_read_b64 v[16:17], v10
    s_waitcnt lgkmcnt(1)
    v_smfmac_f32_16x16x64_bf16 v[20:23], v[12:15], v[28:35], v1
    v_smfmac_f32_16x16x64_bf16 v[24:27], v[12:15], v[40:47], v1
    s_waitcnt lgkmcnt(0)
    v_smfmac_f32_16x16x32_bf16 v[20:23], v[16:17], v[36:39], v1
    v_smfmac_f32_16x16x32_bf16 v[24:27], v[16:17], v[48:51], v1
    s_add_u32 s60, s62, 19456
    s_cmp_eq_u32 s55, 0
    s_nop 4
    v_add_f32 v12, v21, v23
    s_nop 1
    v_add_f32_dpp v12, v25, v27 quad_perm:[0,1,2,3] row_mask:0x2 bank_mask:0xf
    s_cbranch_scc1 L_gs_153
    buffer_store_dword v12, v11, s[40:43], s60 offen
L_gb_154:
    v_mov_b64 v[20:21], 0
    v_mov_b64 v[22:23], 0
    v_mov_b64 v[24:25], 0
    v_mov_b64 v[26:27], 0
L_skip_152:
    s_cmp_lt_u32 s30, 6
    s_barrier
    s_cbranch_scc0 L_se_151
    ds_read_b128 v[12:15], v9
    ds_read_b64 v[16:17], v10
    s_waitcnt lgkmcnt(1)
    v_smfmac_f32_16x16x64_bf16 v[20:23], v[12:15], v[28:35], v1
    v_smfmac_f32_16x16x64_bf16 v[24:27], v[12:15], v[40:47], v1
    s_waitcnt lgkmcnt(0)
    v_smfmac_f32_16x16x32_bf16 v[20:23], v[16:17], v[36:39], v1
    v_smfmac_f32_16x16x32_bf16 v[24:27], v[16:17], v[48:51], v1
    s_cmp_eq_u32 s55, 0
    s_nop 5
    v_add_f32 v12, v20, v22
    s_nop 1
    v_add_f32_dpp v12, v24, v26 quad_perm:[0,1,2,3] row_mask:0x2 bank_mask:0xf
    s_cbranch_scc1 L_gs_155
    buffer_store_dword v12, v11, s[40:43], s59 offen
L_gb_156:
L_se_151:
L_p1:
    s_lshl_b32 s57, s30, 7
    s_add_u32 s57, s57, 158720
    v_lshrrev_b32 v58, 4, v0
    v_lshlrev_b32 v58, 5, v58
    v_bfe_u32 v60, v0, 1, 1
    v_lshl_add_u32 v58, v60, 4, v58
L_pad6:
    s_cbranch_execz L_pad10
    v_bfe_u32 v60, v0, 2, 2
    v_lshl_add_u32 v58, v60, 2, v58
    v_and_b32 v60, 1, v0
    v_lshl_add_u32 v58, v60, 1, v58
    v_add_u32 v58, s57, v58
    v_lshrrev_b32 v61, 4, v0
    v_lshlrev_b32 v61, 5, v61
    v_bfe_u32 v60, v0, 1, 1
    v_lshl_add_u32 v61, v60, 4, v61
    v_add_u32 v61, s57, v61
    v_bfe_u32 v62, v0, 2, 2
    v_lshlrev_b32 v62, 1, v62
    v_and_b32 v60, 1, v0
    v_lshl_add_u32 v62, v60, 0, v62
    v_mov_b32 v60, 160992
    v_cmp_eq_u32 vcc, 0, v62
    s_nop 1
    v_cndmask_b32 v52, v60, v61, vcc
    v_cmp_eq_u32 vcc, 1, v62
    s_nop 1
    v_cndmask_b32 v53, v60, v61, vcc
    v_cmp_eq_u32 vcc, 2, v62
    s_nop 1
    v_cndmask_b32 v54, v60, v61, vcc
    v_cmp_eq_u32 vcc, 3, v62
    s_nop 1
    v_cndmask_b32 v55, v60, v61, vcc
    v_cmp_eq_u32 vcc, 4, v62
    s_nop 1
    v_cndmask_b32 v56, v60, v61, vcc
    v_cmp_eq_u32 vcc, 5, v62
    s_nop 1
    v_cndmask_b32 v57, v60, v61, vcc
    s_lshl_b32 s58, s30, 2
    s_add_u32 s58, s58, 159808
    v_mov_b32 v60, s58
    v_lshlrev_b32 v59, 2, v0
    v_add_u32 v59, 158208, v59
    v_cmp_eq_u32 vcc, 63, v0
    s_nop 1
    v_cndmask_b32 v59, v59, v60, vcc
    v_and_b32 v62, 7, v0
    v_lshlrev_b32 v62, 2, v62
    v_add_u32 v62, 159808, v62
    s_lshl_b32 s57, s30, 11
    v_lshlrev_b32 v63, 4, v0
    v_add_u32 v63, s57, v63
    v_add_u32 v63, 92160, v63
    s_sub_u32 s57, s30, 1
    s_lshl_b32 s58, s57, 11
    v_lshlrev_b32 v7, 4, v0
    v_add_u32 v7, s58, v7
    s_lshl_b32 s58, s57, 7
    v_bfe_u32 v8, v0, 2, 2
    v_lshlrev_b32 v8, 5, v8
    v_lshrrev_b32 v60, 5, v0
    v_lshl_add_u32 v8, v60, 4, v8
    v_and_b32 v60, 3, v0
    v_lshl_add_u32 v8, v60, 2, v8
    v_bfe_u32 v60, v0, 4, 1
    v_lshl_add_u32 v8, v60, 1, v8
    v_add_u32 v8, s58, v8
    v_add_u32 v8, 124928, v8
    s_cmp_eq_u32 s30, 7
    s_cbranch_scc1 L_w7_164
    s_cmp_lt_u32 s30, 6
    s_cbranch_scc0 L_skip_166
    s_lshr_b32 s57, s30, 1
    s_mul_i32 s57, s57, 1024
    s_and_b32 s58, s30, 1
    s_lshl_b32 s58, s58, 6
    s_add_u32 s57, s57, s58
    v_lshrrev_b32 v18, 5, v0
    v_mul_u32_u24 v18, 6144, v18
    v_bfe_u32 v60, v0, 3, 1
    v_mul_u32_u24 v60, 3072, v60
    v_add_u32 v18, v60, v18
    v_bfe_u32 v60, v0, 4, 1
    v_lshl_add_u32 v18, v60, 9, v18
    v_bfe_u32 v60, v0, 2, 1
    v_lshl_add_u32 v18, v60, 7, v18
    v_and_b32 v60, 3, v0
    v_lshl_add_u32 v18, v60, 3, v18
    v_add_u32 v18, s57, v18
    v_bfe_u32 v19, v0, 4, 1
    v_mul_u32_u24 v19, 3072, v19
    v_bfe_u32 v60, v0, 3, 1
    v_lshl_add_u32 v19, v60, 9, v19
    v_bfe_u32 v60, v0, 2, 1
    v_lshl_add_u32 v19, v60, 7, v19
    v_and_b32 v60, 3, v0
    v_lshl_add_u32 v19, v60, 3, v19
    v_add_u32 v19, s57, v19
L_pad7:
    s_cbranch_execz L_pad11
    v_add_u32 v19, 24576, v19
    ds_read_b64_tr_b16 v[28:29], v18 offset:0
    ds_read_b64_tr_b16 v[30:31], v18 offset:256
    ds_read_b64_tr_b16 v[32:33], v18 offset:12288
    ds_read_b64_tr_b16 v[34:35], v18 offset:12544
    ds_read_b64_tr_b16 v[36:37], v19 offset:0
    ds_read_b64_tr_b16 v[38:39], v19 offset:256
    ds_read_b64_tr_b16 v[40:41], v18 offset:32
    ds_read_b64_tr_b16 v[42:43], v18 offset:288
    ds_read_b64_tr_b16 v[44:45], v18 offset:12320
    ds_read_b64_tr_b16 v[46:47], v18 offset:12576
    ds_read_b64_tr_b16 v[48:49], v19 offset:32
    ds_read_b64_tr_b16 v[50:51], v19 offset:288
    v_lshrrev_b32 v9, 4, v0
    v_lshlrev_b32 v9, 5, v9
    v_bfe_u32 v60, v0, 1, 1
    v_lshl_add_u32 v9, v60, 4, v9
    v_and_b32 v60, 1, v0
    v_mul_u32_u24 v60, 192, v60
    v_add_u32 v9, v60, v9
    v_add_u32 v9, 160832, v9
    v_lshrrev_b32 v10, 4, v0
    v_lshlrev_b32 v10, 4, v10
    v_bfe_u32 v60, v0, 1, 1
    v_lshl_add_u32 v10, v60, 3, v10
    v_and_b32 v60, 1, v0
    v_mul_u32_u24 v60, 192, v60
    v_add_u32 v10, v60, v10
    v_add_u32 v10, 160960, v10
    v_mov_b64 v[20:21], 0
    v_mov_b64 v[22:23], 0
    v_mov_b64 v[24:25], 0
    v_mov_b64 v[26:27], 0
    s_lshr_b32 s57, s30, 1
    s_lshl_b32 s57, s57, 11
    s_lshl_b32 s58, s58, 1
    s_add_u32 s57, s57, s58
    s_lshl_b32 s58, s54, 8
    s_add_u32 s57, s57, s58
    v_and_b32 v11, 31, v0
    v_lshlrev_b32 v11, 2, v11
    v_lshrrev_b32 v60, 5, v0
    v_lshl_add_u32 v11, v60, 30, v11
    v_add_u32 v11, s57, v11
    s_mul_i32 s59, s53, 6144
    s_add_u32 s59, s59, s62
    s_add_u32 s59, s59, 46080
    s_lshl_b32 s60, s53, 6
    s_add_u32 s60, s60, s62
    s_add_u32 s60, s60, 25600
L_skip_166:
    s_cmp_lt_u32 s30, 6
    s_barrier
    s_cbranch_scc0 L_se_165
    ds_read_b128 v[12:15], v9
    ds_read_b64 v[16:17], v10
    s_waitcnt lgkmcnt(1)
    v_smfmac_f32_16x16x64_bf16 v[20:23], v[12:15], v[28:35], v1
    v_smfmac_f32_16x16x64_bf16 v[24:27], v[12:15], v[40:47], v1
    s_waitcnt lgkmcnt(0)
    v_smfmac_f32_16x16x32_bf16 v[20:23], v[16:17], v[36:39], v1
    v_smfmac_f32_16x16x32_bf16 v[24:27], v[16:17], v[48:51], v1
    s_cmp_eq_u32 s55, 0
    s_nop 5
    v_add_f32 v12, v20, v22
    s_nop 1
    v_add_f32_dpp v12, v24, v26 quad_perm:[0,1,2,3] row_mask:0x2 bank_mask:0xf
    s_cbranch_scc1 L_gs_167
    buffer_store_dword v12, v11, s[40:43], s59 offen
L_gb_168:
L_se_165:
    s_sub_u32 s57, s30, 1
    s_cmp_lt_u32 s57, 3
    s_cbranch_scc0 L_qo_182
    v_and_b32 v9, 7, v0
    v_lshlrev_b32 v9, 3, v9
    buffer_load_dwordx2 v[10:11], v9, s[40:43], s60 offen sc1
    buffer_load_dwordx4 v[40:43], v7, s[40:43], s59 offen offset:0 sc1
    buffer_load_dwordx4 v[44:47], v7, s[40:43], s59 offen offset:1024 sc1
    v_mov_b64 v[24:25], 0
    v_mov_b64 v[26:27], 0
    v_mov_b64 v[28:29], 0
    v_mov_b64 v[30:31], 0
    v_mov_b64 v[32:33], 0
    v_mov_b64 v[34:35], 0
    v_mov_b64 v[36:37], 0
    v_mov_b64 v[38:39], 0
    v_lshrrev_b32 v5, 4, v0
    v_lshlrev_b32 v5, 5, v5
    v_bfe_u32 v60, v0, 1, 1
    v_lshl_add_u32 v5, v60, 4, v5
    v_add_u32 v5, 124928, v5
L_pad8:
    s_cbranch_execz L_pad12
    v_mov_b32 v60, 0x3c75e03e
    v_mov_b32 v61, 0x3a71d1e6
    v_mov_b32 v51, 0x3e13985d
    s_branch L_pw_184
.p2align 5
L_pr_185:
    buffer_load_dwordx2 v[10:11], v9, s[40:43], s60 offen sc1
    buffer_load_dwordx4 v[40:43], v7, s[40:43], s59 offen offset:0 sc1
    buffer_load_dwordx4 v[44:47], v7, s[40:43], s59 offen offset:1024 sc1
    s_sub_u32 s56, s56, 1
    s_cbranch_scc1 L_done
L_pw_184:
    s_waitcnt vmcnt(0)
    v_max_u32 v20, v10, v11
    v_cmp_eq_u32 vcc, -1, v20
    s_cbranch_vccnz L_pr_185
    buffer_load_dwordx4 v[40:43], v7, s[40:43], s59 offen offset:0 sc1
    buffer_load_dwordx4 v[44:47], v7, s[40:43], s59 offen offset:1024 sc1
    v_add_f32_dpp v48, v10, v10 row_ror:4 row_mask:0xf bank_mask:0xf
    v_add_f32_dpp v49, v11, v11 row_ror:4 row_mask:0xf bank_mask:0xf
    v_pk_add_f32 v[20:21], v[40:41], v[44:45]
    v_pk_add_f32 v[22:23], v[42:43], v[46:47]
    v_add_f32_dpp v48, v48, v48 row_ror:2 row_mask:0xf bank_mask:0xf
    v_add_f32_dpp v49, v49, v49 row_ror:2 row_mask:0xf bank_mask:0xf
    v_permlane32_swap_b32 v20, v22
    v_permlane32_swap_b32 v21, v23
    v_add_f32_dpp v48, v48, v48 row_ror:1 row_mask:0xf bank_mask:0xf
    v_add_f32_dpp v49, v49, v49 row_ror:1 row_mask:0xf bank_mask:0xf
    v_pk_add_f32 v[20:21], v[20:21], v[22:23]
    v_mul_f32 v48, v48, v60
    v_fma_f32 v49, v49, v51, v61
    v_permlane16_swap_b32 v20, v21
    v_fma_f32 v49, -v48, v48, v49
    v_add_f32 v20, v20, v21
    v_max_f32 v49, v49, v61
    v_mul_f32 v50, v6, v48
    v_rsq_f32 v49, v49
    v_cmp_u_f32 vcc, v20, v20
    v_sub_f32 v20, v20, v50
    s_cbranch_vccnz L_hr_186
L_hk_187:
    v_mul_f32 v20, v20, v49
    v_cvt_pk_bf16_f32 v20, v20, v20
    ds_write_b16 v8, v20
L_qb_183:
    s_waitcnt lgkmcnt(0)
    s_barrier
    ds_read_b128 v[12:15], v5 offset:0
    ds_read_b128 v[16:19], v5 offset:128
    ds_read_b128 v[20:23], v5 offset:256
    s_cmp_lt_u32 s30, 4
    s_waitcnt lgkmcnt(0)
    v_smfmac_f32_16x16x64_bf16 v[24:27], v[12:15], v[64:71], v1
    v_smfmac_f32_16x16x64_bf16 v[24:27], v[16:19], v[72:79], v1
    v_smfmac_f32_16x16x64_bf16 v[24:27], v[20:23], v[80:87], v1
    v_smfmac_f32_16x16x64_bf16 v[28:31], v[12:15], v[88:95], v1
    v_smfmac_f32_16x16x64_bf16 v[28:31], v[16:19], v[96:103], v1
    v_smfmac_f32_16x16x64_bf16 v[28:31], v[20:23], v[104:111], v1
    v_smfmac_f32_16x16x64_bf16 v[32:35], v[12:15], v[112:119], v1
    v_smfmac_f32_16x16x64_bf16 v[32:35], v[16:19], v[120:127], v1
    v_smfmac_f32_16x16x64_bf16 v[32:35], v[20:23], v[128:135], v1
    v_smfmac_f32_16x16x64_bf16 v[36:39], v[12:15], v[136:143], v1
    v_smfmac_f32_16x16x64_bf16 v[36:39], v[16:19], v[144:151], v1
    v_smfmac_f32_16x16x64_bf16 v[36:39], v[20:23], v[152:159], v1
    v_add_f32 v24, v24, v26
    s_waitcnt vmcnt(0)
    v_add_f32 v28, v28, v30
    s_nop 1
    v_add_f32 v32, v32, v34
    v_max3_f32 v61, v24, v28, v32
    v_mov_b32_dpp v24, v28 quad_perm:[0,1,2,3] row_mask:0x2 bank_mask:0xf
    v_add_f32 v36, v36, v38
    v_max_f32 v61, v61, v36
    v_mov_b32_dpp v24, v32 quad_perm:[0,1,2,3] row_mask:0x4 bank_mask:0xf
    s_nop 0
    v_max_f32_dpp v61, v61, v61 row_ror:8 row_mask:0xf bank_mask:0xf
    s_nop 0
    v_mov_b32_dpp v24, v36 quad_perm:[0,1,2,3] row_mask:0x8 bank_mask:0xf
    v_max_f32_dpp v61, v61, v61 row_ror:4 row_mask:0xf bank_mask:0xf
    s_nop 1
    v_max_f32_dpp v61, v61, v61 row_ror:2 row_mask:0xf bank_mask:0xf
L_pad9:
    s_cbranch_execz L_pad13
    s_nop 1
    v_max_f32_dpp v61, v61, v61 row_ror:1 row_mask:0xf bank_mask:0xf
    v_sub_f32 v36, v24, v61
    ds_write_b32 v59, v61
    v_exp_f32 v36, v36
    s_nop 0
    v_cvt_pk_bf16_f32 v39, v36, v36
    ds_write_b16 v58, v39
    ds_read_b128 v[12:15], v52
    ds_read_b128 v[16:19], v53
    ds_read_b128 v[20:23], v54
    ds_read_b128 v[24:27], v55
    ds_read_b128 v[28:31], v56
    ds_read_b128 v[32:35], v57
    v_add_f32_dpp v38, v36, v36 row_ror:8 row_mask:0xf bank_mask:0xf
    v_mov_b64 v[40:41], 0
    v_mov_b64 v[42:43], 0
    v_add_f32_dpp v38, v38, v38 row_ror:4 row_mask:0xf bank_mask:0xf
    v_mov_b64 v[44:45], 0
    v_mov_b64 v[46:47], 0
    s_waitcnt lgkmcnt(5)
    v_smfmac_f32_16x16x64_bf16 v[40:43], v[12:15], v[160:167], v1
    v_add_f32_dpp v38, v38, v38 row_ror:2 row_mask:0xf bank_mask:0xf
    v_smfmac_f32_16x16x64_bf16 v[44:47], v[12:15], v[208:215], v1
    ds_read_b32 v36, v62
    s_waitcnt lgkmcnt(5)
    v_smfmac_f32_16x16x64_bf16 v[40:43], v[16:19], v[168:175], v1
    v_add_f32_dpp v38, v38, v38 row_ror:1 row_mask:0xf bank_mask:0xf
    v_smfmac_f32_16x16x64_bf16 v[44:47], v[16:19], v[216:223], v1
    s_waitcnt lgkmcnt(4)
    v_smfmac_f32_16x16x64_bf16 v[40:43], v[20:23], v[176:183], v1
    v_add_f32_dpp v38, v38, v38 row_bcast:15 row_mask:0xa bank_mask:0xf
    v_smfmac_f32_16x16x64_bf16 v[44:47], v[20:23], v[224:231], v1
    s_waitcnt lgkmcnt(0)
    v_max_f32_dpp v37, v36, v36 row_ror:4 row_mask:0xf bank_mask:0xf
    v_smfmac_f32_16x16x64_bf16 v[40:43], v[24:27], v[184:191], v1
    v_add_f32_dpp v38, v38, v38 row_bcast:31 row_mask:0xc bank_mask:0xf
    v_smfmac_f32_16x16x64_bf16 v[44:47], v[24:27], v[232:239], v1
    v_max_f32_dpp v37, v37, v37 row_ror:2 row_mask:0xf bank_mask:0xf
    v_smfmac_f32_16x16x64_bf16 v[40:43], v[28:31], v[192:199], v1
    v_cmp_eq_u32 vcc, -1, v36
    v_smfmac_f32_16x16x64_bf16 v[44:47], v[28:31], v[240:247], v1
    v_max_f32_dpp v37, v37, v37 row_ror:1 row_mask:0xf bank_mask:0xf
    v_smfmac_f32_16x16x64_bf16 v[40:43], v[32:35], v[200:207], v1
    v_sub_f32 v39, v61, v37
    v_smfmac_f32_16x16x64_bf16 v[44:47], v[32:35], v[248:255], v1
    v_exp_f32 v39, v39
    s_cbranch_vccnz L_mr_189
L_mk_190:
    v_mul_f32 v38, v38, v39
    ds_write_b32 v63, v38 offset:1024
    s_cmp_lt_u32 s30, 2
    s_nop 0
    v_pk_add_f32 v[40:41], v[40:41], v[42:43]
    s_nop 0
    v_pk_add_f32 v[42:43], v[44:45], v[46:47]
    v_pk_mul_f32 v[40:41], v[40:41], v[38:39] op_sel:[0,1] op_sel_hi:[1,1]
    v_pk_mul_f32 v[42:43], v[42:43], v[38:39] op_sel:[0,1] op_sel_hi:[1,1]
    ds_write_b128 v63, v[40:43]
    s_cbranch_scc1 L_comb_1
    s_waitcnt lgkmcnt(0)
    s_barrier
L_comb_1b:
    s_cmp_lt_u32 s3, 20
    s_cbranch_scc0 L_typeB_1
    s_mul_i32 s74, s30, 1664
    s_add_u32 s74, s74, s62
    s_add_u32 s74, s74, 26624
    v_and_b32 v56, 7, v0
    v_lshlrev_b32 v56, 2, v56
    v_lshrrev_b32 v62, 4, v0
    v_lshlrev_b32 v62, 3, v62
    buffer_load_dword v52, v56, s[40:43], s74 offen offset:1536 sc1
    buffer_load_dwordx2 v[54:55], v62, s[40:43], s74 offen offset:1536 sc1
    v_lshlrev_b32 v57, 4, v0
    v_lshlrev_b32 v58, 3, v0
    s_mul_i32 s57, s30, 6144
    s_add_u32 s57, s57, 30720
    v_lshrrev_b32 v59, 2, v0
    v_lshlrev_b32 v59, 6, v59
    v_bfe_u32 v53, v0, 4, 1
    v_lshl_add_u32 v59, v53, 5, v59
    v_and_b32 v53, 3, v0
L_pad10:
    s_cbranch_execz L_pad14
    v_lshl_add_u32 v59, v53, 3, v59
    v_add_u32 v59, s57, v59
    v_xor_b32 v60, 32, v59
    s_lshl_b32 s57, s30, 8
    s_add_u32 s57, s57, 157696
    v_lshl_add_u32 v61, v0, 2, s57
    ds_read_b64_tr_b16 v[28:29], v59 offset:0
    ds_read_b64_tr_b16 v[30:31], v59 offset:1024
    ds_read_b64_tr_b16 v[32:33], v59 offset:2048
    ds_read_b64_tr_b16 v[34:35], v59 offset:3072
    ds_read_b64_tr_b16 v[36:37], v59 offset:4096
    ds_read_b64_tr_b16 v[38:39], v59 offset:5120
    ds_read_b64_tr_b16 v[40:41], v60 offset:0
    ds_read_b64_tr_b16 v[42:43], v60 offset:1024
    ds_read_b64_tr_b16 v[44:45], v60 offset:2048
    ds_read_b64_tr_b16 v[46:47], v60 offset:3072
    ds_read_b64_tr_b16 v[48:49], v60 offset:4096
    ds_read_b64_tr_b16 v[50:51], v60 offset:5120
    v_mov_b64 v[20:21], 0
    v_mov_b64 v[22:23], 0
    v_mov_b64 v[24:25], 0
    v_mov_b64 v[26:27], 0
    s_add_u32 s58, s6, 132096
    s_branch L_pw_197
.p2align 5
L_pr_198:
    buffer_load_dword v52, v56, s[40:43], s74 offen offset:1536 sc1
    buffer_load_dwordx2 v[54:55], v62, s[40:43], s74 offen offset:1536 sc1
    s_sub_u32 s56, s56, 1
    s_cbranch_scc1 L_done
L_pw_197:
    s_waitcnt vmcnt(0)
    v_max3_u32 v53, v52, v54, v55
    v_cmp_eq_u32 vcc, -1, v53
    s_cbranch_vccnz L_pr_198
    buffer_load_dwordx4 v[12:15], v57, s[40:43], s74 offen sc1
    buffer_load_dwordx2 v[16:17], v58, s[40:43], s74 offen offset:1024 sc1
    buffer_load_dword v18, v56, s[40:43], s74 offen offset:1568 sc1
    v_max_f32_dpp v53, v52, v52 row_ror:4 row_mask:0xf bank_mask:0xf
    s_nop 1
    v_max_f32_dpp v53, v53, v53 row_ror:2 row_mask:0xf bank_mask:0xf
    s_nop 1
    v_max_f32_dpp v53, v53, v53 row_ror:1 row_mask:0xf bank_mask:0xf
    v_sub_f32 v52, v52, v53
    v_sub_f32 v54, v54, v53
    v_sub_f32 v55, v55, v53
    v_exp_f32 v52, v52
    v_exp_f32 v54, v54
    v_exp_f32 v55, v55
    s_waitcnt lgkmcnt(0)
    s_branch L_ow_199
.p2align 5
L_or_200:
    buffer_load_dwordx4 v[12:15], v57, s[40:43], s74 offen sc1
    buffer_load_dwordx2 v[16:17], v58, s[40:43], s74 offen offset:1024 sc1
    buffer_load_dword v18, v56, s[40:43], s74 offen offset:1568 sc1
    s_sub_u32 s56, s56, 1
    s_cbranch_scc1 L_done
    v_mov_b64 v[20:21], 0
    v_mov_b64 v[22:23], 0
    v_mov_b64 v[24:25], 0
    v_mov_b64 v[26:27], 0
L_ow_199:
    s_waitcnt vmcnt(2)
    v_smfmac_f32_16x16x64_bf16 v[20:23], v[12:15], v[28:35], v1
    v_max3_u32 v19, v12, v13, v14
    v_smfmac_f32_16x16x64_bf16 v[24:27], v[12:15], v[40:47], v1
    s_waitcnt vmcnt(0)
    v_mul_f32 v53, v52, v18
    v_smfmac_f32_16x16x32_bf16 v[20:23], v[16:17], v[36:39], v1
    v_max3_u32 v62, v15, v16, v17
    v_smfmac_f32_16x16x32_bf16 v[24:27], v[16:17], v[48:51], v1
    v_max3_u32 v19, v19, v62, v18
    v_add_f32_dpp v53, v53, v53 row_ror:4 row_mask:0xf bank_mask:0xf
    v_cmp_eq_u32 vcc, -1, v19
    s_cmp_eq_u32 s30, 2
    v_add_f32_dpp v53, v53, v53 row_ror:2 row_mask:0xf bank_mask:0xf
    s_cbranch_vccnz L_or_200
    s_nop 0
    v_add_f32_dpp v53, v53, v53 row_ror:1 row_mask:0xf bank_mask:0xf
    v_rcp_f32 v52, v53
L_pad11:
    s_cbranch_execz L_pad15
    v_pk_add_f32 v[20:21], v[20:21], v[22:23]
    v_pk_add_f32 v[24:25], v[24:25], v[26:27]
    v_pk_mul_f32 v[54:55], v[54:55], v[52:53] op_sel:[0,0] op_sel_hi:[1,0]
    v_mul_f32 v20, v20, v54
    v_mul_f32 v24, v24, v54
    v_fmac_f32 v20, v21, v55
    v_fmac_f32 v24, v25, v55
    s_nop 1
    v_permlane32_swap_b32 v20, v24
    v_add_f32 v20, v20, v24
    ds_write_b32 v61, v20
    s_waitcnt lgkmcnt(0)
    s_barrier
    s_cbranch_scc0 L_finb_201
    ds_read2st64_b32 v[12:13], v2 offset0:0 offset1:1
    ds_read2st64_b32 v[14:15], v2 offset0:2 offset1:3
    ds_read2st64_b32 v[16:17], v2 offset0:4 offset1:5
    ds_read2st64_b32 v[18:19], v2 offset0:6 offset1:7
    s_waitcnt lgkmcnt(2)
    v_pk_add_f32 v[12:13], v[12:13], v[14:15]
    s_waitcnt lgkmcnt(0)
    v_pk_add_f32 v[16:17], v[16:17], v[18:19]
    v_pk_add_f32 v[12:13], v[12:13], v[16:17]
    v_add_f32 v14, v12, v13
    v_add_f32 v15, v12, v13
    s_nop 1
    v_permlane16_swap_b32 v14, v15
    v_add_f32 v12, v14, v15
    buffer_store_dword v12, v3, s[40:43], s58 offen sc1
L_finb_201:
    s_sub_u32 s57, s30, 4
    s_cmp_lt_u32 s57, 3
    s_cbranch_scc0 L_skip_202
    s_sub_u32 s60, s30, 4
    s_lshl_b32 s57, s60, 11
    v_lshlrev_b32 v11, 4, v0
    v_add_u32 v11, s57, v11
    s_add_u32 s65, s62, 19456
    buffer_load_dwordx4 v[52:55], v11, s[40:43], s65 offen offset:0 sc1
    buffer_load_dwordx4 v[56:59], v11, s[40:43], s65 offen offset:1024 sc1
    s_lshl_b32 s59, s60, 12
    s_add_u32 s59, s59, 79872
    v_bfe_u32 v35, v0, 4, 1
    v_lshlrev_b32 v35, 11, v35
    v_bfe_u32 v60, v0, 2, 2
    v_lshl_add_u32 v35, v60, 8, v35
    v_lshrrev_b32 v60, 5, v0
    v_lshl_add_u32 v35, v60, 6, v35
    v_and_b32 v60, 3, v0
    v_lshl_add_u32 v35, v60, 3, v35
    v_add_u32 v35, s59, v35
    v_mov_b32 v9, 0xbdd2d3e8
    v_mov_b32 v10, 0xc0135761
    s_lshl_b32 s57, s60, 7
    s_add_u32 s57, s57, 160256
    v_lshlrev_b32 v32, 3, v0
    v_add_u32 v32, s57, v32
    v_lshlrev_b32 v33, 3, v0
    v_add_u32 v33, 129024, v33
    v_cmp_gt_u32 vcc, 16, v0
    s_nop 1
    v_cndmask_b32 v32, v33, v32, vcc
    v_and_b32 v33, 15, v0
    v_lshlrev_b32 v33, 3, v33
    v_lshrrev_b32 v60, 5, v0
    v_lshl_add_u32 v33, v60, 2, v33
    v_add_u32 v33, 160256, v33
    v_and_b32 v34, 15, v0
    v_lshlrev_b32 v34, 2, v34
    v_lshrrev_b32 v60, 5, v0
    v_lshl_add_u32 v34, v60, 6, v34
    v_bfe_u32 v60, v0, 4, 1
    v_lshl_add_u32 v34, v60, 13, v34
    s_add_u32 s60, s6, 198144
    s_add_u32 s58, s62, 39936
    s_add_u32 s57, s62, 25984
    v_and_b32 v7, 7, v0
    v_lshlrev_b32 v7, 3, v7
    v_mov_b32 v60, 0x3acccccd
    v_mov_b32 v61, 0x3727c5ac
    s_waitcnt vmcnt(0)
    buffer_load_dwordx2 v[24:25], v7, s[40:43], s57 offen sc1
    buffer_load_dwordx4 v[12:15], v11, s[40:43], s58 offen offset:0 sc1
    buffer_load_dwordx4 v[16:19], v11, s[40:43], s58 offen offset:1024 sc1
    ds_read_b64_tr_b16 v[36:37], v35 offset:0
    ds_read_b64_tr_b16 v[38:39], v35 offset:1024
    ds_read_b64_tr_b16 v[40:41], v35 offset:128
L_pad12:
    s_cbranch_execz L_pad16
    ds_read_b64_tr_b16 v[42:43], v35 offset:1152
    ds_read_b64_tr_b16 v[44:45], v35 offset:32
    ds_read_b64_tr_b16 v[46:47], v35 offset:1056
    ds_read_b64_tr_b16 v[48:49], v35 offset:160
    ds_read_b64_tr_b16 v[50:51], v35 offset:1184
L_sw_205:
    v_max3_u32 v20, v52, v53, v54
    v_max3_u32 v20, v20, v55, v56
    v_max3_u32 v20, v20, v57, v58
    v_max_u32 v20, v20, v59
    v_cmp_eq_u32 vcc, -1, v20
    s_cbranch_vccnz L_sr_206
    v_pk_add_f32 v[28:29], v[52:53], v[56:57]
    v_pk_add_f32 v[30:31], v[54:55], v[58:59]
    s_nop 1
    v_permlane32_swap_b32 v28, v30
    v_permlane32_swap_b32 v29, v31
    v_pk_add_f32 v[28:29], v[28:29], v[30:31]
    s_nop 1
    v_permlane16_swap_b32 v28, v29
    v_add_f32 v28, v28, v29
    v_mov_b64 v[52:53], 0
    v_mov_b64 v[54:55], 0
    v_mov_b64 v[56:57], 0
    v_mov_b64 v[58:59], 0
    s_waitcnt lgkmcnt(0)
    s_branch L_pw_203
.p2align 5
L_pr_204:
    buffer_load_dwordx2 v[24:25], v7, s[40:43], s57 offen sc1
    buffer_load_dwordx4 v[12:15], v11, s[40:43], s58 offen offset:0 sc1
    buffer_load_dwordx4 v[16:19], v11, s[40:43], s58 offen offset:1024 sc1
    s_sub_u32 s56, s56, 1
    s_cbranch_scc1 L_done
L_pw_203:
    s_waitcnt vmcnt(0)
    v_max_u32 v20, v24, v25
    v_cmp_eq_u32 vcc, -1, v20
    s_cbranch_vccnz L_pr_204
    buffer_load_dwordx4 v[12:15], v11, s[40:43], s58 offen offset:0 sc1
    buffer_load_dwordx4 v[16:19], v11, s[40:43], s58 offen offset:1024 sc1
    v_add_f32_dpp v2, v24, v24 row_ror:4 row_mask:0xf bank_mask:0xf
    v_add_f32_dpp v3, v25, v25 row_ror:4 row_mask:0xf bank_mask:0xf
    v_pk_add_f32 v[20:21], v[12:13], v[16:17]
    v_pk_add_f32 v[22:23], v[14:15], v[18:19]
    v_add_f32_dpp v2, v2, v2 row_ror:2 row_mask:0xf bank_mask:0xf
    v_add_f32_dpp v3, v3, v3 row_ror:2 row_mask:0xf bank_mask:0xf
    v_permlane32_swap_b32 v20, v22
    v_permlane32_swap_b32 v21, v23
    v_add_f32_dpp v2, v2, v2 row_ror:1 row_mask:0xf bank_mask:0xf
    v_add_f32_dpp v3, v3, v3 row_ror:1 row_mask:0xf bank_mask:0xf
    v_pk_add_f32 v[20:21], v[20:21], v[22:23]
    v_mul_f32 v2, v2, v60
    v_fma_f32 v3, v3, v60, v61
    v_permlane16_swap_b32 v20, v21
    v_fma_f32 v3, -v2, v2, v3
    v_add_f32 v20, v20, v21
    v_max_f32 v3, v3, v61
    v_mul_f32 v26, v28, v2
    v_rsq_f32 v3, v3
    v_cmp_u_f32 vcc, v20, v20
    v_sub_f32 v20, v20, v26
    s_cbranch_vccnz L_hr_207
L_hk_208:
    v_fma_f32 v20, v20, v3, v4
    v_mul_f32 v21, v20, v20
    v_fma_f32 v21, v21, v9, v10
    v_mul_f32 v21, v21, v20
    v_exp_f32 v21, v21
    s_nop 0
    v_add_f32 v21, 1.0, v21
    v_rcp_f32 v21, v21
    s_nop 0
    v_mul_f32 v20, v20, v21
    s_nop 1
    v_mov_b32_dpp v21, v20 row_shl:1 row_mask:0xf bank_mask:0xf bound_ctrl:0
    v_cvt_pk_bf16_f32 v28, v20, v21
    s_nop 1
    v_mov_b32_dpp v29, v28 row_shl:4 row_mask:0xf bank_mask:0xf bound_ctrl:0
    v_mov_b32_dpp v30, v28 row_shl:8 row_mask:0xf bank_mask:0xf bound_ctrl:0
    v_mov_b32_dpp v31, v28 row_shl:12 row_mask:0xf bank_mask:0xf bound_ctrl:0
    s_nop 1
    v_smfmac_f32_16x16x64_bf16 v[52:55], v[28:31], v[36:43], v1
    v_smfmac_f32_16x16x64_bf16 v[56:59], v[28:31], v[44:51], v1
    s_cmp_eq_u32 s30, 4
    s_nop 5
    v_add_f32 v22, v52, v54
    v_add_f32 v23, v56, v58
    ds_write_b64 v32, v[22:23]
    s_cbranch_scc0 L_skip_210
L_xw_211:
    ds_read2_b32 v[20:21], v33 offset0:0 offset1:32
    ds_read_b32 v22, v33 offset:256
L_pad13:
    s_cbranch_execz L_pad17
    s_sub_u32 s56, s56, 1
    s_cbranch_scc1 L_done
    s_waitcnt lgkmcnt(0)
    v_max3_u32 v23, v20, v21, v22
    v_add_f32 v20, v20, v21
    v_cmp_eq_u32 vcc, -1, v23
    v_add_f32 v20, v20, v22
    s_cbranch_vccnz L_xw_211
    buffer_store_dword v20, v34, s[40:43], s60 offen sc1
L_skip_210:
L_skip_202:
    s_branch L_done
.p2align 5
L_typeB_1:
    s_cmp_eq_u32 s53, 3
    s_cbranch_scc0 L_typeC_212
    s_cmp_eq_u32 s30, 7
    s_cbranch_scc1 L_w7_217
    s_cmp_lt_u32 s30, 6
    s_cbranch_scc0 L_skip_219
    s_lshr_b32 s57, s30, 1
    s_mul_i32 s57, s57, 128
    s_and_b32 s58, s30, 1
    s_lshl_b32 s58, s58, 6
    s_add_u32 s57, s57, s58
    v_lshrrev_b32 v18, 5, v0
    v_lshlrev_b32 v18, 13, v18
    v_bfe_u32 v60, v0, 3, 1
    v_lshl_add_u32 v18, v60, 12, v18
    v_bfe_u32 v60, v0, 4, 1
    v_lshl_add_u32 v18, v60, 11, v18
    v_bfe_u32 v60, v0, 2, 1
    v_mul_u32_u24 v60, 384, v60
    v_add_u32 v18, v60, v18
    v_and_b32 v60, 3, v0
    v_lshl_add_u32 v18, v60, 3, v18
    v_add_u32 v18, s57, v18
    v_add_u32 v18, 30720, v18
    v_bfe_u32 v19, v0, 4, 1
    v_lshlrev_b32 v19, 12, v19
    v_bfe_u32 v60, v0, 3, 1
    v_lshl_add_u32 v19, v60, 11, v19
    v_bfe_u32 v60, v0, 2, 1
    v_mul_u32_u24 v60, 384, v60
    v_add_u32 v19, v60, v19
    v_and_b32 v60, 3, v0
    v_lshl_add_u32 v19, v60, 3, v19
    v_add_u32 v19, s57, v19
    v_add_u32 v19, 63488, v19
    ds_read_b64_tr_b16 v[28:29], v18 offset:0
    ds_read_b64_tr_b16 v[30:31], v18 offset:1024
    ds_read_b64_tr_b16 v[32:33], v18 offset:16384
    ds_read_b64_tr_b16 v[34:35], v18 offset:17408
    ds_read_b64_tr_b16 v[36:37], v19 offset:0
    ds_read_b64_tr_b16 v[38:39], v19 offset:1024
    ds_read_b64_tr_b16 v[40:41], v18 offset:32
    ds_read_b64_tr_b16 v[42:43], v18 offset:1056
    ds_read_b64_tr_b16 v[44:45], v18 offset:16416
    ds_read_b64_tr_b16 v[46:47], v18 offset:17440
    ds_read_b64_tr_b16 v[48:49], v19 offset:32
    ds_read_b64_tr_b16 v[50:51], v19 offset:1056
    v_lshrrev_b32 v9, 4, v0
    v_lshlrev_b32 v9, 5, v9
    v_bfe_u32 v60, v0, 1, 1
    v_lshl_add_u32 v9, v60, 4, v9
    v_and_b32 v60, 1, v0
    v_mul_u32_u24 v60, 192, v60
    v_add_u32 v9, v60, v9
    v_add_u32 v9, 160832, v9
    v_lshrrev_b32 v10, 4, v0
    v_lshlrev_b32 v10, 4, v10
    v_bfe_u32 v60, v0, 1, 1
    v_lshl_add_u32 v10, v60, 3, v10
    v_and_b32 v60, 1, v0
    v_mul_u32_u24 v60, 192, v60
    v_add_u32 v10, v60, v10
    v_add_u32 v10, 160960, v10
    v_mov_b64 v[20:21], 0
    v_mov_b64 v[22:23], 0
    v_mov_b64 v[24:25], 0
    v_mov_b64 v[26:27], 0
    s_lshr_b32 s57, s30, 1
    s_lshl_b32 s57, s57, 11
    s_lshl_b32 s58, s58, 1
    s_add_u32 s57, s57, s58
    s_lshl_b32 s58, s54, 8
    s_add_u32 s57, s57, s58
    v_and_b32 v11, 31, v0
    v_lshlrev_b32 v11, 2, v11
    v_lshrrev_b32 v60, 5, v0
L_pad14:
    s_cbranch_execz L_pad18
    v_lshl_add_u32 v11, v60, 30, v11
    v_add_u32 v11, s57, v11
    s_add_u32 s59, s62, 39936
    s_add_u32 s60, s62, 25984
L_skip_219:
    s_cmp_lt_u32 s30, 6
    s_barrier
    s_cbranch_scc0 L_se_218
    ds_read_b128 v[12:15], v9
    ds_read_b64 v[16:17], v10
    s_waitcnt lgkmcnt(1)
    v_smfmac_f32_16x16x64_bf16 v[20:23], v[12:15], v[28:35], v1
    v_smfmac_f32_16x16x64_bf16 v[24:27], v[12:15], v[40:47], v1
    s_waitcnt lgkmcnt(0)
    v_smfmac_f32_16x16x32_bf16 v[20:23], v[16:17], v[36:39], v1
    v_smfmac_f32_16x16x32_bf16 v[24:27], v[16:17], v[48:51], v1
    s_cmp_eq_u32 s55, 0
    s_nop 5
    v_add_f32 v12, v20, v22
    s_nop 1
    v_add_f32_dpp v12, v24, v26 quad_perm:[0,1,2,3] row_mask:0x2 bank_mask:0xf
    s_cbranch_scc1 L_gs_220
    buffer_store_dword v12, v11, s[40:43], s59 offen
L_gb_221:
L_se_218:
    s_cmp_eq_u32 s30, 7
    s_cbranch_scc0 L_done
    s_cmp_eq_u32 s31, 0
    s_cbranch_scc0 L_done
    v_lshlrev_b32 v60, 16, v4
    v_add_f32 v2, v2, v60
    v_and_b32 v60, 0xffff0000, v4
    v_add_f32 v3, v3, v60
    v_and_b32 v60, 31, v0
    v_min_u32 v60, 19, v60
    s_mul_i32 s57, s54, 160
    v_lshrrev_b32 v7, 5, v0
    v_lshlrev_b32 v7, 2, v7
    v_add_u32 v7, s57, v7
    v_lshl_add_u32 v7, v60, 3, v7
    s_add_u32 s57, s7, 198144
    s_add_u32 s58, s7, 214528
    s_add_u32 s59, s7, 230912
    s_add_u32 s60, s7, 247296
    v_mov_b64 v[36:37], 0
    v_mov_b64 v[38:39], 0
    s_nop 0
    v_mov_b32_dpp v36, v2 quad_perm:[0,1,2,3] row_mask:0x3 bank_mask:0xf
    v_mov_b32_dpp v37, v3 quad_perm:[0,1,2,3] row_mask:0x3 bank_mask:0xf
    v_mov_b32_dpp v38, v2 quad_perm:[0,1,2,3] row_mask:0xc bank_mask:0xf
    v_mov_b32_dpp v39, v3 quad_perm:[0,1,2,3] row_mask:0xc bank_mask:0xf
    s_add_u32 s75, s7, 266252
    v_and_b32 v9, 7, v0
    v_lshlrev_b32 v9, 9, v9
L_pr_233:
    buffer_load_dword v12, v9, s[40:43], s75 offen sc1
    s_sub_u32 s56, s56, 1
    s_cbranch_scc1 L_done
L_pw_232:
    s_waitcnt vmcnt(0)
    v_cmp_eq_u32 vcc, -1, v12
    s_cbranch_vccnz L_pr_233
L_gw_229:
    buffer_load_dwordx4 v[12:15], v5, s[40:43], s57 offen sc1
    buffer_load_dwordx4 v[16:19], v5, s[40:43], s58 offen sc1
    buffer_load_dwordx4 v[20:23], v5, s[40:43], s59 offen sc1
    buffer_load_dwordx4 v[24:27], v5, s[40:43], s60 offen sc1
    s_sub_u32 s56, s56, 1
    s_cbranch_scc1 L_done
    s_and_b32 s74, s56, 31
    s_waitcnt vmcnt(3)
    v_pk_add_f32 v[28:29], v[12:13], v[36:37]
    v_pk_add_f32 v[30:31], v[14:15], v[38:39]
    s_waitcnt vmcnt(2)
    v_pk_add_f32 v[28:29], v[28:29], v[16:17]
    v_pk_add_f32 v[30:31], v[30:31], v[18:19]
    s_waitcnt vmcnt(1)
    v_pk_add_f32 v[28:29], v[28:29], v[20:21]
    v_pk_add_f32 v[30:31], v[30:31], v[22:23]
    s_waitcnt vmcnt(0)
    v_pk_add_f32 v[28:29], v[28:29], v[24:25]
    v_pk_add_f32 v[30:31], v[30:31], v[26:27]
    v_pk_add_f32 v[32:33], v[28:29], v[30:31]
    v_cmp_u_f32 vcc, v32, v33
    v_permlane32_swap_b32 v28, v30
    v_permlane32_swap_b32 v29, v31
    s_cbranch_vccnz L_gr_230
L_gk_231:
    v_pk_add_f32 v[28:29], v[28:29], v[30:31]
    v_cvt_pk_bf16_f32 v28, v28, v29
    global_store_dword v7, v28, s[24:25]
    s_branch L_done
.p2align 5
L_gs_34:
L_pad15:
    s_cbranch_execz L_pad19
    buffer_store_dword v33, v34, s[40:43], s67 offen sc1
    s_branch L_gb_35
.p2align 5
L_gs_37:
    buffer_store_dword v12, v54, s[40:43], s59 offen sc1
    s_branch L_gb_38
.p2align 5
L_cr_49:
    s_sub_u32 s56, s56, 1
    s_cbranch_scc1 L_done
    global_load_dword v2, v3, s[26:27] sc1
    s_waitcnt vmcnt(0)
    s_branch L_cw_48
.p2align 5
L_far_50:
    s_lshl_b32 s57, s52, 2
    s_add_u32 s57, s57, s72
    s_mov_b64 exec, 1
    buffer_store_dword v25, v0, s[40:43], s57 offen offset:128 sc1
    s_mov_b64 exec, -1
    s_branch L_fb_51
.p2align 5
L_cr_63:
    s_sub_u32 s56, s56, 1
    s_cbranch_scc1 L_done
    buffer_load_dword v2, v24, s[40:43], s72 offen sc1
    s_branch L_cw_62
.p2align 5
L_gs_70:
    buffer_store_dword v33, v34, s[40:43], s67 offen sc1
    s_branch L_gb_71
.p2align 5
L_gs_73:
    buffer_store_dword v12, v54, s[40:43], s59 offen sc1
    s_branch L_gb_74
.p2align 5
L_gs_91:
    buffer_store_dword v37, v4, s[40:43], s58 offen sc1
    s_branch L_gb_92
.p2align 5
L_cr_105:
    s_sub_u32 s56, s56, 1
    s_cbranch_scc1 L_done
    global_load_dword v2, v3, s[26:27] offset:4 sc1
    s_branch L_cw_104
.p2align 5
L_cr_115:
    buffer_load_dword v52, v56, s[40:43], s74 offen offset:1536 sc1
    buffer_load_dwordx2 v[54:55], v62, s[40:43], s74 offen offset:1536 sc1
    s_sub_u32 s56, s56, 1
    s_cbranch_scc1 L_done
    s_branch L_cw_114
.p2align 5
L_gs_120:
    buffer_store_dword v14, v3, s[40:43], s57 offen sc1
    s_branch L_gb_121
.p2align 5
L_gs_122:
    buffer_store_dword v12, v4, s[40:43], s57 offen offset:32 sc1
    s_branch L_gb_123
.p2align 5
L_comb_0:
    s_mov_b32 s57, 0
    s_cmp_eq_u32 s55, 0
    s_waitcnt lgkmcnt(0)
    s_barrier
    ds_read2st64_b64 v[12:15], v2 offset0:0 offset1:4
    ds_read2st64_b64 v[16:19], v2 offset0:8 offset1:12
    ds_read2st64_b64 v[20:23], v2 offset0:16 offset1:20
    ds_read2st64_b64 v[24:27], v2 offset0:24 offset1:28
    s_waitcnt lgkmcnt(2)
    v_pk_add_f32 v[12:13], v[12:13], v[14:15]
    v_pk_add_f32 v[16:17], v[16:17], v[18:19]
    v_pk_add_f32 v[12:13], v[12:13], v[16:17]
    s_waitcnt lgkmcnt(0)
    v_pk_add_f32 v[20:21], v[20:21], v[22:23]
    v_pk_add_f32 v[24:25], v[24:25], v[26:27]
    v_pk_add_f32 v[12:13], v[12:13], v[20:21]
    v_pk_add_f32 v[12:13], v[12:13], v[24:25]
    v_cvt_pk_bf16_f32 v14, v12, v13
    v_min_u32 v14, -2, v14
    s_cbranch_scc1 L_gs_120
L_pad16:
    s_cbranch_execz L_pad20
    buffer_store_dword v14, v3, s[40:43], s57 offen
L_gb_121:
    s_cbranch_scc1 L_gs_122
    buffer_store_dword v12, v4, s[40:43], s57 offen offset:32
L_gb_123:
    s_branch L_comb_0b
.p2align 5
L_sr_132:
    buffer_load_dwordx4 v[52:55], v11, s[40:43], s65 offen offset:0 sc1
    buffer_load_dwordx4 v[56:59], v11, s[40:43], s65 offen offset:1024 sc1
    s_sub_u32 s56, s56, 1
    s_cbranch_scc1 L_done
    s_waitcnt vmcnt(0)
    s_branch L_sw_131
L_hr_133:
    buffer_load_dwordx4 v[12:15], v11, s[40:43], s58 offen offset:0 sc1
    buffer_load_dwordx4 v[16:19], v11, s[40:43], s58 offen offset:1024 sc1
    s_sub_u32 s56, s56, 1
    s_cbranch_scc1 L_done
    s_and_b32 s64, s56, 31
    s_cbranch_scc0 L_hx_135
    s_waitcnt vmcnt(2)
    v_pk_add_f32 v[20:21], v[12:13], v[16:17]
    v_pk_add_f32 v[22:23], v[14:15], v[18:19]
    s_nop 1
    v_permlane32_swap_b32 v20, v22
    v_permlane32_swap_b32 v21, v23
    v_pk_add_f32 v[20:21], v[20:21], v[22:23]
    s_nop 1
    v_permlane16_swap_b32 v20, v21
    v_add_f32 v20, v20, v21
    v_cmp_u_f32 vcc, v20, v20
    v_sub_f32 v20, v20, v26
    s_cbranch_vccnz L_hr_133
    s_branch L_hk_134
.p2align 5
L_hx_135:
    s_waitcnt vmcnt(0)
    v_max3_u32 v20, v12, v13, v14
    v_max3_u32 v20, v20, v15, v16
    v_max3_u32 v20, v20, v17, v18
    v_max_u32 v20, v20, v19
    v_cmp_eq_u32 vcc, -1, v20
    s_cbranch_vccnz L_hr_133
    v_pk_add_f32 v[20:21], v[12:13], v[16:17]
    v_pk_add_f32 v[22:23], v[14:15], v[18:19]
    s_nop 1
    v_permlane32_swap_b32 v20, v22
    v_permlane32_swap_b32 v21, v23
    v_pk_add_f32 v[20:21], v[20:21], v[22:23]
    s_nop 1
    v_permlane16_swap_b32 v20, v21
    v_add_f32 v20, v20, v21
    v_sub_f32 v20, v20, v26
    s_branch L_hk_134
L_gs_143:
    buffer_store_dword v0, v11, s[40:43], s58 offen sc1
    s_branch L_gb_144
.p2align 5
L_typeC_139:
    s_cmp_eq_u32 s30, 6
    s_cbranch_scc0 L_p1
    s_bitcmp1_b32 s3, 0
    s_cbranch_scc0 L_skip_140
    v_and_b32 v11, 3, v0
    v_lshlrev_b32 v11, 7, v11
    v_lshrrev_b32 v60, 2, v0
    v_lshl_add_u32 v11, v60, 24, v11
    s_add_u32 s58, s62, 26116
    s_add_u32 s75, s7, 266244
    v_and_b32 v9, 7, v0
    v_lshlrev_b32 v9, 9, v9
L_pr_142:
    buffer_load_dword v12, v9, s[40:43], s75 offen sc1
    s_sub_u32 s56, s56, 1
    s_cbranch_scc1 L_done
L_pw_141:
    s_waitcnt vmcnt(0)
    v_cmp_eq_u32 vcc, -1, v12
    s_cbranch_vccnz L_pr_142
    s_cmp_eq_u32 s55, 0
    s_cbranch_scc1 L_gs_143
    buffer_store_dword v0, v11, s[40:43], s58 offen
L_gb_144:
    s_waitcnt vmcnt(1)
    s_branch L_p1
.p2align 5
L_skip_140:
    s_lshl_b32 s59, s31, 9
    s_add_u32 s59, s59, s8
    s_add_u32 s59, s59, 266240
    v_and_b32 v10, 1, v0
    v_lshlrev_b32 v10, 13, v10
    v_lshrrev_b32 v60, 1, v0
    v_lshl_add_u32 v10, v60, 24, v10
    s_cmp_eq_u32 s3, 20
    s_cbranch_scc0 L_skip_145
    s_add_u32 s58, s62, 1568
    v_lshrrev_b32 v9, 3, v0
    v_mul_u32_u24 v9, 1664, v9
L_pad17:
    s_cbranch_execz L_pad21
    v_and_b32 v60, 7, v0
    v_lshl_add_u32 v9, v60, 2, v9
L_pr_147:
    buffer_load_dword v12, v9, s[40:43], s58 offen sc1
    s_sub_u32 s56, s56, 1
    s_cbranch_scc1 L_done
L_pw_146:
    s_waitcnt vmcnt(0)
    v_cmp_eq_u32 vcc, -1, v12
    s_cbranch_vccnz L_pr_147
    buffer_store_dword v0, v10, s[40:43], s59 offen offset:0 sc1
L_skip_145:
    s_add_u32 s58, s62, 25856
    v_and_b32 v9, 15, v0
    v_lshlrev_b32 v9, 2, v9
L_pr_149:
    buffer_load_dword v13, v9, s[40:43], s58 offen sc1
    s_sub_u32 s56, s56, 1
    s_cbranch_scc1 L_done
L_pw_148:
    s_waitcnt vmcnt(0)
    v_cmp_eq_u32 vcc, -1, v13
    s_cbranch_vccnz L_pr_149
    buffer_store_dword v0, v10, s[40:43], s59 offen offset:4 sc1
    s_waitcnt vmcnt(1)
    s_branch L_p1
.p2align 5
L_gs_153:
    buffer_store_dword v12, v11, s[40:43], s60 offen sc1
    s_branch L_gb_154
.p2align 5
L_gs_155:
    buffer_store_dword v12, v11, s[40:43], s59 offen sc1
    s_branch L_gb_156
.p2align 5
L_gr_158:
    s_cbranch_scc1 L_gw_157
    s_waitcnt vmcnt(0)
    v_max3_u32 v32, v12, v13, v14
    v_max3_u32 v32, v32, v15, v16
    v_max3_u32 v32, v32, v17, v18
    v_max3_u32 v32, v32, v19, v20
    v_max3_u32 v32, v32, v21, v22
    v_max3_u32 v32, v32, v23, v24
    v_max3_u32 v32, v32, v25, v26
    v_max_u32 v32, v32, v27
    v_cmp_eq_u32 vcc, -1, v32
    s_cbranch_vccnz L_gw_157
    v_pk_add_f32 v[28:29], v[12:13], v[36:37]
    v_pk_add_f32 v[30:31], v[14:15], v[38:39]
    v_pk_add_f32 v[28:29], v[28:29], v[16:17]
    v_pk_add_f32 v[30:31], v[30:31], v[18:19]
    v_pk_add_f32 v[28:29], v[28:29], v[20:21]
    v_pk_add_f32 v[30:31], v[30:31], v[22:23]
    v_pk_add_f32 v[28:29], v[28:29], v[24:25]
    v_pk_add_f32 v[30:31], v[30:31], v[26:27]
    s_nop 1
    v_permlane32_swap_b32 v28, v30
    v_permlane32_swap_b32 v29, v31
    s_branch L_gk_159
.p2align 5
L_gs_162:
    buffer_store_dword v33, v34, s[40:43], s67 offen sc1
    s_branch L_gb_163
.p2align 5
L_w7_150:
    v_and_b32 v60, 31, v0
    v_min_u32 v60, 19, v60
    s_mul_i32 s57, s54, 320
    v_lshrrev_b32 v5, 5, v0
    v_lshlrev_b32 v5, 12, v5
    v_add_u32 v5, s57, v5
    v_lshl_add_u32 v5, v60, 4, v5
    v_and_b32 v60, 31, v0
    v_cmp_gt_u32 s[64:65], 20, v60
    v_min_u32 v60, 19, v60
    v_lshrrev_b32 v35, 5, v0
    v_lshlrev_b32 v35, 2, v35
    v_add_u32 v35, 160832, v35
    v_lshl_add_u32 v35, v60, 3, v35
    s_add_u32 s66, s62, 13312
    s_add_u32 s67, s62, 25856
    s_lshl_b32 s57, s54, 3
    v_lshrrev_b32 v34, 5, v0
    v_lshlrev_b32 v34, 2, v34
    v_add_u32 v34, s57, v34
    v_and_b32 v60, 31, v0
    v_mov_b32 v61, 0x7f000000
    v_cmp_ne_u32 vcc, 31, v60
    s_nop 1
L_pad18:
    s_cbranch_execz L_pad22
    v_cndmask_b32 v34, v34, v61, vcc
    v_mov_b32 v61, 0x3f803f80
    s_add_u32 s57, s7, 0
    s_add_u32 s58, s7, 16384
    s_add_u32 s59, s7, 32768
    s_add_u32 s60, s7, 49152
    v_mov_b64 v[36:37], 0
    v_mov_b64 v[38:39], 0
    s_nop 0
    v_mov_b32_dpp v36, v2 quad_perm:[0,1,2,3] row_mask:0x3 bank_mask:0xf
    v_mov_b32_dpp v37, v3 quad_perm:[0,1,2,3] row_mask:0x3 bank_mask:0xf
    v_mov_b32_dpp v38, v2 quad_perm:[0,1,2,3] row_mask:0xc bank_mask:0xf
    v_mov_b32_dpp v39, v3 quad_perm:[0,1,2,3] row_mask:0xc bank_mask:0xf
    s_add_u32 s75, s7, 266240
    v_and_b32 v9, 7, v0
    v_lshlrev_b32 v9, 9, v9
L_pr_161:
    buffer_load_dword v12, v9, s[40:43], s75 offen sc1
    s_sub_u32 s56, s56, 1
    s_cbranch_scc1 L_done
L_pw_160:
    s_waitcnt vmcnt(0)
    v_cmp_eq_u32 vcc, -1, v12
    s_cbranch_vccnz L_pr_161
L_gw_157:
    buffer_load_dwordx4 v[12:15], v5, s[40:43], s57 offen sc1
    buffer_load_dwordx4 v[16:19], v5, s[40:43], s58 offen sc1
    buffer_load_dwordx4 v[20:23], v5, s[40:43], s59 offen sc1
    buffer_load_dwordx4 v[24:27], v5, s[40:43], s60 offen sc1
    s_sub_u32 s56, s56, 1
    s_cbranch_scc1 L_done
    s_and_b32 s74, s56, 31
    s_waitcnt vmcnt(3)
    v_pk_add_f32 v[28:29], v[12:13], v[36:37]
    v_pk_add_f32 v[30:31], v[14:15], v[38:39]
    s_waitcnt vmcnt(2)
    v_pk_add_f32 v[28:29], v[28:29], v[16:17]
    v_pk_add_f32 v[30:31], v[30:31], v[18:19]
    s_waitcnt vmcnt(1)
    v_pk_add_f32 v[28:29], v[28:29], v[20:21]
    v_pk_add_f32 v[30:31], v[30:31], v[22:23]
    s_waitcnt vmcnt(0)
    v_pk_add_f32 v[28:29], v[28:29], v[24:25]
    v_pk_add_f32 v[30:31], v[30:31], v[26:27]
    v_pk_add_f32 v[32:33], v[28:29], v[30:31]
    v_cmp_u_f32 vcc, v32, v33
    v_permlane32_swap_b32 v28, v30
    v_permlane32_swap_b32 v29, v31
    s_cbranch_vccnz L_gr_158
L_gk_159:
    v_pk_add_f32 v[28:29], v[28:29], v[30:31]
    v_cvt_pk_bf16_f32 v28, v28, v29
    ds_write_b32 v35, v28
    s_waitcnt lgkmcnt(0)
    s_barrier
    v_cndmask_b32 v29, 0, v28, s[64:65]
    v_dot2_f32_bf16 v33, v29, v61, 0
    v_dot2_f32_bf16 v32, v29, v29, 0
    v_lshlrev_b32 v2, 16, v28
    v_and_b32 v3, 0xffff0000, v28
    s_cmp_eq_u32 s55, 0
    v_permlane32_swap_b32 v33, v32
    v_add_f32 v33, v33, v32
    s_nop 1
    v_add_f32_dpp v33, v33, v33 row_ror:8 row_mask:0xf bank_mask:0xf
    s_nop 1
    v_add_f32_dpp v33, v33, v33 row_ror:4 row_mask:0xf bank_mask:0xf
    s_nop 1
    v_add_f32_dpp v33, v33, v33 row_ror:2 row_mask:0xf bank_mask:0xf
    s_nop 1
    v_add_f32_dpp v33, v33, v33 row_ror:1 row_mask:0xf bank_mask:0xf
    s_nop 1
    v_add_f32_dpp v33, v33, v33 row_bcast:15 row_mask:0xa bank_mask:0xf
    s_cbranch_scc1 L_gs_162
    buffer_store_dword v33, v34, s[40:43], s67 offen
L_gb_163:
    s_waitcnt vmcnt(1)
    s_branch L_se_151
.p2align 5
L_gs_167:
    buffer_store_dword v12, v11, s[40:43], s59 offen sc1
    s_branch L_gb_168
.p2align 5
L_gr_173:
    s_cbranch_scc1 L_gw_172
    s_waitcnt vmcnt(0)
    v_max3_u32 v32, v12, v13, v14
    v_max3_u32 v32, v32, v15, v16
    v_max3_u32 v32, v32, v17, v18
L_pad19:
    s_cbranch_execz L_pad23
    v_max3_u32 v32, v32, v19, v20
    v_max3_u32 v32, v32, v21, v22
    v_max3_u32 v32, v32, v23, v24
    v_max3_u32 v32, v32, v25, v26
    v_max_u32 v32, v32, v27
    v_cmp_eq_u32 vcc, -1, v32
    s_cbranch_vccnz L_gw_172
    v_pk_add_f32 v[28:29], v[12:13], v[36:37]
    v_pk_add_f32 v[30:31], v[14:15], v[38:39]
    v_pk_add_f32 v[28:29], v[28:29], v[16:17]
    v_pk_add_f32 v[30:31], v[30:31], v[18:19]
    v_pk_add_f32 v[28:29], v[28:29], v[20:21]
    v_pk_add_f32 v[30:31], v[30:31], v[22:23]
    v_pk_add_f32 v[28:29], v[28:29], v[24:25]
    v_pk_add_f32 v[30:31], v[30:31], v[26:27]
    s_nop 1
    v_permlane32_swap_b32 v28, v30
    v_permlane32_swap_b32 v29, v31
    s_branch L_gk_174
L_gr_176:
    s_cbranch_scc1 L_gw_175
    s_waitcnt vmcnt(0)
    v_max3_u32 v32, v12, v13, v14
    v_max3_u32 v32, v32, v15, v16
    v_max3_u32 v32, v32, v17, v18
    v_max3_u32 v32, v32, v19, v20
    v_max3_u32 v32, v32, v21, v22
    v_max3_u32 v32, v32, v23, v24
    v_max3_u32 v32, v32, v25, v26
    v_max_u32 v32, v32, v27
    v_cmp_eq_u32 vcc, -1, v32
    s_cbranch_vccnz L_gw_175
    v_pk_add_f32 v[28:29], v[12:13], v[36:37]
    v_pk_add_f32 v[30:31], v[14:15], v[38:39]
    v_pk_add_f32 v[28:29], v[28:29], v[16:17]
    v_pk_add_f32 v[30:31], v[30:31], v[18:19]
    v_pk_add_f32 v[28:29], v[28:29], v[20:21]
    v_pk_add_f32 v[30:31], v[30:31], v[22:23]
    v_pk_add_f32 v[28:29], v[28:29], v[24:25]
    v_pk_add_f32 v[30:31], v[30:31], v[26:27]
    s_nop 1
    v_permlane32_swap_b32 v28, v30
    v_permlane32_swap_b32 v29, v31
    s_branch L_gk_177
.p2align 5
L_gs_180:
    buffer_store_dword v33, v34, s[40:43], s67 offen sc1
    s_branch L_gb_181
.p2align 5
L_w7_164:
    v_and_b32 v60, 31, v0
    v_min_u32 v60, 19, v60
    s_mul_i32 s57, s54, 320
    v_lshrrev_b32 v5, 5, v0
    v_lshlrev_b32 v5, 12, v5
    v_add_u32 v5, s57, v5
    v_lshl_add_u32 v5, v60, 4, v5
    v_and_b32 v60, 31, v0
    v_cmp_gt_u32 s[64:65], 20, v60
    v_min_u32 v60, 19, v60
    v_lshrrev_b32 v35, 5, v0
    v_lshlrev_b32 v35, 2, v35
    v_add_u32 v35, 160832, v35
    v_lshl_add_u32 v35, v60, 3, v35
    s_mul_i32 s66, s53, 6144
    s_add_u32 s66, s66, s62
    s_add_u32 s66, s66, 46080
    s_lshl_b32 s67, s53, 6
    s_add_u32 s67, s67, s62
    s_add_u32 s67, s67, 25600
    s_lshl_b32 s57, s54, 3
    v_lshrrev_b32 v34, 5, v0
    v_lshlrev_b32 v34, 2, v34
    v_add_u32 v34, s57, v34
    v_and_b32 v60, 31, v0
    v_mov_b32 v61, 0x7f000000
    v_cmp_ne_u32 vcc, 31, v60
    s_nop 1
    v_cndmask_b32 v34, v34, v61, vcc
    v_mov_b32 v61, 0x3f803f80
    s_cmp_lg_u32 s53, 3
    s_cbranch_scc0 L_skip_169
    s_add_u32 s57, s62, 25856
    v_mov_b32 v9, 0
L_pr_171:
    buffer_load_dword v12, v9, s[40:43], s57 offen sc1
    s_sub_u32 s56, s56, 1
L_pad20:
    s_cbranch_execz L_pad24
    s_cbranch_scc1 L_done
L_pw_170:
    s_waitcnt vmcnt(0)
    v_cmp_eq_u32 vcc, -1, v12
    s_cbranch_vccnz L_pr_171
    s_add_u32 s57, s7, 0
    s_add_u32 s58, s7, 16384
    s_add_u32 s59, s7, 32768
    s_add_u32 s60, s7, 49152
    v_mov_b64 v[36:37], 0
    v_mov_b64 v[38:39], 0
    s_nop 0
    v_mov_b32_dpp v36, v2 quad_perm:[0,1,2,3] row_mask:0x3 bank_mask:0xf
    v_mov_b32_dpp v37, v3 quad_perm:[0,1,2,3] row_mask:0x3 bank_mask:0xf
    v_mov_b32_dpp v38, v2 quad_perm:[0,1,2,3] row_mask:0xc bank_mask:0xf
    v_mov_b32_dpp v39, v3 quad_perm:[0,1,2,3] row_mask:0xc bank_mask:0xf
L_gw_172:
    buffer_load_dwordx4 v[12:15], v5, s[40:43], s57 offen sc1
    buffer_load_dwordx4 v[16:19], v5, s[40:43], s58 offen sc1
    buffer_load_dwordx4 v[20:23], v5, s[40:43], s59 offen sc1
    buffer_load_dwordx4 v[24:27], v5, s[40:43], s60 offen sc1
    s_sub_u32 s56, s56, 1
    s_cbranch_scc1 L_done
    s_and_b32 s74, s56, 31
    s_waitcnt vmcnt(3)
    v_pk_add_f32 v[28:29], v[12:13], v[36:37]
    v_pk_add_f32 v[30:31], v[14:15], v[38:39]
    s_waitcnt vmcnt(2)
    v_pk_add_f32 v[28:29], v[28:29], v[16:17]
    v_pk_add_f32 v[30:31], v[30:31], v[18:19]
    s_waitcnt vmcnt(1)
    v_pk_add_f32 v[28:29], v[28:29], v[20:21]
    v_pk_add_f32 v[30:31], v[30:31], v[22:23]
    s_waitcnt vmcnt(0)
    v_pk_add_f32 v[28:29], v[28:29], v[24:25]
    v_pk_add_f32 v[30:31], v[30:31], v[26:27]
    v_pk_add_f32 v[32:33], v[28:29], v[30:31]
    v_cmp_u_f32 vcc, v32, v33
    v_permlane32_swap_b32 v28, v30
    v_permlane32_swap_b32 v29, v31
    s_cbranch_vccnz L_gr_173
L_gk_174:
    v_pk_add_f32 v[28:29], v[28:29], v[30:31]
    v_cvt_pk_bf16_f32 v28, v28, v29
    v_lshlrev_b32 v2, 16, v28
    v_and_b32 v3, 0xffff0000, v28
L_skip_169:
    v_lshlrev_b32 v60, 16, v4
    v_add_f32 v2, v2, v60
    v_and_b32 v60, 0xffff0000, v4
    v_add_f32 v3, v3, v60
    s_add_u32 s57, s7, 66048
    s_add_u32 s58, s7, 82432
    s_add_u32 s59, s7, 98816
    s_add_u32 s60, s7, 115200
    v_mov_b64 v[36:37], 0
    v_mov_b64 v[38:39], 0
    s_nop 0
    v_mov_b32_dpp v36, v2 quad_perm:[0,1,2,3] row_mask:0x3 bank_mask:0xf
    v_mov_b32_dpp v37, v3 quad_perm:[0,1,2,3] row_mask:0x3 bank_mask:0xf
    v_mov_b32_dpp v38, v2 quad_perm:[0,1,2,3] row_mask:0xc bank_mask:0xf
    v_mov_b32_dpp v39, v3 quad_perm:[0,1,2,3] row_mask:0xc bank_mask:0xf
    s_lshl_b32 s74, s53, 7
    s_add_u32 s75, s62, s74
    s_add_u32 s75, s75, 26116
    v_mov_b32 v9, 0
L_pr_179:
    buffer_load_dword v12, v9, s[40:43], s75 offen sc1
    s_sub_u32 s56, s56, 1
    s_cbranch_scc1 L_done
L_pw_178:
    s_waitcnt vmcnt(0)
    v_cmp_eq_u32 vcc, -1, v12
    s_cbranch_vccnz L_pr_179
L_gw_175:
    buffer_load_dwordx4 v[12:15], v5, s[40:43], s57 offen sc1
    buffer_load_dwordx4 v[16:19], v5, s[40:43], s58 offen sc1
    buffer_load_dwordx4 v[20:23], v5, s[40:43], s59 offen sc1
    buffer_load_dwordx4 v[24:27], v5, s[40:43], s60 offen sc1
    s_sub_u32 s56, s56, 1
    s_cbranch_scc1 L_done
    s_and_b32 s74, s56, 31
    s_waitcnt vmcnt(3)
    v_pk_add_f32 v[28:29], v[12:13], v[36:37]
    v_pk_add_f32 v[30:31], v[14:15], v[38:39]
    s_waitcnt vmcnt(2)
    v_pk_add_f32 v[28:29], v[28:29], v[16:17]
    v_pk_add_f32 v[30:31], v[30:31], v[18:19]
    s_waitcnt vmcnt(1)
    v_pk_add_f32 v[28:29], v[28:29], v[20:21]
    v_pk_add_f32 v[30:31], v[30:31], v[22:23]
L_pad21:
    s_cbranch_execz L_pad25
    s_waitcnt vmcnt(0)
    v_pk_add_f32 v[28:29], v[28:29], v[24:25]
    v_pk_add_f32 v[30:31], v[30:31], v[26:27]
    v_pk_add_f32 v[32:33], v[28:29], v[30:31]
    v_cmp_u_f32 vcc, v32, v33
    v_permlane32_swap_b32 v28, v30
    v_permlane32_swap_b32 v29, v31
    s_cbranch_vccnz L_gr_176
L_gk_177:
    v_pk_add_f32 v[28:29], v[28:29], v[30:31]
    v_cvt_pk_bf16_f32 v28, v28, v29
    ds_write_b32 v35, v28
    s_waitcnt lgkmcnt(0)
    s_barrier
    v_cndmask_b32 v29, 0, v28, s[64:65]
    v_dot2_f32_bf16 v33, v29, v61, 0
    v_dot2_f32_bf16 v32, v29, v29, 0
    v_lshlrev_b32 v2, 16, v28
    v_and_b32 v3, 0xffff0000, v28
    s_cmp_eq_u32 s55, 0
    v_permlane32_swap_b32 v33, v32
    v_add_f32 v33, v33, v32
    s_nop 1
    v_add_f32_dpp v33, v33, v33 row_ror:8 row_mask:0xf bank_mask:0xf
    s_nop 1
    v_add_f32_dpp v33, v33, v33 row_ror:4 row_mask:0xf bank_mask:0xf
    s_nop 1
    v_add_f32_dpp v33, v33, v33 row_ror:2 row_mask:0xf bank_mask:0xf
    s_nop 1
    v_add_f32_dpp v33, v33, v33 row_ror:1 row_mask:0xf bank_mask:0xf
    s_nop 1
    v_add_f32_dpp v33, v33, v33 row_bcast:15 row_mask:0xa bank_mask:0xf
    s_cbranch_scc1 L_gs_180
    buffer_store_dword v33, v34, s[40:43], s67 offen
L_gb_181:
    s_waitcnt vmcnt(1)
    s_branch L_se_165
.p2align 5
L_hr_186:
    buffer_load_dwordx4 v[40:43], v7, s[40:43], s59 offen offset:0 sc1
    buffer_load_dwordx4 v[44:47], v7, s[40:43], s59 offen offset:1024 sc1
    s_sub_u32 s56, s56, 1
    s_cbranch_scc1 L_done
    s_and_b32 s64, s56, 31
    s_cbranch_scc0 L_hx_188
    s_waitcnt vmcnt(2)
    v_pk_add_f32 v[20:21], v[40:41], v[44:45]
    v_pk_add_f32 v[22:23], v[42:43], v[46:47]
    s_nop 1
    v_permlane32_swap_b32 v20, v22
    v_permlane32_swap_b32 v21, v23
    v_pk_add_f32 v[20:21], v[20:21], v[22:23]
    s_nop 1
    v_permlane16_swap_b32 v20, v21
    v_add_f32 v20, v20, v21
    v_cmp_u_f32 vcc, v20, v20
    v_sub_f32 v20, v20, v50
    s_cbranch_vccnz L_hr_186
    s_branch L_hk_187
.p2align 5
L_hx_188:
    s_waitcnt vmcnt(0)
    v_max3_u32 v20, v40, v41, v42
    v_max3_u32 v20, v20, v43, v44
    v_max3_u32 v20, v20, v45, v46
    v_max_u32 v20, v20, v47
    v_cmp_eq_u32 vcc, -1, v20
    s_cbranch_vccnz L_hr_186
    v_pk_add_f32 v[20:21], v[40:41], v[44:45]
    v_pk_add_f32 v[22:23], v[42:43], v[46:47]
    s_nop 1
    v_permlane32_swap_b32 v20, v22
    v_permlane32_swap_b32 v21, v23
    v_pk_add_f32 v[20:21], v[20:21], v[22:23]
    s_nop 1
    v_permlane16_swap_b32 v20, v21
    v_add_f32 v20, v20, v21
    v_sub_f32 v20, v20, v50
    s_branch L_hk_187
L_qo_182:
    v_mov_b64 v[24:25], 0
    v_mov_b64 v[26:27], 0
    v_mov_b64 v[28:29], 0
    v_mov_b64 v[30:31], 0
    v_mov_b64 v[32:33], 0
    v_mov_b64 v[34:35], 0
    v_mov_b64 v[36:37], 0
    v_mov_b64 v[38:39], 0
    v_lshrrev_b32 v5, 4, v0
    v_lshlrev_b32 v5, 5, v5
    v_bfe_u32 v60, v0, 1, 1
    v_lshl_add_u32 v5, v60, 4, v5
    v_add_u32 v5, 124928, v5
L_pad22:
    s_cbranch_execz L_padback
    s_branch L_qb_183
.p2align 5
L_mr_189:
    ds_read_b32 v36, v62
    s_sub_u32 s56, s56, 1
    s_cbranch_scc1 L_done
    s_waitcnt lgkmcnt(0)
    v_cmp_eq_u32 vcc, -1, v36
    s_cbranch_vccnz L_mr_189
    v_max_f32_dpp v37, v36, v36 row_ror:4 row_mask:0xf bank_mask:0xf
    s_nop 1
    v_max_f32_dpp v37, v37, v37 row_ror:2 row_mask:0xf bank_mask:0xf
    s_nop 1
    v_max_f32_dpp v37, v37, v37 row_ror:1 row_mask:0xf bank_mask:0xf
    v_sub_f32 v39, v61, v37
    v_exp_f32 v39, v39
    s_branch L_mk_190
.p2align 5
L_gs_191:
    buffer_store_dword v37, v4, s[40:43], s58 offen sc1
    s_branch L_gb_192
.p2align 5
L_gs_193:
    buffer_store_dword v14, v3, s[40:43], s57 offen sc1
    s_branch L_gb_194
.p2align 5
L_gs_195:
    buffer_store_dword v12, v4, s[40:43], s57 offen offset:32 sc1
    s_branch L_gb_196
.p2align 5
L_comb_1:
    s_mov_b32 s58, 26624
    s_cmp_eq_u32 s55, 0
    s_cbranch_scc1 L_gs_191
    buffer_store_dword v37, v4, s[40:43], s58 offen
L_gb_192:
    s_mov_b32 s57, 26624
    s_cmp_eq_u32 s55, 0
    s_waitcnt lgkmcnt(0)
    s_barrier
    ds_read2st64_b64 v[12:15], v2 offset0:0 offset1:4
    ds_read2st64_b64 v[16:19], v2 offset0:8 offset1:12
    ds_read2st64_b64 v[20:23], v2 offset0:16 offset1:20
    ds_read2st64_b64 v[24:27], v2 offset0:24 offset1:28
    s_waitcnt lgkmcnt(2)
    v_pk_add_f32 v[12:13], v[12:13], v[14:15]
    v_pk_add_f32 v[16:17], v[16:17], v[18:19]
    v_pk_add_f32 v[12:13], v[12:13], v[16:17]
    s_waitcnt lgkmcnt(0)
    v_pk_add_f32 v[20:21], v[20:21], v[22:23]
    v_pk_add_f32 v[24:25], v[24:25], v[26:27]
    v_pk_add_f32 v[12:13], v[12:13], v[20:21]
    v_pk_add_f32 v[12:13], v[12:13], v[24:25]
    v_cvt_pk_bf16_f32 v14, v12, v13
    v_min_u32 v14, -2, v14
    s_cbranch_scc1 L_gs_193
    buffer_store_dword v14, v3, s[40:43], s57 offen
L_gb_194:
    s_cbranch_scc1 L_gs_195
    buffer_store_dword v12, v4, s[40:43], s57 offen offset:32
L_gb_196:
    s_branch L_comb_1b
.p2align 5
L_sr_206:
    buffer_load_dwordx4 v[52:55], v11, s[40:43], s65 offen offset:0 sc1
    buffer_load_dwordx4 v[56:59], v11, s[40:43], s65 offen offset:1024 sc1
    s_sub_u32 s56, s56, 1
    s_cbranch_scc1 L_done
    s_waitcnt vmcnt(0)
    s_branch L_sw_205
L_hr_207:
    buffer_load_dwordx4 v[12:15], v11, s[40:43], s58 offen offset:0 sc1
    buffer_load_dwordx4 v[16:19], v11, s[40:43], s58 offen offset:1024 sc1
    s_sub_u32 s56, s56, 1
    s_cbranch_scc1 L_done
    s_and_b32 s64, s56, 31
    s_cbranch_scc0 L_hx_209
    s_waitcnt vmcnt(2)
    v_pk_add_f32 v[20:21], v[12:13], v[16:17]
    v_pk_add_f32 v[22:23], v[14:15], v[18:19]
    s_nop 1
    v_permlane32_swap_b32 v20, v22
    v_permlane32_swap_b32 v21, v23
L_pad23:
    s_cbranch_execz L_padback
    v_pk_add_f32 v[20:21], v[20:21], v[22:23]
    s_nop 1
    v_permlane16_swap_b32 v20, v21
    v_add_f32 v20, v20, v21
    v_cmp_u_f32 vcc, v20, v20
    v_sub_f32 v20, v20, v26
    s_cbranch_vccnz L_hr_207
    s_branch L_hk_208
.p2align 5
L_hx_209:
    s_waitcnt vmcnt(0)
    v_max3_u32 v20, v12, v13, v14
    v_max3_u32 v20, v20, v15, v16
    v_max3_u32 v20, v20, v17, v18
    v_max_u32 v20, v20, v19
    v_cmp_eq_u32 vcc, -1, v20
    s_cbranch_vccnz L_hr_207
    v_pk_add_f32 v[20:21], v[12:13], v[16:17]
    v_pk_add_f32 v[22:23], v[14:15], v[18:19]
    s_nop 1
    v_permlane32_swap_b32 v20, v22
    v_permlane32_swap_b32 v21, v23
    v_pk_add_f32 v[20:21], v[20:21], v[22:23]
    s_nop 1
    v_permlane16_swap_b32 v20, v21
    v_add_f32 v20, v20, v21
    v_sub_f32 v20, v20, v26
    s_branch L_hk_208
L_typeC_212:
    s_cmp_eq_u32 s30, 6
    s_cbranch_scc0 L_done
    s_cmp_eq_u32 s3, 20
    s_cbranch_scc0 L_done
    s_lshl_b32 s59, s31, 9
    s_add_u32 s59, s59, s8
    s_add_u32 s59, s59, 266240
    v_and_b32 v10, 1, v0
    v_lshlrev_b32 v10, 13, v10
    v_lshrrev_b32 v60, 1, v0
    v_lshl_add_u32 v10, v60, 24, v10
    s_add_u32 s58, s62, 28192
    v_lshrrev_b32 v9, 3, v0
    v_mul_u32_u24 v9, 1664, v9
    v_and_b32 v60, 7, v0
    v_lshl_add_u32 v9, v60, 2, v9
L_pr_214:
    buffer_load_dword v12, v9, s[40:43], s58 offen sc1
    s_sub_u32 s56, s56, 1
    s_cbranch_scc1 L_done
L_pw_213:
    s_waitcnt vmcnt(0)
    v_cmp_eq_u32 vcc, -1, v12
    s_cbranch_vccnz L_pr_214
    buffer_store_dword v0, v10, s[40:43], s59 offen offset:8 sc1
    s_add_u32 s58, s62, 25984
    v_and_b32 v9, 15, v0
    v_lshlrev_b32 v9, 2, v9
L_pr_216:
    buffer_load_dword v13, v9, s[40:43], s58 offen sc1
    s_sub_u32 s56, s56, 1
    s_cbranch_scc1 L_done
L_pw_215:
    s_waitcnt vmcnt(0)
    v_cmp_eq_u32 vcc, -1, v13
    s_cbranch_vccnz L_pr_216
    buffer_store_dword v0, v10, s[40:43], s59 offen offset:12 sc1
    s_waitcnt vmcnt(1)
    s_branch L_done
.p2align 5
L_gs_220:
    buffer_store_dword v12, v11, s[40:43], s59 offen sc1
    s_branch L_gb_221
.p2align 5
L_gr_223:
    s_cbranch_scc1 L_gw_222
    s_waitcnt vmcnt(0)
    v_max3_u32 v32, v12, v13, v14
    v_max3_u32 v32, v32, v15, v16
    v_max3_u32 v32, v32, v17, v18
    v_max3_u32 v32, v32, v19, v20
    v_max3_u32 v32, v32, v21, v22
    v_max3_u32 v32, v32, v23, v24
    v_max3_u32 v32, v32, v25, v26
    v_max_u32 v32, v32, v27
    v_cmp_eq_u32 vcc, -1, v32
    s_cbranch_vccnz L_gw_222
    v_pk_add_f32 v[28:29], v[12:13], v[36:37]
    v_pk_add_f32 v[30:31], v[14:15], v[38:39]
    v_pk_add_f32 v[28:29], v[28:29], v[16:17]
    v_pk_add_f32 v[30:31], v[30:31], v[18:19]
    v_pk_add_f32 v[28:29], v[28:29], v[20:21]
    v_pk_add_f32 v[30:31], v[30:31], v[22:23]
    v_pk_add_f32 v[28:29], v[28:29], v[24:25]
L_pad24:
    s_cbranch_execz L_padback
    v_pk_add_f32 v[30:31], v[30:31], v[26:27]
    s_nop 1
    v_permlane32_swap_b32 v28, v30
    v_permlane32_swap_b32 v29, v31
    s_branch L_gk_224
L_gs_227:
    buffer_store_dword v33, v34, s[40:43], s67 offen sc1
    s_branch L_gb_228
.p2align 5
L_w7_217:
    v_and_b32 v60, 31, v0
    v_min_u32 v60, 19, v60
    s_mul_i32 s57, s54, 320
    v_lshrrev_b32 v5, 5, v0
    v_lshlrev_b32 v5, 12, v5
    v_add_u32 v5, s57, v5
    v_lshl_add_u32 v5, v60, 4, v5
    v_and_b32 v60, 31, v0
    v_cmp_gt_u32 s[64:65], 20, v60
    v_min_u32 v60, 19, v60
    v_lshrrev_b32 v35, 5, v0
    v_lshlrev_b32 v35, 2, v35
    v_add_u32 v35, 160832, v35
    v_lshl_add_u32 v35, v60, 3, v35
    s_add_u32 s66, s62, 39936
    s_add_u32 s67, s62, 25984
    s_lshl_b32 s57, s54, 3
    v_lshrrev_b32 v34, 5, v0
    v_lshlrev_b32 v34, 2, v34
    v_add_u32 v34, s57, v34
    v_and_b32 v60, 31, v0
    v_mov_b32 v61, 0x7f000000
    v_cmp_ne_u32 vcc, 31, v60
    s_nop 1
    v_cndmask_b32 v34, v34, v61, vcc
    v_mov_b32 v61, 0x3f803f80
    s_add_u32 s57, s7, 132096
    s_add_u32 s58, s7, 148480
    s_add_u32 s59, s7, 164864
    s_add_u32 s60, s7, 181248
    v_mov_b64 v[36:37], 0
    v_mov_b64 v[38:39], 0
    s_nop 0
    v_mov_b32_dpp v36, v2 quad_perm:[0,1,2,3] row_mask:0x3 bank_mask:0xf
    v_mov_b32_dpp v37, v3 quad_perm:[0,1,2,3] row_mask:0x3 bank_mask:0xf
    v_mov_b32_dpp v38, v2 quad_perm:[0,1,2,3] row_mask:0xc bank_mask:0xf
    v_mov_b32_dpp v39, v3 quad_perm:[0,1,2,3] row_mask:0xc bank_mask:0xf
    s_add_u32 s75, s7, 266248
    v_and_b32 v9, 7, v0
    v_lshlrev_b32 v9, 9, v9
L_pr_226:
    buffer_load_dword v12, v9, s[40:43], s75 offen sc1
    s_sub_u32 s56, s56, 1
    s_cbranch_scc1 L_done
L_pw_225:
    s_waitcnt vmcnt(0)
    v_cmp_eq_u32 vcc, -1, v12
    s_cbranch_vccnz L_pr_226
L_gw_222:
    buffer_load_dwordx4 v[12:15], v5, s[40:43], s57 offen sc1
    buffer_load_dwordx4 v[16:19], v5, s[40:43], s58 offen sc1
    buffer_load_dwordx4 v[20:23], v5, s[40:43], s59 offen sc1
    buffer_load_dwordx4 v[24:27], v5, s[40:43], s60 offen sc1
    s_sub_u32 s56, s56, 1
    s_cbranch_scc1 L_done
    s_and_b32 s74, s56, 31
    s_waitcnt vmcnt(3)
    v_pk_add_f32 v[28:29], v[12:13], v[36:37]
    v_pk_add_f32 v[30:31], v[14:15], v[38:39]
    s_waitcnt vmcnt(2)
    v_pk_add_f32 v[28:29], v[28:29], v[16:17]
    v_pk_add_f32 v[30:31], v[30:31], v[18:19]
    s_waitcnt vmcnt(1)
    v_pk_add_f32 v[28:29], v[28:29], v[20:21]
    v_pk_add_f32 v[30:31], v[30:31], v[22:23]
    s_waitcnt vmcnt(0)
    v_pk_add_f32 v[28:29], v[28:29], v[24:25]
    v_pk_add_f32 v[30:31], v[30:31], v[26:27]
    v_pk_add_f32 v[32:33], v[28:29], v[30:31]
    v_cmp_u_f32 vcc, v32, v33
    v_permlane32_swap_b32 v28, v30
    v_permlane32_swap_b32 v29, v31
    s_cbranch_vccnz L_gr_223
L_gk_224:
    v_pk_add_f32 v[28:29], v[28:29], v[30:31]
    v_cvt_pk_bf16_f32 v28, v28, v29
    ds_write_b32 v35, v28
    s_waitcnt lgkmcnt(0)
    s_barrier
    v_cndmask_b32 v29, 0, v28, s[64:65]
L_pad25:
    s_cbranch_execz L_padback
    v_dot2_f32_bf16 v33, v29, v61, 0
    v_dot2_f32_bf16 v32, v29, v29, 0
    v_lshlrev_b32 v2, 16, v28
    v_and_b32 v3, 0xffff0000, v28
    s_cmp_eq_u32 s55, 0
    v_permlane32_swap_b32 v33, v32
    v_add_f32 v33, v33, v32
    s_nop 1
    v_add_f32_dpp v33, v33, v33 row_ror:8 row_mask:0xf bank_mask:0xf
    s_nop 1
    v_add_f32_dpp v33, v33, v33 row_ror:4 row_mask:0xf bank_mask:0xf
    s_nop 1
    v_add_f32_dpp v33, v33, v33 row_ror:2 row_mask:0xf bank_mask:0xf
    s_nop 1
    v_add_f32_dpp v33, v33, v33 row_ror:1 row_mask:0xf bank_mask:0xf
    s_nop 1
    v_add_f32_dpp v33, v33, v33 row_bcast:15 row_mask:0xa bank_mask:0xf
    s_cbranch_scc1 L_gs_227
    buffer_store_dword v33, v34, s[40:43], s67 offen
L_gb_228:
    s_waitcnt vmcnt(1)
    s_branch L_se_218
.p2align 5
L_gr_230:
    s_cbranch_scc1 L_gw_229
    s_waitcnt vmcnt(0)
    v_max3_u32 v32, v12, v13, v14
    v_max3_u32 v32, v32, v15, v16
    v_max3_u32 v32, v32, v17, v18
    v_max3_u32 v32, v32, v19, v20
    v_max3_u32 v32, v32, v21, v22
    v_max3_u32 v32, v32, v23, v24
    v_max3_u32 v32, v32, v25, v26
    v_max_u32 v32, v32, v27
    v_cmp_eq_u32 vcc, -1, v32
    s_cbranch_vccnz L_gw_229
    v_pk_add_f32 v[28:29], v[12:13], v[36:37]
    v_pk_add_f32 v[30:31], v[14:15], v[38:39]
    v_pk_add_f32 v[28:29], v[28:29], v[16:17]
    v_pk_add_f32 v[30:31], v[30:31], v[18:19]
    v_pk_add_f32 v[28:29], v[28:29], v[20:21]
    v_pk_add_f32 v[30:31], v[30:31], v[22:23]
    v_pk_add_f32 v[28:29], v[28:29], v[24:25]
    v_pk_add_f32 v[30:31], v[30:31], v[26:27]
    s_nop 1
    v_permlane32_swap_b32 v28, v30
    v_permlane32_swap_b32 v29, v31
    s_branch L_gk_231
L_tail_end:
.p2align 5
L_spread:
    s_add_u32 s62, s62, 966656
    s_cmp_eq_u32 s30, 5
    s_cbranch_scc0 L_skip_67
    v_mov_b64 v[12:13], -1
    v_mov_b64 v[14:15], -1
    v_lshlrev_b32 v16, 4, v0
    s_mul_i32 s57, s52, 2208
    s_add_u32 s57, s57, s62
    s_mov_b64 exec, 0x3ff
    buffer_store_dwordx4 v[12:15], v16, s[40:43], s57 offen offset:2048 sc1
    s_mov_b64 exec, -1
    buffer_store_dwordx4 v[12:15], v16, s[40:43], s57 offen offset:0 sc1
    buffer_store_dwordx4 v[12:15], v16, s[40:43], s57 offen offset:1024 sc1
L_skip_67:
    s_cmp_eq_u32 s30, 7
    s_cbranch_scc0 L_skip_68
    v_and_b32 v60, 31, v0
    v_cmp_gt_u32 s[64:65], 20, v60
    v_min_u32 v60, 19, v60
    v_lshrrev_b32 v35, 5, v0
    v_lshlrev_b32 v35, 2, v35
    v_add_u32 v35, 160832, v35
    v_lshl_add_u32 v35, v60, 3, v35
    s_mul_i32 s66, s53, 12416
    s_add_u32 s66, s66, s62
    s_add_u32 s66, s66, 70656
    s_add_u32 s67, s66, 12288
    s_lshl_b32 s57, s54, 3
    v_lshrrev_b32 v34, 5, v0
    v_lshlrev_b32 v34, 2, v34
    v_add_u32 v34, s57, v34
    v_and_b32 v60, 31, v0
    v_mov_b32 v61, 0x7f000000
    v_cmp_ne_u32 vcc, 31, v60
    s_nop 1
    v_cndmask_b32 v34, v34, v61, vcc
    v_mov_b32 v61, 0x3f803f80
    v_cvt_pk_bf16_f32 v28, v2, v3
L_skip_68:
    s_cmp_eq_u32 s30, 7
    s_cbranch_scc0 L_skip_69
    v_cndmask_b32 v29, 0, v28, s[64:65]
    v_dot2_f32_bf16 v33, v29, v61, 0
    v_dot2_f32_bf16 v32, v29, v29, 0
    v_lshlrev_b32 v2, 16, v28
    v_and_b32 v3, 0xffff0000, v28
    s_cmp_eq_u32 s55, 0
    v_permlane32_swap_b32 v33, v32
    v_add_f32 v33, v33, v32
    s_nop 1
    v_add_f32_dpp v33, v33, v33 row_ror:8 row_mask:0xf bank_mask:0xf
    s_nop 1
    v_add_f32_dpp v33, v33, v33 row_ror:4 row_mask:0xf bank_mask:0xf
    s_nop 1
    v_add_f32_dpp v33, v33, v33 row_ror:2 row_mask:0xf bank_mask:0xf
    s_nop 1
    v_add_f32_dpp v33, v33, v33 row_ror:1 row_mask:0xf bank_mask:0xf
    s_nop 1
    v_add_f32_dpp v33, v33, v33 row_bcast:15 row_mask:0xa bank_mask:0xf
    s_cbranch_scc1 L_gs_70
    buffer_store_dword v33, v34, s[40:43], s67 offen
L_gb_71:
    s_waitcnt vmcnt(1)
L_skip_69:
    s_cmp_lt_u32 s30, 6
    s_cbranch_scc0 L_skip_72
    s_lshr_b32 s57, s30, 1
    s_mul_i32 s57, s57, 1024
    s_and_b32 s58, s30, 1
    s_lshl_b32 s58, s58, 6
    s_add_u32 s57, s57, s58
    v_lshrrev_b32 v18, 5, v0
    v_mul_u32_u24 v18, 6144, v18
    v_bfe_u32 v60, v0, 3, 1
    v_mul_u32_u24 v60, 3072, v60
    v_add_u32 v18, v60, v18
    v_bfe_u32 v60, v0, 4, 1
    v_lshl_add_u32 v18, v60, 9, v18
    v_bfe_u32 v60, v0, 2, 1
    v_lshl_add_u32 v18, v60, 7, v18
    v_and_b32 v60, 3, v0
    v_lshl_add_u32 v18, v60, 3, v18
    v_add_u32 v18, s57, v18
    v_bfe_u32 v19, v0, 4, 1
    v_mul_u32_u24 v19, 3072, v19
    v_bfe_u32 v60, v0, 3, 1
    v_lshl_add_u32 v19, v60, 9, v19
    v_bfe_u32 v60, v0, 2, 1
    v_lshl_add_u32 v19, v60, 7, v19
    v_and_b32 v60, 3, v0
    v_lshl_add_u32 v19, v60, 3, v19
    v_add_u32 v19, s57, v19
    v_add_u32 v19, 24576, v19
    ds_read_b64_tr_b16 v[28:29], v18 offset:0
    ds_read_b64_tr_b16 v[30:31], v18 offset:256
    ds_read_b64_tr_b16 v[32:33], v18 offset:12288
    ds_read_b64_tr_b16 v[34:35], v18 offset:12544
    ds_read_b64_tr_b16 v[36:37], v19 offset:0
    ds_read_b64_tr_b16 v[38:39], v19 offset:256
    ds_read_b64_tr_b16 v[40:41], v18 offset:32
    ds_read_b64_tr_b16 v[42:43], v18 offset:288
    ds_read_b64_tr_b16 v[44:45], v18 offset:12320
    ds_read_b64_tr_b16 v[46:47], v18 offset:12576
    ds_read_b64_tr_b16 v[48:49], v19 offset:32
    ds_read_b64_tr_b16 v[50:51], v19 offset:288
    v_lshrrev_b32 v52, 4, v0
    v_lshlrev_b32 v52, 5, v52
    v_bfe_u32 v60, v0, 1, 1
    v_lshl_add_u32 v52, v60, 4, v52
    v_and_b32 v60, 1, v0
    v_mul_u32_u24 v60, 192, v60
    v_add_u32 v52, v60, v52
    v_add_u32 v52, 160832, v52
    v_lshrrev_b32 v53, 4, v0
    v_lshlrev_b32 v53, 4, v53
    v_bfe_u32 v60, v0, 1, 1
    v_lshl_add_u32 v53, v60, 3, v53
    v_and_b32 v60, 1, v0
    v_mul_u32_u24 v60, 192, v60
    v_add_u32 v53, v60, v53
    v_add_u32 v53, 160960, v53
    v_mov_b64 v[20:21], 0
    v_mov_b64 v[22:23], 0
    v_mov_b64 v[24:25], 0
    v_mov_b64 v[26:27], 0
    s_lshr_b32 s57, s30, 1
    s_lshl_b32 s57, s57, 11
    s_lshl_b32 s58, s58, 1
    s_add_u32 s57, s57, s58
    s_lshl_b32 s58, s54, 8
    s_add_u32 s57, s57, s58
    v_and_b32 v54, 31, v0
    v_lshlrev_b32 v54, 2, v54
    v_lshrrev_b32 v60, 5, v0
    v_mul_u32_u24 v60, 6144, v60
    v_add_u32 v54, v60, v54
    v_add_u32 v54, s57, v54
    s_mul_i32 s59, s53, 12416
    s_add_u32 s59, s59, s62
    s_add_u32 s59, s59, 70656
    s_add_u32 s60, s59, 12288
    ds_read_b128 v[12:15], v52
    ds_read_b64 v[16:17], v53
    s_waitcnt lgkmcnt(1)
    v_smfmac_f32_16x16x64_bf16 v[20:23], v[12:15], v[28:35], v1
    v_smfmac_f32_16x16x64_bf16 v[24:27], v[12:15], v[40:47], v1
    s_waitcnt lgkmcnt(0)
    v_smfmac_f32_16x16x32_bf16 v[20:23], v[16:17], v[36:39], v1
    v_smfmac_f32_16x16x32_bf16 v[24:27], v[16:17], v[48:51], v1
    s_cmp_eq_u32 s55, 0
    s_nop 5
    v_add_f32 v12, v20, v22
    s_nop 1
    v_add_f32_dpp v12, v24, v26 quad_perm:[0,1,2,3] row_mask:0x2 bank_mask:0xf
    s_nop 1
    v_add_f32_dpp v12, v21, v23 quad_perm:[0,1,2,3] row_mask:0x4 bank_mask:0xf
    s_nop 1
    v_add_f32_dpp v12, v25, v27 quad_perm:[0,1,2,3] row_mask:0x8 bank_mask:0xf
    s_cbranch_scc1 L_gs_73
    buffer_store_dword v12, v54, s[40:43], s59 offen
L_gb_74:
L_skip_72:
    s_waitcnt vmcnt(0)
    s_barrier
    s_cmp_eq_u32 s30, 5
    s_cbranch_scc0 L_skip_75
    v_mov_b32 v25, 0
    s_lshl_b32 s57, s52, 2
    s_add_u32 s57, s57, s72
    s_mov_b64 exec, 1
    buffer_store_dword v25, v0, s[40:43], s57 offen offset:256 sc1
    s_mov_b64 exec, -1
    v_and_b32 v16, 31, v0
    v_lshlrev_b32 v16, 2, v16
L_pr_77:
    buffer_load_dword v17, v16, s[40:43], s72 offen offset:256 sc1
    s_sub_u32 s56, s56, 1
    s_cbranch_scc1 L_done
L_pw_76:
    s_waitcnt vmcnt(0)
    v_cmp_eq_u32 vcc, -1, v17
    s_cbranch_vccnz L_pr_77
L_skip_75:
    s_barrier
    s_branch L_spread_back
.p2align 5
L_done:
L_exit:
    s_endpgm
.section .rodata,"a"
.p2align 6
.amdhsa_kernel interleave_layers__sliding_block_cached__dense_activation_gelu__decode_kernel
  .amdhsa_next_free_vgpr 256
  .amdhsa_next_free_sgpr 102
  .amdhsa_accum_offset 256
  .amdhsa_group_segment_fixed_size 0
  .amdhsa_kernarg_size 104
  .amdhsa_user_sgpr_count 2
  .amdhsa_user_sgpr_kernarg_segment_ptr 1
  .amdhsa_system_sgpr_workgroup_id_x 1
  .amdhsa_float_denorm_mode_32 3
.end_amdhsa_kernel
```

```asm
; @launch grid=(256,1,1) block=(512,1,1) lds=161216
.amdgcn_target "amdgcn-amd-amdhsa--gfx950"
.text
.fill 64, 4, 0xbf800000
.globl interleave_layers__sliding_block_cached__dense_activation_gelu__decode_kernel
.p2align 8
.type interleave_layers__sliding_block_cached__dense_activation_gelu__decode_kernel,@function
interleave_layers__sliding_block_cached__dense_activation_gelu__decode_kernel:
    s_load_dwordx16 s[4:19], s[0:1], 0
    s_cmp_ge_u32 s2, 256
    s_cbranch_scc1 L_exit
    v_lshrrev_b32 v5, 6, v0
    v_lshlrev_b32 v62, 6, v0
    v_readfirstlane_b32 s30, v5
    v_and_b32 v0, 63, v0
    s_getpc_b64 s[74:75]
L_pc:
    v_min_u32 v62, L_exit-L_pc, v62
    global_load_dword v63, v62, s[74:75]
    s_cmp_eq_u32 s30, 6
    s_cbranch_scc0 L_skip_1
    s_setprio 3
L_skip_1:
    s_and_b32 s31, s2, 7
    s_lshr_b32 s52, s2, 3
    s_and_b32 s53, s52, 3
    s_lshr_b32 s54, s52, 2
    s_lshl_b32 s73, s31, 2
    s_add_u32 s73, s73, s53
    v_lshrrev_b32 v8, 5, v0
    v_lshlrev_b32 v8, 2, v8
    v_bfe_u32 v60, v0, 4, 1
    v_lshl_add_u32 v8, v60, 0, v8
    v_and_b32 v9, 7, v0
    v_xor_b32 v8, v8, v9
    v_lshrrev_b32 v10, 3, v0
    v_mul_u32_u24 v10, 384, v10
    v_lshl_add_u32 v5, v8, 4, v10
    v_xor_b32 v6, 32, v5
    s_mul_i32 s64, s73, 12582912
    s_mul_i32 s58, s54, 3072
    s_add_u32 s64, s64, s58
    s_add_u32 s64, s64, 11010048
    s_sub_u32 s34, 1572864, s58
    s_mov_b32 s35, 0x20000
    s_mov_b32 s57, 0
    s_mov_b32 s58, 195584
    s_mov_b32 m0, 92160
    s_cmp_eq_u32 s30, 6
    s_cselect_b64 vcc, -1, 0
    s_waitcnt lgkmcnt(0)
    s_add_u32 s32, s6, s64
    s_addc_u32 s33, s7, 0
    s_load_dwordx8 s[20:27], s[0:1], 64
    s_load_dwordx2 s[28:29], s[0:1], 96
    s_cbranch_vccz L_skip_3
L_dma_2:
    buffer_load_dwordx4 v5, s[32:35], s57 offen offset:0 nt lds
    buffer_load_dwordx4 v6, s[32:35], s58 offen offset:1024 nt lds
    s_add_u32 s57, s57, 24576
    s_add_u32 s58, s58, 24576
    s_add_u32 m0, m0, 2048
    s_cmp_lg_u32 m0, 108544
    s_cbranch_scc1 L_dma_2
    s_mov_b32 s57, 128
    s_mov_b32 s58, 195712
    s_mov_b32 m0, 108544
L_dma_4:
    s_nop 0
    buffer_load_dwordx4 v5, s[32:35], s57 offen offset:0 nt lds
    buffer_load_dwordx4 v6, s[32:35], s58 offen offset:1024 nt lds
    s_add_u32 s57, s57, 24576
    s_add_u32 s58, s58, 24576
    s_add_u32 m0, m0, 2048
    s_cmp_lg_u32 m0, 116736
    s_cbranch_scc1 L_dma_4
L_skip_3:
    s_mul_i32 s3, s54, 3
    s_add_u32 s3, s3, s53
    s_cmp_eq_u32 s53, 3
    s_cselect_b32 s3, 31, s3
    v_lshrrev_b32 v8, 4, v0
    v_lshlrev_b32 v8, 1, v8
    v_xor_b32 v8, v8, v9
    v_lshl_add_u32 v7, v8, 4, v10
    v_lshrrev_b32 v2, 3, v0
    v_mul_u32_u24 v2, 12288, v2
    v_and_b32 v60, 7, v0
    v_lshl_add_u32 v2, v60, 4, v2
    s_mul_i32 s59, s73, 384
    s_mul_i32 s60, s54, 983040
    s_add_u32 s59, s59, s60
    s_sub_u32 s60, 7866368, s59
    s_lshl_b32 s61, s30, 11
    s_add_u32 s61, s61, 92160
    s_mul_i32 s62, s31, 120832
    s_add_u32 s62, s62, 299008
    s_lshl_b32 s72, s31, 9
    s_add_u32 s72, s72, 294912
    s_mov_b32 s56, 65536
    s_mov_b32 s55, 1
    s_getreg_b32 s63, hwreg(20, 0, 3)
    v_mov_b32 v3, 0
    v_mov_b32 v4, 0
    v_mov_b32 v11, 0
    v_mov_b32 v24, 0
    v_mov_b32 v34, 0
    v_mov_b64 v[12:13], -1
    v_mov_b64 v[14:15], -1
    v_lshlrev_b32 v10, 4, v0
    s_waitcnt lgkmcnt(0)
    s_add_u32 s36, s8, s64
    s_addc_u32 s37, s9, 0
    s_mov_b32 s38, s34
    s_mov_b32 s39, 0x20000
    s_mov_b32 s40, s28
    s_mov_b32 s41, s29
    s_mov_b32 s42, 2232320
    s_mov_b32 s43, 0x20000
    s_add_u32 s44, s10, s59
    s_addc_u32 s45, s11, 0
    s_mov_b32 s46, s60
    s_mov_b32 s47, 0x20000
    s_sub_u32 s44, s44, 2048
    s_subb_u32 s45, s45, 0
    s_cmp_lt_u32 s3, 20
    s_cselect_b32 s57, 7864320, 0
    s_add_u32 s58, s54, 1
    s_mul_i32 s58, s58, 245760
    s_cmp_lg_u32 s53, 3
    s_cselect_b64 s[48:49], s[12:13], s[16:17]
    s_cselect_b32 s50, s57, s58
    s_mov_b32 s51, 0x20000
    s_add_u32 s57, s28, 0
    s_sub_u32 s57, 0, s57
    s_and_b32 s57, s57, 0x3fff
    s_add_u32 s57, s57, 0
    s_lshr_b32 s58, s31, 1
    s_lshl_b32 s58, s58, 14
    s_add_u32 s6, s57, s58
    s_and_b32 s58, s31, 1
    s_lshl_b32 s58, s58, 12
    s_add_u32 s6, s6, s58
    s_lshl_b32 s58, s3, 7
    s_add_u32 s6, s6, s58
    s_mov_b32 s8, s57
    s_and_b32 s59, s3, 3
    s_lshl_b32 s58, s31, 2
    s_add_u32 s59, s59, s58
    s_lshl_b32 s59, s59, 7
    s_add_u32 s59, s59, s57
    s_add_u32 s59, s59, 262144
    s_add_u32 s10, s28, s59
    s_addc_u32 s11, s29, 0
    s_lshr_b32 s58, s63, 2
    s_xor_b32 s58, s58, 0
    s_mul_i32 s58, s58, 8192
    s_add_u32 s7, s57, s58
    s_cmp_eq_u32 s30, 5
    s_cbranch_scc0 L_skip_5
    s_cmp_eq_u32 s52, 31
    s_cbranch_scc0 L_skip_6
    s_mov_b64 exec, 0xffffff
    buffer_store_dwordx4 v[12:15], v10, s[40:43], s72 offen sc1
    s_mov_b64 exec, -1
L_skip_6:
    s_cmp_lt_u32 s3, 20
    s_cbranch_scc0 L_skip_7
    v_and_b32 v16, 7, v0
    v_lshlrev_b32 v16, 4, v16
    v_bfe_u32 v17, v0, 3, 1
    v_lshl_add_u32 v16, v17, 13, v16
    v_lshrrev_b32 v17, 4, v0
    v_mul_u32_u24 v17, 66048, v17
    v_add_u32 v16, v17, v16
    buffer_store_dwordx4 v[12:15], v16, s[40:43], s6 offen sc1
L_skip_7:
    s_cmp_eq_u32 s3, 20
    s_cbranch_scc0 L_skip_8
    s_lshl_b32 s58, s31, 9
    s_add_u32 s58, s58, s8
    s_add_u32 s58, s58, 266240
    v_and_b32 v16, 7, v0
    v_lshlrev_b32 v16, 4, v16
    v_bfe_u32 v60, v0, 3, 1
    v_lshl_add_u32 v16, v60, 13, v16
    v_lshrrev_b32 v60, 4, v0
    v_lshl_add_u32 v16, v60, 28, v16
    buffer_store_dwordx4 v[12:15], v16, s[40:43], s58 offen sc1
L_skip_8:
    s_sub_u32 s58, s3, 20
    s_cmp_lt_u32 s58, 4
    s_cselect_b32 s59, s59, 0x7f000000
    v_and_b32 v16, 7, v0
    v_lshlrev_b32 v16, 4, v16
    v_bfe_u32 v60, v0, 3, 1
    v_lshl_add_u32 v16, v60, 13, v16
    v_lshrrev_b32 v60, 4, v0
    v_lshl_add_u32 v16, v60, 28, v16
    buffer_store_dwordx4 v[12:15], v16, s[40:43], s59 offen sc1
    s_mul_i32 s57, s52, 2208
    s_add_u32 s57, s57, s62
    s_mov_b64 exec, 0x3ff
    buffer_store_dwordx4 v[12:15], v10, s[40:43], s57 offen offset:2048
    s_mov_b64 exec, -1
    buffer_store_dwordx4 v[12:15], v10, s[40:43], s57 offen offset:0
    buffer_store_dwordx4 v[12:15], v10, s[40:43], s57 offen offset:1024
    s_mov_b64 exec, -1
    v_lshlrev_b32 v16, 4, v0
    v_add_u32 v16, 159744, v16
    ds_write_b128 v16, v[12:15]
    v_and_b32 v3, 7, v0
    v_lshlrev_b32 v3, 5, v3
L_skip_5:
    s_cmp_eq_u32 s30, 7
    s_cbranch_scc0 L_skip_9
    v_and_b32 v60, 31, v0
    v_min_u32 v60, 19, v60
    s_mul_i32 s57, s54, 160
    v_lshrrev_b32 v16, 5, v0
    v_lshlrev_b32 v16, 2, v16
    v_add_u32 v16, s57, v16
    v_lshl_add_u32 v16, v60, 3, v16
    global_load_dword v28, v16, s[4:5]
    global_load_dword v4, v16, s[22:23]
L_skip_9:
    s_sub_u32 s58, s30, 4
    s_cmp_lt_u32 s58, 3
    s_cbranch_scc0 L_skip_10
    s_mul_i32 s57, s31, 3
    s_add_u32 s57, s57, s58
    s_lshl_b32 s57, s57, 7
    v_and_b32 v16, 15, v0
    v_lshlrev_b32 v16, 3, v16
    v_lshrrev_b32 v60, 4, v0
    v_lshl_add_u32 v16, v60, 1, v16
    v_add_u32 v16, s57, v16
    global_load_short_d16_hi v4, v16, s[18:19]
L_skip_10:
    v_bfe_u32 v8, v0, 1, 3
    v_lshrrev_b32 v9, 4, v0
    v_xor_b32 v9, v8, v9
    v_bfe_u32 v8, v0, 2, 1
    v_lshlrev_b32 v8, 10, v8
    v_bfe_u32 v60, v0, 3, 1
    v_lshl_add_u32 v8, v60, 9, v8
    v_and_b32 v60, 3, v0
    v_lshl_add_u32 v8, v60, 7, v8
    v_add_u32 v8, s61, v8
    v_lshl_add_u32 v8, v9, 4, v8
    v_xor_b32 v9, 64, v8
    v_bfe_u32 v1, v0, 1, 1
    v_mul_u32_u24 v1, 43690, v1
    v_add_u32 v1, 17476, v1
    s_cmp_eq_u32 s30, 6
    s_cbranch_scc0 L_skip_11
    s_mov_b32 s57, 98432
    s_mov_b32 s58, 294016
    s_mov_b32 m0, 116736
L_dma_12:
    s_waitcnt vmcnt(22)
    buffer_load_dwordx4 v5, s[32:35], s57 offen offset:0 nt lds
    buffer_load_dwordx4 v6, s[32:35], s58 offen offset:1024 nt lds
    s_add_u32 s57, s57, 24576
    s_add_u32 s58, s58, 24576
    s_add_u32 m0, m0, 2048
    s_cmp_lg_u32 m0, 124928
    s_cbranch_scc1 L_dma_12
    s_mov_b32 s57, 2048
    s_mov_b32 s58, 1152
    s_mov_b32 s59, 256
    s_mov_b32 m0, 0
L_dma_13:
    s_waitcnt vmcnt(22)
    buffer_load_dwordx4 v2, s[44:47], s57 offen offset:0 nt lds
    buffer_load_dwordx4 v2, s[44:47], s58 offen offset:1024 nt lds
    buffer_load_dwordx4 v2, s[44:47], s59 offen offset:2048 nt lds
    s_add_u32 s57, s57, 98304
    s_add_u32 s58, s58, 98304
    s_add_u32 s59, s59, 98304
    s_add_u32 m0, m0, 3072
    s_cmp_lg_u32 m0, 15360
    s_cbranch_scc1 L_dma_13
L_skip_11:
    s_waitcnt vmcnt(31)
    s_barrier
    ds_read_b128 v[64:67], v8 offset:0
    ds_read_b128 v[68:71], v9 offset:0
    s_cmp_eq_u32 s30, 6
    s_cbranch_scc0 L_skip_14
    s_mov_b32 s57, 256
    s_mov_b32 s58, 195840
    s_mov_b32 m0, 124928
L_dma_15:
    s_waitcnt vmcnt(22)
    buffer_load_dwordx4 v5, s[32:35], s57 offen offset:0 nt lds
    buffer_load_dwordx4 v6, s[32:35], s58 offen offset:1024 nt lds
    s_add_u32 s57, s57, 24576
    s_add_u32 s58, s58, 24576
    s_add_u32 m0, m0, 2048
    s_cmp_lg_u32 m0, 141312
    s_cbranch_scc1 L_dma_15
L_skip_14:
    s_waitcnt lgkmcnt(0)
    s_cmp_eq_u32 s30, 5
    s_cbranch_scc0 L_skip_16
    s_cmp_eq_u32 s52, 31
    s_cbranch_scc0 L_skip_17
    s_lshl_b32 s57, s31, 5
    v_mov_b32 v16, s57
    s_add_u32 s57, s63, 1
    v_mov_b32 v12, s57
    s_waitcnt vmcnt(5)
    s_mov_b64 exec, 0x1
    global_store_dword v16, v12, s[26:27] sc1
    s_mov_b64 exec, -1
L_skip_17:
L_skip_16:
    s_waitcnt vmcnt(31)
    s_barrier
    ds_read_b128 v[72:75], v8 offset:16384
    ds_read_b128 v[76:79], v9 offset:16384
    s_cmp_eq_u32 s30, 6
    s_cbranch_scc0 L_skip_18
    s_mov_b32 s57, 493568
    s_mov_b32 s58, 492672
    s_mov_b32 s59, 491776
    s_mov_b32 m0, 15360
L_dma_19:
    s_waitcnt vmcnt(22)
    buffer_load_dwordx4 v2, s[44:47], s57 offen offset:0 nt lds
    buffer_load_dwordx4 v2, s[44:47], s58 offen offset:1024 nt lds
    buffer_load_dwordx4 v2, s[44:47], s59 offen offset:2048 nt lds
    s_add_u32 s57, s57, 98304
    s_add_u32 s58, s58, 98304
    s_add_u32 s59, s59, 98304
    s_add_u32 m0, m0, 3072
    s_cmp_lg_u32 m0, 30720
    s_cbranch_scc1 L_dma_19
    s_mov_b32 s57, 393216
    s_mov_b32 s58, 588800
    s_mov_b32 m0, 141312
L_dma_20:
    s_waitcnt vmcnt(22)
    buffer_load_dwordx4 v5, s[32:35], s57 offen offset:0 nt lds
    buffer_load_dwordx4 v6, s[32:35], s58 offen offset:1024 nt lds
    s_add_u32 s57, s57, 24576
    s_add_u32 s58, s58, 24576
    s_add_u32 m0, m0, 2048
    s_cmp_lg_u32 m0, 157696
    s_cbranch_scc1 L_dma_20
L_skip_18:
    s_waitcnt lgkmcnt(0)
    s_cmp_lt_u32 s30, 4
    s_cbranch_scc0 L_skip_21
    s_mov_b64 exec, 0
    s_cmp_eq_u32 s30, 1
    s_cbranch_scc1 L_pad1
    s_cmp_eq_u32 s30, 2
    s_cbranch_scc1 L_pad2
    s_cmp_eq_u32 s30, 3
    s_cbranch_scc1 L_pad3
    s_branch L_pad0
.p2align 5
L_padback:
    s_mov_b64 exec, -1
L_skip_21:
    s_waitcnt vmcnt(31)
    s_barrier
    ds_read_b128 v[80:83], v8 offset:32768
    ds_read_b128 v[84:87], v9 offset:32768
    s_cmp_eq_u32 s30, 6
    s_cbranch_scc0 L_skip_22
    s_cmp_lg_u32 s53, 3
    s_cbranch_scc0 L_wb_23
    s_mul_i32 s57, s31, 983040
    s_lshl_b32 s58, s3, 6
    s_add_u32 s57, s57, s58
    v_bfe_u32 v38, v0, 4, 1
    v_lshlrev_b32 v38, 1, v38
    v_xor_b32 v38, v38, v0
    v_and_b32 v38, 3, v38
    v_lshrrev_b32 v3, 5, v0
    v_mul_u32_u24 v3, 10240, v3
    v_bfe_u32 v39, v0, 4, 1
    v_mul_u32_u24 v39, 2560, v39
    v_add_u32 v3, v39, v3
    v_bfe_u32 v39, v0, 3, 1
    v_mul_u32_u24 v39, 5120, v39
    v_add_u32 v3, v39, v3
    v_bfe_u32 v39, v0, 2, 1
    v_mul_u32_u24 v39, 20480, v39
    v_add_u32 v3, v39, v3
    v_add_u32 v3, s57, v3
    v_lshl_add_u32 v3, v38, 4, v3
    s_mov_b32 s14, 40960
    s_mov_b32 s15, 256
    s_branch L_we_24
.p2align 5
L_wb_23:
    s_mul_i32 s57, s31, 384
    s_mul_i32 s58, s54, 245760
    s_add_u32 s57, s57, s58
    v_lshlrev_b32 v3, 4, v0
    v_add_u32 v3, s57, v3
    v_mov_b32 v38, 2688
    v_cmp_lt_u32 vcc, 23, v0
    s_nop 1
    v_cndmask_b32 v38, 0, v38, vcc
    v_add_u32 v3, v38, v3
    v_mov_b32 v38, 0x7f000000
    v_cmp_lt_u32 vcc, 47, v0
    s_nop 1
    v_cndmask_b32 v3, v3, v38, vcc
    s_mov_b32 s14, 12288
    s_mov_b32 s15, 5120
L_we_24:
    s_mul_i32 s57, s14, 0
    s_mov_b32 m0, 30720
    s_nop 0
    buffer_load_dwordx4 v3, s[48:51], s57 offen offset:0 nt lds
    s_mul_i32 s57, s14, 0
    s_add_u32 s57, s57, s15
    s_mov_b32 m0, 30720
    s_nop 0
    buffer_load_dwordx4 v3, s[48:51], s57 offen offset:1024 nt lds
    s_mov_b32 s57, 393344
    s_mov_b32 s58, 588928
    s_mov_b32 m0, 92160
L_dma_25:
    s_waitcnt vmcnt(22)
    buffer_load_dwordx4 v5, s[32:35], s57 offen offset:0 nt lds
    buffer_load_dwordx4 v6, s[32:35], s58 offen offset:1024 nt lds
    s_add_u32 s57, s57, 24576
    s_add_u32 s58, s58, 24576
    s_add_u32 m0, m0, 2048
    s_cmp_lg_u32 m0, 108544
    s_cbranch_scc1 L_dma_25
    s_mul_i32 s57, s14, 1
    s_mov_b32 m0, 32768
    s_nop 0
    buffer_load_dwordx4 v3, s[48:51], s57 offen offset:0 nt lds
    s_mul_i32 s57, s14, 1
    s_add_u32 s57, s57, s15
    s_mov_b32 m0, 32768
    s_nop 0
    buffer_load_dwordx4 v3, s[48:51], s57 offen offset:1024 nt lds
    s_mov_b32 s57, 393472
    s_mov_b32 s58, 589056
    s_mov_b32 m0, 108544
L_dma_26:
    s_waitcnt vmcnt(22)
    buffer_load_dwordx4 v5, s[32:35], s57 offen offset:0 nt lds
    buffer_load_dwordx4 v6, s[32:35], s58 offen offset:1024 nt lds
    s_add_u32 s57, s57, 24576
    s_add_u32 s58, s58, 24576
    s_add_u32 m0, m0, 2048
    s_cmp_lg_u32 m0, 124928
    s_cbranch_scc1 L_dma_26
L_skip_22:
    s_waitcnt lgkmcnt(0)
    s_cmp_lt_u32 s30, 5
    s_cbranch_scc0 L_skip_27
    s_waitcnt vmcnt(0)
L_skip_27:
    s_cmp_eq_u32 s30, 7
    s_cbranch_scc0 L_skip_28
    v_and_b32 v60, 31, v0
    v_cmp_gt_u32 s[64:65], 20, v60
    v_min_u32 v60, 19, v60
    v_lshrrev_b32 v35, 5, v0
    v_lshlrev_b32 v35, 2, v35
    v_add_u32 v35, 160832, v35
    v_lshl_add_u32 v35, v60, 3, v35
    s_mul_i32 s66, s53, 12416
    s_add_u32 s66, s66, s62
    s_add_u32 s66, s66, 70656
    s_add_u32 s67, s66, 12288
    s_lshl_b32 s57, s54, 3
    v_lshrrev_b32 v34, 5, v0
    v_lshlrev_b32 v34, 2, v34
    v_add_u32 v34, s57, v34
    v_and_b32 v60, 31, v0
    v_mov_b32 v61, 0x7f000000
    v_cmp_ne_u32 vcc, 31, v60
    s_nop 1
    v_cndmask_b32 v34, v34, v61, vcc
    v_mov_b32 v61, 0x3f803f80
    s_waitcnt vmcnt(0)
    ds_write_b32 v35, v28
    s_waitcnt lgkmcnt(0)
L_skip_28:
    s_cmp_eq_u32 s30, 5
    s_cbranch_scc0 L_skip_29
    s_waitcnt vmcnt(0)
    s_lshr_b32 s67, s63, 2
    s_sub_u32 s58, s3, 20
    s_cmp_lt_u32 s58, 4
    s_cbranch_scc0 L_skip_30
    s_mov_b32 s67, 0
    s_load_dword s66, s[10:11], 0
    s_load_dword s67, s[10:11], 8192
    s_waitcnt lgkmcnt(1)
L_skip_30:
    v_subrev_u32 v16, 8, v0
    v_cmp_gt_u32 vcc, 40, v16
    v_mov_b32 v16, 0x3f803f80
    s_nop 0
    v_cndmask_b32 v18, 0, v16, vcc
    v_min_u32 v16, 55, v0
    v_lshlrev_b32 v16, 2, v16
    v_add_u32 v16, 160992, v16
    ds_write_b32 v16, v18
    s_mov_b32 s65, s67
    s_waitcnt lgkmcnt(0)
L_skip_29:
    s_waitcnt vmcnt(36)
    s_barrier
    ds_read_b128 v[88:91], v8 offset:49152
    ds_read_b128 v[92:95], v9 offset:49152
    s_cmp_eq_u32 s30, 6
    s_cbranch_scc0 L_skip_31
    s_mul_i32 s57, s14, 2
    s_mov_b32 m0, 34816
    s_nop 0
    buffer_load_dwordx4 v3, s[48:51], s57 offen offset:0 nt lds
    s_mul_i32 s57, s14, 2
    s_add_u32 s57, s57, s15
    s_mov_b32 m0, 34816
    s_nop 0
    buffer_load_dwordx4 v3, s[48:51], s57 offen offset:1024 nt lds
    s_mov_b32 s57, 786432
    s_mov_b32 s58, 982016
    s_mov_b32 m0, 124928
L_dma_32:
    s_waitcnt vmcnt(22)
    buffer_load_dwordx4 v5, s[32:35], s57 offen offset:0 nt lds
    buffer_load_dwordx4 v6, s[32:35], s58 offen offset:1024 nt lds
    s_add_u32 s57, s57, 24576
    s_add_u32 s58, s58, 24576
    s_add_u32 m0, m0, 2048
    s_cmp_lg_u32 m0, 141312
    s_cbranch_scc1 L_dma_32
L_skip_31:
    s_waitcnt lgkmcnt(0)
    s_cmp_eq_u32 s30, 7
    s_cbranch_scc0 L_skip_33
    v_cndmask_b32 v29, 0, v28, s[64:65]
    v_dot2_f32_bf16 v33, v29, v61, 0
    v_dot2_f32_bf16 v32, v29, v29, 0
    v_lshlrev_b32 v2, 16, v28
    v_and_b32 v3, 0xffff0000, v28
    s_cmp_eq_u32 s55, 0
    v_permlane32_swap_b32 v33, v32
    v_add_f32 v33, v33, v32
    s_nop 1
    v_add_f32_dpp v33, v33, v33 row_ror:8 row_mask:0xf bank_mask:0xf
    s_nop 1
    v_add_f32_dpp v33, v33, v33 row_ror:4 row_mask:0xf bank_mask:0xf
    s_nop 1
    v_add_f32_dpp v33, v33, v33 row_ror:2 row_mask:0xf bank_mask:0xf
    s_nop 1
    v_add_f32_dpp v33, v33, v33 row_ror:1 row_mask:0xf bank_mask:0xf
    s_nop 1
    v_add_f32_dpp v33, v33, v33 row_bcast:15 row_mask:0xa bank_mask:0xf
    s_cbranch_scc1 L_gs_34
    buffer_store_dword v33, v34, s[40:43], s67 offen
L_gb_35:
    s_waitcnt vmcnt(1)
L_skip_33:
    s_cmp_lt_u32 s30, 6
    s_cbranch_scc0 L_skip_36
    s_lshr_b32 s57, s30, 1
    s_mul_i32 s57, s57, 1024
    s_and_b32 s58, s30, 1
    s_lshl_b32 s58, s58, 6
    s_add_u32 s57, s57, s58
    v_lshrrev_b32 v18, 5, v0
    v_mul_u32_u24 v18, 6144, v18
    v_bfe_u32 v60, v0, 3, 1
    v_mul_u32_u24 v60, 3072, v60
    v_add_u32 v18, v60, v18
    v_bfe_u32 v60, v0, 4, 1
    v_lshl_add_u32 v18, v60, 9, v18
    v_bfe_u32 v60, v0, 2, 1
    v_lshl_add_u32 v18, v60, 7, v18
    v_and_b32 v60, 3, v0
    v_lshl_add_u32 v18, v60, 3, v18
    v_add_u32 v18, s57, v18
    v_bfe_u32 v19, v0, 4, 1
    v_mul_u32_u24 v19, 3072, v19
    v_bfe_u32 v60, v0, 3, 1
    v_lshl_add_u32 v19, v60, 9, v19
    v_bfe_u32 v60, v0, 2, 1
    v_lshl_add_u32 v19, v60, 7, v19
    v_and_b32 v60, 3, v0
    v_lshl_add_u32 v19, v60, 3, v19
    v_add_u32 v19, s57, v19
    v_add_u32 v19, 24576, v19
    ds_read_b64_tr_b16 v[28:29], v18 offset:0
    ds_read_b64_tr_b16 v[30:31], v18 offset:256
    ds_read_b64_tr_b16 v[32:33], v18 offset:12288
    ds_read_b64_tr_b16 v[34:35], v18 offset:12544
    ds_read_b64_tr_b16 v[36:37], v19 offset:0
    ds_read_b64_tr_b16 v[38:39], v19 offset:256
    ds_read_b64_tr_b16 v[40:41], v18 offset:32
    ds_read_b64_tr_b16 v[42:43], v18 offset:288
    ds_read_b64_tr_b16 v[44:45], v18 offset:12320
    ds_read_b64_tr_b16 v[46:47], v18 offset:12576
    ds_read_b64_tr_b16 v[48:49], v19 offset:32
    ds_read_b64_tr_b16 v[50:51], v19 offset:288
    v_lshrrev_b32 v52, 4, v0
    v_lshlrev_b32 v52, 5, v52
    v_bfe_u32 v60, v0, 1, 1
    v_lshl_add_u32 v52, v60, 4, v52
    v_and_b32 v60, 1, v0
    v_mul_u32_u24 v60, 192, v60
    v_add_u32 v52, v60, v52
    v_add_u32 v52, 160832, v52
    v_lshrrev_b32 v53, 4, v0
    v_lshlrev_b32 v53, 4, v53
    v_bfe_u32 v60, v0, 1, 1
    v_lshl_add_u32 v53, v60, 3, v53
    v_and_b32 v60, 1, v0
    v_mul_u32_u24 v60, 192, v60
    v_add_u32 v53, v60, v53
    v_add_u32 v53, 160960, v53
    v_mov_b64 v[20:21], 0
    v_mov_b64 v[22:23], 0
    v_mov_b64 v[24:25], 0
    v_mov_b64 v[26:27], 0
    s_lshr_b32 s57, s30, 1
    s_lshl_b32 s57, s57, 11
    s_lshl_b32 s58, s58, 1
    s_add_u32 s57, s57, s58
    s_lshl_b32 s58, s54, 8
    s_add_u32 s57, s57, s58
    v_and_b32 v54, 31, v0
    v_lshlrev_b32 v54, 2, v54
    v_lshrrev_b32 v60, 5, v0
    v_mul_u32_u24 v60, 6144, v60
    v_add_u32 v54, v60, v54
    v_add_u32 v54, s57, v54
    s_mul_i32 s59, s53, 12416
    s_add_u32 s59, s59, s62
    s_add_u32 s59, s59, 70656
    s_add_u32 s60, s59, 12288
    ds_read_b128 v[12:15], v52
    ds_read_b64 v[16:17], v53
    s_waitcnt lgkmcnt(1)
    v_smfmac_f32_16x16x64_bf16 v[20:23], v[12:15], v[28:35], v1
    v_smfmac_f32_16x16x64_bf16 v[24:27], v[12:15], v[40:47], v1
    s_waitcnt lgkmcnt(0)
    v_smfmac_f32_16x16x32_bf16 v[20:23], v[16:17], v[36:39], v1
    v_smfmac_f32_16x16x32_bf16 v[24:27], v[16:17], v[48:51], v1
    s_cmp_eq_u32 s55, 0
    s_nop 5
    v_add_f32 v12, v20, v22
    s_nop 1
    v_add_f32_dpp v12, v24, v26 quad_perm:[0,1,2,3] row_mask:0x2 bank_mask:0xf
    s_nop 1
    v_add_f32_dpp v12, v21, v23 quad_perm:[0,1,2,3] row_mask:0x4 bank_mask:0xf
    s_nop 1
    v_add_f32_dpp v12, v25, v27 quad_perm:[0,1,2,3] row_mask:0x8 bank_mask:0xf
    s_cbranch_scc1 L_gs_37
    buffer_store_dword v12, v54, s[40:43], s59 offen
L_gb_38:
L_skip_36:
    s_cmp_eq_u32 s30, 5
    s_cbranch_scc0 L_skip_39
    global_load_dword v2, v3, s[26:27] sc1
L_skip_39:
    s_waitcnt vmcnt(36)
    s_barrier
    ds_read_b128 v[96:99], v8 offset:0
    ds_read_b128 v[100:103], v9 offset:0
    s_cmp_eq_u32 s30, 6
    s_cbranch_scc0 L_skip_40
    s_mul_i32 s57, s14, 3
    s_mov_b32 m0, 36864
    s_nop 0
    buffer_load_dwordx4 v3, s[48:51], s57 offen offset:0 nt lds
    s_mul_i32 s57, s14, 3
    s_add_u32 s57, s57, s15
    s_mov_b32 m0, 36864
    s_nop 0
    buffer_load_dwordx4 v3, s[48:51], s57 offen offset:1024 nt lds
    s_mov_b32 s57, 786560
    s_mov_b32 s58, 982144
    s_mov_b32 m0, 141312
L_dma_41:
    s_waitcnt vmcnt(22)
    buffer_load_dwordx4 v5, s[32:35], s57 offen offset:0 nt lds
    buffer_load_dwordx4 v6, s[32:35], s58 offen offset:1024 nt lds
    s_add_u32 s57, s57, 24576
    s_add_u32 s58, s58, 24576
    s_add_u32 m0, m0, 2048
    s_cmp_lg_u32 m0, 157696
    s_cbranch_scc1 L_dma_41
L_skip_40:
    s_waitcnt lgkmcnt(0)
    s_waitcnt vmcnt(36)
    s_barrier
    ds_read_b128 v[104:107], v8 offset:16384
    ds_read_b128 v[108:111], v9 offset:16384
    s_cmp_eq_u32 s30, 6
    s_cbranch_scc0 L_skip_42
    s_mul_i32 s57, s14, 4
    s_mov_b32 m0, 38912
    s_nop 0
    buffer_load_dwordx4 v3, s[48:51], s57 offen offset:0 nt lds
    s_mul_i32 s57, s14, 4
    s_add_u32 s57, s57, s15
    s_mov_b32 m0, 38912
    s_nop 0
    buffer_load_dwordx4 v3, s[48:51], s57 offen offset:1024 nt lds
    s_mov_b32 s57, 786688
    s_mov_b32 s58, 982272
    s_mov_b32 m0, 92160
L_dma_43:
    s_waitcnt vmcnt(22)
    buffer_load_dwordx4 v5, s[32:35], s57 offen offset:0 nt lds
    buffer_load_dwordx4 v6, s[32:35], s58 offen offset:1024 nt lds
    s_add_u32 s57, s57, 24576
    s_add_u32 s58, s58, 24576
    s_add_u32 m0, m0, 2048
    s_cmp_lg_u32 m0, 108544
    s_cbranch_scc1 L_dma_43
L_skip_42:
    s_waitcnt lgkmcnt(0)
    s_cmp_lg_u32 s30, 6
    s_cbranch_scc0 L_skip_44
    s_waitcnt vmcnt(0)
L_skip_44:
    s_waitcnt vmcnt(36)
    s_barrier
    ds_read_b128 v[112:115], v8 offset:32768
    ds_read_b128 v[116:119], v9 offset:32768
    s_cmp_eq_u32 s30, 6
    s_cbranch_scc0 L_skip_45
    s_mul_i32 s57, s14, 5
    s_mov_b32 m0, 40960
    s_nop 0
    buffer_load_dwordx4 v3, s[48:51], s57 offen offset:0 nt lds
    s_mul_i32 s57, s14, 5
    s_add_u32 s57, s57, s15
    s_mov_b32 m0, 40960
    s_nop 0
    buffer_load_dwordx4 v3, s[48:51], s57 offen offset:1024 nt lds
    s_mov_b32 s57, 1179648
    s_mov_b32 s58, 1375232
    s_mov_b32 m0, 108544
L_dma_46:
    s_waitcnt vmcnt(22)
    buffer_load_dwordx4 v5, s[32:35], s57 offen offset:0 nt lds
    buffer_load_dwordx4 v6, s[32:35], s58 offen offset:1024 nt lds
    s_add_u32 s57, s57, 24576
    s_add_u32 s58, s58, 24576
    s_add_u32 m0, m0, 2048
    s_cmp_lg_u32 m0, 124928
    s_cbranch_scc1 L_dma_46
L_skip_45:
    s_waitcnt lgkmcnt(0)
    s_cmp_eq_u32 s30, 5
    s_cbranch_scc0 L_skip_47
L_cw_48:
    v_readlane_b32 s57, v2, s31
    s_cmp_eq_u32 s57, 0
    s_cbranch_scc1 L_cr_49
    s_lshr_b32 s58, s63, 2
    s_xor_b32 s58, s58, s65
    s_and_b32 s58, s58, 1
    v_mov_b32 v25, s58
    s_sub_u32 s57, s57, 1
    s_cmp_eq_u32 s57, s63
    s_cselect_b32 s64, 1, 0
    s_cbranch_scc0 L_far_50
    s_lshl_b32 s57, s52, 2
    s_add_u32 s57, s57, s72
    s_mov_b64 exec, 1
    buffer_store_dword v25, v0, s[40:43], s57 offen offset:0
    s_mov_b64 exec, -1
L_fb_51:
L_skip_47:
    s_waitcnt vmcnt(36)
    s_barrier
    ds_read_b128 v[120:123], v8 offset:49152
    ds_read_b128 v[124:127], v9 offset:49152
    s_cmp_eq_u32 s30, 6
    s_cbranch_scc0 L_skip_52
    s_mul_i32 s57, s14, 6
    s_mov_b32 m0, 43008
    s_nop 0
    buffer_load_dwordx4 v3, s[48:51], s57 offen offset:0 nt lds
    s_mul_i32 s57, s14, 6
    s_add_u32 s57, s57, s15
    s_mov_b32 m0, 43008
    s_nop 0
    buffer_load_dwordx4 v3, s[48:51], s57 offen offset:1024 nt lds
    s_mov_b32 s57, 1179776
    s_mov_b32 s58, 1375360
    s_mov_b32 m0, 124928
L_dma_53:
    s_waitcnt vmcnt(22)
    buffer_load_dwordx4 v5, s[32:35], s57 offen offset:0 nt lds
    buffer_load_dwordx4 v6, s[32:35], s58 offen offset:1024 nt lds
    s_add_u32 s57, s57, 24576
    s_add_u32 s58, s58, 24576
    s_add_u32 m0, m0, 2048
    s_cmp_lg_u32 m0, 141312
    s_cbranch_scc1 L_dma_53
L_skip_52:
    s_waitcnt lgkmcnt(0)
    s_waitcnt vmcnt(36)
    s_barrier
    ds_read_b128 v[128:131], v8 offset:0
    ds_read_b128 v[132:135], v9 offset:0
    s_cmp_eq_u32 s30, 6
    s_cbranch_scc0 L_skip_54
    s_mul_i32 s57, s14, 7
    s_mov_b32 m0, 45056
    s_nop 0
    buffer_load_dwordx4 v3, s[48:51], s57 offen offset:0 nt lds
    s_mul_i32 s57, s14, 7
    s_add_u32 s57, s57, s15
    s_mov_b32 m0, 45056
    s_nop 0
    buffer_load_dwordx4 v3, s[48:51], s57 offen offset:1024 nt lds
    s_mov_b32 s57, 1179904
    s_mov_b32 s58, 1375488
    s_mov_b32 m0, 141312
L_dma_55:
    s_waitcnt vmcnt(22)
    buffer_load_dwordx4 v5, s[32:35], s57 offen offset:0 nt lds
    buffer_load_dwordx4 v6, s[32:35], s58 offen offset:1024 nt lds
    s_add_u32 s57, s57, 24576
    s_add_u32 s58, s58, 24576
    s_add_u32 m0, m0, 2048
    s_cmp_lg_u32 m0, 157696
    s_cbranch_scc1 L_dma_55
L_skip_54:
    s_waitcnt lgkmcnt(0)
    s_cmp_eq_u32 s30, 5
    s_cbranch_scc0 L_skip_56
    v_lshlrev_b32 v24, 2, v0
    buffer_load_dword v2, v24, s[40:43], s72 offen sc1
L_skip_56:
    s_waitcnt vmcnt(36)
    s_barrier
    ds_read_b128 v[136:139], v8 offset:16384
    ds_read_b128 v[140:143], v9 offset:16384
    s_cmp_eq_u32 s30, 6
    s_cbranch_scc0 L_skip_57
    s_mul_i32 s57, s14, 8
    s_mov_b32 m0, 47104
    s_nop 0
    buffer_load_dwordx4 v3, s[48:51], s57 offen offset:0 nt lds
    s_mul_i32 s57, s14, 8
    s_add_u32 s57, s57, s15
    s_mov_b32 m0, 47104
    s_nop 0
    buffer_load_dwordx4 v3, s[48:51], s57 offen offset:1024 nt lds
    s_mov_b32 s57, 0
    s_mov_b32 s58, 392192
    s_mov_b32 m0, 92160
L_dma_58:
    s_waitcnt vmcnt(22)
    buffer_load_dwordx4 v7, s[36:39], s57 offen offset:0 nt lds
    buffer_load_dwordx4 v7, s[36:39], s58 offen offset:1024 nt lds
    s_add_u32 s57, s57, 24576
    s_add_u32 s58, s58, 24576
    s_add_u32 m0, m0, 2048
    s_cmp_lg_u32 m0, 108544
    s_cbranch_scc1 L_dma_58
L_skip_57:
    s_waitcnt lgkmcnt(0)
    s_waitcnt vmcnt(36)
    s_barrier
    ds_read_b128 v[144:147], v8 offset:32768
    ds_read_b128 v[148:151], v9 offset:32768
    s_cmp_eq_u32 s30, 6
    s_cbranch_scc0 L_skip_59
    s_mul_i32 s57, s14, 9
    s_mov_b32 m0, 49152
    s_nop 0
    buffer_load_dwordx4 v3, s[48:51], s57 offen offset:0 nt lds
    s_mul_i32 s57, s14, 9
    s_add_u32 s57, s57, s15
    s_mov_b32 m0, 49152
    s_nop 0
    buffer_load_dwordx4 v3, s[48:51], s57 offen offset:1024 nt lds
    s_mov_b32 s57, 128
    s_mov_b32 s58, 392320
    s_mov_b32 m0, 108544
L_dma_60:
    s_waitcnt vmcnt(22)
    buffer_load_dwordx4 v7, s[36:39], s57 offen offset:0 nt lds
    buffer_load_dwordx4 v7, s[36:39], s58 offen offset:1024 nt lds
    s_add_u32 s57, s57, 24576
    s_add_u32 s58, s58, 24576
    s_add_u32 m0, m0, 2048
    s_cmp_lg_u32 m0, 124928
    s_cbranch_scc1 L_dma_60
L_skip_59:
    s_waitcnt lgkmcnt(0)
    s_cmp_eq_u32 s30, 5
    s_cbranch_scc0 L_skip_61
L_cw_62:
    s_waitcnt vmcnt(0)
    v_cmp_ne_u32 vcc, -1, v2
    s_mov_b32 s57, 0
    s_mov_b32 s68, 2
    s_cmp_eq_u32 s64, 0
    s_cbranch_scc1 L_cd_64
    s_cmp_lg_u32 vcc_hi, 0
    s_cbranch_scc1 L_cd_64
    s_cmp_lg_u32 vcc_lo, -1
    s_cbranch_scc1 L_cr_63
    v_cmp_eq_u32 vcc, 1, v2
    s_bcnt1_i32_b32 s68, vcc_lo
    s_mov_b32 s57, 1
L_cd_64:
    v_mov_b32 v37, 160768
    v_mov_b32 v38, s57
    ds_write_b32 v37, v38
    s_waitcnt lgkmcnt(0)
L_skip_61:
    s_waitcnt vmcnt(36)
    s_barrier
    ds_read_b128 v[152:155], v8 offset:49152
    ds_read_b128 v[156:159], v9 offset:49152
    s_cmp_eq_u32 s30, 6
    s_cbranch_scc0 L_skip_65
    s_mul_i32 s57, s14, 10
    s_mov_b32 m0, 51200
    s_nop 0
    buffer_load_dwordx4 v3, s[48:51], s57 offen offset:0 nt lds
    s_mul_i32 s57, s14, 10
    s_add_u32 s57, s57, s15
    s_mov_b32 m0, 51200
    s_nop 0
    buffer_load_dwordx4 v3, s[48:51], s57 offen offset:1024 nt lds
    s_mov_b32 s57, 256
    s_mov_b32 s58, 392448
    s_mov_b32 m0, 124928
L_dma_66:
    s_waitcnt vmcnt(22)
    buffer_load_dwordx4 v7, s[36:39], s57 offen offset:0 nt lds
    buffer_load_dwordx4 v7, s[36:39], s58 offen offset:1024 nt lds
    s_add_u32 s57, s57, 24576
    s_add_u32 s58, s58, 24576
    s_add_u32 m0, m0, 2048
    s_cmp_lg_u32 m0, 141312
    s_cbranch_scc1 L_dma_66
L_skip_65:
    s_waitcnt lgkmcnt(0)
    v_lshrrev_b32 v8, 2, v0
    v_lshlrev_b32 v8, 7, v8
    v_bfe_u32 v60, v0, 3, 2
    v_lshl_add_u32 v8, v60, 5, v8
    v_and_b32 v60, 3, v0
    v_lshl_add_u32 v8, v60, 3, v8
    v_add_u32 v8, s61, v8
    v_xor_b32 v9, 32, v8
    v_xor_b32 v10, 64, v8
    v_xor_b32 v11, 96, v8
    v_mov_b32 v41, 160768
    ds_read_b32 v42, v41
    s_waitcnt lgkmcnt(0)
    v_readfirstlane_b32 s55, v42
    s_cmp_eq_u32 s55, 0
    s_cbranch_scc1 L_spread
L_spread_back:
    s_cmp_eq_u32 s30, 5
    s_cbranch_scc0 L_skip_78
    s_cmp_eq_u32 s52, 31
    s_cbranch_scc0 L_skip_79
    s_lshl_b32 s57, s31, 5
    v_mov_b32 v16, s57
    s_add_u32 s57, s68, 1
    v_mov_b32 v12, s57
    s_mov_b64 exec, 0x1
    global_store_dword v16, v12, s[26:27] offset:4 sc1
    s_mov_b64 exec, -1
L_skip_79:
L_skip_78:
    s_sub_u32 s58, s30, 1
    s_cmp_lt_u32 s58, 3
    s_cbranch_scc0 L_skip_80
    s_mul_i32 s59, s53, 12416
    s_add_u32 s59, s59, s62
    s_add_u32 s59, s59, 70656
    s_add_u32 s60, s59, 12288
    s_lshl_b32 s57, s58, 11
    v_lshlrev_b32 v48, 4, v0
    v_add_u32 v48, s57, v48
    v_and_b32 v49, 7, v0
    v_lshlrev_b32 v49, 3, v49
    s_add_u32 s57, s59, 6144
    buffer_load_dwordx4 v[12:15], v48, s[40:43], s59 offen offset:0 sc1 nt
    buffer_load_dwordx4 v[16:19], v48, s[40:43], s59 offen offset:1024 sc1 nt
    buffer_load_dwordx4 v[28:31], v48, s[40:43], s57 offen offset:0 sc1 nt
    buffer_load_dwordx4 v[32:35], v48, s[40:43], s57 offen offset:1024 sc1 nt
    buffer_load_dwordx2 v[24:25], v49, s[40:43], s60 offen sc1 nt
L_skip_80:
    s_waitcnt vmcnt(36)
    s_barrier
    ds_read_b64_tr_b16 v[160:161], v8 offset:0
    ds_read_b64_tr_b16 v[168:169], v9 offset:0
    ds_read_b64_tr_b16 v[176:177], v10 offset:0
    ds_read_b64_tr_b16 v[184:185], v11 offset:0
    s_cmp_eq_u32 s30, 6
    s_cbranch_scc0 L_skip_81
    s_mul_i32 s57, s14, 11
    s_mov_b32 m0, 53248
    s_nop 0
    buffer_load_dwordx4 v3, s[48:51], s57 offen offset:0 nt lds
    s_mul_i32 s57, s14, 11
    s_add_u32 s57, s57, s15
    s_mov_b32 m0, 53248
    s_nop 0
    buffer_load_dwordx4 v3, s[48:51], s57 offen offset:1024 nt lds
    s_mov_b32 s57, 196608
    s_mov_b32 s58, 588800
    s_mov_b32 m0, 141312
L_dma_82:
    s_waitcnt vmcnt(22)
    buffer_load_dwordx4 v7, s[36:39], s57 offen offset:0 nt lds
    buffer_load_dwordx4 v7, s[36:39], s58 offen offset:1024 nt lds
    s_add_u32 s57, s57, 24576
    s_add_u32 s58, s58, 24576
    s_add_u32 m0, m0, 2048
    s_cmp_lg_u32 m0, 157696
    s_cbranch_scc1 L_dma_82
L_skip_81:
    s_waitcnt lgkmcnt(0)
    s_waitcnt vmcnt(36)
    s_barrier
    ds_read_b64_tr_b16 v[192:193], v8 offset:16384
    ds_read_b64_tr_b16 v[200:201], v9 offset:16384
    ds_read_b64_tr_b16 v[208:209], v10 offset:16384
    ds_read_b64_tr_b16 v[216:217], v11 offset:16384
    s_cmp_eq_u32 s30, 6
    s_cbranch_scc0 L_skip_83
    s_mov_b32 s57, 196736
    s_mov_b32 s58, 588928
    s_mov_b32 m0, 92160
L_dma_84:
    s_waitcnt vmcnt(22)
    buffer_load_dwordx4 v7, s[36:39], s57 offen offset:0 nt lds
    buffer_load_dwordx4 v7, s[36:39], s58 offen offset:1024 nt lds
    s_add_u32 s57, s57, 24576
    s_add_u32 s58, s58, 24576
    s_add_u32 m0, m0, 2048
    s_cmp_lg_u32 m0, 108544
    s_cbranch_scc1 L_dma_84
L_skip_83:
    s_waitcnt lgkmcnt(0)
    s_sub_u32 s58, s30, 1
    s_cmp_lt_u32 s58, 3
    s_cbranch_scc0 L_skip_85
    s_lshl_b32 s57, s58, 7
    v_bfe_u32 v51, v0, 2, 2
    v_lshlrev_b32 v51, 5, v51
    v_lshrrev_b32 v60, 5, v0
    v_lshl_add_u32 v51, v60, 4, v51
    v_and_b32 v60, 3, v0
    v_lshl_add_u32 v51, v60, 2, v51
    v_bfe_u32 v60, v0, 4, 1
    v_lshl_add_u32 v51, v60, 1, v51
    v_add_u32 v51, s57, v51
    v_add_u32 v51, 157696, v51
    v_mov_b32 v60, 0x3c75e03e
    v_mov_b32 v61, 0x3a71d1e6
    v_mov_b32 v47, 0x3e13985d
    s_waitcnt vmcnt(0)
    v_pk_add_f32 v[36:37], v[28:29], v[32:33]
    v_pk_add_f32 v[38:39], v[30:31], v[34:35]
    s_nop 1
    v_permlane32_swap_b32 v36, v38
    v_permlane32_swap_b32 v37, v39
    v_pk_add_f32 v[36:37], v[36:37], v[38:39]
    s_nop 1
    v_permlane16_swap_b32 v36, v37
    v_add_f32 v36, v36, v37
    v_mul_f32 v6, 0x3dd53b95, v36
    v_add_f32_dpp v48, v24, v24 row_ror:4 row_mask:0xf bank_mask:0xf
    v_add_f32_dpp v49, v25, v25 row_ror:4 row_mask:0xf bank_mask:0xf
    v_pk_add_f32 v[20:21], v[12:13], v[16:17]
    v_pk_add_f32 v[22:23], v[14:15], v[18:19]
    v_add_f32_dpp v48, v48, v48 row_ror:2 row_mask:0xf bank_mask:0xf
    v_add_f32_dpp v49, v49, v49 row_ror:2 row_mask:0xf bank_mask:0xf
    v_permlane32_swap_b32 v20, v22
    v_permlane32_swap_b32 v21, v23
    v_add_f32_dpp v48, v48, v48 row_ror:1 row_mask:0xf bank_mask:0xf
    v_add_f32_dpp v49, v49, v49 row_ror:1 row_mask:0xf bank_mask:0xf
    v_pk_add_f32 v[20:21], v[20:21], v[22:23]
    v_mul_f32 v48, v48, v60
    v_fma_f32 v49, v49, v47, v61
    v_permlane16_swap_b32 v20, v21
    v_fma_f32 v49, -v48, v48, v49
    v_add_f32 v20, v20, v21
    v_max_f32 v49, v49, v61
    v_mul_f32 v50, v6, v48
    v_rsq_f32 v49, v49
    v_cmp_u_f32 vcc, v20, v20
    v_sub_f32 v20, v20, v50
    v_mul_f32 v20, v20, v49
    v_cvt_pk_bf16_f32 v20, v20, v20
    ds_write_b16 v51, v20
    s_waitcnt lgkmcnt(0)
L_skip_85:
    s_lshl_b32 s57, s30, 7
    s_add_u32 s57, s57, 158720
    v_lshrrev_b32 v58, 4, v0
    v_lshlrev_b32 v58, 5, v58
    v_bfe_u32 v60, v0, 1, 1
    v_lshl_add_u32 v58, v60, 4, v58
    v_bfe_u32 v60, v0, 2, 2
    v_lshl_add_u32 v58, v60, 2, v58
    v_and_b32 v60, 1, v0
    v_lshl_add_u32 v58, v60, 1, v58
    v_add_u32 v58, s57, v58
    v_lshrrev_b32 v61, 4, v0
    v_lshlrev_b32 v61, 5, v61
    v_bfe_u32 v60, v0, 1, 1
    v_lshl_add_u32 v61, v60, 4, v61
    v_add_u32 v61, s57, v61
    v_bfe_u32 v62, v0, 2, 2
    v_lshlrev_b32 v62, 1, v62
    v_and_b32 v60, 1, v0
    v_lshl_add_u32 v62, v60, 0, v62
    v_mov_b32 v60, 160992
    v_cmp_eq_u32 vcc, 0, v62
    s_nop 1
    v_cndmask_b32 v52, v60, v61, vcc
    v_cmp_eq_u32 vcc, 1, v62
    s_nop 1
    v_cndmask_b32 v53, v60, v61, vcc
    v_cmp_eq_u32 vcc, 2, v62
    s_nop 1
    v_cndmask_b32 v54, v60, v61, vcc
    v_cmp_eq_u32 vcc, 3, v62
    s_nop 1
    v_cndmask_b32 v55, v60, v61, vcc
    v_cmp_eq_u32 vcc, 4, v62
    s_nop 1
    v_cndmask_b32 v56, v60, v61, vcc
    v_cmp_eq_u32 vcc, 5, v62
    s_nop 1
    v_cndmask_b32 v57, v60, v61, vcc
    s_lshl_b32 s58, s30, 2
    s_add_u32 s58, s58, 159744
    v_mov_b32 v60, s58
    v_lshlrev_b32 v59, 2, v0
    v_add_u32 v59, 158208, v59
    v_cmp_eq_u32 vcc, 63, v0
    s_nop 1
    v_cndmask_b32 v59, v59, v60, vcc
    v_and_b32 v62, 7, v0
    v_lshlrev_b32 v62, 2, v62
    v_add_u32 v62, 159744, v62
    s_lshl_b32 s57, s30, 11
    v_lshlrev_b32 v63, 4, v0
    v_add_u32 v63, s57, v63
    v_add_u32 v63, 92160, v63
    s_waitcnt vmcnt(34)
    s_barrier
    ds_read_b64_tr_b16 v[224:225], v8 offset:32768
    ds_read_b64_tr_b16 v[232:233], v9 offset:32768
    ds_read_b64_tr_b16 v[240:241], v10 offset:32768
    ds_read_b64_tr_b16 v[248:249], v11 offset:32768
    s_cmp_eq_u32 s30, 6
    s_cbranch_scc0 L_skip_86
    s_mov_b32 s57, 196864
    s_mov_b32 s58, 589056
    s_mov_b32 m0, 108544
L_dma_87:
    s_nop 0
    buffer_load_dwordx4 v7, s[36:39], s57 offen offset:0 nt lds
    buffer_load_dwordx4 v7, s[36:39], s58 offen offset:1024 nt lds
    s_add_u32 s57, s57, 24576
    s_add_u32 s58, s58, 24576
    s_add_u32 m0, m0, 2048
    s_cmp_lg_u32 m0, 124928
    s_cbranch_scc1 L_dma_87
L_skip_86:
    s_waitcnt lgkmcnt(0)
    v_lshrrev_b32 v5, 4, v0
    v_lshlrev_b32 v5, 5, v5
    v_bfe_u32 v60, v0, 1, 1
    v_lshl_add_u32 v5, v60, 4, v5
    v_add_u32 v5, 157696, v5
    ds_read_b128 v[12:15], v5 offset:0
    ds_read_b128 v[16:19], v5 offset:128
    ds_read_b128 v[20:23], v5 offset:256
    v_mov_b64 v[24:25], 0
    v_mov_b64 v[26:27], 0
    v_mov_b64 v[28:29], 0
    v_mov_b64 v[30:31], 0
    v_mov_b64 v[32:33], 0
    v_mov_b64 v[34:35], 0
    v_mov_b64 v[36:37], 0
    v_mov_b64 v[38:39], 0
    v_mov_b64 v[40:41], 0
    v_mov_b64 v[42:43], 0
    v_mov_b64 v[44:45], 0
    v_mov_b64 v[46:47], 0
    s_waitcnt lgkmcnt(0)
    v_smfmac_f32_16x16x64_bf16 v[24:27], v[12:15], v[64:71], v1
    v_smfmac_f32_16x16x64_bf16 v[24:27], v[16:19], v[72:79], v1
    v_smfmac_f32_16x16x64_bf16 v[24:27], v[20:23], v[80:87], v1
    v_smfmac_f32_16x16x64_bf16 v[28:31], v[12:15], v[88:95], v1
    v_smfmac_f32_16x16x64_bf16 v[28:31], v[16:19], v[96:103], v1
    v_smfmac_f32_16x16x64_bf16 v[28:31], v[20:23], v[104:111], v1
    v_smfmac_f32_16x16x64_bf16 v[32:35], v[12:15], v[112:119], v1
    v_smfmac_f32_16x16x64_bf16 v[32:35], v[16:19], v[120:127], v1
    v_smfmac_f32_16x16x64_bf16 v[32:35], v[20:23], v[128:135], v1
    v_smfmac_f32_16x16x64_bf16 v[36:39], v[12:15], v[136:143], v1
    v_smfmac_f32_16x16x64_bf16 v[36:39], v[16:19], v[144:151], v1
    v_smfmac_f32_16x16x64_bf16 v[36:39], v[20:23], v[152:159], v1
    v_add_f32 v24, v24, v26
    s_nop 0
    v_add_f32 v28, v28, v30
    s_nop 1
    v_add_f32 v32, v32, v34
    v_max3_f32 v61, v24, v28, v32
    v_mov_b32_dpp v24, v28 quad_perm:[0,1,2,3] row_mask:0x2 bank_mask:0xf
    v_add_f32 v36, v36, v38
    v_max_f32 v61, v61, v36
    v_mov_b32_dpp v24, v32 quad_perm:[0,1,2,3] row_mask:0x4 bank_mask:0xf
    s_nop 0
    v_max_f32_dpp v61, v61, v61 row_ror:8 row_mask:0xf bank_mask:0xf
    s_nop 0
    v_mov_b32_dpp v24, v36 quad_perm:[0,1,2,3] row_mask:0x8 bank_mask:0xf
    v_max_f32_dpp v61, v61, v61 row_ror:4 row_mask:0xf bank_mask:0xf
    s_nop 1
    v_max_f32_dpp v61, v61, v61 row_ror:2 row_mask:0xf bank_mask:0xf
    s_nop 1
    v_max_f32_dpp v61, v61, v61 row_ror:1 row_mask:0xf bank_mask:0xf
    v_sub_f32 v36, v24, v61
    ds_write_b32 v59, v61
    v_exp_f32 v36, v36
    s_nop 0
    v_cvt_pk_bf16_f32 v39, v36, v36
    ds_write_b16 v58, v39
    ds_read_b128 v[12:15], v52
    ds_read_b128 v[16:19], v53
    ds_read_b128 v[20:23], v54
    ds_read_b128 v[24:27], v55
    ds_read_b128 v[28:31], v56
    ds_read_b128 v[32:35], v57
    v_add_f32_dpp v38, v36, v36 row_ror:8 row_mask:0xf bank_mask:0xf
    s_nop 1
    v_add_f32_dpp v38, v38, v38 row_ror:4 row_mask:0xf bank_mask:0xf
    s_nop 1
    v_add_f32_dpp v38, v38, v38 row_ror:2 row_mask:0xf bank_mask:0xf
    s_nop 1
    v_add_f32_dpp v38, v38, v38 row_ror:1 row_mask:0xf bank_mask:0xf
    s_nop 1
    v_add_f32_dpp v38, v38, v38 row_bcast:15 row_mask:0xa bank_mask:0xf
    s_nop 1
    v_add_f32_dpp v38, v38, v38 row_bcast:31 row_mask:0xc bank_mask:0xf
    s_waitcnt lgkmcnt(0)
    s_waitcnt vmcnt(32)
    s_barrier
    ds_read_b64_tr_b16 v[162:163], v8 offset:49152
    ds_read_b64_tr_b16 v[170:171], v9 offset:49152
    ds_read_b64_tr_b16 v[178:179], v10 offset:49152
    ds_read_b64_tr_b16 v[186:187], v11 offset:49152
    s_cmp_eq_u32 s30, 6
    s_cbranch_scc0 L_skip_88
    s_mov_b32 s57, 786432
    s_mov_b32 s58, 1178624
    s_mov_b32 m0, 124928
L_dma_89:
    s_nop 0
    buffer_load_dwordx4 v7, s[36:39], s57 offen offset:0 nt lds
    buffer_load_dwordx4 v7, s[36:39], s58 offen offset:1024 nt lds
    s_add_u32 s57, s57, 24576
    s_add_u32 s58, s58, 24576
    s_add_u32 m0, m0, 2048
    s_cmp_lg_u32 m0, 141312
    s_cbranch_scc1 L_dma_89
L_skip_88:
    s_waitcnt lgkmcnt(0)
    ds_read_b32 v36, v62
    s_waitcnt lgkmcnt(0)
    v_max_f32_dpp v37, v36, v36 row_ror:4 row_mask:0xf bank_mask:0xf
    s_nop 1
    v_max_f32_dpp v37, v37, v37 row_ror:2 row_mask:0xf bank_mask:0xf
    s_nop 1
    v_max_f32_dpp v37, v37, v37 row_ror:1 row_mask:0xf bank_mask:0xf
    v_sub_f32 v39, v61, v37
    v_exp_f32 v39, v39
    s_cmp_lt_u32 s30, 2
    s_cbranch_scc0 L_skip_90
    s_lshl_b32 s57, s30, 3
    v_lshlrev_b32 v2, 4, v0
    v_add_u32 v2, s57, v2
    v_add_u32 v2, 92160, v2
    v_mov_b32 v60, 94192
    v_cmp_le_u32 vcc, 48, v0
    s_nop 1
    v_cndmask_b32 v2, v2, v60, vcc
    s_lshr_b32 s57, s54, 1
    s_lshl_b32 s57, s57, 2
    s_and_b32 s58, s54, 1
    s_add_u32 s57, s57, s58
    s_lshl_b32 s58, s57, 4
    s_lshl_b32 s57, s57, 3
    v_bfe_u32 v3, v0, 3, 2
    v_lshlrev_b32 v3, 8, v3
    v_bfe_u32 v61, v0, 2, 1
    v_lshl_add_u32 v3, v61, 5, v3
    v_and_b32 v61, 3, v0
    v_lshl_add_u32 v3, v61, 2, v3
    v_add_u32 v3, s58, v3
    v_bfe_u32 v60, v0, 3, 1
    v_lshlrev_b32 v60, 8, v60
    v_bfe_u32 v61, v0, 1, 1
    v_lshl_add_u32 v60, v61, 7, v60
    v_bfe_u32 v61, v0, 2, 1
    v_lshl_add_u32 v60, v61, 4, v60
    v_and_b32 v61, 1, v0
    v_lshl_add_u32 v60, v61, 2, v60
    v_add_u32 v60, s57, v60
    v_add_u32 v60, 1024, v60
    v_cmp_gt_u32 vcc, 32, v0
    s_nop 1
    v_cndmask_b32 v3, v60, v3, vcc
    s_lshl_b32 s57, s53, 1
    s_add_u32 s57, s57, s30
    s_mul_i32 s57, s57, 1664
    s_add_u32 s57, s57, s62
    v_add_u32 v3, s57, v3
    v_mov_b32 v60, 0x7f000000
    v_cmp_le_u32 vcc, 48, v0
    s_nop 1
    v_cndmask_b32 v3, v3, v60, vcc
    s_lshl_b32 s58, s54, 2
    s_add_u32 s57, s57, s58
    s_add_u32 s57, s57, 1536
    v_mov_b32 v4, s57
    v_mov_b32 v60, 0x7f000000
    v_cmp_ne_u32 vcc, 48, v0
    s_nop 1
    v_cndmask_b32 v4, v4, v60, vcc
    s_mov_b32 s58, 0
    s_cmp_eq_u32 s55, 0
    s_cbranch_scc1 L_gs_91
    buffer_store_dword v37, v4, s[40:43], s58 offen
L_gb_92:
L_skip_90:
    s_cmp_eq_u32 s30, 2
    s_cbranch_scc0 L_skip_93
    v_lshlrev_b32 v2, 2, v0
    v_add_u32 v2, 157696, v2
    v_and_b32 v3, 15, v0
    v_lshlrev_b32 v3, 2, v3
    v_lshrrev_b32 v60, 5, v0
    v_lshl_add_u32 v3, v60, 6, v3
    v_bfe_u32 v60, v0, 4, 1
    v_lshl_add_u32 v3, v60, 13, v3
L_skip_93:
    s_waitcnt vmcnt(32)
    s_barrier
    ds_read_b64_tr_b16 v[194:195], v8 offset:0
    ds_read_b64_tr_b16 v[202:203], v9 offset:0
    ds_read_b64_tr_b16 v[210:211], v10 offset:0
    ds_read_b64_tr_b16 v[218:219], v11 offset:0
    s_cmp_eq_u32 s30, 6
    s_cbranch_scc0 L_skip_94
    s_mov_b32 s57, 786560
    s_mov_b32 s58, 1178752
    s_mov_b32 m0, 141312
L_dma_95:
    s_nop 0
    buffer_load_dwordx4 v7, s[36:39], s57 offen offset:0 nt lds
    buffer_load_dwordx4 v7, s[36:39], s58 offen offset:1024 nt lds
    s_add_u32 s57, s57, 24576
    s_add_u32 s58, s58, 24576
    s_add_u32 m0, m0, 2048
    s_cmp_lg_u32 m0, 157696
    s_cbranch_scc1 L_dma_95
L_skip_94:
    s_waitcnt lgkmcnt(0)
    s_waitcnt vmcnt(32)
    s_barrier
    ds_read_b64_tr_b16 v[226:227], v8 offset:16384
    ds_read_b64_tr_b16 v[234:235], v9 offset:16384
    ds_read_b64_tr_b16 v[242:243], v10 offset:16384
    ds_read_b64_tr_b16 v[250:251], v11 offset:16384
    s_cmp_eq_u32 s30, 6
    s_cbranch_scc0 L_skip_96
    s_mov_b32 s57, 786688
    s_mov_b32 s58, 1178880
    s_mov_b32 m0, 92160
L_dma_97:
    s_nop 0
    buffer_load_dwordx4 v7, s[36:39], s57 offen offset:0 nt lds
    buffer_load_dwordx4 v7, s[36:39], s58 offen offset:1024 nt lds
    s_add_u32 s57, s57, 24576
    s_add_u32 s58, s58, 24576
    s_add_u32 m0, m0, 2048
    s_cmp_lg_u32 m0, 108544
    s_cbranch_scc1 L_dma_97
L_skip_96:
    s_waitcnt lgkmcnt(0)
    s_cmp_eq_u32 s30, 5
    s_cbranch_scc0 L_skip_98
    global_load_dword v2, v3, s[26:27] offset:4 sc1
L_skip_98:
    s_waitcnt vmcnt(32)
    s_barrier
    ds_read_b64_tr_b16 v[164:165], v8 offset:32768
    ds_read_b64_tr_b16 v[172:173], v9 offset:32768
    ds_read_b64_tr_b16 v[180:181], v10 offset:32768
    ds_read_b64_tr_b16 v[188:189], v11 offset:32768
    s_cmp_eq_u32 s30, 6
    s_cbranch_scc0 L_skip_99
    s_mov_b32 s57, 983040
    s_mov_b32 s58, 1375232
    s_mov_b32 m0, 108544
L_dma_100:
    s_nop 0
    buffer_load_dwordx4 v7, s[36:39], s57 offen offset:0 nt lds
    buffer_load_dwordx4 v7, s[36:39], s58 offen offset:1024 nt lds
    s_add_u32 s57, s57, 24576
    s_add_u32 s58, s58, 24576
    s_add_u32 m0, m0, 2048
    s_cmp_lg_u32 m0, 124928
    s_cbranch_scc1 L_dma_100
L_skip_99:
    s_waitcnt lgkmcnt(0)
    s_waitcnt vmcnt(32)
    s_barrier
    ds_read_b64_tr_b16 v[196:197], v8 offset:49152
    ds_read_b64_tr_b16 v[204:205], v9 offset:49152
    ds_read_b64_tr_b16 v[212:213], v10 offset:49152
    ds_read_b64_tr_b16 v[220:221], v11 offset:49152
    s_cmp_eq_u32 s30, 6
    s_cbranch_scc0 L_skip_101
    s_mov_b32 s57, 983168
    s_mov_b32 s58, 1375360
    s_mov_b32 m0, 124928
L_dma_102:
    s_nop 0
    buffer_load_dwordx4 v7, s[36:39], s57 offen offset:0 nt lds
    buffer_load_dwordx4 v7, s[36:39], s58 offen offset:1024 nt lds
    s_add_u32 s57, s57, 24576
    s_add_u32 s58, s58, 24576
    s_add_u32 m0, m0, 2048
    s_cmp_lg_u32 m0, 141312
    s_cbranch_scc1 L_dma_102
L_skip_101:
    s_waitcnt lgkmcnt(0)
    s_cmp_eq_u32 s30, 5
    s_cbranch_scc0 L_skip_103
L_cw_104:
    s_waitcnt vmcnt(0)
    v_cmp_eq_u32 vcc, 0, v2
    s_cbranch_vccnz L_cr_105
    v_add_u32_dpp v2, v2, v2 row_ror:4 row_mask:0xf bank_mask:0xf
    s_nop 1
    v_add_u32_dpp v2, v2, v2 row_ror:2 row_mask:0xf bank_mask:0xf
    s_nop 1
    v_add_u32_dpp v2, v2, v2 row_ror:1 row_mask:0xf bank_mask:0xf
    v_mov_b32 v60, 160772
    ds_write_b32 v60, v2
    s_waitcnt lgkmcnt(0)
L_skip_103:
    s_cmp_lt_u32 s3, 20
    s_cbranch_scc0 L_skip_106
    s_mul_i32 s74, s30, 1664
    s_add_u32 s74, s74, s62
    s_add_u32 s74, s74, 0
    v_and_b32 v56, 7, v0
    v_lshlrev_b32 v56, 2, v56
    v_lshrrev_b32 v62, 4, v0
    v_lshlrev_b32 v62, 3, v62
    s_cmp_lg_u32 s30, 6
    s_cbranch_scc0 L_skip_106
    buffer_load_dword v52, v56, s[40:43], s74 offen offset:1536 sc1
    buffer_load_dwordx2 v[54:55], v62, s[40:43], s74 offen offset:1536 sc1
L_skip_106:
    s_cmp_eq_u32 s30, 2
    s_cbranch_scc0 L_skip_107
    s_sub_u32 s57, s3, 20
    s_cmp_lt_u32 s57, 4
    s_cbranch_scc0 L_skip_108
    s_sub_u32 s57, s3, 20
    s_lshl_b32 s57, s57, 6
    v_add_u32 v50, s57, v0
    v_min_u32 v50, 207, v50
    v_lshlrev_b32 v50, 7, v50
    s_add_u32 s57, s62, 0
    buffer_load_dword v50, v50, s[40:43], s57 offen sc1 nt
    s_sub_u32 s57, s3, 20
    s_lshl_b32 s57, s57, 6
    v_add_u32 v51, s57, v0
    v_min_u32 v51, 151, v51
    v_lshlrev_b32 v51, 7, v51
    s_add_u32 s57, s62, 26624
    buffer_load_dword v51, v51, s[40:43], s57 offen sc1 nt
    s_sub_u32 s57, s3, 20
    s_lshl_b32 s57, s57, 6
    v_add_u32 v49, s57, v0
    v_min_u32 v49, 191, v49
    v_lshlrev_b32 v49, 7, v49
    s_add_u32 s57, s62, 46080
    buffer_load_dword v49, v49, s[40:43], s57 offen sc1 nt
L_skip_108:
L_skip_107:
    s_waitcnt vmcnt(32)
    s_barrier
    ds_read_b64_tr_b16 v[228:229], v8 offset:0
    ds_read_b64_tr_b16 v[236:237], v9 offset:0
    ds_read_b64_tr_b16 v[244:245], v10 offset:0
    ds_read_b64_tr_b16 v[252:253], v11 offset:0
    s_cmp_eq_u32 s30, 6
    s_cbranch_scc0 L_skip_109
    s_mov_b32 s57, 983296
    s_mov_b32 s58, 1375488
    s_mov_b32 m0, 141312
L_dma_110:
    s_nop 0
    buffer_load_dwordx4 v7, s[36:39], s57 offen offset:0 nt lds
    buffer_load_dwordx4 v7, s[36:39], s58 offen offset:1024 nt lds
    s_add_u32 s57, s57, 24576
    s_add_u32 s58, s58, 24576
    s_add_u32 m0, m0, 2048
    s_cmp_lg_u32 m0, 157696
    s_cbranch_scc1 L_dma_110
L_skip_109:
    s_waitcnt lgkmcnt(0)
    s_cmp_ge_u32 s30, 6
    s_cbranch_scc0 L_skip_111
    v_mov_b32 v60, 160772
    ds_read_b32 v60, v60
    s_lshr_b32 s58, s63, 2
    s_waitcnt lgkmcnt(0)
    v_readfirstlane_b32 s57, v60
    s_cmp_gt_u32 s57, 24
    s_cselect_b32 s57, 1, 0
    s_xor_b32 s57, s57, s58
    s_lshl_b32 s57, s57, 13
    s_add_u32 s7, s8, s57
L_skip_111:
    s_branch L_tail
.p2align 10
L_tail:
L_pad0:
    s_cbranch_execz L_pad4
    s_waitcnt vmcnt(32)
    s_barrier
    ds_read_b64_tr_b16 v[166:167], v8 offset:16384
    ds_read_b64_tr_b16 v[174:175], v9 offset:16384
    ds_read_b64_tr_b16 v[182:183], v10 offset:16384
    ds_read_b64_tr_b16 v[190:191], v11 offset:16384
    s_waitcnt lgkmcnt(0)
    s_cmp_lt_u32 s30, 5
    s_cbranch_scc0 L_skip_112
    s_waitcnt vmcnt(0)
L_skip_112:
    s_cmp_lt_u32 s3, 20
    s_cbranch_scc0 L_skip_113
    v_lshlrev_b32 v57, 4, v0
    v_lshlrev_b32 v58, 3, v0
    s_mul_i32 s57, s30, 6144
    s_add_u32 s57, s57, 30720
    v_lshrrev_b32 v59, 2, v0
    v_lshlrev_b32 v59, 6, v59
    v_bfe_u32 v53, v0, 4, 1
    v_lshl_add_u32 v59, v53, 5, v59
    v_and_b32 v53, 3, v0
    v_lshl_add_u32 v59, v53, 3, v59
    v_add_u32 v59, s57, v59
    v_xor_b32 v60, 32, v59
    s_lshl_b32 s57, s30, 8
    s_add_u32 s57, s57, 157696
    v_lshl_add_u32 v61, v0, 2, s57
    s_cmp_lg_u32 s30, 6
    s_cbranch_scc0 L_skip_113
L_cw_114:
    s_waitcnt vmcnt(0)
    v_max3_u32 v53, v52, v54, v55
    v_cmp_eq_u32 vcc, -1, v53
    s_cbranch_vccnz L_cr_115
    v_max_f32_dpp v53, v52, v52 row_ror:4 row_mask:0xf bank_mask:0xf
    s_nop 1
    v_max_f32_dpp v53, v53, v53 row_ror:2 row_mask:0xf bank_mask:0xf
    s_nop 1
    v_max_f32_dpp v53, v53, v53 row_ror:1 row_mask:0xf bank_mask:0xf
    v_sub_f32 v52, v52, v53
    v_sub_f32 v54, v54, v53
    v_sub_f32 v55, v55, v53
    v_exp_f32 v52, v52
    v_exp_f32 v54, v54
    v_exp_f32 v55, v55
    s_cmp_eq_u32 s30, 7
    s_cbranch_scc0 L_skip_113
    v_add_u32 v62, 158720, v57
    ds_write_b128 v62, v[52:55]
    s_waitcnt lgkmcnt(0)
L_skip_113:
    v_smfmac_f32_16x16x64_bf16 v[40:43], v[12:15], v[160:167], v1
    v_smfmac_f32_16x16x64_bf16 v[40:43], v[16:19], v[168:175], v1
    v_smfmac_f32_16x16x64_bf16 v[40:43], v[20:23], v[176:183], v1
    v_smfmac_f32_16x16x64_bf16 v[40:43], v[24:27], v[184:191], v1
    s_cmp_eq_u32 s30, 6
    s_cbranch_scc0 L_skip_116
    s_mul_i32 s57, s14, 12
    s_add_u32 s58, s57, s15
    s_mov_b32 m0, 55296
L_dma_117:
    s_nop 0
    buffer_load_dwordx4 v3, s[48:51], s57 offen offset:0 nt lds
    buffer_load_dwordx4 v3, s[48:51], s58 offen offset:1024 nt lds
    s_add_u32 s57, s57, s14
    s_add_u32 s58, s58, s14
    s_add_u32 m0, m0, 2048
    s_cmp_lg_u32 m0, 67584
    s_cbranch_scc1 L_dma_117
    s_mul_i32 s57, s14, 18
    s_add_u32 s58, s57, s15
    s_mov_b32 m0, 67584
L_dma_118:
    s_nop 0
    buffer_load_dwordx4 v3, s[48:51], s57 offen offset:0 nt lds
    buffer_load_dwordx4 v3, s[48:51], s58 offen offset:1024 nt lds
    s_add_u32 s57, s57, s14
    s_add_u32 s58, s58, s14
    s_add_u32 m0, m0, 2048
    s_cmp_lg_u32 m0, 79872
    s_cbranch_scc1 L_dma_118
L_skip_116:
    s_waitcnt vmcnt(40)
    s_barrier
    ds_read_b64_tr_b16 v[198:199], v8 offset:32768
    ds_read_b64_tr_b16 v[206:207], v9 offset:32768
    ds_read_b64_tr_b16 v[214:215], v10 offset:32768
    ds_read_b64_tr_b16 v[222:223], v11 offset:32768
    s_waitcnt lgkmcnt(0)
    s_cmp_lt_u32 s3, 20
    s_cbranch_scc0 L_skip_119
    s_cmp_eq_u32 s30, 6
    s_cbranch_scc0 L_skip_119
    v_add_u32 v62, 158720, v57
    ds_read_b128 v[52:55], v62
L_skip_119:
L_pad1:
    s_cbranch_execz L_pad5
    v_smfmac_f32_16x16x64_bf16 v[40:43], v[28:31], v[192:199], v1
    v_smfmac_f32_16x16x64_bf16 v[40:43], v[32:35], v[200:207], v1
    v_smfmac_f32_16x16x64_bf16 v[44:47], v[12:15], v[208:215], v1
    v_smfmac_f32_16x16x64_bf16 v[44:47], v[16:19], v[216:223], v1
    v_mul_f32 v38, v38, v39
    ds_write_b32 v63, v38 offset:1024
    s_waitcnt vmcnt(24)
    s_barrier
    ds_read_b64_tr_b16 v[230:231], v8 offset:49152
    ds_read_b64_tr_b16 v[238:239], v9 offset:49152
    ds_read_b64_tr_b16 v[246:247], v10 offset:49152
    ds_read_b64_tr_b16 v[254:255], v11 offset:49152
    s_waitcnt lgkmcnt(0)
    v_smfmac_f32_16x16x64_bf16 v[44:47], v[20:23], v[224:231], v1
    v_smfmac_f32_16x16x64_bf16 v[44:47], v[24:27], v[232:239], v1
    v_smfmac_f32_16x16x64_bf16 v[44:47], v[28:31], v[240:247], v1
    v_smfmac_f32_16x16x64_bf16 v[44:47], v[32:35], v[248:255], v1
    s_setprio 0
    s_cmp_lt_u32 s30, 2
    v_pk_add_f32 v[40:41], v[40:41], v[42:43]
    s_nop 4
    v_pk_add_f32 v[42:43], v[44:45], v[46:47]
    v_pk_mul_f32 v[40:41], v[40:41], v[38:39] op_sel:[0,1] op_sel_hi:[1,1]
    v_pk_mul_f32 v[42:43], v[42:43], v[38:39] op_sel:[0,1] op_sel_hi:[1,1]
    ds_write_b128 v63, v[40:43]
    s_cbranch_scc1 L_comb_0
    s_waitcnt lgkmcnt(0)
    s_barrier
L_comb_0b:
    s_cmp_eq_u32 s30, 6
    s_cbranch_scc0 L_skip_124
    s_waitcnt vmcnt(0)
L_skip_124:
    s_barrier
    s_cmp_lt_u32 s3, 20
    s_cbranch_scc0 L_typeB_0
    buffer_load_dwordx4 v[12:15], v57, s[40:43], s74 offen sc1
    buffer_load_dwordx2 v[16:17], v58, s[40:43], s74 offen offset:1024 sc1
    buffer_load_dword v18, v56, s[40:43], s74 offen offset:1568 sc1
    ds_read_b64_tr_b16 v[28:29], v59 offset:0
    ds_read_b64_tr_b16 v[30:31], v59 offset:1024
    ds_read_b64_tr_b16 v[32:33], v59 offset:2048
    ds_read_b64_tr_b16 v[34:35], v59 offset:3072
    ds_read_b64_tr_b16 v[36:37], v59 offset:4096
    ds_read_b64_tr_b16 v[38:39], v59 offset:5120
    ds_read_b64_tr_b16 v[40:41], v60 offset:0
    ds_read_b64_tr_b16 v[42:43], v60 offset:1024
    ds_read_b64_tr_b16 v[44:45], v60 offset:2048
    ds_read_b64_tr_b16 v[46:47], v60 offset:3072
    ds_read_b64_tr_b16 v[48:49], v60 offset:4096
    ds_read_b64_tr_b16 v[50:51], v60 offset:5120
    v_mov_b64 v[20:21], 0
    v_mov_b64 v[22:23], 0
    v_mov_b64 v[24:25], 0
    v_mov_b64 v[26:27], 0
    s_add_u32 s58, s6, 0
    s_waitcnt lgkmcnt(0)
    s_branch L_ow_125
.p2align 5
L_or_126:
    buffer_load_dwordx4 v[12:15], v57, s[40:43], s74 offen sc1
    buffer_load_dwordx2 v[16:17], v58, s[40:43], s74 offen offset:1024 sc1
    buffer_load_dword v18, v56, s[40:43], s74 offen offset:1568 sc1
    s_sub_u32 s56, s56, 1
    s_cbranch_scc1 L_done
    v_mov_b64 v[20:21], 0
    v_mov_b64 v[22:23], 0
    v_mov_b64 v[24:25], 0
    v_mov_b64 v[26:27], 0
L_ow_125:
    s_waitcnt vmcnt(2)
    v_smfmac_f32_16x16x64_bf16 v[20:23], v[12:15], v[28:35], v1
    v_max3_u32 v19, v12, v13, v14
    v_smfmac_f32_16x16x64_bf16 v[24:27], v[12:15], v[40:47], v1
    s_waitcnt vmcnt(0)
    v_mul_f32 v53, v52, v18
    v_smfmac_f32_16x16x32_bf16 v[20:23], v[16:17], v[36:39], v1
    v_max3_u32 v62, v15, v16, v17
    v_smfmac_f32_16x16x32_bf16 v[24:27], v[16:17], v[48:51], v1
    v_max3_u32 v19, v19, v62, v18
    v_add_f32_dpp v53, v53, v53 row_ror:4 row_mask:0xf bank_mask:0xf
    v_cmp_eq_u32 vcc, -1, v19
L_pad2:
    s_cbranch_execz L_pad6
    s_cmp_eq_u32 s30, 2
    v_add_f32_dpp v53, v53, v53 row_ror:2 row_mask:0xf bank_mask:0xf
    s_cbranch_vccnz L_or_126
    s_nop 0
    v_add_f32_dpp v53, v53, v53 row_ror:1 row_mask:0xf bank_mask:0xf
    v_rcp_f32 v52, v53
    v_pk_add_f32 v[20:21], v[20:21], v[22:23]
    v_pk_add_f32 v[24:25], v[24:25], v[26:27]
    v_pk_mul_f32 v[54:55], v[54:55], v[52:53] op_sel:[0,0] op_sel_hi:[1,0]
    v_mul_f32 v20, v20, v54
    v_mul_f32 v24, v24, v54
    v_fmac_f32 v20, v21, v55
    v_fmac_f32 v24, v25, v55
    s_nop 1
    v_permlane32_swap_b32 v20, v24
    v_add_f32 v20, v20, v24
    ds_write_b32 v61, v20
    s_waitcnt lgkmcnt(0)
    s_barrier
    s_cbranch_scc0 L_finb_127
    ds_read2st64_b32 v[12:13], v2 offset0:0 offset1:1
    ds_read2st64_b32 v[14:15], v2 offset0:2 offset1:3
    ds_read2st64_b32 v[16:17], v2 offset0:4 offset1:5
    ds_read2st64_b32 v[18:19], v2 offset0:6 offset1:7
    s_waitcnt lgkmcnt(2)
    v_pk_add_f32 v[12:13], v[12:13], v[14:15]
    s_waitcnt lgkmcnt(0)
    v_pk_add_f32 v[16:17], v[16:17], v[18:19]
    v_pk_add_f32 v[12:13], v[12:13], v[16:17]
    v_add_f32 v14, v12, v13
    v_add_f32 v15, v12, v13
    s_nop 1
    v_permlane16_swap_b32 v14, v15
    v_add_f32 v12, v14, v15
    buffer_store_dword v12, v3, s[40:43], s58 offen sc1
L_finb_127:
    s_sub_u32 s57, s30, 4
    s_cmp_lt_u32 s57, 3
    s_cbranch_scc0 L_skip_128
    s_sub_u32 s60, s30, 4
    s_lshl_b32 s57, s60, 11
    v_lshlrev_b32 v11, 4, v0
    v_add_u32 v11, s57, v11
    s_add_u32 s65, s62, 19456
    buffer_load_dwordx4 v[52:55], v11, s[40:43], s65 offen offset:0 sc1
    buffer_load_dwordx4 v[56:59], v11, s[40:43], s65 offen offset:1024 sc1
    s_lshl_b32 s59, s60, 12
    s_add_u32 s59, s59, 79872
    s_mov_b32 s44, s20
    s_mov_b32 s45, s21
    s_mov_b32 s46, 1966080
    s_mov_b32 s47, 0x20000
    s_mul_i32 s57, s31, 3
    s_add_u32 s57, s57, s60
    s_mul_i32 s57, s57, 81920
    s_lshl_b32 s64, s3, 6
    s_add_u32 s57, s57, s64
    v_lshrrev_b32 v5, 2, v0
    v_mul_u32_u24 v5, 1280, v5
    v_and_b32 v60, 3, v0
    v_lshl_add_u32 v5, v60, 4, v5
    v_add_u32 v5, s57, v5
    s_add_u32 m0, s59, 0
    s_mov_b32 s57, 0
    buffer_load_dwordx4 v5, s[44:47], s57 offen nt lds
    s_add_u32 m0, s59, 1024
    s_mov_b32 s57, 20480
    buffer_load_dwordx4 v5, s[44:47], s57 offen nt lds
    s_add_u32 m0, s59, 2048
    s_mov_b32 s57, 40960
    buffer_load_dwordx4 v5, s[44:47], s57 offen nt lds
    s_add_u32 m0, s59, 3072
    s_mov_b32 s57, 61440
    buffer_load_dwordx4 v5, s[44:47], s57 offen nt lds
    v_bfe_u32 v35, v0, 4, 1
    v_lshlrev_b32 v35, 11, v35
    v_bfe_u32 v60, v0, 2, 2
    v_lshl_add_u32 v35, v60, 8, v35
    v_lshrrev_b32 v60, 5, v0
    v_lshl_add_u32 v35, v60, 6, v35
    v_and_b32 v60, 3, v0
    v_lshl_add_u32 v35, v60, 3, v35
    v_add_u32 v35, s59, v35
    v_mov_b32 v9, 0xbdd2d3e8
    v_mov_b32 v10, 0xc0135761
    s_lshl_b32 s57, s60, 7
    s_add_u32 s57, s57, 159872
L_pad3:
    s_cbranch_execz L_pad7
    v_lshlrev_b32 v32, 3, v0
    v_add_u32 v32, s57, v32
    v_lshlrev_b32 v33, 3, v0
    v_add_u32 v33, 129024, v33
    v_cmp_gt_u32 vcc, 16, v0
    s_nop 1
    v_cndmask_b32 v32, v33, v32, vcc
    v_and_b32 v33, 15, v0
    v_lshlrev_b32 v33, 3, v33
    v_lshrrev_b32 v60, 5, v0
    v_lshl_add_u32 v33, v60, 2, v33
    v_add_u32 v33, 159872, v33
    v_and_b32 v34, 15, v0
    v_lshlrev_b32 v34, 2, v34
    v_lshrrev_b32 v60, 5, v0
    v_lshl_add_u32 v34, v60, 6, v34
    v_bfe_u32 v60, v0, 4, 1
    v_lshl_add_u32 v34, v60, 13, v34
    s_add_u32 s60, s6, 66048
    s_add_u32 s58, s62, 13312
    s_add_u32 s57, s62, 25856
    v_and_b32 v7, 7, v0
    v_lshlrev_b32 v7, 3, v7
    v_mov_b32 v60, 0x3acccccd
    v_mov_b32 v61, 0x3727c5ac
    s_waitcnt vmcnt(0)
    buffer_load_dwordx2 v[24:25], v7, s[40:43], s57 offen sc1
    buffer_load_dwordx4 v[12:15], v11, s[40:43], s58 offen offset:0 sc1
    buffer_load_dwordx4 v[16:19], v11, s[40:43], s58 offen offset:1024 sc1
    ds_read_b64_tr_b16 v[36:37], v35 offset:0
    ds_read_b64_tr_b16 v[38:39], v35 offset:1024
    ds_read_b64_tr_b16 v[40:41], v35 offset:128
    ds_read_b64_tr_b16 v[42:43], v35 offset:1152
    ds_read_b64_tr_b16 v[44:45], v35 offset:32
    ds_read_b64_tr_b16 v[46:47], v35 offset:1056
    ds_read_b64_tr_b16 v[48:49], v35 offset:160
    ds_read_b64_tr_b16 v[50:51], v35 offset:1184
L_sw_131:
    v_max3_u32 v20, v52, v53, v54
    v_max3_u32 v20, v20, v55, v56
    v_max3_u32 v20, v20, v57, v58
    v_max_u32 v20, v20, v59
    v_cmp_eq_u32 vcc, -1, v20
    s_cbranch_vccnz L_sr_132
    v_pk_add_f32 v[28:29], v[52:53], v[56:57]
    v_pk_add_f32 v[30:31], v[54:55], v[58:59]
    s_nop 1
    v_permlane32_swap_b32 v28, v30
    v_permlane32_swap_b32 v29, v31
    v_pk_add_f32 v[28:29], v[28:29], v[30:31]
    s_nop 1
    v_permlane16_swap_b32 v28, v29
    v_add_f32 v28, v28, v29
    v_mov_b64 v[52:53], 0
    v_mov_b64 v[54:55], 0
    v_mov_b64 v[56:57], 0
    v_mov_b64 v[58:59], 0
    s_waitcnt lgkmcnt(0)
    s_branch L_pw_129
.p2align 5
L_pr_130:
    buffer_load_dwordx2 v[24:25], v7, s[40:43], s57 offen sc1
    buffer_load_dwordx4 v[12:15], v11, s[40:43], s58 offen offset:0 sc1
    buffer_load_dwordx4 v[16:19], v11, s[40:43], s58 offen offset:1024 sc1
    s_sub_u32 s56, s56, 1
    s_cbranch_scc1 L_done
L_pw_129:
    s_waitcnt vmcnt(0)
    v_max_u32 v20, v24, v25
    v_cmp_eq_u32 vcc, -1, v20
    s_cbranch_vccnz L_pr_130
    buffer_load_dwordx4 v[12:15], v11, s[40:43], s58 offen offset:0 sc1
    buffer_load_dwordx4 v[16:19], v11, s[40:43], s58 offen offset:1024 sc1
    v_add_f32_dpp v2, v24, v24 row_ror:4 row_mask:0xf bank_mask:0xf
    v_add_f32_dpp v3, v25, v25 row_ror:4 row_mask:0xf bank_mask:0xf
    v_pk_add_f32 v[20:21], v[12:13], v[16:17]
    v_pk_add_f32 v[22:23], v[14:15], v[18:19]
    v_add_f32_dpp v2, v2, v2 row_ror:2 row_mask:0xf bank_mask:0xf
    v_add_f32_dpp v3, v3, v3 row_ror:2 row_mask:0xf bank_mask:0xf
    v_permlane32_swap_b32 v20, v22
    v_permlane32_swap_b32 v21, v23
    v_add_f32_dpp v2, v2, v2 row_ror:1 row_mask:0xf bank_mask:0xf
    v_add_f32_dpp v3, v3, v3 row_ror:1 row_mask:0xf bank_mask:0xf
    v_pk_add_f32 v[20:21], v[20:21], v[22:23]
    v_mul_f32 v2, v2, v60
    v_fma_f32 v3, v3, v60, v61
    v_permlane16_swap_b32 v20, v21
L_pad4:
    s_cbranch_execz L_pad8
    v_fma_f32 v3, -v2, v2, v3
    v_add_f32 v20, v20, v21
    v_max_f32 v3, v3, v61
    v_mul_f32 v26, v28, v2
    v_rsq_f32 v3, v3
    v_cmp_u_f32 vcc, v20, v20
    v_sub_f32 v20, v20, v26
    s_cbranch_vccnz L_hr_133
L_hk_134:
    v_fma_f32 v20, v20, v3, v4
    v_mul_f32 v21, v20, v20
    v_fma_f32 v21, v21, v9, v10
    v_mul_f32 v21, v21, v20
    v_exp_f32 v21, v21
    s_nop 0
    v_add_f32 v21, 1.0, v21
    v_rcp_f32 v21, v21
    s_nop 0
    v_mul_f32 v20, v20, v21
    s_nop 1
    v_mov_b32_dpp v21, v20 row_shl:1 row_mask:0xf bank_mask:0xf bound_ctrl:0
    v_cvt_pk_bf16_f32 v28, v20, v21
    s_nop 1
    v_mov_b32_dpp v29, v28 row_shl:4 row_mask:0xf bank_mask:0xf bound_ctrl:0
    v_mov_b32_dpp v30, v28 row_shl:8 row_mask:0xf bank_mask:0xf bound_ctrl:0
    v_mov_b32_dpp v31, v28 row_shl:12 row_mask:0xf bank_mask:0xf bound_ctrl:0
    s_nop 1
    v_smfmac_f32_16x16x64_bf16 v[52:55], v[28:31], v[36:43], v1
    v_smfmac_f32_16x16x64_bf16 v[56:59], v[28:31], v[44:51], v1
    s_cmp_eq_u32 s30, 4
    s_nop 5
    v_add_f32 v22, v52, v54
    v_add_f32 v23, v56, v58
    ds_write_b64 v32, v[22:23]
    s_cbranch_scc0 L_skip_136
L_xw_137:
    ds_read2_b32 v[20:21], v33 offset0:0 offset1:32
    ds_read_b32 v22, v33 offset:256
    s_sub_u32 s56, s56, 1
    s_cbranch_scc1 L_done
    s_waitcnt lgkmcnt(0)
    v_max3_u32 v23, v20, v21, v22
    v_add_f32 v20, v20, v21
    v_cmp_eq_u32 vcc, -1, v23
    v_add_f32 v20, v20, v22
    s_cbranch_vccnz L_xw_137
    buffer_store_dword v20, v34, s[40:43], s60 offen sc1
    s_waitcnt vmcnt(1)
    s_branch L_pe_138
.p2align 5
L_skip_136:
    s_waitcnt vmcnt(0)
L_pe_138:
L_skip_128:
    s_branch L_p1
.p2align 5
L_typeB_0:
    s_cmp_eq_u32 s53, 3
    s_cbranch_scc0 L_typeC_139
    s_cmp_eq_u32 s30, 7
    s_cbranch_scc1 L_w7_150
    s_cmp_lt_u32 s30, 6
    s_cbranch_scc0 L_skip_152
    s_lshr_b32 s57, s30, 1
    s_mul_i32 s57, s57, 128
    s_and_b32 s58, s30, 1
    s_lshl_b32 s58, s58, 6
    s_add_u32 s57, s57, s58
    v_lshrrev_b32 v18, 5, v0
    v_lshlrev_b32 v18, 13, v18
    v_bfe_u32 v60, v0, 3, 1
    v_lshl_add_u32 v18, v60, 12, v18
    v_bfe_u32 v60, v0, 4, 1
    v_lshl_add_u32 v18, v60, 11, v18
    v_bfe_u32 v60, v0, 2, 1
    v_mul_u32_u24 v60, 384, v60
    v_add_u32 v18, v60, v18
    v_and_b32 v60, 3, v0
    v_lshl_add_u32 v18, v60, 3, v18
    v_add_u32 v18, s57, v18
    v_add_u32 v18, 30720, v18
    v_bfe_u32 v19, v0, 4, 1
    v_lshlrev_b32 v19, 12, v19
    v_bfe_u32 v60, v0, 3, 1
    v_lshl_add_u32 v19, v60, 11, v19
    v_bfe_u32 v60, v0, 2, 1
    v_mul_u32_u24 v60, 384, v60
    v_add_u32 v19, v60, v19
    v_and_b32 v60, 3, v0
    v_lshl_add_u32 v19, v60, 3, v19
    v_add_u32 v19, s57, v19
    v_add_u32 v19, 63488, v19
    ds_read_b64_tr_b16 v[28:29], v18 offset:0
    ds_read_b64_tr_b16 v[30:31], v18 offset:1024
    ds_read_b64_tr_b16 v[32:33], v18 offset:16384
L_pad5:
    s_cbranch_execz L_pad9
    ds_read_b64_tr_b16 v[34:35], v18 offset:17408
    ds_read_b64_tr_b16 v[36:37], v19 offset:0
    ds_read_b64_tr_b16 v[38:39], v19 offset:1024
    ds_read_b64_tr_b16 v[40:41], v18 offset:32
    ds_read_b64_tr_b16 v[42:43], v18 offset:1056
    ds_read_b64_tr_b16 v[44:45], v18 offset:16416
    ds_read_b64_tr_b16 v[46:47], v18 offset:17440
    ds_read_b64_tr_b16 v[48:49], v19 offset:32
    ds_read_b64_tr_b16 v[50:51], v19 offset:1056
    v_lshrrev_b32 v9, 4, v0
    v_lshlrev_b32 v9, 5, v9
    v_bfe_u32 v60, v0, 1, 1
    v_lshl_add_u32 v9, v60, 4, v9
    v_and_b32 v60, 1, v0
    v_mul_u32_u24 v60, 192, v60
    v_add_u32 v9, v60, v9
    v_add_u32 v9, 160832, v9
    v_lshrrev_b32 v10, 4, v0
    v_lshlrev_b32 v10, 4, v10
    v_bfe_u32 v60, v0, 1, 1
    v_lshl_add_u32 v10, v60, 3, v10
    v_and_b32 v60, 1, v0
    v_mul_u32_u24 v60, 192, v60
    v_add_u32 v10, v60, v10
    v_add_u32 v10, 160960, v10
    v_mov_b64 v[20:21], 0
    v_mov_b64 v[22:23], 0
    v_mov_b64 v[24:25], 0
    v_mov_b64 v[26:27], 0
    s_lshr_b32 s57, s30, 1
    s_lshl_b32 s57, s57, 11
    s_lshl_b32 s58, s58, 1
    s_add_u32 s57, s57, s58
    s_lshl_b32 s58, s54, 8
    s_add_u32 s57, s57, s58
    v_and_b32 v11, 31, v0
    v_lshlrev_b32 v11, 2, v11
    v_lshrrev_b32 v60, 5, v0
    v_lshl_add_u32 v11, v60, 30, v11
    v_add_u32 v11, s57, v11
    s_add_u32 s59, s62, 13312
    s_add_u32 s60, s62, 25856
    ds_read_b128 v[12:15], v9
    ds_read_b64 v[16:17], v10
    s_waitcnt lgkmcnt(1)
    v_smfmac_f32_16x16x64_bf16 v[20:23], v[12:15], v[28:35], v1
    v_smfmac_f32_16x16x64_bf16 v[24:27], v[12:15], v[40:47], v1
    s_waitcnt lgkmcnt(0)
    v_smfmac_f32_16x16x32_bf16 v[20:23], v[16:17], v[36:39], v1
    v_smfmac_f32_16x16x32_bf16 v[24:27], v[16:17], v[48:51], v1
    s_add_u32 s60, s62, 19456
    s_cmp_eq_u32 s55, 0
    s_nop 4
    v_add_f32 v12, v21, v23
    s_nop 1
    v_add_f32_dpp v12, v25, v27 quad_perm:[0,1,2,3] row_mask:0x2 bank_mask:0xf
    s_cbranch_scc1 L_gs_153
    buffer_store_dword v12, v11, s[40:43], s60 offen
L_gb_154:
    v_mov_b64 v[20:21], 0
    v_mov_b64 v[22:23], 0
    v_mov_b64 v[24:25], 0
    v_mov_b64 v[26:27], 0
L_skip_152:
    s_cmp_lt_u32 s30, 6
    s_barrier
    s_cbranch_scc0 L_se_151
    ds_read_b128 v[12:15], v9
    ds_read_b64 v[16:17], v10
    s_waitcnt lgkmcnt(1)
    v_smfmac_f32_16x16x64_bf16 v[20:23], v[12:15], v[28:35], v1
    v_smfmac_f32_16x16x64_bf16 v[24:27], v[12:15], v[40:47], v1
    s_waitcnt lgkmcnt(0)
    v_smfmac_f32_16x16x32_bf16 v[20:23], v[16:17], v[36:39], v1
    v_smfmac_f32_16x16x32_bf16 v[24:27], v[16:17], v[48:51], v1
    s_cmp_eq_u32 s55, 0
    s_nop 5
    v_add_f32 v12, v20, v22
    s_nop 1
    v_add_f32_dpp v12, v24, v26 quad_perm:[0,1,2,3] row_mask:0x2 bank_mask:0xf
    s_cbranch_scc1 L_gs_155
    buffer_store_dword v12, v11, s[40:43], s59 offen
L_gb_156:
L_se_151:
L_p1:
    s_lshl_b32 s57, s30, 7
    s_add_u32 s57, s57, 158720
    v_lshrrev_b32 v58, 4, v0
    v_lshlrev_b32 v58, 5, v58
    v_bfe_u32 v60, v0, 1, 1
    v_lshl_add_u32 v58, v60, 4, v58
L_pad6:
    s_cbranch_execz L_pad10
    v_bfe_u32 v60, v0, 2, 2
    v_lshl_add_u32 v58, v60, 2, v58
    v_and_b32 v60, 1, v0
    v_lshl_add_u32 v58, v60, 1, v58
    v_add_u32 v58, s57, v58
    v_lshrrev_b32 v61, 4, v0
    v_lshlrev_b32 v61, 5, v61
    v_bfe_u32 v60, v0, 1, 1
    v_lshl_add_u32 v61, v60, 4, v61
    v_add_u32 v61, s57, v61
    v_bfe_u32 v62, v0, 2, 2
    v_lshlrev_b32 v62, 1, v62
    v_and_b32 v60, 1, v0
    v_lshl_add_u32 v62, v60, 0, v62
    v_mov_b32 v60, 160992
    v_cmp_eq_u32 vcc, 0, v62
    s_nop 1
    v_cndmask_b32 v52, v60, v61, vcc
    v_cmp_eq_u32 vcc, 1, v62
    s_nop 1
    v_cndmask_b32 v53, v60, v61, vcc
    v_cmp_eq_u32 vcc, 2, v62
    s_nop 1
    v_cndmask_b32 v54, v60, v61, vcc
    v_cmp_eq_u32 vcc, 3, v62
    s_nop 1
    v_cndmask_b32 v55, v60, v61, vcc
    v_cmp_eq_u32 vcc, 4, v62
    s_nop 1
    v_cndmask_b32 v56, v60, v61, vcc
    v_cmp_eq_u32 vcc, 5, v62
    s_nop 1
    v_cndmask_b32 v57, v60, v61, vcc
    s_lshl_b32 s58, s30, 2
    s_add_u32 s58, s58, 159808
    v_mov_b32 v60, s58
    v_lshlrev_b32 v59, 2, v0
    v_add_u32 v59, 158208, v59
    v_cmp_eq_u32 vcc, 63, v0
    s_nop 1
    v_cndmask_b32 v59, v59, v60, vcc
    v_and_b32 v62, 7, v0
    v_lshlrev_b32 v62, 2, v62
    v_add_u32 v62, 159808, v62
    s_lshl_b32 s57, s30, 11
    v_lshlrev_b32 v63, 4, v0
    v_add_u32 v63, s57, v63
    v_add_u32 v63, 92160, v63
    s_sub_u32 s57, s30, 1
    s_lshl_b32 s58, s57, 11
    v_lshlrev_b32 v7, 4, v0
    v_add_u32 v7, s58, v7
    s_lshl_b32 s58, s57, 7
    v_bfe_u32 v8, v0, 2, 2
    v_lshlrev_b32 v8, 5, v8
    v_lshrrev_b32 v60, 5, v0
    v_lshl_add_u32 v8, v60, 4, v8
    v_and_b32 v60, 3, v0
    v_lshl_add_u32 v8, v60, 2, v8
    v_bfe_u32 v60, v0, 4, 1
    v_lshl_add_u32 v8, v60, 1, v8
    v_add_u32 v8, s58, v8
    v_add_u32 v8, 124928, v8
    s_cmp_eq_u32 s30, 7
    s_cbranch_scc1 L_w7_164
    s_cmp_lt_u32 s30, 6
    s_cbranch_scc0 L_skip_166
    s_lshr_b32 s57, s30, 1
    s_mul_i32 s57, s57, 1024
    s_and_b32 s58, s30, 1
    s_lshl_b32 s58, s58, 6
    s_add_u32 s57, s57, s58
    v_lshrrev_b32 v18, 5, v0
    v_mul_u32_u24 v18, 6144, v18
    v_bfe_u32 v60, v0, 3, 1
    v_mul_u32_u24 v60, 3072, v60
    v_add_u32 v18, v60, v18
    v_bfe_u32 v60, v0, 4, 1
    v_lshl_add_u32 v18, v60, 9, v18
    v_bfe_u32 v60, v0, 2, 1
    v_lshl_add_u32 v18, v60, 7, v18
    v_and_b32 v60, 3, v0
    v_lshl_add_u32 v18, v60, 3, v18
    v_add_u32 v18, s57, v18
    v_bfe_u32 v19, v0, 4, 1
    v_mul_u32_u24 v19, 3072, v19
    v_bfe_u32 v60, v0, 3, 1
    v_lshl_add_u32 v19, v60, 9, v19
    v_bfe_u32 v60, v0, 2, 1
    v_lshl_add_u32 v19, v60, 7, v19
    v_and_b32 v60, 3, v0
    v_lshl_add_u32 v19, v60, 3, v19
    v_add_u32 v19, s57, v19
L_pad7:
    s_cbranch_execz L_pad11
    v_add_u32 v19, 24576, v19
    ds_read_b64_tr_b16 v[28:29], v18 offset:0
    ds_read_b64_tr_b16 v[30:31], v18 offset:256
    ds_read_b64_tr_b16 v[32:33], v18 offset:12288
    ds_read_b64_tr_b16 v[34:35], v18 offset:12544
    ds_read_b64_tr_b16 v[36:37], v19 offset:0
    ds_read_b64_tr_b16 v[38:39], v19 offset:256
    ds_read_b64_tr_b16 v[40:41], v18 offset:32
    ds_read_b64_tr_b16 v[42:43], v18 offset:288
    ds_read_b64_tr_b16 v[44:45], v18 offset:12320
    ds_read_b64_tr_b16 v[46:47], v18 offset:12576
    ds_read_b64_tr_b16 v[48:49], v19 offset:32
    ds_read_b64_tr_b16 v[50:51], v19 offset:288
    v_lshrrev_b32 v9, 4, v0
    v_lshlrev_b32 v9, 5, v9
    v_bfe_u32 v60, v0, 1, 1
    v_lshl_add_u32 v9, v60, 4, v9
    v_and_b32 v60, 1, v0
    v_mul_u32_u24 v60, 192, v60
    v_add_u32 v9, v60, v9
    v_add_u32 v9, 160832, v9
    v_lshrrev_b32 v10, 4, v0
    v_lshlrev_b32 v10, 4, v10
    v_bfe_u32 v60, v0, 1, 1
    v_lshl_add_u32 v10, v60, 3, v10
    v_and_b32 v60, 1, v0
    v_mul_u32_u24 v60, 192, v60
    v_add_u32 v10, v60, v10
    v_add_u32 v10, 160960, v10
    v_mov_b64 v[20:21], 0
    v_mov_b64 v[22:23], 0
    v_mov_b64 v[24:25], 0
    v_mov_b64 v[26:27], 0
    s_lshr_b32 s57, s30, 1
    s_lshl_b32 s57, s57, 11
    s_lshl_b32 s58, s58, 1
    s_add_u32 s57, s57, s58
    s_lshl_b32 s58, s54, 8
    s_add_u32 s57, s57, s58
    v_and_b32 v11, 31, v0
    v_lshlrev_b32 v11, 2, v11
    v_lshrrev_b32 v60, 5, v0
    v_lshl_add_u32 v11, v60, 30, v11
    v_add_u32 v11, s57, v11
    s_mul_i32 s59, s53, 6144
    s_add_u32 s59, s59, s62
    s_add_u32 s59, s59, 46080
    s_lshl_b32 s60, s53, 6
    s_add_u32 s60, s60, s62
    s_add_u32 s60, s60, 25600
L_skip_166:
    s_cmp_lt_u32 s30, 6
    s_barrier
    s_cbranch_scc0 L_se_165
    ds_read_b128 v[12:15], v9
    ds_read_b64 v[16:17], v10
    s_waitcnt lgkmcnt(1)
    v_smfmac_f32_16x16x64_bf16 v[20:23], v[12:15], v[28:35], v1
    v_smfmac_f32_16x16x64_bf16 v[24:27], v[12:15], v[40:47], v1
    s_waitcnt lgkmcnt(0)
    v_smfmac_f32_16x16x32_bf16 v[20:23], v[16:17], v[36:39], v1
    v_smfmac_f32_16x16x32_bf16 v[24:27], v[16:17], v[48:51], v1
    s_cmp_eq_u32 s55, 0
    s_nop 5
    v_add_f32 v12, v20, v22
    s_nop 1
    v_add_f32_dpp v12, v24, v26 quad_perm:[0,1,2,3] row_mask:0x2 bank_mask:0xf
    s_cbranch_scc1 L_gs_167
    buffer_store_dword v12, v11, s[40:43], s59 offen
L_gb_168:
L_se_165:
    s_sub_u32 s57, s30, 1
    s_cmp_lt_u32 s57, 3
    s_cbranch_scc0 L_qo_182
    v_and_b32 v9, 7, v0
    v_lshlrev_b32 v9, 3, v9
    buffer_load_dwordx2 v[10:11], v9, s[40:43], s60 offen sc1
    buffer_load_dwordx4 v[40:43], v7, s[40:43], s59 offen offset:0 sc1
    buffer_load_dwordx4 v[44:47], v7, s[40:43], s59 offen offset:1024 sc1
    v_mov_b64 v[24:25], 0
    v_mov_b64 v[26:27], 0
    v_mov_b64 v[28:29], 0
    v_mov_b64 v[30:31], 0
    v_mov_b64 v[32:33], 0
    v_mov_b64 v[34:35], 0
    v_mov_b64 v[36:37], 0
    v_mov_b64 v[38:39], 0
    v_lshrrev_b32 v5, 4, v0
    v_lshlrev_b32 v5, 5, v5
    v_bfe_u32 v60, v0, 1, 1
    v_lshl_add_u32 v5, v60, 4, v5
    v_add_u32 v5, 124928, v5
L_pad8:
    s_cbranch_execz L_pad12
    v_mov_b32 v60, 0x3c75e03e
    v_mov_b32 v61, 0x3a71d1e6
    v_mov_b32 v51, 0x3e13985d
    s_branch L_pw_184
.p2align 5
L_pr_185:
    buffer_load_dwordx2 v[10:11], v9, s[40:43], s60 offen sc1
    buffer_load_dwordx4 v[40:43], v7, s[40:43], s59 offen offset:0 sc1
    buffer_load_dwordx4 v[44:47], v7, s[40:43], s59 offen offset:1024 sc1
    s_sub_u32 s56, s56, 1
    s_cbranch_scc1 L_done
L_pw_184:
    s_waitcnt vmcnt(0)
    v_max_u32 v20, v10, v11
    v_cmp_eq_u32 vcc, -1, v20
    s_cbranch_vccnz L_pr_185
    buffer_load_dwordx4 v[40:43], v7, s[40:43], s59 offen offset:0 sc1
    buffer_load_dwordx4 v[44:47], v7, s[40:43], s59 offen offset:1024 sc1
    v_add_f32_dpp v48, v10, v10 row_ror:4 row_mask:0xf bank_mask:0xf
    v_add_f32_dpp v49, v11, v11 row_ror:4 row_mask:0xf bank_mask:0xf
    v_pk_add_f32 v[20:21], v[40:41], v[44:45]
    v_pk_add_f32 v[22:23], v[42:43], v[46:47]
    v_add_f32_dpp v48, v48, v48 row_ror:2 row_mask:0xf bank_mask:0xf
    v_add_f32_dpp v49, v49, v49 row_ror:2 row_mask:0xf bank_mask:0xf
    v_permlane32_swap_b32 v20, v22
    v_permlane32_swap_b32 v21, v23
    v_add_f32_dpp v48, v48, v48 row_ror:1 row_mask:0xf bank_mask:0xf
    v_add_f32_dpp v49, v49, v49 row_ror:1 row_mask:0xf bank_mask:0xf
    v_pk_add_f32 v[20:21], v[20:21], v[22:23]
    v_mul_f32 v48, v48, v60
    v_fma_f32 v49, v49, v51, v61
    v_permlane16_swap_b32 v20, v21
    v_fma_f32 v49, -v48, v48, v49
    v_add_f32 v20, v20, v21
    v_max_f32 v49, v49, v61
    v_mul_f32 v50, v6, v48
    v_rsq_f32 v49, v49
    v_cmp_u_f32 vcc, v20, v20
    v_sub_f32 v20, v20, v50
    s_cbranch_vccnz L_hr_186
L_hk_187:
    v_mul_f32 v20, v20, v49
    v_cvt_pk_bf16_f32 v20, v20, v20
    ds_write_b16 v8, v20
L_qb_183:
    s_waitcnt lgkmcnt(0)
    s_barrier
    ds_read_b128 v[12:15], v5 offset:0
    ds_read_b128 v[16:19], v5 offset:128
    ds_read_b128 v[20:23], v5 offset:256
    s_cmp_lt_u32 s30, 4
    s_waitcnt lgkmcnt(0)
    v_smfmac_f32_16x16x64_bf16 v[24:27], v[12:15], v[64:71], v1
    v_smfmac_f32_16x16x64_bf16 v[24:27], v[16:19], v[72:79], v1
    v_smfmac_f32_16x16x64_bf16 v[24:27], v[20:23], v[80:87], v1
    v_smfmac_f32_16x16x64_bf16 v[28:31], v[12:15], v[88:95], v1
    v_smfmac_f32_16x16x64_bf16 v[28:31], v[16:19], v[96:103], v1
    v_smfmac_f32_16x16x64_bf16 v[28:31], v[20:23], v[104:111], v1
    v_smfmac_f32_16x16x64_bf16 v[32:35], v[12:15], v[112:119], v1
    v_smfmac_f32_16x16x64_bf16 v[32:35], v[16:19], v[120:127], v1
    v_smfmac_f32_16x16x64_bf16 v[32:35], v[20:23], v[128:135], v1
    v_smfmac_f32_16x16x64_bf16 v[36:39], v[12:15], v[136:143], v1
    v_smfmac_f32_16x16x64_bf16 v[36:39], v[16:19], v[144:151], v1
    v_smfmac_f32_16x16x64_bf16 v[36:39], v[20:23], v[152:159], v1
    v_add_f32 v24, v24, v26
    s_waitcnt vmcnt(0)
    v_add_f32 v28, v28, v30
    s_nop 1
    v_add_f32 v32, v32, v34
    v_max3_f32 v61, v24, v28, v32
    v_mov_b32_dpp v24, v28 quad_perm:[0,1,2,3] row_mask:0x2 bank_mask:0xf
    v_add_f32 v36, v36, v38
    v_max_f32 v61, v61, v36
    v_mov_b32_dpp v24, v32 quad_perm:[0,1,2,3] row_mask:0x4 bank_mask:0xf
    s_nop 0
    v_max_f32_dpp v61, v61, v61 row_ror:8 row_mask:0xf bank_mask:0xf
    s_nop 0
    v_mov_b32_dpp v24, v36 quad_perm:[0,1,2,3] row_mask:0x8 bank_mask:0xf
    v_max_f32_dpp v61, v61, v61 row_ror:4 row_mask:0xf bank_mask:0xf
    s_nop 1
    v_max_f32_dpp v61, v61, v61 row_ror:2 row_mask:0xf bank_mask:0xf
L_pad9:
    s_cbranch_execz L_pad13
    s_nop 1
    v_max_f32_dpp v61, v61, v61 row_ror:1 row_mask:0xf bank_mask:0xf
    v_sub_f32 v36, v24, v61
    ds_write_b32 v59, v61
    v_exp_f32 v36, v36
    s_nop 0
    v_cvt_pk_bf16_f32 v39, v36, v36
    ds_write_b16 v58, v39
    ds_read_b128 v[12:15], v52
    ds_read_b128 v[16:19], v53
    ds_read_b128 v[20:23], v54
    ds_read_b128 v[24:27], v55
    ds_read_b128 v[28:31], v56
    ds_read_b128 v[32:35], v57
    v_add_f32_dpp v38, v36, v36 row_ror:8 row_mask:0xf bank_mask:0xf
    v_mov_b64 v[40:41], 0
    v_mov_b64 v[42:43], 0
    v_add_f32_dpp v38, v38, v38 row_ror:4 row_mask:0xf bank_mask:0xf
    v_mov_b64 v[44:45], 0
    v_mov_b64 v[46:47], 0
    s_waitcnt lgkmcnt(5)
    v_smfmac_f32_16x16x64_bf16 v[40:43], v[12:15], v[160:167], v1
    v_add_f32_dpp v38, v38, v38 row_ror:2 row_mask:0xf bank_mask:0xf
    v_smfmac_f32_16x16x64_bf16 v[44:47], v[12:15], v[208:215], v1
    ds_read_b32 v36, v62
    s_waitcnt lgkmcnt(5)
    v_smfmac_f32_16x16x64_bf16 v[40:43], v[16:19], v[168:175], v1
    v_add_f32_dpp v38, v38, v38 row_ror:1 row_mask:0xf bank_mask:0xf
    v_smfmac_f32_16x16x64_bf16 v[44:47], v[16:19], v[216:223], v1
    s_waitcnt lgkmcnt(4)
    v_smfmac_f32_16x16x64_bf16 v[40:43], v[20:23], v[176:183], v1
    v_add_f32_dpp v38, v38, v38 row_bcast:15 row_mask:0xa bank_mask:0xf
    v_smfmac_f32_16x16x64_bf16 v[44:47], v[20:23], v[224:231], v1
    s_waitcnt lgkmcnt(0)
    v_max_f32_dpp v37, v36, v36 row_ror:4 row_mask:0xf bank_mask:0xf
    v_smfmac_f32_16x16x64_bf16 v[40:43], v[24:27], v[184:191], v1
    v_add_f32_dpp v38, v38, v38 row_bcast:31 row_mask:0xc bank_mask:0xf
    v_smfmac_f32_16x16x64_bf16 v[44:47], v[24:27], v[232:239], v1
    v_max_f32_dpp v37, v37, v37 row_ror:2 row_mask:0xf bank_mask:0xf
    v_smfmac_f32_16x16x64_bf16 v[40:43], v[28:31], v[192:199], v1
    v_cmp_eq_u32 vcc, -1, v36
    v_smfmac_f32_16x16x64_bf16 v[44:47], v[28:31], v[240:247], v1
    v_max_f32_dpp v37, v37, v37 row_ror:1 row_mask:0xf bank_mask:0xf
    v_smfmac_f32_16x16x64_bf16 v[40:43], v[32:35], v[200:207], v1
    v_sub_f32 v39, v61, v37
    v_smfmac_f32_16x16x64_bf16 v[44:47], v[32:35], v[248:255], v1
    v_exp_f32 v39, v39
    s_cbranch_vccnz L_mr_189
L_mk_190:
    v_mul_f32 v38, v38, v39
    ds_write_b32 v63, v38 offset:1024
    s_cmp_lt_u32 s30, 2
    s_nop 0
    v_pk_add_f32 v[40:41], v[40:41], v[42:43]
    s_nop 0
    v_pk_add_f32 v[42:43], v[44:45], v[46:47]
    v_pk_mul_f32 v[40:41], v[40:41], v[38:39] op_sel:[0,1] op_sel_hi:[1,1]
    v_pk_mul_f32 v[42:43], v[42:43], v[38:39] op_sel:[0,1] op_sel_hi:[1,1]
    ds_write_b128 v63, v[40:43]
    s_cbranch_scc1 L_comb_1
    s_waitcnt lgkmcnt(0)
    s_barrier
L_comb_1b:
    s_cmp_lt_u32 s3, 20
    s_cbranch_scc0 L_typeB_1
    s_mul_i32 s74, s30, 1664
    s_add_u32 s74, s74, s62
    s_add_u32 s74, s74, 26624
    v_and_b32 v56, 7, v0
    v_lshlrev_b32 v56, 2, v56
    v_lshrrev_b32 v62, 4, v0
    v_lshlrev_b32 v62, 3, v62
    buffer_load_dword v52, v56, s[40:43], s74 offen offset:1536 sc1
    buffer_load_dwordx2 v[54:55], v62, s[40:43], s74 offen offset:1536 sc1
    v_lshlrev_b32 v57, 4, v0
    v_lshlrev_b32 v58, 3, v0
    s_mul_i32 s57, s30, 6144
    s_add_u32 s57, s57, 30720
    v_lshrrev_b32 v59, 2, v0
    v_lshlrev_b32 v59, 6, v59
    v_bfe_u32 v53, v0, 4, 1
    v_lshl_add_u32 v59, v53, 5, v59
    v_and_b32 v53, 3, v0
L_pad10:
    s_cbranch_execz L_pad14
    v_lshl_add_u32 v59, v53, 3, v59
    v_add_u32 v59, s57, v59
    v_xor_b32 v60, 32, v59
    s_lshl_b32 s57, s30, 8
    s_add_u32 s57, s57, 157696
    v_lshl_add_u32 v61, v0, 2, s57
    ds_read_b64_tr_b16 v[28:29], v59 offset:0
    ds_read_b64_tr_b16 v[30:31], v59 offset:1024
    ds_read_b64_tr_b16 v[32:33], v59 offset:2048
    ds_read_b64_tr_b16 v[34:35], v59 offset:3072
    ds_read_b64_tr_b16 v[36:37], v59 offset:4096
    ds_read_b64_tr_b16 v[38:39], v59 offset:5120
    ds_read_b64_tr_b16 v[40:41], v60 offset:0
    ds_read_b64_tr_b16 v[42:43], v60 offset:1024
    ds_read_b64_tr_b16 v[44:45], v60 offset:2048
    ds_read_b64_tr_b16 v[46:47], v60 offset:3072
    ds_read_b64_tr_b16 v[48:49], v60 offset:4096
    ds_read_b64_tr_b16 v[50:51], v60 offset:5120
    v_mov_b64 v[20:21], 0
    v_mov_b64 v[22:23], 0
    v_mov_b64 v[24:25], 0
    v_mov_b64 v[26:27], 0
    s_add_u32 s58, s6, 132096
    s_branch L_pw_197
.p2align 5
L_pr_198:
    buffer_load_dword v52, v56, s[40:43], s74 offen offset:1536 sc1
    buffer_load_dwordx2 v[54:55], v62, s[40:43], s74 offen offset:1536 sc1
    s_sub_u32 s56, s56, 1
    s_cbranch_scc1 L_done
L_pw_197:
    s_waitcnt vmcnt(0)
    v_max3_u32 v53, v52, v54, v55
    v_cmp_eq_u32 vcc, -1, v53
    s_cbranch_vccnz L_pr_198
    buffer_load_dwordx4 v[12:15], v57, s[40:43], s74 offen sc1
    buffer_load_dwordx2 v[16:17], v58, s[40:43], s74 offen offset:1024 sc1
    buffer_load_dword v18, v56, s[40:43], s74 offen offset:1568 sc1
    v_max_f32_dpp v53, v52, v52 row_ror:4 row_mask:0xf bank_mask:0xf
    s_nop 1
    v_max_f32_dpp v53, v53, v53 row_ror:2 row_mask:0xf bank_mask:0xf
    s_nop 1
    v_max_f32_dpp v53, v53, v53 row_ror:1 row_mask:0xf bank_mask:0xf
    v_sub_f32 v52, v52, v53
    v_sub_f32 v54, v54, v53
    v_sub_f32 v55, v55, v53
    v_exp_f32 v52, v52
    v_exp_f32 v54, v54
    v_exp_f32 v55, v55
    s_waitcnt lgkmcnt(0)
    s_branch L_ow_199
.p2align 5
L_or_200:
    buffer_load_dwordx4 v[12:15], v57, s[40:43], s74 offen sc1
    buffer_load_dwordx2 v[16:17], v58, s[40:43], s74 offen offset:1024 sc1
    buffer_load_dword v18, v56, s[40:43], s74 offen offset:1568 sc1
    s_sub_u32 s56, s56, 1
    s_cbranch_scc1 L_done
    v_mov_b64 v[20:21], 0
    v_mov_b64 v[22:23], 0
    v_mov_b64 v[24:25], 0
    v_mov_b64 v[26:27], 0
L_ow_199:
    s_waitcnt vmcnt(2)
    v_smfmac_f32_16x16x64_bf16 v[20:23], v[12:15], v[28:35], v1
    v_max3_u32 v19, v12, v13, v14
    v_smfmac_f32_16x16x64_bf16 v[24:27], v[12:15], v[40:47], v1
    s_waitcnt vmcnt(0)
    v_mul_f32 v53, v52, v18
    v_smfmac_f32_16x16x32_bf16 v[20:23], v[16:17], v[36:39], v1
    v_max3_u32 v62, v15, v16, v17
    v_smfmac_f32_16x16x32_bf16 v[24:27], v[16:17], v[48:51], v1
    v_max3_u32 v19, v19, v62, v18
    v_add_f32_dpp v53, v53, v53 row_ror:4 row_mask:0xf bank_mask:0xf
    v_cmp_eq_u32 vcc, -1, v19
    s_cmp_eq_u32 s30, 2
    v_add_f32_dpp v53, v53, v53 row_ror:2 row_mask:0xf bank_mask:0xf
    s_cbranch_vccnz L_or_200
    s_nop 0
    v_add_f32_dpp v53, v53, v53 row_ror:1 row_mask:0xf bank_mask:0xf
    v_rcp_f32 v52, v53
L_pad11:
    s_cbranch_execz L_pad15
    v_pk_add_f32 v[20:21], v[20:21], v[22:23]
    v_pk_add_f32 v[24:25], v[24:25], v[26:27]
    v_pk_mul_f32 v[54:55], v[54:55], v[52:53] op_sel:[0,0] op_sel_hi:[1,0]
    v_mul_f32 v20, v20, v54
    v_mul_f32 v24, v24, v54
    v_fmac_f32 v20, v21, v55
    v_fmac_f32 v24, v25, v55
    s_nop 1
    v_permlane32_swap_b32 v20, v24
    v_add_f32 v20, v20, v24
    ds_write_b32 v61, v20
    s_waitcnt lgkmcnt(0)
    s_barrier
    s_cbranch_scc0 L_finb_201
    ds_read2st64_b32 v[12:13], v2 offset0:0 offset1:1
    ds_read2st64_b32 v[14:15], v2 offset0:2 offset1:3
    ds_read2st64_b32 v[16:17], v2 offset0:4 offset1:5
    ds_read2st64_b32 v[18:19], v2 offset0:6 offset1:7
    s_waitcnt lgkmcnt(2)
    v_pk_add_f32 v[12:13], v[12:13], v[14:15]
    s_waitcnt lgkmcnt(0)
    v_pk_add_f32 v[16:17], v[16:17], v[18:19]
    v_pk_add_f32 v[12:13], v[12:13], v[16:17]
    v_add_f32 v14, v12, v13
    v_add_f32 v15, v12, v13
    s_nop 1
    v_permlane16_swap_b32 v14, v15
    v_add_f32 v12, v14, v15
    buffer_store_dword v12, v3, s[40:43], s58 offen sc1
L_finb_201:
    s_sub_u32 s57, s30, 4
    s_cmp_lt_u32 s57, 3
    s_cbranch_scc0 L_skip_202
    s_sub_u32 s60, s30, 4
    s_lshl_b32 s57, s60, 11
    v_lshlrev_b32 v11, 4, v0
    v_add_u32 v11, s57, v11
    s_add_u32 s65, s62, 19456
    buffer_load_dwordx4 v[52:55], v11, s[40:43], s65 offen offset:0 sc1
    buffer_load_dwordx4 v[56:59], v11, s[40:43], s65 offen offset:1024 sc1
    s_lshl_b32 s59, s60, 12
    s_add_u32 s59, s59, 79872
    v_bfe_u32 v35, v0, 4, 1
    v_lshlrev_b32 v35, 11, v35
    v_bfe_u32 v60, v0, 2, 2
    v_lshl_add_u32 v35, v60, 8, v35
    v_lshrrev_b32 v60, 5, v0
    v_lshl_add_u32 v35, v60, 6, v35
    v_and_b32 v60, 3, v0
    v_lshl_add_u32 v35, v60, 3, v35
    v_add_u32 v35, s59, v35
    v_mov_b32 v9, 0xbdd2d3e8
    v_mov_b32 v10, 0xc0135761
    s_lshl_b32 s57, s60, 7
    s_add_u32 s57, s57, 160256
    v_lshlrev_b32 v32, 3, v0
    v_add_u32 v32, s57, v32
    v_lshlrev_b32 v33, 3, v0
    v_add_u32 v33, 129024, v33
    v_cmp_gt_u32 vcc, 16, v0
    s_nop 1
    v_cndmask_b32 v32, v33, v32, vcc
    v_and_b32 v33, 15, v0
    v_lshlrev_b32 v33, 3, v33
    v_lshrrev_b32 v60, 5, v0
    v_lshl_add_u32 v33, v60, 2, v33
    v_add_u32 v33, 160256, v33
    v_and_b32 v34, 15, v0
    v_lshlrev_b32 v34, 2, v34
    v_lshrrev_b32 v60, 5, v0
    v_lshl_add_u32 v34, v60, 6, v34
    v_bfe_u32 v60, v0, 4, 1
    v_lshl_add_u32 v34, v60, 13, v34
    s_add_u32 s60, s6, 198144
    s_add_u32 s58, s62, 39936
    s_add_u32 s57, s62, 25984
    v_and_b32 v7, 7, v0
    v_lshlrev_b32 v7, 3, v7
    v_mov_b32 v60, 0x3acccccd
    v_mov_b32 v61, 0x3727c5ac
    s_waitcnt vmcnt(0)
    buffer_load_dwordx2 v[24:25], v7, s[40:43], s57 offen sc1
    buffer_load_dwordx4 v[12:15], v11, s[40:43], s58 offen offset:0 sc1
    buffer_load_dwordx4 v[16:19], v11, s[40:43], s58 offen offset:1024 sc1
    ds_read_b64_tr_b16 v[36:37], v35 offset:0
    ds_read_b64_tr_b16 v[38:39], v35 offset:1024
    ds_read_b64_tr_b16 v[40:41], v35 offset:128
L_pad12:
    s_cbranch_execz L_pad16
    ds_read_b64_tr_b16 v[42:43], v35 offset:1152
    ds_read_b64_tr_b16 v[44:45], v35 offset:32
    ds_read_b64_tr_b16 v[46:47], v35 offset:1056
    ds_read_b64_tr_b16 v[48:49], v35 offset:160
    ds_read_b64_tr_b16 v[50:51], v35 offset:1184
L_sw_205:
    v_max3_u32 v20, v52, v53, v54
    v_max3_u32 v20, v20, v55, v56
    v_max3_u32 v20, v20, v57, v58
    v_max_u32 v20, v20, v59
    v_cmp_eq_u32 vcc, -1, v20
    s_cbranch_vccnz L_sr_206
    v_pk_add_f32 v[28:29], v[52:53], v[56:57]
    v_pk_add_f32 v[30:31], v[54:55], v[58:59]
    s_nop 1
    v_permlane32_swap_b32 v28, v30
    v_permlane32_swap_b32 v29, v31
    v_pk_add_f32 v[28:29], v[28:29], v[30:31]
    s_nop 1
    v_permlane16_swap_b32 v28, v29
    v_add_f32 v28, v28, v29
    v_mov_b64 v[52:53], 0
    v_mov_b64 v[54:55], 0
    v_mov_b64 v[56:57], 0
    v_mov_b64 v[58:59], 0
    s_waitcnt lgkmcnt(0)
    s_branch L_pw_203
.p2align 5
L_pr_204:
    buffer_load_dwordx2 v[24:25], v7, s[40:43], s57 offen sc1
    buffer_load_dwordx4 v[12:15], v11, s[40:43], s58 offen offset:0 sc1
    buffer_load_dwordx4 v[16:19], v11, s[40:43], s58 offen offset:1024 sc1
    s_sub_u32 s56, s56, 1
    s_cbranch_scc1 L_done
L_pw_203:
    s_waitcnt vmcnt(0)
    v_max_u32 v20, v24, v25
    v_cmp_eq_u32 vcc, -1, v20
    s_cbranch_vccnz L_pr_204
    buffer_load_dwordx4 v[12:15], v11, s[40:43], s58 offen offset:0 sc1
    buffer_load_dwordx4 v[16:19], v11, s[40:43], s58 offen offset:1024 sc1
    v_add_f32_dpp v2, v24, v24 row_ror:4 row_mask:0xf bank_mask:0xf
    v_add_f32_dpp v3, v25, v25 row_ror:4 row_mask:0xf bank_mask:0xf
    v_pk_add_f32 v[20:21], v[12:13], v[16:17]
    v_pk_add_f32 v[22:23], v[14:15], v[18:19]
    v_add_f32_dpp v2, v2, v2 row_ror:2 row_mask:0xf bank_mask:0xf
    v_add_f32_dpp v3, v3, v3 row_ror:2 row_mask:0xf bank_mask:0xf
    v_permlane32_swap_b32 v20, v22
    v_permlane32_swap_b32 v21, v23
    v_add_f32_dpp v2, v2, v2 row_ror:1 row_mask:0xf bank_mask:0xf
    v_add_f32_dpp v3, v3, v3 row_ror:1 row_mask:0xf bank_mask:0xf
    v_pk_add_f32 v[20:21], v[20:21], v[22:23]
    v_mul_f32 v2, v2, v60
    v_fma_f32 v3, v3, v60, v61
    v_permlane16_swap_b32 v20, v21
    v_fma_f32 v3, -v2, v2, v3
    v_add_f32 v20, v20, v21
    v_max_f32 v3, v3, v61
    v_mul_f32 v26, v28, v2
    v_rsq_f32 v3, v3
    v_cmp_u_f32 vcc, v20, v20
    v_sub_f32 v20, v20, v26
    s_cbranch_vccnz L_hr_207
L_hk_208:
    v_fma_f32 v20, v20, v3, v4
    v_mul_f32 v21, v20, v20
    v_fma_f32 v21, v21, v9, v10
    v_mul_f32 v21, v21, v20
    v_exp_f32 v21, v21
    s_nop 0
    v_add_f32 v21, 1.0, v21
    v_rcp_f32 v21, v21
    s_nop 0
    v_mul_f32 v20, v20, v21
    s_nop 1
    v_mov_b32_dpp v21, v20 row_shl:1 row_mask:0xf bank_mask:0xf bound_ctrl:0
    v_cvt_pk_bf16_f32 v28, v20, v21
    s_nop 1
    v_mov_b32_dpp v29, v28 row_shl:4 row_mask:0xf bank_mask:0xf bound_ctrl:0
    v_mov_b32_dpp v30, v28 row_shl:8 row_mask:0xf bank_mask:0xf bound_ctrl:0
    v_mov_b32_dpp v31, v28 row_shl:12 row_mask:0xf bank_mask:0xf bound_ctrl:0
    s_nop 1
    v_smfmac_f32_16x16x64_bf16 v[52:55], v[28:31], v[36:43], v1
    v_smfmac_f32_16x16x64_bf16 v[56:59], v[28:31], v[44:51], v1
    s_cmp_eq_u32 s30, 4
    s_nop 5
    v_add_f32 v22, v52, v54
    v_add_f32 v23, v56, v58
    ds_write_b64 v32, v[22:23]
    s_cbranch_scc0 L_skip_210
L_xw_211:
    ds_read2_b32 v[20:21], v33 offset0:0 offset1:32
    ds_read_b32 v22, v33 offset:256
L_pad13:
    s_cbranch_execz L_pad17
    s_sub_u32 s56, s56, 1
    s_cbranch_scc1 L_done
    s_waitcnt lgkmcnt(0)
    v_max3_u32 v23, v20, v21, v22
    v_add_f32 v20, v20, v21
    v_cmp_eq_u32 vcc, -1, v23
    v_add_f32 v20, v20, v22
    s_cbranch_vccnz L_xw_211
    buffer_store_dword v20, v34, s[40:43], s60 offen sc1
L_skip_210:
L_skip_202:
    s_branch L_done
.p2align 5
L_typeB_1:
    s_cmp_eq_u32 s53, 3
    s_cbranch_scc0 L_typeC_212
    s_cmp_eq_u32 s30, 7
    s_cbranch_scc1 L_w7_217
    s_cmp_lt_u32 s30, 6
    s_cbranch_scc0 L_skip_219
    s_lshr_b32 s57, s30, 1
    s_mul_i32 s57, s57, 128
    s_and_b32 s58, s30, 1
    s_lshl_b32 s58, s58, 6
    s_add_u32 s57, s57, s58
    v_lshrrev_b32 v18, 5, v0
    v_lshlrev_b32 v18, 13, v18
    v_bfe_u32 v60, v0, 3, 1
    v_lshl_add_u32 v18, v60, 12, v18
    v_bfe_u32 v60, v0, 4, 1
    v_lshl_add_u32 v18, v60, 11, v18
    v_bfe_u32 v60, v0, 2, 1
    v_mul_u32_u24 v60, 384, v60
    v_add_u32 v18, v60, v18
    v_and_b32 v60, 3, v0
    v_lshl_add_u32 v18, v60, 3, v18
    v_add_u32 v18, s57, v18
    v_add_u32 v18, 30720, v18
    v_bfe_u32 v19, v0, 4, 1
    v_lshlrev_b32 v19, 12, v19
    v_bfe_u32 v60, v0, 3, 1
    v_lshl_add_u32 v19, v60, 11, v19
    v_bfe_u32 v60, v0, 2, 1
    v_mul_u32_u24 v60, 384, v60
    v_add_u32 v19, v60, v19
    v_and_b32 v60, 3, v0
    v_lshl_add_u32 v19, v60, 3, v19
    v_add_u32 v19, s57, v19
    v_add_u32 v19, 63488, v19
    ds_read_b64_tr_b16 v[28:29], v18 offset:0
    ds_read_b64_tr_b16 v[30:31], v18 offset:1024
    ds_read_b64_tr_b16 v[32:33], v18 offset:16384
    ds_read_b64_tr_b16 v[34:35], v18 offset:17408
    ds_read_b64_tr_b16 v[36:37], v19 offset:0
    ds_read_b64_tr_b16 v[38:39], v19 offset:1024
    ds_read_b64_tr_b16 v[40:41], v18 offset:32
    ds_read_b64_tr_b16 v[42:43], v18 offset:1056
    ds_read_b64_tr_b16 v[44:45], v18 offset:16416
    ds_read_b64_tr_b16 v[46:47], v18 offset:17440
    ds_read_b64_tr_b16 v[48:49], v19 offset:32
    ds_read_b64_tr_b16 v[50:51], v19 offset:1056
    v_lshrrev_b32 v9, 4, v0
    v_lshlrev_b32 v9, 5, v9
    v_bfe_u32 v60, v0, 1, 1
    v_lshl_add_u32 v9, v60, 4, v9
    v_and_b32 v60, 1, v0
    v_mul_u32_u24 v60, 192, v60
    v_add_u32 v9, v60, v9
    v_add_u32 v9, 160832, v9
    v_lshrrev_b32 v10, 4, v0
    v_lshlrev_b32 v10, 4, v10
    v_bfe_u32 v60, v0, 1, 1
    v_lshl_add_u32 v10, v60, 3, v10
    v_and_b32 v60, 1, v0
    v_mul_u32_u24 v60, 192, v60
    v_add_u32 v10, v60, v10
    v_add_u32 v10, 160960, v10
    v_mov_b64 v[20:21], 0
    v_mov_b64 v[22:23], 0
    v_mov_b64 v[24:25], 0
    v_mov_b64 v[26:27], 0
    s_lshr_b32 s57, s30, 1
    s_lshl_b32 s57, s57, 11
    s_lshl_b32 s58, s58, 1
    s_add_u32 s57, s57, s58
    s_lshl_b32 s58, s54, 8
    s_add_u32 s57, s57, s58
    v_and_b32 v11, 31, v0
    v_lshlrev_b32 v11, 2, v11
    v_lshrrev_b32 v60, 5, v0
L_pad14:
    s_cbranch_execz L_pad18
    v_lshl_add_u32 v11, v60, 30, v11
    v_add_u32 v11, s57, v11
    s_add_u32 s59, s62, 39936
    s_add_u32 s60, s62, 25984
L_skip_219:
    s_cmp_lt_u32 s30, 6
    s_barrier
    s_cbranch_scc0 L_se_218
    ds_read_b128 v[12:15], v9
    ds_read_b64 v[16:17], v10
    s_waitcnt lgkmcnt(1)
    v_smfmac_f32_16x16x64_bf16 v[20:23], v[12:15], v[28:35], v1
    v_smfmac_f32_16x16x64_bf16 v[24:27], v[12:15], v[40:47], v1
    s_waitcnt lgkmcnt(0)
    v_smfmac_f32_16x16x32_bf16 v[20:23], v[16:17], v[36:39], v1
    v_smfmac_f32_16x16x32_bf16 v[24:27], v[16:17], v[48:51], v1
    s_cmp_eq_u32 s55, 0
    s_nop 5
    v_add_f32 v12, v20, v22
    s_nop 1
    v_add_f32_dpp v12, v24, v26 quad_perm:[0,1,2,3] row_mask:0x2 bank_mask:0xf
    s_cbranch_scc1 L_gs_220
    buffer_store_dword v12, v11, s[40:43], s59 offen
L_gb_221:
L_se_218:
    s_cmp_eq_u32 s30, 7
    s_cbranch_scc0 L_done
    s_cmp_eq_u32 s31, 0
    s_cbranch_scc0 L_done
    v_lshlrev_b32 v60, 16, v4
    v_add_f32 v2, v2, v60
    v_and_b32 v60, 0xffff0000, v4
    v_add_f32 v3, v3, v60
    v_and_b32 v60, 31, v0
    v_min_u32 v60, 19, v60
    s_mul_i32 s57, s54, 160
    v_lshrrev_b32 v7, 5, v0
    v_lshlrev_b32 v7, 2, v7
    v_add_u32 v7, s57, v7
    v_lshl_add_u32 v7, v60, 3, v7
    s_add_u32 s57, s7, 198144
    s_add_u32 s58, s7, 214528
    s_add_u32 s59, s7, 230912
    s_add_u32 s60, s7, 247296
    v_mov_b64 v[36:37], 0
    v_mov_b64 v[38:39], 0
    s_nop 0
    v_mov_b32_dpp v36, v2 quad_perm:[0,1,2,3] row_mask:0x3 bank_mask:0xf
    v_mov_b32_dpp v37, v3 quad_perm:[0,1,2,3] row_mask:0x3 bank_mask:0xf
    v_mov_b32_dpp v38, v2 quad_perm:[0,1,2,3] row_mask:0xc bank_mask:0xf
    v_mov_b32_dpp v39, v3 quad_perm:[0,1,2,3] row_mask:0xc bank_mask:0xf
    s_add_u32 s75, s7, 266252
    v_and_b32 v9, 7, v0
    v_lshlrev_b32 v9, 9, v9
L_pr_233:
    buffer_load_dword v12, v9, s[40:43], s75 offen sc1
    s_sub_u32 s56, s56, 1
    s_cbranch_scc1 L_done
L_pw_232:
    s_waitcnt vmcnt(0)
    v_cmp_eq_u32 vcc, -1, v12
    s_cbranch_vccnz L_pr_233
L_gw_229:
    buffer_load_dwordx4 v[12:15], v5, s[40:43], s57 offen sc1
    buffer_load_dwordx4 v[16:19], v5, s[40:43], s58 offen sc1
    buffer_load_dwordx4 v[20:23], v5, s[40:43], s59 offen sc1
    buffer_load_dwordx4 v[24:27], v5, s[40:43], s60 offen sc1
    s_sub_u32 s56, s56, 1
    s_cbranch_scc1 L_done
    s_and_b32 s74, s56, 31
    s_waitcnt vmcnt(3)
    v_pk_add_f32 v[28:29], v[12:13], v[36:37]
    v_pk_add_f32 v[30:31], v[14:15], v[38:39]
    s_waitcnt vmcnt(2)
    v_pk_add_f32 v[28:29], v[28:29], v[16:17]
    v_pk_add_f32 v[30:31], v[30:31], v[18:19]
    s_waitcnt vmcnt(1)
    v_pk_add_f32 v[28:29], v[28:29], v[20:21]
    v_pk_add_f32 v[30:31], v[30:31], v[22:23]
    s_waitcnt vmcnt(0)
    v_pk_add_f32 v[28:29], v[28:29], v[24:25]
    v_pk_add_f32 v[30:31], v[30:31], v[26:27]
    v_pk_add_f32 v[32:33], v[28:29], v[30:31]
    v_cmp_u_f32 vcc, v32, v33
    v_permlane32_swap_b32 v28, v30
    v_permlane32_swap_b32 v29, v31
    s_cbranch_vccnz L_gr_230
L_gk_231:
    v_pk_add_f32 v[28:29], v[28:29], v[30:31]
    v_cvt_pk_bf16_f32 v28, v28, v29
    global_store_dword v7, v28, s[24:25]
    s_branch L_done
.p2align 5
L_gs_34:
L_pad15:
    s_cbranch_execz L_pad19
    buffer_store_dword v33, v34, s[40:43], s67 offen sc1
    s_branch L_gb_35
.p2align 5
L_gs_37:
    buffer_store_dword v12, v54, s[40:43], s59 offen sc1
    s_branch L_gb_38
.p2align 5
L_cr_49:
    s_sub_u32 s56, s56, 1
    s_cbranch_scc1 L_done
    global_load_dword v2, v3, s[26:27] sc1
    s_waitcnt vmcnt(0)
    s_branch L_cw_48
.p2align 5
L_far_50:
    s_lshl_b32 s57, s52, 2
    s_add_u32 s57, s57, s72
    s_mov_b64 exec, 1
    buffer_store_dword v25, v0, s[40:43], s57 offen offset:128 sc1
    s_mov_b64 exec, -1
    s_branch L_fb_51
.p2align 5
L_cr_63:
    s_sub_u32 s56, s56, 1
    s_cbranch_scc1 L_done
    buffer_load_dword v2, v24, s[40:43], s72 offen sc1
    s_branch L_cw_62
.p2align 5
L_gs_70:
    buffer_store_dword v33, v34, s[40:43], s67 offen sc1
    s_branch L_gb_71
.p2align 5
L_gs_73:
    buffer_store_dword v12, v54, s[40:43], s59 offen sc1
    s_branch L_gb_74
.p2align 5
L_gs_91:
    buffer_store_dword v37, v4, s[40:43], s58 offen sc1
    s_branch L_gb_92
.p2align 5
L_cr_105:
    s_sub_u32 s56, s56, 1
    s_cbranch_scc1 L_done
    global_load_dword v2, v3, s[26:27] offset:4 sc1
    s_branch L_cw_104
.p2align 5
L_cr_115:
    buffer_load_dword v52, v56, s[40:43], s74 offen offset:1536 sc1
    buffer_load_dwordx2 v[54:55], v62, s[40:43], s74 offen offset:1536 sc1
    s_sub_u32 s56, s56, 1
    s_cbranch_scc1 L_done
    s_branch L_cw_114
.p2align 5
L_gs_120:
    buffer_store_dword v14, v3, s[40:43], s57 offen sc1
    s_branch L_gb_121
.p2align 5
L_gs_122:
    buffer_store_dword v12, v4, s[40:43], s57 offen offset:32 sc1
    s_branch L_gb_123
.p2align 5
L_comb_0:
    s_mov_b32 s57, 0
    s_cmp_eq_u32 s55, 0
    s_waitcnt lgkmcnt(0)
    s_barrier
    ds_read2st64_b64 v[12:15], v2 offset0:0 offset1:4
    ds_read2st64_b64 v[16:19], v2 offset0:8 offset1:12
    ds_read2st64_b64 v[20:23], v2 offset0:16 offset1:20
    ds_read2st64_b64 v[24:27], v2 offset0:24 offset1:28
    s_waitcnt lgkmcnt(2)
    v_pk_add_f32 v[12:13], v[12:13], v[14:15]
    v_pk_add_f32 v[16:17], v[16:17], v[18:19]
    v_pk_add_f32 v[12:13], v[12:13], v[16:17]
    s_waitcnt lgkmcnt(0)
    v_pk_add_f32 v[20:21], v[20:21], v[22:23]
    v_pk_add_f32 v[24:25], v[24:25], v[26:27]
    v_pk_add_f32 v[12:13], v[12:13], v[20:21]
    v_pk_add_f32 v[12:13], v[12:13], v[24:25]
    v_cvt_pk_bf16_f32 v14, v12, v13
    v_min_u32 v14, -2, v14
    s_cbranch_scc1 L_gs_120
L_pad16:
    s_cbranch_execz L_pad20
    buffer_store_dword v14, v3, s[40:43], s57 offen
L_gb_121:
    s_cbranch_scc1 L_gs_122
    buffer_store_dword v12, v4, s[40:43], s57 offen offset:32
L_gb_123:
    s_branch L_comb_0b
.p2align 5
L_sr_132:
    buffer_load_dwordx4 v[52:55], v11, s[40:43], s65 offen offset:0 sc1
    buffer_load_dwordx4 v[56:59], v11, s[40:43], s65 offen offset:1024 sc1
    s_sub_u32 s56, s56, 1
    s_cbranch_scc1 L_done
    s_waitcnt vmcnt(0)
    s_branch L_sw_131
L_hr_133:
    buffer_load_dwordx4 v[12:15], v11, s[40:43], s58 offen offset:0 sc1
    buffer_load_dwordx4 v[16:19], v11, s[40:43], s58 offen offset:1024 sc1
    s_sub_u32 s56, s56, 1
    s_cbranch_scc1 L_done
    s_and_b32 s64, s56, 31
    s_cbranch_scc0 L_hx_135
    s_waitcnt vmcnt(2)
    v_pk_add_f32 v[20:21], v[12:13], v[16:17]
    v_pk_add_f32 v[22:23], v[14:15], v[18:19]
    s_nop 1
    v_permlane32_swap_b32 v20, v22
    v_permlane32_swap_b32 v21, v23
    v_pk_add_f32 v[20:21], v[20:21], v[22:23]
    s_nop 1
    v_permlane16_swap_b32 v20, v21
    v_add_f32 v20, v20, v21
    v_cmp_u_f32 vcc, v20, v20
    v_sub_f32 v20, v20, v26
    s_cbranch_vccnz L_hr_133
    s_branch L_hk_134
.p2align 5
L_hx_135:
    s_waitcnt vmcnt(0)
    v_max3_u32 v20, v12, v13, v14
    v_max3_u32 v20, v20, v15, v16
    v_max3_u32 v20, v20, v17, v18
    v_max_u32 v20, v20, v19
    v_cmp_eq_u32 vcc, -1, v20
    s_cbranch_vccnz L_hr_133
    v_pk_add_f32 v[20:21], v[12:13], v[16:17]
    v_pk_add_f32 v[22:23], v[14:15], v[18:19]
    s_nop 1
    v_permlane32_swap_b32 v20, v22
    v_permlane32_swap_b32 v21, v23
    v_pk_add_f32 v[20:21], v[20:21], v[22:23]
    s_nop 1
    v_permlane16_swap_b32 v20, v21
    v_add_f32 v20, v20, v21
    v_sub_f32 v20, v20, v26
    s_branch L_hk_134
L_gs_143:
    buffer_store_dword v0, v11, s[40:43], s58 offen sc1
    s_branch L_gb_144
.p2align 5
L_typeC_139:
    s_cmp_eq_u32 s30, 6
    s_cbranch_scc0 L_p1
    s_bitcmp1_b32 s3, 0
    s_cbranch_scc0 L_skip_140
    v_and_b32 v11, 3, v0
    v_lshlrev_b32 v11, 7, v11
    v_lshrrev_b32 v60, 2, v0
    v_lshl_add_u32 v11, v60, 24, v11
    s_add_u32 s58, s62, 26116
    s_add_u32 s75, s7, 266244
    v_and_b32 v9, 7, v0
    v_lshlrev_b32 v9, 9, v9
L_pr_142:
    buffer_load_dword v12, v9, s[40:43], s75 offen sc1
    s_sub_u32 s56, s56, 1
    s_cbranch_scc1 L_done
L_pw_141:
    s_waitcnt vmcnt(0)
    v_cmp_eq_u32 vcc, -1, v12
    s_cbranch_vccnz L_pr_142
    s_cmp_eq_u32 s55, 0
    s_cbranch_scc1 L_gs_143
    buffer_store_dword v0, v11, s[40:43], s58 offen
L_gb_144:
    s_waitcnt vmcnt(1)
    s_branch L_p1
.p2align 5
L_skip_140:
    s_lshl_b32 s59, s31, 9
    s_add_u32 s59, s59, s8
    s_add_u32 s59, s59, 266240
    v_and_b32 v10, 1, v0
    v_lshlrev_b32 v10, 13, v10
    v_lshrrev_b32 v60, 1, v0
    v_lshl_add_u32 v10, v60, 24, v10
    s_cmp_eq_u32 s3, 20
    s_cbranch_scc0 L_skip_145
    s_add_u32 s58, s62, 1568
    v_lshrrev_b32 v9, 3, v0
    v_mul_u32_u24 v9, 1664, v9
L_pad17:
    s_cbranch_execz L_pad21
    v_and_b32 v60, 7, v0
    v_lshl_add_u32 v9, v60, 2, v9
L_pr_147:
    buffer_load_dword v12, v9, s[40:43], s58 offen sc1
    s_sub_u32 s56, s56, 1
    s_cbranch_scc1 L_done
L_pw_146:
    s_waitcnt vmcnt(0)
    v_cmp_eq_u32 vcc, -1, v12
    s_cbranch_vccnz L_pr_147
    buffer_store_dword v0, v10, s[40:43], s59 offen offset:0 sc1
L_skip_145:
    s_add_u32 s58, s62, 25856
    v_and_b32 v9, 15, v0
    v_lshlrev_b32 v9, 2, v9
L_pr_149:
    buffer_load_dword v13, v9, s[40:43], s58 offen sc1
    s_sub_u32 s56, s56, 1
    s_cbranch_scc1 L_done
L_pw_148:
    s_waitcnt vmcnt(0)
    v_cmp_eq_u32 vcc, -1, v13
    s_cbranch_vccnz L_pr_149
    buffer_store_dword v0, v10, s[40:43], s59 offen offset:4 sc1
    s_waitcnt vmcnt(1)
    s_branch L_p1
.p2align 5
L_gs_153:
    buffer_store_dword v12, v11, s[40:43], s60 offen sc1
    s_branch L_gb_154
.p2align 5
L_gs_155:
    buffer_store_dword v12, v11, s[40:43], s59 offen sc1
    s_branch L_gb_156
.p2align 5
L_gr_158:
    s_cbranch_scc1 L_gw_157
    s_waitcnt vmcnt(0)
    v_max3_u32 v32, v12, v13, v14
    v_max3_u32 v32, v32, v15, v16
    v_max3_u32 v32, v32, v17, v18
    v_max3_u32 v32, v32, v19, v20
    v_max3_u32 v32, v32, v21, v22
    v_max3_u32 v32, v32, v23, v24
    v_max3_u32 v32, v32, v25, v26
    v_max_u32 v32, v32, v27
    v_cmp_eq_u32 vcc, -1, v32
    s_cbranch_vccnz L_gw_157
    v_pk_add_f32 v[28:29], v[12:13], v[36:37]
    v_pk_add_f32 v[30:31], v[14:15], v[38:39]
    v_pk_add_f32 v[28:29], v[28:29], v[16:17]
    v_pk_add_f32 v[30:31], v[30:31], v[18:19]
    v_pk_add_f32 v[28:29], v[28:29], v[20:21]
    v_pk_add_f32 v[30:31], v[30:31], v[22:23]
    v_pk_add_f32 v[28:29], v[28:29], v[24:25]
    v_pk_add_f32 v[30:31], v[30:31], v[26:27]
    s_nop 1
    v_permlane32_swap_b32 v28, v30
    v_permlane32_swap_b32 v29, v31
    s_branch L_gk_159
.p2align 5
L_gs_162:
    buffer_store_dword v33, v34, s[40:43], s67 offen sc1
    s_branch L_gb_163
.p2align 5
L_w7_150:
    v_and_b32 v60, 31, v0
    v_min_u32 v60, 19, v60
    s_mul_i32 s57, s54, 320
    v_lshrrev_b32 v5, 5, v0
    v_lshlrev_b32 v5, 12, v5
    v_add_u32 v5, s57, v5
    v_lshl_add_u32 v5, v60, 4, v5
    v_and_b32 v60, 31, v0
    v_cmp_gt_u32 s[64:65], 20, v60
    v_min_u32 v60, 19, v60
    v_lshrrev_b32 v35, 5, v0
    v_lshlrev_b32 v35, 2, v35
    v_add_u32 v35, 160832, v35
    v_lshl_add_u32 v35, v60, 3, v35
    s_add_u32 s66, s62, 13312
    s_add_u32 s67, s62, 25856
    s_lshl_b32 s57, s54, 3
    v_lshrrev_b32 v34, 5, v0
    v_lshlrev_b32 v34, 2, v34
    v_add_u32 v34, s57, v34
    v_and_b32 v60, 31, v0
    v_mov_b32 v61, 0x7f000000
    v_cmp_ne_u32 vcc, 31, v60
    s_nop 1
L_pad18:
    s_cbranch_execz L_pad22
    v_cndmask_b32 v34, v34, v61, vcc
    v_mov_b32 v61, 0x3f803f80
    s_add_u32 s57, s7, 0
    s_add_u32 s58, s7, 16384
    s_add_u32 s59, s7, 32768
    s_add_u32 s60, s7, 49152
    v_mov_b64 v[36:37], 0
    v_mov_b64 v[38:39], 0
    s_nop 0
    v_mov_b32_dpp v36, v2 quad_perm:[0,1,2,3] row_mask:0x3 bank_mask:0xf
    v_mov_b32_dpp v37, v3 quad_perm:[0,1,2,3] row_mask:0x3 bank_mask:0xf
    v_mov_b32_dpp v38, v2 quad_perm:[0,1,2,3] row_mask:0xc bank_mask:0xf
    v_mov_b32_dpp v39, v3 quad_perm:[0,1,2,3] row_mask:0xc bank_mask:0xf
    s_add_u32 s75, s7, 266240
    v_and_b32 v9, 7, v0
    v_lshlrev_b32 v9, 9, v9
L_pr_161:
    buffer_load_dword v12, v9, s[40:43], s75 offen sc1
    s_sub_u32 s56, s56, 1
    s_cbranch_scc1 L_done
L_pw_160:
    s_waitcnt vmcnt(0)
    v_cmp_eq_u32 vcc, -1, v12
    s_cbranch_vccnz L_pr_161
L_gw_157:
    buffer_load_dwordx4 v[12:15], v5, s[40:43], s57 offen sc1
    buffer_load_dwordx4 v[16:19], v5, s[40:43], s58 offen sc1
    buffer_load_dwordx4 v[20:23], v5, s[40:43], s59 offen sc1
    buffer_load_dwordx4 v[24:27], v5, s[40:43], s60 offen sc1
    s_sub_u32 s56, s56, 1
    s_cbranch_scc1 L_done
    s_and_b32 s74, s56, 31
    s_waitcnt vmcnt(3)
    v_pk_add_f32 v[28:29], v[12:13], v[36:37]
    v_pk_add_f32 v[30:31], v[14:15], v[38:39]
    s_waitcnt vmcnt(2)
    v_pk_add_f32 v[28:29], v[28:29], v[16:17]
    v_pk_add_f32 v[30:31], v[30:31], v[18:19]
    s_waitcnt vmcnt(1)
    v_pk_add_f32 v[28:29], v[28:29], v[20:21]
    v_pk_add_f32 v[30:31], v[30:31], v[22:23]
    s_waitcnt vmcnt(0)
    v_pk_add_f32 v[28:29], v[28:29], v[24:25]
    v_pk_add_f32 v[30:31], v[30:31], v[26:27]
    v_pk_add_f32 v[32:33], v[28:29], v[30:31]
    v_cmp_u_f32 vcc, v32, v33
    v_permlane32_swap_b32 v28, v30
    v_permlane32_swap_b32 v29, v31
    s_cbranch_vccnz L_gr_158
L_gk_159:
    v_pk_add_f32 v[28:29], v[28:29], v[30:31]
    v_cvt_pk_bf16_f32 v28, v28, v29
    ds_write_b32 v35, v28
    s_waitcnt lgkmcnt(0)
    s_barrier
    v_cndmask_b32 v29, 0, v28, s[64:65]
    v_dot2_f32_bf16 v33, v29, v61, 0
    v_dot2_f32_bf16 v32, v29, v29, 0
    v_lshlrev_b32 v2, 16, v28
    v_and_b32 v3, 0xffff0000, v28
    s_cmp_eq_u32 s55, 0
    v_permlane32_swap_b32 v33, v32
    v_add_f32 v33, v33, v32
    s_nop 1
    v_add_f32_dpp v33, v33, v33 row_ror:8 row_mask:0xf bank_mask:0xf
    s_nop 1
    v_add_f32_dpp v33, v33, v33 row_ror:4 row_mask:0xf bank_mask:0xf
    s_nop 1
    v_add_f32_dpp v33, v33, v33 row_ror:2 row_mask:0xf bank_mask:0xf
    s_nop 1
    v_add_f32_dpp v33, v33, v33 row_ror:1 row_mask:0xf bank_mask:0xf
    s_nop 1
    v_add_f32_dpp v33, v33, v33 row_bcast:15 row_mask:0xa bank_mask:0xf
    s_cbranch_scc1 L_gs_162
    buffer_store_dword v33, v34, s[40:43], s67 offen
L_gb_163:
    s_waitcnt vmcnt(1)
    s_branch L_se_151
.p2align 5
L_gs_167:
    buffer_store_dword v12, v11, s[40:43], s59 offen sc1
    s_branch L_gb_168
.p2align 5
L_gr_173:
    s_cbranch_scc1 L_gw_172
    s_waitcnt vmcnt(0)
    v_max3_u32 v32, v12, v13, v14
    v_max3_u32 v32, v32, v15, v16
    v_max3_u32 v32, v32, v17, v18
L_pad19:
    s_cbranch_execz L_pad23
    v_max3_u32 v32, v32, v19, v20
    v_max3_u32 v32, v32, v21, v22
    v_max3_u32 v32, v32, v23, v24
    v_max3_u32 v32, v32, v25, v26
    v_max_u32 v32, v32, v27
    v_cmp_eq_u32 vcc, -1, v32
    s_cbranch_vccnz L_gw_172
    v_pk_add_f32 v[28:29], v[12:13], v[36:37]
    v_pk_add_f32 v[30:31], v[14:15], v[38:39]
    v_pk_add_f32 v[28:29], v[28:29], v[16:17]
    v_pk_add_f32 v[30:31], v[30:31], v[18:19]
    v_pk_add_f32 v[28:29], v[28:29], v[20:21]
    v_pk_add_f32 v[30:31], v[30:31], v[22:23]
    v_pk_add_f32 v[28:29], v[28:29], v[24:25]
    v_pk_add_f32 v[30:31], v[30:31], v[26:27]
    s_nop 1
    v_permlane32_swap_b32 v28, v30
    v_permlane32_swap_b32 v29, v31
    s_branch L_gk_174
L_gr_176:
    s_cbranch_scc1 L_gw_175
    s_waitcnt vmcnt(0)
    v_max3_u32 v32, v12, v13, v14
    v_max3_u32 v32, v32, v15, v16
    v_max3_u32 v32, v32, v17, v18
    v_max3_u32 v32, v32, v19, v20
    v_max3_u32 v32, v32, v21, v22
    v_max3_u32 v32, v32, v23, v24
    v_max3_u32 v32, v32, v25, v26
    v_max_u32 v32, v32, v27
    v_cmp_eq_u32 vcc, -1, v32
    s_cbranch_vccnz L_gw_175
    v_pk_add_f32 v[28:29], v[12:13], v[36:37]
    v_pk_add_f32 v[30:31], v[14:15], v[38:39]
    v_pk_add_f32 v[28:29], v[28:29], v[16:17]
    v_pk_add_f32 v[30:31], v[30:31], v[18:19]
    v_pk_add_f32 v[28:29], v[28:29], v[20:21]
    v_pk_add_f32 v[30:31], v[30:31], v[22:23]
    v_pk_add_f32 v[28:29], v[28:29], v[24:25]
    v_pk_add_f32 v[30:31], v[30:31], v[26:27]
    s_nop 1
    v_permlane32_swap_b32 v28, v30
    v_permlane32_swap_b32 v29, v31
    s_branch L_gk_177
.p2align 5
L_gs_180:
    buffer_store_dword v33, v34, s[40:43], s67 offen sc1
    s_branch L_gb_181
.p2align 5
L_w7_164:
    v_and_b32 v60, 31, v0
    v_min_u32 v60, 19, v60
    s_mul_i32 s57, s54, 320
    v_lshrrev_b32 v5, 5, v0
    v_lshlrev_b32 v5, 12, v5
    v_add_u32 v5, s57, v5
    v_lshl_add_u32 v5, v60, 4, v5
    v_and_b32 v60, 31, v0
    v_cmp_gt_u32 s[64:65], 20, v60
    v_min_u32 v60, 19, v60
    v_lshrrev_b32 v35, 5, v0
    v_lshlrev_b32 v35, 2, v35
    v_add_u32 v35, 160832, v35
    v_lshl_add_u32 v35, v60, 3, v35
    s_mul_i32 s66, s53, 6144
    s_add_u32 s66, s66, s62
    s_add_u32 s66, s66, 46080
    s_lshl_b32 s67, s53, 6
    s_add_u32 s67, s67, s62
    s_add_u32 s67, s67, 25600
    s_lshl_b32 s57, s54, 3
    v_lshrrev_b32 v34, 5, v0
    v_lshlrev_b32 v34, 2, v34
    v_add_u32 v34, s57, v34
    v_and_b32 v60, 31, v0
    v_mov_b32 v61, 0x7f000000
    v_cmp_ne_u32 vcc, 31, v60
    s_nop 1
    v_cndmask_b32 v34, v34, v61, vcc
    v_mov_b32 v61, 0x3f803f80
    s_cmp_lg_u32 s53, 3
    s_cbranch_scc0 L_skip_169
    s_add_u32 s57, s62, 25856
    v_mov_b32 v9, 0
L_pr_171:
    buffer_load_dword v12, v9, s[40:43], s57 offen sc1
    s_sub_u32 s56, s56, 1
L_pad20:
    s_cbranch_execz L_pad24
    s_cbranch_scc1 L_done
L_pw_170:
    s_waitcnt vmcnt(0)
    v_cmp_eq_u32 vcc, -1, v12
    s_cbranch_vccnz L_pr_171
    s_add_u32 s57, s7, 0
    s_add_u32 s58, s7, 16384
    s_add_u32 s59, s7, 32768
    s_add_u32 s60, s7, 49152
    v_mov_b64 v[36:37], 0
    v_mov_b64 v[38:39], 0
    s_nop 0
    v_mov_b32_dpp v36, v2 quad_perm:[0,1,2,3] row_mask:0x3 bank_mask:0xf
    v_mov_b32_dpp v37, v3 quad_perm:[0,1,2,3] row_mask:0x3 bank_mask:0xf
    v_mov_b32_dpp v38, v2 quad_perm:[0,1,2,3] row_mask:0xc bank_mask:0xf
    v_mov_b32_dpp v39, v3 quad_perm:[0,1,2,3] row_mask:0xc bank_mask:0xf
L_gw_172:
    buffer_load_dwordx4 v[12:15], v5, s[40:43], s57 offen sc1
    buffer_load_dwordx4 v[16:19], v5, s[40:43], s58 offen sc1
    buffer_load_dwordx4 v[20:23], v5, s[40:43], s59 offen sc1
    buffer_load_dwordx4 v[24:27], v5, s[40:43], s60 offen sc1
    s_sub_u32 s56, s56, 1
    s_cbranch_scc1 L_done
    s_and_b32 s74, s56, 31
    s_waitcnt vmcnt(3)
    v_pk_add_f32 v[28:29], v[12:13], v[36:37]
    v_pk_add_f32 v[30:31], v[14:15], v[38:39]
    s_waitcnt vmcnt(2)
    v_pk_add_f32 v[28:29], v[28:29], v[16:17]
    v_pk_add_f32 v[30:31], v[30:31], v[18:19]
    s_waitcnt vmcnt(1)
    v_pk_add_f32 v[28:29], v[28:29], v[20:21]
    v_pk_add_f32 v[30:31], v[30:31], v[22:23]
    s_waitcnt vmcnt(0)
    v_pk_add_f32 v[28:29], v[28:29], v[24:25]
    v_pk_add_f32 v[30:31], v[30:31], v[26:27]
    v_pk_add_f32 v[32:33], v[28:29], v[30:31]
    v_cmp_u_f32 vcc, v32, v33
    v_permlane32_swap_b32 v28, v30
    v_permlane32_swap_b32 v29, v31
    s_cbranch_vccnz L_gr_173
L_gk_174:
    v_pk_add_f32 v[28:29], v[28:29], v[30:31]
    v_cvt_pk_bf16_f32 v28, v28, v29
    v_lshlrev_b32 v2, 16, v28
    v_and_b32 v3, 0xffff0000, v28
L_skip_169:
    v_lshlrev_b32 v60, 16, v4
    v_add_f32 v2, v2, v60
    v_and_b32 v60, 0xffff0000, v4
    v_add_f32 v3, v3, v60
    s_add_u32 s57, s7, 66048
    s_add_u32 s58, s7, 82432
    s_add_u32 s59, s7, 98816
    s_add_u32 s60, s7, 115200
    v_mov_b64 v[36:37], 0
    v_mov_b64 v[38:39], 0
    s_nop 0
    v_mov_b32_dpp v36, v2 quad_perm:[0,1,2,3] row_mask:0x3 bank_mask:0xf
    v_mov_b32_dpp v37, v3 quad_perm:[0,1,2,3] row_mask:0x3 bank_mask:0xf
    v_mov_b32_dpp v38, v2 quad_perm:[0,1,2,3] row_mask:0xc bank_mask:0xf
    v_mov_b32_dpp v39, v3 quad_perm:[0,1,2,3] row_mask:0xc bank_mask:0xf
    s_lshl_b32 s74, s53, 7
    s_add_u32 s75, s62, s74
    s_add_u32 s75, s75, 26116
    v_mov_b32 v9, 0
L_pr_179:
    buffer_load_dword v12, v9, s[40:43], s75 offen sc1
    s_sub_u32 s56, s56, 1
    s_cbranch_scc1 L_done
L_pw_178:
    s_waitcnt vmcnt(0)
    v_cmp_eq_u32 vcc, -1, v12
    s_cbranch_vccnz L_pr_179
L_gw_175:
    buffer_load_dwordx4 v[12:15], v5, s[40:43], s57 offen sc1
    buffer_load_dwordx4 v[16:19], v5, s[40:43], s58 offen sc1
    buffer_load_dwordx4 v[20:23], v5, s[40:43], s59 offen sc1
    buffer_load_dwordx4 v[24:27], v5, s[40:43], s60 offen sc1
    s_sub_u32 s56, s56, 1
    s_cbranch_scc1 L_done
    s_and_b32 s74, s56, 31
    s_waitcnt vmcnt(3)
    v_pk_add_f32 v[28:29], v[12:13], v[36:37]
    v_pk_add_f32 v[30:31], v[14:15], v[38:39]
    s_waitcnt vmcnt(2)
    v_pk_add_f32 v[28:29], v[28:29], v[16:17]
    v_pk_add_f32 v[30:31], v[30:31], v[18:19]
    s_waitcnt vmcnt(1)
    v_pk_add_f32 v[28:29], v[28:29], v[20:21]
    v_pk_add_f32 v[30:31], v[30:31], v[22:23]
L_pad21:
    s_cbranch_execz L_pad25
    s_waitcnt vmcnt(0)
    v_pk_add_f32 v[28:29], v[28:29], v[24:25]
    v_pk_add_f32 v[30:31], v[30:31], v[26:27]
    v_pk_add_f32 v[32:33], v[28:29], v[30:31]
    v_cmp_u_f32 vcc, v32, v33
    v_permlane32_swap_b32 v28, v30
    v_permlane32_swap_b32 v29, v31
    s_cbranch_vccnz L_gr_176
L_gk_177:
    v_pk_add_f32 v[28:29], v[28:29], v[30:31]
    v_cvt_pk_bf16_f32 v28, v28, v29
    ds_write_b32 v35, v28
    s_waitcnt lgkmcnt(0)
    s_barrier
    v_cndmask_b32 v29, 0, v28, s[64:65]
    v_dot2_f32_bf16 v33, v29, v61, 0
    v_dot2_f32_bf16 v32, v29, v29, 0
    v_lshlrev_b32 v2, 16, v28
    v_and_b32 v3, 0xffff0000, v28
    s_cmp_eq_u32 s55, 0
    v_permlane32_swap_b32 v33, v32
    v_add_f32 v33, v33, v32
    s_nop 1
    v_add_f32_dpp v33, v33, v33 row_ror:8 row_mask:0xf bank_mask:0xf
    s_nop 1
    v_add_f32_dpp v33, v33, v33 row_ror:4 row_mask:0xf bank_mask:0xf
    s_nop 1
    v_add_f32_dpp v33, v33, v33 row_ror:2 row_mask:0xf bank_mask:0xf
    s_nop 1
    v_add_f32_dpp v33, v33, v33 row_ror:1 row_mask:0xf bank_mask:0xf
    s_nop 1
    v_add_f32_dpp v33, v33, v33 row_bcast:15 row_mask:0xa bank_mask:0xf
    s_cbranch_scc1 L_gs_180
    buffer_store_dword v33, v34, s[40:43], s67 offen
L_gb_181:
    s_waitcnt vmcnt(1)
    s_branch L_se_165
.p2align 5
L_hr_186:
    buffer_load_dwordx4 v[40:43], v7, s[40:43], s59 offen offset:0 sc1
    buffer_load_dwordx4 v[44:47], v7, s[40:43], s59 offen offset:1024 sc1
    s_sub_u32 s56, s56, 1
    s_cbranch_scc1 L_done
    s_and_b32 s64, s56, 31
    s_cbranch_scc0 L_hx_188
    s_waitcnt vmcnt(2)
    v_pk_add_f32 v[20:21], v[40:41], v[44:45]
    v_pk_add_f32 v[22:23], v[42:43], v[46:47]
    s_nop 1
    v_permlane32_swap_b32 v20, v22
    v_permlane32_swap_b32 v21, v23
    v_pk_add_f32 v[20:21], v[20:21], v[22:23]
    s_nop 1
    v_permlane16_swap_b32 v20, v21
    v_add_f32 v20, v20, v21
    v_cmp_u_f32 vcc, v20, v20
    v_sub_f32 v20, v20, v50
    s_cbranch_vccnz L_hr_186
    s_branch L_hk_187
.p2align 5
L_hx_188:
    s_waitcnt vmcnt(0)
    v_max3_u32 v20, v40, v41, v42
    v_max3_u32 v20, v20, v43, v44
    v_max3_u32 v20, v20, v45, v46
    v_max_u32 v20, v20, v47
    v_cmp_eq_u32 vcc, -1, v20
    s_cbranch_vccnz L_hr_186
    v_pk_add_f32 v[20:21], v[40:41], v[44:45]
    v_pk_add_f32 v[22:23], v[42:43], v[46:47]
    s_nop 1
    v_permlane32_swap_b32 v20, v22
    v_permlane32_swap_b32 v21, v23
    v_pk_add_f32 v[20:21], v[20:21], v[22:23]
    s_nop 1
    v_permlane16_swap_b32 v20, v21
    v_add_f32 v20, v20, v21
    v_sub_f32 v20, v20, v50
    s_branch L_hk_187
L_qo_182:
    v_mov_b64 v[24:25], 0
    v_mov_b64 v[26:27], 0
    v_mov_b64 v[28:29], 0
    v_mov_b64 v[30:31], 0
    v_mov_b64 v[32:33], 0
    v_mov_b64 v[34:35], 0
    v_mov_b64 v[36:37], 0
    v_mov_b64 v[38:39], 0
    v_lshrrev_b32 v5, 4, v0
    v_lshlrev_b32 v5, 5, v5
    v_bfe_u32 v60, v0, 1, 1
    v_lshl_add_u32 v5, v60, 4, v5
    v_add_u32 v5, 124928, v5
L_pad22:
    s_cbranch_execz L_padback
    s_branch L_qb_183
.p2align 5
L_mr_189:
    ds_read_b32 v36, v62
    s_sub_u32 s56, s56, 1
    s_cbranch_scc1 L_done
    s_waitcnt lgkmcnt(0)
    v_cmp_eq_u32 vcc, -1, v36
    s_cbranch_vccnz L_mr_189
    v_max_f32_dpp v37, v36, v36 row_ror:4 row_mask:0xf bank_mask:0xf
    s_nop 1
    v_max_f32_dpp v37, v37, v37 row_ror:2 row_mask:0xf bank_mask:0xf
    s_nop 1
    v_max_f32_dpp v37, v37, v37 row_ror:1 row_mask:0xf bank_mask:0xf
    v_sub_f32 v39, v61, v37
    v_exp_f32 v39, v39
    s_branch L_mk_190
.p2align 5
L_gs_191:
    buffer_store_dword v37, v4, s[40:43], s58 offen sc1
    s_branch L_gb_192
.p2align 5
L_gs_193:
    buffer_store_dword v14, v3, s[40:43], s57 offen sc1
    s_branch L_gb_194
.p2align 5
L_gs_195:
    buffer_store_dword v12, v4, s[40:43], s57 offen offset:32 sc1
    s_branch L_gb_196
.p2align 5
L_comb_1:
    s_mov_b32 s58, 26624
    s_cmp_eq_u32 s55, 0
    s_cbranch_scc1 L_gs_191
    buffer_store_dword v37, v4, s[40:43], s58 offen
L_gb_192:
    s_mov_b32 s57, 26624
    s_cmp_eq_u32 s55, 0
    s_waitcnt lgkmcnt(0)
    s_barrier
    ds_read2st64_b64 v[12:15], v2 offset0:0 offset1:4
    ds_read2st64_b64 v[16:19], v2 offset0:8 offset1:12
    ds_read2st64_b64 v[20:23], v2 offset0:16 offset1:20
    ds_read2st64_b64 v[24:27], v2 offset0:24 offset1:28
    s_waitcnt lgkmcnt(2)
    v_pk_add_f32 v[12:13], v[12:13], v[14:15]
    v_pk_add_f32 v[16:17], v[16:17], v[18:19]
    v_pk_add_f32 v[12:13], v[12:13], v[16:17]
    s_waitcnt lgkmcnt(0)
    v_pk_add_f32 v[20:21], v[20:21], v[22:23]
    v_pk_add_f32 v[24:25], v[24:25], v[26:27]
    v_pk_add_f32 v[12:13], v[12:13], v[20:21]
    v_pk_add_f32 v[12:13], v[12:13], v[24:25]
    v_cvt_pk_bf16_f32 v14, v12, v13
    v_min_u32 v14, -2, v14
    s_cbranch_scc1 L_gs_193
    buffer_store_dword v14, v3, s[40:43], s57 offen
L_gb_194:
    s_cbranch_scc1 L_gs_195
    buffer_store_dword v12, v4, s[40:43], s57 offen offset:32
L_gb_196:
    s_branch L_comb_1b
.p2align 5
L_sr_206:
    buffer_load_dwordx4 v[52:55], v11, s[40:43], s65 offen offset:0 sc1
    buffer_load_dwordx4 v[56:59], v11, s[40:43], s65 offen offset:1024 sc1
    s_sub_u32 s56, s56, 1
    s_cbranch_scc1 L_done
    s_waitcnt vmcnt(0)
    s_branch L_sw_205
L_hr_207:
    buffer_load_dwordx4 v[12:15], v11, s[40:43], s58 offen offset:0 sc1
    buffer_load_dwordx4 v[16:19], v11, s[40:43], s58 offen offset:1024 sc1
    s_sub_u32 s56, s56, 1
    s_cbranch_scc1 L_done
    s_and_b32 s64, s56, 31
    s_cbranch_scc0 L_hx_209
    s_waitcnt vmcnt(2)
    v_pk_add_f32 v[20:21], v[12:13], v[16:17]
    v_pk_add_f32 v[22:23], v[14:15], v[18:19]
    s_nop 1
    v_permlane32_swap_b32 v20, v22
    v_permlane32_swap_b32 v21, v23
L_pad23:
    s_cbranch_execz L_padback
    v_pk_add_f32 v[20:21], v[20:21], v[22:23]
    s_nop 1
    v_permlane16_swap_b32 v20, v21
    v_add_f32 v20, v20, v21
    v_cmp_u_f32 vcc, v20, v20
    v_sub_f32 v20, v20, v26
    s_cbranch_vccnz L_hr_207
    s_branch L_hk_208
.p2align 5
L_hx_209:
    s_waitcnt vmcnt(0)
    v_max3_u32 v20, v12, v13, v14
    v_max3_u32 v20, v20, v15, v16
    v_max3_u32 v20, v20, v17, v18
    v_max_u32 v20, v20, v19
    v_cmp_eq_u32 vcc, -1, v20
    s_cbranch_vccnz L_hr_207
    v_pk_add_f32 v[20:21], v[12:13], v[16:17]
    v_pk_add_f32 v[22:23], v[14:15], v[18:19]
    s_nop 1
    v_permlane32_swap_b32 v20, v22
    v_permlane32_swap_b32 v21, v23
    v_pk_add_f32 v[20:21], v[20:21], v[22:23]
    s_nop 1
    v_permlane16_swap_b32 v20, v21
    v_add_f32 v20, v20, v21
    v_sub_f32 v20, v20, v26
    s_branch L_hk_208
L_typeC_212:
    s_cmp_eq_u32 s30, 6
    s_cbranch_scc0 L_done
    s_cmp_eq_u32 s3, 20
    s_cbranch_scc0 L_done
    s_lshl_b32 s59, s31, 9
    s_add_u32 s59, s59, s8
    s_add_u32 s59, s59, 266240
    v_and_b32 v10, 1, v0
    v_lshlrev_b32 v10, 13, v10
    v_lshrrev_b32 v60, 1, v0
    v_lshl_add_u32 v10, v60, 24, v10
    s_add_u32 s58, s62, 28192
    v_lshrrev_b32 v9, 3, v0
    v_mul_u32_u24 v9, 1664, v9
    v_and_b32 v60, 7, v0
    v_lshl_add_u32 v9, v60, 2, v9
L_pr_214:
    buffer_load_dword v12, v9, s[40:43], s58 offen sc1
    s_sub_u32 s56, s56, 1
    s_cbranch_scc1 L_done
L_pw_213:
    s_waitcnt vmcnt(0)
    v_cmp_eq_u32 vcc, -1, v12
    s_cbranch_vccnz L_pr_214
    buffer_store_dword v0, v10, s[40:43], s59 offen offset:8 sc1
    s_add_u32 s58, s62, 25984
    v_and_b32 v9, 15, v0
    v_lshlrev_b32 v9, 2, v9
L_pr_216:
    buffer_load_dword v13, v9, s[40:43], s58 offen sc1
    s_sub_u32 s56, s56, 1
    s_cbranch_scc1 L_done
L_pw_215:
    s_waitcnt vmcnt(0)
    v_cmp_eq_u32 vcc, -1, v13
    s_cbranch_vccnz L_pr_216
    buffer_store_dword v0, v10, s[40:43], s59 offen offset:12 sc1
    s_waitcnt vmcnt(1)
    s_branch L_done
.p2align 5
L_gs_220:
    buffer_store_dword v12, v11, s[40:43], s59 offen sc1
    s_branch L_gb_221
.p2align 5
L_gr_223:
    s_cbranch_scc1 L_gw_222
    s_waitcnt vmcnt(0)
    v_max3_u32 v32, v12, v13, v14
    v_max3_u32 v32, v32, v15, v16
    v_max3_u32 v32, v32, v17, v18
    v_max3_u32 v32, v32, v19, v20
    v_max3_u32 v32, v32, v21, v22
    v_max3_u32 v32, v32, v23, v24
    v_max3_u32 v32, v32, v25, v26
    v_max_u32 v32, v32, v27
    v_cmp_eq_u32 vcc, -1, v32
    s_cbranch_vccnz L_gw_222
    v_pk_add_f32 v[28:29], v[12:13], v[36:37]
    v_pk_add_f32 v[30:31], v[14:15], v[38:39]
    v_pk_add_f32 v[28:29], v[28:29], v[16:17]
    v_pk_add_f32 v[30:31], v[30:31], v[18:19]
    v_pk_add_f32 v[28:29], v[28:29], v[20:21]
    v_pk_add_f32 v[30:31], v[30:31], v[22:23]
    v_pk_add_f32 v[28:29], v[28:29], v[24:25]
L_pad24:
    s_cbranch_execz L_padback
    v_pk_add_f32 v[30:31], v[30:31], v[26:27]
    s_nop 1
    v_permlane32_swap_b32 v28, v30
    v_permlane32_swap_b32 v29, v31
    s_branch L_gk_224
L_gs_227:
    buffer_store_dword v33, v34, s[40:43], s67 offen sc1
    s_branch L_gb_228
.p2align 5
L_w7_217:
    v_and_b32 v60, 31, v0
    v_min_u32 v60, 19, v60
    s_mul_i32 s57, s54, 320
    v_lshrrev_b32 v5, 5, v0
    v_lshlrev_b32 v5, 12, v5
    v_add_u32 v5, s57, v5
    v_lshl_add_u32 v5, v60, 4, v5
    v_and_b32 v60, 31, v0
    v_cmp_gt_u32 s[64:65], 20, v60
    v_min_u32 v60, 19, v60
    v_lshrrev_b32 v35, 5, v0
    v_lshlrev_b32 v35, 2, v35
    v_add_u32 v35, 160832, v35
    v_lshl_add_u32 v35, v60, 3, v35
    s_add_u32 s66, s62, 39936
    s_add_u32 s67, s62, 25984
    s_lshl_b32 s57, s54, 3
    v_lshrrev_b32 v34, 5, v0
    v_lshlrev_b32 v34, 2, v34
    v_add_u32 v34, s57, v34
    v_and_b32 v60, 31, v0
    v_mov_b32 v61, 0x7f000000
    v_cmp_ne_u32 vcc, 31, v60
    s_nop 1
    v_cndmask_b32 v34, v34, v61, vcc
    v_mov_b32 v61, 0x3f803f80
    s_add_u32 s57, s7, 132096
    s_add_u32 s58, s7, 148480
    s_add_u32 s59, s7, 164864
    s_add_u32 s60, s7, 181248
    v_mov_b64 v[36:37], 0
    v_mov_b64 v[38:39], 0
    s_nop 0
    v_mov_b32_dpp v36, v2 quad_perm:[0,1,2,3] row_mask:0x3 bank_mask:0xf
    v_mov_b32_dpp v37, v3 quad_perm:[0,1,2,3] row_mask:0x3 bank_mask:0xf
    v_mov_b32_dpp v38, v2 quad_perm:[0,1,2,3] row_mask:0xc bank_mask:0xf
    v_mov_b32_dpp v39, v3 quad_perm:[0,1,2,3] row_mask:0xc bank_mask:0xf
    s_add_u32 s75, s7, 266248
    v_and_b32 v9, 7, v0
    v_lshlrev_b32 v9, 9, v9
L_pr_226:
    buffer_load_dword v12, v9, s[40:43], s75 offen sc1
    s_sub_u32 s56, s56, 1
    s_cbranch_scc1 L_done
L_pw_225:
    s_waitcnt vmcnt(0)
    v_cmp_eq_u32 vcc, -1, v12
    s_cbranch_vccnz L_pr_226
L_gw_222:
    buffer_load_dwordx4 v[12:15], v5, s[40:43], s57 offen sc1
    buffer_load_dwordx4 v[16:19], v5, s[40:43], s58 offen sc1
    buffer_load_dwordx4 v[20:23], v5, s[40:43], s59 offen sc1
    buffer_load_dwordx4 v[24:27], v5, s[40:43], s60 offen sc1
    s_sub_u32 s56, s56, 1
    s_cbranch_scc1 L_done
    s_and_b32 s74, s56, 31
    s_waitcnt vmcnt(3)
    v_pk_add_f32 v[28:29], v[12:13], v[36:37]
    v_pk_add_f32 v[30:31], v[14:15], v[38:39]
    s_waitcnt vmcnt(2)
    v_pk_add_f32 v[28:29], v[28:29], v[16:17]
    v_pk_add_f32 v[30:31], v[30:31], v[18:19]
    s_waitcnt vmcnt(1)
    v_pk_add_f32 v[28:29], v[28:29], v[20:21]
    v_pk_add_f32 v[30:31], v[30:31], v[22:23]
    s_waitcnt vmcnt(0)
    v_pk_add_f32 v[28:29], v[28:29], v[24:25]
    v_pk_add_f32 v[30:31], v[30:31], v[26:27]
    v_pk_add_f32 v[32:33], v[28:29], v[30:31]
    v_cmp_u_f32 vcc, v32, v33
    v_permlane32_swap_b32 v28, v30
    v_permlane32_swap_b32 v29, v31
    s_cbranch_vccnz L_gr_223
L_gk_224:
    v_pk_add_f32 v[28:29], v[28:29], v[30:31]
    v_cvt_pk_bf16_f32 v28, v28, v29
    ds_write_b32 v35, v28
    s_waitcnt lgkmcnt(0)
    s_barrier
    v_cndmask_b32 v29, 0, v28, s[64:65]
L_pad25:
    s_cbranch_execz L_padback
    v_dot2_f32_bf16 v33, v29, v61, 0
    v_dot2_f32_bf16 v32, v29, v29, 0
    v_lshlrev_b32 v2, 16, v28
    v_and_b32 v3, 0xffff0000, v28
    s_cmp_eq_u32 s55, 0
    v_permlane32_swap_b32 v33, v32
    v_add_f32 v33, v33, v32
    s_nop 1
    v_add_f32_dpp v33, v33, v33 row_ror:8 row_mask:0xf bank_mask:0xf
    s_nop 1
    v_add_f32_dpp v33, v33, v33 row_ror:4 row_mask:0xf bank_mask:0xf
    s_nop 1
    v_add_f32_dpp v33, v33, v33 row_ror:2 row_mask:0xf bank_mask:0xf
    s_nop 1
    v_add_f32_dpp v33, v33, v33 row_ror:1 row_mask:0xf bank_mask:0xf
    s_nop 1
    v_add_f32_dpp v33, v33, v33 row_bcast:15 row_mask:0xa bank_mask:0xf
    s_cbranch_scc1 L_gs_227
    buffer_store_dword v33, v34, s[40:43], s67 offen
L_gb_228:
    s_waitcnt vmcnt(1)
    s_branch L_se_218
.p2align 5
L_gr_230:
    s_cbranch_scc1 L_gw_229
    s_waitcnt vmcnt(0)
    v_max3_u32 v32, v12, v13, v14
    v_max3_u32 v32, v32, v15, v16
    v_max3_u32 v32, v32, v17, v18
    v_max3_u32 v32, v32, v19, v20
    v_max3_u32 v32, v32, v21, v22
    v_max3_u32 v32, v32, v23, v24
    v_max3_u32 v32, v32, v25, v26
    v_max_u32 v32, v32, v27
    v_cmp_eq_u32 vcc, -1, v32
    s_cbranch_vccnz L_gw_229
    v_pk_add_f32 v[28:29], v[12:13], v[36:37]
    v_pk_add_f32 v[30:31], v[14:15], v[38:39]
    v_pk_add_f32 v[28:29], v[28:29], v[16:17]
    v_pk_add_f32 v[30:31], v[30:31], v[18:19]
    v_pk_add_f32 v[28:29], v[28:29], v[20:21]
    v_pk_add_f32 v[30:31], v[30:31], v[22:23]
    v_pk_add_f32 v[28:29], v[28:29], v[24:25]
    v_pk_add_f32 v[30:31], v[30:31], v[26:27]
    s_nop 1
    v_permlane32_swap_b32 v28, v30
    v_permlane32_swap_b32 v29, v31
    s_branch L_gk_231
L_tail_end:
.p2align 5
L_spread:
    s_add_u32 s62, s62, 966656
    s_cmp_eq_u32 s30, 5
    s_cbranch_scc0 L_skip_67
    v_mov_b64 v[12:13], -1
    v_mov_b64 v[14:15], -1
    v_lshlrev_b32 v16, 4, v0
    s_mul_i32 s57, s52, 2208
    s_add_u32 s57, s57, s62
    s_mov_b64 exec, 0x3ff
    buffer_store_dwordx4 v[12:15], v16, s[40:43], s57 offen offset:2048 sc1
    s_mov_b64 exec, -1
    buffer_store_dwordx4 v[12:15], v16, s[40:43], s57 offen offset:0 sc1
    buffer_store_dwordx4 v[12:15], v16, s[40:43], s57 offen offset:1024 sc1
L_skip_67:
    s_cmp_eq_u32 s30, 7
    s_cbranch_scc0 L_skip_68
    v_and_b32 v60, 31, v0
    v_cmp_gt_u32 s[64:65], 20, v60
    v_min_u32 v60, 19, v60
    v_lshrrev_b32 v35, 5, v0
    v_lshlrev_b32 v35, 2, v35
    v_add_u32 v35, 160832, v35
    v_lshl_add_u32 v35, v60, 3, v35
    s_mul_i32 s66, s53, 12416
    s_add_u32 s66, s66, s62
    s_add_u32 s66, s66, 70656
    s_add_u32 s67, s66, 12288
    s_lshl_b32 s57, s54, 3
    v_lshrrev_b32 v34, 5, v0
    v_lshlrev_b32 v34, 2, v34
    v_add_u32 v34, s57, v34
    v_and_b32 v60, 31, v0
    v_mov_b32 v61, 0x7f000000
    v_cmp_ne_u32 vcc, 31, v60
    s_nop 1
    v_cndmask_b32 v34, v34, v61, vcc
    v_mov_b32 v61, 0x3f803f80
    v_cvt_pk_bf16_f32 v28, v2, v3
L_skip_68:
    s_cmp_eq_u32 s30, 7
    s_cbranch_scc0 L_skip_69
    v_cndmask_b32 v29, 0, v28, s[64:65]
    v_dot2_f32_bf16 v33, v29, v61, 0
    v_dot2_f32_bf16 v32, v29, v29, 0
    v_lshlrev_b32 v2, 16, v28
    v_and_b32 v3, 0xffff0000, v28
    s_cmp_eq_u32 s55, 0
    v_permlane32_swap_b32 v33, v32
    v_add_f32 v33, v33, v32
    s_nop 1
    v_add_f32_dpp v33, v33, v33 row_ror:8 row_mask:0xf bank_mask:0xf
    s_nop 1
    v_add_f32_dpp v33, v33, v33 row_ror:4 row_mask:0xf bank_mask:0xf
    s_nop 1
    v_add_f32_dpp v33, v33, v33 row_ror:2 row_mask:0xf bank_mask:0xf
    s_nop 1
    v_add_f32_dpp v33, v33, v33 row_ror:1 row_mask:0xf bank_mask:0xf
    s_nop 1
    v_add_f32_dpp v33, v33, v33 row_bcast:15 row_mask:0xa bank_mask:0xf
    s_cbranch_scc1 L_gs_70
    buffer_store_dword v33, v34, s[40:43], s67 offen
L_gb_71:
    s_waitcnt vmcnt(1)
L_skip_69:
    s_cmp_lt_u32 s30, 6
    s_cbranch_scc0 L_skip_72
    s_lshr_b32 s57, s30, 1
    s_mul_i32 s57, s57, 1024
    s_and_b32 s58, s30, 1
    s_lshl_b32 s58, s58, 6
    s_add_u32 s57, s57, s58
    v_lshrrev_b32 v18, 5, v0
    v_mul_u32_u24 v18, 6144, v18
    v_bfe_u32 v60, v0, 3, 1
    v_mul_u32_u24 v60, 3072, v60
    v_add_u32 v18, v60, v18
    v_bfe_u32 v60, v0, 4, 1
    v_lshl_add_u32 v18, v60, 9, v18
    v_bfe_u32 v60, v0, 2, 1
    v_lshl_add_u32 v18, v60, 7, v18
    v_and_b32 v60, 3, v0
    v_lshl_add_u32 v18, v60, 3, v18
    v_add_u32 v18, s57, v18
    v_bfe_u32 v19, v0, 4, 1
    v_mul_u32_u24 v19, 3072, v19
    v_bfe_u32 v60, v0, 3, 1
    v_lshl_add_u32 v19, v60, 9, v19
    v_bfe_u32 v60, v0, 2, 1
    v_lshl_add_u32 v19, v60, 7, v19
    v_and_b32 v60, 3, v0
    v_lshl_add_u32 v19, v60, 3, v19
    v_add_u32 v19, s57, v19
    v_add_u32 v19, 24576, v19
    ds_read_b64_tr_b16 v[28:29], v18 offset:0
    ds_read_b64_tr_b16 v[30:31], v18 offset:256
    ds_read_b64_tr_b16 v[32:33], v18 offset:12288
    ds_read_b64_tr_b16 v[34:35], v18 offset:12544
    ds_read_b64_tr_b16 v[36:37], v19 offset:0
    ds_read_b64_tr_b16 v[38:39], v19 offset:256
    ds_read_b64_tr_b16 v[40:41], v18 offset:32
    ds_read_b64_tr_b16 v[42:43], v18 offset:288
    ds_read_b64_tr_b16 v[44:45], v18 offset:12320
    ds_read_b64_tr_b16 v[46:47], v18 offset:12576
    ds_read_b64_tr_b16 v[48:49], v19 offset:32
    ds_read_b64_tr_b16 v[50:51], v19 offset:288
    v_lshrrev_b32 v52, 4, v0
    v_lshlrev_b32 v52, 5, v52
    v_bfe_u32 v60, v0, 1, 1
    v_lshl_add_u32 v52, v60, 4, v52
    v_and_b32 v60, 1, v0
    v_mul_u32_u24 v60, 192, v60
    v_add_u32 v52, v60, v52
    v_add_u32 v52, 160832, v52
    v_lshrrev_b32 v53, 4, v0
    v_lshlrev_b32 v53, 4, v53
    v_bfe_u32 v60, v0, 1, 1
    v_lshl_add_u32 v53, v60, 3, v53
    v_and_b32 v60, 1, v0
    v_mul_u32_u24 v60, 192, v60
    v_add_u32 v53, v60, v53
    v_add_u32 v53, 160960, v53
    v_mov_b64 v[20:21], 0
    v_mov_b64 v[22:23], 0
    v_mov_b64 v[24:25], 0
    v_mov_b64 v[26:27], 0
    s_lshr_b32 s57, s30, 1
    s_lshl_b32 s57, s57, 11
    s_lshl_b32 s58, s58, 1
    s_add_u32 s57, s57, s58
    s_lshl_b32 s58, s54, 8
    s_add_u32 s57, s57, s58
    v_and_b32 v54, 31, v0
    v_lshlrev_b32 v54, 2, v54
    v_lshrrev_b32 v60, 5, v0
    v_mul_u32_u24 v60, 6144, v60
    v_add_u32 v54, v60, v54
    v_add_u32 v54, s57, v54
    s_mul_i32 s59, s53, 12416
    s_add_u32 s59, s59, s62
    s_add_u32 s59, s59, 70656
    s_add_u32 s60, s59, 12288
    ds_read_b128 v[12:15], v52
    ds_read_b64 v[16:17], v53
    s_waitcnt lgkmcnt(1)
    v_smfmac_f32_16x16x64_bf16 v[20:23], v[12:15], v[28:35], v1
    v_smfmac_f32_16x16x64_bf16 v[24:27], v[12:15], v[40:47], v1
    s_waitcnt lgkmcnt(0)
    v_smfmac_f32_16x16x32_bf16 v[20:23], v[16:17], v[36:39], v1
    v_smfmac_f32_16x16x32_bf16 v[24:27], v[16:17], v[48:51], v1
    s_cmp_eq_u32 s55, 0
    s_nop 5
    v_add_f32 v12, v20, v22
    s_nop 1
    v_add_f32_dpp v12, v24, v26 quad_perm:[0,1,2,3] row_mask:0x2 bank_mask:0xf
    s_nop 1
    v_add_f32_dpp v12, v21, v23 quad_perm:[0,1,2,3] row_mask:0x4 bank_mask:0xf
    s_nop 1
    v_add_f32_dpp v12, v25, v27 quad_perm:[0,1,2,3] row_mask:0x8 bank_mask:0xf
    s_cbranch_scc1 L_gs_73
    buffer_store_dword v12, v54, s[40:43], s59 offen
L_gb_74:
L_skip_72:
    s_waitcnt vmcnt(0)
    s_barrier
    s_cmp_eq_u32 s30, 5
    s_cbranch_scc0 L_skip_75
    v_mov_b32 v25, 0
    s_lshl_b32 s57, s52, 2
    s_add_u32 s57, s57, s72
    s_mov_b64 exec, 1
    buffer_store_dword v25, v0, s[40:43], s57 offen offset:256 sc1
    s_mov_b64 exec, -1
    v_and_b32 v16, 31, v0
    v_lshlrev_b32 v16, 2, v16
L_pr_77:
    buffer_load_dword v17, v16, s[40:43], s72 offen offset:256 sc1
    s_sub_u32 s56, s56, 1
    s_cbranch_scc1 L_done
L_pw_76:
    s_waitcnt vmcnt(0)
    v_cmp_eq_u32 vcc, -1, v17
    s_cbranch_vccnz L_pr_77
L_skip_75:
    s_barrier
    s_branch L_spread_back
.p2align 5
L_done:
L_exit:
    s_endpgm
.section .rodata,"a"
.p2align 6
.amdhsa_kernel interleave_layers__sliding_block_cached__dense_activation_gelu__decode_kernel
  .amdhsa_next_free_vgpr 256
  .amdhsa_next_free_sgpr 102
  .amdhsa_accum_offset 256
  .amdhsa_group_segment_fixed_size 0
  .amdhsa_kernarg_size 104
  .amdhsa_user_sgpr_count 2
  .amdhsa_user_sgpr_kernarg_segment_ptr 1
  .amdhsa_system_sgpr_workgroup_id_x 1
  .amdhsa_float_denorm_mode_32 3
.end_amdhsa_kernel
```

```asm
; @launch grid=(256,1,1) block=(512,1,1) lds=161216
.amdgcn_target "amdgcn-amd-amdhsa--gfx950"
.text
.fill 64, 4, 0xbf800000
.globl interleave_layers__sliding_block_cached__dense_activation_gelu__decode_kernel
.p2align 8
.type interleave_layers__sliding_block_cached__dense_activation_gelu__decode_kernel,@function
interleave_layers__sliding_block_cached__dense_activation_gelu__decode_kernel:
    s_load_dwordx16 s[4:19], s[0:1], 0
    s_cmp_ge_u32 s2, 256
    s_cbranch_scc1 L_exit
    v_lshrrev_b32 v5, 6, v0
    v_lshlrev_b32 v62, 6, v0
    v_readfirstlane_b32 s30, v5
    v_and_b32 v0, 63, v0
    s_getpc_b64 s[74:75]
L_pc:
    v_min_u32 v62, L_exit-L_pc, v62
    global_load_dword v63, v62, s[74:75]
    s_cmp_eq_u32 s30, 6
    s_cbranch_scc0 L_skip_1
    s_setprio 3
L_skip_1:
    s_and_b32 s31, s2, 7
    s_lshr_b32 s52, s2, 3
    s_and_b32 s53, s52, 3
    s_lshr_b32 s54, s52, 2
    s_lshl_b32 s73, s31, 2
    s_add_u32 s73, s73, s53
    v_lshrrev_b32 v8, 5, v0
    v_lshlrev_b32 v8, 2, v8
    v_bfe_u32 v60, v0, 4, 1
    v_lshl_add_u32 v8, v60, 0, v8
    v_and_b32 v9, 7, v0
    v_xor_b32 v8, v8, v9
    v_lshrrev_b32 v10, 3, v0
    v_mul_u32_u24 v10, 384, v10
    v_lshl_add_u32 v5, v8, 4, v10
    v_xor_b32 v6, 32, v5
    s_mul_i32 s64, s73, 12582912
    s_mul_i32 s58, s54, 3072
    s_add_u32 s64, s64, s58
    s_add_u32 s64, s64, 11010048
    s_sub_u32 s34, 1572864, s58
    s_mov_b32 s35, 0x20000
    s_mov_b32 s57, 0
    s_mov_b32 s58, 195584
    s_mov_b32 m0, 92160
    s_cmp_eq_u32 s30, 6
    s_cselect_b64 vcc, -1, 0
    s_waitcnt lgkmcnt(0)
    s_add_u32 s32, s6, s64
    s_addc_u32 s33, s7, 0
    s_load_dwordx8 s[20:27], s[0:1], 64
    s_load_dwordx2 s[28:29], s[0:1], 96
    s_cbranch_vccz L_skip_3
L_dma_2:
    buffer_load_dwordx4 v5, s[32:35], s57 offen offset:0 nt lds
    buffer_load_dwordx4 v6, s[32:35], s58 offen offset:1024 nt lds
    s_add_u32 s57, s57, 24576
    s_add_u32 s58, s58, 24576
    s_add_u32 m0, m0, 2048
    s_cmp_lg_u32 m0, 108544
    s_cbranch_scc1 L_dma_2
    s_mov_b32 s57, 128
    s_mov_b32 s58, 195712
    s_mov_b32 m0, 108544
L_dma_4:
    s_nop 0
    buffer_load_dwordx4 v5, s[32:35], s57 offen offset:0 nt lds
    buffer_load_dwordx4 v6, s[32:35], s58 offen offset:1024 nt lds
    s_add_u32 s57, s57, 24576
    s_add_u32 s58, s58, 24576
    s_add_u32 m0, m0, 2048
    s_cmp_lg_u32 m0, 116736
    s_cbranch_scc1 L_dma_4
L_skip_3:
    s_mul_i32 s3, s54, 3
    s_add_u32 s3, s3, s53
    s_cmp_eq_u32 s53, 3
    s_cselect_b32 s3, 31, s3
    v_lshrrev_b32 v8, 4, v0
    v_lshlrev_b32 v8, 1, v8
    v_xor_b32 v8, v8, v9
    v_lshl_add_u32 v7, v8, 4, v10
    v_lshrrev_b32 v2, 3, v0
    v_mul_u32_u24 v2, 12288, v2
    v_and_b32 v60, 7, v0
    v_lshl_add_u32 v2, v60, 4, v2
    s_mul_i32 s59, s73, 384
    s_mul_i32 s60, s54, 983040
    s_add_u32 s59, s59, s60
    s_sub_u32 s60, 7866368, s59
    s_lshl_b32 s61, s30, 11
    s_add_u32 s61, s61, 92160
    s_mul_i32 s62, s31, 120832
    s_add_u32 s62, s62, 299008
    s_lshl_b32 s72, s31, 9
    s_add_u32 s72, s72, 294912
    s_mov_b32 s56, 65536
    s_mov_b32 s55, 1
    s_getreg_b32 s63, hwreg(20, 0, 3)
    v_mov_b32 v3, 0
    v_mov_b32 v4, 0
    v_mov_b32 v11, 0
    v_mov_b32 v24, 0
    v_mov_b32 v34, 0
    v_mov_b64 v[12:13], -1
    v_mov_b64 v[14:15], -1
    v_lshlrev_b32 v10, 4, v0
    s_waitcnt lgkmcnt(0)
    s_add_u32 s36, s8, s64
    s_addc_u32 s37, s9, 0
    s_mov_b32 s38, s34
    s_mov_b32 s39, 0x20000
    s_mov_b32 s40, s28
    s_mov_b32 s41, s29
    s_mov_b32 s42, 2232320
    s_mov_b32 s43, 0x20000
    s_add_u32 s44, s10, s59
    s_addc_u32 s45, s11, 0
    s_mov_b32 s46, s60
    s_mov_b32 s47, 0x20000
    s_sub_u32 s44, s44, 2048
    s_subb_u32 s45, s45, 0
    s_cmp_lt_u32 s3, 20
    s_cselect_b32 s57, 7864320, 0
    s_add_u32 s58, s54, 1
    s_mul_i32 s58, s58, 245760
    s_cmp_lg_u32 s53, 3
    s_cselect_b64 s[48:49], s[12:13], s[16:17]
    s_cselect_b32 s50, s57, s58
    s_mov_b32 s51, 0x20000
    s_add_u32 s57, s28, 0
    s_sub_u32 s57, 0, s57
    s_and_b32 s57, s57, 0x3fff
    s_add_u32 s57, s57, 0
    s_lshr_b32 s58, s31, 1
    s_lshl_b32 s58, s58, 14
    s_add_u32 s6, s57, s58
    s_and_b32 s58, s31, 1
    s_lshl_b32 s58, s58, 12
    s_add_u32 s6, s6, s58
    s_lshl_b32 s58, s3, 7
    s_add_u32 s6, s6, s58
    s_mov_b32 s8, s57
    s_and_b32 s59, s3, 3
    s_lshl_b32 s58, s31, 2
    s_add_u32 s59, s59, s58
    s_lshl_b32 s59, s59, 7
    s_add_u32 s59, s59, s57
    s_add_u32 s59, s59, 262144
    s_add_u32 s10, s28, s59
    s_addc_u32 s11, s29, 0
    s_lshr_b32 s58, s63, 2
    s_xor_b32 s58, s58, 0
    s_mul_i32 s58, s58, 8192
    s_add_u32 s7, s57, s58
    s_cmp_eq_u32 s30, 5
    s_cbranch_scc0 L_skip_5
    s_cmp_eq_u32 s52, 31
    s_cbranch_scc0 L_skip_6
    s_mov_b64 exec, 0xffffff
    buffer_store_dwordx4 v[12:15], v10, s[40:43], s72 offen sc1
    s_mov_b64 exec, -1
L_skip_6:
    s_cmp_lt_u32 s3, 20
    s_cbranch_scc0 L_skip_7
    v_and_b32 v16, 7, v0
    v_lshlrev_b32 v16, 4, v16
    v_bfe_u32 v17, v0, 3, 1
    v_lshl_add_u32 v16, v17, 13, v16
    v_lshrrev_b32 v17, 4, v0
    v_mul_u32_u24 v17, 66048, v17
    v_add_u32 v16, v17, v16
    buffer_store_dwordx4 v[12:15], v16, s[40:43], s6 offen sc1
L_skip_7:
    s_cmp_eq_u32 s3, 20
    s_cbranch_scc0 L_skip_8
    s_lshl_b32 s58, s31, 9
    s_add_u32 s58, s58, s8
    s_add_u32 s58, s58, 266240
    v_and_b32 v16, 7, v0
    v_lshlrev_b32 v16, 4, v16
    v_bfe_u32 v60, v0, 3, 1
    v_lshl_add_u32 v16, v60, 13, v16
    v_lshrrev_b32 v60, 4, v0
    v_lshl_add_u32 v16, v60, 28, v16
    buffer_store_dwordx4 v[12:15], v16, s[40:43], s58 offen sc1
L_skip_8:
    s_sub_u32 s58, s3, 20
    s_cmp_lt_u32 s58, 4
    s_cselect_b32 s59, s59, 0x7f000000
    v_and_b32 v16, 7, v0
    v_lshlrev_b32 v16, 4, v16
    v_bfe_u32 v60, v0, 3, 1
    v_lshl_add_u32 v16, v60, 13, v16
    v_lshrrev_b32 v60, 4, v0
    v_lshl_add_u32 v16, v60, 28, v16
    buffer_store_dwordx4 v[12:15], v16, s[40:43], s59 offen sc1
    s_mul_i32 s57, s52, 2208
    s_add_u32 s57, s57, s62
    s_mov_b64 exec, 0x3ff
    buffer_store_dwordx4 v[12:15], v10, s[40:43], s57 offen offset:2048
    s_mov_b64 exec, -1
    buffer_store_dwordx4 v[12:15], v10, s[40:43], s57 offen offset:0
    buffer_store_dwordx4 v[12:15], v10, s[40:43], s57 offen offset:1024
    s_mov_b64 exec, -1
    v_lshlrev_b32 v16, 4, v0
    v_add_u32 v16, 159744, v16
    ds_write_b128 v16, v[12:15]
    v_and_b32 v3, 7, v0
    v_lshlrev_b32 v3, 5, v3
L_skip_5:
    s_cmp_eq_u32 s30, 7
    s_cbranch_scc0 L_skip_9
    v_and_b32 v60, 31, v0
    v_min_u32 v60, 19, v60
    s_mul_i32 s57, s54, 160
    v_lshrrev_b32 v16, 5, v0
    v_lshlrev_b32 v16, 2, v16
    v_add_u32 v16, s57, v16
    v_lshl_add_u32 v16, v60, 3, v16
    global_load_dword v28, v16, s[4:5]
    global_load_dword v4, v16, s[22:23]
L_skip_9:
    s_sub_u32 s58, s30, 4
    s_cmp_lt_u32 s58, 3
    s_cbranch_scc0 L_skip_10
    s_mul_i32 s57, s31, 3
    s_add_u32 s57, s57, s58
    s_lshl_b32 s57, s57, 7
    v_and_b32 v16, 15, v0
    v_lshlrev_b32 v16, 3, v16
    v_lshrrev_b32 v60, 4, v0
    v_lshl_add_u32 v16, v60, 1, v16
    v_add_u32 v16, s57, v16
    global_load_short_d16_hi v4, v16, s[18:19]
L_skip_10:
    v_bfe_u32 v8, v0, 1, 3
    v_lshrrev_b32 v9, 4, v0
    v_xor_b32 v9, v8, v9
    v_bfe_u32 v8, v0, 2, 1
    v_lshlrev_b32 v8, 10, v8
    v_bfe_u32 v60, v0, 3, 1
    v_lshl_add_u32 v8, v60, 9, v8
    v_and_b32 v60, 3, v0
    v_lshl_add_u32 v8, v60, 7, v8
    v_add_u32 v8, s61, v8
    v_lshl_add_u32 v8, v9, 4, v8
    v_xor_b32 v9, 64, v8
    v_bfe_u32 v1, v0, 1, 1
    v_mul_u32_u24 v1, 43690, v1
    v_add_u32 v1, 17476, v1
    s_cmp_eq_u32 s30, 6
    s_cbranch_scc0 L_skip_11
    s_mov_b32 s57, 98432
    s_mov_b32 s58, 294016
    s_mov_b32 m0, 116736
L_dma_12:
    s_waitcnt vmcnt(22)
    buffer_load_dwordx4 v5, s[32:35], s57 offen offset:0 nt lds
    buffer_load_dwordx4 v6, s[32:35], s58 offen offset:1024 nt lds
    s_add_u32 s57, s57, 24576
    s_add_u32 s58, s58, 24576
    s_add_u32 m0, m0, 2048
    s_cmp_lg_u32 m0, 124928
    s_cbranch_scc1 L_dma_12
    s_mov_b32 s57, 2048
    s_mov_b32 s58, 1152
    s_mov_b32 s59, 256
    s_mov_b32 m0, 0
L_dma_13:
    s_waitcnt vmcnt(22)
    buffer_load_dwordx4 v2, s[44:47], s57 offen offset:0 nt lds
    buffer_load_dwordx4 v2, s[44:47], s58 offen offset:1024 nt lds
    buffer_load_dwordx4 v2, s[44:47], s59 offen offset:2048 nt lds
    s_add_u32 s57, s57, 98304
    s_add_u32 s58, s58, 98304
    s_add_u32 s59, s59, 98304
    s_add_u32 m0, m0, 3072
    s_cmp_lg_u32 m0, 15360
    s_cbranch_scc1 L_dma_13
L_skip_11:
    s_waitcnt vmcnt(31)
    s_barrier
    ds_read_b128 v[64:67], v8 offset:0
    ds_read_b128 v[68:71], v9 offset:0
    s_cmp_eq_u32 s30, 6
    s_cbranch_scc0 L_skip_14
    s_mov_b32 s57, 256
    s_mov_b32 s58, 195840
    s_mov_b32 m0, 124928
L_dma_15:
    s_waitcnt vmcnt(22)
    buffer_load_dwordx4 v5, s[32:35], s57 offen offset:0 nt lds
    buffer_load_dwordx4 v6, s[32:35], s58 offen offset:1024 nt lds
    s_add_u32 s57, s57, 24576
    s_add_u32 s58, s58, 24576
    s_add_u32 m0, m0, 2048
    s_cmp_lg_u32 m0, 141312
    s_cbranch_scc1 L_dma_15
L_skip_14:
    s_waitcnt lgkmcnt(0)
    s_cmp_eq_u32 s30, 5
    s_cbranch_scc0 L_skip_16
    s_cmp_eq_u32 s52, 31
    s_cbranch_scc0 L_skip_17
    s_lshl_b32 s57, s31, 5
    v_mov_b32 v16, s57
    s_add_u32 s57, s63, 1
    v_mov_b32 v12, s57
    s_waitcnt vmcnt(5)
    s_mov_b64 exec, 0x1
    global_store_dword v16, v12, s[26:27] sc1
    s_mov_b64 exec, -1
L_skip_17:
L_skip_16:
    s_waitcnt vmcnt(31)
    s_barrier
    ds_read_b128 v[72:75], v8 offset:16384
    ds_read_b128 v[76:79], v9 offset:16384
    s_cmp_eq_u32 s30, 6
    s_cbranch_scc0 L_skip_18
    s_mov_b32 s57, 493568
    s_mov_b32 s58, 492672
    s_mov_b32 s59, 491776
    s_mov_b32 m0, 15360
L_dma_19:
    s_waitcnt vmcnt(22)
    buffer_load_dwordx4 v2, s[44:47], s57 offen offset:0 nt lds
    buffer_load_dwordx4 v2, s[44:47], s58 offen offset:1024 nt lds
    buffer_load_dwordx4 v2, s[44:47], s59 offen offset:2048 nt lds
    s_add_u32 s57, s57, 98304
    s_add_u32 s58, s58, 98304
    s_add_u32 s59, s59, 98304
    s_add_u32 m0, m0, 3072
    s_cmp_lg_u32 m0, 30720
    s_cbranch_scc1 L_dma_19
    s_mov_b32 s57, 393216
    s_mov_b32 s58, 588800
    s_mov_b32 m0, 141312
L_dma_20:
    s_waitcnt vmcnt(22)
    buffer_load_dwordx4 v5, s[32:35], s57 offen offset:0 nt lds
    buffer_load_dwordx4 v6, s[32:35], s58 offen offset:1024 nt lds
    s_add_u32 s57, s57, 24576
    s_add_u32 s58, s58, 24576
    s_add_u32 m0, m0, 2048
    s_cmp_lg_u32 m0, 157696
    s_cbranch_scc1 L_dma_20
L_skip_18:
    s_waitcnt lgkmcnt(0)
    s_cmp_lt_u32 s30, 4
    s_cbranch_scc0 L_skip_21
    s_mov_b64 exec, 0
    s_cmp_eq_u32 s30, 1
    s_cbranch_scc1 L_pad1
    s_cmp_eq_u32 s30, 2
    s_cbranch_scc1 L_pad2
    s_cmp_eq_u32 s30, 3
    s_cbranch_scc1 L_pad3
    s_branch L_pad0
.p2align 5
L_padback:
    s_mov_b64 exec, -1
L_skip_21:
    s_waitcnt vmcnt(31)
    s_barrier
    ds_read_b128 v[80:83], v8 offset:32768
    ds_read_b128 v[84:87], v9 offset:32768
    s_cmp_eq_u32 s30, 6
    s_cbranch_scc0 L_skip_22
    s_cmp_lg_u32 s53, 3
    s_cbranch_scc0 L_wb_23
    s_mul_i32 s57, s31, 983040
    s_lshl_b32 s58, s3, 6
    s_add_u32 s57, s57, s58
    v_bfe_u32 v38, v0, 4, 1
    v_lshlrev_b32 v38, 1, v38
    v_xor_b32 v38, v38, v0
    v_and_b32 v38, 3, v38
    v_lshrrev_b32 v3, 5, v0
    v_mul_u32_u24 v3, 10240, v3
    v_bfe_u32 v39, v0, 4, 1
    v_mul_u32_u24 v39, 2560, v39
    v_add_u32 v3, v39, v3
    v_bfe_u32 v39, v0, 3, 1
    v_mul_u32_u24 v39, 5120, v39
    v_add_u32 v3, v39, v3
    v_bfe_u32 v39, v0, 2, 1
    v_mul_u32_u24 v39, 20480, v39
    v_add_u32 v3, v39, v3
    v_add_u32 v3, s57, v3
    v_lshl_add_u32 v3, v38, 4, v3
    s_mov_b32 s14, 40960
    s_mov_b32 s15, 256
    s_branch L_we_24
.p2align 5
L_wb_23:
    s_mul_i32 s57, s31, 384
    s_mul_i32 s58, s54, 245760
    s_add_u32 s57, s57, s58
    v_lshlrev_b32 v3, 4, v0
    v_add_u32 v3, s57, v3
    v_mov_b32 v38, 2688
    v_cmp_lt_u32 vcc, 23, v0
    s_nop 1
    v_cndmask_b32 v38, 0, v38, vcc
    v_add_u32 v3, v38, v3
    v_mov_b32 v38, 0x7f000000
    v_cmp_lt_u32 vcc, 47, v0
    s_nop 1
    v_cndmask_b32 v3, v3, v38, vcc
    s_mov_b32 s14, 12288
    s_mov_b32 s15, 5120
L_we_24:
    s_mul_i32 s57, s14, 0
    s_mov_b32 m0, 30720
    s_nop 0
    buffer_load_dwordx4 v3, s[48:51], s57 offen offset:0 nt lds
    s_mul_i32 s57, s14, 0
    s_add_u32 s57, s57, s15
    s_mov_b32 m0, 30720
    s_nop 0
    buffer_load_dwordx4 v3, s[48:51], s57 offen offset:1024 nt lds
    s_mov_b32 s57, 393344
    s_mov_b32 s58, 588928
    s_mov_b32 m0, 92160
L_dma_25:
    s_waitcnt vmcnt(22)
    buffer_load_dwordx4 v5, s[32:35], s57 offen offset:0 nt lds
    buffer_load_dwordx4 v6, s[32:35], s58 offen offset:1024 nt lds
    s_add_u32 s57, s57, 24576
    s_add_u32 s58, s58, 24576
    s_add_u32 m0, m0, 2048
    s_cmp_lg_u32 m0, 108544
    s_cbranch_scc1 L_dma_25
    s_mul_i32 s57, s14, 1
    s_mov_b32 m0, 32768
    s_nop 0
    buffer_load_dwordx4 v3, s[48:51], s57 offen offset:0 nt lds
    s_mul_i32 s57, s14, 1
    s_add_u32 s57, s57, s15
    s_mov_b32 m0, 32768
    s_nop 0
    buffer_load_dwordx4 v3, s[48:51], s57 offen offset:1024 nt lds
    s_mov_b32 s57, 393472
    s_mov_b32 s58, 589056
    s_mov_b32 m0, 108544
L_dma_26:
    s_waitcnt vmcnt(22)
    buffer_load_dwordx4 v5, s[32:35], s57 offen offset:0 nt lds
    buffer_load_dwordx4 v6, s[32:35], s58 offen offset:1024 nt lds
    s_add_u32 s57, s57, 24576
    s_add_u32 s58, s58, 24576
    s_add_u32 m0, m0, 2048
    s_cmp_lg_u32 m0, 124928
    s_cbranch_scc1 L_dma_26
L_skip_22:
    s_waitcnt lgkmcnt(0)
    s_cmp_lt_u32 s30, 5
    s_cbranch_scc0 L_skip_27
    s_waitcnt vmcnt(0)
L_skip_27:
    s_cmp_eq_u32 s30, 7
    s_cbranch_scc0 L_skip_28
    v_and_b32 v60, 31, v0
    v_cmp_gt_u32 s[64:65], 20, v60
    v_min_u32 v60, 19, v60
    v_lshrrev_b32 v35, 5, v0
    v_lshlrev_b32 v35, 2, v35
    v_add_u32 v35, 160832, v35
    v_lshl_add_u32 v35, v60, 3, v35
    s_mul_i32 s66, s53, 12416
    s_add_u32 s66, s66, s62
    s_add_u32 s66, s66, 70656
    s_add_u32 s67, s66, 12288
    s_lshl_b32 s57, s54, 3
    v_lshrrev_b32 v34, 5, v0
    v_lshlrev_b32 v34, 2, v34
    v_add_u32 v34, s57, v34
    v_and_b32 v60, 31, v0
    v_mov_b32 v61, 0x7f000000
    v_cmp_ne_u32 vcc, 31, v60
    s_nop 1
    v_cndmask_b32 v34, v34, v61, vcc
    v_mov_b32 v61, 0x3f803f80
    s_waitcnt vmcnt(0)
    ds_write_b32 v35, v28
    s_waitcnt lgkmcnt(0)
L_skip_28:
    s_cmp_eq_u32 s30, 5
    s_cbranch_scc0 L_skip_29
    s_waitcnt vmcnt(0)
    s_lshr_b32 s67, s63, 2
    s_sub_u32 s58, s3, 20
    s_cmp_lt_u32 s58, 4
    s_cbranch_scc0 L_skip_30
    s_mov_b32 s67, 0
    s_load_dword s66, s[10:11], 0
    s_load_dword s67, s[10:11], 8192
    s_waitcnt lgkmcnt(1)
L_skip_30:
    v_subrev_u32 v16, 8, v0
    v_cmp_gt_u32 vcc, 40, v16
    v_mov_b32 v16, 0x3f803f80
    s_nop 0
    v_cndmask_b32 v18, 0, v16, vcc
    v_min_u32 v16, 55, v0
    v_lshlrev_b32 v16, 2, v16
    v_add_u32 v16, 160992, v16
    ds_write_b32 v16, v18
    s_mov_b32 s65, s67
    s_waitcnt lgkmcnt(0)
L_skip_29:
    s_waitcnt vmcnt(36)
    s_barrier
    ds_read_b128 v[88:91], v8 offset:49152
    ds_read_b128 v[92:95], v9 offset:49152
    s_cmp_eq_u32 s30, 6
    s_cbranch_scc0 L_skip_31
    s_mul_i32 s57, s14, 2
    s_mov_b32 m0, 34816
    s_nop 0
    buffer_load_dwordx4 v3, s[48:51], s57 offen offset:0 nt lds
    s_mul_i32 s57, s14, 2
    s_add_u32 s57, s57, s15
    s_mov_b32 m0, 34816
    s_nop 0
    buffer_load_dwordx4 v3, s[48:51], s57 offen offset:1024 nt lds
    s_mov_b32 s57, 786432
    s_mov_b32 s58, 982016
    s_mov_b32 m0, 124928
L_dma_32:
    s_waitcnt vmcnt(22)
    buffer_load_dwordx4 v5, s[32:35], s57 offen offset:0 nt lds
    buffer_load_dwordx4 v6, s[32:35], s58 offen offset:1024 nt lds
    s_add_u32 s57, s57, 24576
    s_add_u32 s58, s58, 24576
    s_add_u32 m0, m0, 2048
    s_cmp_lg_u32 m0, 141312
    s_cbranch_scc1 L_dma_32
L_skip_31:
    s_waitcnt lgkmcnt(0)
    s_cmp_eq_u32 s30, 7
    s_cbranch_scc0 L_skip_33
    v_cndmask_b32 v29, 0, v28, s[64:65]
    v_dot2_f32_bf16 v33, v29, v61, 0
    v_dot2_f32_bf16 v32, v29, v29, 0
    v_lshlrev_b32 v2, 16, v28
    v_and_b32 v3, 0xffff0000, v28
    s_cmp_eq_u32 s55, 0
    v_permlane32_swap_b32 v33, v32
    v_add_f32 v33, v33, v32
    s_nop 1
    v_add_f32_dpp v33, v33, v33 row_ror:8 row_mask:0xf bank_mask:0xf
    s_nop 1
    v_add_f32_dpp v33, v33, v33 row_ror:4 row_mask:0xf bank_mask:0xf
    s_nop 1
    v_add_f32_dpp v33, v33, v33 row_ror:2 row_mask:0xf bank_mask:0xf
    s_nop 1
    v_add_f32_dpp v33, v33, v33 row_ror:1 row_mask:0xf bank_mask:0xf
    s_nop 1
    v_add_f32_dpp v33, v33, v33 row_bcast:15 row_mask:0xa bank_mask:0xf
    s_cbranch_scc1 L_gs_34
    buffer_store_dword v33, v34, s[40:43], s67 offen
L_gb_35:
    s_waitcnt vmcnt(1)
L_skip_33:
    s_cmp_lt_u32 s30, 6
    s_cbranch_scc0 L_skip_36
    s_lshr_b32 s57, s30, 1
    s_mul_i32 s57, s57, 1024
    s_and_b32 s58, s30, 1
    s_lshl_b32 s58, s58, 6
    s_add_u32 s57, s57, s58
    v_lshrrev_b32 v18, 5, v0
    v_mul_u32_u24 v18, 6144, v18
    v_bfe_u32 v60, v0, 3, 1
    v_mul_u32_u24 v60, 3072, v60
    v_add_u32 v18, v60, v18
    v_bfe_u32 v60, v0, 4, 1
    v_lshl_add_u32 v18, v60, 9, v18
    v_bfe_u32 v60, v0, 2, 1
    v_lshl_add_u32 v18, v60, 7, v18
    v_and_b32 v60, 3, v0
    v_lshl_add_u32 v18, v60, 3, v18
    v_add_u32 v18, s57, v18
    v_bfe_u32 v19, v0, 4, 1
    v_mul_u32_u24 v19, 3072, v19
    v_bfe_u32 v60, v0, 3, 1
    v_lshl_add_u32 v19, v60, 9, v19
    v_bfe_u32 v60, v0, 2, 1
    v_lshl_add_u32 v19, v60, 7, v19
    v_and_b32 v60, 3, v0
    v_lshl_add_u32 v19, v60, 3, v19
    v_add_u32 v19, s57, v19
    v_add_u32 v19, 24576, v19
    ds_read_b64_tr_b16 v[28:29], v18 offset:0
    ds_read_b64_tr_b16 v[30:31], v18 offset:256
    ds_read_b64_tr_b16 v[32:33], v18 offset:12288
    ds_read_b64_tr_b16 v[34:35], v18 offset:12544
    ds_read_b64_tr_b16 v[36:37], v19 offset:0
    ds_read_b64_tr_b16 v[38:39], v19 offset:256
    ds_read_b64_tr_b16 v[40:41], v18 offset:32
    ds_read_b64_tr_b16 v[42:43], v18 offset:288
    ds_read_b64_tr_b16 v[44:45], v18 offset:12320
    ds_read_b64_tr_b16 v[46:47], v18 offset:12576
    ds_read_b64_tr_b16 v[48:49], v19 offset:32
    ds_read_b64_tr_b16 v[50:51], v19 offset:288
    v_lshrrev_b32 v52, 4, v0
    v_lshlrev_b32 v52, 5, v52
    v_bfe_u32 v60, v0, 1, 1
    v_lshl_add_u32 v52, v60, 4, v52
    v_and_b32 v60, 1, v0
    v_mul_u32_u24 v60, 192, v60
    v_add_u32 v52, v60, v52
    v_add_u32 v52, 160832, v52
    v_lshrrev_b32 v53, 4, v0
    v_lshlrev_b32 v53, 4, v53
    v_bfe_u32 v60, v0, 1, 1
    v_lshl_add_u32 v53, v60, 3, v53
    v_and_b32 v60, 1, v0
    v_mul_u32_u24 v60, 192, v60
    v_add_u32 v53, v60, v53
    v_add_u32 v53, 160960, v53
    v_mov_b64 v[20:21], 0
    v_mov_b64 v[22:23], 0
    v_mov_b64 v[24:25], 0
    v_mov_b64 v[26:27], 0
    s_lshr_b32 s57, s30, 1
    s_lshl_b32 s57, s57, 11
    s_lshl_b32 s58, s58, 1
    s_add_u32 s57, s57, s58
    s_lshl_b32 s58, s54, 8
    s_add_u32 s57, s57, s58
    v_and_b32 v54, 31, v0
    v_lshlrev_b32 v54, 2, v54
    v_lshrrev_b32 v60, 5, v0
    v_mul_u32_u24 v60, 6144, v60
    v_add_u32 v54, v60, v54
    v_add_u32 v54, s57, v54
    s_mul_i32 s59, s53, 12416
    s_add_u32 s59, s59, s62
    s_add_u32 s59, s59, 70656
    s_add_u32 s60, s59, 12288
    ds_read_b128 v[12:15], v52
    ds_read_b64 v[16:17], v53
    s_waitcnt lgkmcnt(1)
    v_smfmac_f32_16x16x64_bf16 v[20:23], v[12:15], v[28:35], v1
    v_smfmac_f32_16x16x64_bf16 v[24:27], v[12:15], v[40:47], v1
    s_waitcnt lgkmcnt(0)
    v_smfmac_f32_16x16x32_bf16 v[20:23], v[16:17], v[36:39], v1
    v_smfmac_f32_16x16x32_bf16 v[24:27], v[16:17], v[48:51], v1
    s_cmp_eq_u32 s55, 0
    s_nop 5
    v_add_f32 v12, v20, v22
    s_nop 1
    v_add_f32_dpp v12, v24, v26 quad_perm:[0,1,2,3] row_mask:0x2 bank_mask:0xf
    s_nop 1
    v_add_f32_dpp v12, v21, v23 quad_perm:[0,1,2,3] row_mask:0x4 bank_mask:0xf
    s_nop 1
    v_add_f32_dpp v12, v25, v27 quad_perm:[0,1,2,3] row_mask:0x8 bank_mask:0xf
    s_cbranch_scc1 L_gs_37
    buffer_store_dword v12, v54, s[40:43], s59 offen
L_gb_38:
L_skip_36:
    s_cmp_eq_u32 s30, 5
    s_cbranch_scc0 L_skip_39
    global_load_dword v2, v3, s[26:27] sc1
L_skip_39:
    s_waitcnt vmcnt(36)
    s_barrier
    ds_read_b128 v[96:99], v8 offset:0
    ds_read_b128 v[100:103], v9 offset:0
    s_cmp_eq_u32 s30, 6
    s_cbranch_scc0 L_skip_40
    s_mul_i32 s57, s14, 3
    s_mov_b32 m0, 36864
    s_nop 0
    buffer_load_dwordx4 v3, s[48:51], s57 offen offset:0 nt lds
    s_mul_i32 s57, s14, 3
    s_add_u32 s57, s57, s15
    s_mov_b32 m0, 36864
    s_nop 0
    buffer_load_dwordx4 v3, s[48:51], s57 offen offset:1024 nt lds
    s_mov_b32 s57, 786560
    s_mov_b32 s58, 982144
    s_mov_b32 m0, 141312
L_dma_41:
    s_waitcnt vmcnt(22)
    buffer_load_dwordx4 v5, s[32:35], s57 offen offset:0 nt lds
    buffer_load_dwordx4 v6, s[32:35], s58 offen offset:1024 nt lds
    s_add_u32 s57, s57, 24576
    s_add_u32 s58, s58, 24576
    s_add_u32 m0, m0, 2048
    s_cmp_lg_u32 m0, 157696
    s_cbranch_scc1 L_dma_41
L_skip_40:
    s_waitcnt lgkmcnt(0)
    s_waitcnt vmcnt(36)
    s_barrier
    ds_read_b128 v[104:107], v8 offset:16384
    ds_read_b128 v[108:111], v9 offset:16384
    s_cmp_eq_u32 s30, 6
    s_cbranch_scc0 L_skip_42
    s_mul_i32 s57, s14, 4
    s_mov_b32 m0, 38912
    s_nop 0
    buffer_load_dwordx4 v3, s[48:51], s57 offen offset:0 nt lds
    s_mul_i32 s57, s14, 4
    s_add_u32 s57, s57, s15
    s_mov_b32 m0, 38912
    s_nop 0
    buffer_load_dwordx4 v3, s[48:51], s57 offen offset:1024 nt lds
    s_mov_b32 s57, 786688
    s_mov_b32 s58, 982272
    s_mov_b32 m0, 92160
L_dma_43:
    s_waitcnt vmcnt(22)
    buffer_load_dwordx4 v5, s[32:35], s57 offen offset:0 nt lds
    buffer_load_dwordx4 v6, s[32:35], s58 offen offset:1024 nt lds
    s_add_u32 s57, s57, 24576
    s_add_u32 s58, s58, 24576
    s_add_u32 m0, m0, 2048
    s_cmp_lg_u32 m0, 108544
    s_cbranch_scc1 L_dma_43
L_skip_42:
    s_waitcnt lgkmcnt(0)
    s_cmp_lg_u32 s30, 6
    s_cbranch_scc0 L_skip_44
    s_waitcnt vmcnt(0)
L_skip_44:
    s_waitcnt vmcnt(36)
    s_barrier
    ds_read_b128 v[112:115], v8 offset:32768
    ds_read_b128 v[116:119], v9 offset:32768
    s_cmp_eq_u32 s30, 6
    s_cbranch_scc0 L_skip_45
    s_mul_i32 s57, s14, 5
    s_mov_b32 m0, 40960
    s_nop 0
    buffer_load_dwordx4 v3, s[48:51], s57 offen offset:0 nt lds
    s_mul_i32 s57, s14, 5
    s_add_u32 s57, s57, s15
    s_mov_b32 m0, 40960
    s_nop 0
    buffer_load_dwordx4 v3, s[48:51], s57 offen offset:1024 nt lds
    s_mov_b32 s57, 1179648
    s_mov_b32 s58, 1375232
    s_mov_b32 m0, 108544
L_dma_46:
    s_waitcnt vmcnt(22)
    buffer_load_dwordx4 v5, s[32:35], s57 offen offset:0 nt lds
    buffer_load_dwordx4 v6, s[32:35], s58 offen offset:1024 nt lds
    s_add_u32 s57, s57, 24576
    s_add_u32 s58, s58, 24576
    s_add_u32 m0, m0, 2048
    s_cmp_lg_u32 m0, 124928
    s_cbranch_scc1 L_dma_46
L_skip_45:
    s_waitcnt lgkmcnt(0)
    s_cmp_eq_u32 s30, 5
    s_cbranch_scc0 L_skip_47
L_cw_48:
    v_readlane_b32 s57, v2, s31
    s_cmp_eq_u32 s57, 0
    s_cbranch_scc1 L_cr_49
    s_lshr_b32 s58, s63, 2
    s_xor_b32 s58, s58, s65
    s_and_b32 s58, s58, 1
    v_mov_b32 v25, s58
    s_sub_u32 s57, s57, 1
    s_cmp_eq_u32 s57, s63
    s_cselect_b32 s64, 1, 0
    s_cbranch_scc0 L_far_50
    s_lshl_b32 s57, s52, 2
    s_add_u32 s57, s57, s72
    s_mov_b64 exec, 1
    buffer_store_dword v25, v0, s[40:43], s57 offen offset:0
    s_mov_b64 exec, -1
L_fb_51:
L_skip_47:
    s_waitcnt vmcnt(36)
    s_barrier
    ds_read_b128 v[120:123], v8 offset:49152
    ds_read_b128 v[124:127], v9 offset:49152
    s_cmp_eq_u32 s30, 6
    s_cbranch_scc0 L_skip_52
    s_mul_i32 s57, s14, 6
    s_mov_b32 m0, 43008
    s_nop 0
    buffer_load_dwordx4 v3, s[48:51], s57 offen offset:0 nt lds
    s_mul_i32 s57, s14, 6
    s_add_u32 s57, s57, s15
    s_mov_b32 m0, 43008
    s_nop 0
    buffer_load_dwordx4 v3, s[48:51], s57 offen offset:1024 nt lds
    s_mov_b32 s57, 1179776
    s_mov_b32 s58, 1375360
    s_mov_b32 m0, 124928
L_dma_53:
    s_waitcnt vmcnt(22)
    buffer_load_dwordx4 v5, s[32:35], s57 offen offset:0 nt lds
    buffer_load_dwordx4 v6, s[32:35], s58 offen offset:1024 nt lds
    s_add_u32 s57, s57, 24576
    s_add_u32 s58, s58, 24576
    s_add_u32 m0, m0, 2048
    s_cmp_lg_u32 m0, 141312
    s_cbranch_scc1 L_dma_53
L_skip_52:
    s_waitcnt lgkmcnt(0)
    s_waitcnt vmcnt(36)
    s_barrier
    ds_read_b128 v[128:131], v8 offset:0
    ds_read_b128 v[132:135], v9 offset:0
    s_cmp_eq_u32 s30, 6
    s_cbranch_scc0 L_skip_54
    s_mul_i32 s57, s14, 7
    s_mov_b32 m0, 45056
    s_nop 0
    buffer_load_dwordx4 v3, s[48:51], s57 offen offset:0 nt lds
    s_mul_i32 s57, s14, 7
    s_add_u32 s57, s57, s15
    s_mov_b32 m0, 45056
    s_nop 0
    buffer_load_dwordx4 v3, s[48:51], s57 offen offset:1024 nt lds
    s_mov_b32 s57, 1179904
    s_mov_b32 s58, 1375488
    s_mov_b32 m0, 141312
L_dma_55:
    s_waitcnt vmcnt(22)
    buffer_load_dwordx4 v5, s[32:35], s57 offen offset:0 nt lds
    buffer_load_dwordx4 v6, s[32:35], s58 offen offset:1024 nt lds
    s_add_u32 s57, s57, 24576
    s_add_u32 s58, s58, 24576
    s_add_u32 m0, m0, 2048
    s_cmp_lg_u32 m0, 157696
    s_cbranch_scc1 L_dma_55
L_skip_54:
    s_waitcnt lgkmcnt(0)
    s_cmp_eq_u32 s30, 5
    s_cbranch_scc0 L_skip_56
    v_lshlrev_b32 v24, 2, v0
    buffer_load_dword v2, v24, s[40:43], s72 offen sc1
L_skip_56:
    s_waitcnt vmcnt(36)
    s_barrier
    ds_read_b128 v[136:139], v8 offset:16384
    ds_read_b128 v[140:143], v9 offset:16384
    s_cmp_eq_u32 s30, 6
    s_cbranch_scc0 L_skip_57
    s_mul_i32 s57, s14, 8
    s_mov_b32 m0, 47104
    s_nop 0
    buffer_load_dwordx4 v3, s[48:51], s57 offen offset:0 nt lds
    s_mul_i32 s57, s14, 8
    s_add_u32 s57, s57, s15
    s_mov_b32 m0, 47104
    s_nop 0
    buffer_load_dwordx4 v3, s[48:51], s57 offen offset:1024 nt lds
    s_mov_b32 s57, 0
    s_mov_b32 s58, 392192
    s_mov_b32 m0, 92160
L_dma_58:
    s_waitcnt vmcnt(22)
    buffer_load_dwordx4 v7, s[36:39], s57 offen offset:0 nt lds
    buffer_load_dwordx4 v7, s[36:39], s58 offen offset:1024 nt lds
    s_add_u32 s57, s57, 24576
    s_add_u32 s58, s58, 24576
    s_add_u32 m0, m0, 2048
    s_cmp_lg_u32 m0, 108544
    s_cbranch_scc1 L_dma_58
L_skip_57:
    s_waitcnt lgkmcnt(0)
    s_waitcnt vmcnt(36)
    s_barrier
    ds_read_b128 v[144:147], v8 offset:32768
    ds_read_b128 v[148:151], v9 offset:32768
    s_cmp_eq_u32 s30, 6
    s_cbranch_scc0 L_skip_59
    s_mul_i32 s57, s14, 9
    s_mov_b32 m0, 49152
    s_nop 0
    buffer_load_dwordx4 v3, s[48:51], s57 offen offset:0 nt lds
    s_mul_i32 s57, s14, 9
    s_add_u32 s57, s57, s15
    s_mov_b32 m0, 49152
    s_nop 0
    buffer_load_dwordx4 v3, s[48:51], s57 offen offset:1024 nt lds
    s_mov_b32 s57, 128
    s_mov_b32 s58, 392320
    s_mov_b32 m0, 108544
L_dma_60:
    s_waitcnt vmcnt(22)
    buffer_load_dwordx4 v7, s[36:39], s57 offen offset:0 nt lds
    buffer_load_dwordx4 v7, s[36:39], s58 offen offset:1024 nt lds
    s_add_u32 s57, s57, 24576
    s_add_u32 s58, s58, 24576
    s_add_u32 m0, m0, 2048
    s_cmp_lg_u32 m0, 124928
    s_cbranch_scc1 L_dma_60
L_skip_59:
    s_waitcnt lgkmcnt(0)
    s_cmp_eq_u32 s30, 5
    s_cbranch_scc0 L_skip_61
L_cw_62:
    s_waitcnt vmcnt(0)
    v_cmp_ne_u32 vcc, -1, v2
    s_mov_b32 s57, 0
    s_mov_b32 s68, 2
    s_cmp_eq_u32 s64, 0
    s_cbranch_scc1 L_cd_64
    s_cmp_lg_u32 vcc_hi, 0
    s_cbranch_scc1 L_cd_64
    s_cmp_lg_u32 vcc_lo, -1
    s_cbranch_scc1 L_cr_63
    v_cmp_eq_u32 vcc, 1, v2
    s_bcnt1_i32_b32 s68, vcc_lo
    s_mov_b32 s57, 1
L_cd_64:
    v_mov_b32 v37, 160768
    v_mov_b32 v38, s57
    ds_write_b32 v37, v38
    s_waitcnt lgkmcnt(0)
L_skip_61:
    s_waitcnt vmcnt(36)
    s_barrier
    ds_read_b128 v[152:155], v8 offset:49152
    ds_read_b128 v[156:159], v9 offset:49152
    s_cmp_eq_u32 s30, 6
    s_cbranch_scc0 L_skip_65
    s_mul_i32 s57, s14, 10
    s_mov_b32 m0, 51200
    s_nop 0
    buffer_load_dwordx4 v3, s[48:51], s57 offen offset:0 nt lds
    s_mul_i32 s57, s14, 10
    s_add_u32 s57, s57, s15
    s_mov_b32 m0, 51200
    s_nop 0
    buffer_load_dwordx4 v3, s[48:51], s57 offen offset:1024 nt lds
    s_mov_b32 s57, 256
    s_mov_b32 s58, 392448
    s_mov_b32 m0, 124928
L_dma_66:
    s_waitcnt vmcnt(22)
    buffer_load_dwordx4 v7, s[36:39], s57 offen offset:0 nt lds
    buffer_load_dwordx4 v7, s[36:39], s58 offen offset:1024 nt lds
    s_add_u32 s57, s57, 24576
    s_add_u32 s58, s58, 24576
    s_add_u32 m0, m0, 2048
    s_cmp_lg_u32 m0, 141312
    s_cbranch_scc1 L_dma_66
L_skip_65:
    s_waitcnt lgkmcnt(0)
    v_lshrrev_b32 v8, 2, v0
    v_lshlrev_b32 v8, 7, v8
    v_bfe_u32 v60, v0, 3, 2
    v_lshl_add_u32 v8, v60, 5, v8
    v_and_b32 v60, 3, v0
    v_lshl_add_u32 v8, v60, 3, v8
    v_add_u32 v8, s61, v8
    v_xor_b32 v9, 32, v8
    v_xor_b32 v10, 64, v8
    v_xor_b32 v11, 96, v8
    v_mov_b32 v41, 160768
    ds_read_b32 v42, v41
    s_waitcnt lgkmcnt(0)
    v_readfirstlane_b32 s55, v42
    s_cmp_eq_u32 s55, 0
    s_cbranch_scc1 L_spread
L_spread_back:
    s_cmp_eq_u32 s30, 5
    s_cbranch_scc0 L_skip_78
    s_cmp_eq_u32 s52, 31
    s_cbranch_scc0 L_skip_79
    s_lshl_b32 s57, s31, 5
    v_mov_b32 v16, s57
    s_add_u32 s57, s68, 1
    v_mov_b32 v12, s57
    s_mov_b64 exec, 0x1
    global_store_dword v16, v12, s[26:27] offset:4 sc1
    s_mov_b64 exec, -1
L_skip_79:
L_skip_78:
    s_sub_u32 s58, s30, 1
    s_cmp_lt_u32 s58, 3
    s_cbranch_scc0 L_skip_80
    s_mul_i32 s59, s53, 12416
    s_add_u32 s59, s59, s62
    s_add_u32 s59, s59, 70656
    s_add_u32 s60, s59, 12288
    s_lshl_b32 s57, s58, 11
    v_lshlrev_b32 v48, 4, v0
    v_add_u32 v48, s57, v48
    v_and_b32 v49, 7, v0
    v_lshlrev_b32 v49, 3, v49
    s_add_u32 s57, s59, 6144
    buffer_load_dwordx4 v[12:15], v48, s[40:43], s59 offen offset:0 sc1 nt
    buffer_load_dwordx4 v[16:19], v48, s[40:43], s59 offen offset:1024 sc1 nt
    buffer_load_dwordx4 v[28:31], v48, s[40:43], s57 offen offset:0 sc1 nt
    buffer_load_dwordx4 v[32:35], v48, s[40:43], s57 offen offset:1024 sc1 nt
    buffer_load_dwordx2 v[24:25], v49, s[40:43], s60 offen sc1 nt
L_skip_80:
    s_waitcnt vmcnt(36)
    s_barrier
    ds_read_b64_tr_b16 v[160:161], v8 offset:0
    ds_read_b64_tr_b16 v[168:169], v9 offset:0
    ds_read_b64_tr_b16 v[176:177], v10 offset:0
    ds_read_b64_tr_b16 v[184:185], v11 offset:0
    s_cmp_eq_u32 s30, 6
    s_cbranch_scc0 L_skip_81
    s_mul_i32 s57, s14, 11
    s_mov_b32 m0, 53248
    s_nop 0
    buffer_load_dwordx4 v3, s[48:51], s57 offen offset:0 nt lds
    s_mul_i32 s57, s14, 11
    s_add_u32 s57, s57, s15
    s_mov_b32 m0, 53248
    s_nop 0
    buffer_load_dwordx4 v3, s[48:51], s57 offen offset:1024 nt lds
    s_mov_b32 s57, 196608
    s_mov_b32 s58, 588800
    s_mov_b32 m0, 141312
L_dma_82:
    s_waitcnt vmcnt(22)
    buffer_load_dwordx4 v7, s[36:39], s57 offen offset:0 nt lds
    buffer_load_dwordx4 v7, s[36:39], s58 offen offset:1024 nt lds
    s_add_u32 s57, s57, 24576
    s_add_u32 s58, s58, 24576
    s_add_u32 m0, m0, 2048
    s_cmp_lg_u32 m0, 157696
    s_cbranch_scc1 L_dma_82
L_skip_81:
    s_waitcnt lgkmcnt(0)
    s_waitcnt vmcnt(36)
    s_barrier
    ds_read_b64_tr_b16 v[192:193], v8 offset:16384
    ds_read_b64_tr_b16 v[200:201], v9 offset:16384
    ds_read_b64_tr_b16 v[208:209], v10 offset:16384
    ds_read_b64_tr_b16 v[216:217], v11 offset:16384
    s_cmp_eq_u32 s30, 6
    s_cbranch_scc0 L_skip_83
    s_mov_b32 s57, 196736
    s_mov_b32 s58, 588928
    s_mov_b32 m0, 92160
L_dma_84:
    s_waitcnt vmcnt(22)
    buffer_load_dwordx4 v7, s[36:39], s57 offen offset:0 nt lds
    buffer_load_dwordx4 v7, s[36:39], s58 offen offset:1024 nt lds
    s_add_u32 s57, s57, 24576
    s_add_u32 s58, s58, 24576
    s_add_u32 m0, m0, 2048
    s_cmp_lg_u32 m0, 108544
    s_cbranch_scc1 L_dma_84
L_skip_83:
    s_waitcnt lgkmcnt(0)
    s_sub_u32 s58, s30, 1
    s_cmp_lt_u32 s58, 3
    s_cbranch_scc0 L_skip_85
    s_lshl_b32 s57, s58, 7
    v_bfe_u32 v51, v0, 2, 2
    v_lshlrev_b32 v51, 5, v51
    v_lshrrev_b32 v60, 5, v0
    v_lshl_add_u32 v51, v60, 4, v51
    v_and_b32 v60, 3, v0
    v_lshl_add_u32 v51, v60, 2, v51
    v_bfe_u32 v60, v0, 4, 1
    v_lshl_add_u32 v51, v60, 1, v51
    v_add_u32 v51, s57, v51
    v_add_u32 v51, 157696, v51
    v_mov_b32 v60, 0x3c75e03e
    v_mov_b32 v61, 0x3a71d1e6
    v_mov_b32 v47, 0x3e13985d
    s_waitcnt vmcnt(0)
    v_pk_add_f32 v[36:37], v[28:29], v[32:33]
    v_pk_add_f32 v[38:39], v[30:31], v[34:35]
    s_nop 1
    v_permlane32_swap_b32 v36, v38
    v_permlane32_swap_b32 v37, v39
    v_pk_add_f32 v[36:37], v[36:37], v[38:39]
    s_nop 1
    v_permlane16_swap_b32 v36, v37
    v_add_f32 v36, v36, v37
    v_mul_f32 v6, 0x3dd53b95, v36
    v_add_f32_dpp v48, v24, v24 row_ror:4 row_mask:0xf bank_mask:0xf
    v_add_f32_dpp v49, v25, v25 row_ror:4 row_mask:0xf bank_mask:0xf
    v_pk_add_f32 v[20:21], v[12:13], v[16:17]
    v_pk_add_f32 v[22:23], v[14:15], v[18:19]
    v_add_f32_dpp v48, v48, v48 row_ror:2 row_mask:0xf bank_mask:0xf
    v_add_f32_dpp v49, v49, v49 row_ror:2 row_mask:0xf bank_mask:0xf
    v_permlane32_swap_b32 v20, v22
    v_permlane32_swap_b32 v21, v23
    v_add_f32_dpp v48, v48, v48 row_ror:1 row_mask:0xf bank_mask:0xf
    v_add_f32_dpp v49, v49, v49 row_ror:1 row_mask:0xf bank_mask:0xf
    v_pk_add_f32 v[20:21], v[20:21], v[22:23]
    v_mul_f32 v48, v48, v60
    v_fma_f32 v49, v49, v47, v61
    v_permlane16_swap_b32 v20, v21
    v_fma_f32 v49, -v48, v48, v49
    v_add_f32 v20, v20, v21
    v_max_f32 v49, v49, v61
    v_mul_f32 v50, v6, v48
    v_rsq_f32 v49, v49
    v_cmp_u_f32 vcc, v20, v20
    v_sub_f32 v20, v20, v50
    v_mul_f32 v20, v20, v49
    v_cvt_pk_bf16_f32 v20, v20, v20
    ds_write_b16 v51, v20
    s_waitcnt lgkmcnt(0)
L_skip_85:
    s_lshl_b32 s57, s30, 7
    s_add_u32 s57, s57, 158720
    v_lshrrev_b32 v58, 4, v0
    v_lshlrev_b32 v58, 5, v58
    v_bfe_u32 v60, v0, 1, 1
    v_lshl_add_u32 v58, v60, 4, v58
    v_bfe_u32 v60, v0, 2, 2
    v_lshl_add_u32 v58, v60, 2, v58
    v_and_b32 v60, 1, v0
    v_lshl_add_u32 v58, v60, 1, v58
    v_add_u32 v58, s57, v58
    v_lshrrev_b32 v61, 4, v0
    v_lshlrev_b32 v61, 5, v61
    v_bfe_u32 v60, v0, 1, 1
    v_lshl_add_u32 v61, v60, 4, v61
    v_add_u32 v61, s57, v61
    v_bfe_u32 v62, v0, 2, 2
    v_lshlrev_b32 v62, 1, v62
    v_and_b32 v60, 1, v0
    v_lshl_add_u32 v62, v60, 0, v62
    v_mov_b32 v60, 160992
    v_cmp_eq_u32 vcc, 0, v62
    s_nop 1
    v_cndmask_b32 v52, v60, v61, vcc
    v_cmp_eq_u32 vcc, 1, v62
    s_nop 1
    v_cndmask_b32 v53, v60, v61, vcc
    v_cmp_eq_u32 vcc, 2, v62
    s_nop 1
    v_cndmask_b32 v54, v60, v61, vcc
    v_cmp_eq_u32 vcc, 3, v62
    s_nop 1
    v_cndmask_b32 v55, v60, v61, vcc
    v_cmp_eq_u32 vcc, 4, v62
    s_nop 1
    v_cndmask_b32 v56, v60, v61, vcc
    v_cmp_eq_u32 vcc, 5, v62
    s_nop 1
    v_cndmask_b32 v57, v60, v61, vcc
    s_lshl_b32 s58, s30, 2
    s_add_u32 s58, s58, 159744
    v_mov_b32 v60, s58
    v_lshlrev_b32 v59, 2, v0
    v_add_u32 v59, 158208, v59
    v_cmp_eq_u32 vcc, 63, v0
    s_nop 1
    v_cndmask_b32 v59, v59, v60, vcc
    v_and_b32 v62, 7, v0
    v_lshlrev_b32 v62, 2, v62
    v_add_u32 v62, 159744, v62
    s_lshl_b32 s57, s30, 11
    v_lshlrev_b32 v63, 4, v0
    v_add_u32 v63, s57, v63
    v_add_u32 v63, 92160, v63
    s_waitcnt vmcnt(34)
    s_barrier
    ds_read_b64_tr_b16 v[224:225], v8 offset:32768
    ds_read_b64_tr_b16 v[232:233], v9 offset:32768
    ds_read_b64_tr_b16 v[240:241], v10 offset:32768
    ds_read_b64_tr_b16 v[248:249], v11 offset:32768
    s_cmp_eq_u32 s30, 6
    s_cbranch_scc0 L_skip_86
    s_mov_b32 s57, 196864
    s_mov_b32 s58, 589056
    s_mov_b32 m0, 108544
L_dma_87:
    s_nop 0
    buffer_load_dwordx4 v7, s[36:39], s57 offen offset:0 nt lds
    buffer_load_dwordx4 v7, s[36:39], s58 offen offset:1024 nt lds
    s_add_u32 s57, s57, 24576
    s_add_u32 s58, s58, 24576
    s_add_u32 m0, m0, 2048
    s_cmp_lg_u32 m0, 124928
    s_cbranch_scc1 L_dma_87
L_skip_86:
    s_waitcnt lgkmcnt(0)
    v_lshrrev_b32 v5, 4, v0
    v_lshlrev_b32 v5, 5, v5
    v_bfe_u32 v60, v0, 1, 1
    v_lshl_add_u32 v5, v60, 4, v5
    v_add_u32 v5, 157696, v5
    ds_read_b128 v[12:15], v5 offset:0
    ds_read_b128 v[16:19], v5 offset:128
    ds_read_b128 v[20:23], v5 offset:256
    v_mov_b64 v[24:25], 0
    v_mov_b64 v[26:27], 0
    v_mov_b64 v[28:29], 0
    v_mov_b64 v[30:31], 0
    v_mov_b64 v[32:33], 0
    v_mov_b64 v[34:35], 0
    v_mov_b64 v[36:37], 0
    v_mov_b64 v[38:39], 0
    v_mov_b64 v[40:41], 0
    v_mov_b64 v[42:43], 0
    v_mov_b64 v[44:45], 0
    v_mov_b64 v[46:47], 0
    s_waitcnt lgkmcnt(0)
    v_smfmac_f32_16x16x64_bf16 v[24:27], v[12:15], v[64:71], v1
    v_smfmac_f32_16x16x64_bf16 v[24:27], v[16:19], v[72:79], v1
    v_smfmac_f32_16x16x64_bf16 v[24:27], v[20:23], v[80:87], v1
    v_smfmac_f32_16x16x64_bf16 v[28:31], v[12:15], v[88:95], v1
    v_smfmac_f32_16x16x64_bf16 v[28:31], v[16:19], v[96:103], v1
    v_smfmac_f32_16x16x64_bf16 v[28:31], v[20:23], v[104:111], v1
    v_smfmac_f32_16x16x64_bf16 v[32:35], v[12:15], v[112:119], v1
    v_smfmac_f32_16x16x64_bf16 v[32:35], v[16:19], v[120:127], v1
    v_smfmac_f32_16x16x64_bf16 v[32:35], v[20:23], v[128:135], v1
    v_smfmac_f32_16x16x64_bf16 v[36:39], v[12:15], v[136:143], v1
    v_smfmac_f32_16x16x64_bf16 v[36:39], v[16:19], v[144:151], v1
    v_smfmac_f32_16x16x64_bf16 v[36:39], v[20:23], v[152:159], v1
    v_add_f32 v24, v24, v26
    s_nop 0
    v_add_f32 v28, v28, v30
    s_nop 1
    v_add_f32 v32, v32, v34
    v_max3_f32 v61, v24, v28, v32
    v_mov_b32_dpp v24, v28 quad_perm:[0,1,2,3] row_mask:0x2 bank_mask:0xf
    v_add_f32 v36, v36, v38
    v_max_f32 v61, v61, v36
    v_mov_b32_dpp v24, v32 quad_perm:[0,1,2,3] row_mask:0x4 bank_mask:0xf
    s_nop 0
    v_max_f32_dpp v61, v61, v61 row_ror:8 row_mask:0xf bank_mask:0xf
    s_nop 0
    v_mov_b32_dpp v24, v36 quad_perm:[0,1,2,3] row_mask:0x8 bank_mask:0xf
    v_max_f32_dpp v61, v61, v61 row_ror:4 row_mask:0xf bank_mask:0xf
    s_nop 1
    v_max_f32_dpp v61, v61, v61 row_ror:2 row_mask:0xf bank_mask:0xf
    s_nop 1
    v_max_f32_dpp v61, v61, v61 row_ror:1 row_mask:0xf bank_mask:0xf
    v_sub_f32 v36, v24, v61
    ds_write_b32 v59, v61
    v_exp_f32 v36, v36
    s_nop 0
    v_cvt_pk_bf16_f32 v39, v36, v36
    ds_write_b16 v58, v39
    ds_read_b128 v[12:15], v52
    ds_read_b128 v[16:19], v53
    ds_read_b128 v[20:23], v54
    ds_read_b128 v[24:27], v55
    ds_read_b128 v[28:31], v56
    ds_read_b128 v[32:35], v57
    v_add_f32_dpp v38, v36, v36 row_ror:8 row_mask:0xf bank_mask:0xf
    s_nop 1
    v_add_f32_dpp v38, v38, v38 row_ror:4 row_mask:0xf bank_mask:0xf
    s_nop 1
    v_add_f32_dpp v38, v38, v38 row_ror:2 row_mask:0xf bank_mask:0xf
    s_nop 1
    v_add_f32_dpp v38, v38, v38 row_ror:1 row_mask:0xf bank_mask:0xf
    s_nop 1
    v_add_f32_dpp v38, v38, v38 row_bcast:15 row_mask:0xa bank_mask:0xf
    s_nop 1
    v_add_f32_dpp v38, v38, v38 row_bcast:31 row_mask:0xc bank_mask:0xf
    s_waitcnt lgkmcnt(0)
    s_waitcnt vmcnt(32)
    s_barrier
    ds_read_b64_tr_b16 v[162:163], v8 offset:49152
    ds_read_b64_tr_b16 v[170:171], v9 offset:49152
    ds_read_b64_tr_b16 v[178:179], v10 offset:49152
    ds_read_b64_tr_b16 v[186:187], v11 offset:49152
    s_cmp_eq_u32 s30, 6
    s_cbranch_scc0 L_skip_88
    s_mov_b32 s57, 786432
    s_mov_b32 s58, 1178624
    s_mov_b32 m0, 124928
L_dma_89:
    s_nop 0
    buffer_load_dwordx4 v7, s[36:39], s57 offen offset:0 nt lds
    buffer_load_dwordx4 v7, s[36:39], s58 offen offset:1024 nt lds
    s_add_u32 s57, s57, 24576
    s_add_u32 s58, s58, 24576
    s_add_u32 m0, m0, 2048
    s_cmp_lg_u32 m0, 141312
    s_cbranch_scc1 L_dma_89
L_skip_88:
    s_waitcnt lgkmcnt(0)
    ds_read_b32 v36, v62
    s_waitcnt lgkmcnt(0)
    v_max_f32_dpp v37, v36, v36 row_ror:4 row_mask:0xf bank_mask:0xf
    s_nop 1
    v_max_f32_dpp v37, v37, v37 row_ror:2 row_mask:0xf bank_mask:0xf
    s_nop 1
    v_max_f32_dpp v37, v37, v37 row_ror:1 row_mask:0xf bank_mask:0xf
    v_sub_f32 v39, v61, v37
    v_exp_f32 v39, v39
    s_cmp_lt_u32 s30, 2
    s_cbranch_scc0 L_skip_90
    s_lshl_b32 s57, s30, 3
    v_lshlrev_b32 v2, 4, v0
    v_add_u32 v2, s57, v2
    v_add_u32 v2, 92160, v2
    v_mov_b32 v60, 94192
    v_cmp_le_u32 vcc, 48, v0
    s_nop 1
    v_cndmask_b32 v2, v2, v60, vcc
    s_lshr_b32 s57, s54, 1
    s_lshl_b32 s57, s57, 2
    s_and_b32 s58, s54, 1
    s_add_u32 s57, s57, s58
    s_lshl_b32 s58, s57, 4
    s_lshl_b32 s57, s57, 3
    v_bfe_u32 v3, v0, 3, 2
    v_lshlrev_b32 v3, 8, v3
    v_bfe_u32 v61, v0, 2, 1
    v_lshl_add_u32 v3, v61, 5, v3
    v_and_b32 v61, 3, v0
    v_lshl_add_u32 v3, v61, 2, v3
    v_add_u32 v3, s58, v3
    v_bfe_u32 v60, v0, 3, 1
    v_lshlrev_b32 v60, 8, v60
    v_bfe_u32 v61, v0, 1, 1
    v_lshl_add_u32 v60, v61, 7, v60
    v_bfe_u32 v61, v0, 2, 1
    v_lshl_add_u32 v60, v61, 4, v60
    v_and_b32 v61, 1, v0
    v_lshl_add_u32 v60, v61, 2, v60
    v_add_u32 v60, s57, v60
    v_add_u32 v60, 1024, v60
    v_cmp_gt_u32 vcc, 32, v0
    s_nop 1
    v_cndmask_b32 v3, v60, v3, vcc
    s_lshl_b32 s57, s53, 1
    s_add_u32 s57, s57, s30
    s_mul_i32 s57, s57, 1664
    s_add_u32 s57, s57, s62
    v_add_u32 v3, s57, v3
    v_mov_b32 v60, 0x7f000000
    v_cmp_le_u32 vcc, 48, v0
    s_nop 1
    v_cndmask_b32 v3, v3, v60, vcc
    s_lshl_b32 s58, s54, 2
    s_add_u32 s57, s57, s58
    s_add_u32 s57, s57, 1536
    v_mov_b32 v4, s57
    v_mov_b32 v60, 0x7f000000
    v_cmp_ne_u32 vcc, 48, v0
    s_nop 1
    v_cndmask_b32 v4, v4, v60, vcc
    s_mov_b32 s58, 0
    s_cmp_eq_u32 s55, 0
    s_cbranch_scc1 L_gs_91
    buffer_store_dword v37, v4, s[40:43], s58 offen
L_gb_92:
L_skip_90:
    s_cmp_eq_u32 s30, 2
    s_cbranch_scc0 L_skip_93
    v_lshlrev_b32 v2, 2, v0
    v_add_u32 v2, 157696, v2
    v_and_b32 v3, 15, v0
    v_lshlrev_b32 v3, 2, v3
    v_lshrrev_b32 v60, 5, v0
    v_lshl_add_u32 v3, v60, 6, v3
    v_bfe_u32 v60, v0, 4, 1
    v_lshl_add_u32 v3, v60, 13, v3
L_skip_93:
    s_waitcnt vmcnt(32)
    s_barrier
    ds_read_b64_tr_b16 v[194:195], v8 offset:0
    ds_read_b64_tr_b16 v[202:203], v9 offset:0
    ds_read_b64_tr_b16 v[210:211], v10 offset:0
    ds_read_b64_tr_b16 v[218:219], v11 offset:0
    s_cmp_eq_u32 s30, 6
    s_cbranch_scc0 L_skip_94
    s_mov_b32 s57, 786560
    s_mov_b32 s58, 1178752
    s_mov_b32 m0, 141312
L_dma_95:
    s_nop 0
    buffer_load_dwordx4 v7, s[36:39], s57 offen offset:0 nt lds
    buffer_load_dwordx4 v7, s[36:39], s58 offen offset:1024 nt lds
    s_add_u32 s57, s57, 24576
    s_add_u32 s58, s58, 24576
    s_add_u32 m0, m0, 2048
    s_cmp_lg_u32 m0, 157696
    s_cbranch_scc1 L_dma_95
L_skip_94:
    s_waitcnt lgkmcnt(0)
    s_waitcnt vmcnt(32)
    s_barrier
    ds_read_b64_tr_b16 v[226:227], v8 offset:16384
    ds_read_b64_tr_b16 v[234:235], v9 offset:16384
    ds_read_b64_tr_b16 v[242:243], v10 offset:16384
    ds_read_b64_tr_b16 v[250:251], v11 offset:16384
    s_cmp_eq_u32 s30, 6
    s_cbranch_scc0 L_skip_96
    s_mov_b32 s57, 786688
    s_mov_b32 s58, 1178880
    s_mov_b32 m0, 92160
L_dma_97:
    s_nop 0
    buffer_load_dwordx4 v7, s[36:39], s57 offen offset:0 nt lds
    buffer_load_dwordx4 v7, s[36:39], s58 offen offset:1024 nt lds
    s_add_u32 s57, s57, 24576
    s_add_u32 s58, s58, 24576
    s_add_u32 m0, m0, 2048
    s_cmp_lg_u32 m0, 108544
    s_cbranch_scc1 L_dma_97
L_skip_96:
    s_waitcnt lgkmcnt(0)
    s_cmp_eq_u32 s30, 5
    s_cbranch_scc0 L_skip_98
    global_load_dword v2, v3, s[26:27] offset:4 sc1
L_skip_98:
    s_waitcnt vmcnt(32)
    s_barrier
    ds_read_b64_tr_b16 v[164:165], v8 offset:32768
    ds_read_b64_tr_b16 v[172:173], v9 offset:32768
    ds_read_b64_tr_b16 v[180:181], v10 offset:32768
    ds_read_b64_tr_b16 v[188:189], v11 offset:32768
    s_cmp_eq_u32 s30, 6
    s_cbranch_scc0 L_skip_99
    s_mov_b32 s57, 983040
    s_mov_b32 s58, 1375232
    s_mov_b32 m0, 108544
L_dma_100:
    s_nop 0
    buffer_load_dwordx4 v7, s[36:39], s57 offen offset:0 nt lds
    buffer_load_dwordx4 v7, s[36:39], s58 offen offset:1024 nt lds
    s_add_u32 s57, s57, 24576
    s_add_u32 s58, s58, 24576
    s_add_u32 m0, m0, 2048
    s_cmp_lg_u32 m0, 124928
    s_cbranch_scc1 L_dma_100
L_skip_99:
    s_waitcnt lgkmcnt(0)
    s_waitcnt vmcnt(32)
    s_barrier
    ds_read_b64_tr_b16 v[196:197], v8 offset:49152
    ds_read_b64_tr_b16 v[204:205], v9 offset:49152
    ds_read_b64_tr_b16 v[212:213], v10 offset:49152
    ds_read_b64_tr_b16 v[220:221], v11 offset:49152
    s_cmp_eq_u32 s30, 6
    s_cbranch_scc0 L_skip_101
    s_mov_b32 s57, 983168
    s_mov_b32 s58, 1375360
    s_mov_b32 m0, 124928
L_dma_102:
    s_nop 0
    buffer_load_dwordx4 v7, s[36:39], s57 offen offset:0 nt lds
    buffer_load_dwordx4 v7, s[36:39], s58 offen offset:1024 nt lds
    s_add_u32 s57, s57, 24576
    s_add_u32 s58, s58, 24576
    s_add_u32 m0, m0, 2048
    s_cmp_lg_u32 m0, 141312
    s_cbranch_scc1 L_dma_102
L_skip_101:
    s_waitcnt lgkmcnt(0)
    s_cmp_eq_u32 s30, 5
    s_cbranch_scc0 L_skip_103
L_cw_104:
    s_waitcnt vmcnt(0)
    v_cmp_eq_u32 vcc, 0, v2
    s_cbranch_vccnz L_cr_105
    v_add_u32_dpp v2, v2, v2 row_ror:4 row_mask:0xf bank_mask:0xf
    s_nop 1
    v_add_u32_dpp v2, v2, v2 row_ror:2 row_mask:0xf bank_mask:0xf
    s_nop 1
    v_add_u32_dpp v2, v2, v2 row_ror:1 row_mask:0xf bank_mask:0xf
    v_mov_b32 v60, 160772
    ds_write_b32 v60, v2
    s_waitcnt lgkmcnt(0)
L_skip_103:
    s_cmp_lt_u32 s3, 20
    s_cbranch_scc0 L_skip_106
    s_mul_i32 s74, s30, 1664
    s_add_u32 s74, s74, s62
    s_add_u32 s74, s74, 0
    v_and_b32 v56, 7, v0
    v_lshlrev_b32 v56, 2, v56
    v_lshrrev_b32 v62, 4, v0
    v_lshlrev_b32 v62, 3, v62
    s_cmp_lg_u32 s30, 6
    s_cbranch_scc0 L_skip_106
    buffer_load_dword v52, v56, s[40:43], s74 offen offset:1536 sc1
    buffer_load_dwordx2 v[54:55], v62, s[40:43], s74 offen offset:1536 sc1
L_skip_106:
    s_cmp_eq_u32 s30, 2
    s_cbranch_scc0 L_skip_107
    s_sub_u32 s57, s3, 20
    s_cmp_lt_u32 s57, 4
    s_cbranch_scc0 L_skip_108
    s_sub_u32 s57, s3, 20
    s_lshl_b32 s57, s57, 6
    v_add_u32 v50, s57, v0
    v_min_u32 v50, 207, v50
    v_lshlrev_b32 v50, 7, v50
    s_add_u32 s57, s62, 0
    buffer_load_dword v50, v50, s[40:43], s57 offen sc1 nt
    s_sub_u32 s57, s3, 20
    s_lshl_b32 s57, s57, 6
    v_add_u32 v51, s57, v0
    v_min_u32 v51, 151, v51
    v_lshlrev_b32 v51, 7, v51
    s_add_u32 s57, s62, 26624
    buffer_load_dword v51, v51, s[40:43], s57 offen sc1 nt
    s_sub_u32 s57, s3, 20
    s_lshl_b32 s57, s57, 6
    v_add_u32 v49, s57, v0
    v_min_u32 v49, 191, v49
    v_lshlrev_b32 v49, 7, v49
    s_add_u32 s57, s62, 46080
    buffer_load_dword v49, v49, s[40:43], s57 offen sc1 nt
L_skip_108:
L_skip_107:
    s_waitcnt vmcnt(32)
    s_barrier
    ds_read_b64_tr_b16 v[228:229], v8 offset:0
    ds_read_b64_tr_b16 v[236:237], v9 offset:0
    ds_read_b64_tr_b16 v[244:245], v10 offset:0
    ds_read_b64_tr_b16 v[252:253], v11 offset:0
    s_cmp_eq_u32 s30, 6
    s_cbranch_scc0 L_skip_109
    s_mov_b32 s57, 983296
    s_mov_b32 s58, 1375488
    s_mov_b32 m0, 141312
L_dma_110:
    s_nop 0
    buffer_load_dwordx4 v7, s[36:39], s57 offen offset:0 nt lds
    buffer_load_dwordx4 v7, s[36:39], s58 offen offset:1024 nt lds
    s_add_u32 s57, s57, 24576
    s_add_u32 s58, s58, 24576
    s_add_u32 m0, m0, 2048
    s_cmp_lg_u32 m0, 157696
    s_cbranch_scc1 L_dma_110
L_skip_109:
    s_waitcnt lgkmcnt(0)
    s_cmp_ge_u32 s30, 6
    s_cbranch_scc0 L_skip_111
    v_mov_b32 v60, 160772
    ds_read_b32 v60, v60
    s_lshr_b32 s58, s63, 2
    s_waitcnt lgkmcnt(0)
    v_readfirstlane_b32 s57, v60
    s_cmp_gt_u32 s57, 24
    s_cselect_b32 s57, 1, 0
    s_xor_b32 s57, s57, s58
    s_lshl_b32 s57, s57, 13
    s_add_u32 s7, s8, s57
L_skip_111:
    s_branch L_tail
.p2align 10
L_tail:
L_pad0:
    s_cbranch_execz L_pad4
    s_waitcnt vmcnt(32)
    s_barrier
    ds_read_b64_tr_b16 v[166:167], v8 offset:16384
    ds_read_b64_tr_b16 v[174:175], v9 offset:16384
    ds_read_b64_tr_b16 v[182:183], v10 offset:16384
    ds_read_b64_tr_b16 v[190:191], v11 offset:16384
    s_waitcnt lgkmcnt(0)
    s_cmp_lt_u32 s30, 5
    s_cbranch_scc0 L_skip_112
    s_waitcnt vmcnt(0)
L_skip_112:
    s_cmp_lt_u32 s3, 20
    s_cbranch_scc0 L_skip_113
    v_lshlrev_b32 v57, 4, v0
    v_lshlrev_b32 v58, 3, v0
    s_mul_i32 s57, s30, 6144
    s_add_u32 s57, s57, 30720
    v_lshrrev_b32 v59, 2, v0
    v_lshlrev_b32 v59, 6, v59
    v_bfe_u32 v53, v0, 4, 1
    v_lshl_add_u32 v59, v53, 5, v59
    v_and_b32 v53, 3, v0
    v_lshl_add_u32 v59, v53, 3, v59
    v_add_u32 v59, s57, v59
    v_xor_b32 v60, 32, v59
    s_lshl_b32 s57, s30, 8
    s_add_u32 s57, s57, 157696
    v_lshl_add_u32 v61, v0, 2, s57
    s_cmp_lg_u32 s30, 6
    s_cbranch_scc0 L_skip_113
L_cw_114:
    s_waitcnt vmcnt(0)
    v_max3_u32 v53, v52, v54, v55
    v_cmp_eq_u32 vcc, -1, v53
    s_cbranch_vccnz L_cr_115
    v_max_f32_dpp v53, v52, v52 row_ror:4 row_mask:0xf bank_mask:0xf
    s_nop 1
    v_max_f32_dpp v53, v53, v53 row_ror:2 row_mask:0xf bank_mask:0xf
    s_nop 1
    v_max_f32_dpp v53, v53, v53 row_ror:1 row_mask:0xf bank_mask:0xf
    v_sub_f32 v52, v52, v53
    v_sub_f32 v54, v54, v53
    v_sub_f32 v55, v55, v53
    v_exp_f32 v52, v52
    v_exp_f32 v54, v54
    v_exp_f32 v55, v55
    s_cmp_eq_u32 s30, 7
    s_cbranch_scc0 L_skip_113
    v_add_u32 v62, 158720, v57
    ds_write_b128 v62, v[52:55]
    s_waitcnt lgkmcnt(0)
L_skip_113:
    v_smfmac_f32_16x16x64_bf16 v[40:43], v[12:15], v[160:167], v1
    v_smfmac_f32_16x16x64_bf16 v[40:43], v[16:19], v[168:175], v1
    v_smfmac_f32_16x16x64_bf16 v[40:43], v[20:23], v[176:183], v1
    v_smfmac_f32_16x16x64_bf16 v[40:43], v[24:27], v[184:191], v1
    s_cmp_eq_u32 s30, 6
    s_cbranch_scc0 L_skip_116
    s_mul_i32 s57, s14, 12
    s_add_u32 s58, s57, s15
    s_mov_b32 m0, 55296
L_dma_117:
    s_nop 0
    buffer_load_dwordx4 v3, s[48:51], s57 offen offset:0 nt lds
    buffer_load_dwordx4 v3, s[48:51], s58 offen offset:1024 nt lds
    s_add_u32 s57, s57, s14
    s_add_u32 s58, s58, s14
    s_add_u32 m0, m0, 2048
    s_cmp_lg_u32 m0, 67584
    s_cbranch_scc1 L_dma_117
    s_mul_i32 s57, s14, 18
    s_add_u32 s58, s57, s15
    s_mov_b32 m0, 67584
L_dma_118:
    s_nop 0
    buffer_load_dwordx4 v3, s[48:51], s57 offen offset:0 nt lds
    buffer_load_dwordx4 v3, s[48:51], s58 offen offset:1024 nt lds
    s_add_u32 s57, s57, s14
    s_add_u32 s58, s58, s14
    s_add_u32 m0, m0, 2048
    s_cmp_lg_u32 m0, 79872
    s_cbranch_scc1 L_dma_118
L_skip_116:
    s_waitcnt vmcnt(40)
    s_barrier
    ds_read_b64_tr_b16 v[198:199], v8 offset:32768
    ds_read_b64_tr_b16 v[206:207], v9 offset:32768
    ds_read_b64_tr_b16 v[214:215], v10 offset:32768
    ds_read_b64_tr_b16 v[222:223], v11 offset:32768
    s_waitcnt lgkmcnt(0)
    s_cmp_lt_u32 s3, 20
    s_cbranch_scc0 L_skip_119
    s_cmp_eq_u32 s30, 6
    s_cbranch_scc0 L_skip_119
    v_add_u32 v62, 158720, v57
    ds_read_b128 v[52:55], v62
L_skip_119:
L_pad1:
    s_cbranch_execz L_pad5
    v_smfmac_f32_16x16x64_bf16 v[40:43], v[28:31], v[192:199], v1
    v_smfmac_f32_16x16x64_bf16 v[40:43], v[32:35], v[200:207], v1
    v_smfmac_f32_16x16x64_bf16 v[44:47], v[12:15], v[208:215], v1
    v_smfmac_f32_16x16x64_bf16 v[44:47], v[16:19], v[216:223], v1
    v_mul_f32 v38, v38, v39
    ds_write_b32 v63, v38 offset:1024
    s_waitcnt vmcnt(24)
    s_barrier
    ds_read_b64_tr_b16 v[230:231], v8 offset:49152
    ds_read_b64_tr_b16 v[238:239], v9 offset:49152
    ds_read_b64_tr_b16 v[246:247], v10 offset:49152
    ds_read_b64_tr_b16 v[254:255], v11 offset:49152
    s_waitcnt lgkmcnt(0)
    v_smfmac_f32_16x16x64_bf16 v[44:47], v[20:23], v[224:231], v1
    v_smfmac_f32_16x16x64_bf16 v[44:47], v[24:27], v[232:239], v1
    v_smfmac_f32_16x16x64_bf16 v[44:47], v[28:31], v[240:247], v1
    v_smfmac_f32_16x16x64_bf16 v[44:47], v[32:35], v[248:255], v1
    s_setprio 0
    s_cmp_lt_u32 s30, 2
    v_pk_add_f32 v[40:41], v[40:41], v[42:43]
    s_nop 4
    v_pk_add_f32 v[42:43], v[44:45], v[46:47]
    v_pk_mul_f32 v[40:41], v[40:41], v[38:39] op_sel:[0,1] op_sel_hi:[1,1]
    v_pk_mul_f32 v[42:43], v[42:43], v[38:39] op_sel:[0,1] op_sel_hi:[1,1]
    ds_write_b128 v63, v[40:43]
    s_cbranch_scc1 L_comb_0
    s_waitcnt lgkmcnt(0)
    s_barrier
L_comb_0b:
    s_cmp_eq_u32 s30, 6
    s_cbranch_scc0 L_skip_124
    s_waitcnt vmcnt(0)
L_skip_124:
    s_barrier
    s_cmp_lt_u32 s3, 20
    s_cbranch_scc0 L_typeB_0
    buffer_load_dwordx4 v[12:15], v57, s[40:43], s74 offen sc1
    buffer_load_dwordx2 v[16:17], v58, s[40:43], s74 offen offset:1024 sc1
    buffer_load_dword v18, v56, s[40:43], s74 offen offset:1568 sc1
    ds_read_b64_tr_b16 v[28:29], v59 offset:0
    ds_read_b64_tr_b16 v[30:31], v59 offset:1024
    ds_read_b64_tr_b16 v[32:33], v59 offset:2048
    ds_read_b64_tr_b16 v[34:35], v59 offset:3072
    ds_read_b64_tr_b16 v[36:37], v59 offset:4096
    ds_read_b64_tr_b16 v[38:39], v59 offset:5120
    ds_read_b64_tr_b16 v[40:41], v60 offset:0
    ds_read_b64_tr_b16 v[42:43], v60 offset:1024
    ds_read_b64_tr_b16 v[44:45], v60 offset:2048
    ds_read_b64_tr_b16 v[46:47], v60 offset:3072
    ds_read_b64_tr_b16 v[48:49], v60 offset:4096
    ds_read_b64_tr_b16 v[50:51], v60 offset:5120
    v_mov_b64 v[20:21], 0
    v_mov_b64 v[22:23], 0
    v_mov_b64 v[24:25], 0
    v_mov_b64 v[26:27], 0
    s_add_u32 s58, s6, 0
    s_waitcnt lgkmcnt(0)
    s_branch L_ow_125
.p2align 5
L_or_126:
    buffer_load_dwordx4 v[12:15], v57, s[40:43], s74 offen sc1
    buffer_load_dwordx2 v[16:17], v58, s[40:43], s74 offen offset:1024 sc1
    buffer_load_dword v18, v56, s[40:43], s74 offen offset:1568 sc1
    s_sub_u32 s56, s56, 1
    s_cbranch_scc1 L_done
    v_mov_b64 v[20:21], 0
    v_mov_b64 v[22:23], 0
    v_mov_b64 v[24:25], 0
    v_mov_b64 v[26:27], 0
L_ow_125:
    s_waitcnt vmcnt(2)
    v_smfmac_f32_16x16x64_bf16 v[20:23], v[12:15], v[28:35], v1
    v_max3_u32 v19, v12, v13, v14
    v_smfmac_f32_16x16x64_bf16 v[24:27], v[12:15], v[40:47], v1
    s_waitcnt vmcnt(0)
    v_mul_f32 v53, v52, v18
    v_smfmac_f32_16x16x32_bf16 v[20:23], v[16:17], v[36:39], v1
    v_max3_u32 v62, v15, v16, v17
    v_smfmac_f32_16x16x32_bf16 v[24:27], v[16:17], v[48:51], v1
    v_max3_u32 v19, v19, v62, v18
    v_add_f32_dpp v53, v53, v53 row_ror:4 row_mask:0xf bank_mask:0xf
    v_cmp_eq_u32 vcc, -1, v19
L_pad2:
    s_cbranch_execz L_pad6
    s_cmp_eq_u32 s30, 2
    v_add_f32_dpp v53, v53, v53 row_ror:2 row_mask:0xf bank_mask:0xf
    s_cbranch_vccnz L_or_126
    s_nop 0
    v_add_f32_dpp v53, v53, v53 row_ror:1 row_mask:0xf bank_mask:0xf
    v_rcp_f32 v52, v53
    v_pk_add_f32 v[20:21], v[20:21], v[22:23]
    v_pk_add_f32 v[24:25], v[24:25], v[26:27]
    v_pk_mul_f32 v[54:55], v[54:55], v[52:53] op_sel:[0,0] op_sel_hi:[1,0]
    v_mul_f32 v20, v20, v54
    v_mul_f32 v24, v24, v54
    v_fmac_f32 v20, v21, v55
    v_fmac_f32 v24, v25, v55
    s_nop 1
    v_permlane32_swap_b32 v20, v24
    v_add_f32 v20, v20, v24
    ds_write_b32 v61, v20
    s_waitcnt lgkmcnt(0)
    s_barrier
    s_cbranch_scc0 L_finb_127
    ds_read2st64_b32 v[12:13], v2 offset0:0 offset1:1
    ds_read2st64_b32 v[14:15], v2 offset0:2 offset1:3
    ds_read2st64_b32 v[16:17], v2 offset0:4 offset1:5
    ds_read2st64_b32 v[18:19], v2 offset0:6 offset1:7
    s_waitcnt lgkmcnt(2)
    v_pk_add_f32 v[12:13], v[12:13], v[14:15]
    s_waitcnt lgkmcnt(0)
    v_pk_add_f32 v[16:17], v[16:17], v[18:19]
    v_pk_add_f32 v[12:13], v[12:13], v[16:17]
    v_add_f32 v14, v12, v13
    v_add_f32 v15, v12, v13
    s_nop 1
    v_permlane16_swap_b32 v14, v15
    v_add_f32 v12, v14, v15
    buffer_store_dword v12, v3, s[40:43], s58 offen sc1
L_finb_127:
    s_sub_u32 s57, s30, 4
    s_cmp_lt_u32 s57, 3
    s_cbranch_scc0 L_skip_128
    s_sub_u32 s60, s30, 4
    s_lshl_b32 s57, s60, 11
    v_lshlrev_b32 v11, 4, v0
    v_add_u32 v11, s57, v11
    s_add_u32 s65, s62, 19456
    buffer_load_dwordx4 v[52:55], v11, s[40:43], s65 offen offset:0 sc1
    buffer_load_dwordx4 v[56:59], v11, s[40:43], s65 offen offset:1024 sc1
    s_lshl_b32 s59, s60, 12
    s_add_u32 s59, s59, 79872
    s_mov_b32 s44, s20
    s_mov_b32 s45, s21
    s_mov_b32 s46, 1966080
    s_mov_b32 s47, 0x20000
    s_mul_i32 s57, s31, 3
    s_add_u32 s57, s57, s60
    s_mul_i32 s57, s57, 81920
    s_lshl_b32 s64, s3, 6
    s_add_u32 s57, s57, s64
    v_lshrrev_b32 v5, 2, v0
    v_mul_u32_u24 v5, 1280, v5
    v_and_b32 v60, 3, v0
    v_lshl_add_u32 v5, v60, 4, v5
    v_add_u32 v5, s57, v5
    s_add_u32 m0, s59, 0
    s_mov_b32 s57, 0
    buffer_load_dwordx4 v5, s[44:47], s57 offen nt lds
    s_add_u32 m0, s59, 1024
    s_mov_b32 s57, 20480
    buffer_load_dwordx4 v5, s[44:47], s57 offen nt lds
    s_add_u32 m0, s59, 2048
    s_mov_b32 s57, 40960
    buffer_load_dwordx4 v5, s[44:47], s57 offen nt lds
    s_add_u32 m0, s59, 3072
    s_mov_b32 s57, 61440
    buffer_load_dwordx4 v5, s[44:47], s57 offen nt lds
    v_bfe_u32 v35, v0, 4, 1
    v_lshlrev_b32 v35, 11, v35
    v_bfe_u32 v60, v0, 2, 2
    v_lshl_add_u32 v35, v60, 8, v35
    v_lshrrev_b32 v60, 5, v0
    v_lshl_add_u32 v35, v60, 6, v35
    v_and_b32 v60, 3, v0
    v_lshl_add_u32 v35, v60, 3, v35
    v_add_u32 v35, s59, v35
    v_mov_b32 v9, 0xbdd2d3e8
    v_mov_b32 v10, 0xc0135761
    s_lshl_b32 s57, s60, 7
    s_add_u32 s57, s57, 159872
L_pad3:
    s_cbranch_execz L_pad7
    v_lshlrev_b32 v32, 3, v0
    v_add_u32 v32, s57, v32
    v_lshlrev_b32 v33, 3, v0
    v_add_u32 v33, 129024, v33
    v_cmp_gt_u32 vcc, 16, v0
    s_nop 1
    v_cndmask_b32 v32, v33, v32, vcc
    v_and_b32 v33, 15, v0
    v_lshlrev_b32 v33, 3, v33
    v_lshrrev_b32 v60, 5, v0
    v_lshl_add_u32 v33, v60, 2, v33
    v_add_u32 v33, 159872, v33
    v_and_b32 v34, 15, v0
    v_lshlrev_b32 v34, 2, v34
    v_lshrrev_b32 v60, 5, v0
    v_lshl_add_u32 v34, v60, 6, v34
    v_bfe_u32 v60, v0, 4, 1
    v_lshl_add_u32 v34, v60, 13, v34
    s_add_u32 s60, s6, 66048
    s_add_u32 s58, s62, 13312
    s_add_u32 s57, s62, 25856
    v_and_b32 v7, 7, v0
    v_lshlrev_b32 v7, 3, v7
    v_mov_b32 v60, 0x3acccccd
    v_mov_b32 v61, 0x3727c5ac
    s_waitcnt vmcnt(0)
    buffer_load_dwordx2 v[24:25], v7, s[40:43], s57 offen sc1
    buffer_load_dwordx4 v[12:15], v11, s[40:43], s58 offen offset:0 sc1
    buffer_load_dwordx4 v[16:19], v11, s[40:43], s58 offen offset:1024 sc1
    ds_read_b64_tr_b16 v[36:37], v35 offset:0
    ds_read_b64_tr_b16 v[38:39], v35 offset:1024
    ds_read_b64_tr_b16 v[40:41], v35 offset:128
    ds_read_b64_tr_b16 v[42:43], v35 offset:1152
    ds_read_b64_tr_b16 v[44:45], v35 offset:32
    ds_read_b64_tr_b16 v[46:47], v35 offset:1056
    ds_read_b64_tr_b16 v[48:49], v35 offset:160
    ds_read_b64_tr_b16 v[50:51], v35 offset:1184
L_sw_131:
    v_max3_u32 v20, v52, v53, v54
    v_max3_u32 v20, v20, v55, v56
    v_max3_u32 v20, v20, v57, v58
    v_max_u32 v20, v20, v59
    v_cmp_eq_u32 vcc, -1, v20
    s_cbranch_vccnz L_sr_132
    v_pk_add_f32 v[28:29], v[52:53], v[56:57]
    v_pk_add_f32 v[30:31], v[54:55], v[58:59]
    s_nop 1
    v_permlane32_swap_b32 v28, v30
    v_permlane32_swap_b32 v29, v31
    v_pk_add_f32 v[28:29], v[28:29], v[30:31]
    s_nop 1
    v_permlane16_swap_b32 v28, v29
    v_add_f32 v28, v28, v29
    v_mov_b64 v[52:53], 0
    v_mov_b64 v[54:55], 0
    v_mov_b64 v[56:57], 0
    v_mov_b64 v[58:59], 0
    s_waitcnt lgkmcnt(0)
    s_branch L_pw_129
.p2align 5
L_pr_130:
    buffer_load_dwordx2 v[24:25], v7, s[40:43], s57 offen sc1
    buffer_load_dwordx4 v[12:15], v11, s[40:43], s58 offen offset:0 sc1
    buffer_load_dwordx4 v[16:19], v11, s[40:43], s58 offen offset:1024 sc1
    s_sub_u32 s56, s56, 1
    s_cbranch_scc1 L_done
L_pw_129:
    s_waitcnt vmcnt(0)
    v_max_u32 v20, v24, v25
    v_cmp_eq_u32 vcc, -1, v20
    s_cbranch_vccnz L_pr_130
    buffer_load_dwordx4 v[12:15], v11, s[40:43], s58 offen offset:0 sc1
    buffer_load_dwordx4 v[16:19], v11, s[40:43], s58 offen offset:1024 sc1
    v_add_f32_dpp v2, v24, v24 row_ror:4 row_mask:0xf bank_mask:0xf
    v_add_f32_dpp v3, v25, v25 row_ror:4 row_mask:0xf bank_mask:0xf
    v_pk_add_f32 v[20:21], v[12:13], v[16:17]
    v_pk_add_f32 v[22:23], v[14:15], v[18:19]
    v_add_f32_dpp v2, v2, v2 row_ror:2 row_mask:0xf bank_mask:0xf
    v_add_f32_dpp v3, v3, v3 row_ror:2 row_mask:0xf bank_mask:0xf
    v_permlane32_swap_b32 v20, v22
    v_permlane32_swap_b32 v21, v23
    v_add_f32_dpp v2, v2, v2 row_ror:1 row_mask:0xf bank_mask:0xf
    v_add_f32_dpp v3, v3, v3 row_ror:1 row_mask:0xf bank_mask:0xf
    v_pk_add_f32 v[20:21], v[20:21], v[22:23]
    v_mul_f32 v2, v2, v60
    v_fma_f32 v3, v3, v60, v61
    v_permlane16_swap_b32 v20, v21
L_pad4:
    s_cbranch_execz L_pad8
    v_fma_f32 v3, -v2, v2, v3
    v_add_f32 v20, v20, v21
    v_max_f32 v3, v3, v61
    v_mul_f32 v26, v28, v2
    v_rsq_f32 v3, v3
    v_cmp_u_f32 vcc, v20, v20
    v_sub_f32 v20, v20, v26
    s_cbranch_vccnz L_hr_133
L_hk_134:
    v_fma_f32 v20, v20, v3, v4
    v_mul_f32 v21, v20, v20
    v_fma_f32 v21, v21, v9, v10
    v_mul_f32 v21, v21, v20
    v_exp_f32 v21, v21
    s_nop 0
    v_add_f32 v21, 1.0, v21
    v_rcp_f32 v21, v21
    s_nop 0
    v_mul_f32 v20, v20, v21
    s_nop 1
    v_mov_b32_dpp v21, v20 row_shl:1 row_mask:0xf bank_mask:0xf bound_ctrl:0
    v_cvt_pk_bf16_f32 v28, v20, v21
    s_nop 1
    v_mov_b32_dpp v29, v28 row_shl:4 row_mask:0xf bank_mask:0xf bound_ctrl:0
    v_mov_b32_dpp v30, v28 row_shl:8 row_mask:0xf bank_mask:0xf bound_ctrl:0
    v_mov_b32_dpp v31, v28 row_shl:12 row_mask:0xf bank_mask:0xf bound_ctrl:0
    s_nop 1
    v_smfmac_f32_16x16x64_bf16 v[52:55], v[28:31], v[36:43], v1
    v_smfmac_f32_16x16x64_bf16 v[56:59], v[28:31], v[44:51], v1
    s_cmp_eq_u32 s30, 4
    s_nop 5
    v_add_f32 v22, v52, v54
    v_add_f32 v23, v56, v58
    ds_write_b64 v32, v[22:23]
    s_cbranch_scc0 L_skip_136
L_xw_137:
    ds_read2_b32 v[20:21], v33 offset0:0 offset1:32
    ds_read_b32 v22, v33 offset:256
    s_sub_u32 s56, s56, 1
    s_cbranch_scc1 L_done
    s_waitcnt lgkmcnt(0)
    v_max3_u32 v23, v20, v21, v22
    v_add_f32 v20, v20, v21
    v_cmp_eq_u32 vcc, -1, v23
    v_add_f32 v20, v20, v22
    s_cbranch_vccnz L_xw_137
    buffer_store_dword v20, v34, s[40:43], s60 offen sc1
    s_waitcnt vmcnt(1)
    s_branch L_pe_138
.p2align 5
L_skip_136:
    s_waitcnt vmcnt(0)
L_pe_138:
L_skip_128:
    s_branch L_p1
.p2align 5
L_typeB_0:
    s_cmp_eq_u32 s53, 3
    s_cbranch_scc0 L_typeC_139
    s_cmp_eq_u32 s30, 7
    s_cbranch_scc1 L_w7_150
    s_cmp_lt_u32 s30, 6
    s_cbranch_scc0 L_skip_152
    s_lshr_b32 s57, s30, 1
    s_mul_i32 s57, s57, 128
    s_and_b32 s58, s30, 1
    s_lshl_b32 s58, s58, 6
    s_add_u32 s57, s57, s58
    v_lshrrev_b32 v18, 5, v0
    v_lshlrev_b32 v18, 13, v18
    v_bfe_u32 v60, v0, 3, 1
    v_lshl_add_u32 v18, v60, 12, v18
    v_bfe_u32 v60, v0, 4, 1
    v_lshl_add_u32 v18, v60, 11, v18
    v_bfe_u32 v60, v0, 2, 1
    v_mul_u32_u24 v60, 384, v60
    v_add_u32 v18, v60, v18
    v_and_b32 v60, 3, v0
    v_lshl_add_u32 v18, v60, 3, v18
    v_add_u32 v18, s57, v18
    v_add_u32 v18, 30720, v18
    v_bfe_u32 v19, v0, 4, 1
    v_lshlrev_b32 v19, 12, v19
    v_bfe_u32 v60, v0, 3, 1
    v_lshl_add_u32 v19, v60, 11, v19
    v_bfe_u32 v60, v0, 2, 1
    v_mul_u32_u24 v60, 384, v60
    v_add_u32 v19, v60, v19
    v_and_b32 v60, 3, v0
    v_lshl_add_u32 v19, v60, 3, v19
    v_add_u32 v19, s57, v19
    v_add_u32 v19, 63488, v19
    ds_read_b64_tr_b16 v[28:29], v18 offset:0
    ds_read_b64_tr_b16 v[30:31], v18 offset:1024
    ds_read_b64_tr_b16 v[32:33], v18 offset:16384
L_pad5:
    s_cbranch_execz L_pad9
    ds_read_b64_tr_b16 v[34:35], v18 offset:17408
    ds_read_b64_tr_b16 v[36:37], v19 offset:0
    ds_read_b64_tr_b16 v[38:39], v19 offset:1024
    ds_read_b64_tr_b16 v[40:41], v18 offset:32
    ds_read_b64_tr_b16 v[42:43], v18 offset:1056
    ds_read_b64_tr_b16 v[44:45], v18 offset:16416
    ds_read_b64_tr_b16 v[46:47], v18 offset:17440
    ds_read_b64_tr_b16 v[48:49], v19 offset:32
    ds_read_b64_tr_b16 v[50:51], v19 offset:1056
    v_lshrrev_b32 v9, 4, v0
    v_lshlrev_b32 v9, 5, v9
    v_bfe_u32 v60, v0, 1, 1
    v_lshl_add_u32 v9, v60, 4, v9
    v_and_b32 v60, 1, v0
    v_mul_u32_u24 v60, 192, v60
    v_add_u32 v9, v60, v9
    v_add_u32 v9, 160832, v9
    v_lshrrev_b32 v10, 4, v0
    v_lshlrev_b32 v10, 4, v10
    v_bfe_u32 v60, v0, 1, 1
    v_lshl_add_u32 v10, v60, 3, v10
    v_and_b32 v60, 1, v0
    v_mul_u32_u24 v60, 192, v60
    v_add_u32 v10, v60, v10
    v_add_u32 v10, 160960, v10
    v_mov_b64 v[20:21], 0
    v_mov_b64 v[22:23], 0
    v_mov_b64 v[24:25], 0
    v_mov_b64 v[26:27], 0
    s_lshr_b32 s57, s30, 1
    s_lshl_b32 s57, s57, 11
    s_lshl_b32 s58, s58, 1
    s_add_u32 s57, s57, s58
    s_lshl_b32 s58, s54, 8
    s_add_u32 s57, s57, s58
    v_and_b32 v11, 31, v0
    v_lshlrev_b32 v11, 2, v11
    v_lshrrev_b32 v60, 5, v0
    v_lshl_add_u32 v11, v60, 30, v11
    v_add_u32 v11, s57, v11
    s_add_u32 s59, s62, 13312
    s_add_u32 s60, s62, 25856
    ds_read_b128 v[12:15], v9
    ds_read_b64 v[16:17], v10
    s_waitcnt lgkmcnt(1)
    v_smfmac_f32_16x16x64_bf16 v[20:23], v[12:15], v[28:35], v1
    v_smfmac_f32_16x16x64_bf16 v[24:27], v[12:15], v[40:47], v1
    s_waitcnt lgkmcnt(0)
    v_smfmac_f32_16x16x32_bf16 v[20:23], v[16:17], v[36:39], v1
    v_smfmac_f32_16x16x32_bf16 v[24:27], v[16:17], v[48:51], v1
    s_add_u32 s60, s62, 19456
    s_cmp_eq_u32 s55, 0
    s_nop 4
    v_add_f32 v12, v21, v23
    s_nop 1
    v_add_f32_dpp v12, v25, v27 quad_perm:[0,1,2,3] row_mask:0x2 bank_mask:0xf
    s_cbranch_scc1 L_gs_153
    buffer_store_dword v12, v11, s[40:43], s60 offen
L_gb_154:
    v_mov_b64 v[20:21], 0
    v_mov_b64 v[22:23], 0
    v_mov_b64 v[24:25], 0
    v_mov_b64 v[26:27], 0
L_skip_152:
    s_cmp_lt_u32 s30, 6
    s_barrier
    s_cbranch_scc0 L_se_151
    ds_read_b128 v[12:15], v9
    ds_read_b64 v[16:17], v10
    s_waitcnt lgkmcnt(1)
    v_smfmac_f32_16x16x64_bf16 v[20:23], v[12:15], v[28:35], v1
    v_smfmac_f32_16x16x64_bf16 v[24:27], v[12:15], v[40:47], v1
    s_waitcnt lgkmcnt(0)
    v_smfmac_f32_16x16x32_bf16 v[20:23], v[16:17], v[36:39], v1
    v_smfmac_f32_16x16x32_bf16 v[24:27], v[16:17], v[48:51], v1
    s_cmp_eq_u32 s55, 0
    s_nop 5
    v_add_f32 v12, v20, v22
    s_nop 1
    v_add_f32_dpp v12, v24, v26 quad_perm:[0,1,2,3] row_mask:0x2 bank_mask:0xf
    s_cbranch_scc1 L_gs_155
    buffer_store_dword v12, v11, s[40:43], s59 offen
L_gb_156:
L_se_151:
L_p1:
    s_lshl_b32 s57, s30, 7
    s_add_u32 s57, s57, 158720
    v_lshrrev_b32 v58, 4, v0
    v_lshlrev_b32 v58, 5, v58
    v_bfe_u32 v60, v0, 1, 1
    v_lshl_add_u32 v58, v60, 4, v58
L_pad6:
    s_cbranch_execz L_pad10
    v_bfe_u32 v60, v0, 2, 2
    v_lshl_add_u32 v58, v60, 2, v58
    v_and_b32 v60, 1, v0
    v_lshl_add_u32 v58, v60, 1, v58
    v_add_u32 v58, s57, v58
    v_lshrrev_b32 v61, 4, v0
    v_lshlrev_b32 v61, 5, v61
    v_bfe_u32 v60, v0, 1, 1
    v_lshl_add_u32 v61, v60, 4, v61
    v_add_u32 v61, s57, v61
    v_bfe_u32 v62, v0, 2, 2
    v_lshlrev_b32 v62, 1, v62
    v_and_b32 v60, 1, v0
    v_lshl_add_u32 v62, v60, 0, v62
    v_mov_b32 v60, 160992
    v_cmp_eq_u32 vcc, 0, v62
    s_nop 1
    v_cndmask_b32 v52, v60, v61, vcc
    v_cmp_eq_u32 vcc, 1, v62
    s_nop 1
    v_cndmask_b32 v53, v60, v61, vcc
    v_cmp_eq_u32 vcc, 2, v62
    s_nop 1
    v_cndmask_b32 v54, v60, v61, vcc
    v_cmp_eq_u32 vcc, 3, v62
    s_nop 1
    v_cndmask_b32 v55, v60, v61, vcc
    v_cmp_eq_u32 vcc, 4, v62
    s_nop 1
    v_cndmask_b32 v56, v60, v61, vcc
    v_cmp_eq_u32 vcc, 5, v62
    s_nop 1
    v_cndmask_b32 v57, v60, v61, vcc
    s_lshl_b32 s58, s30, 2
    s_add_u32 s58, s58, 159808
    v_mov_b32 v60, s58
    v_lshlrev_b32 v59, 2, v0
    v_add_u32 v59, 158208, v59
    v_cmp_eq_u32 vcc, 63, v0
    s_nop 1
    v_cndmask_b32 v59, v59, v60, vcc
    v_and_b32 v62, 7, v0
    v_lshlrev_b32 v62, 2, v62
    v_add_u32 v62, 159808, v62
    s_lshl_b32 s57, s30, 11
    v_lshlrev_b32 v63, 4, v0
    v_add_u32 v63, s57, v63
    v_add_u32 v63, 92160, v63
    s_sub_u32 s57, s30, 1
    s_lshl_b32 s58, s57, 11
    v_lshlrev_b32 v7, 4, v0
    v_add_u32 v7, s58, v7
    s_lshl_b32 s58, s57, 7
    v_bfe_u32 v8, v0, 2, 2
    v_lshlrev_b32 v8, 5, v8
    v_lshrrev_b32 v60, 5, v0
    v_lshl_add_u32 v8, v60, 4, v8
    v_and_b32 v60, 3, v0
    v_lshl_add_u32 v8, v60, 2, v8
    v_bfe_u32 v60, v0, 4, 1
    v_lshl_add_u32 v8, v60, 1, v8
    v_add_u32 v8, s58, v8
    v_add_u32 v8, 124928, v8
    s_cmp_eq_u32 s30, 7
    s_cbranch_scc1 L_w7_164
    s_cmp_lt_u32 s30, 6
    s_cbranch_scc0 L_skip_166
    s_lshr_b32 s57, s30, 1
    s_mul_i32 s57, s57, 1024
    s_and_b32 s58, s30, 1
    s_lshl_b32 s58, s58, 6
    s_add_u32 s57, s57, s58
    v_lshrrev_b32 v18, 5, v0
    v_mul_u32_u24 v18, 6144, v18
    v_bfe_u32 v60, v0, 3, 1
    v_mul_u32_u24 v60, 3072, v60
    v_add_u32 v18, v60, v18
    v_bfe_u32 v60, v0, 4, 1
    v_lshl_add_u32 v18, v60, 9, v18
    v_bfe_u32 v60, v0, 2, 1
    v_lshl_add_u32 v18, v60, 7, v18
    v_and_b32 v60, 3, v0
    v_lshl_add_u32 v18, v60, 3, v18
    v_add_u32 v18, s57, v18
    v_bfe_u32 v19, v0, 4, 1
    v_mul_u32_u24 v19, 3072, v19
    v_bfe_u32 v60, v0, 3, 1
    v_lshl_add_u32 v19, v60, 9, v19
    v_bfe_u32 v60, v0, 2, 1
    v_lshl_add_u32 v19, v60, 7, v19
    v_and_b32 v60, 3, v0
    v_lshl_add_u32 v19, v60, 3, v19
    v_add_u32 v19, s57, v19
L_pad7:
    s_cbranch_execz L_pad11
    v_add_u32 v19, 24576, v19
    ds_read_b64_tr_b16 v[28:29], v18 offset:0
    ds_read_b64_tr_b16 v[30:31], v18 offset:256
    ds_read_b64_tr_b16 v[32:33], v18 offset:12288
    ds_read_b64_tr_b16 v[34:35], v18 offset:12544
    ds_read_b64_tr_b16 v[36:37], v19 offset:0
    ds_read_b64_tr_b16 v[38:39], v19 offset:256
    ds_read_b64_tr_b16 v[40:41], v18 offset:32
    ds_read_b64_tr_b16 v[42:43], v18 offset:288
    ds_read_b64_tr_b16 v[44:45], v18 offset:12320
    ds_read_b64_tr_b16 v[46:47], v18 offset:12576
    ds_read_b64_tr_b16 v[48:49], v19 offset:32
    ds_read_b64_tr_b16 v[50:51], v19 offset:288
    v_lshrrev_b32 v9, 4, v0
    v_lshlrev_b32 v9, 5, v9
    v_bfe_u32 v60, v0, 1, 1
    v_lshl_add_u32 v9, v60, 4, v9
    v_and_b32 v60, 1, v0
    v_mul_u32_u24 v60, 192, v60
    v_add_u32 v9, v60, v9
    v_add_u32 v9, 160832, v9
    v_lshrrev_b32 v10, 4, v0
    v_lshlrev_b32 v10, 4, v10
    v_bfe_u32 v60, v0, 1, 1
    v_lshl_add_u32 v10, v60, 3, v10
    v_and_b32 v60, 1, v0
    v_mul_u32_u24 v60, 192, v60
    v_add_u32 v10, v60, v10
    v_add_u32 v10, 160960, v10
    v_mov_b64 v[20:21], 0
    v_mov_b64 v[22:23], 0
    v_mov_b64 v[24:25], 0
    v_mov_b64 v[26:27], 0
    s_lshr_b32 s57, s30, 1
    s_lshl_b32 s57, s57, 11
    s_lshl_b32 s58, s58, 1
    s_add_u32 s57, s57, s58
    s_lshl_b32 s58, s54, 8
    s_add_u32 s57, s57, s58
    v_and_b32 v11, 31, v0
    v_lshlrev_b32 v11, 2, v11
    v_lshrrev_b32 v60, 5, v0
    v_lshl_add_u32 v11, v60, 30, v11
    v_add_u32 v11, s57, v11
    s_mul_i32 s59, s53, 6144
    s_add_u32 s59, s59, s62
    s_add_u32 s59, s59, 46080
    s_lshl_b32 s60, s53, 6
    s_add_u32 s60, s60, s62
    s_add_u32 s60, s60, 25600
L_skip_166:
    s_cmp_lt_u32 s30, 6
    s_barrier
    s_cbranch_scc0 L_se_165
    ds_read_b128 v[12:15], v9
    ds_read_b64 v[16:17], v10
    s_waitcnt lgkmcnt(1)
    v_smfmac_f32_16x16x64_bf16 v[20:23], v[12:15], v[28:35], v1
    v_smfmac_f32_16x16x64_bf16 v[24:27], v[12:15], v[40:47], v1
    s_waitcnt lgkmcnt(0)
    v_smfmac_f32_16x16x32_bf16 v[20:23], v[16:17], v[36:39], v1
    v_smfmac_f32_16x16x32_bf16 v[24:27], v[16:17], v[48:51], v1
    s_cmp_eq_u32 s55, 0
    s_nop 5
    v_add_f32 v12, v20, v22
    s_nop 1
    v_add_f32_dpp v12, v24, v26 quad_perm:[0,1,2,3] row_mask:0x2 bank_mask:0xf
    s_cbranch_scc1 L_gs_167
    buffer_store_dword v12, v11, s[40:43], s59 offen
L_gb_168:
L_se_165:
    s_sub_u32 s57, s30, 1
    s_cmp_lt_u32 s57, 3
    s_cbranch_scc0 L_qo_182
    v_and_b32 v9, 7, v0
    v_lshlrev_b32 v9, 3, v9
    buffer_load_dwordx2 v[10:11], v9, s[40:43], s60 offen sc1
    buffer_load_dwordx4 v[40:43], v7, s[40:43], s59 offen offset:0 sc1
    buffer_load_dwordx4 v[44:47], v7, s[40:43], s59 offen offset:1024 sc1
    v_mov_b64 v[24:25], 0
    v_mov_b64 v[26:27], 0
    v_mov_b64 v[28:29], 0
    v_mov_b64 v[30:31], 0
    v_mov_b64 v[32:33], 0
    v_mov_b64 v[34:35], 0
    v_mov_b64 v[36:37], 0
    v_mov_b64 v[38:39], 0
    v_lshrrev_b32 v5, 4, v0
    v_lshlrev_b32 v5, 5, v5
    v_bfe_u32 v60, v0, 1, 1
    v_lshl_add_u32 v5, v60, 4, v5
    v_add_u32 v5, 124928, v5
L_pad8:
    s_cbranch_execz L_pad12
    v_mov_b32 v60, 0x3c75e03e
    v_mov_b32 v61, 0x3a71d1e6
    v_mov_b32 v51, 0x3e13985d
    s_branch L_pw_184
.p2align 5
L_pr_185:
    buffer_load_dwordx2 v[10:11], v9, s[40:43], s60 offen sc1
    buffer_load_dwordx4 v[40:43], v7, s[40:43], s59 offen offset:0 sc1
    buffer_load_dwordx4 v[44:47], v7, s[40:43], s59 offen offset:1024 sc1
    s_sub_u32 s56, s56, 1
    s_cbranch_scc1 L_done
L_pw_184:
    s_waitcnt vmcnt(0)
    v_max_u32 v20, v10, v11
    v_cmp_eq_u32 vcc, -1, v20
    s_cbranch_vccnz L_pr_185
    buffer_load_dwordx4 v[40:43], v7, s[40:43], s59 offen offset:0 sc1
    buffer_load_dwordx4 v[44:47], v7, s[40:43], s59 offen offset:1024 sc1
    v_add_f32_dpp v48, v10, v10 row_ror:4 row_mask:0xf bank_mask:0xf
    v_add_f32_dpp v49, v11, v11 row_ror:4 row_mask:0xf bank_mask:0xf
    v_pk_add_f32 v[20:21], v[40:41], v[44:45]
    v_pk_add_f32 v[22:23], v[42:43], v[46:47]
    v_add_f32_dpp v48, v48, v48 row_ror:2 row_mask:0xf bank_mask:0xf
    v_add_f32_dpp v49, v49, v49 row_ror:2 row_mask:0xf bank_mask:0xf
    v_permlane32_swap_b32 v20, v22
    v_permlane32_swap_b32 v21, v23
    v_add_f32_dpp v48, v48, v48 row_ror:1 row_mask:0xf bank_mask:0xf
    v_add_f32_dpp v49, v49, v49 row_ror:1 row_mask:0xf bank_mask:0xf
    v_pk_add_f32 v[20:21], v[20:21], v[22:23]
    v_mul_f32 v48, v48, v60
    v_fma_f32 v49, v49, v51, v61
    v_permlane16_swap_b32 v20, v21
    v_fma_f32 v49, -v48, v48, v49
    v_add_f32 v20, v20, v21
    v_max_f32 v49, v49, v61
    v_mul_f32 v50, v6, v48
    v_rsq_f32 v49, v49
    v_cmp_u_f32 vcc, v20, v20
    v_sub_f32 v20, v20, v50
    s_cbranch_vccnz L_hr_186
L_hk_187:
    v_mul_f32 v20, v20, v49
    v_cvt_pk_bf16_f32 v20, v20, v20
    ds_write_b16 v8, v20
L_qb_183:
    s_waitcnt lgkmcnt(0)
    s_barrier
    ds_read_b128 v[12:15], v5 offset:0
    ds_read_b128 v[16:19], v5 offset:128
    ds_read_b128 v[20:23], v5 offset:256
    s_cmp_lt_u32 s30, 4
    s_waitcnt lgkmcnt(0)
    v_smfmac_f32_16x16x64_bf16 v[24:27], v[12:15], v[64:71], v1
    v_smfmac_f32_16x16x64_bf16 v[24:27], v[16:19], v[72:79], v1
    v_smfmac_f32_16x16x64_bf16 v[24:27], v[20:23], v[80:87], v1
    v_smfmac_f32_16x16x64_bf16 v[28:31], v[12:15], v[88:95], v1
    v_smfmac_f32_16x16x64_bf16 v[28:31], v[16:19], v[96:103], v1
    v_smfmac_f32_16x16x64_bf16 v[28:31], v[20:23], v[104:111], v1
    v_smfmac_f32_16x16x64_bf16 v[32:35], v[12:15], v[112:119], v1
    v_smfmac_f32_16x16x64_bf16 v[32:35], v[16:19], v[120:127], v1
    v_smfmac_f32_16x16x64_bf16 v[32:35], v[20:23], v[128:135], v1
    v_smfmac_f32_16x16x64_bf16 v[36:39], v[12:15], v[136:143], v1
    v_smfmac_f32_16x16x64_bf16 v[36:39], v[16:19], v[144:151], v1
    v_smfmac_f32_16x16x64_bf16 v[36:39], v[20:23], v[152:159], v1
    v_add_f32 v24, v24, v26
    s_waitcnt vmcnt(0)
    v_add_f32 v28, v28, v30
    s_nop 1
    v_add_f32 v32, v32, v34
    v_max3_f32 v61, v24, v28, v32
    v_mov_b32_dpp v24, v28 quad_perm:[0,1,2,3] row_mask:0x2 bank_mask:0xf
    v_add_f32 v36, v36, v38
    v_max_f32 v61, v61, v36
    v_mov_b32_dpp v24, v32 quad_perm:[0,1,2,3] row_mask:0x4 bank_mask:0xf
    s_nop 0
    v_max_f32_dpp v61, v61, v61 row_ror:8 row_mask:0xf bank_mask:0xf
    s_nop 0
    v_mov_b32_dpp v24, v36 quad_perm:[0,1,2,3] row_mask:0x8 bank_mask:0xf
    v_max_f32_dpp v61, v61, v61 row_ror:4 row_mask:0xf bank_mask:0xf
    s_nop 1
    v_max_f32_dpp v61, v61, v61 row_ror:2 row_mask:0xf bank_mask:0xf
L_pad9:
    s_cbranch_execz L_pad13
    s_nop 1
    v_max_f32_dpp v61, v61, v61 row_ror:1 row_mask:0xf bank_mask:0xf
    v_sub_f32 v36, v24, v61
    ds_write_b32 v59, v61
    v_exp_f32 v36, v36
    s_nop 0
    v_cvt_pk_bf16_f32 v39, v36, v36
    ds_write_b16 v58, v39
    ds_read_b128 v[12:15], v52
    ds_read_b128 v[16:19], v53
    ds_read_b128 v[20:23], v54
    ds_read_b128 v[24:27], v55
    ds_read_b128 v[28:31], v56
    ds_read_b128 v[32:35], v57
    v_add_f32_dpp v38, v36, v36 row_ror:8 row_mask:0xf bank_mask:0xf
    v_mov_b64 v[40:41], 0
    v_mov_b64 v[42:43], 0
    v_add_f32_dpp v38, v38, v38 row_ror:4 row_mask:0xf bank_mask:0xf
    v_mov_b64 v[44:45], 0
    v_mov_b64 v[46:47], 0
    s_waitcnt lgkmcnt(5)
    v_smfmac_f32_16x16x64_bf16 v[40:43], v[12:15], v[160:167], v1
    v_add_f32_dpp v38, v38, v38 row_ror:2 row_mask:0xf bank_mask:0xf
    v_smfmac_f32_16x16x64_bf16 v[44:47], v[12:15], v[208:215], v1
    ds_read_b32 v36, v62
    s_waitcnt lgkmcnt(5)
    v_smfmac_f32_16x16x64_bf16 v[40:43], v[16:19], v[168:175], v1
    v_add_f32_dpp v38, v38, v38 row_ror:1 row_mask:0xf bank_mask:0xf
    v_smfmac_f32_16x16x64_bf16 v[44:47], v[16:19], v[216:223], v1
    s_waitcnt lgkmcnt(4)
    v_smfmac_f32_16x16x64_bf16 v[40:43], v[20:23], v[176:183], v1
    v_add_f32_dpp v38, v38, v38 row_bcast:15 row_mask:0xa bank_mask:0xf
    v_smfmac_f32_16x16x64_bf16 v[44:47], v[20:23], v[224:231], v1
    s_waitcnt lgkmcnt(0)
    v_max_f32_dpp v37, v36, v36 row_ror:4 row_mask:0xf bank_mask:0xf
    v_smfmac_f32_16x16x64_bf16 v[40:43], v[24:27], v[184:191], v1
    v_add_f32_dpp v38, v38, v38 row_bcast:31 row_mask:0xc bank_mask:0xf
    v_smfmac_f32_16x16x64_bf16 v[44:47], v[24:27], v[232:239], v1
    v_max_f32_dpp v37, v37, v37 row_ror:2 row_mask:0xf bank_mask:0xf
    v_smfmac_f32_16x16x64_bf16 v[40:43], v[28:31], v[192:199], v1
    v_cmp_eq_u32 vcc, -1, v36
    v_smfmac_f32_16x16x64_bf16 v[44:47], v[28:31], v[240:247], v1
    v_max_f32_dpp v37, v37, v37 row_ror:1 row_mask:0xf bank_mask:0xf
    v_smfmac_f32_16x16x64_bf16 v[40:43], v[32:35], v[200:207], v1
    v_sub_f32 v39, v61, v37
    v_smfmac_f32_16x16x64_bf16 v[44:47], v[32:35], v[248:255], v1
    v_exp_f32 v39, v39
    s_cbranch_vccnz L_mr_189
L_mk_190:
    v_mul_f32 v38, v38, v39
    ds_write_b32 v63, v38 offset:1024
    s_cmp_lt_u32 s30, 2
    s_nop 0
    v_pk_add_f32 v[40:41], v[40:41], v[42:43]
    s_nop 0
    v_pk_add_f32 v[42:43], v[44:45], v[46:47]
    v_pk_mul_f32 v[40:41], v[40:41], v[38:39] op_sel:[0,1] op_sel_hi:[1,1]
    v_pk_mul_f32 v[42:43], v[42:43], v[38:39] op_sel:[0,1] op_sel_hi:[1,1]
    ds_write_b128 v63, v[40:43]
    s_cbranch_scc1 L_comb_1
    s_waitcnt lgkmcnt(0)
    s_barrier
L_comb_1b:
    s_cmp_lt_u32 s3, 20
    s_cbranch_scc0 L_typeB_1
    s_mul_i32 s74, s30, 1664
    s_add_u32 s74, s74, s62
    s_add_u32 s74, s74, 26624
    v_and_b32 v56, 7, v0
    v_lshlrev_b32 v56, 2, v56
    v_lshrrev_b32 v62, 4, v0
    v_lshlrev_b32 v62, 3, v62
    buffer_load_dword v52, v56, s[40:43], s74 offen offset:1536 sc1
    buffer_load_dwordx2 v[54:55], v62, s[40:43], s74 offen offset:1536 sc1
    v_lshlrev_b32 v57, 4, v0
    v_lshlrev_b32 v58, 3, v0
    s_mul_i32 s57, s30, 6144
    s_add_u32 s57, s57, 30720
    v_lshrrev_b32 v59, 2, v0
    v_lshlrev_b32 v59, 6, v59
    v_bfe_u32 v53, v0, 4, 1
    v_lshl_add_u32 v59, v53, 5, v59
    v_and_b32 v53, 3, v0
L_pad10:
    s_cbranch_execz L_pad14
    v_lshl_add_u32 v59, v53, 3, v59
    v_add_u32 v59, s57, v59
    v_xor_b32 v60, 32, v59
    s_lshl_b32 s57, s30, 8
    s_add_u32 s57, s57, 157696
    v_lshl_add_u32 v61, v0, 2, s57
    ds_read_b64_tr_b16 v[28:29], v59 offset:0
    ds_read_b64_tr_b16 v[30:31], v59 offset:1024
    ds_read_b64_tr_b16 v[32:33], v59 offset:2048
    ds_read_b64_tr_b16 v[34:35], v59 offset:3072
    ds_read_b64_tr_b16 v[36:37], v59 offset:4096
    ds_read_b64_tr_b16 v[38:39], v59 offset:5120
    ds_read_b64_tr_b16 v[40:41], v60 offset:0
    ds_read_b64_tr_b16 v[42:43], v60 offset:1024
    ds_read_b64_tr_b16 v[44:45], v60 offset:2048
    ds_read_b64_tr_b16 v[46:47], v60 offset:3072
    ds_read_b64_tr_b16 v[48:49], v60 offset:4096
    ds_read_b64_tr_b16 v[50:51], v60 offset:5120
    v_mov_b64 v[20:21], 0
    v_mov_b64 v[22:23], 0
    v_mov_b64 v[24:25], 0
    v_mov_b64 v[26:27], 0
    s_add_u32 s58, s6, 132096
    s_branch L_pw_197
.p2align 5
L_pr_198:
    buffer_load_dword v52, v56, s[40:43], s74 offen offset:1536 sc1
    buffer_load_dwordx2 v[54:55], v62, s[40:43], s74 offen offset:1536 sc1
    s_sub_u32 s56, s56, 1
    s_cbranch_scc1 L_done
L_pw_197:
    s_waitcnt vmcnt(0)
    v_max3_u32 v53, v52, v54, v55
    v_cmp_eq_u32 vcc, -1, v53
    s_cbranch_vccnz L_pr_198
    buffer_load_dwordx4 v[12:15], v57, s[40:43], s74 offen sc1
    buffer_load_dwordx2 v[16:17], v58, s[40:43], s74 offen offset:1024 sc1
    buffer_load_dword v18, v56, s[40:43], s74 offen offset:1568 sc1
    v_max_f32_dpp v53, v52, v52 row_ror:4 row_mask:0xf bank_mask:0xf
    s_nop 1
    v_max_f32_dpp v53, v53, v53 row_ror:2 row_mask:0xf bank_mask:0xf
    s_nop 1
    v_max_f32_dpp v53, v53, v53 row_ror:1 row_mask:0xf bank_mask:0xf
    v_sub_f32 v52, v52, v53
    v_sub_f32 v54, v54, v53
    v_sub_f32 v55, v55, v53
    v_exp_f32 v52, v52
    v_exp_f32 v54, v54
    v_exp_f32 v55, v55
    s_waitcnt lgkmcnt(0)
    s_branch L_ow_199
.p2align 5
L_or_200:
    buffer_load_dwordx4 v[12:15], v57, s[40:43], s74 offen sc1
    buffer_load_dwordx2 v[16:17], v58, s[40:43], s74 offen offset:1024 sc1
    buffer_load_dword v18, v56, s[40:43], s74 offen offset:1568 sc1
    s_sub_u32 s56, s56, 1
    s_cbranch_scc1 L_done
    v_mov_b64 v[20:21], 0
    v_mov_b64 v[22:23], 0
    v_mov_b64 v[24:25], 0
    v_mov_b64 v[26:27], 0
L_ow_199:
    s_waitcnt vmcnt(2)
    v_smfmac_f32_16x16x64_bf16 v[20:23], v[12:15], v[28:35], v1
    v_max3_u32 v19, v12, v13, v14
    v_smfmac_f32_16x16x64_bf16 v[24:27], v[12:15], v[40:47], v1
    s_waitcnt vmcnt(0)
    v_mul_f32 v53, v52, v18
    v_smfmac_f32_16x16x32_bf16 v[20:23], v[16:17], v[36:39], v1
    v_max3_u32 v62, v15, v16, v17
    v_smfmac_f32_16x16x32_bf16 v[24:27], v[16:17], v[48:51], v1
    v_max3_u32 v19, v19, v62, v18
    v_add_f32_dpp v53, v53, v53 row_ror:4 row_mask:0xf bank_mask:0xf
    v_cmp_eq_u32 vcc, -1, v19
    s_cmp_eq_u32 s30, 2
    v_add_f32_dpp v53, v53, v53 row_ror:2 row_mask:0xf bank_mask:0xf
    s_cbranch_vccnz L_or_200
    s_nop 0
    v_add_f32_dpp v53, v53, v53 row_ror:1 row_mask:0xf bank_mask:0xf
    v_rcp_f32 v52, v53
L_pad11:
    s_cbranch_execz L_pad15
    v_pk_add_f32 v[20:21], v[20:21], v[22:23]
    v_pk_add_f32 v[24:25], v[24:25], v[26:27]
    v_pk_mul_f32 v[54:55], v[54:55], v[52:53] op_sel:[0,0] op_sel_hi:[1,0]
    v_mul_f32 v20, v20, v54
    v_mul_f32 v24, v24, v54
    v_fmac_f32 v20, v21, v55
    v_fmac_f32 v24, v25, v55
    s_nop 1
    v_permlane32_swap_b32 v20, v24
    v_add_f32 v20, v20, v24
    ds_write_b32 v61, v20
    s_waitcnt lgkmcnt(0)
    s_barrier
    s_cbranch_scc0 L_finb_201
    ds_read2st64_b32 v[12:13], v2 offset0:0 offset1:1
    ds_read2st64_b32 v[14:15], v2 offset0:2 offset1:3
    ds_read2st64_b32 v[16:17], v2 offset0:4 offset1:5
    ds_read2st64_b32 v[18:19], v2 offset0:6 offset1:7
    s_waitcnt lgkmcnt(2)
    v_pk_add_f32 v[12:13], v[12:13], v[14:15]
    s_waitcnt lgkmcnt(0)
    v_pk_add_f32 v[16:17], v[16:17], v[18:19]
    v_pk_add_f32 v[12:13], v[12:13], v[16:17]
    v_add_f32 v14, v12, v13
    v_add_f32 v15, v12, v13
    s_nop 1
    v_permlane16_swap_b32 v14, v15
    v_add_f32 v12, v14, v15
    buffer_store_dword v12, v3, s[40:43], s58 offen sc1
L_finb_201:
    s_sub_u32 s57, s30, 4
    s_cmp_lt_u32 s57, 3
    s_cbranch_scc0 L_skip_202
    s_sub_u32 s60, s30, 4
    s_lshl_b32 s57, s60, 11
    v_lshlrev_b32 v11, 4, v0
    v_add_u32 v11, s57, v11
    s_add_u32 s65, s62, 19456
    buffer_load_dwordx4 v[52:55], v11, s[40:43], s65 offen offset:0 sc1
    buffer_load_dwordx4 v[56:59], v11, s[40:43], s65 offen offset:1024 sc1
    s_lshl_b32 s59, s60, 12
    s_add_u32 s59, s59, 79872
    v_bfe_u32 v35, v0, 4, 1
    v_lshlrev_b32 v35, 11, v35
    v_bfe_u32 v60, v0, 2, 2
    v_lshl_add_u32 v35, v60, 8, v35
    v_lshrrev_b32 v60, 5, v0
    v_lshl_add_u32 v35, v60, 6, v35
    v_and_b32 v60, 3, v0
    v_lshl_add_u32 v35, v60, 3, v35
    v_add_u32 v35, s59, v35
    v_mov_b32 v9, 0xbdd2d3e8
    v_mov_b32 v10, 0xc0135761
    s_lshl_b32 s57, s60, 7
    s_add_u32 s57, s57, 160256
    v_lshlrev_b32 v32, 3, v0
    v_add_u32 v32, s57, v32
    v_lshlrev_b32 v33, 3, v0
    v_add_u32 v33, 129024, v33
    v_cmp_gt_u32 vcc, 16, v0
    s_nop 1
    v_cndmask_b32 v32, v33, v32, vcc
    v_and_b32 v33, 15, v0
    v_lshlrev_b32 v33, 3, v33
    v_lshrrev_b32 v60, 5, v0
    v_lshl_add_u32 v33, v60, 2, v33
    v_add_u32 v33, 160256, v33
    v_and_b32 v34, 15, v0
    v_lshlrev_b32 v34, 2, v34
    v_lshrrev_b32 v60, 5, v0
    v_lshl_add_u32 v34, v60, 6, v34
    v_bfe_u32 v60, v0, 4, 1
    v_lshl_add_u32 v34, v60, 13, v34
    s_add_u32 s60, s6, 198144
    s_add_u32 s58, s62, 39936
    s_add_u32 s57, s62, 25984
    v_and_b32 v7, 7, v0
    v_lshlrev_b32 v7, 3, v7
    v_mov_b32 v60, 0x3acccccd
    v_mov_b32 v61, 0x3727c5ac
    s_waitcnt vmcnt(0)
    buffer_load_dwordx2 v[24:25], v7, s[40:43], s57 offen sc1
    buffer_load_dwordx4 v[12:15], v11, s[40:43], s58 offen offset:0 sc1
    buffer_load_dwordx4 v[16:19], v11, s[40:43], s58 offen offset:1024 sc1
    ds_read_b64_tr_b16 v[36:37], v35 offset:0
    ds_read_b64_tr_b16 v[38:39], v35 offset:1024
    ds_read_b64_tr_b16 v[40:41], v35 offset:128
L_pad12:
    s_cbranch_execz L_pad16
    ds_read_b64_tr_b16 v[42:43], v35 offset:1152
    ds_read_b64_tr_b16 v[44:45], v35 offset:32
    ds_read_b64_tr_b16 v[46:47], v35 offset:1056
    ds_read_b64_tr_b16 v[48:49], v35 offset:160
    ds_read_b64_tr_b16 v[50:51], v35 offset:1184
L_sw_205:
    v_max3_u32 v20, v52, v53, v54
    v_max3_u32 v20, v20, v55, v56
    v_max3_u32 v20, v20, v57, v58
    v_max_u32 v20, v20, v59
    v_cmp_eq_u32 vcc, -1, v20
    s_cbranch_vccnz L_sr_206
    v_pk_add_f32 v[28:29], v[52:53], v[56:57]
    v_pk_add_f32 v[30:31], v[54:55], v[58:59]
    s_nop 1
    v_permlane32_swap_b32 v28, v30
    v_permlane32_swap_b32 v29, v31
    v_pk_add_f32 v[28:29], v[28:29], v[30:31]
    s_nop 1
    v_permlane16_swap_b32 v28, v29
    v_add_f32 v28, v28, v29
    v_mov_b64 v[52:53], 0
    v_mov_b64 v[54:55], 0
    v_mov_b64 v[56:57], 0
    v_mov_b64 v[58:59], 0
    s_waitcnt lgkmcnt(0)
    s_branch L_pw_203
.p2align 5
L_pr_204:
    buffer_load_dwordx2 v[24:25], v7, s[40:43], s57 offen sc1
    buffer_load_dwordx4 v[12:15], v11, s[40:43], s58 offen offset:0 sc1
    buffer_load_dwordx4 v[16:19], v11, s[40:43], s58 offen offset:1024 sc1
    s_sub_u32 s56, s56, 1
    s_cbranch_scc1 L_done
L_pw_203:
    s_waitcnt vmcnt(0)
    v_max_u32 v20, v24, v25
    v_cmp_eq_u32 vcc, -1, v20
    s_cbranch_vccnz L_pr_204
    buffer_load_dwordx4 v[12:15], v11, s[40:43], s58 offen offset:0 sc1
    buffer_load_dwordx4 v[16:19], v11, s[40:43], s58 offen offset:1024 sc1
    v_add_f32_dpp v2, v24, v24 row_ror:4 row_mask:0xf bank_mask:0xf
    v_add_f32_dpp v3, v25, v25 row_ror:4 row_mask:0xf bank_mask:0xf
    v_pk_add_f32 v[20:21], v[12:13], v[16:17]
    v_pk_add_f32 v[22:23], v[14:15], v[18:19]
    v_add_f32_dpp v2, v2, v2 row_ror:2 row_mask:0xf bank_mask:0xf
    v_add_f32_dpp v3, v3, v3 row_ror:2 row_mask:0xf bank_mask:0xf
    v_permlane32_swap_b32 v20, v22
    v_permlane32_swap_b32 v21, v23
    v_add_f32_dpp v2, v2, v2 row_ror:1 row_mask:0xf bank_mask:0xf
    v_add_f32_dpp v3, v3, v3 row_ror:1 row_mask:0xf bank_mask:0xf
    v_pk_add_f32 v[20:21], v[20:21], v[22:23]
    v_mul_f32 v2, v2, v60
    v_fma_f32 v3, v3, v60, v61
    v_permlane16_swap_b32 v20, v21
    v_fma_f32 v3, -v2, v2, v3
    v_add_f32 v20, v20, v21
    v_max_f32 v3, v3, v61
    v_mul_f32 v26, v28, v2
    v_rsq_f32 v3, v3
    v_cmp_u_f32 vcc, v20, v20
    v_sub_f32 v20, v20, v26
    s_cbranch_vccnz L_hr_207
L_hk_208:
    v_fma_f32 v20, v20, v3, v4
    v_mul_f32 v21, v20, v20
    v_fma_f32 v21, v21, v9, v10
    v_mul_f32 v21, v21, v20
    v_exp_f32 v21, v21
    s_nop 0
    v_add_f32 v21, 1.0, v21
    v_rcp_f32 v21, v21
    s_nop 0
    v_mul_f32 v20, v20, v21
    s_nop 1
    v_mov_b32_dpp v21, v20 row_shl:1 row_mask:0xf bank_mask:0xf bound_ctrl:0
    v_cvt_pk_bf16_f32 v28, v20, v21
    s_nop 1
    v_mov_b32_dpp v29, v28 row_shl:4 row_mask:0xf bank_mask:0xf bound_ctrl:0
    v_mov_b32_dpp v30, v28 row_shl:8 row_mask:0xf bank_mask:0xf bound_ctrl:0
    v_mov_b32_dpp v31, v28 row_shl:12 row_mask:0xf bank_mask:0xf bound_ctrl:0
    s_nop 1
    v_smfmac_f32_16x16x64_bf16 v[52:55], v[28:31], v[36:43], v1
    v_smfmac_f32_16x16x64_bf16 v[56:59], v[28:31], v[44:51], v1
    s_cmp_eq_u32 s30, 4
    s_nop 5
    v_add_f32 v22, v52, v54
    v_add_f32 v23, v56, v58
    ds_write_b64 v32, v[22:23]
    s_cbranch_scc0 L_skip_210
L_xw_211:
    ds_read2_b32 v[20:21], v33 offset0:0 offset1:32
    ds_read_b32 v22, v33 offset:256
L_pad13:
    s_cbranch_execz L_pad17
    s_sub_u32 s56, s56, 1
    s_cbranch_scc1 L_done
    s_waitcnt lgkmcnt(0)
    v_max3_u32 v23, v20, v21, v22
    v_add_f32 v20, v20, v21
    v_cmp_eq_u32 vcc, -1, v23
    v_add_f32 v20, v20, v22
    s_cbranch_vccnz L_xw_211
    buffer_store_dword v20, v34, s[40:43], s60 offen sc1
L_skip_210:
L_skip_202:
    s_branch L_done
.p2align 5
L_typeB_1:
    s_cmp_eq_u32 s53, 3
    s_cbranch_scc0 L_typeC_212
    s_cmp_eq_u32 s30, 7
    s_cbranch_scc1 L_w7_217
    s_cmp_lt_u32 s30, 6
    s_cbranch_scc0 L_skip_219
    s_lshr_b32 s57, s30, 1
    s_mul_i32 s57, s57, 128
    s_and_b32 s58, s30, 1
    s_lshl_b32 s58, s58, 6
    s_add_u32 s57, s57, s58
    v_lshrrev_b32 v18, 5, v0
    v_lshlrev_b32 v18, 13, v18
    v_bfe_u32 v60, v0, 3, 1
    v_lshl_add_u32 v18, v60, 12, v18
    v_bfe_u32 v60, v0, 4, 1
    v_lshl_add_u32 v18, v60, 11, v18
    v_bfe_u32 v60, v0, 2, 1
    v_mul_u32_u24 v60, 384, v60
    v_add_u32 v18, v60, v18
    v_and_b32 v60, 3, v0
    v_lshl_add_u32 v18, v60, 3, v18
    v_add_u32 v18, s57, v18
    v_add_u32 v18, 30720, v18
    v_bfe_u32 v19, v0, 4, 1
    v_lshlrev_b32 v19, 12, v19
    v_bfe_u32 v60, v0, 3, 1
    v_lshl_add_u32 v19, v60, 11, v19
    v_bfe_u32 v60, v0, 2, 1
    v_mul_u32_u24 v60, 384, v60
    v_add_u32 v19, v60, v19
    v_and_b32 v60, 3, v0
    v_lshl_add_u32 v19, v60, 3, v19
    v_add_u32 v19, s57, v19
    v_add_u32 v19, 63488, v19
    ds_read_b64_tr_b16 v[28:29], v18 offset:0
    ds_read_b64_tr_b16 v[30:31], v18 offset:1024
    ds_read_b64_tr_b16 v[32:33], v18 offset:16384
    ds_read_b64_tr_b16 v[34:35], v18 offset:17408
    ds_read_b64_tr_b16 v[36:37], v19 offset:0
    ds_read_b64_tr_b16 v[38:39], v19 offset:1024
    ds_read_b64_tr_b16 v[40:41], v18 offset:32
    ds_read_b64_tr_b16 v[42:43], v18 offset:1056
    ds_read_b64_tr_b16 v[44:45], v18 offset:16416
    ds_read_b64_tr_b16 v[46:47], v18 offset:17440
    ds_read_b64_tr_b16 v[48:49], v19 offset:32
    ds_read_b64_tr_b16 v[50:51], v19 offset:1056
    v_lshrrev_b32 v9, 4, v0
    v_lshlrev_b32 v9, 5, v9
    v_bfe_u32 v60, v0, 1, 1
    v_lshl_add_u32 v9, v60, 4, v9
    v_and_b32 v60, 1, v0
    v_mul_u32_u24 v60, 192, v60
    v_add_u32 v9, v60, v9
    v_add_u32 v9, 160832, v9
    v_lshrrev_b32 v10, 4, v0
    v_lshlrev_b32 v10, 4, v10
    v_bfe_u32 v60, v0, 1, 1
    v_lshl_add_u32 v10, v60, 3, v10
    v_and_b32 v60, 1, v0
    v_mul_u32_u24 v60, 192, v60
    v_add_u32 v10, v60, v10
    v_add_u32 v10, 160960, v10
    v_mov_b64 v[20:21], 0
    v_mov_b64 v[22:23], 0
    v_mov_b64 v[24:25], 0
    v_mov_b64 v[26:27], 0
    s_lshr_b32 s57, s30, 1
    s_lshl_b32 s57, s57, 11
    s_lshl_b32 s58, s58, 1
    s_add_u32 s57, s57, s58
    s_lshl_b32 s58, s54, 8
    s_add_u32 s57, s57, s58
    v_and_b32 v11, 31, v0
    v_lshlrev_b32 v11, 2, v11
    v_lshrrev_b32 v60, 5, v0
L_pad14:
    s_cbranch_execz L_pad18
    v_lshl_add_u32 v11, v60, 30, v11
    v_add_u32 v11, s57, v11
    s_add_u32 s59, s62, 39936
    s_add_u32 s60, s62, 25984
L_skip_219:
    s_cmp_lt_u32 s30, 6
    s_barrier
    s_cbranch_scc0 L_se_218
    ds_read_b128 v[12:15], v9
    ds_read_b64 v[16:17], v10
    s_waitcnt lgkmcnt(1)
    v_smfmac_f32_16x16x64_bf16 v[20:23], v[12:15], v[28:35], v1
    v_smfmac_f32_16x16x64_bf16 v[24:27], v[12:15], v[40:47], v1
    s_waitcnt lgkmcnt(0)
    v_smfmac_f32_16x16x32_bf16 v[20:23], v[16:17], v[36:39], v1
    v_smfmac_f32_16x16x32_bf16 v[24:27], v[16:17], v[48:51], v1
    s_cmp_eq_u32 s55, 0
    s_nop 5
    v_add_f32 v12, v20, v22
    s_nop 1
    v_add_f32_dpp v12, v24, v26 quad_perm:[0,1,2,3] row_mask:0x2 bank_mask:0xf
    s_cbranch_scc1 L_gs_220
    buffer_store_dword v12, v11, s[40:43], s59 offen
L_gb_221:
L_se_218:
    s_cmp_eq_u32 s30, 7
    s_cbranch_scc0 L_done
    s_cmp_eq_u32 s31, 0
    s_cbranch_scc0 L_done
    v_lshlrev_b32 v60, 16, v4
    v_add_f32 v2, v2, v60
    v_and_b32 v60, 0xffff0000, v4
    v_add_f32 v3, v3, v60
    v_and_b32 v60, 31, v0
    v_min_u32 v60, 19, v60
    s_mul_i32 s57, s54, 160
    v_lshrrev_b32 v7, 5, v0
    v_lshlrev_b32 v7, 2, v7
    v_add_u32 v7, s57, v7
    v_lshl_add_u32 v7, v60, 3, v7
    s_add_u32 s57, s7, 198144
    s_add_u32 s58, s7, 214528
    s_add_u32 s59, s7, 230912
    s_add_u32 s60, s7, 247296
    v_mov_b64 v[36:37], 0
    v_mov_b64 v[38:39], 0
    s_nop 0
    v_mov_b32_dpp v36, v2 quad_perm:[0,1,2,3] row_mask:0x3 bank_mask:0xf
    v_mov_b32_dpp v37, v3 quad_perm:[0,1,2,3] row_mask:0x3 bank_mask:0xf
    v_mov_b32_dpp v38, v2 quad_perm:[0,1,2,3] row_mask:0xc bank_mask:0xf
    v_mov_b32_dpp v39, v3 quad_perm:[0,1,2,3] row_mask:0xc bank_mask:0xf
    s_add_u32 s75, s7, 266252
    v_and_b32 v9, 7, v0
    v_lshlrev_b32 v9, 9, v9
L_pr_233:
    buffer_load_dword v12, v9, s[40:43], s75 offen sc1
    s_sub_u32 s56, s56, 1
    s_cbranch_scc1 L_done
L_pw_232:
    s_waitcnt vmcnt(0)
    v_cmp_eq_u32 vcc, -1, v12
    s_cbranch_vccnz L_pr_233
L_gw_229:
    buffer_load_dwordx4 v[12:15], v5, s[40:43], s57 offen sc1
    buffer_load_dwordx4 v[16:19], v5, s[40:43], s58 offen sc1
    buffer_load_dwordx4 v[20:23], v5, s[40:43], s59 offen sc1
    buffer_load_dwordx4 v[24:27], v5, s[40:43], s60 offen sc1
    s_sub_u32 s56, s56, 1
    s_cbranch_scc1 L_done
    s_and_b32 s74, s56, 31
    s_waitcnt vmcnt(3)
    v_pk_add_f32 v[28:29], v[12:13], v[36:37]
    v_pk_add_f32 v[30:31], v[14:15], v[38:39]
    s_waitcnt vmcnt(2)
    v_pk_add_f32 v[28:29], v[28:29], v[16:17]
    v_pk_add_f32 v[30:31], v[30:31], v[18:19]
    s_waitcnt vmcnt(1)
    v_pk_add_f32 v[28:29], v[28:29], v[20:21]
    v_pk_add_f32 v[30:31], v[30:31], v[22:23]
    s_waitcnt vmcnt(0)
    v_pk_add_f32 v[28:29], v[28:29], v[24:25]
    v_pk_add_f32 v[30:31], v[30:31], v[26:27]
    v_pk_add_f32 v[32:33], v[28:29], v[30:31]
    v_cmp_u_f32 vcc, v32, v33
    v_permlane32_swap_b32 v28, v30
    v_permlane32_swap_b32 v29, v31
    s_cbranch_vccnz L_gr_230
L_gk_231:
    v_pk_add_f32 v[28:29], v[28:29], v[30:31]
    v_cvt_pk_bf16_f32 v28, v28, v29
    global_store_dword v7, v28, s[24:25]
    s_branch L_done
.p2align 5
L_gs_34:
L_pad15:
    s_cbranch_execz L_pad19
    buffer_store_dword v33, v34, s[40:43], s67 offen sc1
    s_branch L_gb_35
.p2align 5
L_gs_37:
    buffer_store_dword v12, v54, s[40:43], s59 offen sc1
    s_branch L_gb_38
.p2align 5
L_cr_49:
    s_sub_u32 s56, s56, 1
    s_cbranch_scc1 L_done
    global_load_dword v2, v3, s[26:27] sc1
    s_waitcnt vmcnt(0)
    s_branch L_cw_48
.p2align 5
L_far_50:
    s_lshl_b32 s57, s52, 2
    s_add_u32 s57, s57, s72
    s_mov_b64 exec, 1
    buffer_store_dword v25, v0, s[40:43], s57 offen offset:128 sc1
    s_mov_b64 exec, -1
    s_branch L_fb_51
.p2align 5
L_cr_63:
    s_sub_u32 s56, s56, 1
    s_cbranch_scc1 L_done
    buffer_load_dword v2, v24, s[40:43], s72 offen sc1
    s_branch L_cw_62
.p2align 5
L_gs_70:
    buffer_store_dword v33, v34, s[40:43], s67 offen sc1
    s_branch L_gb_71
.p2align 5
L_gs_73:
    buffer_store_dword v12, v54, s[40:43], s59 offen sc1
    s_branch L_gb_74
.p2align 5
L_gs_91:
    buffer_store_dword v37, v4, s[40:43], s58 offen sc1
    s_branch L_gb_92
.p2align 5
L_cr_105:
    s_sub_u32 s56, s56, 1
    s_cbranch_scc1 L_done
    global_load_dword v2, v3, s[26:27] offset:4 sc1
    s_branch L_cw_104
.p2align 5
L_cr_115:
    buffer_load_dword v52, v56, s[40:43], s74 offen offset:1536 sc1
    buffer_load_dwordx2 v[54:55], v62, s[40:43], s74 offen offset:1536 sc1
    s_sub_u32 s56, s56, 1
    s_cbranch_scc1 L_done
    s_branch L_cw_114
.p2align 5
L_gs_120:
    buffer_store_dword v14, v3, s[40:43], s57 offen sc1
    s_branch L_gb_121
.p2align 5
L_gs_122:
    buffer_store_dword v12, v4, s[40:43], s57 offen offset:32 sc1
    s_branch L_gb_123
.p2align 5
L_comb_0:
    s_mov_b32 s57, 0
    s_cmp_eq_u32 s55, 0
    s_waitcnt lgkmcnt(0)
    s_barrier
    ds_read2st64_b64 v[12:15], v2 offset0:0 offset1:4
    ds_read2st64_b64 v[16:19], v2 offset0:8 offset1:12
    ds_read2st64_b64 v[20:23], v2 offset0:16 offset1:20
    ds_read2st64_b64 v[24:27], v2 offset0:24 offset1:28
    s_waitcnt lgkmcnt(2)
    v_pk_add_f32 v[12:13], v[12:13], v[14:15]
    v_pk_add_f32 v[16:17], v[16:17], v[18:19]
    v_pk_add_f32 v[12:13], v[12:13], v[16:17]
    s_waitcnt lgkmcnt(0)
    v_pk_add_f32 v[20:21], v[20:21], v[22:23]
    v_pk_add_f32 v[24:25], v[24:25], v[26:27]
    v_pk_add_f32 v[12:13], v[12:13], v[20:21]
    v_pk_add_f32 v[12:13], v[12:13], v[24:25]
    v_cvt_pk_bf16_f32 v14, v12, v13
    v_min_u32 v14, -2, v14
    s_cbranch_scc1 L_gs_120
L_pad16:
    s_cbranch_execz L_pad20
    buffer_store_dword v14, v3, s[40:43], s57 offen
L_gb_121:
    s_cbranch_scc1 L_gs_122
    buffer_store_dword v12, v4, s[40:43], s57 offen offset:32
L_gb_123:
    s_branch L_comb_0b
.p2align 5
L_sr_132:
    buffer_load_dwordx4 v[52:55], v11, s[40:43], s65 offen offset:0 sc1
    buffer_load_dwordx4 v[56:59], v11, s[40:43], s65 offen offset:1024 sc1
    s_sub_u32 s56, s56, 1
    s_cbranch_scc1 L_done
    s_waitcnt vmcnt(0)
    s_branch L_sw_131
L_hr_133:
    buffer_load_dwordx4 v[12:15], v11, s[40:43], s58 offen offset:0 sc1
    buffer_load_dwordx4 v[16:19], v11, s[40:43], s58 offen offset:1024 sc1
    s_sub_u32 s56, s56, 1
    s_cbranch_scc1 L_done
    s_and_b32 s64, s56, 31
    s_cbranch_scc0 L_hx_135
    s_waitcnt vmcnt(2)
    v_pk_add_f32 v[20:21], v[12:13], v[16:17]
    v_pk_add_f32 v[22:23], v[14:15], v[18:19]
    s_nop 1
    v_permlane32_swap_b32 v20, v22
    v_permlane32_swap_b32 v21, v23
    v_pk_add_f32 v[20:21], v[20:21], v[22:23]
    s_nop 1
    v_permlane16_swap_b32 v20, v21
    v_add_f32 v20, v20, v21
    v_cmp_u_f32 vcc, v20, v20
    v_sub_f32 v20, v20, v26
    s_cbranch_vccnz L_hr_133
    s_branch L_hk_134
.p2align 5
L_hx_135:
    s_waitcnt vmcnt(0)
    v_max3_u32 v20, v12, v13, v14
    v_max3_u32 v20, v20, v15, v16
    v_max3_u32 v20, v20, v17, v18
    v_max_u32 v20, v20, v19
    v_cmp_eq_u32 vcc, -1, v20
    s_cbranch_vccnz L_hr_133
    v_pk_add_f32 v[20:21], v[12:13], v[16:17]
    v_pk_add_f32 v[22:23], v[14:15], v[18:19]
    s_nop 1
    v_permlane32_swap_b32 v20, v22
    v_permlane32_swap_b32 v21, v23
    v_pk_add_f32 v[20:21], v[20:21], v[22:23]
    s_nop 1
    v_permlane16_swap_b32 v20, v21
    v_add_f32 v20, v20, v21
    v_sub_f32 v20, v20, v26
    s_branch L_hk_134
L_gs_143:
    buffer_store_dword v0, v11, s[40:43], s58 offen sc1
    s_branch L_gb_144
.p2align 5
L_typeC_139:
    s_cmp_eq_u32 s30, 6
    s_cbranch_scc0 L_p1
    s_bitcmp1_b32 s3, 0
    s_cbranch_scc0 L_skip_140
    v_and_b32 v11, 3, v0
    v_lshlrev_b32 v11, 7, v11
    v_lshrrev_b32 v60, 2, v0
    v_lshl_add_u32 v11, v60, 24, v11
    s_add_u32 s58, s62, 26116
    s_add_u32 s75, s7, 266244
    v_and_b32 v9, 7, v0
    v_lshlrev_b32 v9, 9, v9
L_pr_142:
    buffer_load_dword v12, v9, s[40:43], s75 offen sc1
    s_sub_u32 s56, s56, 1
    s_cbranch_scc1 L_done
L_pw_141:
    s_waitcnt vmcnt(0)
    v_cmp_eq_u32 vcc, -1, v12
    s_cbranch_vccnz L_pr_142
    s_cmp_eq_u32 s55, 0
    s_cbranch_scc1 L_gs_143
    buffer_store_dword v0, v11, s[40:43], s58 offen
L_gb_144:
    s_waitcnt vmcnt(1)
    s_branch L_p1
.p2align 5
L_skip_140:
    s_lshl_b32 s59, s31, 9
    s_add_u32 s59, s59, s8
    s_add_u32 s59, s59, 266240
    v_and_b32 v10, 1, v0
    v_lshlrev_b32 v10, 13, v10
    v_lshrrev_b32 v60, 1, v0
    v_lshl_add_u32 v10, v60, 24, v10
    s_cmp_eq_u32 s3, 20
    s_cbranch_scc0 L_skip_145
    s_add_u32 s58, s62, 1568
    v_lshrrev_b32 v9, 3, v0
    v_mul_u32_u24 v9, 1664, v9
L_pad17:
    s_cbranch_execz L_pad21
    v_and_b32 v60, 7, v0
    v_lshl_add_u32 v9, v60, 2, v9
L_pr_147:
    buffer_load_dword v12, v9, s[40:43], s58 offen sc1
    s_sub_u32 s56, s56, 1
    s_cbranch_scc1 L_done
L_pw_146:
    s_waitcnt vmcnt(0)
    v_cmp_eq_u32 vcc, -1, v12
    s_cbranch_vccnz L_pr_147
    buffer_store_dword v0, v10, s[40:43], s59 offen offset:0 sc1
L_skip_145:
    s_add_u32 s58, s62, 25856
    v_and_b32 v9, 15, v0
    v_lshlrev_b32 v9, 2, v9
L_pr_149:
    buffer_load_dword v13, v9, s[40:43], s58 offen sc1
    s_sub_u32 s56, s56, 1
    s_cbranch_scc1 L_done
L_pw_148:
    s_waitcnt vmcnt(0)
    v_cmp_eq_u32 vcc, -1, v13
    s_cbranch_vccnz L_pr_149
    buffer_store_dword v0, v10, s[40:43], s59 offen offset:4 sc1
    s_waitcnt vmcnt(1)
    s_branch L_p1
.p2align 5
L_gs_153:
    buffer_store_dword v12, v11, s[40:43], s60 offen sc1
    s_branch L_gb_154
.p2align 5
L_gs_155:
    buffer_store_dword v12, v11, s[40:43], s59 offen sc1
    s_branch L_gb_156
.p2align 5
L_gr_158:
    s_cbranch_scc1 L_gw_157
    s_waitcnt vmcnt(0)
    v_max3_u32 v32, v12, v13, v14
    v_max3_u32 v32, v32, v15, v16
    v_max3_u32 v32, v32, v17, v18
    v_max3_u32 v32, v32, v19, v20
    v_max3_u32 v32, v32, v21, v22
    v_max3_u32 v32, v32, v23, v24
    v_max3_u32 v32, v32, v25, v26
    v_max_u32 v32, v32, v27
    v_cmp_eq_u32 vcc, -1, v32
    s_cbranch_vccnz L_gw_157
    v_pk_add_f32 v[28:29], v[12:13], v[36:37]
    v_pk_add_f32 v[30:31], v[14:15], v[38:39]
    v_pk_add_f32 v[28:29], v[28:29], v[16:17]
    v_pk_add_f32 v[30:31], v[30:31], v[18:19]
    v_pk_add_f32 v[28:29], v[28:29], v[20:21]
    v_pk_add_f32 v[30:31], v[30:31], v[22:23]
    v_pk_add_f32 v[28:29], v[28:29], v[24:25]
    v_pk_add_f32 v[30:31], v[30:31], v[26:27]
    s_nop 1
    v_permlane32_swap_b32 v28, v30
    v_permlane32_swap_b32 v29, v31
    s_branch L_gk_159
.p2align 5
L_gs_162:
    buffer_store_dword v33, v34, s[40:43], s67 offen sc1
    s_branch L_gb_163
.p2align 5
L_w7_150:
    v_and_b32 v60, 31, v0
    v_min_u32 v60, 19, v60
    s_mul_i32 s57, s54, 320
    v_lshrrev_b32 v5, 5, v0
    v_lshlrev_b32 v5, 12, v5
    v_add_u32 v5, s57, v5
    v_lshl_add_u32 v5, v60, 4, v5
    v_and_b32 v60, 31, v0
    v_cmp_gt_u32 s[64:65], 20, v60
    v_min_u32 v60, 19, v60
    v_lshrrev_b32 v35, 5, v0
    v_lshlrev_b32 v35, 2, v35
    v_add_u32 v35, 160832, v35
    v_lshl_add_u32 v35, v60, 3, v35
    s_add_u32 s66, s62, 13312
    s_add_u32 s67, s62, 25856
    s_lshl_b32 s57, s54, 3
    v_lshrrev_b32 v34, 5, v0
    v_lshlrev_b32 v34, 2, v34
    v_add_u32 v34, s57, v34
    v_and_b32 v60, 31, v0
    v_mov_b32 v61, 0x7f000000
    v_cmp_ne_u32 vcc, 31, v60
    s_nop 1
L_pad18:
    s_cbranch_execz L_pad22
    v_cndmask_b32 v34, v34, v61, vcc
    v_mov_b32 v61, 0x3f803f80
    s_add_u32 s57, s7, 0
    s_add_u32 s58, s7, 16384
    s_add_u32 s59, s7, 32768
    s_add_u32 s60, s7, 49152
    v_mov_b64 v[36:37], 0
    v_mov_b64 v[38:39], 0
    s_nop 0
    v_mov_b32_dpp v36, v2 quad_perm:[0,1,2,3] row_mask:0x3 bank_mask:0xf
    v_mov_b32_dpp v37, v3 quad_perm:[0,1,2,3] row_mask:0x3 bank_mask:0xf
    v_mov_b32_dpp v38, v2 quad_perm:[0,1,2,3] row_mask:0xc bank_mask:0xf
    v_mov_b32_dpp v39, v3 quad_perm:[0,1,2,3] row_mask:0xc bank_mask:0xf
    s_add_u32 s75, s7, 266240
    v_and_b32 v9, 7, v0
    v_lshlrev_b32 v9, 9, v9
L_pr_161:
    buffer_load_dword v12, v9, s[40:43], s75 offen sc1
    s_sub_u32 s56, s56, 1
    s_cbranch_scc1 L_done
L_pw_160:
    s_waitcnt vmcnt(0)
    v_cmp_eq_u32 vcc, -1, v12
    s_cbranch_vccnz L_pr_161
L_gw_157:
    buffer_load_dwordx4 v[12:15], v5, s[40:43], s57 offen sc1
    buffer_load_dwordx4 v[16:19], v5, s[40:43], s58 offen sc1
    buffer_load_dwordx4 v[20:23], v5, s[40:43], s59 offen sc1
    buffer_load_dwordx4 v[24:27], v5, s[40:43], s60 offen sc1
    s_sub_u32 s56, s56, 1
    s_cbranch_scc1 L_done
    s_and_b32 s74, s56, 31
    s_waitcnt vmcnt(3)
    v_pk_add_f32 v[28:29], v[12:13], v[36:37]
    v_pk_add_f32 v[30:31], v[14:15], v[38:39]
    s_waitcnt vmcnt(2)
    v_pk_add_f32 v[28:29], v[28:29], v[16:17]
    v_pk_add_f32 v[30:31], v[30:31], v[18:19]
    s_waitcnt vmcnt(1)
    v_pk_add_f32 v[28:29], v[28:29], v[20:21]
    v_pk_add_f32 v[30:31], v[30:31], v[22:23]
    s_waitcnt vmcnt(0)
    v_pk_add_f32 v[28:29], v[28:29], v[24:25]
    v_pk_add_f32 v[30:31], v[30:31], v[26:27]
    v_pk_add_f32 v[32:33], v[28:29], v[30:31]
    v_cmp_u_f32 vcc, v32, v33
    v_permlane32_swap_b32 v28, v30
    v_permlane32_swap_b32 v29, v31
    s_cbranch_vccnz L_gr_158
L_gk_159:
    v_pk_add_f32 v[28:29], v[28:29], v[30:31]
    v_cvt_pk_bf16_f32 v28, v28, v29
    ds_write_b32 v35, v28
    v_cndmask_b32 v29, 0, v28, s[64:65]
    v_dot2_f32_bf16 v33, v29, v61, 0
    v_dot2_f32_bf16 v32, v29, v29, 0
    v_lshlrev_b32 v2, 16, v28
    v_and_b32 v3, 0xffff0000, v28
    s_cmp_eq_u32 s55, 0
    v_permlane32_swap_b32 v33, v32
    v_add_f32 v33, v33, v32
    s_waitcnt lgkmcnt(0)
    s_barrier
    v_add_f32_dpp v33, v33, v33 row_ror:8 row_mask:0xf bank_mask:0xf
    s_nop 1
    v_add_f32_dpp v33, v33, v33 row_ror:4 row_mask:0xf bank_mask:0xf
    s_nop 1
    v_add_f32_dpp v33, v33, v33 row_ror:2 row_mask:0xf bank_mask:0xf
    s_nop 1
    v_add_f32_dpp v33, v33, v33 row_ror:1 row_mask:0xf bank_mask:0xf
    s_nop 1
    v_add_f32_dpp v33, v33, v33 row_bcast:15 row_mask:0xa bank_mask:0xf
    s_cbranch_scc1 L_gs_162
    buffer_store_dword v33, v34, s[40:43], s67 offen
L_gb_163:
    s_waitcnt vmcnt(1)
    s_branch L_se_151
.p2align 5
L_gs_167:
    buffer_store_dword v12, v11, s[40:43], s59 offen sc1
    s_branch L_gb_168
.p2align 5
L_gr_173:
    s_cbranch_scc1 L_gw_172
    s_waitcnt vmcnt(0)
    v_max3_u32 v32, v12, v13, v14
    v_max3_u32 v32, v32, v15, v16
    v_max3_u32 v32, v32, v17, v18
L_pad19:
    s_cbranch_execz L_pad23
    v_max3_u32 v32, v32, v19, v20
    v_max3_u32 v32, v32, v21, v22
    v_max3_u32 v32, v32, v23, v24
    v_max3_u32 v32, v32, v25, v26
    v_max_u32 v32, v32, v27
    v_cmp_eq_u32 vcc, -1, v32
    s_cbranch_vccnz L_gw_172
    v_pk_add_f32 v[28:29], v[12:13], v[36:37]
    v_pk_add_f32 v[30:31], v[14:15], v[38:39]
    v_pk_add_f32 v[28:29], v[28:29], v[16:17]
    v_pk_add_f32 v[30:31], v[30:31], v[18:19]
    v_pk_add_f32 v[28:29], v[28:29], v[20:21]
    v_pk_add_f32 v[30:31], v[30:31], v[22:23]
    v_pk_add_f32 v[28:29], v[28:29], v[24:25]
    v_pk_add_f32 v[30:31], v[30:31], v[26:27]
    s_nop 1
    v_permlane32_swap_b32 v28, v30
    v_permlane32_swap_b32 v29, v31
    s_branch L_gk_174
L_gr_176:
    s_cbranch_scc1 L_gw_175
    s_waitcnt vmcnt(0)
    v_max3_u32 v32, v12, v13, v14
    v_max3_u32 v32, v32, v15, v16
    v_max3_u32 v32, v32, v17, v18
    v_max3_u32 v32, v32, v19, v20
    v_max3_u32 v32, v32, v21, v22
    v_max3_u32 v32, v32, v23, v24
    v_max3_u32 v32, v32, v25, v26
    v_max_u32 v32, v32, v27
    v_cmp_eq_u32 vcc, -1, v32
    s_cbranch_vccnz L_gw_175
    v_pk_add_f32 v[28:29], v[12:13], v[36:37]
    v_pk_add_f32 v[30:31], v[14:15], v[38:39]
    v_pk_add_f32 v[28:29], v[28:29], v[16:17]
    v_pk_add_f32 v[30:31], v[30:31], v[18:19]
    v_pk_add_f32 v[28:29], v[28:29], v[20:21]
    v_pk_add_f32 v[30:31], v[30:31], v[22:23]
    v_pk_add_f32 v[28:29], v[28:29], v[24:25]
    v_pk_add_f32 v[30:31], v[30:31], v[26:27]
    s_nop 1
    v_permlane32_swap_b32 v28, v30
    v_permlane32_swap_b32 v29, v31
    s_branch L_gk_177
.p2align 5
L_gs_180:
    buffer_store_dword v33, v34, s[40:43], s67 offen sc1
    s_branch L_gb_181
.p2align 5
L_w7_164:
    v_and_b32 v60, 31, v0
    v_min_u32 v60, 19, v60
    s_mul_i32 s57, s54, 320
    v_lshrrev_b32 v5, 5, v0
    v_lshlrev_b32 v5, 12, v5
    v_add_u32 v5, s57, v5
    v_lshl_add_u32 v5, v60, 4, v5
    v_and_b32 v60, 31, v0
    v_cmp_gt_u32 s[64:65], 20, v60
    v_min_u32 v60, 19, v60
    v_lshrrev_b32 v35, 5, v0
    v_lshlrev_b32 v35, 2, v35
    v_add_u32 v35, 160832, v35
    v_lshl_add_u32 v35, v60, 3, v35
    s_mul_i32 s66, s53, 6144
    s_add_u32 s66, s66, s62
    s_add_u32 s66, s66, 46080
    s_lshl_b32 s67, s53, 6
    s_add_u32 s67, s67, s62
    s_add_u32 s67, s67, 25600
    s_lshl_b32 s57, s54, 3
    v_lshrrev_b32 v34, 5, v0
    v_lshlrev_b32 v34, 2, v34
    v_add_u32 v34, s57, v34
    v_and_b32 v60, 31, v0
    v_mov_b32 v61, 0x7f000000
    v_cmp_ne_u32 vcc, 31, v60
    s_nop 1
    v_cndmask_b32 v34, v34, v61, vcc
    v_mov_b32 v61, 0x3f803f80
    s_cmp_lg_u32 s53, 3
    s_cbranch_scc0 L_skip_169
    s_add_u32 s57, s62, 25856
    v_mov_b32 v9, 0
L_pr_171:
    buffer_load_dword v12, v9, s[40:43], s57 offen sc1
    s_sub_u32 s56, s56, 1
L_pad20:
    s_cbranch_execz L_pad24
    s_cbranch_scc1 L_done
L_pw_170:
    s_waitcnt vmcnt(0)
    v_cmp_eq_u32 vcc, -1, v12
    s_cbranch_vccnz L_pr_171
    s_add_u32 s57, s7, 0
    s_add_u32 s58, s7, 16384
    s_add_u32 s59, s7, 32768
    s_add_u32 s60, s7, 49152
    v_mov_b64 v[36:37], 0
    v_mov_b64 v[38:39], 0
    s_nop 0
    v_mov_b32_dpp v36, v2 quad_perm:[0,1,2,3] row_mask:0x3 bank_mask:0xf
    v_mov_b32_dpp v37, v3 quad_perm:[0,1,2,3] row_mask:0x3 bank_mask:0xf
    v_mov_b32_dpp v38, v2 quad_perm:[0,1,2,3] row_mask:0xc bank_mask:0xf
    v_mov_b32_dpp v39, v3 quad_perm:[0,1,2,3] row_mask:0xc bank_mask:0xf
L_gw_172:
    buffer_load_dwordx4 v[12:15], v5, s[40:43], s57 offen sc1
    buffer_load_dwordx4 v[16:19], v5, s[40:43], s58 offen sc1
    buffer_load_dwordx4 v[20:23], v5, s[40:43], s59 offen sc1
    buffer_load_dwordx4 v[24:27], v5, s[40:43], s60 offen sc1
    s_sub_u32 s56, s56, 1
    s_cbranch_scc1 L_done
    s_and_b32 s74, s56, 31
    s_waitcnt vmcnt(3)
    v_pk_add_f32 v[28:29], v[12:13], v[36:37]
    v_pk_add_f32 v[30:31], v[14:15], v[38:39]
    s_waitcnt vmcnt(2)
    v_pk_add_f32 v[28:29], v[28:29], v[16:17]
    v_pk_add_f32 v[30:31], v[30:31], v[18:19]
    s_waitcnt vmcnt(1)
    v_pk_add_f32 v[28:29], v[28:29], v[20:21]
    v_pk_add_f32 v[30:31], v[30:31], v[22:23]
    s_waitcnt vmcnt(0)
    v_pk_add_f32 v[28:29], v[28:29], v[24:25]
    v_pk_add_f32 v[30:31], v[30:31], v[26:27]
    v_pk_add_f32 v[32:33], v[28:29], v[30:31]
    v_cmp_u_f32 vcc, v32, v33
    v_permlane32_swap_b32 v28, v30
    v_permlane32_swap_b32 v29, v31
    s_cbranch_vccnz L_gr_173
L_gk_174:
    v_pk_add_f32 v[28:29], v[28:29], v[30:31]
    v_cvt_pk_bf16_f32 v28, v28, v29
    v_lshlrev_b32 v2, 16, v28
    v_and_b32 v3, 0xffff0000, v28
L_skip_169:
    s_lshl_b32 s74, s53, 7
    s_add_u32 s75, s62, s74
    s_add_u32 s75, s75, 26116
    v_mov_b32 v9, 0
    buffer_load_dword v12, v9, s[40:43], s75 offen sc1
    v_lshlrev_b32 v60, 16, v4
    v_add_f32 v2, v2, v60
    v_and_b32 v60, 0xffff0000, v4
    v_add_f32 v3, v3, v60
    s_add_u32 s57, s7, 66048
    s_add_u32 s58, s7, 82432
    s_add_u32 s59, s7, 98816
    s_add_u32 s60, s7, 115200
    v_mov_b64 v[36:37], 0
    v_mov_b64 v[38:39], 0
    s_nop 0
    v_mov_b32_dpp v36, v2 quad_perm:[0,1,2,3] row_mask:0x3 bank_mask:0xf
    v_mov_b32_dpp v37, v3 quad_perm:[0,1,2,3] row_mask:0x3 bank_mask:0xf
    v_mov_b32_dpp v38, v2 quad_perm:[0,1,2,3] row_mask:0xc bank_mask:0xf
    v_mov_b32_dpp v39, v3 quad_perm:[0,1,2,3] row_mask:0xc bank_mask:0xf
L_pr_179:
    buffer_load_dword v12, v9, s[40:43], s75 offen sc1
    s_sub_u32 s56, s56, 1
    s_cbranch_scc1 L_done
L_pw_178:
    s_waitcnt vmcnt(1)
    v_cmp_eq_u32 vcc, -1, v12
    s_cbranch_vccnz L_pr_179
L_gw_175:
    buffer_load_dwordx4 v[12:15], v5, s[40:43], s57 offen sc1
    buffer_load_dwordx4 v[16:19], v5, s[40:43], s58 offen sc1
    buffer_load_dwordx4 v[20:23], v5, s[40:43], s59 offen sc1
    buffer_load_dwordx4 v[24:27], v5, s[40:43], s60 offen sc1
    s_sub_u32 s56, s56, 1
    s_cbranch_scc1 L_done
    s_and_b32 s74, s56, 31
    s_waitcnt vmcnt(3)
    v_pk_add_f32 v[28:29], v[12:13], v[36:37]
    v_pk_add_f32 v[30:31], v[14:15], v[38:39]
    s_waitcnt vmcnt(2)
    v_pk_add_f32 v[28:29], v[28:29], v[16:17]
    v_pk_add_f32 v[30:31], v[30:31], v[18:19]
    s_waitcnt vmcnt(1)
    v_pk_add_f32 v[28:29], v[28:29], v[20:21]
L_pad21:
    s_cbranch_execz L_pad25
    v_pk_add_f32 v[30:31], v[30:31], v[22:23]
    s_waitcnt vmcnt(0)
    v_pk_add_f32 v[28:29], v[28:29], v[24:25]
    v_pk_add_f32 v[30:31], v[30:31], v[26:27]
    v_pk_add_f32 v[32:33], v[28:29], v[30:31]
    v_cmp_u_f32 vcc, v32, v33
    v_permlane32_swap_b32 v28, v30
    v_permlane32_swap_b32 v29, v31
    s_cbranch_vccnz L_gr_176
L_gk_177:
    v_pk_add_f32 v[28:29], v[28:29], v[30:31]
    v_cvt_pk_bf16_f32 v28, v28, v29
    ds_write_b32 v35, v28
    v_cndmask_b32 v29, 0, v28, s[64:65]
    v_dot2_f32_bf16 v33, v29, v61, 0
    v_dot2_f32_bf16 v32, v29, v29, 0
    v_lshlrev_b32 v2, 16, v28
    v_and_b32 v3, 0xffff0000, v28
    s_cmp_eq_u32 s55, 0
    v_permlane32_swap_b32 v33, v32
    v_add_f32 v33, v33, v32
    s_waitcnt lgkmcnt(0)
    s_barrier
    v_add_f32_dpp v33, v33, v33 row_ror:8 row_mask:0xf bank_mask:0xf
    s_nop 1
    v_add_f32_dpp v33, v33, v33 row_ror:4 row_mask:0xf bank_mask:0xf
    s_nop 1
    v_add_f32_dpp v33, v33, v33 row_ror:2 row_mask:0xf bank_mask:0xf
    s_nop 1
    v_add_f32_dpp v33, v33, v33 row_ror:1 row_mask:0xf bank_mask:0xf
    s_nop 1
    v_add_f32_dpp v33, v33, v33 row_bcast:15 row_mask:0xa bank_mask:0xf
    s_cbranch_scc1 L_gs_180
    buffer_store_dword v33, v34, s[40:43], s67 offen
L_gb_181:
    s_waitcnt vmcnt(1)
    s_branch L_se_165
.p2align 5
L_hr_186:
    buffer_load_dwordx4 v[40:43], v7, s[40:43], s59 offen offset:0 sc1
    buffer_load_dwordx4 v[44:47], v7, s[40:43], s59 offen offset:1024 sc1
    s_sub_u32 s56, s56, 1
    s_cbranch_scc1 L_done
    s_and_b32 s64, s56, 31
    s_cbranch_scc0 L_hx_188
    s_waitcnt vmcnt(2)
    v_pk_add_f32 v[20:21], v[40:41], v[44:45]
    v_pk_add_f32 v[22:23], v[42:43], v[46:47]
    s_nop 1
    v_permlane32_swap_b32 v20, v22
    v_permlane32_swap_b32 v21, v23
    v_pk_add_f32 v[20:21], v[20:21], v[22:23]
    s_nop 1
    v_permlane16_swap_b32 v20, v21
    v_add_f32 v20, v20, v21
    v_cmp_u_f32 vcc, v20, v20
    v_sub_f32 v20, v20, v50
    s_cbranch_vccnz L_hr_186
    s_branch L_hk_187
.p2align 5
L_hx_188:
    s_waitcnt vmcnt(0)
    v_max3_u32 v20, v40, v41, v42
    v_max3_u32 v20, v20, v43, v44
    v_max3_u32 v20, v20, v45, v46
    v_max_u32 v20, v20, v47
    v_cmp_eq_u32 vcc, -1, v20
    s_cbranch_vccnz L_hr_186
    v_pk_add_f32 v[20:21], v[40:41], v[44:45]
    v_pk_add_f32 v[22:23], v[42:43], v[46:47]
    s_nop 1
    v_permlane32_swap_b32 v20, v22
    v_permlane32_swap_b32 v21, v23
    v_pk_add_f32 v[20:21], v[20:21], v[22:23]
    s_nop 1
    v_permlane16_swap_b32 v20, v21
    v_add_f32 v20, v20, v21
    v_sub_f32 v20, v20, v50
    s_branch L_hk_187
L_qo_182:
    v_mov_b64 v[24:25], 0
    v_mov_b64 v[26:27], 0
    v_mov_b64 v[28:29], 0
    v_mov_b64 v[30:31], 0
    v_mov_b64 v[32:33], 0
    v_mov_b64 v[34:35], 0
    v_mov_b64 v[36:37], 0
    v_mov_b64 v[38:39], 0
    v_lshrrev_b32 v5, 4, v0
    v_lshlrev_b32 v5, 5, v5
    v_bfe_u32 v60, v0, 1, 1
    v_lshl_add_u32 v5, v60, 4, v5
    v_add_u32 v5, 124928, v5
L_pad22:
    s_cbranch_execz L_padback
    s_branch L_qb_183
.p2align 5
L_mr_189:
    ds_read_b32 v36, v62
    s_sub_u32 s56, s56, 1
    s_cbranch_scc1 L_done
    s_waitcnt lgkmcnt(0)
    v_cmp_eq_u32 vcc, -1, v36
    s_cbranch_vccnz L_mr_189
    v_max_f32_dpp v37, v36, v36 row_ror:4 row_mask:0xf bank_mask:0xf
    s_nop 1
    v_max_f32_dpp v37, v37, v37 row_ror:2 row_mask:0xf bank_mask:0xf
    s_nop 1
    v_max_f32_dpp v37, v37, v37 row_ror:1 row_mask:0xf bank_mask:0xf
    v_sub_f32 v39, v61, v37
    v_exp_f32 v39, v39
    s_branch L_mk_190
.p2align 5
L_gs_191:
    buffer_store_dword v37, v4, s[40:43], s58 offen sc1
    s_branch L_gb_192
.p2align 5
L_gs_193:
    buffer_store_dword v14, v3, s[40:43], s57 offen sc1
    s_branch L_gb_194
.p2align 5
L_gs_195:
    buffer_store_dword v12, v4, s[40:43], s57 offen offset:32 sc1
    s_branch L_gb_196
.p2align 5
L_comb_1:
    s_mov_b32 s58, 26624
    s_cmp_eq_u32 s55, 0
    s_cbranch_scc1 L_gs_191
    buffer_store_dword v37, v4, s[40:43], s58 offen
L_gb_192:
    s_mov_b32 s57, 26624
    s_cmp_eq_u32 s55, 0
    s_waitcnt lgkmcnt(0)
    s_barrier
    ds_read2st64_b64 v[12:15], v2 offset0:0 offset1:4
    ds_read2st64_b64 v[16:19], v2 offset0:8 offset1:12
    ds_read2st64_b64 v[20:23], v2 offset0:16 offset1:20
    ds_read2st64_b64 v[24:27], v2 offset0:24 offset1:28
    s_waitcnt lgkmcnt(2)
    v_pk_add_f32 v[12:13], v[12:13], v[14:15]
    v_pk_add_f32 v[16:17], v[16:17], v[18:19]
    v_pk_add_f32 v[12:13], v[12:13], v[16:17]
    s_waitcnt lgkmcnt(0)
    v_pk_add_f32 v[20:21], v[20:21], v[22:23]
    v_pk_add_f32 v[24:25], v[24:25], v[26:27]
    v_pk_add_f32 v[12:13], v[12:13], v[20:21]
    v_pk_add_f32 v[12:13], v[12:13], v[24:25]
    v_cvt_pk_bf16_f32 v14, v12, v13
    v_min_u32 v14, -2, v14
    s_cbranch_scc1 L_gs_193
    buffer_store_dword v14, v3, s[40:43], s57 offen
L_gb_194:
    s_cbranch_scc1 L_gs_195
    buffer_store_dword v12, v4, s[40:43], s57 offen offset:32
L_gb_196:
    s_branch L_comb_1b
.p2align 5
L_sr_206:
    buffer_load_dwordx4 v[52:55], v11, s[40:43], s65 offen offset:0 sc1
    buffer_load_dwordx4 v[56:59], v11, s[40:43], s65 offen offset:1024 sc1
    s_sub_u32 s56, s56, 1
    s_cbranch_scc1 L_done
    s_waitcnt vmcnt(0)
    s_branch L_sw_205
L_hr_207:
    buffer_load_dwordx4 v[12:15], v11, s[40:43], s58 offen offset:0 sc1
    buffer_load_dwordx4 v[16:19], v11, s[40:43], s58 offen offset:1024 sc1
    s_sub_u32 s56, s56, 1
    s_cbranch_scc1 L_done
    s_and_b32 s64, s56, 31
    s_cbranch_scc0 L_hx_209
    s_waitcnt vmcnt(2)
    v_pk_add_f32 v[20:21], v[12:13], v[16:17]
    v_pk_add_f32 v[22:23], v[14:15], v[18:19]
    s_nop 1
    v_permlane32_swap_b32 v20, v22
    v_permlane32_swap_b32 v21, v23
L_pad23:
    s_cbranch_execz L_padback
    v_pk_add_f32 v[20:21], v[20:21], v[22:23]
    s_nop 1
    v_permlane16_swap_b32 v20, v21
    v_add_f32 v20, v20, v21
    v_cmp_u_f32 vcc, v20, v20
    v_sub_f32 v20, v20, v26
    s_cbranch_vccnz L_hr_207
    s_branch L_hk_208
.p2align 5
L_hx_209:
    s_waitcnt vmcnt(0)
    v_max3_u32 v20, v12, v13, v14
    v_max3_u32 v20, v20, v15, v16
    v_max3_u32 v20, v20, v17, v18
    v_max_u32 v20, v20, v19
    v_cmp_eq_u32 vcc, -1, v20
    s_cbranch_vccnz L_hr_207
    v_pk_add_f32 v[20:21], v[12:13], v[16:17]
    v_pk_add_f32 v[22:23], v[14:15], v[18:19]
    s_nop 1
    v_permlane32_swap_b32 v20, v22
    v_permlane32_swap_b32 v21, v23
    v_pk_add_f32 v[20:21], v[20:21], v[22:23]
    s_nop 1
    v_permlane16_swap_b32 v20, v21
    v_add_f32 v20, v20, v21
    v_sub_f32 v20, v20, v26
    s_branch L_hk_208
L_typeC_212:
    s_cmp_eq_u32 s30, 6
    s_cbranch_scc0 L_done
    s_cmp_eq_u32 s3, 20
    s_cbranch_scc0 L_done
    s_lshl_b32 s59, s31, 9
    s_add_u32 s59, s59, s8
    s_add_u32 s59, s59, 266240
    v_and_b32 v10, 1, v0
    v_lshlrev_b32 v10, 13, v10
    v_lshrrev_b32 v60, 1, v0
    v_lshl_add_u32 v10, v60, 24, v10
    s_add_u32 s58, s62, 28192
    v_lshrrev_b32 v9, 3, v0
    v_mul_u32_u24 v9, 1664, v9
    v_and_b32 v60, 7, v0
    v_lshl_add_u32 v9, v60, 2, v9
L_pr_214:
    buffer_load_dword v12, v9, s[40:43], s58 offen sc1
    s_sub_u32 s56, s56, 1
    s_cbranch_scc1 L_done
L_pw_213:
    s_waitcnt vmcnt(0)
    v_cmp_eq_u32 vcc, -1, v12
    s_cbranch_vccnz L_pr_214
    buffer_store_dword v0, v10, s[40:43], s59 offen offset:8 sc1
    s_add_u32 s58, s62, 25984
    v_and_b32 v9, 15, v0
    v_lshlrev_b32 v9, 2, v9
L_pr_216:
    buffer_load_dword v13, v9, s[40:43], s58 offen sc1
    s_sub_u32 s56, s56, 1
    s_cbranch_scc1 L_done
L_pw_215:
    s_waitcnt vmcnt(0)
    v_cmp_eq_u32 vcc, -1, v13
    s_cbranch_vccnz L_pr_216
    buffer_store_dword v0, v10, s[40:43], s59 offen offset:12 sc1
    s_waitcnt vmcnt(1)
    s_branch L_done
.p2align 5
L_gs_220:
    buffer_store_dword v12, v11, s[40:43], s59 offen sc1
    s_branch L_gb_221
.p2align 5
L_gr_223:
    s_cbranch_scc1 L_gw_222
    s_waitcnt vmcnt(0)
    v_max3_u32 v32, v12, v13, v14
    v_max3_u32 v32, v32, v15, v16
    v_max3_u32 v32, v32, v17, v18
    v_max3_u32 v32, v32, v19, v20
    v_max3_u32 v32, v32, v21, v22
    v_max3_u32 v32, v32, v23, v24
    v_max3_u32 v32, v32, v25, v26
    v_max_u32 v32, v32, v27
    v_cmp_eq_u32 vcc, -1, v32
    s_cbranch_vccnz L_gw_222
    v_pk_add_f32 v[28:29], v[12:13], v[36:37]
    v_pk_add_f32 v[30:31], v[14:15], v[38:39]
    v_pk_add_f32 v[28:29], v[28:29], v[16:17]
    v_pk_add_f32 v[30:31], v[30:31], v[18:19]
    v_pk_add_f32 v[28:29], v[28:29], v[20:21]
    v_pk_add_f32 v[30:31], v[30:31], v[22:23]
    v_pk_add_f32 v[28:29], v[28:29], v[24:25]
L_pad24:
    s_cbranch_execz L_padback
    v_pk_add_f32 v[30:31], v[30:31], v[26:27]
    s_nop 1
    v_permlane32_swap_b32 v28, v30
    v_permlane32_swap_b32 v29, v31
    s_branch L_gk_224
L_gs_227:
    buffer_store_dword v33, v34, s[40:43], s67 offen sc1
    s_branch L_gb_228
.p2align 5
L_w7_217:
    v_and_b32 v60, 31, v0
    v_min_u32 v60, 19, v60
    s_mul_i32 s57, s54, 320
    v_lshrrev_b32 v5, 5, v0
    v_lshlrev_b32 v5, 12, v5
    v_add_u32 v5, s57, v5
    v_lshl_add_u32 v5, v60, 4, v5
    v_and_b32 v60, 31, v0
    v_cmp_gt_u32 s[64:65], 20, v60
    v_min_u32 v60, 19, v60
    v_lshrrev_b32 v35, 5, v0
    v_lshlrev_b32 v35, 2, v35
    v_add_u32 v35, 160832, v35
    v_lshl_add_u32 v35, v60, 3, v35
    s_add_u32 s66, s62, 39936
    s_add_u32 s67, s62, 25984
    s_lshl_b32 s57, s54, 3
    v_lshrrev_b32 v34, 5, v0
    v_lshlrev_b32 v34, 2, v34
    v_add_u32 v34, s57, v34
    v_and_b32 v60, 31, v0
    v_mov_b32 v61, 0x7f000000
    v_cmp_ne_u32 vcc, 31, v60
    s_nop 1
    v_cndmask_b32 v34, v34, v61, vcc
    v_mov_b32 v61, 0x3f803f80
    s_add_u32 s57, s7, 132096
    s_add_u32 s58, s7, 148480
    s_add_u32 s59, s7, 164864
    s_add_u32 s60, s7, 181248
    v_mov_b64 v[36:37], 0
    v_mov_b64 v[38:39], 0
    s_nop 0
    v_mov_b32_dpp v36, v2 quad_perm:[0,1,2,3] row_mask:0x3 bank_mask:0xf
    v_mov_b32_dpp v37, v3 quad_perm:[0,1,2,3] row_mask:0x3 bank_mask:0xf
    v_mov_b32_dpp v38, v2 quad_perm:[0,1,2,3] row_mask:0xc bank_mask:0xf
    v_mov_b32_dpp v39, v3 quad_perm:[0,1,2,3] row_mask:0xc bank_mask:0xf
    s_add_u32 s75, s7, 266248
    v_and_b32 v9, 7, v0
    v_lshlrev_b32 v9, 9, v9
L_pr_226:
    buffer_load_dword v12, v9, s[40:43], s75 offen sc1
    s_sub_u32 s56, s56, 1
    s_cbranch_scc1 L_done
L_pw_225:
    s_waitcnt vmcnt(0)
    v_cmp_eq_u32 vcc, -1, v12
    s_cbranch_vccnz L_pr_226
L_gw_222:
    buffer_load_dwordx4 v[12:15], v5, s[40:43], s57 offen sc1
    buffer_load_dwordx4 v[16:19], v5, s[40:43], s58 offen sc1
    buffer_load_dwordx4 v[20:23], v5, s[40:43], s59 offen sc1
    buffer_load_dwordx4 v[24:27], v5, s[40:43], s60 offen sc1
    s_sub_u32 s56, s56, 1
    s_cbranch_scc1 L_done
    s_and_b32 s74, s56, 31
    s_waitcnt vmcnt(3)
    v_pk_add_f32 v[28:29], v[12:13], v[36:37]
    v_pk_add_f32 v[30:31], v[14:15], v[38:39]
    s_waitcnt vmcnt(2)
    v_pk_add_f32 v[28:29], v[28:29], v[16:17]
    v_pk_add_f32 v[30:31], v[30:31], v[18:19]
    s_waitcnt vmcnt(1)
    v_pk_add_f32 v[28:29], v[28:29], v[20:21]
    v_pk_add_f32 v[30:31], v[30:31], v[22:23]
    s_waitcnt vmcnt(0)
    v_pk_add_f32 v[28:29], v[28:29], v[24:25]
    v_pk_add_f32 v[30:31], v[30:31], v[26:27]
    v_pk_add_f32 v[32:33], v[28:29], v[30:31]
    v_cmp_u_f32 vcc, v32, v33
    v_permlane32_swap_b32 v28, v30
    v_permlane32_swap_b32 v29, v31
    s_cbranch_vccnz L_gr_223
L_gk_224:
    v_pk_add_f32 v[28:29], v[28:29], v[30:31]
    v_cvt_pk_bf16_f32 v28, v28, v29
    ds_write_b32 v35, v28
    v_cndmask_b32 v29, 0, v28, s[64:65]
    v_dot2_f32_bf16 v33, v29, v61, 0
L_pad25:
    s_cbranch_execz L_padback
    v_dot2_f32_bf16 v32, v29, v29, 0
    v_lshlrev_b32 v2, 16, v28
    v_and_b32 v3, 0xffff0000, v28
    s_cmp_eq_u32 s55, 0
    v_permlane32_swap_b32 v33, v32
    v_add_f32 v33, v33, v32
    s_waitcnt lgkmcnt(0)
    s_barrier
    v_add_f32_dpp v33, v33, v33 row_ror:8 row_mask:0xf bank_mask:0xf
    s_nop 1
    v_add_f32_dpp v33, v33, v33 row_ror:4 row_mask:0xf bank_mask:0xf
    s_nop 1
    v_add_f32_dpp v33, v33, v33 row_ror:2 row_mask:0xf bank_mask:0xf
    s_nop 1
    v_add_f32_dpp v33, v33, v33 row_ror:1 row_mask:0xf bank_mask:0xf
    s_nop 1
    v_add_f32_dpp v33, v33, v33 row_bcast:15 row_mask:0xa bank_mask:0xf
    s_cbranch_scc1 L_gs_227
    buffer_store_dword v33, v34, s[40:43], s67 offen
L_gb_228:
    s_waitcnt vmcnt(1)
    s_branch L_se_218
.p2align 5
L_gr_230:
    s_cbranch_scc1 L_gw_229
    s_waitcnt vmcnt(0)
    v_max3_u32 v32, v12, v13, v14
    v_max3_u32 v32, v32, v15, v16
    v_max3_u32 v32, v32, v17, v18
    v_max3_u32 v32, v32, v19, v20
    v_max3_u32 v32, v32, v21, v22
    v_max3_u32 v32, v32, v23, v24
    v_max3_u32 v32, v32, v25, v26
    v_max_u32 v32, v32, v27
    v_cmp_eq_u32 vcc, -1, v32
    s_cbranch_vccnz L_gw_229
    v_pk_add_f32 v[28:29], v[12:13], v[36:37]
    v_pk_add_f32 v[30:31], v[14:15], v[38:39]
    v_pk_add_f32 v[28:29], v[28:29], v[16:17]
    v_pk_add_f32 v[30:31], v[30:31], v[18:19]
    v_pk_add_f32 v[28:29], v[28:29], v[20:21]
    v_pk_add_f32 v[30:31], v[30:31], v[22:23]
    v_pk_add_f32 v[28:29], v[28:29], v[24:25]
    v_pk_add_f32 v[30:31], v[30:31], v[26:27]
    s_nop 1
    v_permlane32_swap_b32 v28, v30
    v_permlane32_swap_b32 v29, v31
    s_branch L_gk_231
L_tail_end:
.p2align 5
L_spread:
    s_add_u32 s62, s62, 966656
    s_cmp_eq_u32 s30, 5
    s_cbranch_scc0 L_skip_67
    v_mov_b64 v[12:13], -1
    v_mov_b64 v[14:15], -1
    v_lshlrev_b32 v16, 4, v0
    s_mul_i32 s57, s52, 2208
    s_add_u32 s57, s57, s62
    s_mov_b64 exec, 0x3ff
    buffer_store_dwordx4 v[12:15], v16, s[40:43], s57 offen offset:2048 sc1
    s_mov_b64 exec, -1
    buffer_store_dwordx4 v[12:15], v16, s[40:43], s57 offen offset:0 sc1
    buffer_store_dwordx4 v[12:15], v16, s[40:43], s57 offen offset:1024 sc1
L_skip_67:
    s_cmp_eq_u32 s30, 7
    s_cbranch_scc0 L_skip_68
    v_and_b32 v60, 31, v0
    v_cmp_gt_u32 s[64:65], 20, v60
    v_min_u32 v60, 19, v60
    v_lshrrev_b32 v35, 5, v0
    v_lshlrev_b32 v35, 2, v35
    v_add_u32 v35, 160832, v35
    v_lshl_add_u32 v35, v60, 3, v35
    s_mul_i32 s66, s53, 12416
    s_add_u32 s66, s66, s62
    s_add_u32 s66, s66, 70656
    s_add_u32 s67, s66, 12288
    s_lshl_b32 s57, s54, 3
    v_lshrrev_b32 v34, 5, v0
    v_lshlrev_b32 v34, 2, v34
    v_add_u32 v34, s57, v34
    v_and_b32 v60, 31, v0
    v_mov_b32 v61, 0x7f000000
    v_cmp_ne_u32 vcc, 31, v60
    s_nop 1
    v_cndmask_b32 v34, v34, v61, vcc
    v_mov_b32 v61, 0x3f803f80
    v_cvt_pk_bf16_f32 v28, v2, v3
L_skip_68:
    s_cmp_eq_u32 s30, 7
    s_cbranch_scc0 L_skip_69
    v_cndmask_b32 v29, 0, v28, s[64:65]
    v_dot2_f32_bf16 v33, v29, v61, 0
    v_dot2_f32_bf16 v32, v29, v29, 0
    v_lshlrev_b32 v2, 16, v28
    v_and_b32 v3, 0xffff0000, v28
    s_cmp_eq_u32 s55, 0
    v_permlane32_swap_b32 v33, v32
    v_add_f32 v33, v33, v32
    s_nop 1
    v_add_f32_dpp v33, v33, v33 row_ror:8 row_mask:0xf bank_mask:0xf
    s_nop 1
    v_add_f32_dpp v33, v33, v33 row_ror:4 row_mask:0xf bank_mask:0xf
    s_nop 1
    v_add_f32_dpp v33, v33, v33 row_ror:2 row_mask:0xf bank_mask:0xf
    s_nop 1
    v_add_f32_dpp v33, v33, v33 row_ror:1 row_mask:0xf bank_mask:0xf
    s_nop 1
    v_add_f32_dpp v33, v33, v33 row_bcast:15 row_mask:0xa bank_mask:0xf
    s_cbranch_scc1 L_gs_70
    buffer_store_dword v33, v34, s[40:43], s67 offen
L_gb_71:
    s_waitcnt vmcnt(1)
L_skip_69:
    s_cmp_lt_u32 s30, 6
    s_cbranch_scc0 L_skip_72
    s_lshr_b32 s57, s30, 1
    s_mul_i32 s57, s57, 1024
    s_and_b32 s58, s30, 1
    s_lshl_b32 s58, s58, 6
    s_add_u32 s57, s57, s58
    v_lshrrev_b32 v18, 5, v0
    v_mul_u32_u24 v18, 6144, v18
    v_bfe_u32 v60, v0, 3, 1
    v_mul_u32_u24 v60, 3072, v60
    v_add_u32 v18, v60, v18
    v_bfe_u32 v60, v0, 4, 1
    v_lshl_add_u32 v18, v60, 9, v18
    v_bfe_u32 v60, v0, 2, 1
    v_lshl_add_u32 v18, v60, 7, v18
    v_and_b32 v60, 3, v0
    v_lshl_add_u32 v18, v60, 3, v18
    v_add_u32 v18, s57, v18
    v_bfe_u32 v19, v0, 4, 1
    v_mul_u32_u24 v19, 3072, v19
    v_bfe_u32 v60, v0, 3, 1
    v_lshl_add_u32 v19, v60, 9, v19
    v_bfe_u32 v60, v0, 2, 1
    v_lshl_add_u32 v19, v60, 7, v19
    v_and_b32 v60, 3, v0
    v_lshl_add_u32 v19, v60, 3, v19
    v_add_u32 v19, s57, v19
    v_add_u32 v19, 24576, v19
    ds_read_b64_tr_b16 v[28:29], v18 offset:0
    ds_read_b64_tr_b16 v[30:31], v18 offset:256
    ds_read_b64_tr_b16 v[32:33], v18 offset:12288
    ds_read_b64_tr_b16 v[34:35], v18 offset:12544
    ds_read_b64_tr_b16 v[36:37], v19 offset:0
    ds_read_b64_tr_b16 v[38:39], v19 offset:256
    ds_read_b64_tr_b16 v[40:41], v18 offset:32
    ds_read_b64_tr_b16 v[42:43], v18 offset:288
    ds_read_b64_tr_b16 v[44:45], v18 offset:12320
    ds_read_b64_tr_b16 v[46:47], v18 offset:12576
    ds_read_b64_tr_b16 v[48:49], v19 offset:32
    ds_read_b64_tr_b16 v[50:51], v19 offset:288
    v_lshrrev_b32 v52, 4, v0
    v_lshlrev_b32 v52, 5, v52
    v_bfe_u32 v60, v0, 1, 1
    v_lshl_add_u32 v52, v60, 4, v52
    v_and_b32 v60, 1, v0
    v_mul_u32_u24 v60, 192, v60
    v_add_u32 v52, v60, v52
    v_add_u32 v52, 160832, v52
    v_lshrrev_b32 v53, 4, v0
    v_lshlrev_b32 v53, 4, v53
    v_bfe_u32 v60, v0, 1, 1
    v_lshl_add_u32 v53, v60, 3, v53
    v_and_b32 v60, 1, v0
    v_mul_u32_u24 v60, 192, v60
    v_add_u32 v53, v60, v53
    v_add_u32 v53, 160960, v53
    v_mov_b64 v[20:21], 0
    v_mov_b64 v[22:23], 0
    v_mov_b64 v[24:25], 0
    v_mov_b64 v[26:27], 0
    s_lshr_b32 s57, s30, 1
    s_lshl_b32 s57, s57, 11
    s_lshl_b32 s58, s58, 1
    s_add_u32 s57, s57, s58
    s_lshl_b32 s58, s54, 8
    s_add_u32 s57, s57, s58
    v_and_b32 v54, 31, v0
    v_lshlrev_b32 v54, 2, v54
    v_lshrrev_b32 v60, 5, v0
    v_mul_u32_u24 v60, 6144, v60
    v_add_u32 v54, v60, v54
    v_add_u32 v54, s57, v54
    s_mul_i32 s59, s53, 12416
    s_add_u32 s59, s59, s62
    s_add_u32 s59, s59, 70656
    s_add_u32 s60, s59, 12288
    ds_read_b128 v[12:15], v52
    ds_read_b64 v[16:17], v53
    s_waitcnt lgkmcnt(1)
    v_smfmac_f32_16x16x64_bf16 v[20:23], v[12:15], v[28:35], v1
    v_smfmac_f32_16x16x64_bf16 v[24:27], v[12:15], v[40:47], v1
    s_waitcnt lgkmcnt(0)
    v_smfmac_f32_16x16x32_bf16 v[20:23], v[16:17], v[36:39], v1
    v_smfmac_f32_16x16x32_bf16 v[24:27], v[16:17], v[48:51], v1
    s_cmp_eq_u32 s55, 0
    s_nop 5
    v_add_f32 v12, v20, v22
    s_nop 1
    v_add_f32_dpp v12, v24, v26 quad_perm:[0,1,2,3] row_mask:0x2 bank_mask:0xf
    s_nop 1
    v_add_f32_dpp v12, v21, v23 quad_perm:[0,1,2,3] row_mask:0x4 bank_mask:0xf
    s_nop 1
    v_add_f32_dpp v12, v25, v27 quad_perm:[0,1,2,3] row_mask:0x8 bank_mask:0xf
    s_cbranch_scc1 L_gs_73
    buffer_store_dword v12, v54, s[40:43], s59 offen
L_gb_74:
L_skip_72:
    s_waitcnt vmcnt(0)
    s_barrier
    s_cmp_eq_u32 s30, 5
    s_cbranch_scc0 L_skip_75
    v_mov_b32 v25, 0
    s_lshl_b32 s57, s52, 2
    s_add_u32 s57, s57, s72
    s_mov_b64 exec, 1
    buffer_store_dword v25, v0, s[40:43], s57 offen offset:256 sc1
    s_mov_b64 exec, -1
    v_and_b32 v16, 31, v0
    v_lshlrev_b32 v16, 2, v16
L_pr_77:
    buffer_load_dword v17, v16, s[40:43], s72 offen offset:256 sc1
    s_sub_u32 s56, s56, 1
    s_cbranch_scc1 L_done
L_pw_76:
    s_waitcnt vmcnt(0)
    v_cmp_eq_u32 vcc, -1, v17
    s_cbranch_vccnz L_pr_77
L_skip_75:
    s_barrier
    s_branch L_spread_back
.p2align 5
L_done:
L_exit:
    s_endpgm
.section .rodata,"a"
.p2align 6
.amdhsa_kernel interleave_layers__sliding_block_cached__dense_activation_gelu__decode_kernel
  .amdhsa_next_free_vgpr 256
  .amdhsa_next_free_sgpr 102
  .amdhsa_accum_offset 256
  .amdhsa_group_segment_fixed_size 0
  .amdhsa_kernarg_size 104
  .amdhsa_user_sgpr_count 2
  .amdhsa_user_sgpr_kernarg_segment_ptr 1
  .amdhsa_system_sgpr_workgroup_id_x 1
  .amdhsa_float_denorm_mode_32 3
.end_amdhsa_kernel
```

```asm
; @launch grid=(256,1,1) block=(512,1,1) lds=161216
.amdgcn_target "amdgcn-amd-amdhsa--gfx950"
.text
.fill 64, 4, 0xbf800000
.globl interleave_layers__sliding_block_cached__dense_activation_gelu__decode_kernel
.p2align 8
.type interleave_layers__sliding_block_cached__dense_activation_gelu__decode_kernel,@function
interleave_layers__sliding_block_cached__dense_activation_gelu__decode_kernel:
    s_load_dwordx16 s[4:19], s[0:1], 0
    s_cmp_ge_u32 s2, 256
    s_cbranch_scc1 L_exit
    v_lshrrev_b32 v5, 6, v0
    v_lshlrev_b32 v62, 6, v0
    v_readfirstlane_b32 s30, v5
    v_and_b32 v0, 63, v0
    s_getpc_b64 s[74:75]
L_pc:
    v_min_u32 v62, L_exit-L_pc, v62
    global_load_dword v63, v62, s[74:75]
    s_cmp_eq_u32 s30, 6
    s_cbranch_scc0 L_skip_1
    s_setprio 3
L_skip_1:
    s_and_b32 s31, s2, 7
    s_lshr_b32 s52, s2, 3
    s_and_b32 s53, s52, 3
    s_lshr_b32 s54, s52, 2
    s_lshl_b32 s73, s31, 2
    s_add_u32 s73, s73, s53
    v_lshrrev_b32 v8, 5, v0
    v_lshlrev_b32 v8, 2, v8
    v_bfe_u32 v60, v0, 4, 1
    v_lshl_add_u32 v8, v60, 0, v8
    v_and_b32 v9, 7, v0
    v_xor_b32 v8, v8, v9
    v_lshrrev_b32 v10, 3, v0
    v_mul_u32_u24 v10, 384, v10
    v_lshl_add_u32 v5, v8, 4, v10
    v_xor_b32 v6, 32, v5
    s_mul_i32 s64, s73, 12582912
    s_mul_i32 s58, s54, 3072
    s_add_u32 s64, s64, s58
    s_add_u32 s64, s64, 11010048
    s_sub_u32 s34, 1572864, s58
    s_mov_b32 s35, 0x20000
    s_mov_b32 s57, 0
    s_mov_b32 s58, 195584
    s_mov_b32 m0, 92160
    s_cmp_eq_u32 s30, 6
    s_cselect_b64 vcc, -1, 0
    s_waitcnt lgkmcnt(0)
    s_add_u32 s32, s6, s64
    s_addc_u32 s33, s7, 0
    s_load_dwordx8 s[20:27], s[0:1], 64
    s_load_dwordx2 s[28:29], s[0:1], 96
    s_cbranch_vccz L_skip_3
L_dma_2:
    buffer_load_dwordx4 v5, s[32:35], s57 offen offset:0 nt lds
    buffer_load_dwordx4 v6, s[32:35], s58 offen offset:1024 nt lds
    s_add_u32 s57, s57, 24576
    s_add_u32 s58, s58, 24576
    s_add_u32 m0, m0, 2048
    s_cmp_lg_u32 m0, 108544
    s_cbranch_scc1 L_dma_2
    s_mov_b32 s57, 128
    s_mov_b32 s58, 195712
    s_mov_b32 m0, 108544
L_dma_4:
    s_nop 0
    buffer_load_dwordx4 v5, s[32:35], s57 offen offset:0 nt lds
    buffer_load_dwordx4 v6, s[32:35], s58 offen offset:1024 nt lds
    s_add_u32 s57, s57, 24576
    s_add_u32 s58, s58, 24576
    s_add_u32 m0, m0, 2048
    s_cmp_lg_u32 m0, 116736
    s_cbranch_scc1 L_dma_4
L_skip_3:
    s_mul_i32 s3, s54, 3
    s_add_u32 s3, s3, s53
    s_cmp_eq_u32 s53, 3
    s_cselect_b32 s3, 31, s3
    v_lshrrev_b32 v8, 4, v0
    v_lshlrev_b32 v8, 1, v8
    v_xor_b32 v8, v8, v9
    v_lshl_add_u32 v7, v8, 4, v10
    v_lshrrev_b32 v2, 3, v0
    v_mul_u32_u24 v2, 12288, v2
    v_and_b32 v60, 7, v0
    v_lshl_add_u32 v2, v60, 4, v2
    s_mul_i32 s59, s73, 384
    s_mul_i32 s60, s54, 983040
    s_add_u32 s59, s59, s60
    s_sub_u32 s60, 7866368, s59
    s_lshl_b32 s61, s30, 11
    s_add_u32 s61, s61, 92160
    s_mul_i32 s62, s31, 120832
    s_add_u32 s62, s62, 299008
    s_lshl_b32 s72, s31, 9
    s_add_u32 s72, s72, 294912
    s_mov_b32 s56, 65536
    s_mov_b32 s55, 1
    s_getreg_b32 s63, hwreg(20, 0, 3)
    v_mov_b32 v3, 0
    v_mov_b32 v4, 0
    v_mov_b32 v11, 0
    v_mov_b32 v24, 0
    v_mov_b32 v34, 0
    v_mov_b64 v[12:13], -1
    v_mov_b64 v[14:15], -1
    v_lshlrev_b32 v10, 4, v0
    s_waitcnt lgkmcnt(0)
    s_add_u32 s36, s8, s64
    s_addc_u32 s37, s9, 0
    s_mov_b32 s38, s34
    s_mov_b32 s39, 0x20000
    s_mov_b32 s40, s28
    s_mov_b32 s41, s29
    s_mov_b32 s42, 2232320
    s_mov_b32 s43, 0x20000
    s_add_u32 s44, s10, s59
    s_addc_u32 s45, s11, 0
    s_mov_b32 s46, s60
    s_mov_b32 s47, 0x20000
    s_sub_u32 s44, s44, 2048
    s_subb_u32 s45, s45, 0
    s_cmp_lt_u32 s3, 20
    s_cselect_b32 s57, 7864320, 0
    s_add_u32 s58, s54, 1
    s_mul_i32 s58, s58, 245760
    s_cmp_lg_u32 s53, 3
    s_cselect_b64 s[48:49], s[12:13], s[16:17]
    s_cselect_b32 s50, s57, s58
    s_mov_b32 s51, 0x20000
    s_add_u32 s57, s28, 0
    s_sub_u32 s57, 0, s57
    s_and_b32 s57, s57, 0x3fff
    s_add_u32 s57, s57, 0
    s_lshr_b32 s58, s31, 1
    s_lshl_b32 s58, s58, 14
    s_add_u32 s6, s57, s58
    s_and_b32 s58, s31, 1
    s_lshl_b32 s58, s58, 12
    s_add_u32 s6, s6, s58
    s_lshl_b32 s58, s3, 7
    s_add_u32 s6, s6, s58
    s_mov_b32 s8, s57
    s_and_b32 s59, s3, 3
    s_lshl_b32 s58, s31, 2
    s_add_u32 s59, s59, s58
    s_lshl_b32 s59, s59, 7
    s_add_u32 s59, s59, s57
    s_add_u32 s59, s59, 262144
    s_add_u32 s10, s28, s59
    s_addc_u32 s11, s29, 0
    s_lshr_b32 s58, s63, 2
    s_xor_b32 s58, s58, 0
    s_mul_i32 s58, s58, 8192
    s_add_u32 s7, s57, s58
    s_cmp_eq_u32 s30, 5
    s_cbranch_scc0 L_skip_5
    s_cmp_eq_u32 s52, 31
    s_cbranch_scc0 L_skip_6
    s_mov_b64 exec, 0xffffff
    buffer_store_dwordx4 v[12:15], v10, s[40:43], s72 offen sc1
    s_mov_b64 exec, -1
L_skip_6:
    s_cmp_lt_u32 s3, 20
    s_cbranch_scc0 L_skip_7
    v_and_b32 v16, 7, v0
    v_lshlrev_b32 v16, 4, v16
    v_bfe_u32 v17, v0, 3, 1
    v_lshl_add_u32 v16, v17, 13, v16
    v_lshrrev_b32 v17, 4, v0
    v_mul_u32_u24 v17, 66048, v17
    v_add_u32 v16, v17, v16
    buffer_store_dwordx4 v[12:15], v16, s[40:43], s6 offen sc1
L_skip_7:
    s_cmp_eq_u32 s3, 20
    s_cbranch_scc0 L_skip_8
    s_lshl_b32 s58, s31, 9
    s_add_u32 s58, s58, s8
    s_add_u32 s58, s58, 266240
    v_and_b32 v16, 7, v0
    v_lshlrev_b32 v16, 4, v16
    v_bfe_u32 v60, v0, 3, 1
    v_lshl_add_u32 v16, v60, 13, v16
    v_lshrrev_b32 v60, 4, v0
    v_lshl_add_u32 v16, v60, 28, v16
    buffer_store_dwordx4 v[12:15], v16, s[40:43], s58 offen sc1
L_skip_8:
    s_sub_u32 s58, s3, 20
    s_cmp_lt_u32 s58, 4
    s_cselect_b32 s59, s59, 0x7f000000
    v_and_b32 v16, 7, v0
    v_lshlrev_b32 v16, 4, v16
    v_bfe_u32 v60, v0, 3, 1
    v_lshl_add_u32 v16, v60, 13, v16
    v_lshrrev_b32 v60, 4, v0
    v_lshl_add_u32 v16, v60, 28, v16
    buffer_store_dwordx4 v[12:15], v16, s[40:43], s59 offen sc1
    s_mul_i32 s57, s52, 2208
    s_add_u32 s57, s57, s62
    s_mov_b64 exec, 0x3ff
    buffer_store_dwordx4 v[12:15], v10, s[40:43], s57 offen offset:2048
    s_mov_b64 exec, -1
    buffer_store_dwordx4 v[12:15], v10, s[40:43], s57 offen offset:0
    buffer_store_dwordx4 v[12:15], v10, s[40:43], s57 offen offset:1024
    s_mov_b64 exec, -1
    v_lshlrev_b32 v16, 4, v0
    v_add_u32 v16, 159744, v16
    ds_write_b128 v16, v[12:15]
    v_and_b32 v3, 7, v0
    v_lshlrev_b32 v3, 5, v3
L_skip_5:
    s_cmp_eq_u32 s30, 7
    s_cbranch_scc0 L_skip_9
    v_and_b32 v60, 31, v0
    v_min_u32 v60, 19, v60
    s_mul_i32 s57, s54, 160
    v_lshrrev_b32 v16, 5, v0
    v_lshlrev_b32 v16, 2, v16
    v_add_u32 v16, s57, v16
    v_lshl_add_u32 v16, v60, 3, v16
    global_load_dword v28, v16, s[4:5]
    global_load_dword v4, v16, s[22:23]
L_skip_9:
    s_sub_u32 s58, s30, 4
    s_cmp_lt_u32 s58, 3
    s_cbranch_scc0 L_skip_10
    s_mul_i32 s57, s31, 3
    s_add_u32 s57, s57, s58
    s_lshl_b32 s57, s57, 7
    v_and_b32 v16, 15, v0
    v_lshlrev_b32 v16, 3, v16
    v_lshrrev_b32 v60, 4, v0
    v_lshl_add_u32 v16, v60, 1, v16
    v_add_u32 v16, s57, v16
    global_load_short_d16_hi v4, v16, s[18:19]
L_skip_10:
    v_bfe_u32 v8, v0, 1, 3
    v_lshrrev_b32 v9, 4, v0
    v_xor_b32 v9, v8, v9
    v_bfe_u32 v8, v0, 2, 1
    v_lshlrev_b32 v8, 10, v8
    v_bfe_u32 v60, v0, 3, 1
    v_lshl_add_u32 v8, v60, 9, v8
    v_and_b32 v60, 3, v0
    v_lshl_add_u32 v8, v60, 7, v8
    v_add_u32 v8, s61, v8
    v_lshl_add_u32 v8, v9, 4, v8
    v_xor_b32 v9, 64, v8
    v_bfe_u32 v1, v0, 1, 1
    v_mul_u32_u24 v1, 43690, v1
    v_add_u32 v1, 17476, v1
    s_cmp_eq_u32 s30, 6
    s_cbranch_scc0 L_skip_11
    s_mov_b32 s57, 98432
    s_mov_b32 s58, 294016
    s_mov_b32 m0, 116736
L_dma_12:
    s_waitcnt vmcnt(22)
    buffer_load_dwordx4 v5, s[32:35], s57 offen offset:0 nt lds
    buffer_load_dwordx4 v6, s[32:35], s58 offen offset:1024 nt lds
    s_add_u32 s57, s57, 24576
    s_add_u32 s58, s58, 24576
    s_add_u32 m0, m0, 2048
    s_cmp_lg_u32 m0, 124928
    s_cbranch_scc1 L_dma_12
    s_mov_b32 s57, 2048
    s_mov_b32 s58, 1152
    s_mov_b32 s59, 256
    s_mov_b32 m0, 0
L_dma_13:
    s_waitcnt vmcnt(22)
    buffer_load_dwordx4 v2, s[44:47], s57 offen offset:0 nt lds
    buffer_load_dwordx4 v2, s[44:47], s58 offen offset:1024 nt lds
    buffer_load_dwordx4 v2, s[44:47], s59 offen offset:2048 nt lds
    s_add_u32 s57, s57, 98304
    s_add_u32 s58, s58, 98304
    s_add_u32 s59, s59, 98304
    s_add_u32 m0, m0, 3072
    s_cmp_lg_u32 m0, 15360
    s_cbranch_scc1 L_dma_13
L_skip_11:
    s_waitcnt vmcnt(31)
    s_barrier
    ds_read_b128 v[64:67], v8 offset:0
    ds_read_b128 v[68:71], v9 offset:0
    s_cmp_eq_u32 s30, 6
    s_cbranch_scc0 L_skip_14
    s_mov_b32 s57, 256
    s_mov_b32 s58, 195840
    s_mov_b32 m0, 124928
L_dma_15:
    s_waitcnt vmcnt(22)
    buffer_load_dwordx4 v5, s[32:35], s57 offen offset:0 nt lds
    buffer_load_dwordx4 v6, s[32:35], s58 offen offset:1024 nt lds
    s_add_u32 s57, s57, 24576
    s_add_u32 s58, s58, 24576
    s_add_u32 m0, m0, 2048
    s_cmp_lg_u32 m0, 141312
    s_cbranch_scc1 L_dma_15
L_skip_14:
    s_waitcnt lgkmcnt(0)
    s_cmp_eq_u32 s30, 5
    s_cbranch_scc0 L_skip_16
    s_cmp_eq_u32 s52, 31
    s_cbranch_scc0 L_skip_17
    s_lshl_b32 s57, s31, 5
    v_mov_b32 v16, s57
    s_add_u32 s57, s63, 1
    v_mov_b32 v12, s57
    s_waitcnt vmcnt(5)
    s_mov_b64 exec, 0x1
    global_store_dword v16, v12, s[26:27] sc1
    s_mov_b64 exec, -1
L_skip_17:
L_skip_16:
    s_waitcnt vmcnt(31)
    s_barrier
    ds_read_b128 v[72:75], v8 offset:16384
    ds_read_b128 v[76:79], v9 offset:16384
    s_cmp_eq_u32 s30, 6
    s_cbranch_scc0 L_skip_18
    s_mov_b32 s57, 493568
    s_mov_b32 s58, 492672
    s_mov_b32 s59, 491776
    s_mov_b32 m0, 15360
L_dma_19:
    s_waitcnt vmcnt(22)
    buffer_load_dwordx4 v2, s[44:47], s57 offen offset:0 nt lds
    buffer_load_dwordx4 v2, s[44:47], s58 offen offset:1024 nt lds
    buffer_load_dwordx4 v2, s[44:47], s59 offen offset:2048 nt lds
    s_add_u32 s57, s57, 98304
    s_add_u32 s58, s58, 98304
    s_add_u32 s59, s59, 98304
    s_add_u32 m0, m0, 3072
    s_cmp_lg_u32 m0, 30720
    s_cbranch_scc1 L_dma_19
    s_mov_b32 s57, 393216
    s_mov_b32 s58, 588800
    s_mov_b32 m0, 141312
L_dma_20:
    s_waitcnt vmcnt(22)
    buffer_load_dwordx4 v5, s[32:35], s57 offen offset:0 nt lds
    buffer_load_dwordx4 v6, s[32:35], s58 offen offset:1024 nt lds
    s_add_u32 s57, s57, 24576
    s_add_u32 s58, s58, 24576
    s_add_u32 m0, m0, 2048
    s_cmp_lg_u32 m0, 157696
    s_cbranch_scc1 L_dma_20
L_skip_18:
    s_waitcnt lgkmcnt(0)
    s_cmp_lt_u32 s30, 4
    s_cbranch_scc0 L_skip_21
    s_mov_b64 exec, 0
    s_cmp_eq_u32 s30, 1
    s_cbranch_scc1 L_pad1
    s_cmp_eq_u32 s30, 2
    s_cbranch_scc1 L_pad2
    s_cmp_eq_u32 s30, 3
    s_cbranch_scc1 L_pad3
    s_branch L_pad0
.p2align 5
L_padback:
    s_mov_b64 exec, -1
L_skip_21:
    s_waitcnt vmcnt(31)
    s_barrier
    ds_read_b128 v[80:83], v8 offset:32768
    ds_read_b128 v[84:87], v9 offset:32768
    s_cmp_eq_u32 s30, 6
    s_cbranch_scc0 L_skip_22
    s_cmp_lg_u32 s53, 3
    s_cbranch_scc0 L_wb_23
    s_mul_i32 s57, s31, 983040
    s_lshl_b32 s58, s3, 6
    s_add_u32 s57, s57, s58
    v_bfe_u32 v38, v0, 4, 1
    v_lshlrev_b32 v38, 1, v38
    v_xor_b32 v38, v38, v0
    v_and_b32 v38, 3, v38
    v_lshrrev_b32 v3, 5, v0
    v_mul_u32_u24 v3, 10240, v3
    v_bfe_u32 v39, v0, 4, 1
    v_mul_u32_u24 v39, 2560, v39
    v_add_u32 v3, v39, v3
    v_bfe_u32 v39, v0, 3, 1
    v_mul_u32_u24 v39, 5120, v39
    v_add_u32 v3, v39, v3
    v_bfe_u32 v39, v0, 2, 1
    v_mul_u32_u24 v39, 20480, v39
    v_add_u32 v3, v39, v3
    v_add_u32 v3, s57, v3
    v_lshl_add_u32 v3, v38, 4, v3
    s_mov_b32 s14, 40960
    s_mov_b32 s15, 256
    s_branch L_we_24
.p2align 5
L_wb_23:
    s_mul_i32 s57, s31, 384
    s_mul_i32 s58, s54, 245760
    s_add_u32 s57, s57, s58
    v_lshlrev_b32 v3, 4, v0
    v_add_u32 v3, s57, v3
    v_mov_b32 v38, 2688
    v_cmp_lt_u32 vcc, 23, v0
    s_nop 1
    v_cndmask_b32 v38, 0, v38, vcc
    v_add_u32 v3, v38, v3
    v_mov_b32 v38, 0x7f000000
    v_cmp_lt_u32 vcc, 47, v0
    s_nop 1
    v_cndmask_b32 v3, v3, v38, vcc
    s_mov_b32 s14, 12288
    s_mov_b32 s15, 5120
L_we_24:
    s_mul_i32 s57, s14, 0
    s_mov_b32 m0, 30720
    s_nop 0
    buffer_load_dwordx4 v3, s[48:51], s57 offen offset:0 nt lds
    s_mul_i32 s57, s14, 0
    s_add_u32 s57, s57, s15
    s_mov_b32 m0, 30720
    s_nop 0
    buffer_load_dwordx4 v3, s[48:51], s57 offen offset:1024 nt lds
    s_mov_b32 s57, 393344
    s_mov_b32 s58, 588928
    s_mov_b32 m0, 92160
L_dma_25:
    s_waitcnt vmcnt(22)
    buffer_load_dwordx4 v5, s[32:35], s57 offen offset:0 nt lds
    buffer_load_dwordx4 v6, s[32:35], s58 offen offset:1024 nt lds
    s_add_u32 s57, s57, 24576
    s_add_u32 s58, s58, 24576
    s_add_u32 m0, m0, 2048
    s_cmp_lg_u32 m0, 108544
    s_cbranch_scc1 L_dma_25
    s_mul_i32 s57, s14, 1
    s_mov_b32 m0, 32768
    s_nop 0
    buffer_load_dwordx4 v3, s[48:51], s57 offen offset:0 nt lds
    s_mul_i32 s57, s14, 1
    s_add_u32 s57, s57, s15
    s_mov_b32 m0, 32768
    s_nop 0
    buffer_load_dwordx4 v3, s[48:51], s57 offen offset:1024 nt lds
    s_mov_b32 s57, 393472
    s_mov_b32 s58, 589056
    s_mov_b32 m0, 108544
L_dma_26:
    s_waitcnt vmcnt(22)
    buffer_load_dwordx4 v5, s[32:35], s57 offen offset:0 nt lds
    buffer_load_dwordx4 v6, s[32:35], s58 offen offset:1024 nt lds
    s_add_u32 s57, s57, 24576
    s_add_u32 s58, s58, 24576
    s_add_u32 m0, m0, 2048
    s_cmp_lg_u32 m0, 124928
    s_cbranch_scc1 L_dma_26
L_skip_22:
    s_waitcnt lgkmcnt(0)
    s_cmp_lt_u32 s30, 5
    s_cbranch_scc0 L_skip_27
    s_waitcnt vmcnt(0)
L_skip_27:
    s_cmp_eq_u32 s30, 7
    s_cbranch_scc0 L_skip_28
    v_and_b32 v60, 31, v0
    v_cmp_gt_u32 s[64:65], 20, v60
    v_min_u32 v60, 19, v60
    v_lshrrev_b32 v35, 5, v0
    v_lshlrev_b32 v35, 2, v35
    v_add_u32 v35, 160832, v35
    v_lshl_add_u32 v35, v60, 3, v35
    s_mul_i32 s66, s53, 12416
    s_add_u32 s66, s66, s62
    s_add_u32 s66, s66, 70656
    s_add_u32 s67, s66, 12288
    s_lshl_b32 s57, s54, 3
    v_lshrrev_b32 v34, 5, v0
    v_lshlrev_b32 v34, 2, v34
    v_add_u32 v34, s57, v34
    v_and_b32 v60, 31, v0
    v_mov_b32 v61, 0x7f000000
    v_cmp_ne_u32 vcc, 31, v60
    s_nop 1
    v_cndmask_b32 v34, v34, v61, vcc
    v_mov_b32 v61, 0x3f803f80
    s_waitcnt vmcnt(0)
    ds_write_b32 v35, v28
    s_waitcnt lgkmcnt(0)
L_skip_28:
    s_cmp_eq_u32 s30, 5
    s_cbranch_scc0 L_skip_29
    s_waitcnt vmcnt(0)
    s_lshr_b32 s67, s63, 2
    s_sub_u32 s58, s3, 20
    s_cmp_lt_u32 s58, 4
    s_cbranch_scc0 L_skip_30
    s_mov_b32 s67, 0
    s_load_dword s66, s[10:11], 0
    s_load_dword s67, s[10:11], 8192
    s_waitcnt lgkmcnt(1)
L_skip_30:
    v_subrev_u32 v16, 8, v0
    v_cmp_gt_u32 vcc, 40, v16
    v_mov_b32 v16, 0x3f803f80
    s_nop 0
    v_cndmask_b32 v18, 0, v16, vcc
    v_min_u32 v16, 55, v0
    v_lshlrev_b32 v16, 2, v16
    v_add_u32 v16, 160992, v16
    ds_write_b32 v16, v18
    s_mov_b32 s65, s67
    s_waitcnt lgkmcnt(0)
L_skip_29:
    s_waitcnt vmcnt(36)
    s_barrier
    ds_read_b128 v[88:91], v8 offset:49152
    ds_read_b128 v[92:95], v9 offset:49152
    s_cmp_eq_u32 s30, 6
    s_cbranch_scc0 L_skip_31
    s_mul_i32 s57, s14, 2
    s_mov_b32 m0, 34816
    s_nop 0
    buffer_load_dwordx4 v3, s[48:51], s57 offen offset:0 nt lds
    s_mul_i32 s57, s14, 2
    s_add_u32 s57, s57, s15
    s_mov_b32 m0, 34816
    s_nop 0
    buffer_load_dwordx4 v3, s[48:51], s57 offen offset:1024 nt lds
    s_mov_b32 s57, 786432
    s_mov_b32 s58, 982016
    s_mov_b32 m0, 124928
L_dma_32:
    s_waitcnt vmcnt(22)
    buffer_load_dwordx4 v5, s[32:35], s57 offen offset:0 nt lds
    buffer_load_dwordx4 v6, s[32:35], s58 offen offset:1024 nt lds
    s_add_u32 s57, s57, 24576
    s_add_u32 s58, s58, 24576
    s_add_u32 m0, m0, 2048
    s_cmp_lg_u32 m0, 141312
    s_cbranch_scc1 L_dma_32
L_skip_31:
    s_waitcnt lgkmcnt(0)
    s_cmp_eq_u32 s30, 7
    s_cbranch_scc0 L_skip_33
    v_cndmask_b32 v29, 0, v28, s[64:65]
    v_dot2_f32_bf16 v33, v29, v61, 0
    v_dot2_f32_bf16 v32, v29, v29, 0
    v_lshlrev_b32 v2, 16, v28
    v_and_b32 v3, 0xffff0000, v28
    s_cmp_eq_u32 s55, 0
    v_permlane32_swap_b32 v33, v32
    v_add_f32 v33, v33, v32
    s_nop 1
    v_add_f32_dpp v33, v33, v33 row_ror:8 row_mask:0xf bank_mask:0xf
    s_nop 1
    v_add_f32_dpp v33, v33, v33 row_ror:4 row_mask:0xf bank_mask:0xf
    s_nop 1
    v_add_f32_dpp v33, v33, v33 row_ror:2 row_mask:0xf bank_mask:0xf
    s_nop 1
    v_add_f32_dpp v33, v33, v33 row_ror:1 row_mask:0xf bank_mask:0xf
    s_nop 1
    v_add_f32_dpp v33, v33, v33 row_bcast:15 row_mask:0xa bank_mask:0xf
    s_cbranch_scc1 L_gs_34
    buffer_store_dword v33, v34, s[40:43], s67 offen
L_gb_35:
    s_waitcnt vmcnt(1)
L_skip_33:
    s_cmp_lt_u32 s30, 6
    s_cbranch_scc0 L_skip_36
    s_lshr_b32 s57, s30, 1
    s_mul_i32 s57, s57, 1024
    s_and_b32 s58, s30, 1
    s_lshl_b32 s58, s58, 6
    s_add_u32 s57, s57, s58
    v_lshrrev_b32 v18, 5, v0
    v_mul_u32_u24 v18, 6144, v18
    v_bfe_u32 v60, v0, 3, 1
    v_mul_u32_u24 v60, 3072, v60
    v_add_u32 v18, v60, v18
    v_bfe_u32 v60, v0, 4, 1
    v_lshl_add_u32 v18, v60, 9, v18
    v_bfe_u32 v60, v0, 2, 1
    v_lshl_add_u32 v18, v60, 7, v18
    v_and_b32 v60, 3, v0
    v_lshl_add_u32 v18, v60, 3, v18
    v_add_u32 v18, s57, v18
    v_bfe_u32 v19, v0, 3, 1
    v_mul_u32_u24 v19, 3072, v19
    v_bfe_u32 v60, v0, 4, 1
    v_lshl_add_u32 v19, v60, 9, v19
    v_bfe_u32 v60, v0, 2, 1
    v_lshl_add_u32 v19, v60, 7, v19
    v_and_b32 v60, 3, v0
    v_lshl_add_u32 v19, v60, 3, v19
    v_lshrrev_b32 v60, 5, v0
    v_lshl_add_u32 v19, v60, 5, v19
    v_add_u32 v19, s57, v19
    v_add_u32 v19, 24576, v19
    ds_read_b64_tr_b16 v[28:29], v18 offset:0
    ds_read_b64_tr_b16 v[30:31], v18 offset:256
    ds_read_b64_tr_b16 v[32:33], v18 offset:12288
    ds_read_b64_tr_b16 v[34:35], v18 offset:12544
    ds_read_b64_tr_b16 v[36:37], v18 offset:32
    ds_read_b64_tr_b16 v[38:39], v18 offset:288
    ds_read_b64_tr_b16 v[40:41], v18 offset:12320
    ds_read_b64_tr_b16 v[42:43], v18 offset:12576
    ds_read_b64_tr_b16 v[24:25], v19 offset:0
    ds_read_b64_tr_b16 v[26:27], v19 offset:256
    v_lshrrev_b32 v49, 4, v0
    v_lshlrev_b32 v49, 5, v49
    v_bfe_u32 v60, v0, 1, 1
    v_lshl_add_u32 v49, v60, 4, v49
    v_bfe_u32 v60, v0, 3, 1
    v_mul_u32_u24 v60, 192, v60
    v_add_u32 v49, v60, v49
    v_add_u32 v49, 160832, v49
    v_bfe_u32 v50, v0, 1, 1
    v_lshlrev_b32 v50, 4, v50
    v_bfe_u32 v60, v0, 3, 1
    v_mul_u32_u24 v60, 192, v60
    v_add_u32 v50, v60, v50
    v_add_u32 v50, 160960, v50
    v_mov_b32 v60, 160992
    v_and_b32 v51, 5, v0
    v_cmp_eq_u32 vcc, 0, v51
    s_nop 1
    v_cndmask_b32 v52, v60, v49, vcc
    v_cmp_eq_u32 vcc, 4, v51
    s_nop 1
    v_cndmask_b32 v53, v60, v49, vcc
    v_lshrrev_b32 v49, 2, v0
    v_and_b32 v49, 12, v49
    v_cmp_eq_u32 vcc, v49, v51
    s_nop 1
    v_cndmask_b32 v48, v60, v50, vcc
    v_mov_b64 v[44:45], 0
    v_mov_b64 v[46:47], 0
    s_lshr_b32 s57, s30, 1
    s_lshl_b32 s57, s57, 11
    s_lshl_b32 s58, s58, 1
    s_add_u32 s57, s57, s58
    s_lshl_b32 s58, s54, 8
    s_add_u32 s57, s57, s58
    v_and_b32 v54, 31, v0
    v_lshlrev_b32 v54, 2, v54
    v_lshrrev_b32 v60, 5, v0
    v_mul_u32_u24 v60, 6144, v60
    v_add_u32 v54, v60, v54
    v_add_u32 v54, s57, v54
    s_mul_i32 s59, s53, 12416
    s_add_u32 s59, s59, s62
    s_add_u32 s59, s59, 70656
    s_add_u32 s60, s59, 12288
    ds_read_b128 v[12:15], v52
    ds_read_b128 v[16:19], v53
    ds_read_b128 v[20:23], v48
    s_waitcnt lgkmcnt(2)
    v_smfmac_f32_16x16x64_bf16 v[44:47], v[12:15], v[28:35], v1
    s_waitcnt lgkmcnt(1)
    v_smfmac_f32_16x16x64_bf16 v[44:47], v[16:19], v[36:43], v1
    s_waitcnt lgkmcnt(0)
    v_smfmac_f32_16x16x64_bf16 v[44:47], v[20:23], v[24:31], v1
    s_cmp_eq_u32 s55, 0
    s_nop 6
    v_add_f32 v12, v44, v46
    s_cbranch_scc1 L_gs_37
    buffer_store_dword v12, v54, s[40:43], s59 offen
L_gb_38:
L_skip_36:
    s_cmp_eq_u32 s30, 5
    s_cbranch_scc0 L_skip_39
    global_load_dword v2, v3, s[26:27] sc1
L_skip_39:
    s_waitcnt vmcnt(36)
    s_barrier
    ds_read_b128 v[96:99], v8 offset:0
    ds_read_b128 v[100:103], v9 offset:0
    s_cmp_eq_u32 s30, 6
    s_cbranch_scc0 L_skip_40
    s_mul_i32 s57, s14, 3
    s_mov_b32 m0, 36864
    s_nop 0
    buffer_load_dwordx4 v3, s[48:51], s57 offen offset:0 nt lds
    s_mul_i32 s57, s14, 3
    s_add_u32 s57, s57, s15
    s_mov_b32 m0, 36864
    s_nop 0
    buffer_load_dwordx4 v3, s[48:51], s57 offen offset:1024 nt lds
    s_mov_b32 s57, 786560
    s_mov_b32 s58, 982144
    s_mov_b32 m0, 141312
L_dma_41:
    s_waitcnt vmcnt(22)
    buffer_load_dwordx4 v5, s[32:35], s57 offen offset:0 nt lds
    buffer_load_dwordx4 v6, s[32:35], s58 offen offset:1024 nt lds
    s_add_u32 s57, s57, 24576
    s_add_u32 s58, s58, 24576
    s_add_u32 m0, m0, 2048
    s_cmp_lg_u32 m0, 157696
    s_cbranch_scc1 L_dma_41
L_skip_40:
    s_waitcnt lgkmcnt(0)
    s_waitcnt vmcnt(36)
    s_barrier
    ds_read_b128 v[104:107], v8 offset:16384
    ds_read_b128 v[108:111], v9 offset:16384
    s_cmp_eq_u32 s30, 6
    s_cbranch_scc0 L_skip_42
    s_mul_i32 s57, s14, 4
    s_mov_b32 m0, 38912
    s_nop 0
    buffer_load_dwordx4 v3, s[48:51], s57 offen offset:0 nt lds
    s_mul_i32 s57, s14, 4
    s_add_u32 s57, s57, s15
    s_mov_b32 m0, 38912
    s_nop 0
    buffer_load_dwordx4 v3, s[48:51], s57 offen offset:1024 nt lds
    s_mov_b32 s57, 786688
    s_mov_b32 s58, 982272
    s_mov_b32 m0, 92160
L_dma_43:
    s_waitcnt vmcnt(22)
    buffer_load_dwordx4 v5, s[32:35], s57 offen offset:0 nt lds
    buffer_load_dwordx4 v6, s[32:35], s58 offen offset:1024 nt lds
    s_add_u32 s57, s57, 24576
    s_add_u32 s58, s58, 24576
    s_add_u32 m0, m0, 2048
    s_cmp_lg_u32 m0, 108544
    s_cbranch_scc1 L_dma_43
L_skip_42:
    s_waitcnt lgkmcnt(0)
    s_cmp_lg_u32 s30, 6
    s_cbranch_scc0 L_skip_44
    s_waitcnt vmcnt(0)
L_skip_44:
    s_waitcnt vmcnt(36)
    s_barrier
    ds_read_b128 v[112:115], v8 offset:32768
    ds_read_b128 v[116:119], v9 offset:32768
    s_cmp_eq_u32 s30, 6
    s_cbranch_scc0 L_skip_45
    s_mul_i32 s57, s14, 5
    s_mov_b32 m0, 40960
    s_nop 0
    buffer_load_dwordx4 v3, s[48:51], s57 offen offset:0 nt lds
    s_mul_i32 s57, s14, 5
    s_add_u32 s57, s57, s15
    s_mov_b32 m0, 40960
    s_nop 0
    buffer_load_dwordx4 v3, s[48:51], s57 offen offset:1024 nt lds
    s_mov_b32 s57, 1179648
    s_mov_b32 s58, 1375232
    s_mov_b32 m0, 108544
L_dma_46:
    s_waitcnt vmcnt(22)
    buffer_load_dwordx4 v5, s[32:35], s57 offen offset:0 nt lds
    buffer_load_dwordx4 v6, s[32:35], s58 offen offset:1024 nt lds
    s_add_u32 s57, s57, 24576
    s_add_u32 s58, s58, 24576
    s_add_u32 m0, m0, 2048
    s_cmp_lg_u32 m0, 124928
    s_cbranch_scc1 L_dma_46
L_skip_45:
    s_waitcnt lgkmcnt(0)
    s_cmp_eq_u32 s30, 5
    s_cbranch_scc0 L_skip_47
L_cw_48:
    v_readlane_b32 s57, v2, s31
    s_cmp_eq_u32 s57, 0
    s_cbranch_scc1 L_cr_49
    s_lshr_b32 s58, s63, 2
    s_xor_b32 s58, s58, s65
    s_and_b32 s58, s58, 1
    v_mov_b32 v25, s58
    s_sub_u32 s57, s57, 1
    s_cmp_eq_u32 s57, s63
    s_cselect_b32 s64, 1, 0
    s_cbranch_scc0 L_far_50
    s_lshl_b32 s57, s52, 2
    s_add_u32 s57, s57, s72
    s_mov_b64 exec, 1
    buffer_store_dword v25, v0, s[40:43], s57 offen offset:0
    s_mov_b64 exec, -1
L_fb_51:
L_skip_47:
    s_waitcnt vmcnt(36)
    s_barrier
    ds_read_b128 v[120:123], v8 offset:49152
    ds_read_b128 v[124:127], v9 offset:49152
    s_cmp_eq_u32 s30, 6
    s_cbranch_scc0 L_skip_52
    s_mul_i32 s57, s14, 6
    s_mov_b32 m0, 43008
    s_nop 0
    buffer_load_dwordx4 v3, s[48:51], s57 offen offset:0 nt lds
    s_mul_i32 s57, s14, 6
    s_add_u32 s57, s57, s15
    s_mov_b32 m0, 43008
    s_nop 0
    buffer_load_dwordx4 v3, s[48:51], s57 offen offset:1024 nt lds
    s_mov_b32 s57, 1179776
    s_mov_b32 s58, 1375360
    s_mov_b32 m0, 124928
L_dma_53:
    s_waitcnt vmcnt(22)
    buffer_load_dwordx4 v5, s[32:35], s57 offen offset:0 nt lds
    buffer_load_dwordx4 v6, s[32:35], s58 offen offset:1024 nt lds
    s_add_u32 s57, s57, 24576
    s_add_u32 s58, s58, 24576
    s_add_u32 m0, m0, 2048
    s_cmp_lg_u32 m0, 141312
    s_cbranch_scc1 L_dma_53
L_skip_52:
    s_waitcnt lgkmcnt(0)
    s_waitcnt vmcnt(36)
    s_barrier
    ds_read_b128 v[128:131], v8 offset:0
    ds_read_b128 v[132:135], v9 offset:0
    s_cmp_eq_u32 s30, 6
    s_cbranch_scc0 L_skip_54
    s_mul_i32 s57, s14, 7
    s_mov_b32 m0, 45056
    s_nop 0
    buffer_load_dwordx4 v3, s[48:51], s57 offen offset:0 nt lds
    s_mul_i32 s57, s14, 7
    s_add_u32 s57, s57, s15
    s_mov_b32 m0, 45056
    s_nop 0
    buffer_load_dwordx4 v3, s[48:51], s57 offen offset:1024 nt lds
    s_mov_b32 s57, 1179904
    s_mov_b32 s58, 1375488
    s_mov_b32 m0, 141312
L_dma_55:
    s_waitcnt vmcnt(22)
    buffer_load_dwordx4 v5, s[32:35], s57 offen offset:0 nt lds
    buffer_load_dwordx4 v6, s[32:35], s58 offen offset:1024 nt lds
    s_add_u32 s57, s57, 24576
    s_add_u32 s58, s58, 24576
    s_add_u32 m0, m0, 2048
    s_cmp_lg_u32 m0, 157696
    s_cbranch_scc1 L_dma_55
L_skip_54:
    s_waitcnt lgkmcnt(0)
    s_cmp_eq_u32 s30, 5
    s_cbranch_scc0 L_skip_56
    v_lshlrev_b32 v24, 2, v0
    buffer_load_dword v2, v24, s[40:43], s72 offen sc1
L_skip_56:
    s_waitcnt vmcnt(36)
    s_barrier
    ds_read_b128 v[136:139], v8 offset:16384
    ds_read_b128 v[140:143], v9 offset:16384
    s_cmp_eq_u32 s30, 6
    s_cbranch_scc0 L_skip_57
    s_mul_i32 s57, s14, 8
    s_mov_b32 m0, 47104
    s_nop 0
    buffer_load_dwordx4 v3, s[48:51], s57 offen offset:0 nt lds
    s_mul_i32 s57, s14, 8
    s_add_u32 s57, s57, s15
    s_mov_b32 m0, 47104
    s_nop 0
    buffer_load_dwordx4 v3, s[48:51], s57 offen offset:1024 nt lds
    s_mov_b32 s57, 0
    s_mov_b32 s58, 392192
    s_mov_b32 m0, 92160
L_dma_58:
    s_waitcnt vmcnt(22)
    buffer_load_dwordx4 v7, s[36:39], s57 offen offset:0 nt lds
    buffer_load_dwordx4 v7, s[36:39], s58 offen offset:1024 nt lds
    s_add_u32 s57, s57, 24576
    s_add_u32 s58, s58, 24576
    s_add_u32 m0, m0, 2048
    s_cmp_lg_u32 m0, 108544
    s_cbranch_scc1 L_dma_58
L_skip_57:
    s_waitcnt lgkmcnt(0)
    s_waitcnt vmcnt(36)
    s_barrier
    ds_read_b128 v[144:147], v8 offset:32768
    ds_read_b128 v[148:151], v9 offset:32768
    s_cmp_eq_u32 s30, 6
    s_cbranch_scc0 L_skip_59
    s_mul_i32 s57, s14, 9
    s_mov_b32 m0, 49152
    s_nop 0
    buffer_load_dwordx4 v3, s[48:51], s57 offen offset:0 nt lds
    s_mul_i32 s57, s14, 9
    s_add_u32 s57, s57, s15
    s_mov_b32 m0, 49152
    s_nop 0
    buffer_load_dwordx4 v3, s[48:51], s57 offen offset:1024 nt lds
    s_mov_b32 s57, 128
    s_mov_b32 s58, 392320
    s_mov_b32 m0, 108544
L_dma_60:
    s_waitcnt vmcnt(22)
    buffer_load_dwordx4 v7, s[36:39], s57 offen offset:0 nt lds
    buffer_load_dwordx4 v7, s[36:39], s58 offen offset:1024 nt lds
    s_add_u32 s57, s57, 24576
    s_add_u32 s58, s58, 24576
    s_add_u32 m0, m0, 2048
    s_cmp_lg_u32 m0, 124928
    s_cbranch_scc1 L_dma_60
L_skip_59:
    s_waitcnt lgkmcnt(0)
    s_cmp_eq_u32 s30, 5
    s_cbranch_scc0 L_skip_61
L_cw_62:
    s_waitcnt vmcnt(0)
    v_cmp_ne_u32 vcc, -1, v2
    s_mov_b32 s57, 0
    s_mov_b32 s68, 2
    s_cmp_eq_u32 s64, 0
    s_cbranch_scc1 L_cd_64
    s_cmp_lg_u32 vcc_hi, 0
    s_cbranch_scc1 L_cd_64
    s_cmp_lg_u32 vcc_lo, -1
    s_cbranch_scc1 L_cr_63
    v_cmp_eq_u32 vcc, 1, v2
    s_bcnt1_i32_b32 s68, vcc_lo
    s_mov_b32 s57, 1
L_cd_64:
    v_mov_b32 v37, 160768
    v_mov_b32 v38, s57
    ds_write_b32 v37, v38
    s_waitcnt lgkmcnt(0)
L_skip_61:
    s_waitcnt vmcnt(36)
    s_barrier
    ds_read_b128 v[152:155], v8 offset:49152
    ds_read_b128 v[156:159], v9 offset:49152
    s_cmp_eq_u32 s30, 6
    s_cbranch_scc0 L_skip_65
    s_mul_i32 s57, s14, 10
    s_mov_b32 m0, 51200
    s_nop 0
    buffer_load_dwordx4 v3, s[48:51], s57 offen offset:0 nt lds
    s_mul_i32 s57, s14, 10
    s_add_u32 s57, s57, s15
    s_mov_b32 m0, 51200
    s_nop 0
    buffer_load_dwordx4 v3, s[48:51], s57 offen offset:1024 nt lds
    s_mov_b32 s57, 256
    s_mov_b32 s58, 392448
    s_mov_b32 m0, 124928
L_dma_66:
    s_waitcnt vmcnt(22)
    buffer_load_dwordx4 v7, s[36:39], s57 offen offset:0 nt lds
    buffer_load_dwordx4 v7, s[36:39], s58 offen offset:1024 nt lds
    s_add_u32 s57, s57, 24576
    s_add_u32 s58, s58, 24576
    s_add_u32 m0, m0, 2048
    s_cmp_lg_u32 m0, 141312
    s_cbranch_scc1 L_dma_66
L_skip_65:
    s_waitcnt lgkmcnt(0)
    v_lshrrev_b32 v8, 2, v0
    v_lshlrev_b32 v8, 7, v8
    v_bfe_u32 v60, v0, 3, 2
    v_lshl_add_u32 v8, v60, 5, v8
    v_and_b32 v60, 3, v0
    v_lshl_add_u32 v8, v60, 3, v8
    v_add_u32 v8, s61, v8
    v_xor_b32 v9, 32, v8
    v_xor_b32 v10, 64, v8
    v_xor_b32 v11, 96, v8
    v_mov_b32 v41, 160768
    ds_read_b32 v42, v41
    s_waitcnt lgkmcnt(0)
    v_readfirstlane_b32 s55, v42
    s_cmp_eq_u32 s55, 0
    s_cbranch_scc1 L_spread
L_spread_back:
    s_cmp_eq_u32 s30, 5
    s_cbranch_scc0 L_skip_78
    s_cmp_eq_u32 s52, 31
    s_cbranch_scc0 L_skip_79
    s_lshl_b32 s57, s31, 5
    v_mov_b32 v16, s57
    s_add_u32 s57, s68, 1
    v_mov_b32 v12, s57
    s_mov_b64 exec, 0x1
    global_store_dword v16, v12, s[26:27] offset:4 sc1
    s_mov_b64 exec, -1
L_skip_79:
L_skip_78:
    s_sub_u32 s58, s30, 1
    s_cmp_lt_u32 s58, 3
    s_cbranch_scc0 L_skip_80
    s_mul_i32 s59, s53, 12416
    s_add_u32 s59, s59, s62
    s_add_u32 s59, s59, 70656
    s_add_u32 s60, s59, 12288
    s_lshl_b32 s57, s58, 11
    v_lshlrev_b32 v48, 4, v0
    v_add_u32 v48, s57, v48
    v_and_b32 v49, 7, v0
    v_lshlrev_b32 v49, 3, v49
    s_add_u32 s57, s59, 6144
    buffer_load_dwordx4 v[12:15], v48, s[40:43], s59 offen offset:0 sc1 nt
    buffer_load_dwordx4 v[16:19], v48, s[40:43], s59 offen offset:1024 sc1 nt
    buffer_load_dwordx4 v[28:31], v48, s[40:43], s57 offen offset:0 sc1 nt
    buffer_load_dwordx4 v[32:35], v48, s[40:43], s57 offen offset:1024 sc1 nt
    buffer_load_dwordx2 v[24:25], v49, s[40:43], s60 offen sc1 nt
L_skip_80:
    s_waitcnt vmcnt(36)
    s_barrier
    ds_read_b64_tr_b16 v[160:161], v8 offset:0
    ds_read_b64_tr_b16 v[168:169], v9 offset:0
    ds_read_b64_tr_b16 v[176:177], v10 offset:0
    ds_read_b64_tr_b16 v[184:185], v11 offset:0
    s_cmp_eq_u32 s30, 6
    s_cbranch_scc0 L_skip_81
    s_mul_i32 s57, s14, 11
    s_mov_b32 m0, 53248
    s_nop 0
    buffer_load_dwordx4 v3, s[48:51], s57 offen offset:0 nt lds
    s_mul_i32 s57, s14, 11
    s_add_u32 s57, s57, s15
    s_mov_b32 m0, 53248
    s_nop 0
    buffer_load_dwordx4 v3, s[48:51], s57 offen offset:1024 nt lds
    s_mov_b32 s57, 196608
    s_mov_b32 s58, 588800
    s_mov_b32 m0, 141312
L_dma_82:
    s_waitcnt vmcnt(22)
    buffer_load_dwordx4 v7, s[36:39], s57 offen offset:0 nt lds
    buffer_load_dwordx4 v7, s[36:39], s58 offen offset:1024 nt lds
    s_add_u32 s57, s57, 24576
    s_add_u32 s58, s58, 24576
    s_add_u32 m0, m0, 2048
    s_cmp_lg_u32 m0, 157696
    s_cbranch_scc1 L_dma_82
L_skip_81:
    s_waitcnt lgkmcnt(0)
    s_waitcnt vmcnt(36)
    s_barrier
    ds_read_b64_tr_b16 v[192:193], v8 offset:16384
    ds_read_b64_tr_b16 v[200:201], v9 offset:16384
    ds_read_b64_tr_b16 v[208:209], v10 offset:16384
    ds_read_b64_tr_b16 v[216:217], v11 offset:16384
    s_cmp_eq_u32 s30, 6
    s_cbranch_scc0 L_skip_83
    s_mov_b32 s57, 196736
    s_mov_b32 s58, 588928
    s_mov_b32 m0, 92160
L_dma_84:
    s_waitcnt vmcnt(22)
    buffer_load_dwordx4 v7, s[36:39], s57 offen offset:0 nt lds
    buffer_load_dwordx4 v7, s[36:39], s58 offen offset:1024 nt lds
    s_add_u32 s57, s57, 24576
    s_add_u32 s58, s58, 24576
    s_add_u32 m0, m0, 2048
    s_cmp_lg_u32 m0, 108544
    s_cbranch_scc1 L_dma_84
L_skip_83:
    s_waitcnt lgkmcnt(0)
    s_sub_u32 s58, s30, 1
    s_cmp_lt_u32 s58, 3
    s_cbranch_scc0 L_skip_85
    s_lshl_b32 s57, s58, 7
    v_bfe_u32 v51, v0, 2, 2
    v_lshlrev_b32 v51, 5, v51
    v_lshrrev_b32 v60, 5, v0
    v_lshl_add_u32 v51, v60, 4, v51
    v_and_b32 v60, 3, v0
    v_lshl_add_u32 v51, v60, 2, v51
    v_bfe_u32 v60, v0, 4, 1
    v_lshl_add_u32 v51, v60, 1, v51
    v_add_u32 v51, s57, v51
    v_add_u32 v51, 157696, v51
    v_mov_b32 v60, 0x3c75e03e
    v_mov_b32 v61, 0x3a71d1e6
    v_mov_b32 v47, 0x3e13985d
    s_waitcnt vmcnt(0)
    v_pk_add_f32 v[36:37], v[28:29], v[32:33]
    v_pk_add_f32 v[38:39], v[30:31], v[34:35]
    s_nop 1
    v_permlane32_swap_b32 v36, v38
    v_permlane32_swap_b32 v37, v39
    v_pk_add_f32 v[36:37], v[36:37], v[38:39]
    s_nop 1
    v_permlane16_swap_b32 v36, v37
    v_add_f32 v36, v36, v37
    v_mul_f32 v6, 0x3dd53b95, v36
    v_add_f32_dpp v48, v24, v24 row_ror:4 row_mask:0xf bank_mask:0xf
    v_add_f32_dpp v49, v25, v25 row_ror:4 row_mask:0xf bank_mask:0xf
    v_pk_add_f32 v[20:21], v[12:13], v[16:17]
    v_pk_add_f32 v[22:23], v[14:15], v[18:19]
    v_add_f32_dpp v48, v48, v48 row_ror:2 row_mask:0xf bank_mask:0xf
    v_add_f32_dpp v49, v49, v49 row_ror:2 row_mask:0xf bank_mask:0xf
    v_permlane32_swap_b32 v20, v22
    v_permlane32_swap_b32 v21, v23
    v_add_f32_dpp v48, v48, v48 row_ror:1 row_mask:0xf bank_mask:0xf
    v_add_f32_dpp v49, v49, v49 row_ror:1 row_mask:0xf bank_mask:0xf
    v_pk_add_f32 v[20:21], v[20:21], v[22:23]
    v_mul_f32 v48, v48, v60
    v_fma_f32 v49, v49, v47, v61
    v_permlane16_swap_b32 v20, v21
    v_fma_f32 v49, -v48, v48, v49
    v_add_f32 v20, v20, v21
    v_max_f32 v49, v49, v61
    v_mul_f32 v50, v6, v48
    v_rsq_f32 v49, v49
    v_cmp_u_f32 vcc, v20, v20
    v_sub_f32 v20, v20, v50
    v_mul_f32 v20, v20, v49
    v_cvt_pk_bf16_f32 v20, v20, v20
    ds_write_b16 v51, v20
    s_waitcnt lgkmcnt(0)
L_skip_85:
    s_lshl_b32 s57, s30, 7
    s_add_u32 s57, s57, 158720
    v_lshrrev_b32 v58, 4, v0
    v_lshlrev_b32 v58, 5, v58
    v_bfe_u32 v60, v0, 1, 1
    v_lshl_add_u32 v58, v60, 4, v58
    v_bfe_u32 v60, v0, 2, 2
    v_lshl_add_u32 v58, v60, 2, v58
    v_and_b32 v60, 1, v0
    v_lshl_add_u32 v58, v60, 1, v58
    v_add_u32 v58, s57, v58
    v_lshrrev_b32 v61, 4, v0
    v_lshlrev_b32 v61, 5, v61
    v_bfe_u32 v60, v0, 1, 1
    v_lshl_add_u32 v61, v60, 4, v61
    v_add_u32 v61, s57, v61
    v_bfe_u32 v62, v0, 2, 2
    v_lshlrev_b32 v62, 1, v62
    v_and_b32 v60, 1, v0
    v_lshl_add_u32 v62, v60, 0, v62
    v_mov_b32 v60, 160992
    v_cmp_eq_u32 vcc, 0, v62
    s_nop 1
    v_cndmask_b32 v52, v60, v61, vcc
    v_cmp_eq_u32 vcc, 1, v62
    s_nop 1
    v_cndmask_b32 v53, v60, v61, vcc
    v_cmp_eq_u32 vcc, 2, v62
    s_nop 1
    v_cndmask_b32 v54, v60, v61, vcc
    v_cmp_eq_u32 vcc, 3, v62
    s_nop 1
    v_cndmask_b32 v55, v60, v61, vcc
    v_cmp_eq_u32 vcc, 4, v62
    s_nop 1
    v_cndmask_b32 v56, v60, v61, vcc
    v_cmp_eq_u32 vcc, 5, v62
    s_nop 1
    v_cndmask_b32 v57, v60, v61, vcc
    s_lshl_b32 s58, s30, 2
    s_add_u32 s58, s58, 159744
    v_mov_b32 v60, s58
    v_lshlrev_b32 v59, 2, v0
    v_add_u32 v59, 158208, v59
    v_cmp_eq_u32 vcc, 63, v0
    s_nop 1
    v_cndmask_b32 v59, v59, v60, vcc
    v_and_b32 v62, 7, v0
    v_lshlrev_b32 v62, 2, v62
    v_add_u32 v62, 159744, v62
    s_lshl_b32 s57, s30, 11
    v_lshlrev_b32 v63, 4, v0
    v_add_u32 v63, s57, v63
    v_add_u32 v63, 92160, v63
    s_waitcnt vmcnt(34)
    s_barrier
    ds_read_b64_tr_b16 v[224:225], v8 offset:32768
    ds_read_b64_tr_b16 v[232:233], v9 offset:32768
    ds_read_b64_tr_b16 v[240:241], v10 offset:32768
    ds_read_b64_tr_b16 v[248:249], v11 offset:32768
    s_cmp_eq_u32 s30, 6
    s_cbranch_scc0 L_skip_86
    s_mov_b32 s57, 196864
    s_mov_b32 s58, 589056
    s_mov_b32 m0, 108544
L_dma_87:
    s_nop 0
    buffer_load_dwordx4 v7, s[36:39], s57 offen offset:0 nt lds
    buffer_load_dwordx4 v7, s[36:39], s58 offen offset:1024 nt lds
    s_add_u32 s57, s57, 24576
    s_add_u32 s58, s58, 24576
    s_add_u32 m0, m0, 2048
    s_cmp_lg_u32 m0, 124928
    s_cbranch_scc1 L_dma_87
L_skip_86:
    s_waitcnt lgkmcnt(0)
    v_lshrrev_b32 v5, 4, v0
    v_lshlrev_b32 v5, 5, v5
    v_bfe_u32 v60, v0, 1, 1
    v_lshl_add_u32 v5, v60, 4, v5
    v_add_u32 v5, 157696, v5
    ds_read_b128 v[12:15], v5 offset:0
    ds_read_b128 v[16:19], v5 offset:128
    ds_read_b128 v[20:23], v5 offset:256
    v_mov_b64 v[24:25], 0
    v_mov_b64 v[26:27], 0
    v_mov_b64 v[28:29], 0
    v_mov_b64 v[30:31], 0
    v_mov_b64 v[32:33], 0
    v_mov_b64 v[34:35], 0
    v_mov_b64 v[36:37], 0
    v_mov_b64 v[38:39], 0
    v_mov_b64 v[40:41], 0
    v_mov_b64 v[42:43], 0
    v_mov_b64 v[44:45], 0
    v_mov_b64 v[46:47], 0
    s_waitcnt lgkmcnt(0)
    v_smfmac_f32_16x16x64_bf16 v[24:27], v[12:15], v[64:71], v1
    v_smfmac_f32_16x16x64_bf16 v[24:27], v[16:19], v[72:79], v1
    v_smfmac_f32_16x16x64_bf16 v[24:27], v[20:23], v[80:87], v1
    v_smfmac_f32_16x16x64_bf16 v[28:31], v[12:15], v[88:95], v1
    v_smfmac_f32_16x16x64_bf16 v[28:31], v[16:19], v[96:103], v1
    v_smfmac_f32_16x16x64_bf16 v[28:31], v[20:23], v[104:111], v1
    v_smfmac_f32_16x16x64_bf16 v[32:35], v[12:15], v[112:119], v1
    v_smfmac_f32_16x16x64_bf16 v[32:35], v[16:19], v[120:127], v1
    v_smfmac_f32_16x16x64_bf16 v[32:35], v[20:23], v[128:135], v1
    v_smfmac_f32_16x16x64_bf16 v[36:39], v[12:15], v[136:143], v1
    v_smfmac_f32_16x16x64_bf16 v[36:39], v[16:19], v[144:151], v1
    v_smfmac_f32_16x16x64_bf16 v[36:39], v[20:23], v[152:159], v1
    v_add_f32 v24, v24, v26
    s_nop 0
    v_add_f32 v28, v28, v30
    s_nop 1
    v_add_f32 v32, v32, v34
    v_max3_f32 v61, v24, v28, v32
    v_mov_b32_dpp v24, v28 quad_perm:[0,1,2,3] row_mask:0x2 bank_mask:0xf
    v_add_f32 v36, v36, v38
    v_max_f32 v61, v61, v36
    v_mov_b32_dpp v24, v32 quad_perm:[0,1,2,3] row_mask:0x4 bank_mask:0xf
    s_nop 0
    v_max_f32_dpp v61, v61, v61 row_ror:8 row_mask:0xf bank_mask:0xf
    s_nop 0
    v_mov_b32_dpp v24, v36 quad_perm:[0,1,2,3] row_mask:0x8 bank_mask:0xf
    v_max_f32_dpp v61, v61, v61 row_ror:4 row_mask:0xf bank_mask:0xf
    s_nop 1
    v_max_f32_dpp v61, v61, v61 row_ror:2 row_mask:0xf bank_mask:0xf
    s_nop 1
    v_max_f32_dpp v61, v61, v61 row_ror:1 row_mask:0xf bank_mask:0xf
    v_sub_f32 v36, v24, v61
    ds_write_b32 v59, v61
    v_exp_f32 v36, v36
    s_nop 0
    v_cvt_pk_bf16_f32 v39, v36, v36
    ds_write_b16 v58, v39
    ds_read_b128 v[12:15], v52
    ds_read_b128 v[16:19], v53
    ds_read_b128 v[20:23], v54
    ds_read_b128 v[24:27], v55
    ds_read_b128 v[28:31], v56
    ds_read_b128 v[32:35], v57
    v_add_f32_dpp v38, v36, v36 row_ror:8 row_mask:0xf bank_mask:0xf
    s_nop 1
    v_add_f32_dpp v38, v38, v38 row_ror:4 row_mask:0xf bank_mask:0xf
    s_nop 1
    v_add_f32_dpp v38, v38, v38 row_ror:2 row_mask:0xf bank_mask:0xf
    s_nop 1
    v_add_f32_dpp v38, v38, v38 row_ror:1 row_mask:0xf bank_mask:0xf
    s_nop 1
    v_add_f32_dpp v38, v38, v38 row_bcast:15 row_mask:0xa bank_mask:0xf
    s_nop 1
    v_add_f32_dpp v38, v38, v38 row_bcast:31 row_mask:0xc bank_mask:0xf
    s_waitcnt lgkmcnt(0)
    s_waitcnt vmcnt(32)
    s_barrier
    ds_read_b64_tr_b16 v[162:163], v8 offset:49152
    ds_read_b64_tr_b16 v[170:171], v9 offset:49152
    ds_read_b64_tr_b16 v[178:179], v10 offset:49152
    ds_read_b64_tr_b16 v[186:187], v11 offset:49152
    s_cmp_eq_u32 s30, 6
    s_cbranch_scc0 L_skip_88
    s_mov_b32 s57, 786432
    s_mov_b32 s58, 1178624
    s_mov_b32 m0, 124928
L_dma_89:
    s_nop 0
    buffer_load_dwordx4 v7, s[36:39], s57 offen offset:0 nt lds
    buffer_load_dwordx4 v7, s[36:39], s58 offen offset:1024 nt lds
    s_add_u32 s57, s57, 24576
    s_add_u32 s58, s58, 24576
    s_add_u32 m0, m0, 2048
    s_cmp_lg_u32 m0, 141312
    s_cbranch_scc1 L_dma_89
L_skip_88:
    s_waitcnt lgkmcnt(0)
    ds_read_b32 v36, v62
    s_waitcnt lgkmcnt(0)
    v_max_f32_dpp v37, v36, v36 row_ror:4 row_mask:0xf bank_mask:0xf
    s_nop 1
    v_max_f32_dpp v37, v37, v37 row_ror:2 row_mask:0xf bank_mask:0xf
    s_nop 1
    v_max_f32_dpp v37, v37, v37 row_ror:1 row_mask:0xf bank_mask:0xf
    v_sub_f32 v39, v61, v37
    v_exp_f32 v39, v39
    s_cmp_lt_u32 s30, 2
    s_cbranch_scc0 L_skip_90
    s_lshl_b32 s57, s30, 3
    v_lshlrev_b32 v2, 4, v0
    v_add_u32 v2, s57, v2
    v_add_u32 v2, 92160, v2
    v_mov_b32 v60, 94192
    v_cmp_le_u32 vcc, 48, v0
    s_nop 1
    v_cndmask_b32 v2, v2, v60, vcc
    s_lshr_b32 s57, s54, 1
    s_lshl_b32 s57, s57, 2
    s_and_b32 s58, s54, 1
    s_add_u32 s57, s57, s58
    s_lshl_b32 s58, s57, 4
    s_lshl_b32 s57, s57, 3
    v_bfe_u32 v3, v0, 3, 2
    v_lshlrev_b32 v3, 8, v3
    v_bfe_u32 v61, v0, 2, 1
    v_lshl_add_u32 v3, v61, 5, v3
    v_and_b32 v61, 3, v0
    v_lshl_add_u32 v3, v61, 2, v3
    v_add_u32 v3, s58, v3
    v_bfe_u32 v60, v0, 3, 1
    v_lshlrev_b32 v60, 8, v60
    v_bfe_u32 v61, v0, 1, 1
    v_lshl_add_u32 v60, v61, 7, v60
    v_bfe_u32 v61, v0, 2, 1
    v_lshl_add_u32 v60, v61, 4, v60
    v_and_b32 v61, 1, v0
    v_lshl_add_u32 v60, v61, 2, v60
    v_add_u32 v60, s57, v60
    v_add_u32 v60, 1024, v60
    v_cmp_gt_u32 vcc, 32, v0
    s_nop 1
    v_cndmask_b32 v3, v60, v3, vcc
    s_lshl_b32 s57, s53, 1
    s_add_u32 s57, s57, s30
    s_mul_i32 s57, s57, 1664
    s_add_u32 s57, s57, s62
    v_add_u32 v3, s57, v3
    v_mov_b32 v60, 0x7f000000
    v_cmp_le_u32 vcc, 48, v0
    s_nop 1
    v_cndmask_b32 v3, v3, v60, vcc
    s_lshl_b32 s58, s54, 2
    s_add_u32 s57, s57, s58
    s_add_u32 s57, s57, 1536
    v_mov_b32 v4, s57
    v_mov_b32 v60, 0x7f000000
    v_cmp_ne_u32 vcc, 48, v0
    s_nop 1
    v_cndmask_b32 v4, v4, v60, vcc
    s_mov_b32 s58, 0
    s_cmp_eq_u32 s55, 0
    s_cbranch_scc1 L_gs_91
    buffer_store_dword v37, v4, s[40:43], s58 offen
L_gb_92:
L_skip_90:
    s_cmp_eq_u32 s30, 2
    s_cbranch_scc0 L_skip_93
    v_lshlrev_b32 v2, 2, v0
    v_add_u32 v2, 157696, v2
    v_and_b32 v3, 15, v0
    v_lshlrev_b32 v3, 2, v3
    v_lshrrev_b32 v60, 5, v0
    v_lshl_add_u32 v3, v60, 6, v3
    v_bfe_u32 v60, v0, 4, 1
    v_lshl_add_u32 v3, v60, 13, v3
L_skip_93:
    s_waitcnt vmcnt(32)
    s_barrier
    ds_read_b64_tr_b16 v[194:195], v8 offset:0
    ds_read_b64_tr_b16 v[202:203], v9 offset:0
    ds_read_b64_tr_b16 v[210:211], v10 offset:0
    ds_read_b64_tr_b16 v[218:219], v11 offset:0
    s_cmp_eq_u32 s30, 6
    s_cbranch_scc0 L_skip_94
    s_mov_b32 s57, 786560
    s_mov_b32 s58, 1178752
    s_mov_b32 m0, 141312
L_dma_95:
    s_nop 0
    buffer_load_dwordx4 v7, s[36:39], s57 offen offset:0 nt lds
    buffer_load_dwordx4 v7, s[36:39], s58 offen offset:1024 nt lds
    s_add_u32 s57, s57, 24576
    s_add_u32 s58, s58, 24576
    s_add_u32 m0, m0, 2048
    s_cmp_lg_u32 m0, 157696
    s_cbranch_scc1 L_dma_95
L_skip_94:
    s_waitcnt lgkmcnt(0)
    s_waitcnt vmcnt(32)
    s_barrier
    ds_read_b64_tr_b16 v[226:227], v8 offset:16384
    ds_read_b64_tr_b16 v[234:235], v9 offset:16384
    ds_read_b64_tr_b16 v[242:243], v10 offset:16384
    ds_read_b64_tr_b16 v[250:251], v11 offset:16384
    s_cmp_eq_u32 s30, 6
    s_cbranch_scc0 L_skip_96
    s_mov_b32 s57, 786688
    s_mov_b32 s58, 1178880
    s_mov_b32 m0, 92160
L_dma_97:
    s_nop 0
    buffer_load_dwordx4 v7, s[36:39], s57 offen offset:0 nt lds
    buffer_load_dwordx4 v7, s[36:39], s58 offen offset:1024 nt lds
    s_add_u32 s57, s57, 24576
    s_add_u32 s58, s58, 24576
    s_add_u32 m0, m0, 2048
    s_cmp_lg_u32 m0, 108544
    s_cbranch_scc1 L_dma_97
L_skip_96:
    s_waitcnt lgkmcnt(0)
    s_cmp_eq_u32 s30, 5
    s_cbranch_scc0 L_skip_98
    global_load_dword v2, v3, s[26:27] offset:4 sc1
L_skip_98:
    s_waitcnt vmcnt(32)
    s_barrier
    ds_read_b64_tr_b16 v[164:165], v8 offset:32768
    ds_read_b64_tr_b16 v[172:173], v9 offset:32768
    ds_read_b64_tr_b16 v[180:181], v10 offset:32768
    ds_read_b64_tr_b16 v[188:189], v11 offset:32768
    s_cmp_eq_u32 s30, 6
    s_cbranch_scc0 L_skip_99
    s_mov_b32 s57, 983040
    s_mov_b32 s58, 1375232
    s_mov_b32 m0, 108544
L_dma_100:
    s_nop 0
    buffer_load_dwordx4 v7, s[36:39], s57 offen offset:0 nt lds
    buffer_load_dwordx4 v7, s[36:39], s58 offen offset:1024 nt lds
    s_add_u32 s57, s57, 24576
    s_add_u32 s58, s58, 24576
    s_add_u32 m0, m0, 2048
    s_cmp_lg_u32 m0, 124928
    s_cbranch_scc1 L_dma_100
L_skip_99:
    s_waitcnt lgkmcnt(0)
    s_waitcnt vmcnt(32)
    s_barrier
    ds_read_b64_tr_b16 v[196:197], v8 offset:49152
    ds_read_b64_tr_b16 v[204:205], v9 offset:49152
    ds_read_b64_tr_b16 v[212:213], v10 offset:49152
    ds_read_b64_tr_b16 v[220:221], v11 offset:49152
    s_cmp_eq_u32 s30, 6
    s_cbranch_scc0 L_skip_101
    s_mov_b32 s57, 983168
    s_mov_b32 s58, 1375360
    s_mov_b32 m0, 124928
L_dma_102:
    s_nop 0
    buffer_load_dwordx4 v7, s[36:39], s57 offen offset:0 nt lds
    buffer_load_dwordx4 v7, s[36:39], s58 offen offset:1024 nt lds
    s_add_u32 s57, s57, 24576
    s_add_u32 s58, s58, 24576
    s_add_u32 m0, m0, 2048
    s_cmp_lg_u32 m0, 141312
    s_cbranch_scc1 L_dma_102
L_skip_101:
    s_waitcnt lgkmcnt(0)
    s_cmp_eq_u32 s30, 5
    s_cbranch_scc0 L_skip_103
L_cw_104:
    s_waitcnt vmcnt(0)
    v_cmp_eq_u32 vcc, 0, v2
    s_cbranch_vccnz L_cr_105
    v_add_u32_dpp v2, v2, v2 row_ror:4 row_mask:0xf bank_mask:0xf
    s_nop 1
    v_add_u32_dpp v2, v2, v2 row_ror:2 row_mask:0xf bank_mask:0xf
    s_nop 1
    v_add_u32_dpp v2, v2, v2 row_ror:1 row_mask:0xf bank_mask:0xf
    v_mov_b32 v60, 160772
    ds_write_b32 v60, v2
    s_waitcnt lgkmcnt(0)
L_skip_103:
    s_cmp_lt_u32 s3, 20
    s_cbranch_scc0 L_skip_106
    s_mul_i32 s74, s30, 1664
    s_add_u32 s74, s74, s62
    s_add_u32 s74, s74, 0
    v_and_b32 v56, 7, v0
    v_lshlrev_b32 v56, 2, v56
    v_lshrrev_b32 v62, 4, v0
    v_lshlrev_b32 v62, 3, v62
    s_cmp_lg_u32 s30, 6
    s_cbranch_scc0 L_skip_106
    buffer_load_dword v52, v56, s[40:43], s74 offen offset:1536 sc1
    buffer_load_dwordx2 v[54:55], v62, s[40:43], s74 offen offset:1536 sc1
L_skip_106:
    s_cmp_eq_u32 s30, 2
    s_cbranch_scc0 L_skip_107
    s_sub_u32 s57, s3, 20
    s_cmp_lt_u32 s57, 4
    s_cbranch_scc0 L_skip_108
    s_sub_u32 s57, s3, 20
    s_lshl_b32 s57, s57, 6
    v_add_u32 v50, s57, v0
    v_min_u32 v50, 207, v50
    v_lshlrev_b32 v50, 7, v50
    s_add_u32 s57, s62, 0
    buffer_load_dword v50, v50, s[40:43], s57 offen sc1 nt
    s_sub_u32 s57, s3, 20
    s_lshl_b32 s57, s57, 6
    v_add_u32 v51, s57, v0
    v_min_u32 v51, 151, v51
    v_lshlrev_b32 v51, 7, v51
    s_add_u32 s57, s62, 26624
    buffer_load_dword v51, v51, s[40:43], s57 offen sc1 nt
    s_sub_u32 s57, s3, 20
    s_lshl_b32 s57, s57, 6
    v_add_u32 v49, s57, v0
    v_min_u32 v49, 191, v49
    v_lshlrev_b32 v49, 7, v49
    s_add_u32 s57, s62, 46080
    buffer_load_dword v49, v49, s[40:43], s57 offen sc1 nt
L_skip_108:
L_skip_107:
    s_waitcnt vmcnt(32)
    s_barrier
    ds_read_b64_tr_b16 v[228:229], v8 offset:0
    ds_read_b64_tr_b16 v[236:237], v9 offset:0
    ds_read_b64_tr_b16 v[244:245], v10 offset:0
    ds_read_b64_tr_b16 v[252:253], v11 offset:0
    s_cmp_eq_u32 s30, 6
    s_cbranch_scc0 L_skip_109
    s_mov_b32 s57, 983296
    s_mov_b32 s58, 1375488
    s_mov_b32 m0, 141312
L_dma_110:
    s_nop 0
    buffer_load_dwordx4 v7, s[36:39], s57 offen offset:0 nt lds
    buffer_load_dwordx4 v7, s[36:39], s58 offen offset:1024 nt lds
    s_add_u32 s57, s57, 24576
    s_add_u32 s58, s58, 24576
    s_add_u32 m0, m0, 2048
    s_cmp_lg_u32 m0, 157696
    s_cbranch_scc1 L_dma_110
L_skip_109:
    s_waitcnt lgkmcnt(0)
    s_cmp_ge_u32 s30, 6
    s_cbranch_scc0 L_skip_111
    v_mov_b32 v60, 160772
    ds_read_b32 v60, v60
    s_lshr_b32 s58, s63, 2
    s_waitcnt lgkmcnt(0)
    v_readfirstlane_b32 s57, v60
    s_cmp_gt_u32 s57, 24
    s_cselect_b32 s57, 1, 0
    s_xor_b32 s57, s57, s58
    s_lshl_b32 s57, s57, 13
    s_add_u32 s7, s8, s57
L_skip_111:
    s_branch L_tail
.p2align 10
L_tail:
L_pad0:
    s_cbranch_execz L_pad4
    s_waitcnt vmcnt(32)
    s_barrier
    ds_read_b64_tr_b16 v[166:167], v8 offset:16384
    ds_read_b64_tr_b16 v[174:175], v9 offset:16384
    ds_read_b64_tr_b16 v[182:183], v10 offset:16384
    ds_read_b64_tr_b16 v[190:191], v11 offset:16384
    s_waitcnt lgkmcnt(0)
    s_cmp_lt_u32 s30, 5
    s_cbranch_scc0 L_skip_112
    s_waitcnt vmcnt(0)
L_skip_112:
    s_cmp_lt_u32 s3, 20
    s_cbranch_scc0 L_skip_113
    v_lshlrev_b32 v57, 4, v0
    v_lshlrev_b32 v58, 3, v0
    s_mul_i32 s57, s30, 6144
    s_add_u32 s57, s57, 30720
    v_lshrrev_b32 v59, 2, v0
    v_lshlrev_b32 v59, 6, v59
    v_bfe_u32 v53, v0, 4, 1
    v_lshl_add_u32 v59, v53, 5, v59
    v_and_b32 v53, 3, v0
    v_lshl_add_u32 v59, v53, 3, v59
    v_add_u32 v59, s57, v59
    v_xor_b32 v60, 32, v59
    s_lshl_b32 s57, s30, 8
    s_add_u32 s57, s57, 157696
    v_lshl_add_u32 v61, v0, 2, s57
    s_cmp_lg_u32 s30, 6
    s_cbranch_scc0 L_skip_113
L_cw_114:
    s_waitcnt vmcnt(0)
    v_max3_u32 v53, v52, v54, v55
    v_cmp_eq_u32 vcc, -1, v53
    s_cbranch_vccnz L_cr_115
    v_max_f32_dpp v53, v52, v52 row_ror:4 row_mask:0xf bank_mask:0xf
    s_nop 1
    v_max_f32_dpp v53, v53, v53 row_ror:2 row_mask:0xf bank_mask:0xf
    s_nop 1
    v_max_f32_dpp v53, v53, v53 row_ror:1 row_mask:0xf bank_mask:0xf
    v_sub_f32 v52, v52, v53
    v_sub_f32 v54, v54, v53
    v_sub_f32 v55, v55, v53
    v_exp_f32 v52, v52
    v_exp_f32 v54, v54
    v_exp_f32 v55, v55
    s_cmp_eq_u32 s30, 7
    s_cbranch_scc0 L_skip_113
    v_add_u32 v62, 158720, v57
    ds_write_b128 v62, v[52:55]
    s_waitcnt lgkmcnt(0)
L_skip_113:
    v_smfmac_f32_16x16x64_bf16 v[40:43], v[12:15], v[160:167], v1
    v_smfmac_f32_16x16x64_bf16 v[40:43], v[16:19], v[168:175], v1
    v_smfmac_f32_16x16x64_bf16 v[40:43], v[20:23], v[176:183], v1
    v_smfmac_f32_16x16x64_bf16 v[40:43], v[24:27], v[184:191], v1
    s_cmp_eq_u32 s30, 6
    s_cbranch_scc0 L_skip_116
    s_mul_i32 s57, s14, 12
    s_add_u32 s58, s57, s15
    s_mov_b32 m0, 55296
L_dma_117:
    s_nop 0
    buffer_load_dwordx4 v3, s[48:51], s57 offen offset:0 nt lds
    buffer_load_dwordx4 v3, s[48:51], s58 offen offset:1024 nt lds
    s_add_u32 s57, s57, s14
    s_add_u32 s58, s58, s14
    s_add_u32 m0, m0, 2048
    s_cmp_lg_u32 m0, 67584
    s_cbranch_scc1 L_dma_117
    s_mul_i32 s57, s14, 18
    s_add_u32 s58, s57, s15
    s_mov_b32 m0, 67584
L_dma_118:
    s_nop 0
    buffer_load_dwordx4 v3, s[48:51], s57 offen offset:0 nt lds
    buffer_load_dwordx4 v3, s[48:51], s58 offen offset:1024 nt lds
    s_add_u32 s57, s57, s14
    s_add_u32 s58, s58, s14
    s_add_u32 m0, m0, 2048
    s_cmp_lg_u32 m0, 79872
    s_cbranch_scc1 L_dma_118
L_skip_116:
    s_waitcnt vmcnt(40)
    s_barrier
    ds_read_b64_tr_b16 v[198:199], v8 offset:32768
    ds_read_b64_tr_b16 v[206:207], v9 offset:32768
    ds_read_b64_tr_b16 v[214:215], v10 offset:32768
    ds_read_b64_tr_b16 v[222:223], v11 offset:32768
    s_waitcnt lgkmcnt(0)
    s_cmp_lt_u32 s3, 20
    s_cbranch_scc0 L_skip_119
    s_cmp_eq_u32 s30, 6
    s_cbranch_scc0 L_skip_119
    v_add_u32 v62, 158720, v57
    ds_read_b128 v[52:55], v62
L_skip_119:
L_pad1:
    s_cbranch_execz L_pad5
    v_smfmac_f32_16x16x64_bf16 v[40:43], v[28:31], v[192:199], v1
    v_smfmac_f32_16x16x64_bf16 v[40:43], v[32:35], v[200:207], v1
    v_smfmac_f32_16x16x64_bf16 v[44:47], v[12:15], v[208:215], v1
    v_smfmac_f32_16x16x64_bf16 v[44:47], v[16:19], v[216:223], v1
    v_mul_f32 v38, v38, v39
    ds_write_b32 v63, v38 offset:1024
    s_waitcnt vmcnt(24)
    s_barrier
    ds_read_b64_tr_b16 v[230:231], v8 offset:49152
    ds_read_b64_tr_b16 v[238:239], v9 offset:49152
    ds_read_b64_tr_b16 v[246:247], v10 offset:49152
    ds_read_b64_tr_b16 v[254:255], v11 offset:49152
    s_waitcnt lgkmcnt(0)
    v_smfmac_f32_16x16x64_bf16 v[44:47], v[20:23], v[224:231], v1
    v_smfmac_f32_16x16x64_bf16 v[44:47], v[24:27], v[232:239], v1
    v_smfmac_f32_16x16x64_bf16 v[44:47], v[28:31], v[240:247], v1
    v_smfmac_f32_16x16x64_bf16 v[44:47], v[32:35], v[248:255], v1
    s_setprio 0
    s_cmp_lt_u32 s30, 2
    v_pk_add_f32 v[40:41], v[40:41], v[42:43]
    s_nop 4
    v_pk_add_f32 v[42:43], v[44:45], v[46:47]
    v_pk_mul_f32 v[40:41], v[40:41], v[38:39] op_sel:[0,1] op_sel_hi:[1,1]
    v_pk_mul_f32 v[42:43], v[42:43], v[38:39] op_sel:[0,1] op_sel_hi:[1,1]
    ds_write_b128 v63, v[40:43]
    s_cbranch_scc1 L_comb_0
    s_waitcnt lgkmcnt(0)
    s_barrier
.p2align 5
L_comb_0b:
    s_cmp_eq_u32 s30, 6
    s_cbranch_scc0 L_skip_124
    s_waitcnt vmcnt(0)
L_skip_124:
    s_barrier
    s_cmp_lt_u32 s3, 20
    s_cbranch_scc0 L_typeB_0
    buffer_load_dwordx4 v[12:15], v57, s[40:43], s74 offen sc1
    buffer_load_dwordx2 v[16:17], v58, s[40:43], s74 offen offset:1024 sc1
    buffer_load_dword v18, v56, s[40:43], s74 offen offset:1568 sc1
    ds_read_b64_tr_b16 v[28:29], v59 offset:0
    ds_read_b64_tr_b16 v[30:31], v59 offset:1024
    ds_read_b64_tr_b16 v[32:33], v59 offset:2048
    ds_read_b64_tr_b16 v[34:35], v59 offset:3072
    ds_read_b64_tr_b16 v[36:37], v59 offset:4096
    ds_read_b64_tr_b16 v[38:39], v59 offset:5120
    ds_read_b64_tr_b16 v[40:41], v60 offset:0
    ds_read_b64_tr_b16 v[42:43], v60 offset:1024
    ds_read_b64_tr_b16 v[44:45], v60 offset:2048
    ds_read_b64_tr_b16 v[46:47], v60 offset:3072
    ds_read_b64_tr_b16 v[48:49], v60 offset:4096
    ds_read_b64_tr_b16 v[50:51], v60 offset:5120
    v_mov_b64 v[20:21], 0
    v_mov_b64 v[22:23], 0
    v_mov_b64 v[24:25], 0
    v_mov_b64 v[26:27], 0
    s_add_u32 s58, s6, 0
    s_waitcnt lgkmcnt(0)
    s_branch L_ow_125
.p2align 5
L_or_126:
    buffer_load_dwordx4 v[12:15], v57, s[40:43], s74 offen sc1
    buffer_load_dwordx2 v[16:17], v58, s[40:43], s74 offen offset:1024 sc1
    buffer_load_dword v18, v56, s[40:43], s74 offen offset:1568 sc1
    s_sub_u32 s56, s56, 1
    s_cbranch_scc1 L_done
    v_mov_b64 v[20:21], 0
    v_mov_b64 v[22:23], 0
    v_mov_b64 v[24:25], 0
    v_mov_b64 v[26:27], 0
L_ow_125:
    s_waitcnt vmcnt(2)
    v_smfmac_f32_16x16x64_bf16 v[20:23], v[12:15], v[28:35], v1
    s_nop 2
    v_smfmac_f32_16x16x64_bf16 v[24:27], v[12:15], v[40:47], v1
    s_waitcnt vmcnt(0)
    v_mul_f32 v53, v52, v18
    v_smfmac_f32_16x16x32_bf16 v[20:23], v[16:17], v[36:39], v1
    s_nop 2
    v_smfmac_f32_16x16x32_bf16 v[24:27], v[16:17], v[48:51], v1
    v_add_f32_dpp v53, v53, v53 row_ror:4 row_mask:0xf bank_mask:0xf
    v_max3_u32 v19, v12, v13, v14
    v_max3_u32 v62, v15, v16, v17
    v_add_f32_dpp v53, v53, v53 row_ror:2 row_mask:0xf bank_mask:0xf
L_pad2:
    s_cbranch_execz L_pad6
    v_max3_u32 v19, v19, v62, v18
    s_cmp_eq_u32 s30, 2
    v_add_f32_dpp v53, v53, v53 row_ror:1 row_mask:0xf bank_mask:0xf
    v_cmp_eq_u32 vcc, -1, v19
    v_rcp_f32 v53, v53
    s_cbranch_vccnz L_or_126
    v_pk_add_f32 v[20:21], v[20:21], v[22:23]
    v_pk_add_f32 v[24:25], v[24:25], v[26:27]
    v_pk_mul_f32 v[54:55], v[54:55], v[52:53] op_sel:[0,1] op_sel_hi:[1,1]
    v_mul_f32 v20, v20, v54
    v_mul_f32 v24, v24, v54
    v_fmac_f32 v20, v21, v55
    v_fmac_f32 v24, v25, v55
    s_nop 1
    v_permlane32_swap_b32 v20, v24
    v_add_f32 v20, v20, v24
    ds_write_b32 v61, v20
    s_waitcnt lgkmcnt(0)
    s_barrier
    s_cbranch_scc0 L_finb_127
    ds_read2st64_b32 v[12:13], v2 offset0:0 offset1:1
    ds_read2st64_b32 v[14:15], v2 offset0:2 offset1:3
    ds_read2st64_b32 v[16:17], v2 offset0:4 offset1:5
    ds_read2st64_b32 v[18:19], v2 offset0:6 offset1:7
    s_waitcnt lgkmcnt(2)
    v_pk_add_f32 v[12:13], v[12:13], v[14:15]
    s_waitcnt lgkmcnt(0)
    v_pk_add_f32 v[16:17], v[16:17], v[18:19]
    v_pk_add_f32 v[12:13], v[12:13], v[16:17]
    v_add_f32 v14, v12, v13
    v_add_f32 v15, v12, v13
    s_nop 1
    v_permlane16_swap_b32 v14, v15
    v_add_f32 v12, v14, v15
    buffer_store_dword v12, v3, s[40:43], s58 offen sc1
.p2align 5
L_finb_127:
    s_sub_u32 s57, s30, 4
    s_cmp_lt_u32 s57, 3
    s_cbranch_scc0 L_skip_128
    s_sub_u32 s60, s30, 4
    s_lshl_b32 s57, s60, 11
    v_lshlrev_b32 v11, 4, v0
    v_add_u32 v11, s57, v11
    s_add_u32 s65, s62, 19456
    buffer_load_dwordx4 v[52:55], v11, s[40:43], s65 offen offset:0 sc1
    buffer_load_dwordx4 v[56:59], v11, s[40:43], s65 offen offset:1024 sc1
    s_lshl_b32 s59, s60, 12
    s_add_u32 s59, s59, 79872
    s_mov_b32 s44, s20
    s_mov_b32 s45, s21
    s_mov_b32 s46, 1966080
    s_mov_b32 s47, 0x20000
    s_mul_i32 s57, s31, 3
    s_add_u32 s57, s57, s60
    s_mul_i32 s57, s57, 81920
    s_lshl_b32 s64, s3, 6
    s_add_u32 s57, s57, s64
    v_lshrrev_b32 v5, 2, v0
    v_mul_u32_u24 v5, 1280, v5
    v_and_b32 v60, 3, v0
    v_lshl_add_u32 v5, v60, 4, v5
    v_add_u32 v5, s57, v5
    s_add_u32 m0, s59, 0
    s_mov_b32 s57, 0
    buffer_load_dwordx4 v5, s[44:47], s57 offen nt lds
    s_add_u32 m0, s59, 1024
    s_mov_b32 s57, 20480
    buffer_load_dwordx4 v5, s[44:47], s57 offen nt lds
    s_add_u32 m0, s59, 2048
    s_mov_b32 s57, 40960
    buffer_load_dwordx4 v5, s[44:47], s57 offen nt lds
    s_add_u32 m0, s59, 3072
    s_mov_b32 s57, 61440
    buffer_load_dwordx4 v5, s[44:47], s57 offen nt lds
    v_bfe_u32 v35, v0, 4, 1
    v_lshlrev_b32 v35, 11, v35
    v_bfe_u32 v60, v0, 2, 2
    v_lshl_add_u32 v35, v60, 8, v35
    v_lshrrev_b32 v60, 5, v0
    v_lshl_add_u32 v35, v60, 6, v35
    v_and_b32 v60, 3, v0
    v_lshl_add_u32 v35, v60, 3, v35
    v_add_u32 v35, s59, v35
    v_mov_b32 v9, 0xbdd2d3e8
L_pad3:
    s_cbranch_execz L_pad7
    v_mov_b32 v10, 0xc0135761
    s_lshl_b32 s57, s60, 7
    s_add_u32 s57, s57, 159872
    v_lshlrev_b32 v32, 3, v0
    v_add_u32 v32, s57, v32
    v_lshlrev_b32 v33, 3, v0
    v_add_u32 v33, 129024, v33
    v_cmp_gt_u32 vcc, 16, v0
    s_nop 1
    v_cndmask_b32 v32, v33, v32, vcc
    v_and_b32 v33, 15, v0
    v_lshlrev_b32 v33, 3, v33
    v_lshrrev_b32 v60, 5, v0
    v_lshl_add_u32 v33, v60, 2, v33
    v_add_u32 v33, 159872, v33
    v_and_b32 v34, 15, v0
    v_lshlrev_b32 v34, 2, v34
    v_lshrrev_b32 v60, 5, v0
    v_lshl_add_u32 v34, v60, 6, v34
    v_bfe_u32 v60, v0, 4, 1
    v_lshl_add_u32 v34, v60, 13, v34
    s_add_u32 s60, s6, 66048
    s_add_u32 s58, s62, 13312
    s_add_u32 s57, s62, 25856
    v_and_b32 v7, 7, v0
    v_lshlrev_b32 v7, 3, v7
    v_mov_b32 v60, 0x3acccccd
    v_mov_b32 v61, 0x3727c5ac
    s_waitcnt vmcnt(0)
    buffer_load_dwordx2 v[24:25], v7, s[40:43], s57 offen sc1
    buffer_load_dwordx4 v[12:15], v11, s[40:43], s58 offen offset:0 sc1
    buffer_load_dwordx4 v[16:19], v11, s[40:43], s58 offen offset:1024 sc1
    ds_read_b64_tr_b16 v[36:37], v35 offset:0
    ds_read_b64_tr_b16 v[38:39], v35 offset:1024
    ds_read_b64_tr_b16 v[40:41], v35 offset:128
    ds_read_b64_tr_b16 v[42:43], v35 offset:1152
    ds_read_b64_tr_b16 v[44:45], v35 offset:32
    ds_read_b64_tr_b16 v[46:47], v35 offset:1056
    ds_read_b64_tr_b16 v[48:49], v35 offset:160
    ds_read_b64_tr_b16 v[50:51], v35 offset:1184
L_sw_131:
    v_max3_u32 v20, v52, v53, v54
    v_max3_u32 v20, v20, v55, v56
    v_max3_u32 v20, v20, v57, v58
    v_max_u32 v20, v20, v59
    v_cmp_eq_u32 vcc, -1, v20
    s_cbranch_vccnz L_sr_132
    v_pk_add_f32 v[28:29], v[52:53], v[56:57]
    v_pk_add_f32 v[30:31], v[54:55], v[58:59]
    s_nop 1
    v_permlane32_swap_b32 v28, v30
    v_permlane32_swap_b32 v29, v31
    v_pk_add_f32 v[28:29], v[28:29], v[30:31]
    s_nop 1
    v_permlane16_swap_b32 v28, v29
    v_add_f32 v28, v28, v29
    v_mov_b64 v[52:53], 0
    v_mov_b64 v[54:55], 0
    v_mov_b64 v[56:57], 0
    v_mov_b64 v[58:59], 0
    s_waitcnt lgkmcnt(0)
    s_branch L_pw_129
.p2align 5
L_pr_130:
    buffer_load_dwordx2 v[24:25], v7, s[40:43], s57 offen sc1
    buffer_load_dwordx4 v[12:15], v11, s[40:43], s58 offen offset:0 sc1
    buffer_load_dwordx4 v[16:19], v11, s[40:43], s58 offen offset:1024 sc1
    s_sub_u32 s56, s56, 1
    s_cbranch_scc1 L_done
L_pw_129:
    s_waitcnt vmcnt(0)
    v_max_u32 v20, v24, v25
    v_cmp_eq_u32 vcc, -1, v20
    s_cbranch_vccnz L_pr_130
    buffer_load_dwordx4 v[12:15], v11, s[40:43], s58 offen offset:0 sc1
    buffer_load_dwordx4 v[16:19], v11, s[40:43], s58 offen offset:1024 sc1
    v_add_f32_dpp v2, v24, v24 row_ror:4 row_mask:0xf bank_mask:0xf
    v_add_f32_dpp v3, v25, v25 row_ror:4 row_mask:0xf bank_mask:0xf
    v_pk_add_f32 v[20:21], v[12:13], v[16:17]
    v_pk_add_f32 v[22:23], v[14:15], v[18:19]
    v_add_f32_dpp v2, v2, v2 row_ror:2 row_mask:0xf bank_mask:0xf
    v_add_f32_dpp v3, v3, v3 row_ror:2 row_mask:0xf bank_mask:0xf
    v_permlane32_swap_b32 v20, v22
    v_permlane32_swap_b32 v21, v23
    v_add_f32_dpp v2, v2, v2 row_ror:1 row_mask:0xf bank_mask:0xf
L_pad4:
    s_cbranch_execz L_pad8
    v_add_f32_dpp v3, v3, v3 row_ror:1 row_mask:0xf bank_mask:0xf
    v_pk_add_f32 v[20:21], v[20:21], v[22:23]
    v_mul_f32 v2, v2, v60
    v_fma_f32 v3, v3, v60, v61
    v_permlane16_swap_b32 v20, v21
    v_fma_f32 v3, -v2, v2, v3
    v_add_f32 v20, v20, v21
    v_max_f32 v3, v3, v61
    v_mul_f32 v26, v28, v2
    v_rsq_f32 v3, v3
    v_cmp_u_f32 vcc, v20, v20
    v_sub_f32 v20, v20, v26
    s_cbranch_vccnz L_hr_133
L_hk_134:
    v_fma_f32 v20, v20, v3, v4
    v_mul_f32 v21, v20, v20
    v_mul_f32 v22, v20, v9
    v_mul_f32 v23, v20, v10
    v_fma_f32 v21, v21, v22, v23
    v_exp_f32 v21, v21
    s_nop 0
    v_add_f32 v21, 1.0, v21
    v_rcp_f32 v21, v21
    s_nop 0
    v_mul_f32 v20, v20, v21
    s_nop 1
    v_mov_b32_dpp v21, v20 row_shl:1 row_mask:0xf bank_mask:0xf bound_ctrl:0
    v_cvt_pk_bf16_f32 v28, v20, v21
    s_nop 1
    v_mov_b32_dpp v29, v28 row_shl:4 row_mask:0xf bank_mask:0xf bound_ctrl:0
    v_mov_b32_dpp v30, v28 row_shl:8 row_mask:0xf bank_mask:0xf bound_ctrl:0
    v_mov_b32_dpp v31, v28 row_shl:12 row_mask:0xf bank_mask:0xf bound_ctrl:0
    s_nop 1
    v_smfmac_f32_16x16x64_bf16 v[52:55], v[28:31], v[36:43], v1
    v_smfmac_f32_16x16x64_bf16 v[56:59], v[28:31], v[44:51], v1
    s_cmp_eq_u32 s30, 4
    s_nop 5
    v_add_f32 v22, v52, v54
    v_add_f32 v23, v56, v58
    ds_write_b64 v32, v[22:23]
    s_cbranch_scc0 L_skip_136
.p2align 5
L_xw_137:
    ds_read2_b32 v[20:21], v33 offset0:0 offset1:32
    ds_read_b32 v22, v33 offset:256
    s_sub_u32 s56, s56, 1
    s_cbranch_scc1 L_done
    s_waitcnt lgkmcnt(0)
    v_max3_u32 v23, v20, v21, v22
    v_add_f32 v20, v20, v21
    v_cmp_eq_u32 vcc, -1, v23
    v_add_f32 v20, v20, v22
    s_cbranch_vccnz L_xw_137
    buffer_store_dword v20, v34, s[40:43], s60 offen sc1
    s_waitcnt vmcnt(1)
    s_branch L_pe_138
.p2align 5
L_skip_136:
    s_waitcnt vmcnt(0)
L_pe_138:
L_skip_128:
    s_branch L_p1
.p2align 5
L_typeB_0:
    s_cmp_eq_u32 s53, 3
    s_cbranch_scc0 L_typeC_139
    s_cmp_eq_u32 s30, 7
    s_cbranch_scc1 L_w7_150
    s_cmp_lt_u32 s30, 6
    s_cbranch_scc0 L_skip_152
    s_lshr_b32 s57, s30, 1
    s_mul_i32 s57, s57, 128
    s_and_b32 s58, s30, 1
    s_lshl_b32 s58, s58, 6
    s_add_u32 s57, s57, s58
    v_lshrrev_b32 v18, 5, v0
    v_lshlrev_b32 v18, 13, v18
    v_bfe_u32 v60, v0, 3, 1
    v_lshl_add_u32 v18, v60, 12, v18
    v_bfe_u32 v60, v0, 4, 1
    v_lshl_add_u32 v18, v60, 11, v18
    v_bfe_u32 v60, v0, 2, 1
    v_mul_u32_u24 v60, 384, v60
    v_add_u32 v18, v60, v18
    v_and_b32 v60, 3, v0
    v_lshl_add_u32 v18, v60, 3, v18
    v_add_u32 v18, s57, v18
    v_add_u32 v18, 30720, v18
    v_bfe_u32 v19, v0, 3, 1
    v_lshlrev_b32 v19, 12, v19
    v_bfe_u32 v60, v0, 4, 1
    v_lshl_add_u32 v19, v60, 11, v19
L_pad5:
    s_cbranch_execz L_pad9
    v_bfe_u32 v60, v0, 2, 1
    v_mul_u32_u24 v60, 384, v60
    v_add_u32 v19, v60, v19
    v_and_b32 v60, 3, v0
    v_lshl_add_u32 v19, v60, 3, v19
    v_lshrrev_b32 v60, 5, v0
    v_lshl_add_u32 v19, v60, 5, v19
    v_add_u32 v19, s57, v19
    v_add_u32 v19, 63488, v19
    ds_read_b64_tr_b16 v[28:29], v18 offset:0
    ds_read_b64_tr_b16 v[30:31], v18 offset:1024
    ds_read_b64_tr_b16 v[32:33], v18 offset:16384
    ds_read_b64_tr_b16 v[34:35], v18 offset:17408
    ds_read_b64_tr_b16 v[36:37], v18 offset:32
    ds_read_b64_tr_b16 v[38:39], v18 offset:1056
    ds_read_b64_tr_b16 v[40:41], v18 offset:16416
    ds_read_b64_tr_b16 v[42:43], v18 offset:17440
    ds_read_b64_tr_b16 v[24:25], v19 offset:0
    ds_read_b64_tr_b16 v[26:27], v19 offset:1024
    v_lshrrev_b32 v49, 4, v0
    v_lshlrev_b32 v49, 5, v49
    v_bfe_u32 v60, v0, 1, 1
    v_lshl_add_u32 v49, v60, 4, v49
    v_bfe_u32 v60, v0, 3, 1
    v_mul_u32_u24 v60, 192, v60
    v_add_u32 v49, v60, v49
    v_add_u32 v49, 160832, v49
    v_bfe_u32 v50, v0, 1, 1
    v_lshlrev_b32 v50, 4, v50
    v_bfe_u32 v60, v0, 3, 1
    v_mul_u32_u24 v60, 192, v60
    v_add_u32 v50, v60, v50
    v_add_u32 v50, 160960, v50
    v_mov_b32 v60, 160992
    v_and_b32 v51, 5, v0
    v_cmp_eq_u32 vcc, 0, v51
    s_nop 1
    v_cndmask_b32 v9, v60, v49, vcc
    v_cmp_eq_u32 vcc, 4, v51
    s_nop 1
    v_cndmask_b32 v10, v60, v49, vcc
    v_lshrrev_b32 v49, 2, v0
    v_and_b32 v49, 12, v49
    v_cmp_eq_u32 vcc, v49, v51
    s_nop 1
    v_cndmask_b32 v48, v60, v50, vcc
    v_mov_b64 v[44:45], 0
    v_mov_b64 v[46:47], 0
    s_lshr_b32 s57, s30, 1
    s_lshl_b32 s57, s57, 11
    s_lshl_b32 s58, s58, 1
    s_add_u32 s57, s57, s58
    s_lshl_b32 s58, s54, 8
    s_add_u32 s57, s57, s58
    v_and_b32 v11, 31, v0
    v_lshlrev_b32 v11, 2, v11
    v_lshrrev_b32 v60, 5, v0
    v_lshl_add_u32 v11, v60, 30, v11
    v_add_u32 v11, s57, v11
    v_xor_b32 v49, 0x40000000, v11
    s_add_u32 s59, s62, 13312
    s_add_u32 s60, s62, 25856
    ds_read_b128 v[12:15], v9
    ds_read_b128 v[16:19], v10
    ds_read_b128 v[20:23], v48
    s_waitcnt lgkmcnt(2)
    v_smfmac_f32_16x16x64_bf16 v[44:47], v[12:15], v[28:35], v1
    s_waitcnt lgkmcnt(1)
    v_smfmac_f32_16x16x64_bf16 v[44:47], v[16:19], v[36:43], v1
    s_waitcnt lgkmcnt(0)
    v_smfmac_f32_16x16x64_bf16 v[44:47], v[20:23], v[24:31], v1
    s_add_u32 s60, s62, 19456
    s_cmp_eq_u32 s55, 0
    s_nop 5
    v_add_f32 v12, v44, v46
    s_cbranch_scc1 L_gs_153
    buffer_store_dword v12, v49, s[40:43], s60 offen
L_gb_154:
    v_mov_b64 v[44:45], 0
    v_mov_b64 v[46:47], 0
L_skip_152:
    s_cmp_lt_u32 s30, 6
    s_barrier
    s_cbranch_scc0 L_se_151
    ds_read_b128 v[12:15], v9
    ds_read_b128 v[16:19], v10
    ds_read_b128 v[20:23], v48
    s_waitcnt lgkmcnt(2)
    v_smfmac_f32_16x16x64_bf16 v[44:47], v[12:15], v[28:35], v1
L_pad6:
    s_cbranch_execz L_pad10
    s_waitcnt lgkmcnt(1)
    v_smfmac_f32_16x16x64_bf16 v[44:47], v[16:19], v[36:43], v1
    s_waitcnt lgkmcnt(0)
    v_smfmac_f32_16x16x64_bf16 v[44:47], v[20:23], v[24:31], v1
    s_cmp_eq_u32 s55, 0
    s_nop 6
    v_add_f32 v12, v44, v46
    s_cbranch_scc1 L_gs_155
    buffer_store_dword v12, v11, s[40:43], s59 offen
L_gb_156:
.p2align 5
L_se_151:
L_p1:
    s_lshl_b32 s57, s30, 7
    s_add_u32 s57, s57, 158720
    v_lshrrev_b32 v58, 4, v0
    v_lshlrev_b32 v58, 5, v58
    v_bfe_u32 v60, v0, 1, 1
    v_lshl_add_u32 v58, v60, 4, v58
    v_bfe_u32 v60, v0, 2, 2
    v_lshl_add_u32 v58, v60, 2, v58
    v_and_b32 v60, 1, v0
    v_lshl_add_u32 v58, v60, 1, v58
    v_add_u32 v58, s57, v58
    v_lshrrev_b32 v61, 4, v0
    v_lshlrev_b32 v61, 5, v61
    v_bfe_u32 v60, v0, 1, 1
    v_lshl_add_u32 v61, v60, 4, v61
    v_add_u32 v61, s57, v61
    v_bfe_u32 v62, v0, 2, 2
    v_lshlrev_b32 v62, 1, v62
    v_and_b32 v60, 1, v0
    v_lshl_add_u32 v62, v60, 0, v62
    v_mov_b32 v60, 160992
    v_cmp_eq_u32 vcc, 0, v62
    s_nop 1
    v_cndmask_b32 v52, v60, v61, vcc
    v_cmp_eq_u32 vcc, 1, v62
    s_nop 1
    v_cndmask_b32 v53, v60, v61, vcc
    v_cmp_eq_u32 vcc, 2, v62
    s_nop 1
    v_cndmask_b32 v54, v60, v61, vcc
    v_cmp_eq_u32 vcc, 3, v62
    s_nop 1
    v_cndmask_b32 v55, v60, v61, vcc
    v_cmp_eq_u32 vcc, 4, v62
    s_nop 1
    v_cndmask_b32 v56, v60, v61, vcc
    v_cmp_eq_u32 vcc, 5, v62
    s_nop 1
    v_cndmask_b32 v57, v60, v61, vcc
    s_lshl_b32 s58, s30, 2
    s_add_u32 s58, s58, 159808
    v_mov_b32 v60, s58
    v_lshlrev_b32 v59, 2, v0
    v_add_u32 v59, 158208, v59
    v_cmp_eq_u32 vcc, 63, v0
    s_nop 1
    v_cndmask_b32 v59, v59, v60, vcc
    v_and_b32 v62, 7, v0
    v_lshlrev_b32 v62, 2, v62
    v_add_u32 v62, 159808, v62
    s_lshl_b32 s57, s30, 11
    v_lshlrev_b32 v63, 4, v0
    v_add_u32 v63, s57, v63
    v_add_u32 v63, 92160, v63
    s_sub_u32 s57, s30, 1
    s_lshl_b32 s58, s57, 11
    v_lshlrev_b32 v7, 4, v0
    v_add_u32 v7, s58, v7
    s_lshl_b32 s58, s57, 7
    v_bfe_u32 v8, v0, 2, 2
    v_lshlrev_b32 v8, 5, v8
    v_lshrrev_b32 v60, 5, v0
    v_lshl_add_u32 v8, v60, 4, v8
    v_and_b32 v60, 3, v0
    v_lshl_add_u32 v8, v60, 2, v8
    v_bfe_u32 v60, v0, 4, 1
    v_lshl_add_u32 v8, v60, 1, v8
    v_add_u32 v8, s58, v8
    v_add_u32 v8, 124928, v8
    s_cmp_eq_u32 s30, 7
    s_cbranch_scc1 L_w7_164
    s_cmp_lt_u32 s30, 6
    s_cbranch_scc0 L_skip_166
    s_lshr_b32 s57, s30, 1
    s_mul_i32 s57, s57, 1024
    s_and_b32 s58, s30, 1
    s_lshl_b32 s58, s58, 6
    s_add_u32 s57, s57, s58
    v_lshrrev_b32 v18, 5, v0
    v_mul_u32_u24 v18, 6144, v18
    v_bfe_u32 v60, v0, 3, 1
    v_mul_u32_u24 v60, 3072, v60
    v_add_u32 v18, v60, v18
    v_bfe_u32 v60, v0, 4, 1
    v_lshl_add_u32 v18, v60, 9, v18
L_pad7:
    s_cbranch_execz L_pad11
    v_bfe_u32 v60, v0, 2, 1
    v_lshl_add_u32 v18, v60, 7, v18
    v_and_b32 v60, 3, v0
    v_lshl_add_u32 v18, v60, 3, v18
    v_add_u32 v18, s57, v18
    v_bfe_u32 v19, v0, 3, 1
    v_mul_u32_u24 v19, 3072, v19
    v_bfe_u32 v60, v0, 4, 1
    v_lshl_add_u32 v19, v60, 9, v19
    v_bfe_u32 v60, v0, 2, 1
    v_lshl_add_u32 v19, v60, 7, v19
    v_and_b32 v60, 3, v0
    v_lshl_add_u32 v19, v60, 3, v19
    v_lshrrev_b32 v60, 5, v0
    v_lshl_add_u32 v19, v60, 5, v19
    v_add_u32 v19, s57, v19
    v_add_u32 v19, 24576, v19
    ds_read_b64_tr_b16 v[28:29], v18 offset:0
    ds_read_b64_tr_b16 v[30:31], v18 offset:256
    ds_read_b64_tr_b16 v[32:33], v18 offset:12288
    ds_read_b64_tr_b16 v[34:35], v18 offset:12544
    ds_read_b64_tr_b16 v[36:37], v18 offset:32
    ds_read_b64_tr_b16 v[38:39], v18 offset:288
    ds_read_b64_tr_b16 v[40:41], v18 offset:12320
    ds_read_b64_tr_b16 v[42:43], v18 offset:12576
    ds_read_b64_tr_b16 v[24:25], v19 offset:0
    ds_read_b64_tr_b16 v[26:27], v19 offset:256
    v_lshrrev_b32 v49, 4, v0
    v_lshlrev_b32 v49, 5, v49
    v_bfe_u32 v60, v0, 1, 1
    v_lshl_add_u32 v49, v60, 4, v49
    v_bfe_u32 v60, v0, 3, 1
    v_mul_u32_u24 v60, 192, v60
    v_add_u32 v49, v60, v49
    v_add_u32 v49, 160832, v49
    v_bfe_u32 v50, v0, 1, 1
    v_lshlrev_b32 v50, 4, v50
    v_bfe_u32 v60, v0, 3, 1
    v_mul_u32_u24 v60, 192, v60
    v_add_u32 v50, v60, v50
    v_add_u32 v50, 160960, v50
    v_mov_b32 v60, 160992
    v_and_b32 v51, 5, v0
    v_cmp_eq_u32 vcc, 0, v51
    s_nop 1
    v_cndmask_b32 v9, v60, v49, vcc
    v_cmp_eq_u32 vcc, 4, v51
    s_nop 1
    v_cndmask_b32 v10, v60, v49, vcc
    v_lshrrev_b32 v49, 2, v0
    v_and_b32 v49, 12, v49
    v_cmp_eq_u32 vcc, v49, v51
    s_nop 1
    v_cndmask_b32 v48, v60, v50, vcc
    v_mov_b64 v[44:45], 0
    v_mov_b64 v[46:47], 0
    s_lshr_b32 s57, s30, 1
    s_lshl_b32 s57, s57, 11
    s_lshl_b32 s58, s58, 1
    s_add_u32 s57, s57, s58
    s_lshl_b32 s58, s54, 8
    s_add_u32 s57, s57, s58
    v_and_b32 v11, 31, v0
    v_lshlrev_b32 v11, 2, v11
    v_lshrrev_b32 v60, 5, v0
    v_lshl_add_u32 v11, v60, 30, v11
    v_add_u32 v11, s57, v11
    s_mul_i32 s59, s53, 6144
    s_add_u32 s59, s59, s62
    s_add_u32 s59, s59, 46080
    s_lshl_b32 s60, s53, 6
    s_add_u32 s60, s60, s62
    s_add_u32 s60, s60, 25600
L_skip_166:
    s_cmp_lt_u32 s30, 6
    s_barrier
    s_cbranch_scc0 L_se_165
    ds_read_b128 v[12:15], v9
    ds_read_b128 v[16:19], v10
    ds_read_b128 v[20:23], v48
    s_waitcnt lgkmcnt(2)
    v_smfmac_f32_16x16x64_bf16 v[44:47], v[12:15], v[28:35], v1
    s_waitcnt lgkmcnt(1)
    v_smfmac_f32_16x16x64_bf16 v[44:47], v[16:19], v[36:43], v1
    s_waitcnt lgkmcnt(0)
    v_smfmac_f32_16x16x64_bf16 v[44:47], v[20:23], v[24:31], v1
L_pad8:
    s_cbranch_execz L_pad12
    s_cmp_eq_u32 s55, 0
    s_nop 6
    v_add_f32 v12, v44, v46
    s_cbranch_scc1 L_gs_167
    buffer_store_dword v12, v11, s[40:43], s59 offen
L_gb_168:
.p2align 5
L_se_165:
    s_sub_u32 s57, s30, 1
    s_cmp_lt_u32 s57, 3
    s_cbranch_scc0 L_qo_182
    v_and_b32 v9, 7, v0
    v_lshlrev_b32 v9, 3, v9
    buffer_load_dwordx2 v[10:11], v9, s[40:43], s60 offen sc1
    buffer_load_dwordx4 v[40:43], v7, s[40:43], s59 offen offset:0 sc1
    buffer_load_dwordx4 v[44:47], v7, s[40:43], s59 offen offset:1024 sc1
    v_mov_b64 v[24:25], 0
    v_mov_b64 v[26:27], 0
    v_mov_b64 v[28:29], 0
    v_mov_b64 v[30:31], 0
    v_mov_b64 v[32:33], 0
    v_mov_b64 v[34:35], 0
    v_mov_b64 v[36:37], 0
    v_mov_b64 v[38:39], 0
    v_lshrrev_b32 v5, 4, v0
    v_lshlrev_b32 v5, 5, v5
    v_bfe_u32 v60, v0, 1, 1
    v_lshl_add_u32 v5, v60, 4, v5
    v_add_u32 v5, 124928, v5
    v_mov_b32 v60, 0x3c75e03e
    v_mov_b32 v61, 0x3a71d1e6
    v_mov_b32 v51, 0x3e13985d
    s_branch L_pw_184
.p2align 5
L_pr_185:
    buffer_load_dwordx2 v[10:11], v9, s[40:43], s60 offen sc1
    buffer_load_dwordx4 v[40:43], v7, s[40:43], s59 offen offset:0 sc1
    buffer_load_dwordx4 v[44:47], v7, s[40:43], s59 offen offset:1024 sc1
    s_sub_u32 s56, s56, 1
    s_cbranch_scc1 L_done
L_pw_184:
    s_waitcnt vmcnt(0)
    v_max_u32 v20, v10, v11
    v_cmp_eq_u32 vcc, -1, v20
    s_cbranch_vccnz L_pr_185
    buffer_load_dwordx4 v[40:43], v7, s[40:43], s59 offen offset:0 sc1
    buffer_load_dwordx4 v[44:47], v7, s[40:43], s59 offen offset:1024 sc1
    v_add_f32_dpp v48, v10, v10 row_ror:4 row_mask:0xf bank_mask:0xf
    v_add_f32_dpp v49, v11, v11 row_ror:4 row_mask:0xf bank_mask:0xf
    v_pk_add_f32 v[20:21], v[40:41], v[44:45]
    v_pk_add_f32 v[22:23], v[42:43], v[46:47]
    v_add_f32_dpp v48, v48, v48 row_ror:2 row_mask:0xf bank_mask:0xf
    v_add_f32_dpp v49, v49, v49 row_ror:2 row_mask:0xf bank_mask:0xf
    v_permlane32_swap_b32 v20, v22
    v_permlane32_swap_b32 v21, v23
    v_add_f32_dpp v48, v48, v48 row_ror:1 row_mask:0xf bank_mask:0xf
    v_add_f32_dpp v49, v49, v49 row_ror:1 row_mask:0xf bank_mask:0xf
    v_pk_add_f32 v[20:21], v[20:21], v[22:23]
    v_mul_f32 v48, v48, v60
    v_fma_f32 v49, v49, v51, v61
    v_permlane16_swap_b32 v20, v21
    v_fma_f32 v49, -v48, v48, v49
    v_add_f32 v20, v20, v21
    v_max_f32 v49, v49, v61
    v_mul_f32 v50, v6, v48
    v_rsq_f32 v49, v49
    v_cmp_u_f32 vcc, v20, v20
    v_sub_f32 v20, v20, v50
    s_cbranch_vccnz L_hr_186
L_hk_187:
    v_mul_f32 v20, v20, v49
    v_cvt_pk_bf16_f32 v20, v20, v20
    ds_write_b16 v8, v20
L_qb_183:
    s_waitcnt lgkmcnt(0)
    s_barrier
    ds_read_b128 v[12:15], v5 offset:0
    ds_read_b128 v[16:19], v5 offset:128
    ds_read_b128 v[20:23], v5 offset:256
    s_cmp_lt_u32 s30, 4
    s_waitcnt lgkmcnt(0)
    v_smfmac_f32_16x16x64_bf16 v[24:27], v[12:15], v[64:71], v1
    v_smfmac_f32_16x16x64_bf16 v[24:27], v[16:19], v[72:79], v1
    v_smfmac_f32_16x16x64_bf16 v[24:27], v[20:23], v[80:87], v1
    v_smfmac_f32_16x16x64_bf16 v[28:31], v[12:15], v[88:95], v1
    v_smfmac_f32_16x16x64_bf16 v[28:31], v[16:19], v[96:103], v1
    v_smfmac_f32_16x16x64_bf16 v[28:31], v[20:23], v[104:111], v1
    v_smfmac_f32_16x16x64_bf16 v[32:35], v[12:15], v[112:119], v1
    v_smfmac_f32_16x16x64_bf16 v[32:35], v[16:19], v[120:127], v1
L_pad9:
    s_cbranch_execz L_pad13
    v_smfmac_f32_16x16x64_bf16 v[32:35], v[20:23], v[128:135], v1
    v_smfmac_f32_16x16x64_bf16 v[36:39], v[12:15], v[136:143], v1
    v_smfmac_f32_16x16x64_bf16 v[36:39], v[16:19], v[144:151], v1
    v_smfmac_f32_16x16x64_bf16 v[36:39], v[20:23], v[152:159], v1
    v_add_f32 v24, v24, v26
    s_waitcnt vmcnt(0)
    v_add_f32 v28, v28, v30
    s_nop 1
    v_add_f32 v32, v32, v34
    v_max3_f32 v61, v24, v28, v32
    v_mov_b32_dpp v24, v28 quad_perm:[0,1,2,3] row_mask:0x2 bank_mask:0xf
    v_add_f32 v36, v36, v38
    v_max_f32 v61, v61, v36
    v_mov_b32_dpp v24, v32 quad_perm:[0,1,2,3] row_mask:0x4 bank_mask:0xf
    s_nop 0
    v_max_f32_dpp v61, v61, v61 row_ror:8 row_mask:0xf bank_mask:0xf
    s_nop 0
    v_mov_b32_dpp v24, v36 quad_perm:[0,1,2,3] row_mask:0x8 bank_mask:0xf
    v_max_f32_dpp v61, v61, v61 row_ror:4 row_mask:0xf bank_mask:0xf
    s_nop 1
    v_max_f32_dpp v61, v61, v61 row_ror:2 row_mask:0xf bank_mask:0xf
    s_nop 1
    v_max_f32_dpp v61, v61, v61 row_ror:1 row_mask:0xf bank_mask:0xf
    v_sub_f32 v36, v24, v61
    ds_write_b32 v59, v61
    v_exp_f32 v36, v36
    s_nop 0
    v_cvt_pk_bf16_f32 v39, v36, v36
    ds_write_b16 v58, v39
    ds_read_b128 v[12:15], v52
    ds_read_b128 v[16:19], v53
    ds_read_b128 v[20:23], v54
    ds_read_b128 v[24:27], v55
    ds_read_b128 v[28:31], v56
    ds_read_b128 v[32:35], v57
    v_add_f32_dpp v38, v36, v36 row_ror:8 row_mask:0xf bank_mask:0xf
    v_mov_b64 v[40:41], 0
    v_mov_b64 v[42:43], 0
    v_add_f32_dpp v38, v38, v38 row_ror:4 row_mask:0xf bank_mask:0xf
    v_mov_b64 v[44:45], 0
    v_mov_b64 v[46:47], 0
    s_waitcnt lgkmcnt(5)
    v_smfmac_f32_16x16x64_bf16 v[40:43], v[12:15], v[160:167], v1
    v_add_f32_dpp v38, v38, v38 row_ror:2 row_mask:0xf bank_mask:0xf
    v_smfmac_f32_16x16x64_bf16 v[44:47], v[12:15], v[208:215], v1
    ds_read_b32 v36, v62
    s_waitcnt lgkmcnt(5)
    v_smfmac_f32_16x16x64_bf16 v[40:43], v[16:19], v[168:175], v1
    v_add_f32_dpp v38, v38, v38 row_ror:1 row_mask:0xf bank_mask:0xf
    v_smfmac_f32_16x16x64_bf16 v[44:47], v[16:19], v[216:223], v1
    s_waitcnt lgkmcnt(4)
    v_smfmac_f32_16x16x64_bf16 v[40:43], v[20:23], v[176:183], v1
    v_add_f32_dpp v38, v38, v38 row_bcast:15 row_mask:0xa bank_mask:0xf
    v_smfmac_f32_16x16x64_bf16 v[44:47], v[20:23], v[224:231], v1
    s_waitcnt lgkmcnt(0)
    v_max_f32_dpp v37, v36, v36 row_ror:4 row_mask:0xf bank_mask:0xf
    v_smfmac_f32_16x16x64_bf16 v[40:43], v[24:27], v[184:191], v1
    v_add_f32_dpp v38, v38, v38 row_bcast:31 row_mask:0xc bank_mask:0xf
    v_smfmac_f32_16x16x64_bf16 v[44:47], v[24:27], v[232:239], v1
    v_max_f32_dpp v37, v37, v37 row_ror:2 row_mask:0xf bank_mask:0xf
    v_smfmac_f32_16x16x64_bf16 v[40:43], v[28:31], v[192:199], v1
    v_cmp_eq_u32 vcc, -1, v36
    v_smfmac_f32_16x16x64_bf16 v[44:47], v[28:31], v[240:247], v1
    v_max_f32_dpp v37, v37, v37 row_ror:1 row_mask:0xf bank_mask:0xf
    v_smfmac_f32_16x16x64_bf16 v[40:43], v[32:35], v[200:207], v1
    v_sub_f32 v39, v61, v37
    v_smfmac_f32_16x16x64_bf16 v[44:47], v[32:35], v[248:255], v1
    v_exp_f32 v39, v39
    s_cbranch_vccnz L_mr_189
L_mk_190:
    v_mul_f32 v38, v38, v39
    ds_write_b32 v63, v38 offset:1024
    s_cmp_lt_u32 s30, 2
    s_nop 0
    v_pk_add_f32 v[40:41], v[40:41], v[42:43]
    s_nop 0
    v_pk_add_f32 v[42:43], v[44:45], v[46:47]
    v_pk_mul_f32 v[40:41], v[40:41], v[38:39] op_sel:[0,1] op_sel_hi:[1,1]
    v_pk_mul_f32 v[42:43], v[42:43], v[38:39] op_sel:[0,1] op_sel_hi:[1,1]
    ds_write_b128 v63, v[40:43]
L_pad10:
    s_cbranch_execz L_pad14
    s_cbranch_scc1 L_comb_1
    s_waitcnt lgkmcnt(0)
    s_barrier
.p2align 5
L_comb_1b:
    s_cmp_lt_u32 s3, 20
    s_cbranch_scc0 L_typeB_1
    s_mul_i32 s74, s30, 1664
    s_add_u32 s74, s74, s62
    s_add_u32 s74, s74, 26624
    v_and_b32 v56, 7, v0
    v_lshlrev_b32 v56, 2, v56
    v_lshrrev_b32 v62, 4, v0
    v_lshlrev_b32 v62, 3, v62
    buffer_load_dword v52, v56, s[40:43], s74 offen offset:1536 sc1
    buffer_load_dwordx2 v[54:55], v62, s[40:43], s74 offen offset:1536 sc1
    v_lshlrev_b32 v57, 4, v0
    v_lshlrev_b32 v58, 3, v0
    s_mul_i32 s57, s30, 6144
    s_add_u32 s57, s57, 30720
    v_lshrrev_b32 v59, 2, v0
    v_lshlrev_b32 v59, 6, v59
    v_bfe_u32 v53, v0, 4, 1
    v_lshl_add_u32 v59, v53, 5, v59
    v_and_b32 v53, 3, v0
    v_lshl_add_u32 v59, v53, 3, v59
    v_add_u32 v59, s57, v59
    v_xor_b32 v60, 32, v59
    s_lshl_b32 s57, s30, 8
    s_add_u32 s57, s57, 157696
    v_lshl_add_u32 v61, v0, 2, s57
    ds_read_b64_tr_b16 v[28:29], v59 offset:0
    ds_read_b64_tr_b16 v[30:31], v59 offset:1024
    ds_read_b64_tr_b16 v[32:33], v59 offset:2048
    ds_read_b64_tr_b16 v[34:35], v59 offset:3072
    ds_read_b64_tr_b16 v[36:37], v59 offset:4096
    ds_read_b64_tr_b16 v[38:39], v59 offset:5120
    ds_read_b64_tr_b16 v[40:41], v60 offset:0
    ds_read_b64_tr_b16 v[42:43], v60 offset:1024
    ds_read_b64_tr_b16 v[44:45], v60 offset:2048
    ds_read_b64_tr_b16 v[46:47], v60 offset:3072
    ds_read_b64_tr_b16 v[48:49], v60 offset:4096
    ds_read_b64_tr_b16 v[50:51], v60 offset:5120
    v_mov_b64 v[20:21], 0
    v_mov_b64 v[22:23], 0
    v_mov_b64 v[24:25], 0
    v_mov_b64 v[26:27], 0
    s_add_u32 s58, s6, 132096
    s_branch L_pw_197
.p2align 5
L_pr_198:
    buffer_load_dword v52, v56, s[40:43], s74 offen offset:1536 sc1
    buffer_load_dwordx2 v[54:55], v62, s[40:43], s74 offen offset:1536 sc1
    s_sub_u32 s56, s56, 1
    s_cbranch_scc1 L_done
L_pw_197:
    s_waitcnt vmcnt(0)
    v_max3_u32 v53, v52, v54, v55
    v_cmp_eq_u32 vcc, -1, v53
    s_cbranch_vccnz L_pr_198
    buffer_load_dwordx4 v[12:15], v57, s[40:43], s74 offen sc1
    buffer_load_dwordx2 v[16:17], v58, s[40:43], s74 offen offset:1024 sc1
    buffer_load_dword v18, v56, s[40:43], s74 offen offset:1568 sc1
    v_max_f32_dpp v53, v52, v52 row_ror:4 row_mask:0xf bank_mask:0xf
    s_nop 1
    v_max_f32_dpp v53, v53, v53 row_ror:2 row_mask:0xf bank_mask:0xf
    s_nop 1
    v_max_f32_dpp v53, v53, v53 row_ror:1 row_mask:0xf bank_mask:0xf
    v_sub_f32 v52, v52, v53
    v_sub_f32 v54, v54, v53
    v_sub_f32 v55, v55, v53
    v_exp_f32 v52, v52
    v_exp_f32 v54, v54
    v_exp_f32 v55, v55
    s_waitcnt lgkmcnt(0)
    s_branch L_ow_199
.p2align 5
L_or_200:
    buffer_load_dwordx4 v[12:15], v57, s[40:43], s74 offen sc1
    buffer_load_dwordx2 v[16:17], v58, s[40:43], s74 offen offset:1024 sc1
    buffer_load_dword v18, v56, s[40:43], s74 offen offset:1568 sc1
    s_sub_u32 s56, s56, 1
    s_cbranch_scc1 L_done
L_pad11:
    s_cbranch_execz L_pad15
    v_mov_b64 v[20:21], 0
    v_mov_b64 v[22:23], 0
    v_mov_b64 v[24:25], 0
    v_mov_b64 v[26:27], 0
L_ow_199:
    s_waitcnt vmcnt(2)
    v_smfmac_f32_16x16x64_bf16 v[20:23], v[12:15], v[28:35], v1
    s_nop 2
    v_smfmac_f32_16x16x64_bf16 v[24:27], v[12:15], v[40:47], v1
    s_waitcnt vmcnt(0)
    v_mul_f32 v53, v52, v18
    v_smfmac_f32_16x16x32_bf16 v[20:23], v[16:17], v[36:39], v1
    s_nop 2
    v_smfmac_f32_16x16x32_bf16 v[24:27], v[16:17], v[48:51], v1
    v_add_f32_dpp v53, v53, v53 row_ror:4 row_mask:0xf bank_mask:0xf
    v_max3_u32 v19, v12, v13, v14
    v_max3_u32 v62, v15, v16, v17
    v_add_f32_dpp v53, v53, v53 row_ror:2 row_mask:0xf bank_mask:0xf
    v_max3_u32 v19, v19, v62, v18
    s_cmp_eq_u32 s30, 2
    v_add_f32_dpp v53, v53, v53 row_ror:1 row_mask:0xf bank_mask:0xf
    v_cmp_eq_u32 vcc, -1, v19
    v_rcp_f32 v53, v53
    s_cbranch_vccnz L_or_200
    v_pk_add_f32 v[20:21], v[20:21], v[22:23]
    v_pk_add_f32 v[24:25], v[24:25], v[26:27]
    v_pk_mul_f32 v[54:55], v[54:55], v[52:53] op_sel:[0,1] op_sel_hi:[1,1]
    v_mul_f32 v20, v20, v54
    v_mul_f32 v24, v24, v54
    v_fmac_f32 v20, v21, v55
    v_fmac_f32 v24, v25, v55
    s_nop 1
    v_permlane32_swap_b32 v20, v24
    v_add_f32 v20, v20, v24
    ds_write_b32 v61, v20
    s_waitcnt lgkmcnt(0)
    s_barrier
    s_cbranch_scc0 L_finb_201
    ds_read2st64_b32 v[12:13], v2 offset0:0 offset1:1
    ds_read2st64_b32 v[14:15], v2 offset0:2 offset1:3
    ds_read2st64_b32 v[16:17], v2 offset0:4 offset1:5
    ds_read2st64_b32 v[18:19], v2 offset0:6 offset1:7
    s_waitcnt lgkmcnt(2)
    v_pk_add_f32 v[12:13], v[12:13], v[14:15]
    s_waitcnt lgkmcnt(0)
    v_pk_add_f32 v[16:17], v[16:17], v[18:19]
    v_pk_add_f32 v[12:13], v[12:13], v[16:17]
    v_add_f32 v14, v12, v13
    v_add_f32 v15, v12, v13
    s_nop 1
    v_permlane16_swap_b32 v14, v15
    v_add_f32 v12, v14, v15
    buffer_store_dword v12, v3, s[40:43], s58 offen sc1
.p2align 5
L_finb_201:
    s_sub_u32 s57, s30, 4
    s_cmp_lt_u32 s57, 3
    s_cbranch_scc0 L_skip_202
    s_sub_u32 s60, s30, 4
    s_lshl_b32 s57, s60, 11
    v_lshlrev_b32 v11, 4, v0
    v_add_u32 v11, s57, v11
    s_add_u32 s65, s62, 19456
    buffer_load_dwordx4 v[52:55], v11, s[40:43], s65 offen offset:0 sc1
    buffer_load_dwordx4 v[56:59], v11, s[40:43], s65 offen offset:1024 sc1
    s_lshl_b32 s59, s60, 12
    s_add_u32 s59, s59, 79872
    v_bfe_u32 v35, v0, 4, 1
    v_lshlrev_b32 v35, 11, v35
    v_bfe_u32 v60, v0, 2, 2
    v_lshl_add_u32 v35, v60, 8, v35
    v_lshrrev_b32 v60, 5, v0
    v_lshl_add_u32 v35, v60, 6, v35
    v_and_b32 v60, 3, v0
    v_lshl_add_u32 v35, v60, 3, v35
    v_add_u32 v35, s59, v35
    v_mov_b32 v9, 0xbdd2d3e8
    v_mov_b32 v10, 0xc0135761
    s_lshl_b32 s57, s60, 7
    s_add_u32 s57, s57, 160256
    v_lshlrev_b32 v32, 3, v0
    v_add_u32 v32, s57, v32
    v_lshlrev_b32 v33, 3, v0
    v_add_u32 v33, 129024, v33
    v_cmp_gt_u32 vcc, 16, v0
    s_nop 1
    v_cndmask_b32 v32, v33, v32, vcc
    v_and_b32 v33, 15, v0
    v_lshlrev_b32 v33, 3, v33
    v_lshrrev_b32 v60, 5, v0
L_pad12:
    s_cbranch_execz L_pad16
    v_lshl_add_u32 v33, v60, 2, v33
    v_add_u32 v33, 160256, v33
    v_and_b32 v34, 15, v0
    v_lshlrev_b32 v34, 2, v34
    v_lshrrev_b32 v60, 5, v0
    v_lshl_add_u32 v34, v60, 6, v34
    v_bfe_u32 v60, v0, 4, 1
    v_lshl_add_u32 v34, v60, 13, v34
    s_add_u32 s60, s6, 198144
    s_add_u32 s58, s62, 39936
    s_add_u32 s57, s62, 25984
    v_and_b32 v7, 7, v0
    v_lshlrev_b32 v7, 3, v7
    v_mov_b32 v60, 0x3acccccd
    v_mov_b32 v61, 0x3727c5ac
    s_waitcnt vmcnt(0)
    buffer_load_dwordx2 v[24:25], v7, s[40:43], s57 offen sc1
    buffer_load_dwordx4 v[12:15], v11, s[40:43], s58 offen offset:0 sc1
    buffer_load_dwordx4 v[16:19], v11, s[40:43], s58 offen offset:1024 sc1
    ds_read_b64_tr_b16 v[36:37], v35 offset:0
    ds_read_b64_tr_b16 v[38:39], v35 offset:1024
    ds_read_b64_tr_b16 v[40:41], v35 offset:128
    ds_read_b64_tr_b16 v[42:43], v35 offset:1152
    ds_read_b64_tr_b16 v[44:45], v35 offset:32
    ds_read_b64_tr_b16 v[46:47], v35 offset:1056
    ds_read_b64_tr_b16 v[48:49], v35 offset:160
    ds_read_b64_tr_b16 v[50:51], v35 offset:1184
L_sw_205:
    v_max3_u32 v20, v52, v53, v54
    v_max3_u32 v20, v20, v55, v56
    v_max3_u32 v20, v20, v57, v58
    v_max_u32 v20, v20, v59
    v_cmp_eq_u32 vcc, -1, v20
    s_cbranch_vccnz L_sr_206
    v_pk_add_f32 v[28:29], v[52:53], v[56:57]
    v_pk_add_f32 v[30:31], v[54:55], v[58:59]
    s_nop 1
    v_permlane32_swap_b32 v28, v30
    v_permlane32_swap_b32 v29, v31
    v_pk_add_f32 v[28:29], v[28:29], v[30:31]
    s_nop 1
    v_permlane16_swap_b32 v28, v29
    v_add_f32 v28, v28, v29
    v_mov_b64 v[52:53], 0
    v_mov_b64 v[54:55], 0
    v_mov_b64 v[56:57], 0
    v_mov_b64 v[58:59], 0
    s_waitcnt lgkmcnt(0)
    s_branch L_pw_203
.p2align 5
L_pr_204:
    buffer_load_dwordx2 v[24:25], v7, s[40:43], s57 offen sc1
    buffer_load_dwordx4 v[12:15], v11, s[40:43], s58 offen offset:0 sc1
    buffer_load_dwordx4 v[16:19], v11, s[40:43], s58 offen offset:1024 sc1
    s_sub_u32 s56, s56, 1
    s_cbranch_scc1 L_done
L_pw_203:
    s_waitcnt vmcnt(0)
    v_max_u32 v20, v24, v25
    v_cmp_eq_u32 vcc, -1, v20
    s_cbranch_vccnz L_pr_204
    buffer_load_dwordx4 v[12:15], v11, s[40:43], s58 offen offset:0 sc1
    buffer_load_dwordx4 v[16:19], v11, s[40:43], s58 offen offset:1024 sc1
    v_add_f32_dpp v2, v24, v24 row_ror:4 row_mask:0xf bank_mask:0xf
    v_add_f32_dpp v3, v25, v25 row_ror:4 row_mask:0xf bank_mask:0xf
    v_pk_add_f32 v[20:21], v[12:13], v[16:17]
    v_pk_add_f32 v[22:23], v[14:15], v[18:19]
    v_add_f32_dpp v2, v2, v2 row_ror:2 row_mask:0xf bank_mask:0xf
    v_add_f32_dpp v3, v3, v3 row_ror:2 row_mask:0xf bank_mask:0xf
    v_permlane32_swap_b32 v20, v22
    v_permlane32_swap_b32 v21, v23
    v_add_f32_dpp v2, v2, v2 row_ror:1 row_mask:0xf bank_mask:0xf
    v_add_f32_dpp v3, v3, v3 row_ror:1 row_mask:0xf bank_mask:0xf
    v_pk_add_f32 v[20:21], v[20:21], v[22:23]
    v_mul_f32 v2, v2, v60
    v_fma_f32 v3, v3, v60, v61
    v_permlane16_swap_b32 v20, v21
    v_fma_f32 v3, -v2, v2, v3
    v_add_f32 v20, v20, v21
    v_max_f32 v3, v3, v61
    v_mul_f32 v26, v28, v2
    v_rsq_f32 v3, v3
    v_cmp_u_f32 vcc, v20, v20
    v_sub_f32 v20, v20, v26
L_pad13:
    s_cbranch_execz L_pad17
    s_cbranch_vccnz L_hr_207
L_hk_208:
    v_fma_f32 v20, v20, v3, v4
    v_mul_f32 v21, v20, v20
    v_mul_f32 v22, v20, v9
    v_mul_f32 v23, v20, v10
    v_fma_f32 v21, v21, v22, v23
    v_exp_f32 v21, v21
    s_nop 0
    v_add_f32 v21, 1.0, v21
    v_rcp_f32 v21, v21
    s_nop 0
    v_mul_f32 v20, v20, v21
    s_nop 1
    v_mov_b32_dpp v21, v20 row_shl:1 row_mask:0xf bank_mask:0xf bound_ctrl:0
    v_cvt_pk_bf16_f32 v28, v20, v21
    s_nop 1
    v_mov_b32_dpp v29, v28 row_shl:4 row_mask:0xf bank_mask:0xf bound_ctrl:0
    v_mov_b32_dpp v30, v28 row_shl:8 row_mask:0xf bank_mask:0xf bound_ctrl:0
    v_mov_b32_dpp v31, v28 row_shl:12 row_mask:0xf bank_mask:0xf bound_ctrl:0
    s_nop 1
    v_smfmac_f32_16x16x64_bf16 v[52:55], v[28:31], v[36:43], v1
    v_smfmac_f32_16x16x64_bf16 v[56:59], v[28:31], v[44:51], v1
    s_cmp_eq_u32 s30, 4
    s_nop 5
    v_add_f32 v22, v52, v54
    v_add_f32 v23, v56, v58
    ds_write_b64 v32, v[22:23]
    s_cbranch_scc0 L_skip_210
.p2align 5
L_xw_211:
    ds_read2_b32 v[20:21], v33 offset0:0 offset1:32
    ds_read_b32 v22, v33 offset:256
    s_sub_u32 s56, s56, 1
    s_cbranch_scc1 L_done
    s_waitcnt lgkmcnt(0)
    v_max3_u32 v23, v20, v21, v22
    v_add_f32 v20, v20, v21
    v_cmp_eq_u32 vcc, -1, v23
    v_add_f32 v20, v20, v22
    s_cbranch_vccnz L_xw_211
    buffer_store_dword v20, v34, s[40:43], s60 offen sc1
L_skip_210:
L_skip_202:
    s_branch L_done
L_typeB_1:
    s_cmp_eq_u32 s53, 3
    s_cbranch_scc0 L_typeC_212
    s_cmp_eq_u32 s30, 7
    s_cbranch_scc1 L_w7_217
    s_cmp_lt_u32 s30, 6
    s_cbranch_scc0 L_skip_219
    s_lshr_b32 s57, s30, 1
    s_mul_i32 s57, s57, 128
    s_and_b32 s58, s30, 1
    s_lshl_b32 s58, s58, 6
    s_add_u32 s57, s57, s58
    v_lshrrev_b32 v18, 5, v0
    v_lshlrev_b32 v18, 13, v18
    v_bfe_u32 v60, v0, 3, 1
    v_lshl_add_u32 v18, v60, 12, v18
    v_bfe_u32 v60, v0, 4, 1
    v_lshl_add_u32 v18, v60, 11, v18
    v_bfe_u32 v60, v0, 2, 1
    v_mul_u32_u24 v60, 384, v60
    v_add_u32 v18, v60, v18
    v_and_b32 v60, 3, v0
    v_lshl_add_u32 v18, v60, 3, v18
    v_add_u32 v18, s57, v18
    v_add_u32 v18, 30720, v18
    v_bfe_u32 v19, v0, 3, 1
    v_lshlrev_b32 v19, 12, v19
    v_bfe_u32 v60, v0, 4, 1
    v_lshl_add_u32 v19, v60, 11, v19
    v_bfe_u32 v60, v0, 2, 1
    v_mul_u32_u24 v60, 384, v60
    v_add_u32 v19, v60, v19
    v_and_b32 v60, 3, v0
    v_lshl_add_u32 v19, v60, 3, v19
    v_lshrrev_b32 v60, 5, v0
    v_lshl_add_u32 v19, v60, 5, v19
    v_add_u32 v19, s57, v19
    v_add_u32 v19, 63488, v19
    ds_read_b64_tr_b16 v[28:29], v18 offset:0
    ds_read_b64_tr_b16 v[30:31], v18 offset:1024
    ds_read_b64_tr_b16 v[32:33], v18 offset:16384
    ds_read_b64_tr_b16 v[34:35], v18 offset:17408
    ds_read_b64_tr_b16 v[36:37], v18 offset:32
    ds_read_b64_tr_b16 v[38:39], v18 offset:1056
    ds_read_b64_tr_b16 v[40:41], v18 offset:16416
    ds_read_b64_tr_b16 v[42:43], v18 offset:17440
    ds_read_b64_tr_b16 v[24:25], v19 offset:0
L_pad14:
    s_cbranch_execz L_pad18
    ds_read_b64_tr_b16 v[26:27], v19 offset:1024
    v_lshrrev_b32 v49, 4, v0
    v_lshlrev_b32 v49, 5, v49
    v_bfe_u32 v60, v0, 1, 1
    v_lshl_add_u32 v49, v60, 4, v49
    v_bfe_u32 v60, v0, 3, 1
    v_mul_u32_u24 v60, 192, v60
    v_add_u32 v49, v60, v49
    v_add_u32 v49, 160832, v49
    v_bfe_u32 v50, v0, 1, 1
    v_lshlrev_b32 v50, 4, v50
    v_bfe_u32 v60, v0, 3, 1
    v_mul_u32_u24 v60, 192, v60
    v_add_u32 v50, v60, v50
    v_add_u32 v50, 160960, v50
    v_mov_b32 v60, 160992
    v_and_b32 v51, 5, v0
    v_cmp_eq_u32 vcc, 0, v51
    s_nop 1
    v_cndmask_b32 v9, v60, v49, vcc
    v_cmp_eq_u32 vcc, 4, v51
    s_nop 1
    v_cndmask_b32 v10, v60, v49, vcc
    v_lshrrev_b32 v49, 2, v0
    v_and_b32 v49, 12, v49
    v_cmp_eq_u32 vcc, v49, v51
    s_nop 1
    v_cndmask_b32 v48, v60, v50, vcc
    v_mov_b64 v[44:45], 0
    v_mov_b64 v[46:47], 0
    s_lshr_b32 s57, s30, 1
    s_lshl_b32 s57, s57, 11
    s_lshl_b32 s58, s58, 1
    s_add_u32 s57, s57, s58
    s_lshl_b32 s58, s54, 8
    s_add_u32 s57, s57, s58
    v_and_b32 v11, 31, v0
    v_lshlrev_b32 v11, 2, v11
    v_lshrrev_b32 v60, 5, v0
    v_lshl_add_u32 v11, v60, 30, v11
    v_add_u32 v11, s57, v11
    s_add_u32 s59, s62, 39936
    s_add_u32 s60, s62, 25984
L_skip_219:
    s_cmp_lt_u32 s30, 6
    s_barrier
    s_cbranch_scc0 L_se_218
    ds_read_b128 v[12:15], v9
    ds_read_b128 v[16:19], v10
    ds_read_b128 v[20:23], v48
    s_waitcnt lgkmcnt(2)
    v_smfmac_f32_16x16x64_bf16 v[44:47], v[12:15], v[28:35], v1
    s_waitcnt lgkmcnt(1)
    v_smfmac_f32_16x16x64_bf16 v[44:47], v[16:19], v[36:43], v1
    s_waitcnt lgkmcnt(0)
    v_smfmac_f32_16x16x64_bf16 v[44:47], v[20:23], v[24:31], v1
    s_cmp_eq_u32 s55, 0
    s_nop 6
    v_add_f32 v12, v44, v46
    s_cbranch_scc1 L_gs_220
    buffer_store_dword v12, v11, s[40:43], s59 offen
L_gb_221:
.p2align 5
L_se_218:
    s_cmp_eq_u32 s30, 7
    s_cbranch_scc0 L_done
    s_cmp_eq_u32 s31, 0
    s_cbranch_scc0 L_done
    v_lshlrev_b32 v60, 16, v4
    v_add_f32 v2, v2, v60
    v_and_b32 v60, 0xffff0000, v4
    v_add_f32 v3, v3, v60
    v_and_b32 v60, 31, v0
    v_min_u32 v60, 19, v60
    s_mul_i32 s57, s54, 160
    v_lshrrev_b32 v7, 5, v0
    v_lshlrev_b32 v7, 2, v7
    v_add_u32 v7, s57, v7
    v_lshl_add_u32 v7, v60, 3, v7
    s_add_u32 s57, s7, 198144
    s_add_u32 s58, s7, 214528
    s_add_u32 s59, s7, 230912
    s_add_u32 s60, s7, 247296
    v_mov_b64 v[36:37], 0
    v_mov_b64 v[38:39], 0
    s_nop 0
    v_mov_b32_dpp v36, v2 quad_perm:[0,1,2,3] row_mask:0x3 bank_mask:0xf
    v_mov_b32_dpp v37, v3 quad_perm:[0,1,2,3] row_mask:0x3 bank_mask:0xf
    v_mov_b32_dpp v38, v2 quad_perm:[0,1,2,3] row_mask:0xc bank_mask:0xf
    v_mov_b32_dpp v39, v3 quad_perm:[0,1,2,3] row_mask:0xc bank_mask:0xf
    s_add_u32 s75, s7, 266252
    v_and_b32 v9, 7, v0
L_pad15:
    s_cbranch_execz L_pad19
    v_lshlrev_b32 v9, 9, v9
.p2align 5
L_pr_233:
    buffer_load_dword v12, v9, s[40:43], s75 offen sc1
    s_sub_u32 s56, s56, 1
    s_cbranch_scc1 L_done
L_pw_232:
    s_waitcnt vmcnt(0)
    v_cmp_eq_u32 vcc, -1, v12
    s_cbranch_vccnz L_pr_233
.p2align 5
L_gw_229:
    buffer_load_dwordx4 v[12:15], v5, s[40:43], s57 offen sc1
    buffer_load_dwordx4 v[16:19], v5, s[40:43], s58 offen sc1
    buffer_load_dwordx4 v[20:23], v5, s[40:43], s59 offen sc1
    buffer_load_dwordx4 v[24:27], v5, s[40:43], s60 offen sc1
    s_sub_u32 s56, s56, 1
    s_cbranch_scc1 L_done
    s_and_b32 s74, s56, 31
    s_waitcnt vmcnt(3)
    v_pk_add_f32 v[28:29], v[12:13], v[36:37]
    v_pk_add_f32 v[30:31], v[14:15], v[38:39]
    s_waitcnt vmcnt(2)
    v_pk_add_f32 v[28:29], v[28:29], v[16:17]
    v_pk_add_f32 v[30:31], v[30:31], v[18:19]
    s_waitcnt vmcnt(1)
    v_pk_add_f32 v[28:29], v[28:29], v[20:21]
    v_pk_add_f32 v[30:31], v[30:31], v[22:23]
    s_waitcnt vmcnt(0)
    v_pk_add_f32 v[28:29], v[28:29], v[24:25]
    v_pk_add_f32 v[30:31], v[30:31], v[26:27]
    v_pk_add_f32 v[32:33], v[28:29], v[30:31]
    v_cmp_u_f32 vcc, v32, v33
    v_permlane32_swap_b32 v28, v30
    v_permlane32_swap_b32 v29, v31
    s_cbranch_vccnz L_gr_230
L_gk_231:
    v_pk_add_f32 v[28:29], v[28:29], v[30:31]
    v_cvt_pk_bf16_f32 v28, v28, v29
    global_store_dword v7, v28, s[24:25]
    s_branch L_done
.p2align 5
L_gs_34:
    buffer_store_dword v33, v34, s[40:43], s67 offen sc1
    s_branch L_gb_35
.p2align 5
L_gs_37:
    buffer_store_dword v12, v54, s[40:43], s59 offen sc1
    s_branch L_gb_38
.p2align 5
L_cr_49:
    s_sub_u32 s56, s56, 1
    s_cbranch_scc1 L_done
    global_load_dword v2, v3, s[26:27] sc1
    s_waitcnt vmcnt(0)
    s_branch L_cw_48
.p2align 5
L_far_50:
    s_lshl_b32 s57, s52, 2
    s_add_u32 s57, s57, s72
    s_mov_b64 exec, 1
    buffer_store_dword v25, v0, s[40:43], s57 offen offset:128 sc1
    s_mov_b64 exec, -1
    s_branch L_fb_51
.p2align 5
L_cr_63:
    s_sub_u32 s56, s56, 1
    s_cbranch_scc1 L_done
    buffer_load_dword v2, v24, s[40:43], s72 offen sc1
    s_branch L_cw_62
.p2align 5
L_gs_70:
    buffer_store_dword v33, v34, s[40:43], s67 offen sc1
    s_branch L_gb_71
.p2align 5
L_gs_73:
    buffer_store_dword v12, v54, s[40:43], s59 offen sc1
    s_branch L_gb_74
.p2align 5
L_gs_91:
    buffer_store_dword v37, v4, s[40:43], s58 offen sc1
    s_branch L_gb_92
.p2align 5
L_cr_105:
L_pad16:
    s_cbranch_execz L_pad20
    s_sub_u32 s56, s56, 1
    s_cbranch_scc1 L_done
    global_load_dword v2, v3, s[26:27] offset:4 sc1
    s_branch L_cw_104
.p2align 5
L_cr_115:
    buffer_load_dword v52, v56, s[40:43], s74 offen offset:1536 sc1
    buffer_load_dwordx2 v[54:55], v62, s[40:43], s74 offen offset:1536 sc1
    s_sub_u32 s56, s56, 1
    s_cbranch_scc1 L_done
    s_branch L_cw_114
.p2align 5
L_gs_120:
    buffer_store_dword v14, v3, s[40:43], s57 offen sc1
    s_branch L_gb_121
.p2align 5
L_gs_122:
    buffer_store_dword v12, v4, s[40:43], s57 offen offset:32 sc1
    s_branch L_gb_123
.p2align 5
L_comb_0:
    s_mov_b32 s57, 0
    s_cmp_eq_u32 s55, 0
    s_waitcnt lgkmcnt(0)
    s_barrier
    ds_read2st64_b64 v[12:15], v2 offset0:0 offset1:4
    ds_read2st64_b64 v[16:19], v2 offset0:8 offset1:12
    ds_read2st64_b64 v[20:23], v2 offset0:16 offset1:20
    ds_read2st64_b64 v[24:27], v2 offset0:24 offset1:28
    s_waitcnt lgkmcnt(2)
    v_pk_add_f32 v[12:13], v[12:13], v[14:15]
    v_pk_add_f32 v[16:17], v[16:17], v[18:19]
    v_pk_add_f32 v[12:13], v[12:13], v[16:17]
    s_waitcnt lgkmcnt(0)
    v_pk_add_f32 v[20:21], v[20:21], v[22:23]
    v_pk_add_f32 v[24:25], v[24:25], v[26:27]
    v_pk_add_f32 v[12:13], v[12:13], v[20:21]
    v_pk_add_f32 v[12:13], v[12:13], v[24:25]
    v_cvt_pk_bf16_f32 v14, v12, v13
    v_min_u32 v14, -2, v14
    s_cbranch_scc1 L_gs_120
    buffer_store_dword v14, v3, s[40:43], s57 offen
L_gb_121:
    s_cbranch_scc1 L_gs_122
    buffer_store_dword v12, v4, s[40:43], s57 offen offset:32
L_gb_123:
    s_branch L_comb_0b
.p2align 5
L_sr_132:
    buffer_load_dwordx4 v[52:55], v11, s[40:43], s65 offen offset:0 sc1
    buffer_load_dwordx4 v[56:59], v11, s[40:43], s65 offen offset:1024 sc1
    s_sub_u32 s56, s56, 1
    s_cbranch_scc1 L_done
    s_waitcnt vmcnt(0)
    s_branch L_sw_131
L_hr_133:
    buffer_load_dwordx4 v[12:15], v11, s[40:43], s58 offen offset:0 sc1
    buffer_load_dwordx4 v[16:19], v11, s[40:43], s58 offen offset:1024 sc1
    s_sub_u32 s56, s56, 1
    s_cbranch_scc1 L_done
    s_and_b32 s64, s56, 31
    s_cbranch_scc0 L_hx_135
    s_waitcnt vmcnt(2)
    v_pk_add_f32 v[20:21], v[12:13], v[16:17]
    v_pk_add_f32 v[22:23], v[14:15], v[18:19]
    s_nop 1
    v_permlane32_swap_b32 v20, v22
    v_permlane32_swap_b32 v21, v23
    v_pk_add_f32 v[20:21], v[20:21], v[22:23]
    s_nop 1
    v_permlane16_swap_b32 v20, v21
    v_add_f32 v20, v20, v21
    v_cmp_u_f32 vcc, v20, v20
    v_sub_f32 v20, v20, v26
    s_cbranch_vccnz L_hr_133
    s_branch L_hk_134
.p2align 5
L_hx_135:
    s_waitcnt vmcnt(0)
    v_max3_u32 v20, v12, v13, v14
    v_max3_u32 v20, v20, v15, v16
    v_max3_u32 v20, v20, v17, v18
    v_max_u32 v20, v20, v19
    v_cmp_eq_u32 vcc, -1, v20
    s_cbranch_vccnz L_hr_133
    v_pk_add_f32 v[20:21], v[12:13], v[16:17]
    v_pk_add_f32 v[22:23], v[14:15], v[18:19]
    s_nop 1
    v_permlane32_swap_b32 v20, v22
L_pad17:
    s_cbranch_execz L_pad21
    v_permlane32_swap_b32 v21, v23
    v_pk_add_f32 v[20:21], v[20:21], v[22:23]
    s_nop 1
    v_permlane16_swap_b32 v20, v21
    v_add_f32 v20, v20, v21
    v_sub_f32 v20, v20, v26
    s_branch L_hk_134
.p2align 5
L_gs_143:
    buffer_store_dword v0, v11, s[40:43], s58 offen sc1
    s_branch L_gb_144
.p2align 5
L_typeC_139:
    s_cmp_eq_u32 s30, 6
    s_cbranch_scc0 L_p1
    s_bitcmp1_b32 s3, 0
    s_cbranch_scc0 L_skip_140
    v_and_b32 v11, 3, v0
    v_lshlrev_b32 v11, 7, v11
    v_lshrrev_b32 v60, 2, v0
    v_lshl_add_u32 v11, v60, 24, v11
    s_add_u32 s58, s62, 26116
    s_add_u32 s75, s7, 266244
    v_and_b32 v9, 7, v0
    v_lshlrev_b32 v9, 9, v9
.p2align 5
L_pr_142:
    buffer_load_dword v12, v9, s[40:43], s75 offen sc1
    s_sub_u32 s56, s56, 1
    s_cbranch_scc1 L_done
L_pw_141:
    s_waitcnt vmcnt(0)
    v_cmp_eq_u32 vcc, -1, v12
    s_cbranch_vccnz L_pr_142
    s_cmp_eq_u32 s55, 0
    s_cbranch_scc1 L_gs_143
    buffer_store_dword v0, v11, s[40:43], s58 offen
L_gb_144:
    s_waitcnt vmcnt(1)
    s_branch L_p1
.p2align 5
L_skip_140:
    s_lshl_b32 s59, s31, 9
    s_add_u32 s59, s59, s8
    s_add_u32 s59, s59, 266240
    v_and_b32 v10, 1, v0
    v_lshlrev_b32 v10, 13, v10
    v_lshrrev_b32 v60, 1, v0
    v_lshl_add_u32 v10, v60, 24, v10
    s_cmp_eq_u32 s3, 20
    s_cbranch_scc0 L_skip_145
    s_add_u32 s58, s62, 1568
    v_lshrrev_b32 v9, 3, v0
    v_mul_u32_u24 v9, 1664, v9
    v_and_b32 v60, 7, v0
    v_lshl_add_u32 v9, v60, 2, v9
.p2align 5
L_pr_147:
    buffer_load_dword v12, v9, s[40:43], s58 offen sc1
    s_sub_u32 s56, s56, 1
    s_cbranch_scc1 L_done
L_pw_146:
    s_waitcnt vmcnt(0)
    v_cmp_eq_u32 vcc, -1, v12
    s_cbranch_vccnz L_pr_147
    buffer_store_dword v0, v10, s[40:43], s59 offen offset:0 sc1
L_skip_145:
    s_add_u32 s58, s62, 25856
    v_and_b32 v9, 15, v0
    v_lshlrev_b32 v9, 2, v9
.p2align 5
L_pr_149:
    buffer_load_dword v13, v9, s[40:43], s58 offen sc1
    s_sub_u32 s56, s56, 1
    s_cbranch_scc1 L_done
L_pw_148:
    s_waitcnt vmcnt(0)
    v_cmp_eq_u32 vcc, -1, v13
    s_cbranch_vccnz L_pr_149
    buffer_store_dword v0, v10, s[40:43], s59 offen offset:4 sc1
    s_waitcnt vmcnt(1)
    s_branch L_p1
.p2align 5
L_gs_153:
    buffer_store_dword v12, v49, s[40:43], s60 offen sc1
    s_branch L_gb_154
.p2align 5
L_gs_155:
    buffer_store_dword v12, v11, s[40:43], s59 offen sc1
    s_branch L_gb_156
.p2align 5
L_gr_158:
L_pad18:
    s_cbranch_execz L_pad22
    s_cbranch_scc1 L_gw_157
    s_waitcnt vmcnt(0)
    v_max3_u32 v32, v12, v13, v14
    v_max3_u32 v32, v32, v15, v16
    v_max3_u32 v32, v32, v17, v18
    v_max3_u32 v32, v32, v19, v20
    v_max3_u32 v32, v32, v21, v22
    v_max3_u32 v32, v32, v23, v24
    v_max3_u32 v32, v32, v25, v26
    v_max_u32 v32, v32, v27
    v_cmp_eq_u32 vcc, -1, v32
    s_cbranch_vccnz L_gw_157
    v_pk_add_f32 v[28:29], v[12:13], v[36:37]
    v_pk_add_f32 v[30:31], v[14:15], v[38:39]
    v_pk_add_f32 v[28:29], v[28:29], v[16:17]
    v_pk_add_f32 v[30:31], v[30:31], v[18:19]
    v_pk_add_f32 v[28:29], v[28:29], v[20:21]
    v_pk_add_f32 v[30:31], v[30:31], v[22:23]
    v_pk_add_f32 v[28:29], v[28:29], v[24:25]
    v_pk_add_f32 v[30:31], v[30:31], v[26:27]
    s_nop 1
    v_permlane32_swap_b32 v28, v30
    v_permlane32_swap_b32 v29, v31
    s_branch L_gk_159
L_gs_162:
    buffer_store_dword v33, v34, s[40:43], s67 offen sc1
    s_branch L_gb_163
.p2align 5
L_w7_150:
    v_and_b32 v60, 31, v0
    v_min_u32 v60, 19, v60
    s_mul_i32 s57, s54, 320
    v_lshrrev_b32 v5, 5, v0
    v_lshlrev_b32 v5, 12, v5
    v_add_u32 v5, s57, v5
    v_lshl_add_u32 v5, v60, 4, v5
    v_and_b32 v60, 31, v0
    v_cmp_gt_u32 s[64:65], 20, v60
    v_min_u32 v60, 19, v60
    v_lshrrev_b32 v35, 5, v0
    v_lshlrev_b32 v35, 2, v35
    v_add_u32 v35, 160832, v35
    v_lshl_add_u32 v35, v60, 3, v35
    s_add_u32 s66, s62, 13312
    s_add_u32 s67, s62, 25856
    s_lshl_b32 s57, s54, 3
    v_lshrrev_b32 v34, 5, v0
    v_lshlrev_b32 v34, 2, v34
    v_add_u32 v34, s57, v34
    v_and_b32 v60, 31, v0
    v_mov_b32 v61, 0x7f000000
    v_cmp_ne_u32 vcc, 31, v60
    s_nop 1
    v_cndmask_b32 v34, v34, v61, vcc
    v_mov_b32 v61, 0x3f803f80
    s_add_u32 s57, s7, 0
    s_add_u32 s58, s7, 16384
    s_add_u32 s59, s7, 32768
    s_add_u32 s60, s7, 49152
    v_mov_b64 v[36:37], 0
    v_mov_b64 v[38:39], 0
    s_nop 0
    v_mov_b32_dpp v36, v2 quad_perm:[0,1,2,3] row_mask:0x3 bank_mask:0xf
    v_mov_b32_dpp v37, v3 quad_perm:[0,1,2,3] row_mask:0x3 bank_mask:0xf
    v_mov_b32_dpp v38, v2 quad_perm:[0,1,2,3] row_mask:0xc bank_mask:0xf
    v_mov_b32_dpp v39, v3 quad_perm:[0,1,2,3] row_mask:0xc bank_mask:0xf
    s_add_u32 s75, s7, 266240
    v_and_b32 v9, 7, v0
    v_lshlrev_b32 v9, 9, v9
.p2align 5
L_pr_161:
    buffer_load_dword v12, v9, s[40:43], s75 offen sc1
    s_sub_u32 s56, s56, 1
    s_cbranch_scc1 L_done
L_pw_160:
    s_waitcnt vmcnt(0)
    v_cmp_eq_u32 vcc, -1, v12
    s_cbranch_vccnz L_pr_161
.p2align 5
L_gw_157:
    buffer_load_dwordx4 v[12:15], v5, s[40:43], s57 offen sc1
    buffer_load_dwordx4 v[16:19], v5, s[40:43], s58 offen sc1
    buffer_load_dwordx4 v[20:23], v5, s[40:43], s59 offen sc1
    buffer_load_dwordx4 v[24:27], v5, s[40:43], s60 offen sc1
L_pad19:
    s_cbranch_execz L_pad23
    s_sub_u32 s56, s56, 1
    s_cbranch_scc1 L_done
    s_and_b32 s74, s56, 31
    s_waitcnt vmcnt(3)
    v_pk_add_f32 v[28:29], v[12:13], v[36:37]
    v_pk_add_f32 v[30:31], v[14:15], v[38:39]
    s_waitcnt vmcnt(2)
    v_pk_add_f32 v[28:29], v[28:29], v[16:17]
    v_pk_add_f32 v[30:31], v[30:31], v[18:19]
    s_waitcnt vmcnt(1)
    v_pk_add_f32 v[28:29], v[28:29], v[20:21]
    v_pk_add_f32 v[30:31], v[30:31], v[22:23]
    s_waitcnt vmcnt(0)
    v_pk_add_f32 v[28:29], v[28:29], v[24:25]
    v_pk_add_f32 v[30:31], v[30:31], v[26:27]
    v_pk_add_f32 v[32:33], v[28:29], v[30:31]
    v_cmp_u_f32 vcc, v32, v33
    v_permlane32_swap_b32 v28, v30
    v_permlane32_swap_b32 v29, v31
    s_cbranch_vccnz L_gr_158
L_gk_159:
    v_pk_add_f32 v[28:29], v[28:29], v[30:31]
    v_cvt_pk_bf16_f32 v28, v28, v29
    ds_write_b32 v35, v28
    v_cndmask_b32 v29, 0, v28, s[64:65]
    v_dot2_f32_bf16 v33, v29, v61, 0
    v_dot2_f32_bf16 v32, v29, v29, 0
    v_lshlrev_b32 v2, 16, v28
    v_and_b32 v3, 0xffff0000, v28
    s_cmp_eq_u32 s55, 0
    v_permlane32_swap_b32 v33, v32
    v_add_f32 v33, v33, v32
    s_waitcnt lgkmcnt(0)
    s_barrier
    v_add_f32_dpp v33, v33, v33 row_ror:8 row_mask:0xf bank_mask:0xf
    s_nop 1
    v_add_f32_dpp v33, v33, v33 row_ror:4 row_mask:0xf bank_mask:0xf
    s_nop 1
    v_add_f32_dpp v33, v33, v33 row_ror:2 row_mask:0xf bank_mask:0xf
    s_nop 1
    v_add_f32_dpp v33, v33, v33 row_ror:1 row_mask:0xf bank_mask:0xf
    s_nop 1
    v_add_f32_dpp v33, v33, v33 row_bcast:15 row_mask:0xa bank_mask:0xf
    s_cbranch_scc1 L_gs_162
    buffer_store_dword v33, v34, s[40:43], s67 offen
L_gb_163:
    s_waitcnt vmcnt(1)
    s_branch L_se_151
.p2align 5
L_gs_167:
    buffer_store_dword v12, v11, s[40:43], s59 offen sc1
    s_branch L_gb_168
.p2align 5
L_gr_173:
    s_cbranch_scc1 L_gw_172
    s_waitcnt vmcnt(0)
    v_max3_u32 v32, v12, v13, v14
    v_max3_u32 v32, v32, v15, v16
    v_max3_u32 v32, v32, v17, v18
    v_max3_u32 v32, v32, v19, v20
    v_max3_u32 v32, v32, v21, v22
    v_max3_u32 v32, v32, v23, v24
    v_max3_u32 v32, v32, v25, v26
    v_max_u32 v32, v32, v27
    v_cmp_eq_u32 vcc, -1, v32
    s_cbranch_vccnz L_gw_172
    v_pk_add_f32 v[28:29], v[12:13], v[36:37]
    v_pk_add_f32 v[30:31], v[14:15], v[38:39]
    v_pk_add_f32 v[28:29], v[28:29], v[16:17]
    v_pk_add_f32 v[30:31], v[30:31], v[18:19]
    v_pk_add_f32 v[28:29], v[28:29], v[20:21]
    v_pk_add_f32 v[30:31], v[30:31], v[22:23]
    v_pk_add_f32 v[28:29], v[28:29], v[24:25]
    v_pk_add_f32 v[30:31], v[30:31], v[26:27]
    s_nop 1
    v_permlane32_swap_b32 v28, v30
    v_permlane32_swap_b32 v29, v31
    s_branch L_gk_174
.p2align 5
L_gr_176:
    s_cbranch_scc1 L_gw_175
    s_waitcnt vmcnt(0)
    v_max3_u32 v32, v12, v13, v14
    v_max3_u32 v32, v32, v15, v16
    v_max3_u32 v32, v32, v17, v18
L_pad20:
    s_cbranch_execz L_pad24
    v_max3_u32 v32, v32, v19, v20
    v_max3_u32 v32, v32, v21, v22
    v_max3_u32 v32, v32, v23, v24
    v_max3_u32 v32, v32, v25, v26
    v_max_u32 v32, v32, v27
    v_cmp_eq_u32 vcc, -1, v32
    s_cbranch_vccnz L_gw_175
    v_pk_add_f32 v[28:29], v[12:13], v[36:37]
    v_pk_add_f32 v[30:31], v[14:15], v[38:39]
    v_pk_add_f32 v[28:29], v[28:29], v[16:17]
    v_pk_add_f32 v[30:31], v[30:31], v[18:19]
    v_pk_add_f32 v[28:29], v[28:29], v[20:21]
    v_pk_add_f32 v[30:31], v[30:31], v[22:23]
    v_pk_add_f32 v[28:29], v[28:29], v[24:25]
    v_pk_add_f32 v[30:31], v[30:31], v[26:27]
    s_nop 1
    v_permlane32_swap_b32 v28, v30
    v_permlane32_swap_b32 v29, v31
    s_branch L_gk_177
L_gs_180:
    buffer_store_dword v33, v34, s[40:43], s67 offen sc1
    s_branch L_gb_181
.p2align 5
L_w7_164:
    v_and_b32 v60, 31, v0
    v_min_u32 v60, 19, v60
    s_mul_i32 s57, s54, 320
    v_lshrrev_b32 v5, 5, v0
    v_lshlrev_b32 v5, 12, v5
    v_add_u32 v5, s57, v5
    v_lshl_add_u32 v5, v60, 4, v5
    v_and_b32 v60, 31, v0
    v_cmp_gt_u32 s[64:65], 20, v60
    v_min_u32 v60, 19, v60
    v_lshrrev_b32 v35, 5, v0
    v_lshlrev_b32 v35, 2, v35
    v_add_u32 v35, 160832, v35
    v_lshl_add_u32 v35, v60, 3, v35
    s_mul_i32 s66, s53, 6144
    s_add_u32 s66, s66, s62
    s_add_u32 s66, s66, 46080
    s_lshl_b32 s67, s53, 6
    s_add_u32 s67, s67, s62
    s_add_u32 s67, s67, 25600
    s_lshl_b32 s57, s54, 3
    v_lshrrev_b32 v34, 5, v0
    v_lshlrev_b32 v34, 2, v34
    v_add_u32 v34, s57, v34
    v_and_b32 v60, 31, v0
    v_mov_b32 v61, 0x7f000000
    v_cmp_ne_u32 vcc, 31, v60
    s_nop 1
    v_cndmask_b32 v34, v34, v61, vcc
    v_mov_b32 v61, 0x3f803f80
    s_cmp_lg_u32 s53, 3
    s_cbranch_scc0 L_skip_169
    s_add_u32 s57, s62, 25856
    v_mov_b32 v9, 0
.p2align 5
L_pr_171:
    buffer_load_dword v12, v9, s[40:43], s57 offen sc1
    s_sub_u32 s56, s56, 1
    s_cbranch_scc1 L_done
L_pw_170:
    s_waitcnt vmcnt(0)
    v_cmp_eq_u32 vcc, -1, v12
    s_cbranch_vccnz L_pr_171
    s_add_u32 s57, s7, 0
    s_add_u32 s58, s7, 16384
    s_add_u32 s59, s7, 32768
    s_add_u32 s60, s7, 49152
    v_mov_b64 v[36:37], 0
    v_mov_b64 v[38:39], 0
    s_nop 0
    v_mov_b32_dpp v36, v2 quad_perm:[0,1,2,3] row_mask:0x3 bank_mask:0xf
    v_mov_b32_dpp v37, v3 quad_perm:[0,1,2,3] row_mask:0x3 bank_mask:0xf
    v_mov_b32_dpp v38, v2 quad_perm:[0,1,2,3] row_mask:0xc bank_mask:0xf
    v_mov_b32_dpp v39, v3 quad_perm:[0,1,2,3] row_mask:0xc bank_mask:0xf
.p2align 5
L_gw_172:
    buffer_load_dwordx4 v[12:15], v5, s[40:43], s57 offen sc1
    buffer_load_dwordx4 v[16:19], v5, s[40:43], s58 offen sc1
    buffer_load_dwordx4 v[20:23], v5, s[40:43], s59 offen sc1
    buffer_load_dwordx4 v[24:27], v5, s[40:43], s60 offen sc1
L_pad21:
    s_cbranch_execz L_pad25
    s_sub_u32 s56, s56, 1
    s_cbranch_scc1 L_done
    s_and_b32 s74, s56, 31
    s_waitcnt vmcnt(3)
    v_pk_add_f32 v[28:29], v[12:13], v[36:37]
    v_pk_add_f32 v[30:31], v[14:15], v[38:39]
    s_waitcnt vmcnt(2)
    v_pk_add_f32 v[28:29], v[28:29], v[16:17]
    v_pk_add_f32 v[30:31], v[30:31], v[18:19]
    s_waitcnt vmcnt(1)
    v_pk_add_f32 v[28:29], v[28:29], v[20:21]
    v_pk_add_f32 v[30:31], v[30:31], v[22:23]
    s_waitcnt vmcnt(0)
    v_pk_add_f32 v[28:29], v[28:29], v[24:25]
    v_pk_add_f32 v[30:31], v[30:31], v[26:27]
    v_pk_add_f32 v[32:33], v[28:29], v[30:31]
    v_cmp_u_f32 vcc, v32, v33
    v_permlane32_swap_b32 v28, v30
    v_permlane32_swap_b32 v29, v31
    s_cbranch_vccnz L_gr_173
L_gk_174:
    v_pk_add_f32 v[28:29], v[28:29], v[30:31]
    v_cvt_pk_bf16_f32 v28, v28, v29
    v_lshlrev_b32 v2, 16, v28
    v_and_b32 v3, 0xffff0000, v28
L_skip_169:
    s_lshl_b32 s74, s53, 7
    s_add_u32 s75, s62, s74
    s_add_u32 s75, s75, 26116
    v_mov_b32 v9, 0
    buffer_load_dword v12, v9, s[40:43], s75 offen sc1
    v_lshlrev_b32 v60, 16, v4
    v_add_f32 v2, v2, v60
    v_and_b32 v60, 0xffff0000, v4
    v_add_f32 v3, v3, v60
    s_add_u32 s57, s7, 66048
    s_add_u32 s58, s7, 82432
    s_add_u32 s59, s7, 98816
    s_add_u32 s60, s7, 115200
    v_mov_b64 v[36:37], 0
    v_mov_b64 v[38:39], 0
    s_nop 0
    v_mov_b32_dpp v36, v2 quad_perm:[0,1,2,3] row_mask:0x3 bank_mask:0xf
    v_mov_b32_dpp v37, v3 quad_perm:[0,1,2,3] row_mask:0x3 bank_mask:0xf
    v_mov_b32_dpp v38, v2 quad_perm:[0,1,2,3] row_mask:0xc bank_mask:0xf
    v_mov_b32_dpp v39, v3 quad_perm:[0,1,2,3] row_mask:0xc bank_mask:0xf
.p2align 5
L_pr_179:
    buffer_load_dword v12, v9, s[40:43], s75 offen sc1
    s_sub_u32 s56, s56, 1
    s_cbranch_scc1 L_done
L_pw_178:
    s_waitcnt vmcnt(1)
    v_cmp_eq_u32 vcc, -1, v12
    s_cbranch_vccnz L_pr_179
.p2align 5
L_gw_175:
    buffer_load_dwordx4 v[12:15], v5, s[40:43], s57 offen sc1
    buffer_load_dwordx4 v[16:19], v5, s[40:43], s58 offen sc1
    buffer_load_dwordx4 v[20:23], v5, s[40:43], s59 offen sc1
    buffer_load_dwordx4 v[24:27], v5, s[40:43], s60 offen sc1
    s_sub_u32 s56, s56, 1
    s_cbranch_scc1 L_done
    s_and_b32 s74, s56, 31
    s_waitcnt vmcnt(3)
    v_pk_add_f32 v[28:29], v[12:13], v[36:37]
    v_pk_add_f32 v[30:31], v[14:15], v[38:39]
    s_waitcnt vmcnt(2)
    v_pk_add_f32 v[28:29], v[28:29], v[16:17]
    v_pk_add_f32 v[30:31], v[30:31], v[18:19]
    s_waitcnt vmcnt(1)
    v_pk_add_f32 v[28:29], v[28:29], v[20:21]
    v_pk_add_f32 v[30:31], v[30:31], v[22:23]
    s_waitcnt vmcnt(0)
    v_pk_add_f32 v[28:29], v[28:29], v[24:25]
    v_pk_add_f32 v[30:31], v[30:31], v[26:27]
    v_pk_add_f32 v[32:33], v[28:29], v[30:31]
    v_cmp_u_f32 vcc, v32, v33
    v_permlane32_swap_b32 v28, v30
    v_permlane32_swap_b32 v29, v31
    s_cbranch_vccnz L_gr_176
L_gk_177:
    v_pk_add_f32 v[28:29], v[28:29], v[30:31]
    v_cvt_pk_bf16_f32 v28, v28, v29
    ds_write_b32 v35, v28
    v_cndmask_b32 v29, 0, v28, s[64:65]
    v_dot2_f32_bf16 v33, v29, v61, 0
    v_dot2_f32_bf16 v32, v29, v29, 0
L_pad22:
    s_cbranch_execz L_pad26
    v_lshlrev_b32 v2, 16, v28
    v_and_b32 v3, 0xffff0000, v28
    s_cmp_eq_u32 s55, 0
    v_permlane32_swap_b32 v33, v32
    v_add_f32 v33, v33, v32
    s_waitcnt lgkmcnt(0)
    s_barrier
    v_add_f32_dpp v33, v33, v33 row_ror:8 row_mask:0xf bank_mask:0xf
    s_nop 1
    v_add_f32_dpp v33, v33, v33 row_ror:4 row_mask:0xf bank_mask:0xf
    s_nop 1
    v_add_f32_dpp v33, v33, v33 row_ror:2 row_mask:0xf bank_mask:0xf
    s_nop 1
    v_add_f32_dpp v33, v33, v33 row_ror:1 row_mask:0xf bank_mask:0xf
    s_nop 1
    v_add_f32_dpp v33, v33, v33 row_bcast:15 row_mask:0xa bank_mask:0xf
    s_cbranch_scc1 L_gs_180
    buffer_store_dword v33, v34, s[40:43], s67 offen
L_gb_181:
    s_waitcnt vmcnt(1)
    s_branch L_se_165
.p2align 5
L_hr_186:
    buffer_load_dwordx4 v[40:43], v7, s[40:43], s59 offen offset:0 sc1
    buffer_load_dwordx4 v[44:47], v7, s[40:43], s59 offen offset:1024 sc1
    s_sub_u32 s56, s56, 1
    s_cbranch_scc1 L_done
    s_and_b32 s64, s56, 31
    s_cbranch_scc0 L_hx_188
    s_waitcnt vmcnt(2)
    v_pk_add_f32 v[20:21], v[40:41], v[44:45]
    v_pk_add_f32 v[22:23], v[42:43], v[46:47]
    s_nop 1
    v_permlane32_swap_b32 v20, v22
    v_permlane32_swap_b32 v21, v23
    v_pk_add_f32 v[20:21], v[20:21], v[22:23]
    s_nop 1
    v_permlane16_swap_b32 v20, v21
    v_add_f32 v20, v20, v21
    v_cmp_u_f32 vcc, v20, v20
    v_sub_f32 v20, v20, v50
    s_cbranch_vccnz L_hr_186
    s_branch L_hk_187
.p2align 5
L_hx_188:
    s_waitcnt vmcnt(0)
    v_max3_u32 v20, v40, v41, v42
    v_max3_u32 v20, v20, v43, v44
    v_max3_u32 v20, v20, v45, v46
    v_max_u32 v20, v20, v47
    v_cmp_eq_u32 vcc, -1, v20
    s_cbranch_vccnz L_hr_186
    v_pk_add_f32 v[20:21], v[40:41], v[44:45]
    v_pk_add_f32 v[22:23], v[42:43], v[46:47]
    s_nop 1
    v_permlane32_swap_b32 v20, v22
    v_permlane32_swap_b32 v21, v23
    v_pk_add_f32 v[20:21], v[20:21], v[22:23]
    s_nop 1
    v_permlane16_swap_b32 v20, v21
    v_add_f32 v20, v20, v21
    v_sub_f32 v20, v20, v50
    s_branch L_hk_187
L_qo_182:
    v_mov_b64 v[24:25], 0
    v_mov_b64 v[26:27], 0
    v_mov_b64 v[28:29], 0
    v_mov_b64 v[30:31], 0
    v_mov_b64 v[32:33], 0
    v_mov_b64 v[34:35], 0
    v_mov_b64 v[36:37], 0
    v_mov_b64 v[38:39], 0
    v_lshrrev_b32 v5, 4, v0
    v_lshlrev_b32 v5, 5, v5
    v_bfe_u32 v60, v0, 1, 1
    v_lshl_add_u32 v5, v60, 4, v5
    v_add_u32 v5, 124928, v5
    s_branch L_qb_183
.p2align 5
L_mr_189:
    ds_read_b32 v36, v62
    s_sub_u32 s56, s56, 1
    s_cbranch_scc1 L_done
    s_waitcnt lgkmcnt(0)
    v_cmp_eq_u32 vcc, -1, v36
    s_cbranch_vccnz L_mr_189
    v_max_f32_dpp v37, v36, v36 row_ror:4 row_mask:0xf bank_mask:0xf
    s_nop 1
    v_max_f32_dpp v37, v37, v37 row_ror:2 row_mask:0xf bank_mask:0xf
    s_nop 1
    v_max_f32_dpp v37, v37, v37 row_ror:1 row_mask:0xf bank_mask:0xf
    v_sub_f32 v39, v61, v37
L_pad23:
    s_cbranch_execz L_padback
    v_exp_f32 v39, v39
    s_branch L_mk_190
.p2align 5
L_gs_191:
    buffer_store_dword v37, v4, s[40:43], s58 offen sc1
    s_branch L_gb_192
.p2align 5
L_gs_193:
    buffer_store_dword v14, v3, s[40:43], s57 offen sc1
    s_branch L_gb_194
.p2align 5
L_gs_195:
    buffer_store_dword v12, v4, s[40:43], s57 offen offset:32 sc1
    s_branch L_gb_196
.p2align 5
L_comb_1:
    s_mov_b32 s58, 26624
    s_cmp_eq_u32 s55, 0
    s_cbranch_scc1 L_gs_191
    buffer_store_dword v37, v4, s[40:43], s58 offen
L_gb_192:
    s_mov_b32 s57, 26624
    s_cmp_eq_u32 s55, 0
    s_waitcnt lgkmcnt(0)
    s_barrier
    ds_read2st64_b64 v[12:15], v2 offset0:0 offset1:4
    ds_read2st64_b64 v[16:19], v2 offset0:8 offset1:12
    ds_read2st64_b64 v[20:23], v2 offset0:16 offset1:20
    ds_read2st64_b64 v[24:27], v2 offset0:24 offset1:28
    s_waitcnt lgkmcnt(2)
    v_pk_add_f32 v[12:13], v[12:13], v[14:15]
    v_pk_add_f32 v[16:17], v[16:17], v[18:19]
    v_pk_add_f32 v[12:13], v[12:13], v[16:17]
    s_waitcnt lgkmcnt(0)
    v_pk_add_f32 v[20:21], v[20:21], v[22:23]
    v_pk_add_f32 v[24:25], v[24:25], v[26:27]
    v_pk_add_f32 v[12:13], v[12:13], v[20:21]
    v_pk_add_f32 v[12:13], v[12:13], v[24:25]
    v_cvt_pk_bf16_f32 v14, v12, v13
    v_min_u32 v14, -2, v14
    s_cbranch_scc1 L_gs_193
    buffer_store_dword v14, v3, s[40:43], s57 offen
L_gb_194:
    s_cbranch_scc1 L_gs_195
    buffer_store_dword v12, v4, s[40:43], s57 offen offset:32
L_gb_196:
    s_branch L_comb_1b
.p2align 5
L_sr_206:
    buffer_load_dwordx4 v[52:55], v11, s[40:43], s65 offen offset:0 sc1
    buffer_load_dwordx4 v[56:59], v11, s[40:43], s65 offen offset:1024 sc1
    s_sub_u32 s56, s56, 1
    s_cbranch_scc1 L_done
    s_waitcnt vmcnt(0)
    s_branch L_sw_205
L_hr_207:
    buffer_load_dwordx4 v[12:15], v11, s[40:43], s58 offen offset:0 sc1
    buffer_load_dwordx4 v[16:19], v11, s[40:43], s58 offen offset:1024 sc1
    s_sub_u32 s56, s56, 1
    s_cbranch_scc1 L_done
    s_and_b32 s64, s56, 31
    s_cbranch_scc0 L_hx_209
    s_waitcnt vmcnt(2)
    v_pk_add_f32 v[20:21], v[12:13], v[16:17]
    v_pk_add_f32 v[22:23], v[14:15], v[18:19]
    s_nop 1
    v_permlane32_swap_b32 v20, v22
    v_permlane32_swap_b32 v21, v23
    v_pk_add_f32 v[20:21], v[20:21], v[22:23]
    s_nop 1
    v_permlane16_swap_b32 v20, v21
    v_add_f32 v20, v20, v21
    v_cmp_u_f32 vcc, v20, v20
    v_sub_f32 v20, v20, v26
    s_cbranch_vccnz L_hr_207
    s_branch L_hk_208
.p2align 5
L_hx_209:
    s_waitcnt vmcnt(0)
    v_max3_u32 v20, v12, v13, v14
    v_max3_u32 v20, v20, v15, v16
    v_max3_u32 v20, v20, v17, v18
    v_max_u32 v20, v20, v19
L_pad24:
    s_cbranch_execz L_padback
    v_cmp_eq_u32 vcc, -1, v20
    s_cbranch_vccnz L_hr_207
    v_pk_add_f32 v[20:21], v[12:13], v[16:17]
    v_pk_add_f32 v[22:23], v[14:15], v[18:19]
    s_nop 1
    v_permlane32_swap_b32 v20, v22
    v_permlane32_swap_b32 v21, v23
    v_pk_add_f32 v[20:21], v[20:21], v[22:23]
    s_nop 1
    v_permlane16_swap_b32 v20, v21
    v_add_f32 v20, v20, v21
    v_sub_f32 v20, v20, v26
    s_branch L_hk_208
.p2align 5
L_typeC_212:
    s_cmp_eq_u32 s30, 6
    s_cbranch_scc0 L_done
    s_cmp_eq_u32 s3, 20
    s_cbranch_scc0 L_done
    s_lshl_b32 s59, s31, 9
    s_add_u32 s59, s59, s8
    s_add_u32 s59, s59, 266240
    v_and_b32 v10, 1, v0
    v_lshlrev_b32 v10, 13, v10
    v_lshrrev_b32 v60, 1, v0
    v_lshl_add_u32 v10, v60, 24, v10
    s_add_u32 s58, s62, 28192
    v_lshrrev_b32 v9, 3, v0
    v_mul_u32_u24 v9, 1664, v9
    v_and_b32 v60, 7, v0
    v_lshl_add_u32 v9, v60, 2, v9
.p2align 5
L_pr_214:
    buffer_load_dword v12, v9, s[40:43], s58 offen sc1
    s_sub_u32 s56, s56, 1
    s_cbranch_scc1 L_done
L_pw_213:
    s_waitcnt vmcnt(0)
    v_cmp_eq_u32 vcc, -1, v12
    s_cbranch_vccnz L_pr_214
    buffer_store_dword v0, v10, s[40:43], s59 offen offset:8 sc1
    s_add_u32 s58, s62, 25984
    v_and_b32 v9, 15, v0
    v_lshlrev_b32 v9, 2, v9
.p2align 5
L_pr_216:
    buffer_load_dword v13, v9, s[40:43], s58 offen sc1
    s_sub_u32 s56, s56, 1
    s_cbranch_scc1 L_done
L_pw_215:
    s_waitcnt vmcnt(0)
    v_cmp_eq_u32 vcc, -1, v13
    s_cbranch_vccnz L_pr_216
    buffer_store_dword v0, v10, s[40:43], s59 offen offset:12 sc1
    s_waitcnt vmcnt(1)
    s_branch L_done
.p2align 5
L_gs_220:
    buffer_store_dword v12, v11, s[40:43], s59 offen sc1
    s_branch L_gb_221
.p2align 5
L_gr_223:
    s_cbranch_scc1 L_gw_222
    s_waitcnt vmcnt(0)
    v_max3_u32 v32, v12, v13, v14
    v_max3_u32 v32, v32, v15, v16
    v_max3_u32 v32, v32, v17, v18
    v_max3_u32 v32, v32, v19, v20
    v_max3_u32 v32, v32, v21, v22
    v_max3_u32 v32, v32, v23, v24
    v_max3_u32 v32, v32, v25, v26
    v_max_u32 v32, v32, v27
    v_cmp_eq_u32 vcc, -1, v32
    s_cbranch_vccnz L_gw_222
    v_pk_add_f32 v[28:29], v[12:13], v[36:37]
    v_pk_add_f32 v[30:31], v[14:15], v[38:39]
    v_pk_add_f32 v[28:29], v[28:29], v[16:17]
    v_pk_add_f32 v[30:31], v[30:31], v[18:19]
    v_pk_add_f32 v[28:29], v[28:29], v[20:21]
    v_pk_add_f32 v[30:31], v[30:31], v[22:23]
    v_pk_add_f32 v[28:29], v[28:29], v[24:25]
    v_pk_add_f32 v[30:31], v[30:31], v[26:27]
    s_nop 1
    v_permlane32_swap_b32 v28, v30
    v_permlane32_swap_b32 v29, v31
    s_branch L_gk_224
.p2align 5
L_gs_227:
L_pad25:
    s_cbranch_execz L_padback
    buffer_store_dword v33, v34, s[40:43], s67 offen sc1
    s_branch L_gb_228
.p2align 5
L_w7_217:
    v_and_b32 v60, 31, v0
    v_min_u32 v60, 19, v60
    s_mul_i32 s57, s54, 320
    v_lshrrev_b32 v5, 5, v0
    v_lshlrev_b32 v5, 12, v5
    v_add_u32 v5, s57, v5
    v_lshl_add_u32 v5, v60, 4, v5
    v_and_b32 v60, 31, v0
    v_cmp_gt_u32 s[64:65], 20, v60
    v_min_u32 v60, 19, v60
    v_lshrrev_b32 v35, 5, v0
    v_lshlrev_b32 v35, 2, v35
    v_add_u32 v35, 160832, v35
    v_lshl_add_u32 v35, v60, 3, v35
    s_add_u32 s66, s62, 39936
    s_add_u32 s67, s62, 25984
    s_lshl_b32 s57, s54, 3
    v_lshrrev_b32 v34, 5, v0
    v_lshlrev_b32 v34, 2, v34
    v_add_u32 v34, s57, v34
    v_and_b32 v60, 31, v0
    v_mov_b32 v61, 0x7f000000
    v_cmp_ne_u32 vcc, 31, v60
    s_nop 1
    v_cndmask_b32 v34, v34, v61, vcc
    v_mov_b32 v61, 0x3f803f80
    s_add_u32 s57, s7, 132096
    s_add_u32 s58, s7, 148480
    s_add_u32 s59, s7, 164864
    s_add_u32 s60, s7, 181248
    v_mov_b64 v[36:37], 0
    v_mov_b64 v[38:39], 0
    s_nop 0
    v_mov_b32_dpp v36, v2 quad_perm:[0,1,2,3] row_mask:0x3 bank_mask:0xf
    v_mov_b32_dpp v37, v3 quad_perm:[0,1,2,3] row_mask:0x3 bank_mask:0xf
    v_mov_b32_dpp v38, v2 quad_perm:[0,1,2,3] row_mask:0xc bank_mask:0xf
    v_mov_b32_dpp v39, v3 quad_perm:[0,1,2,3] row_mask:0xc bank_mask:0xf
    s_add_u32 s75, s7, 266248
    v_and_b32 v9, 7, v0
    v_lshlrev_b32 v9, 9, v9
.p2align 5
L_pr_226:
    buffer_load_dword v12, v9, s[40:43], s75 offen sc1
    s_sub_u32 s56, s56, 1
    s_cbranch_scc1 L_done
L_pw_225:
    s_waitcnt vmcnt(0)
    v_cmp_eq_u32 vcc, -1, v12
    s_cbranch_vccnz L_pr_226
.p2align 5
L_gw_222:
    buffer_load_dwordx4 v[12:15], v5, s[40:43], s57 offen sc1
    buffer_load_dwordx4 v[16:19], v5, s[40:43], s58 offen sc1
    buffer_load_dwordx4 v[20:23], v5, s[40:43], s59 offen sc1
    buffer_load_dwordx4 v[24:27], v5, s[40:43], s60 offen sc1
    s_sub_u32 s56, s56, 1
    s_cbranch_scc1 L_done
    s_and_b32 s74, s56, 31
    s_waitcnt vmcnt(3)
    v_pk_add_f32 v[28:29], v[12:13], v[36:37]
    v_pk_add_f32 v[30:31], v[14:15], v[38:39]
    s_waitcnt vmcnt(2)
    v_pk_add_f32 v[28:29], v[28:29], v[16:17]
    v_pk_add_f32 v[30:31], v[30:31], v[18:19]
    s_waitcnt vmcnt(1)
    v_pk_add_f32 v[28:29], v[28:29], v[20:21]
    v_pk_add_f32 v[30:31], v[30:31], v[22:23]
    s_waitcnt vmcnt(0)
    v_pk_add_f32 v[28:29], v[28:29], v[24:25]
    v_pk_add_f32 v[30:31], v[30:31], v[26:27]
    v_pk_add_f32 v[32:33], v[28:29], v[30:31]
    v_cmp_u_f32 vcc, v32, v33
    v_permlane32_swap_b32 v28, v30
    v_permlane32_swap_b32 v29, v31
    s_cbranch_vccnz L_gr_223
L_gk_224:
    v_pk_add_f32 v[28:29], v[28:29], v[30:31]
    v_cvt_pk_bf16_f32 v28, v28, v29
    ds_write_b32 v35, v28
    v_cndmask_b32 v29, 0, v28, s[64:65]
    v_dot2_f32_bf16 v33, v29, v61, 0
    v_dot2_f32_bf16 v32, v29, v29, 0
L_pad26:
    s_cbranch_execz L_padback
    v_lshlrev_b32 v2, 16, v28
    v_and_b32 v3, 0xffff0000, v28
    s_cmp_eq_u32 s55, 0
    v_permlane32_swap_b32 v33, v32
    v_add_f32 v33, v33, v32
    s_waitcnt lgkmcnt(0)
    s_barrier
    v_add_f32_dpp v33, v33, v33 row_ror:8 row_mask:0xf bank_mask:0xf
    s_nop 1
    v_add_f32_dpp v33, v33, v33 row_ror:4 row_mask:0xf bank_mask:0xf
    s_nop 1
    v_add_f32_dpp v33, v33, v33 row_ror:2 row_mask:0xf bank_mask:0xf
    s_nop 1
    v_add_f32_dpp v33, v33, v33 row_ror:1 row_mask:0xf bank_mask:0xf
    s_nop 1
    v_add_f32_dpp v33, v33, v33 row_bcast:15 row_mask:0xa bank_mask:0xf
    s_cbranch_scc1 L_gs_227
    buffer_store_dword v33, v34, s[40:43], s67 offen
L_gb_228:
    s_waitcnt vmcnt(1)
    s_branch L_se_218
.p2align 5
L_gr_230:
    s_cbranch_scc1 L_gw_229
    s_waitcnt vmcnt(0)
    v_max3_u32 v32, v12, v13, v14
    v_max3_u32 v32, v32, v15, v16
    v_max3_u32 v32, v32, v17, v18
    v_max3_u32 v32, v32, v19, v20
    v_max3_u32 v32, v32, v21, v22
    v_max3_u32 v32, v32, v23, v24
    v_max3_u32 v32, v32, v25, v26
    v_max_u32 v32, v32, v27
    v_cmp_eq_u32 vcc, -1, v32
    s_cbranch_vccnz L_gw_229
    v_pk_add_f32 v[28:29], v[12:13], v[36:37]
    v_pk_add_f32 v[30:31], v[14:15], v[38:39]
    v_pk_add_f32 v[28:29], v[28:29], v[16:17]
    v_pk_add_f32 v[30:31], v[30:31], v[18:19]
    v_pk_add_f32 v[28:29], v[28:29], v[20:21]
    v_pk_add_f32 v[30:31], v[30:31], v[22:23]
    v_pk_add_f32 v[28:29], v[28:29], v[24:25]
    v_pk_add_f32 v[30:31], v[30:31], v[26:27]
    s_nop 1
    v_permlane32_swap_b32 v28, v30
    v_permlane32_swap_b32 v29, v31
    s_branch L_gk_231
L_tail_end:
.p2align 5
L_spread:
    s_add_u32 s62, s62, 966656
    s_cmp_eq_u32 s30, 5
    s_cbranch_scc0 L_skip_67
    v_mov_b64 v[12:13], -1
    v_mov_b64 v[14:15], -1
    v_lshlrev_b32 v16, 4, v0
    s_mul_i32 s57, s52, 2208
    s_add_u32 s57, s57, s62
    s_mov_b64 exec, 0x3ff
    buffer_store_dwordx4 v[12:15], v16, s[40:43], s57 offen offset:2048 sc1
    s_mov_b64 exec, -1
    buffer_store_dwordx4 v[12:15], v16, s[40:43], s57 offen offset:0 sc1
    buffer_store_dwordx4 v[12:15], v16, s[40:43], s57 offen offset:1024 sc1
L_skip_67:
    s_cmp_eq_u32 s30, 7
    s_cbranch_scc0 L_skip_68
    v_and_b32 v60, 31, v0
    v_cmp_gt_u32 s[64:65], 20, v60
    v_min_u32 v60, 19, v60
    v_lshrrev_b32 v35, 5, v0
    v_lshlrev_b32 v35, 2, v35
    v_add_u32 v35, 160832, v35
    v_lshl_add_u32 v35, v60, 3, v35
    s_mul_i32 s66, s53, 12416
    s_add_u32 s66, s66, s62
    s_add_u32 s66, s66, 70656
    s_add_u32 s67, s66, 12288
    s_lshl_b32 s57, s54, 3
    v_lshrrev_b32 v34, 5, v0
    v_lshlrev_b32 v34, 2, v34
    v_add_u32 v34, s57, v34
    v_and_b32 v60, 31, v0
    v_mov_b32 v61, 0x7f000000
    v_cmp_ne_u32 vcc, 31, v60
    s_nop 1
    v_cndmask_b32 v34, v34, v61, vcc
    v_mov_b32 v61, 0x3f803f80
    v_cvt_pk_bf16_f32 v28, v2, v3
L_skip_68:
    s_cmp_eq_u32 s30, 7
    s_cbranch_scc0 L_skip_69
    v_cndmask_b32 v29, 0, v28, s[64:65]
    v_dot2_f32_bf16 v33, v29, v61, 0
    v_dot2_f32_bf16 v32, v29, v29, 0
    v_lshlrev_b32 v2, 16, v28
    v_and_b32 v3, 0xffff0000, v28
    s_cmp_eq_u32 s55, 0
    v_permlane32_swap_b32 v33, v32
    v_add_f32 v33, v33, v32
    s_nop 1
    v_add_f32_dpp v33, v33, v33 row_ror:8 row_mask:0xf bank_mask:0xf
    s_nop 1
    v_add_f32_dpp v33, v33, v33 row_ror:4 row_mask:0xf bank_mask:0xf
    s_nop 1
    v_add_f32_dpp v33, v33, v33 row_ror:2 row_mask:0xf bank_mask:0xf
    s_nop 1
    v_add_f32_dpp v33, v33, v33 row_ror:1 row_mask:0xf bank_mask:0xf
    s_nop 1
    v_add_f32_dpp v33, v33, v33 row_bcast:15 row_mask:0xa bank_mask:0xf
    s_cbranch_scc1 L_gs_70
    buffer_store_dword v33, v34, s[40:43], s67 offen
L_gb_71:
    s_waitcnt vmcnt(1)
L_skip_69:
    s_cmp_lt_u32 s30, 6
    s_cbranch_scc0 L_skip_72
    s_lshr_b32 s57, s30, 1
    s_mul_i32 s57, s57, 1024
    s_and_b32 s58, s30, 1
    s_lshl_b32 s58, s58, 6
    s_add_u32 s57, s57, s58
    v_lshrrev_b32 v18, 5, v0
    v_mul_u32_u24 v18, 6144, v18
    v_bfe_u32 v60, v0, 3, 1
    v_mul_u32_u24 v60, 3072, v60
    v_add_u32 v18, v60, v18
    v_bfe_u32 v60, v0, 4, 1
    v_lshl_add_u32 v18, v60, 9, v18
    v_bfe_u32 v60, v0, 2, 1
    v_lshl_add_u32 v18, v60, 7, v18
    v_and_b32 v60, 3, v0
    v_lshl_add_u32 v18, v60, 3, v18
    v_add_u32 v18, s57, v18
    v_bfe_u32 v19, v0, 3, 1
    v_mul_u32_u24 v19, 3072, v19
    v_bfe_u32 v60, v0, 4, 1
    v_lshl_add_u32 v19, v60, 9, v19
    v_bfe_u32 v60, v0, 2, 1
    v_lshl_add_u32 v19, v60, 7, v19
    v_and_b32 v60, 3, v0
    v_lshl_add_u32 v19, v60, 3, v19
    v_lshrrev_b32 v60, 5, v0
    v_lshl_add_u32 v19, v60, 5, v19
    v_add_u32 v19, s57, v19
    v_add_u32 v19, 24576, v19
    ds_read_b64_tr_b16 v[28:29], v18 offset:0
    ds_read_b64_tr_b16 v[30:31], v18 offset:256
    ds_read_b64_tr_b16 v[32:33], v18 offset:12288
    ds_read_b64_tr_b16 v[34:35], v18 offset:12544
    ds_read_b64_tr_b16 v[36:37], v18 offset:32
    ds_read_b64_tr_b16 v[38:39], v18 offset:288
    ds_read_b64_tr_b16 v[40:41], v18 offset:12320
    ds_read_b64_tr_b16 v[42:43], v18 offset:12576
    ds_read_b64_tr_b16 v[24:25], v19 offset:0
    ds_read_b64_tr_b16 v[26:27], v19 offset:256
    v_lshrrev_b32 v49, 4, v0
    v_lshlrev_b32 v49, 5, v49
    v_bfe_u32 v60, v0, 1, 1
    v_lshl_add_u32 v49, v60, 4, v49
    v_bfe_u32 v60, v0, 3, 1
    v_mul_u32_u24 v60, 192, v60
    v_add_u32 v49, v60, v49
    v_add_u32 v49, 160832, v49
    v_bfe_u32 v50, v0, 1, 1
    v_lshlrev_b32 v50, 4, v50
    v_bfe_u32 v60, v0, 3, 1
    v_mul_u32_u24 v60, 192, v60
    v_add_u32 v50, v60, v50
    v_add_u32 v50, 160960, v50
    v_mov_b32 v60, 160992
    v_and_b32 v51, 5, v0
    v_cmp_eq_u32 vcc, 0, v51
    s_nop 1
    v_cndmask_b32 v52, v60, v49, vcc
    v_cmp_eq_u32 vcc, 4, v51
    s_nop 1
    v_cndmask_b32 v53, v60, v49, vcc
    v_lshrrev_b32 v49, 2, v0
    v_and_b32 v49, 12, v49
    v_cmp_eq_u32 vcc, v49, v51
    s_nop 1
    v_cndmask_b32 v48, v60, v50, vcc
    v_mov_b64 v[44:45], 0
    v_mov_b64 v[46:47], 0
    s_lshr_b32 s57, s30, 1
    s_lshl_b32 s57, s57, 11
    s_lshl_b32 s58, s58, 1
    s_add_u32 s57, s57, s58
    s_lshl_b32 s58, s54, 8
    s_add_u32 s57, s57, s58
    v_and_b32 v54, 31, v0
    v_lshlrev_b32 v54, 2, v54
    v_lshrrev_b32 v60, 5, v0
    v_mul_u32_u24 v60, 6144, v60
    v_add_u32 v54, v60, v54
    v_add_u32 v54, s57, v54
    s_mul_i32 s59, s53, 12416
    s_add_u32 s59, s59, s62
    s_add_u32 s59, s59, 70656
    s_add_u32 s60, s59, 12288
    ds_read_b128 v[12:15], v52
    ds_read_b128 v[16:19], v53
    ds_read_b128 v[20:23], v48
    s_waitcnt lgkmcnt(2)
    v_smfmac_f32_16x16x64_bf16 v[44:47], v[12:15], v[28:35], v1
    s_waitcnt lgkmcnt(1)
    v_smfmac_f32_16x16x64_bf16 v[44:47], v[16:19], v[36:43], v1
    s_waitcnt lgkmcnt(0)
    v_smfmac_f32_16x16x64_bf16 v[44:47], v[20:23], v[24:31], v1
    s_cmp_eq_u32 s55, 0
    s_nop 6
    v_add_f32 v12, v44, v46
    s_cbranch_scc1 L_gs_73
    buffer_store_dword v12, v54, s[40:43], s59 offen
L_gb_74:
L_skip_72:
    s_waitcnt vmcnt(0)
    s_barrier
    s_cmp_eq_u32 s30, 5
    s_cbranch_scc0 L_skip_75
    v_mov_b32 v25, 0
    s_lshl_b32 s57, s52, 2
    s_add_u32 s57, s57, s72
    s_mov_b64 exec, 1
    buffer_store_dword v25, v0, s[40:43], s57 offen offset:256 sc1
    s_mov_b64 exec, -1
    v_and_b32 v16, 31, v0
    v_lshlrev_b32 v16, 2, v16
.p2align 5
L_pr_77:
    buffer_load_dword v17, v16, s[40:43], s72 offen offset:256 sc1
    s_sub_u32 s56, s56, 1
    s_cbranch_scc1 L_done
L_pw_76:
    s_waitcnt vmcnt(0)
    v_cmp_eq_u32 vcc, -1, v17
    s_cbranch_vccnz L_pr_77
L_skip_75:
    s_barrier
    s_branch L_spread_back
.p2align 5
L_done:
L_exit:
    s_endpgm
.section .rodata,"a"
.p2align 6
.amdhsa_kernel interleave_layers__sliding_block_cached__dense_activation_gelu__decode_kernel
  .amdhsa_next_free_vgpr 256
  .amdhsa_next_free_sgpr 102
  .amdhsa_accum_offset 256
  .amdhsa_group_segment_fixed_size 0
  .amdhsa_kernarg_size 104
  .amdhsa_user_sgpr_count 2
  .amdhsa_user_sgpr_kernarg_segment_ptr 1
  .amdhsa_system_sgpr_workgroup_id_x 1
  .amdhsa_float_denorm_mode_32 3
.end_amdhsa_kernel
```

```asm
; @launch grid=(256,1,1) block=(512,1,1) lds=161216
.amdgcn_target "amdgcn-amd-amdhsa--gfx950"
.text
.fill 64, 4, 0xbf800000
.globl interleave_layers__sliding_block_cached__dense_activation_gelu__decode_kernel
.p2align 8
.type interleave_layers__sliding_block_cached__dense_activation_gelu__decode_kernel,@function
interleave_layers__sliding_block_cached__dense_activation_gelu__decode_kernel:
    s_load_dwordx16 s[4:19], s[0:1], 0
    s_cmp_ge_u32 s2, 256
    s_cbranch_scc1 L_exit
    v_lshrrev_b32 v5, 6, v0
    v_lshlrev_b32 v62, 6, v0
    v_readfirstlane_b32 s30, v5
    v_and_b32 v0, 63, v0
    s_getpc_b64 s[74:75]
L_pc:
    v_min_u32 v62, L_exit-L_pc, v62
    global_load_dword v63, v62, s[74:75]
    s_cmp_eq_u32 s30, 6
    s_cbranch_scc0 L_skip_1
    s_setprio 3
L_skip_1:
    s_and_b32 s31, s2, 7
    s_lshr_b32 s52, s2, 3
    s_and_b32 s53, s52, 3
    s_lshr_b32 s54, s52, 2
    s_lshl_b32 s73, s31, 2
    s_add_u32 s73, s73, s53
    v_lshrrev_b32 v8, 5, v0
    v_lshlrev_b32 v8, 2, v8
    v_bfe_u32 v60, v0, 4, 1
    v_lshl_add_u32 v8, v60, 0, v8
    v_and_b32 v9, 7, v0
    v_xor_b32 v8, v8, v9
    v_lshrrev_b32 v10, 3, v0
    v_mul_u32_u24 v10, 384, v10
    v_lshl_add_u32 v5, v8, 4, v10
    v_xor_b32 v6, 32, v5
    s_mul_i32 s64, s73, 12582912
    s_mul_i32 s58, s54, 3072
    s_add_u32 s64, s64, s58
    s_add_u32 s64, s64, 11010048
    s_sub_u32 s34, 1572864, s58
    s_mov_b32 s35, 0x20000
    s_mov_b32 s57, 0
    s_mov_b32 s58, 195584
    s_mov_b32 m0, 92160
    s_cmp_eq_u32 s30, 6
    s_cselect_b64 vcc, -1, 0
    s_waitcnt lgkmcnt(0)
    s_add_u32 s32, s6, s64
    s_addc_u32 s33, s7, 0
    s_load_dwordx8 s[20:27], s[0:1], 64
    s_load_dwordx2 s[28:29], s[0:1], 96
    s_cbranch_vccz L_skip_3
L_dma_2:
    buffer_load_dwordx4 v5, s[32:35], s57 offen offset:0 nt lds
    buffer_load_dwordx4 v6, s[32:35], s58 offen offset:1024 nt lds
    s_add_u32 s57, s57, 24576
    s_add_u32 s58, s58, 24576
    s_add_u32 m0, m0, 2048
    s_cmp_lg_u32 m0, 108544
    s_cbranch_scc1 L_dma_2
    s_mov_b32 s57, 128
    s_mov_b32 s58, 195712
    s_mov_b32 m0, 108544
L_dma_4:
    s_nop 0
    buffer_load_dwordx4 v5, s[32:35], s57 offen offset:0 nt lds
    buffer_load_dwordx4 v6, s[32:35], s58 offen offset:1024 nt lds
    s_add_u32 s57, s57, 24576
    s_add_u32 s58, s58, 24576
    s_add_u32 m0, m0, 2048
    s_cmp_lg_u32 m0, 116736
    s_cbranch_scc1 L_dma_4
L_skip_3:
    s_mul_i32 s3, s54, 3
    s_add_u32 s3, s3, s53
    s_cmp_eq_u32 s53, 3
    s_cselect_b32 s3, 31, s3
    v_lshrrev_b32 v8, 4, v0
    v_lshlrev_b32 v8, 1, v8
    v_xor_b32 v8, v8, v9
    v_lshl_add_u32 v7, v8, 4, v10
    v_lshrrev_b32 v2, 3, v0
    v_mul_u32_u24 v2, 12288, v2
    v_and_b32 v60, 7, v0
    v_lshl_add_u32 v2, v60, 4, v2
    s_mul_i32 s59, s73, 384
    s_mul_i32 s60, s54, 983040
    s_add_u32 s59, s59, s60
    s_sub_u32 s60, 7866368, s59
    s_lshl_b32 s61, s30, 11
    s_add_u32 s61, s61, 92160
    s_mul_i32 s62, s31, 120832
    s_add_u32 s62, s62, 299008
    s_lshl_b32 s72, s31, 9
    s_add_u32 s72, s72, 294912
    s_mov_b32 s56, 65536
    s_mov_b32 s55, 1
    s_getreg_b32 s63, hwreg(20, 0, 3)
    v_mov_b32 v3, 0
    v_mov_b32 v4, 0
    v_mov_b32 v11, 0
    v_mov_b32 v24, 0
    v_mov_b32 v34, 0
    v_mov_b64 v[12:13], -1
    v_mov_b64 v[14:15], -1
    v_lshlrev_b32 v10, 4, v0
    s_waitcnt lgkmcnt(0)
    s_add_u32 s36, s8, s64
    s_addc_u32 s37, s9, 0
    s_mov_b32 s38, s34
    s_mov_b32 s39, 0x20000
    s_mov_b32 s40, s28
    s_mov_b32 s41, s29
    s_mov_b32 s42, 2232320
    s_mov_b32 s43, 0x20000
    s_add_u32 s44, s10, s59
    s_addc_u32 s45, s11, 0
    s_mov_b32 s46, s60
    s_mov_b32 s47, 0x20000
    s_sub_u32 s44, s44, 2048
    s_subb_u32 s45, s45, 0
    s_cmp_lt_u32 s3, 20
    s_cselect_b32 s57, 7864320, 0
    s_add_u32 s58, s54, 1
    s_mul_i32 s58, s58, 245760
    s_cmp_lg_u32 s53, 3
    s_cselect_b64 s[48:49], s[12:13], s[16:17]
    s_cselect_b32 s50, s57, s58
    s_mov_b32 s51, 0x20000
    s_add_u32 s57, s28, 0
    s_sub_u32 s57, 0, s57
    s_and_b32 s57, s57, 0x3fff
    s_add_u32 s57, s57, 0
    s_lshr_b32 s58, s31, 1
    s_lshl_b32 s58, s58, 14
    s_add_u32 s6, s57, s58
    s_and_b32 s58, s31, 1
    s_lshl_b32 s58, s58, 12
    s_add_u32 s6, s6, s58
    s_lshl_b32 s58, s3, 7
    s_add_u32 s6, s6, s58
    s_mov_b32 s8, s57
    s_and_b32 s59, s3, 3
    s_lshl_b32 s58, s31, 2
    s_add_u32 s59, s59, s58
    s_lshl_b32 s59, s59, 7
    s_add_u32 s59, s59, s57
    s_add_u32 s59, s59, 262144
    s_add_u32 s10, s28, s59
    s_addc_u32 s11, s29, 0
    s_lshr_b32 s58, s63, 2
    s_xor_b32 s58, s58, 0
    s_mul_i32 s58, s58, 8192
    s_add_u32 s7, s57, s58
    s_cmp_eq_u32 s30, 5
    s_cbranch_scc0 L_skip_5
    s_cmp_eq_u32 s52, 31
    s_cbranch_scc0 L_skip_6
    s_mov_b64 exec, 0xffffff
    buffer_store_dwordx4 v[12:15], v10, s[40:43], s72 offen sc1
    s_mov_b64 exec, -1
L_skip_6:
    s_cmp_lt_u32 s3, 20
    s_cbranch_scc0 L_skip_7
    v_and_b32 v16, 7, v0
    v_lshlrev_b32 v16, 4, v16
    v_bfe_u32 v17, v0, 3, 1
    v_lshl_add_u32 v16, v17, 13, v16
    v_lshrrev_b32 v17, 4, v0
    v_mul_u32_u24 v17, 66048, v17
    v_add_u32 v16, v17, v16
    buffer_store_dwordx4 v[12:15], v16, s[40:43], s6 offen sc1
L_skip_7:
    s_cmp_eq_u32 s3, 20
    s_cbranch_scc0 L_skip_8
    s_lshl_b32 s58, s31, 9
    s_add_u32 s58, s58, s8
    s_add_u32 s58, s58, 266240
    v_and_b32 v16, 7, v0
    v_lshlrev_b32 v16, 4, v16
    v_bfe_u32 v60, v0, 3, 1
    v_lshl_add_u32 v16, v60, 13, v16
    v_lshrrev_b32 v60, 4, v0
    v_lshl_add_u32 v16, v60, 28, v16
    buffer_store_dwordx4 v[12:15], v16, s[40:43], s58 offen sc1
L_skip_8:
    s_sub_u32 s58, s3, 20
    s_cmp_lt_u32 s58, 4
    s_cselect_b32 s59, s59, 0x7f000000
    v_and_b32 v16, 7, v0
    v_lshlrev_b32 v16, 4, v16
    v_bfe_u32 v60, v0, 3, 1
    v_lshl_add_u32 v16, v60, 13, v16
    v_lshrrev_b32 v60, 4, v0
    v_lshl_add_u32 v16, v60, 28, v16
    buffer_store_dwordx4 v[12:15], v16, s[40:43], s59 offen sc1
    s_mul_i32 s57, s52, 2208
    s_add_u32 s57, s57, s62
    s_mov_b64 exec, 0x3ff
    buffer_store_dwordx4 v[12:15], v10, s[40:43], s57 offen offset:2048
    s_mov_b64 exec, -1
    buffer_store_dwordx4 v[12:15], v10, s[40:43], s57 offen offset:0
    buffer_store_dwordx4 v[12:15], v10, s[40:43], s57 offen offset:1024
    s_mov_b64 exec, -1
    v_lshlrev_b32 v16, 4, v0
    v_add_u32 v16, 159744, v16
    ds_write_b128 v16, v[12:15]
    v_and_b32 v3, 7, v0
    v_lshlrev_b32 v3, 5, v3
L_skip_5:
    s_cmp_eq_u32 s30, 7
    s_cbranch_scc0 L_skip_9
    v_and_b32 v60, 31, v0
    v_min_u32 v60, 19, v60
    s_mul_i32 s57, s54, 160
    v_lshrrev_b32 v16, 5, v0
    v_lshlrev_b32 v16, 2, v16
    v_add_u32 v16, s57, v16
    v_lshl_add_u32 v16, v60, 3, v16
    global_load_dword v28, v16, s[4:5]
    global_load_dword v4, v16, s[22:23]
L_skip_9:
    s_sub_u32 s58, s30, 4
    s_cmp_lt_u32 s58, 3
    s_cbranch_scc0 L_skip_10
    s_mul_i32 s57, s31, 3
    s_add_u32 s57, s57, s58
    s_lshl_b32 s57, s57, 7
    v_and_b32 v16, 15, v0
    v_lshlrev_b32 v16, 3, v16
    v_lshrrev_b32 v60, 4, v0
    v_lshl_add_u32 v16, v60, 1, v16
    v_add_u32 v16, s57, v16
    global_load_short_d16_hi v4, v16, s[18:19]
L_skip_10:
    v_bfe_u32 v8, v0, 1, 3
    v_lshrrev_b32 v9, 4, v0
    v_xor_b32 v9, v8, v9
    v_bfe_u32 v8, v0, 2, 1
    v_lshlrev_b32 v8, 10, v8
    v_bfe_u32 v60, v0, 3, 1
    v_lshl_add_u32 v8, v60, 9, v8
    v_and_b32 v60, 3, v0
    v_lshl_add_u32 v8, v60, 7, v8
    v_add_u32 v8, s61, v8
    v_lshl_add_u32 v8, v9, 4, v8
    v_xor_b32 v9, 64, v8
    v_bfe_u32 v1, v0, 1, 1
    v_mul_u32_u24 v1, 43690, v1
    v_add_u32 v1, 17476, v1
    s_cmp_eq_u32 s30, 6
    s_cbranch_scc0 L_skip_11
    s_mov_b32 s57, 98432
    s_mov_b32 s58, 294016
    s_mov_b32 m0, 116736
L_dma_12:
    s_waitcnt vmcnt(22)
    buffer_load_dwordx4 v5, s[32:35], s57 offen offset:0 nt lds
    buffer_load_dwordx4 v6, s[32:35], s58 offen offset:1024 nt lds
    s_add_u32 s57, s57, 24576
    s_add_u32 s58, s58, 24576
    s_add_u32 m0, m0, 2048
    s_cmp_lg_u32 m0, 124928
    s_cbranch_scc1 L_dma_12
    s_mov_b32 s57, 2048
    s_mov_b32 s58, 1152
    s_mov_b32 s59, 256
    s_mov_b32 m0, 0
L_dma_13:
    s_waitcnt vmcnt(22)
    buffer_load_dwordx4 v2, s[44:47], s57 offen offset:0 nt lds
    buffer_load_dwordx4 v2, s[44:47], s58 offen offset:1024 nt lds
    buffer_load_dwordx4 v2, s[44:47], s59 offen offset:2048 nt lds
    s_add_u32 s57, s57, 98304
    s_add_u32 s58, s58, 98304
    s_add_u32 s59, s59, 98304
    s_add_u32 m0, m0, 3072
    s_cmp_lg_u32 m0, 15360
    s_cbranch_scc1 L_dma_13
L_skip_11:
    s_waitcnt vmcnt(31)
    s_barrier
    ds_read_b128 v[64:67], v8 offset:0
    ds_read_b128 v[68:71], v9 offset:0
    s_cmp_eq_u32 s30, 6
    s_cbranch_scc0 L_skip_14
    s_mov_b32 s57, 256
    s_mov_b32 s58, 195840
    s_mov_b32 m0, 124928
L_dma_15:
    s_waitcnt vmcnt(22)
    buffer_load_dwordx4 v5, s[32:35], s57 offen offset:0 nt lds
    buffer_load_dwordx4 v6, s[32:35], s58 offen offset:1024 nt lds
    s_add_u32 s57, s57, 24576
    s_add_u32 s58, s58, 24576
    s_add_u32 m0, m0, 2048
    s_cmp_lg_u32 m0, 141312
    s_cbranch_scc1 L_dma_15
L_skip_14:
    s_waitcnt lgkmcnt(0)
    s_cmp_eq_u32 s30, 5
    s_cbranch_scc0 L_skip_16
    s_cmp_eq_u32 s52, 31
    s_cbranch_scc0 L_skip_17
    s_lshl_b32 s57, s31, 5
    v_mov_b32 v16, s57
    s_add_u32 s57, s63, 1
    v_mov_b32 v12, s57
    s_waitcnt vmcnt(5)
    s_mov_b64 exec, 0x1
    global_store_dword v16, v12, s[26:27] sc1
    s_mov_b64 exec, -1
L_skip_17:
L_skip_16:
    s_waitcnt vmcnt(31)
    s_barrier
    ds_read_b128 v[72:75], v8 offset:16384
    ds_read_b128 v[76:79], v9 offset:16384
    s_cmp_eq_u32 s30, 6
    s_cbranch_scc0 L_skip_18
    s_mov_b32 s57, 493568
    s_mov_b32 s58, 492672
    s_mov_b32 s59, 491776
    s_mov_b32 m0, 15360
L_dma_19:
    s_waitcnt vmcnt(22)
    buffer_load_dwordx4 v2, s[44:47], s57 offen offset:0 nt lds
    buffer_load_dwordx4 v2, s[44:47], s58 offen offset:1024 nt lds
    buffer_load_dwordx4 v2, s[44:47], s59 offen offset:2048 nt lds
    s_add_u32 s57, s57, 98304
    s_add_u32 s58, s58, 98304
    s_add_u32 s59, s59, 98304
    s_add_u32 m0, m0, 3072
    s_cmp_lg_u32 m0, 30720
    s_cbranch_scc1 L_dma_19
    s_mov_b32 s57, 393216
    s_mov_b32 s58, 588800
    s_mov_b32 m0, 141312
L_dma_20:
    s_waitcnt vmcnt(22)
    buffer_load_dwordx4 v5, s[32:35], s57 offen offset:0 nt lds
    buffer_load_dwordx4 v6, s[32:35], s58 offen offset:1024 nt lds
    s_add_u32 s57, s57, 24576
    s_add_u32 s58, s58, 24576
    s_add_u32 m0, m0, 2048
    s_cmp_lg_u32 m0, 157696
    s_cbranch_scc1 L_dma_20
L_skip_18:
    s_waitcnt lgkmcnt(0)
    s_cmp_lt_u32 s30, 4
    s_cbranch_scc0 L_skip_21
    s_mov_b64 exec, 0
    s_cmp_eq_u32 s30, 1
    s_cbranch_scc1 L_pad1
    s_cmp_eq_u32 s30, 2
    s_cbranch_scc1 L_pad2
    s_cmp_eq_u32 s30, 3
    s_cbranch_scc1 L_pad3
    s_branch L_pad0
.p2align 5
L_padback:
    s_mov_b64 exec, -1
L_skip_21:
    s_waitcnt vmcnt(31)
    s_barrier
    ds_read_b128 v[80:83], v8 offset:32768
    ds_read_b128 v[84:87], v9 offset:32768
    s_cmp_eq_u32 s30, 6
    s_cbranch_scc0 L_skip_22
    s_cmp_lg_u32 s53, 3
    s_cbranch_scc0 L_wb_23
    s_mul_i32 s57, s31, 983040
    s_lshl_b32 s58, s3, 6
    s_add_u32 s57, s57, s58
    v_bfe_u32 v38, v0, 4, 1
    v_lshlrev_b32 v38, 1, v38
    v_xor_b32 v38, v38, v0
    v_and_b32 v38, 3, v38
    v_lshrrev_b32 v3, 5, v0
    v_mul_u32_u24 v3, 10240, v3
    v_bfe_u32 v39, v0, 4, 1
    v_mul_u32_u24 v39, 2560, v39
    v_add_u32 v3, v39, v3
    v_bfe_u32 v39, v0, 3, 1
    v_mul_u32_u24 v39, 5120, v39
    v_add_u32 v3, v39, v3
    v_bfe_u32 v39, v0, 2, 1
    v_mul_u32_u24 v39, 20480, v39
    v_add_u32 v3, v39, v3
    v_add_u32 v3, s57, v3
    v_lshl_add_u32 v3, v38, 4, v3
    s_mov_b32 s14, 40960
    s_mov_b32 s15, 256
    s_branch L_we_24
.p2align 5
L_wb_23:
    s_mul_i32 s57, s31, 384
    s_mul_i32 s58, s54, 245760
    s_add_u32 s57, s57, s58
    v_lshlrev_b32 v3, 4, v0
    v_add_u32 v3, s57, v3
    v_mov_b32 v38, 2688
    v_cmp_lt_u32 vcc, 23, v0
    s_nop 1
    v_cndmask_b32 v38, 0, v38, vcc
    v_add_u32 v3, v38, v3
    v_mov_b32 v38, 0x7f000000
    v_cmp_lt_u32 vcc, 47, v0
    s_nop 1
    v_cndmask_b32 v3, v3, v38, vcc
    s_mov_b32 s14, 12288
    s_mov_b32 s15, 5120
L_we_24:
    s_mul_i32 s57, s14, 0
    s_mov_b32 m0, 30720
    s_nop 0
    buffer_load_dwordx4 v3, s[48:51], s57 offen offset:0 nt lds
    s_mul_i32 s57, s14, 0
    s_add_u32 s57, s57, s15
    s_mov_b32 m0, 30720
    s_nop 0
    buffer_load_dwordx4 v3, s[48:51], s57 offen offset:1024 nt lds
    s_mov_b32 s57, 393344
    s_mov_b32 s58, 588928
    s_mov_b32 m0, 92160
L_dma_25:
    s_waitcnt vmcnt(22)
    buffer_load_dwordx4 v5, s[32:35], s57 offen offset:0 nt lds
    buffer_load_dwordx4 v6, s[32:35], s58 offen offset:1024 nt lds
    s_add_u32 s57, s57, 24576
    s_add_u32 s58, s58, 24576
    s_add_u32 m0, m0, 2048
    s_cmp_lg_u32 m0, 108544
    s_cbranch_scc1 L_dma_25
    s_mul_i32 s57, s14, 1
    s_mov_b32 m0, 32768
    s_nop 0
    buffer_load_dwordx4 v3, s[48:51], s57 offen offset:0 nt lds
    s_mul_i32 s57, s14, 1
    s_add_u32 s57, s57, s15
    s_mov_b32 m0, 32768
    s_nop 0
    buffer_load_dwordx4 v3, s[48:51], s57 offen offset:1024 nt lds
    s_mov_b32 s57, 393472
    s_mov_b32 s58, 589056
    s_mov_b32 m0, 108544
L_dma_26:
    s_waitcnt vmcnt(22)
    buffer_load_dwordx4 v5, s[32:35], s57 offen offset:0 nt lds
    buffer_load_dwordx4 v6, s[32:35], s58 offen offset:1024 nt lds
    s_add_u32 s57, s57, 24576
    s_add_u32 s58, s58, 24576
    s_add_u32 m0, m0, 2048
    s_cmp_lg_u32 m0, 124928
    s_cbranch_scc1 L_dma_26
L_skip_22:
    s_waitcnt lgkmcnt(0)
    s_cmp_lt_u32 s30, 5
    s_cbranch_scc0 L_skip_27
    s_waitcnt vmcnt(0)
L_skip_27:
    s_cmp_eq_u32 s30, 7
    s_cbranch_scc0 L_skip_28
    v_and_b32 v60, 31, v0
    v_cmp_gt_u32 s[64:65], 20, v60
    v_min_u32 v60, 19, v60
    v_lshrrev_b32 v35, 5, v0
    v_lshlrev_b32 v35, 2, v35
    v_add_u32 v35, 160832, v35
    v_lshl_add_u32 v35, v60, 3, v35
    s_mul_i32 s66, s53, 12416
    s_add_u32 s66, s66, s62
    s_add_u32 s66, s66, 70656
    s_add_u32 s67, s66, 12288
    s_lshl_b32 s57, s54, 3
    v_lshrrev_b32 v34, 5, v0
    v_lshlrev_b32 v34, 2, v34
    v_add_u32 v34, s57, v34
    v_and_b32 v60, 31, v0
    v_mov_b32 v61, 0x7f000000
    v_cmp_ne_u32 vcc, 31, v60
    s_nop 1
    v_cndmask_b32 v34, v34, v61, vcc
    v_mov_b32 v61, 0x3f803f80
    s_waitcnt vmcnt(0)
    ds_write_b32 v35, v28
    s_waitcnt lgkmcnt(0)
L_skip_28:
    s_cmp_eq_u32 s30, 5
    s_cbranch_scc0 L_skip_29
    s_waitcnt vmcnt(0)
    s_lshr_b32 s67, s63, 2
    s_sub_u32 s58, s3, 20
    s_cmp_lt_u32 s58, 4
    s_cbranch_scc0 L_skip_30
    s_mov_b32 s67, 0
    s_load_dword s66, s[10:11], 0
    s_load_dword s67, s[10:11], 8192
    s_waitcnt lgkmcnt(1)
L_skip_30:
    v_subrev_u32 v16, 8, v0
    v_cmp_gt_u32 vcc, 40, v16
    v_mov_b32 v16, 0x3f803f80
    s_nop 0
    v_cndmask_b32 v18, 0, v16, vcc
    v_min_u32 v16, 55, v0
    v_lshlrev_b32 v16, 2, v16
    v_add_u32 v16, 160992, v16
    ds_write_b32 v16, v18
    s_mov_b32 s65, s67
    s_waitcnt lgkmcnt(0)
L_skip_29:
    s_waitcnt vmcnt(36)
    s_barrier
    ds_read_b128 v[88:91], v8 offset:49152
    ds_read_b128 v[92:95], v9 offset:49152
    s_cmp_eq_u32 s30, 6
    s_cbranch_scc0 L_skip_31
    s_mul_i32 s57, s14, 2
    s_mov_b32 m0, 34816
    s_nop 0
    buffer_load_dwordx4 v3, s[48:51], s57 offen offset:0 nt lds
    s_mul_i32 s57, s14, 2
    s_add_u32 s57, s57, s15
    s_mov_b32 m0, 34816
    s_nop 0
    buffer_load_dwordx4 v3, s[48:51], s57 offen offset:1024 nt lds
    s_mov_b32 s57, 786432
    s_mov_b32 s58, 982016
    s_mov_b32 m0, 124928
L_dma_32:
    s_waitcnt vmcnt(22)
    buffer_load_dwordx4 v5, s[32:35], s57 offen offset:0 nt lds
    buffer_load_dwordx4 v6, s[32:35], s58 offen offset:1024 nt lds
    s_add_u32 s57, s57, 24576
    s_add_u32 s58, s58, 24576
    s_add_u32 m0, m0, 2048
    s_cmp_lg_u32 m0, 141312
    s_cbranch_scc1 L_dma_32
L_skip_31:
    s_waitcnt lgkmcnt(0)
    s_cmp_eq_u32 s30, 7
    s_cbranch_scc0 L_skip_33
    v_cndmask_b32 v29, 0, v28, s[64:65]
    v_dot2_f32_bf16 v33, v29, v61, 0
    v_dot2_f32_bf16 v32, v29, v29, 0
    v_lshlrev_b32 v2, 16, v28
    v_and_b32 v3, 0xffff0000, v28
    s_cmp_eq_u32 s55, 0
    v_permlane32_swap_b32 v33, v32
    v_add_f32 v33, v33, v32
    s_nop 1
    v_add_f32_dpp v33, v33, v33 row_ror:8 row_mask:0xf bank_mask:0xf
    s_nop 1
    v_add_f32_dpp v33, v33, v33 row_ror:4 row_mask:0xf bank_mask:0xf
    s_nop 1
    v_add_f32_dpp v33, v33, v33 row_ror:2 row_mask:0xf bank_mask:0xf
    s_nop 1
    v_add_f32_dpp v33, v33, v33 row_ror:1 row_mask:0xf bank_mask:0xf
    s_nop 1
    v_add_f32_dpp v33, v33, v33 row_bcast:15 row_mask:0xa bank_mask:0xf
    s_cbranch_scc1 L_gs_34
    buffer_store_dword v33, v34, s[40:43], s67 offen
L_gb_35:
    s_waitcnt vmcnt(1)
L_skip_33:
    s_cmp_lt_u32 s30, 6
    s_cbranch_scc0 L_skip_36
    s_lshr_b32 s57, s30, 1
    s_mul_i32 s57, s57, 1024
    s_and_b32 s58, s30, 1
    s_lshl_b32 s58, s58, 6
    s_add_u32 s57, s57, s58
    v_lshrrev_b32 v18, 5, v0
    v_mul_u32_u24 v18, 6144, v18
    v_bfe_u32 v60, v0, 3, 1
    v_mul_u32_u24 v60, 3072, v60
    v_add_u32 v18, v60, v18
    v_bfe_u32 v60, v0, 4, 1
    v_lshl_add_u32 v18, v60, 9, v18
    v_bfe_u32 v60, v0, 2, 1
    v_lshl_add_u32 v18, v60, 7, v18
    v_and_b32 v60, 3, v0
    v_lshl_add_u32 v18, v60, 3, v18
    v_add_u32 v18, s57, v18
    v_bfe_u32 v19, v0, 3, 1
    v_mul_u32_u24 v19, 3072, v19
    v_bfe_u32 v60, v0, 4, 1
    v_lshl_add_u32 v19, v60, 9, v19
    v_bfe_u32 v60, v0, 2, 1
    v_lshl_add_u32 v19, v60, 7, v19
    v_and_b32 v60, 3, v0
    v_lshl_add_u32 v19, v60, 3, v19
    v_lshrrev_b32 v60, 5, v0
    v_lshl_add_u32 v19, v60, 5, v19
    v_add_u32 v19, s57, v19
    v_add_u32 v19, 24576, v19
    ds_read_b64_tr_b16 v[28:29], v18 offset:0
    ds_read_b64_tr_b16 v[30:31], v18 offset:256
    ds_read_b64_tr_b16 v[32:33], v18 offset:12288
    ds_read_b64_tr_b16 v[34:35], v18 offset:12544
    ds_read_b64_tr_b16 v[36:37], v18 offset:32
    ds_read_b64_tr_b16 v[38:39], v18 offset:288
    ds_read_b64_tr_b16 v[40:41], v18 offset:12320
    ds_read_b64_tr_b16 v[42:43], v18 offset:12576
    ds_read_b64_tr_b16 v[24:25], v19 offset:0
    ds_read_b64_tr_b16 v[26:27], v19 offset:256
    v_lshrrev_b32 v49, 4, v0
    v_lshlrev_b32 v49, 5, v49
    v_bfe_u32 v60, v0, 1, 1
    v_lshl_add_u32 v49, v60, 4, v49
    v_bfe_u32 v60, v0, 3, 1
    v_mul_u32_u24 v60, 192, v60
    v_add_u32 v49, v60, v49
    v_add_u32 v49, 160832, v49
    v_bfe_u32 v50, v0, 1, 1
    v_lshlrev_b32 v50, 4, v50
    v_bfe_u32 v60, v0, 3, 1
    v_mul_u32_u24 v60, 192, v60
    v_add_u32 v50, v60, v50
    v_add_u32 v50, 160960, v50
    v_mov_b32 v60, 160992
    v_and_b32 v51, 5, v0
    v_cmp_eq_u32 vcc, 0, v51
    s_nop 1
    v_cndmask_b32 v52, v60, v49, vcc
    v_cmp_eq_u32 vcc, 4, v51
    s_nop 1
    v_cndmask_b32 v53, v60, v49, vcc
    v_lshrrev_b32 v49, 2, v0
    v_and_b32 v49, 12, v49
    v_cmp_eq_u32 vcc, v49, v51
    s_nop 1
    v_cndmask_b32 v48, v60, v50, vcc
    v_mov_b64 v[44:45], 0
    v_mov_b64 v[46:47], 0
    s_lshr_b32 s57, s30, 1
    s_lshl_b32 s57, s57, 11
    s_lshl_b32 s58, s58, 1
    s_add_u32 s57, s57, s58
    s_lshl_b32 s58, s54, 8
    s_add_u32 s57, s57, s58
    v_and_b32 v54, 31, v0
    v_lshlrev_b32 v54, 2, v54
    v_lshrrev_b32 v60, 5, v0
    v_mul_u32_u24 v60, 6144, v60
    v_add_u32 v54, v60, v54
    v_add_u32 v54, s57, v54
    s_mul_i32 s59, s53, 12416
    s_add_u32 s59, s59, s62
    s_add_u32 s59, s59, 70656
    s_add_u32 s60, s59, 12288
    ds_read_b128 v[12:15], v52
    ds_read_b128 v[16:19], v53
    ds_read_b128 v[20:23], v48
    s_waitcnt lgkmcnt(2)
    v_smfmac_f32_16x16x64_bf16 v[44:47], v[12:15], v[28:35], v1
    s_waitcnt lgkmcnt(1)
    v_smfmac_f32_16x16x64_bf16 v[44:47], v[16:19], v[36:43], v1
    s_waitcnt lgkmcnt(0)
    v_smfmac_f32_16x16x64_bf16 v[44:47], v[20:23], v[24:31], v1
    s_cmp_eq_u32 s55, 0
    s_nop 6
    v_add_f32 v12, v44, v46
    s_cbranch_scc1 L_gs_37
    buffer_store_dword v12, v54, s[40:43], s59 offen
L_gb_38:
L_skip_36:
    s_cmp_eq_u32 s30, 5
    s_cbranch_scc0 L_skip_39
    global_load_dword v2, v3, s[26:27] sc1
L_skip_39:
    s_waitcnt vmcnt(36)
    s_barrier
    ds_read_b128 v[96:99], v8 offset:0
    ds_read_b128 v[100:103], v9 offset:0
    s_cmp_eq_u32 s30, 6
    s_cbranch_scc0 L_skip_40
    s_mul_i32 s57, s14, 3
    s_mov_b32 m0, 36864
    s_nop 0
    buffer_load_dwordx4 v3, s[48:51], s57 offen offset:0 nt lds
    s_mul_i32 s57, s14, 3
    s_add_u32 s57, s57, s15
    s_mov_b32 m0, 36864
    s_nop 0
    buffer_load_dwordx4 v3, s[48:51], s57 offen offset:1024 nt lds
    s_mov_b32 s57, 786560
    s_mov_b32 s58, 982144
    s_mov_b32 m0, 141312
L_dma_41:
    s_waitcnt vmcnt(22)
    buffer_load_dwordx4 v5, s[32:35], s57 offen offset:0 nt lds
    buffer_load_dwordx4 v6, s[32:35], s58 offen offset:1024 nt lds
    s_add_u32 s57, s57, 24576
    s_add_u32 s58, s58, 24576
    s_add_u32 m0, m0, 2048
    s_cmp_lg_u32 m0, 157696
    s_cbranch_scc1 L_dma_41
L_skip_40:
    s_waitcnt lgkmcnt(0)
    s_waitcnt vmcnt(36)
    s_barrier
    ds_read_b128 v[104:107], v8 offset:16384
    ds_read_b128 v[108:111], v9 offset:16384
    s_cmp_eq_u32 s30, 6
    s_cbranch_scc0 L_skip_42
    s_mul_i32 s57, s14, 4
    s_mov_b32 m0, 38912
    s_nop 0
    buffer_load_dwordx4 v3, s[48:51], s57 offen offset:0 nt lds
    s_mul_i32 s57, s14, 4
    s_add_u32 s57, s57, s15
    s_mov_b32 m0, 38912
    s_nop 0
    buffer_load_dwordx4 v3, s[48:51], s57 offen offset:1024 nt lds
    s_mov_b32 s57, 786688
    s_mov_b32 s58, 982272
    s_mov_b32 m0, 92160
L_dma_43:
    s_waitcnt vmcnt(22)
    buffer_load_dwordx4 v5, s[32:35], s57 offen offset:0 nt lds
    buffer_load_dwordx4 v6, s[32:35], s58 offen offset:1024 nt lds
    s_add_u32 s57, s57, 24576
    s_add_u32 s58, s58, 24576
    s_add_u32 m0, m0, 2048
    s_cmp_lg_u32 m0, 108544
    s_cbranch_scc1 L_dma_43
L_skip_42:
    s_waitcnt lgkmcnt(0)
    s_cmp_lg_u32 s30, 6
    s_cbranch_scc0 L_skip_44
    s_waitcnt vmcnt(0)
L_skip_44:
    s_waitcnt vmcnt(36)
    s_barrier
    ds_read_b128 v[112:115], v8 offset:32768
    ds_read_b128 v[116:119], v9 offset:32768
    s_cmp_eq_u32 s30, 6
    s_cbranch_scc0 L_skip_45
    s_mul_i32 s57, s14, 5
    s_mov_b32 m0, 40960
    s_nop 0
    buffer_load_dwordx4 v3, s[48:51], s57 offen offset:0 nt lds
    s_mul_i32 s57, s14, 5
    s_add_u32 s57, s57, s15
    s_mov_b32 m0, 40960
    s_nop 0
    buffer_load_dwordx4 v3, s[48:51], s57 offen offset:1024 nt lds
    s_mov_b32 s57, 1179648
    s_mov_b32 s58, 1375232
    s_mov_b32 m0, 108544
L_dma_46:
    s_waitcnt vmcnt(22)
    buffer_load_dwordx4 v5, s[32:35], s57 offen offset:0 nt lds
    buffer_load_dwordx4 v6, s[32:35], s58 offen offset:1024 nt lds
    s_add_u32 s57, s57, 24576
    s_add_u32 s58, s58, 24576
    s_add_u32 m0, m0, 2048
    s_cmp_lg_u32 m0, 124928
    s_cbranch_scc1 L_dma_46
L_skip_45:
    s_waitcnt lgkmcnt(0)
    s_cmp_eq_u32 s30, 5
    s_cbranch_scc0 L_skip_47
L_cw_48:
    v_readlane_b32 s57, v2, s31
    s_cmp_eq_u32 s57, 0
    s_cbranch_scc1 L_cr_49
    s_lshr_b32 s58, s63, 2
    s_xor_b32 s58, s58, s65
    s_and_b32 s58, s58, 1
    v_mov_b32 v25, s58
    s_sub_u32 s57, s57, 1
    s_cmp_eq_u32 s57, s63
    s_cselect_b32 s64, 1, 0
    s_cbranch_scc0 L_far_50
    s_lshl_b32 s57, s52, 2
    s_add_u32 s57, s57, s72
    s_mov_b64 exec, 1
    buffer_store_dword v25, v0, s[40:43], s57 offen offset:0
    s_mov_b64 exec, -1
L_fb_51:
L_skip_47:
    s_waitcnt vmcnt(36)
    s_barrier
    ds_read_b128 v[120:123], v8 offset:49152
    ds_read_b128 v[124:127], v9 offset:49152
    s_cmp_eq_u32 s30, 6
    s_cbranch_scc0 L_skip_52
    s_mul_i32 s57, s14, 6
    s_mov_b32 m0, 43008
    s_nop 0
    buffer_load_dwordx4 v3, s[48:51], s57 offen offset:0 nt lds
    s_mul_i32 s57, s14, 6
    s_add_u32 s57, s57, s15
    s_mov_b32 m0, 43008
    s_nop 0
    buffer_load_dwordx4 v3, s[48:51], s57 offen offset:1024 nt lds
    s_mov_b32 s57, 1179776
    s_mov_b32 s58, 1375360
    s_mov_b32 m0, 124928
L_dma_53:
    s_waitcnt vmcnt(22)
    buffer_load_dwordx4 v5, s[32:35], s57 offen offset:0 nt lds
    buffer_load_dwordx4 v6, s[32:35], s58 offen offset:1024 nt lds
    s_add_u32 s57, s57, 24576
    s_add_u32 s58, s58, 24576
    s_add_u32 m0, m0, 2048
    s_cmp_lg_u32 m0, 141312
    s_cbranch_scc1 L_dma_53
L_skip_52:
    s_waitcnt lgkmcnt(0)
    s_waitcnt vmcnt(36)
    s_barrier
    ds_read_b128 v[128:131], v8 offset:0
    ds_read_b128 v[132:135], v9 offset:0
    s_cmp_eq_u32 s30, 6
    s_cbranch_scc0 L_skip_54
    s_mul_i32 s57, s14, 7
    s_mov_b32 m0, 45056
    s_nop 0
    buffer_load_dwordx4 v3, s[48:51], s57 offen offset:0 nt lds
    s_mul_i32 s57, s14, 7
    s_add_u32 s57, s57, s15
    s_mov_b32 m0, 45056
    s_nop 0
    buffer_load_dwordx4 v3, s[48:51], s57 offen offset:1024 nt lds
    s_mov_b32 s57, 1179904
    s_mov_b32 s58, 1375488
    s_mov_b32 m0, 141312
L_dma_55:
    s_waitcnt vmcnt(22)
    buffer_load_dwordx4 v5, s[32:35], s57 offen offset:0 nt lds
    buffer_load_dwordx4 v6, s[32:35], s58 offen offset:1024 nt lds
    s_add_u32 s57, s57, 24576
    s_add_u32 s58, s58, 24576
    s_add_u32 m0, m0, 2048
    s_cmp_lg_u32 m0, 157696
    s_cbranch_scc1 L_dma_55
L_skip_54:
    s_waitcnt lgkmcnt(0)
    s_cmp_eq_u32 s30, 5
    s_cbranch_scc0 L_skip_56
    v_lshlrev_b32 v24, 2, v0
    buffer_load_dword v2, v24, s[40:43], s72 offen sc1
L_skip_56:
    s_waitcnt vmcnt(36)
    s_barrier
    ds_read_b128 v[136:139], v8 offset:16384
    ds_read_b128 v[140:143], v9 offset:16384
    s_cmp_eq_u32 s30, 6
    s_cbranch_scc0 L_skip_57
    s_mul_i32 s57, s14, 8
    s_mov_b32 m0, 47104
    s_nop 0
    buffer_load_dwordx4 v3, s[48:51], s57 offen offset:0 nt lds
    s_mul_i32 s57, s14, 8
    s_add_u32 s57, s57, s15
    s_mov_b32 m0, 47104
    s_nop 0
    buffer_load_dwordx4 v3, s[48:51], s57 offen offset:1024 nt lds
    s_mov_b32 s57, 0
    s_mov_b32 s58, 392192
    s_mov_b32 m0, 92160
L_dma_58:
    s_waitcnt vmcnt(22)
    buffer_load_dwordx4 v7, s[36:39], s57 offen offset:0 nt lds
    buffer_load_dwordx4 v7, s[36:39], s58 offen offset:1024 nt lds
    s_add_u32 s57, s57, 24576
    s_add_u32 s58, s58, 24576
    s_add_u32 m0, m0, 2048
    s_cmp_lg_u32 m0, 108544
    s_cbranch_scc1 L_dma_58
L_skip_57:
    s_waitcnt lgkmcnt(0)
    s_waitcnt vmcnt(36)
    s_barrier
    ds_read_b128 v[144:147], v8 offset:32768
    ds_read_b128 v[148:151], v9 offset:32768
    s_cmp_eq_u32 s30, 6
    s_cbranch_scc0 L_skip_59
    s_mul_i32 s57, s14, 9
    s_mov_b32 m0, 49152
    s_nop 0
    buffer_load_dwordx4 v3, s[48:51], s57 offen offset:0 nt lds
    s_mul_i32 s57, s14, 9
    s_add_u32 s57, s57, s15
    s_mov_b32 m0, 49152
    s_nop 0
    buffer_load_dwordx4 v3, s[48:51], s57 offen offset:1024 nt lds
    s_mov_b32 s57, 128
    s_mov_b32 s58, 392320
    s_mov_b32 m0, 108544
L_dma_60:
    s_waitcnt vmcnt(22)
    buffer_load_dwordx4 v7, s[36:39], s57 offen offset:0 nt lds
    buffer_load_dwordx4 v7, s[36:39], s58 offen offset:1024 nt lds
    s_add_u32 s57, s57, 24576
    s_add_u32 s58, s58, 24576
    s_add_u32 m0, m0, 2048
    s_cmp_lg_u32 m0, 124928
    s_cbranch_scc1 L_dma_60
L_skip_59:
    s_waitcnt lgkmcnt(0)
    s_cmp_eq_u32 s30, 5
    s_cbranch_scc0 L_skip_61
L_cw_62:
    s_waitcnt vmcnt(0)
    v_cmp_ne_u32 vcc, -1, v2
    s_mov_b32 s57, 0
    s_mov_b32 s68, 2
    s_cmp_eq_u32 s64, 0
    s_cbranch_scc1 L_cd_64
    s_cmp_lg_u32 vcc_hi, 0
    s_cbranch_scc1 L_cd_64
    s_cmp_lg_u32 vcc_lo, -1
    s_cbranch_scc1 L_cr_63
    v_cmp_eq_u32 vcc, 1, v2
    s_bcnt1_i32_b32 s68, vcc_lo
    s_mov_b32 s57, 1
L_cd_64:
    v_mov_b32 v37, 160768
    v_mov_b32 v38, s57
    ds_write_b32 v37, v38
    s_waitcnt lgkmcnt(0)
L_skip_61:
    s_waitcnt vmcnt(36)
    s_barrier
    ds_read_b128 v[152:155], v8 offset:49152
    ds_read_b128 v[156:159], v9 offset:49152
    s_cmp_eq_u32 s30, 6
    s_cbranch_scc0 L_skip_65
    s_mul_i32 s57, s14, 10
    s_mov_b32 m0, 51200
    s_nop 0
    buffer_load_dwordx4 v3, s[48:51], s57 offen offset:0 nt lds
    s_mul_i32 s57, s14, 10
    s_add_u32 s57, s57, s15
    s_mov_b32 m0, 51200
    s_nop 0
    buffer_load_dwordx4 v3, s[48:51], s57 offen offset:1024 nt lds
    s_mov_b32 s57, 256
    s_mov_b32 s58, 392448
    s_mov_b32 m0, 124928
L_dma_66:
    s_waitcnt vmcnt(22)
    buffer_load_dwordx4 v7, s[36:39], s57 offen offset:0 nt lds
    buffer_load_dwordx4 v7, s[36:39], s58 offen offset:1024 nt lds
    s_add_u32 s57, s57, 24576
    s_add_u32 s58, s58, 24576
    s_add_u32 m0, m0, 2048
    s_cmp_lg_u32 m0, 141312
    s_cbranch_scc1 L_dma_66
L_skip_65:
    s_waitcnt lgkmcnt(0)
    v_lshrrev_b32 v8, 2, v0
    v_lshlrev_b32 v8, 7, v8
    v_bfe_u32 v60, v0, 3, 2
    v_lshl_add_u32 v8, v60, 5, v8
    v_and_b32 v60, 3, v0
    v_lshl_add_u32 v8, v60, 3, v8
    v_add_u32 v8, s61, v8
    v_xor_b32 v9, 32, v8
    v_xor_b32 v10, 64, v8
    v_xor_b32 v11, 96, v8
    v_mov_b32 v41, 160768
    ds_read_b32 v42, v41
    s_waitcnt lgkmcnt(0)
    v_readfirstlane_b32 s55, v42
    s_cmp_eq_u32 s55, 0
    s_cbranch_scc1 L_spread
L_spread_back:
    s_cmp_eq_u32 s30, 5
    s_cbranch_scc0 L_skip_78
    s_cmp_eq_u32 s52, 31
    s_cbranch_scc0 L_skip_79
    s_lshl_b32 s57, s31, 5
    v_mov_b32 v16, s57
    s_add_u32 s57, s68, 1
    v_mov_b32 v12, s57
    s_mov_b64 exec, 0x1
    global_store_dword v16, v12, s[26:27] offset:4 sc1
    s_mov_b64 exec, -1
L_skip_79:
L_skip_78:
    s_sub_u32 s58, s30, 1
    s_cmp_lt_u32 s58, 3
    s_cbranch_scc0 L_skip_80
    s_mul_i32 s59, s53, 12416
    s_add_u32 s59, s59, s62
    s_add_u32 s59, s59, 70656
    s_add_u32 s60, s59, 12288
    s_lshl_b32 s57, s58, 11
    v_lshlrev_b32 v48, 4, v0
    v_add_u32 v48, s57, v48
    v_and_b32 v49, 7, v0
    v_lshlrev_b32 v49, 3, v49
    s_add_u32 s57, s59, 6144
    buffer_load_dwordx4 v[12:15], v48, s[40:43], s59 offen offset:0 sc1 nt
    buffer_load_dwordx4 v[16:19], v48, s[40:43], s59 offen offset:1024 sc1 nt
    buffer_load_dwordx4 v[28:31], v48, s[40:43], s57 offen offset:0 sc1 nt
    buffer_load_dwordx4 v[32:35], v48, s[40:43], s57 offen offset:1024 sc1 nt
    buffer_load_dwordx2 v[24:25], v49, s[40:43], s60 offen sc1 nt
L_skip_80:
    s_waitcnt vmcnt(36)
    s_barrier
    ds_read_b64_tr_b16 v[160:161], v8 offset:0
    ds_read_b64_tr_b16 v[168:169], v9 offset:0
    ds_read_b64_tr_b16 v[176:177], v10 offset:0
    ds_read_b64_tr_b16 v[184:185], v11 offset:0
    s_cmp_eq_u32 s30, 6
    s_cbranch_scc0 L_skip_81
    s_mul_i32 s57, s14, 11
    s_mov_b32 m0, 53248
    s_nop 0
    buffer_load_dwordx4 v3, s[48:51], s57 offen offset:0 nt lds
    s_mul_i32 s57, s14, 11
    s_add_u32 s57, s57, s15
    s_mov_b32 m0, 53248
    s_nop 0
    buffer_load_dwordx4 v3, s[48:51], s57 offen offset:1024 nt lds
    s_mov_b32 s57, 196608
    s_mov_b32 s58, 588800
    s_mov_b32 m0, 141312
L_dma_82:
    s_waitcnt vmcnt(22)
    buffer_load_dwordx4 v7, s[36:39], s57 offen offset:0 nt lds
    buffer_load_dwordx4 v7, s[36:39], s58 offen offset:1024 nt lds
    s_add_u32 s57, s57, 24576
    s_add_u32 s58, s58, 24576
    s_add_u32 m0, m0, 2048
    s_cmp_lg_u32 m0, 157696
    s_cbranch_scc1 L_dma_82
L_skip_81:
    s_waitcnt lgkmcnt(0)
    s_waitcnt vmcnt(36)
    s_barrier
    ds_read_b64_tr_b16 v[192:193], v8 offset:16384
    ds_read_b64_tr_b16 v[200:201], v9 offset:16384
    ds_read_b64_tr_b16 v[208:209], v10 offset:16384
    ds_read_b64_tr_b16 v[216:217], v11 offset:16384
    s_cmp_eq_u32 s30, 6
    s_cbranch_scc0 L_skip_83
    s_mov_b32 s57, 196736
    s_mov_b32 s58, 588928
    s_mov_b32 m0, 92160
L_dma_84:
    s_waitcnt vmcnt(22)
    buffer_load_dwordx4 v7, s[36:39], s57 offen offset:0 nt lds
    buffer_load_dwordx4 v7, s[36:39], s58 offen offset:1024 nt lds
    s_add_u32 s57, s57, 24576
    s_add_u32 s58, s58, 24576
    s_add_u32 m0, m0, 2048
    s_cmp_lg_u32 m0, 108544
    s_cbranch_scc1 L_dma_84
L_skip_83:
    s_waitcnt lgkmcnt(0)
    s_sub_u32 s58, s30, 1
    s_cmp_lt_u32 s58, 3
    s_cbranch_scc0 L_skip_85
    s_lshl_b32 s57, s58, 7
    v_bfe_u32 v51, v0, 2, 2
    v_lshlrev_b32 v51, 5, v51
    v_lshrrev_b32 v60, 5, v0
    v_lshl_add_u32 v51, v60, 4, v51
    v_and_b32 v60, 3, v0
    v_lshl_add_u32 v51, v60, 2, v51
    v_bfe_u32 v60, v0, 4, 1
    v_lshl_add_u32 v51, v60, 1, v51
    v_add_u32 v51, s57, v51
    v_add_u32 v51, 157696, v51
    v_mov_b32 v60, 0x3c75e03e
    v_mov_b32 v61, 0x3a71d1e6
    v_mov_b32 v47, 0x3e13985d
    s_waitcnt vmcnt(0)
    v_pk_add_f32 v[36:37], v[28:29], v[32:33]
    v_pk_add_f32 v[38:39], v[30:31], v[34:35]
    s_nop 1
    v_permlane32_swap_b32 v36, v38
    v_permlane32_swap_b32 v37, v39
    v_pk_add_f32 v[36:37], v[36:37], v[38:39]
    s_nop 1
    v_permlane16_swap_b32 v36, v37
    v_add_f32 v36, v36, v37
    v_mul_f32 v6, 0x3dd53b95, v36
    v_add_f32_dpp v48, v24, v24 row_ror:4 row_mask:0xf bank_mask:0xf
    v_add_f32_dpp v49, v25, v25 row_ror:4 row_mask:0xf bank_mask:0xf
    v_pk_add_f32 v[20:21], v[12:13], v[16:17]
    v_pk_add_f32 v[22:23], v[14:15], v[18:19]
    v_add_f32_dpp v48, v48, v48 row_ror:2 row_mask:0xf bank_mask:0xf
    v_add_f32_dpp v49, v49, v49 row_ror:2 row_mask:0xf bank_mask:0xf
    v_permlane32_swap_b32 v20, v22
    v_permlane32_swap_b32 v21, v23
    v_add_f32_dpp v48, v48, v48 row_ror:1 row_mask:0xf bank_mask:0xf
    v_add_f32_dpp v49, v49, v49 row_ror:1 row_mask:0xf bank_mask:0xf
    v_pk_add_f32 v[20:21], v[20:21], v[22:23]
    v_mul_f32 v48, v48, v60
    v_fma_f32 v49, v49, v47, v61
    v_permlane16_swap_b32 v20, v21
    v_fma_f32 v49, -v48, v48, v49
    v_add_f32 v20, v20, v21
    v_max_f32 v49, v49, v61
    v_mul_f32 v50, v6, v48
    v_rsq_f32 v49, v49
    v_cmp_u_f32 vcc, v20, v20
    v_sub_f32 v20, v20, v50
    v_mul_f32 v20, v20, v49
    v_cvt_pk_bf16_f32 v20, v20, v20
    ds_write_b16 v51, v20
    s_waitcnt lgkmcnt(0)
L_skip_85:
    s_lshl_b32 s57, s30, 7
    s_add_u32 s57, s57, 158720
    v_lshrrev_b32 v58, 4, v0
    v_lshlrev_b32 v58, 5, v58
    v_bfe_u32 v60, v0, 1, 1
    v_lshl_add_u32 v58, v60, 4, v58
    v_bfe_u32 v60, v0, 2, 2
    v_lshl_add_u32 v58, v60, 2, v58
    v_and_b32 v60, 1, v0
    v_lshl_add_u32 v58, v60, 1, v58
    v_add_u32 v58, s57, v58
    v_lshrrev_b32 v61, 4, v0
    v_lshlrev_b32 v61, 5, v61
    v_bfe_u32 v60, v0, 1, 1
    v_lshl_add_u32 v61, v60, 4, v61
    v_add_u32 v61, s57, v61
    v_bfe_u32 v62, v0, 2, 2
    v_lshlrev_b32 v62, 1, v62
    v_and_b32 v60, 1, v0
    v_lshl_add_u32 v62, v60, 0, v62
    v_mov_b32 v60, 160992
    v_cmp_eq_u32 vcc, 0, v62
    s_nop 1
    v_cndmask_b32 v52, v60, v61, vcc
    v_cmp_eq_u32 vcc, 1, v62
    s_nop 1
    v_cndmask_b32 v53, v60, v61, vcc
    v_cmp_eq_u32 vcc, 2, v62
    s_nop 1
    v_cndmask_b32 v54, v60, v61, vcc
    v_cmp_eq_u32 vcc, 3, v62
    s_nop 1
    v_cndmask_b32 v55, v60, v61, vcc
    v_cmp_eq_u32 vcc, 4, v62
    s_nop 1
    v_cndmask_b32 v56, v60, v61, vcc
    v_cmp_eq_u32 vcc, 5, v62
    s_nop 1
    v_cndmask_b32 v57, v60, v61, vcc
    s_lshl_b32 s58, s30, 2
    s_add_u32 s58, s58, 159744
    v_mov_b32 v60, s58
    v_lshlrev_b32 v59, 2, v0
    v_add_u32 v59, 158208, v59
    v_cmp_eq_u32 vcc, 63, v0
    s_nop 1
    v_cndmask_b32 v59, v59, v60, vcc
    v_and_b32 v62, 7, v0
    v_lshlrev_b32 v62, 2, v62
    v_add_u32 v62, 159744, v62
    s_lshl_b32 s57, s30, 11
    v_lshlrev_b32 v63, 4, v0
    v_add_u32 v63, s57, v63
    v_add_u32 v63, 92160, v63
    s_waitcnt vmcnt(34)
    s_barrier
    ds_read_b64_tr_b16 v[224:225], v8 offset:32768
    ds_read_b64_tr_b16 v[232:233], v9 offset:32768
    ds_read_b64_tr_b16 v[240:241], v10 offset:32768
    ds_read_b64_tr_b16 v[248:249], v11 offset:32768
    s_cmp_eq_u32 s30, 6
    s_cbranch_scc0 L_skip_86
    s_mov_b32 s57, 196864
    s_mov_b32 s58, 589056
    s_mov_b32 m0, 108544
L_dma_87:
    s_nop 0
    buffer_load_dwordx4 v7, s[36:39], s57 offen offset:0 nt lds
    buffer_load_dwordx4 v7, s[36:39], s58 offen offset:1024 nt lds
    s_add_u32 s57, s57, 24576
    s_add_u32 s58, s58, 24576
    s_add_u32 m0, m0, 2048
    s_cmp_lg_u32 m0, 124928
    s_cbranch_scc1 L_dma_87
L_skip_86:
    s_waitcnt lgkmcnt(0)
    v_lshrrev_b32 v5, 4, v0
    v_lshlrev_b32 v5, 5, v5
    v_bfe_u32 v60, v0, 1, 1
    v_lshl_add_u32 v5, v60, 4, v5
    v_add_u32 v5, 157696, v5
    ds_read_b128 v[12:15], v5 offset:0
    ds_read_b128 v[16:19], v5 offset:128
    ds_read_b128 v[20:23], v5 offset:256
    v_mov_b64 v[24:25], 0
    v_mov_b64 v[26:27], 0
    v_mov_b64 v[28:29], 0
    v_mov_b64 v[30:31], 0
    v_mov_b64 v[32:33], 0
    v_mov_b64 v[34:35], 0
    v_mov_b64 v[36:37], 0
    v_mov_b64 v[38:39], 0
    v_mov_b64 v[40:41], 0
    v_mov_b64 v[42:43], 0
    v_mov_b64 v[44:45], 0
    v_mov_b64 v[46:47], 0
    s_waitcnt lgkmcnt(0)
    v_smfmac_f32_16x16x64_bf16 v[24:27], v[12:15], v[64:71], v1
    v_smfmac_f32_16x16x64_bf16 v[24:27], v[16:19], v[72:79], v1
    v_smfmac_f32_16x16x64_bf16 v[24:27], v[20:23], v[80:87], v1
    v_smfmac_f32_16x16x64_bf16 v[28:31], v[12:15], v[88:95], v1
    v_smfmac_f32_16x16x64_bf16 v[28:31], v[16:19], v[96:103], v1
    v_smfmac_f32_16x16x64_bf16 v[28:31], v[20:23], v[104:111], v1
    v_smfmac_f32_16x16x64_bf16 v[32:35], v[12:15], v[112:119], v1
    v_smfmac_f32_16x16x64_bf16 v[32:35], v[16:19], v[120:127], v1
    v_smfmac_f32_16x16x64_bf16 v[32:35], v[20:23], v[128:135], v1
    v_smfmac_f32_16x16x64_bf16 v[36:39], v[12:15], v[136:143], v1
    v_smfmac_f32_16x16x64_bf16 v[36:39], v[16:19], v[144:151], v1
    v_smfmac_f32_16x16x64_bf16 v[36:39], v[20:23], v[152:159], v1
    v_add_f32 v24, v24, v26
    s_nop 0
    v_add_f32 v28, v28, v30
    s_nop 1
    v_add_f32 v32, v32, v34
    v_max3_f32 v61, v24, v28, v32
    v_mov_b32_dpp v24, v28 quad_perm:[0,1,2,3] row_mask:0x2 bank_mask:0xf
    v_add_f32 v36, v36, v38
    v_max_f32 v61, v61, v36
    v_mov_b32_dpp v24, v32 quad_perm:[0,1,2,3] row_mask:0x4 bank_mask:0xf
    s_nop 0
    v_max_f32_dpp v61, v61, v61 row_ror:8 row_mask:0xf bank_mask:0xf
    s_nop 0
    v_mov_b32_dpp v24, v36 quad_perm:[0,1,2,3] row_mask:0x8 bank_mask:0xf
    v_max_f32_dpp v61, v61, v61 row_ror:4 row_mask:0xf bank_mask:0xf
    s_nop 1
    v_max_f32_dpp v61, v61, v61 row_ror:2 row_mask:0xf bank_mask:0xf
    s_nop 1
    v_max_f32_dpp v61, v61, v61 row_ror:1 row_mask:0xf bank_mask:0xf
    v_sub_f32 v36, v24, v61
    ds_write_b32 v59, v61
    v_exp_f32 v36, v36
    s_nop 0
    v_cvt_pk_bf16_f32 v39, v36, v36
    ds_write_b16 v58, v39
    ds_read_b128 v[12:15], v52
    ds_read_b128 v[16:19], v53
    ds_read_b128 v[20:23], v54
    ds_read_b128 v[24:27], v55
    ds_read_b128 v[28:31], v56
    ds_read_b128 v[32:35], v57
    v_add_f32_dpp v38, v36, v36 row_ror:8 row_mask:0xf bank_mask:0xf
    s_nop 1
    v_add_f32_dpp v38, v38, v38 row_ror:4 row_mask:0xf bank_mask:0xf
    s_nop 1
    v_add_f32_dpp v38, v38, v38 row_ror:2 row_mask:0xf bank_mask:0xf
    s_nop 1
    v_add_f32_dpp v38, v38, v38 row_ror:1 row_mask:0xf bank_mask:0xf
    s_nop 1
    v_add_f32_dpp v38, v38, v38 row_bcast:15 row_mask:0xa bank_mask:0xf
    s_nop 1
    v_add_f32_dpp v38, v38, v38 row_bcast:31 row_mask:0xc bank_mask:0xf
    s_waitcnt lgkmcnt(0)
    s_waitcnt vmcnt(32)
    s_barrier
    ds_read_b64_tr_b16 v[162:163], v8 offset:49152
    ds_read_b64_tr_b16 v[170:171], v9 offset:49152
    ds_read_b64_tr_b16 v[178:179], v10 offset:49152
    ds_read_b64_tr_b16 v[186:187], v11 offset:49152
    s_cmp_eq_u32 s30, 6
    s_cbranch_scc0 L_skip_88
    s_mov_b32 s57, 786432
    s_mov_b32 s58, 1178624
    s_mov_b32 m0, 124928
L_dma_89:
    s_nop 0
    buffer_load_dwordx4 v7, s[36:39], s57 offen offset:0 nt lds
    buffer_load_dwordx4 v7, s[36:39], s58 offen offset:1024 nt lds
    s_add_u32 s57, s57, 24576
    s_add_u32 s58, s58, 24576
    s_add_u32 m0, m0, 2048
    s_cmp_lg_u32 m0, 141312
    s_cbranch_scc1 L_dma_89
L_skip_88:
    s_waitcnt lgkmcnt(0)
    ds_read_b32 v36, v62
    s_waitcnt lgkmcnt(0)
    v_max_f32_dpp v37, v36, v36 row_ror:4 row_mask:0xf bank_mask:0xf
    s_nop 1
    v_max_f32_dpp v37, v37, v37 row_ror:2 row_mask:0xf bank_mask:0xf
    s_nop 1
    v_max_f32_dpp v37, v37, v37 row_ror:1 row_mask:0xf bank_mask:0xf
    v_sub_f32 v39, v61, v37
    v_exp_f32 v39, v39
    s_cmp_lt_u32 s30, 2
    s_cbranch_scc0 L_skip_90
    s_lshl_b32 s57, s30, 3
    v_lshlrev_b32 v2, 4, v0
    v_add_u32 v2, s57, v2
    v_add_u32 v2, 92160, v2
    v_mov_b32 v60, 94192
    v_cmp_le_u32 vcc, 48, v0
    s_nop 1
    v_cndmask_b32 v2, v2, v60, vcc
    s_lshr_b32 s57, s54, 1
    s_lshl_b32 s57, s57, 2
    s_and_b32 s58, s54, 1
    s_add_u32 s57, s57, s58
    s_lshl_b32 s58, s57, 4
    s_lshl_b32 s57, s57, 3
    v_bfe_u32 v3, v0, 3, 2
    v_lshlrev_b32 v3, 8, v3
    v_bfe_u32 v61, v0, 2, 1
    v_lshl_add_u32 v3, v61, 5, v3
    v_and_b32 v61, 3, v0
    v_lshl_add_u32 v3, v61, 2, v3
    v_add_u32 v3, s58, v3
    v_bfe_u32 v60, v0, 3, 1
    v_lshlrev_b32 v60, 8, v60
    v_bfe_u32 v61, v0, 1, 1
    v_lshl_add_u32 v60, v61, 7, v60
    v_bfe_u32 v61, v0, 2, 1
    v_lshl_add_u32 v60, v61, 4, v60
    v_and_b32 v61, 1, v0
    v_lshl_add_u32 v60, v61, 2, v60
    v_add_u32 v60, s57, v60
    v_add_u32 v60, 1024, v60
    v_cmp_gt_u32 vcc, 32, v0
    s_nop 1
    v_cndmask_b32 v3, v60, v3, vcc
    s_lshl_b32 s57, s53, 1
    s_add_u32 s57, s57, s30
    s_mul_i32 s57, s57, 1664
    s_add_u32 s57, s57, s62
    v_add_u32 v3, s57, v3
    v_mov_b32 v60, 0x7f000000
    v_cmp_le_u32 vcc, 48, v0
    s_nop 1
    v_cndmask_b32 v3, v3, v60, vcc
    s_lshl_b32 s58, s54, 2
    s_add_u32 s57, s57, s58
    s_add_u32 s57, s57, 1536
    v_mov_b32 v4, s57
    v_mov_b32 v60, 0x7f000000
    v_cmp_ne_u32 vcc, 48, v0
    s_nop 1
    v_cndmask_b32 v4, v4, v60, vcc
    s_mov_b32 s58, 0
    s_cmp_eq_u32 s55, 0
    s_cbranch_scc1 L_gs_91
    buffer_store_dword v37, v4, s[40:43], s58 offen
L_gb_92:
L_skip_90:
    s_cmp_eq_u32 s30, 2
    s_cbranch_scc0 L_skip_93
    v_lshlrev_b32 v2, 2, v0
    v_add_u32 v2, 157696, v2
    v_and_b32 v3, 15, v0
    v_lshlrev_b32 v3, 2, v3
    v_lshrrev_b32 v60, 5, v0
    v_lshl_add_u32 v3, v60, 6, v3
    v_bfe_u32 v60, v0, 4, 1
    v_lshl_add_u32 v3, v60, 13, v3
L_skip_93:
    s_waitcnt vmcnt(32)
    s_barrier
    ds_read_b64_tr_b16 v[194:195], v8 offset:0
    ds_read_b64_tr_b16 v[202:203], v9 offset:0
    ds_read_b64_tr_b16 v[210:211], v10 offset:0
    ds_read_b64_tr_b16 v[218:219], v11 offset:0
    s_cmp_eq_u32 s30, 6
    s_cbranch_scc0 L_skip_94
    s_mov_b32 s57, 786560
    s_mov_b32 s58, 1178752
    s_mov_b32 m0, 141312
L_dma_95:
    s_nop 0
    buffer_load_dwordx4 v7, s[36:39], s57 offen offset:0 nt lds
    buffer_load_dwordx4 v7, s[36:39], s58 offen offset:1024 nt lds
    s_add_u32 s57, s57, 24576
    s_add_u32 s58, s58, 24576
    s_add_u32 m0, m0, 2048
    s_cmp_lg_u32 m0, 157696
    s_cbranch_scc1 L_dma_95
L_skip_94:
    s_waitcnt lgkmcnt(0)
    s_waitcnt vmcnt(32)
    s_barrier
    ds_read_b64_tr_b16 v[226:227], v8 offset:16384
    ds_read_b64_tr_b16 v[234:235], v9 offset:16384
    ds_read_b64_tr_b16 v[242:243], v10 offset:16384
    ds_read_b64_tr_b16 v[250:251], v11 offset:16384
    s_cmp_eq_u32 s30, 6
    s_cbranch_scc0 L_skip_96
    s_mov_b32 s57, 786688
    s_mov_b32 s58, 1178880
    s_mov_b32 m0, 92160
L_dma_97:
    s_nop 0
    buffer_load_dwordx4 v7, s[36:39], s57 offen offset:0 nt lds
    buffer_load_dwordx4 v7, s[36:39], s58 offen offset:1024 nt lds
    s_add_u32 s57, s57, 24576
    s_add_u32 s58, s58, 24576
    s_add_u32 m0, m0, 2048
    s_cmp_lg_u32 m0, 108544
    s_cbranch_scc1 L_dma_97
L_skip_96:
    s_waitcnt lgkmcnt(0)
    s_cmp_eq_u32 s30, 5
    s_cbranch_scc0 L_skip_98
    global_load_dword v2, v3, s[26:27] offset:4 sc1
L_skip_98:
    s_waitcnt vmcnt(32)
    s_barrier
    ds_read_b64_tr_b16 v[164:165], v8 offset:32768
    ds_read_b64_tr_b16 v[172:173], v9 offset:32768
    ds_read_b64_tr_b16 v[180:181], v10 offset:32768
    ds_read_b64_tr_b16 v[188:189], v11 offset:32768
    s_cmp_eq_u32 s30, 6
    s_cbranch_scc0 L_skip_99
    s_mov_b32 s57, 983040
    s_mov_b32 s58, 1375232
    s_mov_b32 m0, 108544
L_dma_100:
    s_nop 0
    buffer_load_dwordx4 v7, s[36:39], s57 offen offset:0 nt lds
    buffer_load_dwordx4 v7, s[36:39], s58 offen offset:1024 nt lds
    s_add_u32 s57, s57, 24576
    s_add_u32 s58, s58, 24576
    s_add_u32 m0, m0, 2048
    s_cmp_lg_u32 m0, 124928
    s_cbranch_scc1 L_dma_100
L_skip_99:
    s_waitcnt lgkmcnt(0)
    s_waitcnt vmcnt(32)
    s_barrier
    ds_read_b64_tr_b16 v[196:197], v8 offset:49152
    ds_read_b64_tr_b16 v[204:205], v9 offset:49152
    ds_read_b64_tr_b16 v[212:213], v10 offset:49152
    ds_read_b64_tr_b16 v[220:221], v11 offset:49152
    s_cmp_eq_u32 s30, 6
    s_cbranch_scc0 L_skip_101
    s_mov_b32 s57, 983168
    s_mov_b32 s58, 1375360
    s_mov_b32 m0, 124928
L_dma_102:
    s_nop 0
    buffer_load_dwordx4 v7, s[36:39], s57 offen offset:0 nt lds
    buffer_load_dwordx4 v7, s[36:39], s58 offen offset:1024 nt lds
    s_add_u32 s57, s57, 24576
    s_add_u32 s58, s58, 24576
    s_add_u32 m0, m0, 2048
    s_cmp_lg_u32 m0, 141312
    s_cbranch_scc1 L_dma_102
L_skip_101:
    s_waitcnt lgkmcnt(0)
    s_cmp_eq_u32 s30, 5
    s_cbranch_scc0 L_skip_103
L_cw_104:
    s_waitcnt vmcnt(0)
    v_cmp_eq_u32 vcc, 0, v2
    s_cbranch_vccnz L_cr_105
    v_add_u32_dpp v2, v2, v2 row_ror:4 row_mask:0xf bank_mask:0xf
    s_nop 1
    v_add_u32_dpp v2, v2, v2 row_ror:2 row_mask:0xf bank_mask:0xf
    s_nop 1
    v_add_u32_dpp v2, v2, v2 row_ror:1 row_mask:0xf bank_mask:0xf
    v_mov_b32 v60, 160772
    ds_write_b32 v60, v2
    s_waitcnt lgkmcnt(0)
L_skip_103:
    s_cmp_lt_u32 s3, 20
    s_cbranch_scc0 L_skip_106
    s_mul_i32 s74, s30, 1664
    s_add_u32 s74, s74, s62
    s_add_u32 s74, s74, 0
    v_and_b32 v56, 7, v0
    v_lshlrev_b32 v56, 2, v56
    v_lshrrev_b32 v62, 4, v0
    v_lshlrev_b32 v62, 3, v62
    s_cmp_lg_u32 s30, 6
    s_cbranch_scc0 L_skip_106
    buffer_load_dword v52, v56, s[40:43], s74 offen offset:1536 sc1
    buffer_load_dwordx2 v[54:55], v62, s[40:43], s74 offen offset:1536 sc1
L_skip_106:
    s_cmp_eq_u32 s30, 2
    s_cbranch_scc0 L_skip_107
    s_sub_u32 s57, s3, 20
    s_cmp_lt_u32 s57, 4
    s_cbranch_scc0 L_skip_108
    s_sub_u32 s57, s3, 20
    s_lshl_b32 s57, s57, 6
    v_add_u32 v50, s57, v0
    v_min_u32 v50, 207, v50
    v_lshlrev_b32 v50, 7, v50
    s_add_u32 s57, s62, 0
    buffer_load_dword v50, v50, s[40:43], s57 offen sc1 nt
    s_sub_u32 s57, s3, 20
    s_lshl_b32 s57, s57, 6
    v_add_u32 v51, s57, v0
    v_min_u32 v51, 151, v51
    v_lshlrev_b32 v51, 7, v51
    s_add_u32 s57, s62, 26624
    buffer_load_dword v51, v51, s[40:43], s57 offen sc1 nt
    s_sub_u32 s57, s3, 20
    s_lshl_b32 s57, s57, 6
    v_add_u32 v49, s57, v0
    v_min_u32 v49, 191, v49
    v_lshlrev_b32 v49, 7, v49
    s_add_u32 s57, s62, 46080
    buffer_load_dword v49, v49, s[40:43], s57 offen sc1 nt
L_skip_108:
L_skip_107:
    s_waitcnt vmcnt(32)
    s_barrier
    ds_read_b64_tr_b16 v[228:229], v8 offset:0
    ds_read_b64_tr_b16 v[236:237], v9 offset:0
    ds_read_b64_tr_b16 v[244:245], v10 offset:0
    ds_read_b64_tr_b16 v[252:253], v11 offset:0
    s_cmp_eq_u32 s30, 6
    s_cbranch_scc0 L_skip_109
    s_mov_b32 s57, 983296
    s_mov_b32 s58, 1375488
    s_mov_b32 m0, 141312
L_dma_110:
    s_nop 0
    buffer_load_dwordx4 v7, s[36:39], s57 offen offset:0 nt lds
    buffer_load_dwordx4 v7, s[36:39], s58 offen offset:1024 nt lds
    s_add_u32 s57, s57, 24576
    s_add_u32 s58, s58, 24576
    s_add_u32 m0, m0, 2048
    s_cmp_lg_u32 m0, 157696
    s_cbranch_scc1 L_dma_110
L_skip_109:
    s_waitcnt lgkmcnt(0)
    s_cmp_ge_u32 s30, 6
    s_cbranch_scc0 L_skip_111
    v_mov_b32 v60, 160772
    ds_read_b32 v60, v60
    s_lshr_b32 s58, s63, 2
    s_waitcnt lgkmcnt(0)
    v_readfirstlane_b32 s57, v60
    s_cmp_gt_u32 s57, 24
    s_cselect_b32 s57, 1, 0
    s_xor_b32 s57, s57, s58
    s_lshl_b32 s57, s57, 13
    s_add_u32 s7, s8, s57
L_skip_111:
    s_branch L_tail
.p2align 10
L_tail:
L_pad0:
    s_cbranch_execz L_pad4
    s_waitcnt vmcnt(32)
    s_barrier
    ds_read_b64_tr_b16 v[166:167], v8 offset:16384
    ds_read_b64_tr_b16 v[174:175], v9 offset:16384
    ds_read_b64_tr_b16 v[182:183], v10 offset:16384
    ds_read_b64_tr_b16 v[190:191], v11 offset:16384
    s_waitcnt lgkmcnt(0)
    s_cmp_lt_u32 s30, 5
    s_cbranch_scc0 L_skip_112
    s_waitcnt vmcnt(0)
L_skip_112:
    s_cmp_lt_u32 s3, 20
    s_cbranch_scc0 L_skip_113
    v_lshlrev_b32 v57, 4, v0
    v_lshlrev_b32 v58, 3, v0
    s_mul_i32 s57, s30, 6144
    s_add_u32 s57, s57, 30720
    v_lshrrev_b32 v59, 2, v0
    v_lshlrev_b32 v59, 6, v59
    v_bfe_u32 v53, v0, 4, 1
    v_lshl_add_u32 v59, v53, 5, v59
    v_and_b32 v53, 3, v0
    v_lshl_add_u32 v59, v53, 3, v59
    v_add_u32 v59, s57, v59
    v_xor_b32 v60, 32, v59
    s_lshl_b32 s57, s30, 8
    s_add_u32 s57, s57, 157696
    v_lshl_add_u32 v61, v0, 2, s57
    s_cmp_lg_u32 s30, 6
    s_cbranch_scc0 L_skip_113
L_cw_114:
    s_waitcnt vmcnt(0)
    v_max3_u32 v53, v52, v54, v55
    v_cmp_eq_u32 vcc, -1, v53
    s_cbranch_vccnz L_cr_115
    v_max_f32_dpp v53, v52, v52 row_ror:4 row_mask:0xf bank_mask:0xf
    s_nop 1
    v_max_f32_dpp v53, v53, v53 row_ror:2 row_mask:0xf bank_mask:0xf
    s_nop 1
    v_max_f32_dpp v53, v53, v53 row_ror:1 row_mask:0xf bank_mask:0xf
    v_sub_f32 v52, v52, v53
    v_sub_f32 v54, v54, v53
    v_sub_f32 v55, v55, v53
    v_exp_f32 v52, v52
    v_exp_f32 v54, v54
    v_exp_f32 v55, v55
    s_cmp_eq_u32 s30, 7
    s_cbranch_scc0 L_skip_113
    v_add_u32 v62, 158720, v57
    ds_write_b128 v62, v[52:55]
    s_waitcnt lgkmcnt(0)
L_skip_113:
    v_smfmac_f32_16x16x64_bf16 v[40:43], v[12:15], v[160:167], v1
    v_smfmac_f32_16x16x64_bf16 v[40:43], v[16:19], v[168:175], v1
    v_smfmac_f32_16x16x64_bf16 v[40:43], v[20:23], v[176:183], v1
    v_smfmac_f32_16x16x64_bf16 v[40:43], v[24:27], v[184:191], v1
    s_cmp_eq_u32 s30, 6
    s_cbranch_scc0 L_skip_116
    s_mul_i32 s57, s14, 12
    s_add_u32 s58, s57, s15
    s_mov_b32 m0, 55296
L_dma_117:
    s_nop 0
    buffer_load_dwordx4 v3, s[48:51], s57 offen offset:0 nt lds
    buffer_load_dwordx4 v3, s[48:51], s58 offen offset:1024 nt lds
    s_add_u32 s57, s57, s14
    s_add_u32 s58, s58, s14
    s_add_u32 m0, m0, 2048
    s_cmp_lg_u32 m0, 67584
    s_cbranch_scc1 L_dma_117
    s_mul_i32 s57, s14, 18
    s_add_u32 s58, s57, s15
    s_mov_b32 m0, 67584
L_dma_118:
    s_nop 0
    buffer_load_dwordx4 v3, s[48:51], s57 offen offset:0 nt lds
    buffer_load_dwordx4 v3, s[48:51], s58 offen offset:1024 nt lds
    s_add_u32 s57, s57, s14
    s_add_u32 s58, s58, s14
    s_add_u32 m0, m0, 2048
    s_cmp_lg_u32 m0, 79872
    s_cbranch_scc1 L_dma_118
L_skip_116:
    s_waitcnt vmcnt(40)
    s_barrier
    ds_read_b64_tr_b16 v[198:199], v8 offset:32768
    ds_read_b64_tr_b16 v[206:207], v9 offset:32768
    ds_read_b64_tr_b16 v[214:215], v10 offset:32768
    ds_read_b64_tr_b16 v[222:223], v11 offset:32768
    s_waitcnt lgkmcnt(0)
    s_cmp_lt_u32 s3, 20
    s_cbranch_scc0 L_skip_119
    s_cmp_eq_u32 s30, 6
    s_cbranch_scc0 L_skip_119
    v_add_u32 v62, 158720, v57
    ds_read_b128 v[52:55], v62
L_skip_119:
L_pad1:
    s_cbranch_execz L_pad5
    v_smfmac_f32_16x16x64_bf16 v[40:43], v[28:31], v[192:199], v1
    v_smfmac_f32_16x16x64_bf16 v[40:43], v[32:35], v[200:207], v1
    v_smfmac_f32_16x16x64_bf16 v[44:47], v[12:15], v[208:215], v1
    v_smfmac_f32_16x16x64_bf16 v[44:47], v[16:19], v[216:223], v1
    v_mul_f32 v38, v38, v39
    ds_write_b32 v63, v38 offset:1024
    s_waitcnt vmcnt(24)
    s_barrier
    ds_read_b64_tr_b16 v[230:231], v8 offset:49152
    ds_read_b64_tr_b16 v[238:239], v9 offset:49152
    ds_read_b64_tr_b16 v[246:247], v10 offset:49152
    ds_read_b64_tr_b16 v[254:255], v11 offset:49152
    s_waitcnt lgkmcnt(0)
    v_smfmac_f32_16x16x64_bf16 v[44:47], v[20:23], v[224:231], v1
    v_smfmac_f32_16x16x64_bf16 v[44:47], v[24:27], v[232:239], v1
    v_smfmac_f32_16x16x64_bf16 v[44:47], v[28:31], v[240:247], v1
    v_smfmac_f32_16x16x64_bf16 v[44:47], v[32:35], v[248:255], v1
    s_setprio 0
    s_cmp_lt_u32 s30, 2
    v_pk_add_f32 v[40:41], v[40:41], v[42:43]
    s_nop 4
    v_pk_add_f32 v[42:43], v[44:45], v[46:47]
    v_pk_mul_f32 v[40:41], v[40:41], v[38:39] op_sel:[0,1] op_sel_hi:[1,1]
    v_pk_mul_f32 v[42:43], v[42:43], v[38:39] op_sel:[0,1] op_sel_hi:[1,1]
    ds_write_b128 v63, v[40:43]
    s_cbranch_scc1 L_comb_0
    s_waitcnt lgkmcnt(0)
    s_barrier
.p2align 5
L_comb_0b:
    s_cmp_eq_u32 s30, 6
    s_cbranch_scc0 L_skip_124
    s_waitcnt vmcnt(0)
L_skip_124:
    s_barrier
    s_cmp_lt_u32 s3, 20
    s_cbranch_scc0 L_typeB_0
    buffer_load_dwordx4 v[12:15], v57, s[40:43], s74 offen sc1
    buffer_load_dwordx2 v[16:17], v58, s[40:43], s74 offen offset:1024 sc1
    buffer_load_dword v18, v56, s[40:43], s74 offen offset:1568 sc1
    ds_read_b64_tr_b16 v[28:29], v59 offset:0
    ds_read_b64_tr_b16 v[30:31], v59 offset:1024
    ds_read_b64_tr_b16 v[32:33], v59 offset:2048
    ds_read_b64_tr_b16 v[34:35], v59 offset:3072
    ds_read_b64_tr_b16 v[36:37], v59 offset:4096
    ds_read_b64_tr_b16 v[38:39], v59 offset:5120
    ds_read_b64_tr_b16 v[40:41], v60 offset:0
    ds_read_b64_tr_b16 v[42:43], v60 offset:1024
    ds_read_b64_tr_b16 v[44:45], v60 offset:2048
    ds_read_b64_tr_b16 v[46:47], v60 offset:3072
    ds_read_b64_tr_b16 v[48:49], v60 offset:4096
    ds_read_b64_tr_b16 v[50:51], v60 offset:5120
    v_mov_b64 v[20:21], 0
    v_mov_b64 v[22:23], 0
    v_mov_b64 v[24:25], 0
    v_mov_b64 v[26:27], 0
    s_add_u32 s58, s6, 0
    s_waitcnt lgkmcnt(0)
    s_branch L_ow_125
.p2align 5
L_or_126:
    buffer_load_dwordx4 v[12:15], v57, s[40:43], s74 offen sc1
    buffer_load_dwordx2 v[16:17], v58, s[40:43], s74 offen offset:1024 sc1
    buffer_load_dword v18, v56, s[40:43], s74 offen offset:1568 sc1
    s_sub_u32 s56, s56, 1
    s_cbranch_scc1 L_done
    v_mov_b64 v[20:21], 0
    v_mov_b64 v[22:23], 0
    v_mov_b64 v[24:25], 0
    v_mov_b64 v[26:27], 0
L_ow_125:
    s_waitcnt vmcnt(2)
    v_smfmac_f32_16x16x64_bf16 v[20:23], v[12:15], v[28:35], v1
    s_nop 2
    v_smfmac_f32_16x16x64_bf16 v[24:27], v[12:15], v[40:47], v1
    s_waitcnt vmcnt(0)
    v_mul_f32 v53, v52, v18
    v_smfmac_f32_16x16x32_bf16 v[20:23], v[16:17], v[36:39], v1
    s_nop 2
    v_smfmac_f32_16x16x32_bf16 v[24:27], v[16:17], v[48:51], v1
    v_add_f32_dpp v53, v53, v53 row_ror:4 row_mask:0xf bank_mask:0xf
    v_max3_u32 v19, v12, v13, v14
    v_max3_u32 v62, v15, v16, v17
    v_add_f32_dpp v53, v53, v53 row_ror:2 row_mask:0xf bank_mask:0xf
L_pad2:
    s_cbranch_execz L_pad6
    v_max3_u32 v19, v19, v62, v18
    s_cmp_eq_u32 s30, 2
    v_add_f32_dpp v53, v53, v53 row_ror:1 row_mask:0xf bank_mask:0xf
    v_cmp_eq_u32 vcc, -1, v19
    v_rcp_f32 v53, v53
    s_cbranch_vccnz L_or_126
    v_pk_add_f32 v[20:21], v[20:21], v[22:23]
    v_pk_add_f32 v[24:25], v[24:25], v[26:27]
    v_pk_mul_f32 v[54:55], v[54:55], v[52:53] op_sel:[0,1] op_sel_hi:[1,1]
    v_mul_f32 v20, v20, v54
    v_mul_f32 v24, v24, v54
    v_fmac_f32 v20, v21, v55
    v_fmac_f32 v24, v25, v55
    s_nop 1
    v_permlane32_swap_b32 v20, v24
    v_add_f32 v20, v20, v24
    ds_write_b32 v61, v20
    s_waitcnt lgkmcnt(0)
    s_barrier
    s_cbranch_scc0 L_finb_127
    ds_read2st64_b32 v[12:13], v2 offset0:0 offset1:1
    ds_read2st64_b32 v[14:15], v2 offset0:2 offset1:3
    ds_read2st64_b32 v[16:17], v2 offset0:4 offset1:5
    ds_read2st64_b32 v[18:19], v2 offset0:6 offset1:7
    s_waitcnt lgkmcnt(2)
    v_pk_add_f32 v[12:13], v[12:13], v[14:15]
    s_waitcnt lgkmcnt(0)
    v_pk_add_f32 v[16:17], v[16:17], v[18:19]
    v_pk_add_f32 v[12:13], v[12:13], v[16:17]
    v_add_f32 v14, v12, v13
    v_add_f32 v15, v12, v13
    s_nop 1
    v_permlane16_swap_b32 v14, v15
    v_add_f32 v12, v14, v15
    buffer_store_dword v12, v3, s[40:43], s58 offen sc1
.p2align 5
L_finb_127:
    s_sub_u32 s57, s30, 4
    s_cmp_lt_u32 s57, 3
    s_cbranch_scc0 L_skip_128
    s_sub_u32 s60, s30, 4
    s_lshl_b32 s57, s60, 11
    v_lshlrev_b32 v11, 4, v0
    v_add_u32 v11, s57, v11
    s_add_u32 s65, s62, 19456
    buffer_load_dwordx4 v[52:55], v11, s[40:43], s65 offen offset:0 sc1
    buffer_load_dwordx4 v[56:59], v11, s[40:43], s65 offen offset:1024 sc1
    s_lshl_b32 s59, s60, 12
    s_add_u32 s59, s59, 79872
    s_mov_b32 s44, s20
    s_mov_b32 s45, s21
    s_mov_b32 s46, 1966080
    s_mov_b32 s47, 0x20000
    s_mul_i32 s57, s31, 3
    s_add_u32 s57, s57, s60
    s_mul_i32 s57, s57, 81920
    s_lshl_b32 s64, s3, 6
    s_add_u32 s57, s57, s64
    v_lshrrev_b32 v5, 2, v0
    v_mul_u32_u24 v5, 1280, v5
    v_and_b32 v60, 3, v0
    v_lshl_add_u32 v5, v60, 4, v5
    v_add_u32 v5, s57, v5
    s_add_u32 m0, s59, 0
    s_mov_b32 s57, 0
    buffer_load_dwordx4 v5, s[44:47], s57 offen nt lds
    s_add_u32 m0, s59, 1024
    s_mov_b32 s57, 20480
    buffer_load_dwordx4 v5, s[44:47], s57 offen nt lds
    s_add_u32 m0, s59, 2048
    s_mov_b32 s57, 40960
    buffer_load_dwordx4 v5, s[44:47], s57 offen nt lds
    s_add_u32 m0, s59, 3072
    s_mov_b32 s57, 61440
    buffer_load_dwordx4 v5, s[44:47], s57 offen nt lds
    v_bfe_u32 v35, v0, 4, 1
    v_lshlrev_b32 v35, 11, v35
    v_bfe_u32 v60, v0, 2, 2
    v_lshl_add_u32 v35, v60, 8, v35
    v_lshrrev_b32 v60, 5, v0
    v_lshl_add_u32 v35, v60, 6, v35
    v_and_b32 v60, 3, v0
    v_lshl_add_u32 v35, v60, 3, v35
    v_add_u32 v35, s59, v35
    v_mov_b32 v9, 0xbdd2d3e8
L_pad3:
    s_cbranch_execz L_pad7
    v_mov_b32 v10, 0xc0135761
    s_lshl_b32 s57, s60, 7
    s_add_u32 s57, s57, 159872
    v_lshlrev_b32 v32, 3, v0
    v_add_u32 v32, s57, v32
    v_lshlrev_b32 v33, 3, v0
    v_add_u32 v33, 129024, v33
    v_cmp_gt_u32 vcc, 16, v0
    s_nop 1
    v_cndmask_b32 v32, v33, v32, vcc
    v_and_b32 v33, 15, v0
    v_lshlrev_b32 v33, 3, v33
    v_lshrrev_b32 v60, 5, v0
    v_lshl_add_u32 v33, v60, 2, v33
    v_add_u32 v33, 159872, v33
    v_and_b32 v34, 15, v0
    v_lshlrev_b32 v34, 2, v34
    v_lshrrev_b32 v60, 5, v0
    v_lshl_add_u32 v34, v60, 6, v34
    v_bfe_u32 v60, v0, 4, 1
    v_lshl_add_u32 v34, v60, 13, v34
    s_add_u32 s60, s6, 66048
    s_add_u32 s58, s62, 13312
    s_add_u32 s57, s62, 25856
    v_and_b32 v7, 7, v0
    v_lshlrev_b32 v7, 3, v7
    v_mov_b32 v60, 0x3acccccd
    v_mov_b32 v61, 0x3727c5ac
    s_waitcnt vmcnt(0)
    buffer_load_dwordx2 v[24:25], v7, s[40:43], s57 offen sc1
    buffer_load_dwordx4 v[12:15], v11, s[40:43], s58 offen offset:0 sc1
    buffer_load_dwordx4 v[16:19], v11, s[40:43], s58 offen offset:1024 sc1
    ds_read_b64_tr_b16 v[36:37], v35 offset:0
    ds_read_b64_tr_b16 v[38:39], v35 offset:1024
    ds_read_b64_tr_b16 v[40:41], v35 offset:128
    ds_read_b64_tr_b16 v[42:43], v35 offset:1152
    ds_read_b64_tr_b16 v[44:45], v35 offset:32
    ds_read_b64_tr_b16 v[46:47], v35 offset:1056
    ds_read_b64_tr_b16 v[48:49], v35 offset:160
    ds_read_b64_tr_b16 v[50:51], v35 offset:1184
L_sw_131:
    v_max3_u32 v20, v52, v53, v54
    v_max3_u32 v20, v20, v55, v56
    v_max3_u32 v20, v20, v57, v58
    v_max_u32 v20, v20, v59
    v_cmp_eq_u32 vcc, -1, v20
    s_cbranch_vccnz L_sr_132
    v_pk_add_f32 v[28:29], v[52:53], v[56:57]
    v_pk_add_f32 v[30:31], v[54:55], v[58:59]
    s_nop 1
    v_permlane32_swap_b32 v28, v30
    v_permlane32_swap_b32 v29, v31
    v_pk_add_f32 v[28:29], v[28:29], v[30:31]
    s_nop 1
    v_permlane16_swap_b32 v28, v29
    v_add_f32 v28, v28, v29
    v_mov_b64 v[52:53], 0
    v_mov_b64 v[54:55], 0
    v_mov_b64 v[56:57], 0
    v_mov_b64 v[58:59], 0
    s_waitcnt lgkmcnt(0)
    s_branch L_pw_129
.p2align 5
L_pr_130:
    buffer_load_dwordx2 v[24:25], v7, s[40:43], s57 offen sc1
    buffer_load_dwordx4 v[12:15], v11, s[40:43], s58 offen offset:0 sc1
    buffer_load_dwordx4 v[16:19], v11, s[40:43], s58 offen offset:1024 sc1
    s_sub_u32 s56, s56, 1
    s_cbranch_scc1 L_done
L_pw_129:
    s_waitcnt vmcnt(0)
    v_max_u32 v20, v24, v25
    v_cmp_eq_u32 vcc, -1, v20
    s_cbranch_vccnz L_pr_130
    buffer_load_dwordx4 v[12:15], v11, s[40:43], s58 offen offset:0 sc1
    buffer_load_dwordx4 v[16:19], v11, s[40:43], s58 offen offset:1024 sc1
    v_add_f32_dpp v2, v24, v24 row_ror:4 row_mask:0xf bank_mask:0xf
    v_add_f32_dpp v3, v25, v25 row_ror:4 row_mask:0xf bank_mask:0xf
    v_pk_add_f32 v[20:21], v[12:13], v[16:17]
    v_pk_add_f32 v[22:23], v[14:15], v[18:19]
    v_add_f32_dpp v2, v2, v2 row_ror:2 row_mask:0xf bank_mask:0xf
    v_add_f32_dpp v3, v3, v3 row_ror:2 row_mask:0xf bank_mask:0xf
    v_permlane32_swap_b32 v20, v22
    v_permlane32_swap_b32 v21, v23
    v_add_f32_dpp v2, v2, v2 row_ror:1 row_mask:0xf bank_mask:0xf
L_pad4:
    s_cbranch_execz L_pad8
    v_add_f32_dpp v3, v3, v3 row_ror:1 row_mask:0xf bank_mask:0xf
    v_pk_add_f32 v[20:21], v[20:21], v[22:23]
    v_mul_f32 v2, v2, v60
    v_fma_f32 v3, v3, v60, v61
    v_permlane16_swap_b32 v20, v21
    v_fma_f32 v3, -v2, v2, v3
    v_add_f32 v20, v20, v21
    v_max_f32 v3, v3, v61
    v_mul_f32 v26, v28, v2
    v_rsq_f32 v3, v3
    v_cmp_u_f32 vcc, v20, v20
    v_sub_f32 v20, v20, v26
    s_cbranch_vccnz L_hr_133
L_hk_134:
    v_fma_f32 v20, v20, v3, v4
    v_mul_f32 v21, v20, v20
    v_mul_f32 v22, v20, v9
    v_mul_f32 v23, v20, v10
    v_fma_f32 v21, v21, v22, v23
    v_exp_f32 v21, v21
    s_nop 0
    v_add_f32 v21, 1.0, v21
    v_rcp_f32 v21, v21
    s_nop 0
    v_mul_f32 v20, v20, v21
    s_nop 1
    v_mov_b32_dpp v21, v20 row_shl:1 row_mask:0xf bank_mask:0xf bound_ctrl:0
    v_cvt_pk_bf16_f32 v28, v20, v21
    s_nop 1
    v_mov_b32_dpp v29, v28 row_shl:4 row_mask:0xf bank_mask:0xf bound_ctrl:0
    v_mov_b32_dpp v30, v28 row_shl:8 row_mask:0xf bank_mask:0xf bound_ctrl:0
    v_mov_b32_dpp v31, v28 row_shl:12 row_mask:0xf bank_mask:0xf bound_ctrl:0
    s_nop 1
    v_smfmac_f32_16x16x64_bf16 v[52:55], v[28:31], v[36:43], v1
    v_smfmac_f32_16x16x64_bf16 v[56:59], v[28:31], v[44:51], v1
    s_cmp_eq_u32 s30, 4
    s_nop 5
    v_add_f32 v22, v52, v54
    v_add_f32 v23, v56, v58
    ds_write_b64 v32, v[22:23]
    s_cbranch_scc0 L_skip_136
L_xw_137:
    ds_read2_b32 v[20:21], v33 offset0:0 offset1:32
    ds_read_b32 v22, v33 offset:256
    s_sub_u32 s56, s56, 1
    s_cbranch_scc1 L_done
    s_waitcnt lgkmcnt(0)
    v_max3_u32 v23, v20, v21, v22
    v_add_f32 v20, v20, v21
    v_cmp_eq_u32 vcc, -1, v23
    v_add_f32 v20, v20, v22
    s_cbranch_vccnz L_xw_137
    buffer_store_dword v20, v34, s[40:43], s60 offen sc1
    s_waitcnt vmcnt(1)
    s_branch L_pe_138
L_skip_136:
    s_waitcnt vmcnt(0)
L_pe_138:
L_skip_128:
    s_branch L_p1
.p2align 5
L_typeB_0:
    s_cmp_eq_u32 s53, 3
    s_cbranch_scc0 L_typeC_139
    s_cmp_eq_u32 s30, 7
    s_cbranch_scc1 L_w7_150
    s_cmp_lt_u32 s30, 6
    s_cbranch_scc0 L_skip_152
    s_lshr_b32 s57, s30, 1
    s_mul_i32 s57, s57, 128
    s_and_b32 s58, s30, 1
    s_lshl_b32 s58, s58, 6
    s_add_u32 s57, s57, s58
    v_lshrrev_b32 v18, 5, v0
    v_lshlrev_b32 v18, 13, v18
    v_bfe_u32 v60, v0, 3, 1
    v_lshl_add_u32 v18, v60, 12, v18
    v_bfe_u32 v60, v0, 4, 1
    v_lshl_add_u32 v18, v60, 11, v18
    v_bfe_u32 v60, v0, 2, 1
    v_mul_u32_u24 v60, 384, v60
    v_add_u32 v18, v60, v18
    v_and_b32 v60, 3, v0
    v_lshl_add_u32 v18, v60, 3, v18
    v_add_u32 v18, s57, v18
    v_add_u32 v18, 30720, v18
    v_bfe_u32 v19, v0, 3, 1
    v_lshlrev_b32 v19, 12, v19
    v_bfe_u32 v60, v0, 4, 1
    v_lshl_add_u32 v19, v60, 11, v19
    v_bfe_u32 v60, v0, 2, 1
    v_mul_u32_u24 v60, 384, v60
    v_add_u32 v19, v60, v19
    v_and_b32 v60, 3, v0
    v_lshl_add_u32 v19, v60, 3, v19
L_pad5:
    s_cbranch_execz L_pad9
    v_lshrrev_b32 v60, 5, v0
    v_lshl_add_u32 v19, v60, 5, v19
    v_add_u32 v19, s57, v19
    v_add_u32 v19, 63488, v19
    ds_read_b64_tr_b16 v[28:29], v18 offset:0
    ds_read_b64_tr_b16 v[30:31], v18 offset:1024
    ds_read_b64_tr_b16 v[32:33], v18 offset:16384
    ds_read_b64_tr_b16 v[34:35], v18 offset:17408
    ds_read_b64_tr_b16 v[36:37], v18 offset:32
    ds_read_b64_tr_b16 v[38:39], v18 offset:1056
    ds_read_b64_tr_b16 v[40:41], v18 offset:16416
    ds_read_b64_tr_b16 v[42:43], v18 offset:17440
    ds_read_b64_tr_b16 v[24:25], v19 offset:0
    ds_read_b64_tr_b16 v[26:27], v19 offset:1024
    v_lshrrev_b32 v49, 4, v0
    v_lshlrev_b32 v49, 5, v49
    v_bfe_u32 v60, v0, 1, 1
    v_lshl_add_u32 v49, v60, 4, v49
    v_bfe_u32 v60, v0, 3, 1
    v_mul_u32_u24 v60, 192, v60
    v_add_u32 v49, v60, v49
    v_add_u32 v49, 160832, v49
    v_bfe_u32 v50, v0, 1, 1
    v_lshlrev_b32 v50, 4, v50
    v_bfe_u32 v60, v0, 3, 1
    v_mul_u32_u24 v60, 192, v60
    v_add_u32 v50, v60, v50
    v_add_u32 v50, 160960, v50
    v_mov_b32 v60, 160992
    v_and_b32 v51, 5, v0
    v_cmp_eq_u32 vcc, 0, v51
    s_nop 1
    v_cndmask_b32 v9, v60, v49, vcc
    v_cmp_eq_u32 vcc, 4, v51
    s_nop 1
    v_cndmask_b32 v10, v60, v49, vcc
    v_lshrrev_b32 v49, 2, v0
    v_and_b32 v49, 12, v49
    v_cmp_eq_u32 vcc, v49, v51
    s_nop 1
    v_cndmask_b32 v48, v60, v50, vcc
    v_mov_b64 v[44:45], 0
    v_mov_b64 v[46:47], 0
    s_lshr_b32 s57, s30, 1
    s_lshl_b32 s57, s57, 11
    s_lshl_b32 s58, s58, 1
    s_add_u32 s57, s57, s58
    s_lshl_b32 s58, s54, 8
    s_add_u32 s57, s57, s58
    v_and_b32 v11, 31, v0
    v_lshlrev_b32 v11, 2, v11
    v_lshrrev_b32 v60, 5, v0
    v_lshl_add_u32 v11, v60, 30, v11
    v_add_u32 v11, s57, v11
    v_xor_b32 v49, 0x40000000, v11
    s_add_u32 s59, s62, 13312
    s_add_u32 s60, s62, 25856
    ds_read_b128 v[12:15], v9
    ds_read_b128 v[16:19], v10
    ds_read_b128 v[20:23], v48
    s_waitcnt lgkmcnt(2)
    v_smfmac_f32_16x16x64_bf16 v[44:47], v[12:15], v[28:35], v1
    s_waitcnt lgkmcnt(1)
    v_smfmac_f32_16x16x64_bf16 v[44:47], v[16:19], v[36:43], v1
    s_waitcnt lgkmcnt(0)
    v_smfmac_f32_16x16x64_bf16 v[44:47], v[20:23], v[24:31], v1
    s_add_u32 s60, s62, 19456
    s_cmp_eq_u32 s55, 0
    s_nop 5
    v_add_f32 v12, v44, v46
    s_cbranch_scc1 L_gs_153
    buffer_store_dword v12, v49, s[40:43], s60 offen
L_gb_154:
    v_mov_b64 v[44:45], 0
    v_mov_b64 v[46:47], 0
L_skip_152:
    s_cmp_lt_u32 s30, 6
    s_barrier
    s_cbranch_scc0 L_se_151
    ds_read_b128 v[12:15], v9
    ds_read_b128 v[16:19], v10
    ds_read_b128 v[20:23], v48
    s_waitcnt lgkmcnt(2)
    v_smfmac_f32_16x16x64_bf16 v[44:47], v[12:15], v[28:35], v1
    s_waitcnt lgkmcnt(1)
    v_smfmac_f32_16x16x64_bf16 v[44:47], v[16:19], v[36:43], v1
    s_waitcnt lgkmcnt(0)
    v_smfmac_f32_16x16x64_bf16 v[44:47], v[20:23], v[24:31], v1
    s_cmp_eq_u32 s55, 0
    s_nop 6
L_pad6:
    s_cbranch_execz L_pad10
    v_add_f32 v12, v44, v46
    s_cbranch_scc1 L_gs_155
    buffer_store_dword v12, v11, s[40:43], s59 offen
L_gb_156:
.p2align 5
L_se_151:
L_p1:
    s_lshl_b32 s57, s30, 7
    s_add_u32 s57, s57, 158720
    v_lshrrev_b32 v58, 4, v0
    v_lshlrev_b32 v58, 5, v58
    v_bfe_u32 v60, v0, 1, 1
    v_lshl_add_u32 v58, v60, 4, v58
    v_bfe_u32 v60, v0, 2, 2
    v_lshl_add_u32 v58, v60, 2, v58
    v_and_b32 v60, 1, v0
    v_lshl_add_u32 v58, v60, 1, v58
    v_add_u32 v58, s57, v58
    v_lshrrev_b32 v61, 4, v0
    v_lshlrev_b32 v61, 5, v61
    v_bfe_u32 v60, v0, 1, 1
    v_lshl_add_u32 v61, v60, 4, v61
    v_add_u32 v61, s57, v61
    v_bfe_u32 v62, v0, 2, 2
    v_lshlrev_b32 v62, 1, v62
    v_and_b32 v60, 1, v0
    v_lshl_add_u32 v62, v60, 0, v62
    v_mov_b32 v60, 160992
    v_cmp_eq_u32 vcc, 0, v62
    s_nop 1
    v_cndmask_b32 v52, v60, v61, vcc
    v_cmp_eq_u32 vcc, 1, v62
    s_nop 1
    v_cndmask_b32 v53, v60, v61, vcc
    v_cmp_eq_u32 vcc, 2, v62
    s_nop 1
    v_cndmask_b32 v54, v60, v61, vcc
    v_cmp_eq_u32 vcc, 3, v62
    s_nop 1
    v_cndmask_b32 v55, v60, v61, vcc
    v_cmp_eq_u32 vcc, 4, v62
    s_nop 1
    v_cndmask_b32 v56, v60, v61, vcc
    v_cmp_eq_u32 vcc, 5, v62
    s_nop 1
    v_cndmask_b32 v57, v60, v61, vcc
    s_lshl_b32 s58, s30, 2
    s_add_u32 s58, s58, 159808
    v_mov_b32 v60, s58
    v_lshlrev_b32 v59, 2, v0
    v_add_u32 v59, 158208, v59
    v_cmp_eq_u32 vcc, 63, v0
    s_nop 1
    v_cndmask_b32 v59, v59, v60, vcc
    v_and_b32 v62, 7, v0
    v_lshlrev_b32 v62, 2, v62
    v_add_u32 v62, 159808, v62
    s_lshl_b32 s57, s30, 11
    v_lshlrev_b32 v63, 4, v0
    v_add_u32 v63, s57, v63
    v_add_u32 v63, 92160, v63
    s_sub_u32 s57, s30, 1
    s_lshl_b32 s58, s57, 11
    v_lshlrev_b32 v7, 4, v0
    v_add_u32 v7, s58, v7
    s_lshl_b32 s58, s57, 7
    v_bfe_u32 v8, v0, 2, 2
    v_lshlrev_b32 v8, 5, v8
    v_lshrrev_b32 v60, 5, v0
    v_lshl_add_u32 v8, v60, 4, v8
    v_and_b32 v60, 3, v0
    v_lshl_add_u32 v8, v60, 2, v8
    v_bfe_u32 v60, v0, 4, 1
    v_lshl_add_u32 v8, v60, 1, v8
    v_add_u32 v8, s58, v8
    v_add_u32 v8, 124928, v8
    s_cmp_eq_u32 s30, 7
    s_cbranch_scc1 L_w7_164
    s_cmp_lt_u32 s30, 6
    s_cbranch_scc0 L_skip_166
    s_lshr_b32 s57, s30, 1
    s_mul_i32 s57, s57, 1024
    s_and_b32 s58, s30, 1
    s_lshl_b32 s58, s58, 6
    s_add_u32 s57, s57, s58
    v_lshrrev_b32 v18, 5, v0
    v_mul_u32_u24 v18, 6144, v18
    v_bfe_u32 v60, v0, 3, 1
    v_mul_u32_u24 v60, 3072, v60
    v_add_u32 v18, v60, v18
    v_bfe_u32 v60, v0, 4, 1
    v_lshl_add_u32 v18, v60, 9, v18
    v_bfe_u32 v60, v0, 2, 1
    v_lshl_add_u32 v18, v60, 7, v18
    v_and_b32 v60, 3, v0
    v_lshl_add_u32 v18, v60, 3, v18
    v_add_u32 v18, s57, v18
L_pad7:
    s_cbranch_execz L_pad11
    v_bfe_u32 v19, v0, 3, 1
    v_mul_u32_u24 v19, 3072, v19
    v_bfe_u32 v60, v0, 4, 1
    v_lshl_add_u32 v19, v60, 9, v19
    v_bfe_u32 v60, v0, 2, 1
    v_lshl_add_u32 v19, v60, 7, v19
    v_and_b32 v60, 3, v0
    v_lshl_add_u32 v19, v60, 3, v19
    v_lshrrev_b32 v60, 5, v0
    v_lshl_add_u32 v19, v60, 5, v19
    v_add_u32 v19, s57, v19
    v_add_u32 v19, 24576, v19
    ds_read_b64_tr_b16 v[28:29], v18 offset:0
    ds_read_b64_tr_b16 v[30:31], v18 offset:256
    ds_read_b64_tr_b16 v[32:33], v18 offset:12288
    ds_read_b64_tr_b16 v[34:35], v18 offset:12544
    ds_read_b64_tr_b16 v[36:37], v18 offset:32
    ds_read_b64_tr_b16 v[38:39], v18 offset:288
    ds_read_b64_tr_b16 v[40:41], v18 offset:12320
    ds_read_b64_tr_b16 v[42:43], v18 offset:12576
    ds_read_b64_tr_b16 v[24:25], v19 offset:0
    ds_read_b64_tr_b16 v[26:27], v19 offset:256
    v_lshrrev_b32 v49, 4, v0
    v_lshlrev_b32 v49, 5, v49
    v_bfe_u32 v60, v0, 1, 1
    v_lshl_add_u32 v49, v60, 4, v49
    v_bfe_u32 v60, v0, 3, 1
    v_mul_u32_u24 v60, 192, v60
    v_add_u32 v49, v60, v49
    v_add_u32 v49, 160832, v49
    v_bfe_u32 v50, v0, 1, 1
    v_lshlrev_b32 v50, 4, v50
    v_bfe_u32 v60, v0, 3, 1
    v_mul_u32_u24 v60, 192, v60
    v_add_u32 v50, v60, v50
    v_add_u32 v50, 160960, v50
    v_mov_b32 v60, 160992
    v_and_b32 v51, 5, v0
    v_cmp_eq_u32 vcc, 0, v51
    s_nop 1
    v_cndmask_b32 v9, v60, v49, vcc
    v_cmp_eq_u32 vcc, 4, v51
    s_nop 1
    v_cndmask_b32 v10, v60, v49, vcc
    v_lshrrev_b32 v49, 2, v0
    v_and_b32 v49, 12, v49
    v_cmp_eq_u32 vcc, v49, v51
    s_nop 1
    v_cndmask_b32 v48, v60, v50, vcc
    v_mov_b64 v[44:45], 0
    v_mov_b64 v[46:47], 0
    s_lshr_b32 s57, s30, 1
    s_lshl_b32 s57, s57, 11
    s_lshl_b32 s58, s58, 1
    s_add_u32 s57, s57, s58
    s_lshl_b32 s58, s54, 8
    s_add_u32 s57, s57, s58
    v_and_b32 v11, 31, v0
    v_lshlrev_b32 v11, 2, v11
    v_lshrrev_b32 v60, 5, v0
    v_lshl_add_u32 v11, v60, 30, v11
    v_add_u32 v11, s57, v11
    s_mul_i32 s59, s53, 6144
    s_add_u32 s59, s59, s62
    s_add_u32 s59, s59, 46080
    s_lshl_b32 s60, s53, 6
    s_add_u32 s60, s60, s62
    s_add_u32 s60, s60, 25600
L_skip_166:
    s_cmp_lt_u32 s30, 6
    s_barrier
    s_cbranch_scc0 L_se_165
    ds_read_b128 v[12:15], v9
    ds_read_b128 v[16:19], v10
    ds_read_b128 v[20:23], v48
    s_waitcnt lgkmcnt(2)
    v_smfmac_f32_16x16x64_bf16 v[44:47], v[12:15], v[28:35], v1
    s_waitcnt lgkmcnt(1)
    v_smfmac_f32_16x16x64_bf16 v[44:47], v[16:19], v[36:43], v1
    s_waitcnt lgkmcnt(0)
    v_smfmac_f32_16x16x64_bf16 v[44:47], v[20:23], v[24:31], v1
    s_cmp_eq_u32 s55, 0
    s_nop 6
    v_add_f32 v12, v44, v46
    s_cbranch_scc1 L_gs_167
    buffer_store_dword v12, v11, s[40:43], s59 offen
L_gb_168:
.p2align 5
L_se_165:
L_pad8:
    s_cbranch_execz L_pad12
    s_sub_u32 s57, s30, 1
    s_cmp_lt_u32 s57, 3
    s_cbranch_scc0 L_qo_182
    v_and_b32 v9, 7, v0
    v_lshlrev_b32 v9, 3, v9
    buffer_load_dwordx2 v[10:11], v9, s[40:43], s60 offen sc1
    buffer_load_dwordx4 v[40:43], v7, s[40:43], s59 offen offset:0 sc1
    buffer_load_dwordx4 v[44:47], v7, s[40:43], s59 offen offset:1024 sc1
    v_mov_b64 v[24:25], 0
    v_mov_b64 v[26:27], 0
    v_mov_b64 v[28:29], 0
    v_mov_b64 v[30:31], 0
    v_mov_b64 v[32:33], 0
    v_mov_b64 v[34:35], 0
    v_mov_b64 v[36:37], 0
    v_mov_b64 v[38:39], 0
    v_lshrrev_b32 v5, 4, v0
    v_lshlrev_b32 v5, 5, v5
    v_bfe_u32 v60, v0, 1, 1
    v_lshl_add_u32 v5, v60, 4, v5
    v_add_u32 v5, 124928, v5
    v_mov_b32 v60, 0x3c75e03e
    v_mov_b32 v61, 0x3a71d1e6
    v_mov_b32 v51, 0x3e13985d
    s_branch L_pw_184
.p2align 5
L_pr_185:
    buffer_load_dwordx2 v[10:11], v9, s[40:43], s60 offen sc1
    buffer_load_dwordx4 v[40:43], v7, s[40:43], s59 offen offset:0 sc1
    buffer_load_dwordx4 v[44:47], v7, s[40:43], s59 offen offset:1024 sc1
    s_sub_u32 s56, s56, 1
    s_cbranch_scc1 L_done
L_pw_184:
    s_waitcnt vmcnt(0)
    v_max_u32 v20, v10, v11
    v_cmp_eq_u32 vcc, -1, v20
    s_cbranch_vccnz L_pr_185
    buffer_load_dwordx4 v[40:43], v7, s[40:43], s59 offen offset:0 sc1
    buffer_load_dwordx4 v[44:47], v7, s[40:43], s59 offen offset:1024 sc1
    v_add_f32_dpp v48, v10, v10 row_ror:4 row_mask:0xf bank_mask:0xf
    v_add_f32_dpp v49, v11, v11 row_ror:4 row_mask:0xf bank_mask:0xf
    v_pk_add_f32 v[20:21], v[40:41], v[44:45]
    v_pk_add_f32 v[22:23], v[42:43], v[46:47]
    v_add_f32_dpp v48, v48, v48 row_ror:2 row_mask:0xf bank_mask:0xf
    v_add_f32_dpp v49, v49, v49 row_ror:2 row_mask:0xf bank_mask:0xf
    v_permlane32_swap_b32 v20, v22
    v_permlane32_swap_b32 v21, v23
    v_add_f32_dpp v48, v48, v48 row_ror:1 row_mask:0xf bank_mask:0xf
    v_add_f32_dpp v49, v49, v49 row_ror:1 row_mask:0xf bank_mask:0xf
    v_pk_add_f32 v[20:21], v[20:21], v[22:23]
    v_mul_f32 v48, v48, v60
    v_fma_f32 v49, v49, v51, v61
    v_permlane16_swap_b32 v20, v21
    v_fma_f32 v49, -v48, v48, v49
    v_add_f32 v20, v20, v21
    v_max_f32 v49, v49, v61
    v_mul_f32 v50, v6, v48
    v_rsq_f32 v49, v49
    v_cmp_u_f32 vcc, v20, v20
    v_sub_f32 v20, v20, v50
    s_cbranch_vccnz L_hr_186
L_hk_187:
    v_mul_f32 v20, v20, v49
    v_cvt_pk_bf16_f32 v20, v20, v20
    ds_write_b16 v8, v20
L_qb_183:
    s_waitcnt lgkmcnt(0)
    s_barrier
    ds_read_b128 v[12:15], v5 offset:0
    ds_read_b128 v[16:19], v5 offset:128
    ds_read_b128 v[20:23], v5 offset:256
    s_cmp_lt_u32 s30, 4
    s_waitcnt lgkmcnt(0)
    v_smfmac_f32_16x16x64_bf16 v[24:27], v[12:15], v[64:71], v1
    v_smfmac_f32_16x16x64_bf16 v[24:27], v[16:19], v[72:79], v1
    v_smfmac_f32_16x16x64_bf16 v[24:27], v[20:23], v[80:87], v1
    v_smfmac_f32_16x16x64_bf16 v[28:31], v[12:15], v[88:95], v1
    v_smfmac_f32_16x16x64_bf16 v[28:31], v[16:19], v[96:103], v1
    v_smfmac_f32_16x16x64_bf16 v[28:31], v[20:23], v[104:111], v1
    v_smfmac_f32_16x16x64_bf16 v[32:35], v[12:15], v[112:119], v1
    v_smfmac_f32_16x16x64_bf16 v[32:35], v[16:19], v[120:127], v1
    v_smfmac_f32_16x16x64_bf16 v[32:35], v[20:23], v[128:135], v1
    v_smfmac_f32_16x16x64_bf16 v[36:39], v[12:15], v[136:143], v1
    v_smfmac_f32_16x16x64_bf16 v[36:39], v[16:19], v[144:151], v1
    v_smfmac_f32_16x16x64_bf16 v[36:39], v[20:23], v[152:159], v1
L_pad9:
    s_cbranch_execz L_pad13
    v_add_f32 v24, v24, v26
    s_waitcnt vmcnt(0)
    v_add_f32 v28, v28, v30
    s_nop 1
    v_add_f32 v32, v32, v34
    v_max3_f32 v61, v24, v28, v32
    v_mov_b32_dpp v24, v28 quad_perm:[0,1,2,3] row_mask:0x2 bank_mask:0xf
    v_add_f32 v36, v36, v38
    v_max_f32 v61, v61, v36
    v_mov_b32_dpp v24, v32 quad_perm:[0,1,2,3] row_mask:0x4 bank_mask:0xf
    s_nop 0
    v_max_f32_dpp v61, v61, v61 row_ror:8 row_mask:0xf bank_mask:0xf
    s_nop 0
    v_mov_b32_dpp v24, v36 quad_perm:[0,1,2,3] row_mask:0x8 bank_mask:0xf
    v_max_f32_dpp v61, v61, v61 row_ror:4 row_mask:0xf bank_mask:0xf
    s_nop 1
    v_max_f32_dpp v61, v61, v61 row_ror:2 row_mask:0xf bank_mask:0xf
    s_nop 1
    v_max_f32_dpp v61, v61, v61 row_ror:1 row_mask:0xf bank_mask:0xf
    v_sub_f32 v36, v24, v61
    ds_write_b32 v59, v61
    v_exp_f32 v36, v36
    s_nop 0
    v_cvt_pk_bf16_f32 v39, v36, v36
    ds_write_b16 v58, v39
    ds_read_b128 v[12:15], v52
    ds_read_b128 v[16:19], v53
    ds_read_b128 v[20:23], v54
    ds_read_b128 v[24:27], v55
    ds_read_b128 v[28:31], v56
    ds_read_b128 v[32:35], v57
    v_add_f32_dpp v38, v36, v36 row_ror:8 row_mask:0xf bank_mask:0xf
    v_mov_b64 v[40:41], 0
    v_mov_b64 v[42:43], 0
    v_add_f32_dpp v38, v38, v38 row_ror:4 row_mask:0xf bank_mask:0xf
    v_mov_b64 v[44:45], 0
    v_mov_b64 v[46:47], 0
    s_waitcnt lgkmcnt(5)
    v_smfmac_f32_16x16x64_bf16 v[40:43], v[12:15], v[160:167], v1
    v_add_f32_dpp v38, v38, v38 row_ror:2 row_mask:0xf bank_mask:0xf
    v_smfmac_f32_16x16x64_bf16 v[44:47], v[12:15], v[208:215], v1
    ds_read_b32 v36, v62
    s_waitcnt lgkmcnt(5)
    v_smfmac_f32_16x16x64_bf16 v[40:43], v[16:19], v[168:175], v1
    v_add_f32_dpp v38, v38, v38 row_ror:1 row_mask:0xf bank_mask:0xf
    v_smfmac_f32_16x16x64_bf16 v[44:47], v[16:19], v[216:223], v1
    s_waitcnt lgkmcnt(4)
    v_smfmac_f32_16x16x64_bf16 v[40:43], v[20:23], v[176:183], v1
    v_add_f32_dpp v38, v38, v38 row_bcast:15 row_mask:0xa bank_mask:0xf
    v_smfmac_f32_16x16x64_bf16 v[44:47], v[20:23], v[224:231], v1
    s_waitcnt lgkmcnt(0)
    v_max_f32_dpp v37, v36, v36 row_ror:4 row_mask:0xf bank_mask:0xf
    v_smfmac_f32_16x16x64_bf16 v[40:43], v[24:27], v[184:191], v1
    v_add_f32_dpp v38, v38, v38 row_bcast:31 row_mask:0xc bank_mask:0xf
    v_smfmac_f32_16x16x64_bf16 v[44:47], v[24:27], v[232:239], v1
    v_max_f32_dpp v37, v37, v37 row_ror:2 row_mask:0xf bank_mask:0xf
    v_smfmac_f32_16x16x64_bf16 v[40:43], v[28:31], v[192:199], v1
    v_cmp_eq_u32 vcc, -1, v36
    v_smfmac_f32_16x16x64_bf16 v[44:47], v[28:31], v[240:247], v1
    v_max_f32_dpp v37, v37, v37 row_ror:1 row_mask:0xf bank_mask:0xf
    v_smfmac_f32_16x16x64_bf16 v[40:43], v[32:35], v[200:207], v1
    v_sub_f32 v39, v61, v37
    v_smfmac_f32_16x16x64_bf16 v[44:47], v[32:35], v[248:255], v1
    v_exp_f32 v39, v39
    s_cbranch_vccnz L_mr_189
L_mk_190:
    v_mul_f32 v38, v38, v39
    ds_write_b32 v63, v38 offset:1024
    s_cmp_lt_u32 s30, 2
    s_nop 0
    v_pk_add_f32 v[40:41], v[40:41], v[42:43]
    s_nop 0
    v_pk_add_f32 v[42:43], v[44:45], v[46:47]
    v_pk_mul_f32 v[40:41], v[40:41], v[38:39] op_sel:[0,1] op_sel_hi:[1,1]
    v_pk_mul_f32 v[42:43], v[42:43], v[38:39] op_sel:[0,1] op_sel_hi:[1,1]
    ds_write_b128 v63, v[40:43]
    s_cbranch_scc1 L_comb_1
    s_waitcnt lgkmcnt(0)
    s_barrier
.p2align 5
L_comb_1b:
L_pad10:
    s_cbranch_execz L_pad14
    s_cmp_lt_u32 s3, 20
    s_cbranch_scc0 L_typeB_1
    s_mul_i32 s74, s30, 1664
    s_add_u32 s74, s74, s62
    s_add_u32 s74, s74, 26624
    v_and_b32 v56, 7, v0
    v_lshlrev_b32 v56, 2, v56
    v_lshrrev_b32 v62, 4, v0
    v_lshlrev_b32 v62, 3, v62
    buffer_load_dword v52, v56, s[40:43], s74 offen offset:1536 sc1
    buffer_load_dwordx2 v[54:55], v62, s[40:43], s74 offen offset:1536 sc1
    v_lshlrev_b32 v57, 4, v0
    v_lshlrev_b32 v58, 3, v0
    s_mul_i32 s57, s30, 6144
    s_add_u32 s57, s57, 30720
    v_lshrrev_b32 v59, 2, v0
    v_lshlrev_b32 v59, 6, v59
    v_bfe_u32 v53, v0, 4, 1
    v_lshl_add_u32 v59, v53, 5, v59
    v_and_b32 v53, 3, v0
    v_lshl_add_u32 v59, v53, 3, v59
    v_add_u32 v59, s57, v59
    v_xor_b32 v60, 32, v59
    s_lshl_b32 s57, s30, 8
    s_add_u32 s57, s57, 157696
    v_lshl_add_u32 v61, v0, 2, s57
    ds_read_b64_tr_b16 v[28:29], v59 offset:0
    ds_read_b64_tr_b16 v[30:31], v59 offset:1024
    ds_read_b64_tr_b16 v[32:33], v59 offset:2048
    ds_read_b64_tr_b16 v[34:35], v59 offset:3072
    ds_read_b64_tr_b16 v[36:37], v59 offset:4096
    ds_read_b64_tr_b16 v[38:39], v59 offset:5120
    ds_read_b64_tr_b16 v[40:41], v60 offset:0
    ds_read_b64_tr_b16 v[42:43], v60 offset:1024
    ds_read_b64_tr_b16 v[44:45], v60 offset:2048
    ds_read_b64_tr_b16 v[46:47], v60 offset:3072
    ds_read_b64_tr_b16 v[48:49], v60 offset:4096
    ds_read_b64_tr_b16 v[50:51], v60 offset:5120
    v_mov_b64 v[20:21], 0
    v_mov_b64 v[22:23], 0
    v_mov_b64 v[24:25], 0
    v_mov_b64 v[26:27], 0
    s_add_u32 s58, s6, 132096
    s_branch L_pw_197
.p2align 5
L_pr_198:
    buffer_load_dword v52, v56, s[40:43], s74 offen offset:1536 sc1
    buffer_load_dwordx2 v[54:55], v62, s[40:43], s74 offen offset:1536 sc1
    s_sub_u32 s56, s56, 1
    s_cbranch_scc1 L_done
L_pw_197:
    s_waitcnt vmcnt(0)
    v_max3_u32 v53, v52, v54, v55
    v_cmp_eq_u32 vcc, -1, v53
    s_cbranch_vccnz L_pr_198
    buffer_load_dwordx4 v[12:15], v57, s[40:43], s74 offen sc1
    buffer_load_dwordx2 v[16:17], v58, s[40:43], s74 offen offset:1024 sc1
    buffer_load_dword v18, v56, s[40:43], s74 offen offset:1568 sc1
    v_max_f32_dpp v53, v52, v52 row_ror:4 row_mask:0xf bank_mask:0xf
    s_nop 1
    v_max_f32_dpp v53, v53, v53 row_ror:2 row_mask:0xf bank_mask:0xf
    s_nop 1
    v_max_f32_dpp v53, v53, v53 row_ror:1 row_mask:0xf bank_mask:0xf
    v_sub_f32 v52, v52, v53
    v_sub_f32 v54, v54, v53
    v_sub_f32 v55, v55, v53
    v_exp_f32 v52, v52
    v_exp_f32 v54, v54
    v_exp_f32 v55, v55
    s_waitcnt lgkmcnt(0)
    s_branch L_ow_199
.p2align 5
L_or_200:
    buffer_load_dwordx4 v[12:15], v57, s[40:43], s74 offen sc1
    buffer_load_dwordx2 v[16:17], v58, s[40:43], s74 offen offset:1024 sc1
    buffer_load_dword v18, v56, s[40:43], s74 offen offset:1568 sc1
    s_sub_u32 s56, s56, 1
    s_cbranch_scc1 L_done
    v_mov_b64 v[20:21], 0
    v_mov_b64 v[22:23], 0
    v_mov_b64 v[24:25], 0
    v_mov_b64 v[26:27], 0
L_ow_199:
    s_waitcnt vmcnt(2)
    v_smfmac_f32_16x16x64_bf16 v[20:23], v[12:15], v[28:35], v1
    s_nop 2
L_pad11:
    s_cbranch_execz L_pad15
    v_smfmac_f32_16x16x64_bf16 v[24:27], v[12:15], v[40:47], v1
    s_waitcnt vmcnt(0)
    v_mul_f32 v53, v52, v18
    v_smfmac_f32_16x16x32_bf16 v[20:23], v[16:17], v[36:39], v1
    s_nop 2
    v_smfmac_f32_16x16x32_bf16 v[24:27], v[16:17], v[48:51], v1
    v_add_f32_dpp v53, v53, v53 row_ror:4 row_mask:0xf bank_mask:0xf
    v_max3_u32 v19, v12, v13, v14
    v_max3_u32 v62, v15, v16, v17
    v_add_f32_dpp v53, v53, v53 row_ror:2 row_mask:0xf bank_mask:0xf
    v_max3_u32 v19, v19, v62, v18
    s_cmp_eq_u32 s30, 2
    v_add_f32_dpp v53, v53, v53 row_ror:1 row_mask:0xf bank_mask:0xf
    v_cmp_eq_u32 vcc, -1, v19
    v_rcp_f32 v53, v53
    s_cbranch_vccnz L_or_200
    v_pk_add_f32 v[20:21], v[20:21], v[22:23]
    v_pk_add_f32 v[24:25], v[24:25], v[26:27]
    v_pk_mul_f32 v[54:55], v[54:55], v[52:53] op_sel:[0,1] op_sel_hi:[1,1]
    v_mul_f32 v20, v20, v54
    v_mul_f32 v24, v24, v54
    v_fmac_f32 v20, v21, v55
    v_fmac_f32 v24, v25, v55
    s_nop 1
    v_permlane32_swap_b32 v20, v24
    v_add_f32 v20, v20, v24
    ds_write_b32 v61, v20
    s_waitcnt lgkmcnt(0)
    s_barrier
    s_cbranch_scc0 L_finb_201
    ds_read2st64_b32 v[12:13], v2 offset0:0 offset1:1
    ds_read2st64_b32 v[14:15], v2 offset0:2 offset1:3
    ds_read2st64_b32 v[16:17], v2 offset0:4 offset1:5
    ds_read2st64_b32 v[18:19], v2 offset0:6 offset1:7
    s_waitcnt lgkmcnt(2)
    v_pk_add_f32 v[12:13], v[12:13], v[14:15]
    s_waitcnt lgkmcnt(0)
    v_pk_add_f32 v[16:17], v[16:17], v[18:19]
    v_pk_add_f32 v[12:13], v[12:13], v[16:17]
    v_add_f32 v14, v12, v13
    v_add_f32 v15, v12, v13
    s_nop 1
    v_permlane16_swap_b32 v14, v15
    v_add_f32 v12, v14, v15
    buffer_store_dword v12, v3, s[40:43], s58 offen sc1
.p2align 5
L_finb_201:
    s_sub_u32 s57, s30, 4
    s_cmp_lt_u32 s57, 3
    s_cbranch_scc0 L_skip_202
    s_sub_u32 s60, s30, 4
    s_lshl_b32 s57, s60, 11
    v_lshlrev_b32 v11, 4, v0
    v_add_u32 v11, s57, v11
    s_add_u32 s65, s62, 19456
    buffer_load_dwordx4 v[52:55], v11, s[40:43], s65 offen offset:0 sc1
    buffer_load_dwordx4 v[56:59], v11, s[40:43], s65 offen offset:1024 sc1
    s_lshl_b32 s59, s60, 12
    s_add_u32 s59, s59, 79872
    v_bfe_u32 v35, v0, 4, 1
    v_lshlrev_b32 v35, 11, v35
    v_bfe_u32 v60, v0, 2, 2
    v_lshl_add_u32 v35, v60, 8, v35
    v_lshrrev_b32 v60, 5, v0
    v_lshl_add_u32 v35, v60, 6, v35
    v_and_b32 v60, 3, v0
    v_lshl_add_u32 v35, v60, 3, v35
    v_add_u32 v35, s59, v35
    v_mov_b32 v9, 0xbdd2d3e8
    v_mov_b32 v10, 0xc0135761
    s_lshl_b32 s57, s60, 7
    s_add_u32 s57, s57, 160256
    v_lshlrev_b32 v32, 3, v0
    v_add_u32 v32, s57, v32
    v_lshlrev_b32 v33, 3, v0
    v_add_u32 v33, 129024, v33
    v_cmp_gt_u32 vcc, 16, v0
    s_nop 1
    v_cndmask_b32 v32, v33, v32, vcc
    v_and_b32 v33, 15, v0
    v_lshlrev_b32 v33, 3, v33
    v_lshrrev_b32 v60, 5, v0
    v_lshl_add_u32 v33, v60, 2, v33
    v_add_u32 v33, 160256, v33
    v_and_b32 v34, 15, v0
    v_lshlrev_b32 v34, 2, v34
    v_lshrrev_b32 v60, 5, v0
    v_lshl_add_u32 v34, v60, 6, v34
L_pad12:
    s_cbranch_execz L_pad16
    v_bfe_u32 v60, v0, 4, 1
    v_lshl_add_u32 v34, v60, 13, v34
    s_add_u32 s60, s6, 198144
    s_add_u32 s58, s62, 39936
    s_add_u32 s57, s62, 25984
    v_and_b32 v7, 7, v0
    v_lshlrev_b32 v7, 3, v7
    v_mov_b32 v60, 0x3acccccd
    v_mov_b32 v61, 0x3727c5ac
    s_waitcnt vmcnt(0)
    buffer_load_dwordx2 v[24:25], v7, s[40:43], s57 offen sc1
    buffer_load_dwordx4 v[12:15], v11, s[40:43], s58 offen offset:0 sc1
    buffer_load_dwordx4 v[16:19], v11, s[40:43], s58 offen offset:1024 sc1
    ds_read_b64_tr_b16 v[36:37], v35 offset:0
    ds_read_b64_tr_b16 v[38:39], v35 offset:1024
    ds_read_b64_tr_b16 v[40:41], v35 offset:128
    ds_read_b64_tr_b16 v[42:43], v35 offset:1152
    ds_read_b64_tr_b16 v[44:45], v35 offset:32
    ds_read_b64_tr_b16 v[46:47], v35 offset:1056
    ds_read_b64_tr_b16 v[48:49], v35 offset:160
    ds_read_b64_tr_b16 v[50:51], v35 offset:1184
L_sw_205:
    v_max3_u32 v20, v52, v53, v54
    v_max3_u32 v20, v20, v55, v56
    v_max3_u32 v20, v20, v57, v58
    v_max_u32 v20, v20, v59
    v_cmp_eq_u32 vcc, -1, v20
    s_cbranch_vccnz L_sr_206
    v_pk_add_f32 v[28:29], v[52:53], v[56:57]
    v_pk_add_f32 v[30:31], v[54:55], v[58:59]
    s_nop 1
    v_permlane32_swap_b32 v28, v30
    v_permlane32_swap_b32 v29, v31
    v_pk_add_f32 v[28:29], v[28:29], v[30:31]
    s_nop 1
    v_permlane16_swap_b32 v28, v29
    v_add_f32 v28, v28, v29
    v_mov_b64 v[52:53], 0
    v_mov_b64 v[54:55], 0
    v_mov_b64 v[56:57], 0
    v_mov_b64 v[58:59], 0
    s_waitcnt lgkmcnt(0)
    s_branch L_pw_203
.p2align 5
L_pr_204:
    buffer_load_dwordx2 v[24:25], v7, s[40:43], s57 offen sc1
    buffer_load_dwordx4 v[12:15], v11, s[40:43], s58 offen offset:0 sc1
    buffer_load_dwordx4 v[16:19], v11, s[40:43], s58 offen offset:1024 sc1
    s_sub_u32 s56, s56, 1
    s_cbranch_scc1 L_done
L_pw_203:
    s_waitcnt vmcnt(0)
    v_max_u32 v20, v24, v25
    v_cmp_eq_u32 vcc, -1, v20
    s_cbranch_vccnz L_pr_204
    buffer_load_dwordx4 v[12:15], v11, s[40:43], s58 offen offset:0 sc1
    buffer_load_dwordx4 v[16:19], v11, s[40:43], s58 offen offset:1024 sc1
    v_add_f32_dpp v2, v24, v24 row_ror:4 row_mask:0xf bank_mask:0xf
    v_add_f32_dpp v3, v25, v25 row_ror:4 row_mask:0xf bank_mask:0xf
    v_pk_add_f32 v[20:21], v[12:13], v[16:17]
    v_pk_add_f32 v[22:23], v[14:15], v[18:19]
    v_add_f32_dpp v2, v2, v2 row_ror:2 row_mask:0xf bank_mask:0xf
    v_add_f32_dpp v3, v3, v3 row_ror:2 row_mask:0xf bank_mask:0xf
    v_permlane32_swap_b32 v20, v22
    v_permlane32_swap_b32 v21, v23
    v_add_f32_dpp v2, v2, v2 row_ror:1 row_mask:0xf bank_mask:0xf
    v_add_f32_dpp v3, v3, v3 row_ror:1 row_mask:0xf bank_mask:0xf
    v_pk_add_f32 v[20:21], v[20:21], v[22:23]
    v_mul_f32 v2, v2, v60
    v_fma_f32 v3, v3, v60, v61
    v_permlane16_swap_b32 v20, v21
    v_fma_f32 v3, -v2, v2, v3
    v_add_f32 v20, v20, v21
    v_max_f32 v3, v3, v61
    v_mul_f32 v26, v28, v2
    v_rsq_f32 v3, v3
    v_cmp_u_f32 vcc, v20, v20
    v_sub_f32 v20, v20, v26
    s_cbranch_vccnz L_hr_207
L_hk_208:
    v_fma_f32 v20, v20, v3, v4
    v_mul_f32 v21, v20, v20
    v_mul_f32 v22, v20, v9
    v_mul_f32 v23, v20, v10
    v_fma_f32 v21, v21, v22, v23
L_pad13:
    s_cbranch_execz L_pad17
    v_exp_f32 v21, v21
    s_nop 0
    v_add_f32 v21, 1.0, v21
    v_rcp_f32 v21, v21
    s_nop 0
    v_mul_f32 v20, v20, v21
    s_nop 1
    v_mov_b32_dpp v21, v20 row_shl:1 row_mask:0xf bank_mask:0xf bound_ctrl:0
    v_cvt_pk_bf16_f32 v28, v20, v21
    s_nop 1
    v_mov_b32_dpp v29, v28 row_shl:4 row_mask:0xf bank_mask:0xf bound_ctrl:0
    v_mov_b32_dpp v30, v28 row_shl:8 row_mask:0xf bank_mask:0xf bound_ctrl:0
    v_mov_b32_dpp v31, v28 row_shl:12 row_mask:0xf bank_mask:0xf bound_ctrl:0
    s_nop 1
    v_smfmac_f32_16x16x64_bf16 v[52:55], v[28:31], v[36:43], v1
    v_smfmac_f32_16x16x64_bf16 v[56:59], v[28:31], v[44:51], v1
    s_cmp_eq_u32 s30, 4
    s_nop 5
    v_add_f32 v22, v52, v54
    v_add_f32 v23, v56, v58
    ds_write_b64 v32, v[22:23]
    s_cbranch_scc0 L_skip_210
L_xw_211:
    ds_read2_b32 v[20:21], v33 offset0:0 offset1:32
    ds_read_b32 v22, v33 offset:256
    s_sub_u32 s56, s56, 1
    s_cbranch_scc1 L_done
    s_waitcnt lgkmcnt(0)
    v_max3_u32 v23, v20, v21, v22
    v_add_f32 v20, v20, v21
    v_cmp_eq_u32 vcc, -1, v23
    v_add_f32 v20, v20, v22
    s_cbranch_vccnz L_xw_211
    buffer_store_dword v20, v34, s[40:43], s60 offen sc1
L_skip_210:
L_skip_202:
    s_branch L_done
.p2align 5
L_typeB_1:
    s_cmp_eq_u32 s53, 3
    s_cbranch_scc0 L_typeC_212
    s_cmp_eq_u32 s30, 7
    s_cbranch_scc1 L_w7_217
    s_cmp_lt_u32 s30, 6
    s_cbranch_scc0 L_skip_219
    s_lshr_b32 s57, s30, 1
    s_mul_i32 s57, s57, 128
    s_and_b32 s58, s30, 1
    s_lshl_b32 s58, s58, 6
    s_add_u32 s57, s57, s58
    v_lshrrev_b32 v18, 5, v0
    v_lshlrev_b32 v18, 13, v18
    v_bfe_u32 v60, v0, 3, 1
    v_lshl_add_u32 v18, v60, 12, v18
    v_bfe_u32 v60, v0, 4, 1
    v_lshl_add_u32 v18, v60, 11, v18
    v_bfe_u32 v60, v0, 2, 1
    v_mul_u32_u24 v60, 384, v60
    v_add_u32 v18, v60, v18
    v_and_b32 v60, 3, v0
    v_lshl_add_u32 v18, v60, 3, v18
    v_add_u32 v18, s57, v18
    v_add_u32 v18, 30720, v18
    v_bfe_u32 v19, v0, 3, 1
    v_lshlrev_b32 v19, 12, v19
    v_bfe_u32 v60, v0, 4, 1
    v_lshl_add_u32 v19, v60, 11, v19
    v_bfe_u32 v60, v0, 2, 1
    v_mul_u32_u24 v60, 384, v60
    v_add_u32 v19, v60, v19
    v_and_b32 v60, 3, v0
    v_lshl_add_u32 v19, v60, 3, v19
    v_lshrrev_b32 v60, 5, v0
    v_lshl_add_u32 v19, v60, 5, v19
    v_add_u32 v19, s57, v19
    v_add_u32 v19, 63488, v19
    ds_read_b64_tr_b16 v[28:29], v18 offset:0
    ds_read_b64_tr_b16 v[30:31], v18 offset:1024
    ds_read_b64_tr_b16 v[32:33], v18 offset:16384
    ds_read_b64_tr_b16 v[34:35], v18 offset:17408
    ds_read_b64_tr_b16 v[36:37], v18 offset:32
    ds_read_b64_tr_b16 v[38:39], v18 offset:1056
    ds_read_b64_tr_b16 v[40:41], v18 offset:16416
    ds_read_b64_tr_b16 v[42:43], v18 offset:17440
    ds_read_b64_tr_b16 v[24:25], v19 offset:0
    ds_read_b64_tr_b16 v[26:27], v19 offset:1024
    v_lshrrev_b32 v49, 4, v0
    v_lshlrev_b32 v49, 5, v49
    v_bfe_u32 v60, v0, 1, 1
    v_lshl_add_u32 v49, v60, 4, v49
L_pad14:
    s_cbranch_execz L_pad18
    v_bfe_u32 v60, v0, 3, 1
    v_mul_u32_u24 v60, 192, v60
    v_add_u32 v49, v60, v49
    v_add_u32 v49, 160832, v49
    v_bfe_u32 v50, v0, 1, 1
    v_lshlrev_b32 v50, 4, v50
    v_bfe_u32 v60, v0, 3, 1
    v_mul_u32_u24 v60, 192, v60
    v_add_u32 v50, v60, v50
    v_add_u32 v50, 160960, v50
    v_mov_b32 v60, 160992
    v_and_b32 v51, 5, v0
    v_cmp_eq_u32 vcc, 0, v51
    s_nop 1
    v_cndmask_b32 v9, v60, v49, vcc
    v_cmp_eq_u32 vcc, 4, v51
    s_nop 1
    v_cndmask_b32 v10, v60, v49, vcc
    v_lshrrev_b32 v49, 2, v0
    v_and_b32 v49, 12, v49
    v_cmp_eq_u32 vcc, v49, v51
    s_nop 1
    v_cndmask_b32 v48, v60, v50, vcc
    v_mov_b64 v[44:45], 0
    v_mov_b64 v[46:47], 0
    s_lshr_b32 s57, s30, 1
    s_lshl_b32 s57, s57, 11
    s_lshl_b32 s58, s58, 1
    s_add_u32 s57, s57, s58
    s_lshl_b32 s58, s54, 8
    s_add_u32 s57, s57, s58
    v_and_b32 v11, 31, v0
    v_lshlrev_b32 v11, 2, v11
    v_lshrrev_b32 v60, 5, v0
    v_lshl_add_u32 v11, v60, 30, v11
    v_add_u32 v11, s57, v11
    s_add_u32 s59, s62, 39936
    s_add_u32 s60, s62, 25984
L_skip_219:
    s_cmp_lt_u32 s30, 6
    s_barrier
    s_cbranch_scc0 L_se_218
    ds_read_b128 v[12:15], v9
    ds_read_b128 v[16:19], v10
    ds_read_b128 v[20:23], v48
    s_waitcnt lgkmcnt(2)
    v_smfmac_f32_16x16x64_bf16 v[44:47], v[12:15], v[28:35], v1
    s_waitcnt lgkmcnt(1)
    v_smfmac_f32_16x16x64_bf16 v[44:47], v[16:19], v[36:43], v1
    s_waitcnt lgkmcnt(0)
    v_smfmac_f32_16x16x64_bf16 v[44:47], v[20:23], v[24:31], v1
    s_cmp_eq_u32 s55, 0
    s_nop 6
    v_add_f32 v12, v44, v46
    s_cbranch_scc1 L_gs_220
    buffer_store_dword v12, v11, s[40:43], s59 offen
L_gb_221:
.p2align 5
L_se_218:
    s_cmp_eq_u32 s30, 7
    s_cbranch_scc0 L_done
    s_cmp_eq_u32 s31, 0
    s_cbranch_scc0 L_done
    v_lshlrev_b32 v60, 16, v4
    v_add_f32 v2, v2, v60
    v_and_b32 v60, 0xffff0000, v4
    v_add_f32 v3, v3, v60
    v_and_b32 v60, 31, v0
    v_min_u32 v60, 19, v60
    s_mul_i32 s57, s54, 160
    v_lshrrev_b32 v7, 5, v0
    v_lshlrev_b32 v7, 2, v7
    v_add_u32 v7, s57, v7
    v_lshl_add_u32 v7, v60, 3, v7
    s_add_u32 s57, s7, 198144
    s_add_u32 s58, s7, 214528
    s_add_u32 s59, s7, 230912
    s_add_u32 s60, s7, 247296
    v_mov_b64 v[36:37], 0
    v_mov_b64 v[38:39], 0
    s_nop 0
    v_mov_b32_dpp v36, v2 quad_perm:[0,1,2,3] row_mask:0x3 bank_mask:0xf
    v_mov_b32_dpp v37, v3 quad_perm:[0,1,2,3] row_mask:0x3 bank_mask:0xf
    v_mov_b32_dpp v38, v2 quad_perm:[0,1,2,3] row_mask:0xc bank_mask:0xf
    v_mov_b32_dpp v39, v3 quad_perm:[0,1,2,3] row_mask:0xc bank_mask:0xf
    s_add_u32 s75, s7, 266252
    v_and_b32 v9, 7, v0
    v_lshlrev_b32 v9, 9, v9
.p2align 5
L_pr_233:
L_pad15:
    s_cbranch_execz L_pad19
    buffer_load_dword v12, v9, s[40:43], s75 offen sc1
    s_sub_u32 s56, s56, 1
    s_cbranch_scc1 L_done
L_pw_232:
    s_waitcnt vmcnt(0)
    v_cmp_eq_u32 vcc, -1, v12
    s_cbranch_vccnz L_pr_233
L_gw_229:
    buffer_load_dwordx4 v[12:15], v5, s[40:43], s57 offen sc1
    buffer_load_dwordx4 v[16:19], v5, s[40:43], s58 offen sc1
    buffer_load_dwordx4 v[20:23], v5, s[40:43], s59 offen sc1
    buffer_load_dwordx4 v[24:27], v5, s[40:43], s60 offen sc1
    s_sub_u32 s56, s56, 1
    s_cbranch_scc1 L_done
    s_and_b32 s74, s56, 31
    s_waitcnt vmcnt(3)
    v_pk_add_f32 v[28:29], v[12:13], v[36:37]
    v_pk_add_f32 v[30:31], v[14:15], v[38:39]
    s_waitcnt vmcnt(2)
    v_pk_add_f32 v[28:29], v[28:29], v[16:17]
    v_pk_add_f32 v[30:31], v[30:31], v[18:19]
    s_waitcnt vmcnt(1)
    v_pk_add_f32 v[28:29], v[28:29], v[20:21]
    v_pk_add_f32 v[30:31], v[30:31], v[22:23]
    s_waitcnt vmcnt(0)
    v_pk_add_f32 v[28:29], v[28:29], v[24:25]
    v_pk_add_f32 v[30:31], v[30:31], v[26:27]
    v_pk_add_f32 v[32:33], v[28:29], v[30:31]
    v_cmp_u_f32 vcc, v32, v33
    v_permlane32_swap_b32 v28, v30
    v_permlane32_swap_b32 v29, v31
    s_cbranch_vccnz L_gr_230
L_gk_231:
    v_pk_add_f32 v[28:29], v[28:29], v[30:31]
    v_cvt_pk_bf16_f32 v28, v28, v29
    global_store_dword v7, v28, s[24:25]
    s_branch L_done
.p2align 5
L_gs_34:
    buffer_store_dword v33, v34, s[40:43], s67 offen sc1
    s_branch L_gb_35
.p2align 5
L_gs_37:
    buffer_store_dword v12, v54, s[40:43], s59 offen sc1
    s_branch L_gb_38
.p2align 5
L_cr_49:
    s_sub_u32 s56, s56, 1
    s_cbranch_scc1 L_done
    global_load_dword v2, v3, s[26:27] sc1
    s_waitcnt vmcnt(0)
    s_branch L_cw_48
.p2align 5
L_far_50:
    s_lshl_b32 s57, s52, 2
    s_add_u32 s57, s57, s72
    s_mov_b64 exec, 1
    buffer_store_dword v25, v0, s[40:43], s57 offen offset:128 sc1
    s_mov_b64 exec, -1
    s_branch L_fb_51
.p2align 5
L_cr_63:
    s_sub_u32 s56, s56, 1
    s_cbranch_scc1 L_done
    buffer_load_dword v2, v24, s[40:43], s72 offen sc1
    s_branch L_cw_62
.p2align 5
L_gs_70:
    buffer_store_dword v33, v34, s[40:43], s67 offen sc1
    s_branch L_gb_71
.p2align 5
L_gs_73:
    buffer_store_dword v12, v54, s[40:43], s59 offen sc1
    s_branch L_gb_74
.p2align 5
L_gs_91:
    buffer_store_dword v37, v4, s[40:43], s58 offen sc1
    s_branch L_gb_92
.p2align 5
L_cr_105:
    s_sub_u32 s56, s56, 1
    s_cbranch_scc1 L_done
    global_load_dword v2, v3, s[26:27] offset:4 sc1
    s_branch L_cw_104
.p2align 5
L_cr_115:
L_pad16:
    s_cbranch_execz L_pad20
    buffer_load_dword v52, v56, s[40:43], s74 offen offset:1536 sc1
    buffer_load_dwordx2 v[54:55], v62, s[40:43], s74 offen offset:1536 sc1
    s_sub_u32 s56, s56, 1
    s_cbranch_scc1 L_done
    s_branch L_cw_114
L_gs_120:
    buffer_store_dword v14, v3, s[40:43], s57 offen sc1
    s_branch L_gb_121
.p2align 5
L_gs_122:
    buffer_store_dword v12, v4, s[40:43], s57 offen offset:32 sc1
    s_branch L_gb_123
.p2align 5
L_comb_0:
    s_mov_b32 s57, 0
    s_cmp_eq_u32 s55, 0
    s_waitcnt lgkmcnt(0)
    s_barrier
    ds_read2st64_b64 v[12:15], v2 offset0:0 offset1:4
    ds_read2st64_b64 v[16:19], v2 offset0:8 offset1:12
    ds_read2st64_b64 v[20:23], v2 offset0:16 offset1:20
    ds_read2st64_b64 v[24:27], v2 offset0:24 offset1:28
    s_waitcnt lgkmcnt(2)
    v_pk_add_f32 v[12:13], v[12:13], v[14:15]
    v_pk_add_f32 v[16:17], v[16:17], v[18:19]
    v_pk_add_f32 v[12:13], v[12:13], v[16:17]
    s_waitcnt lgkmcnt(0)
    v_pk_add_f32 v[20:21], v[20:21], v[22:23]
    v_pk_add_f32 v[24:25], v[24:25], v[26:27]
    v_pk_add_f32 v[12:13], v[12:13], v[20:21]
    v_pk_add_f32 v[12:13], v[12:13], v[24:25]
    v_cvt_pk_bf16_f32 v14, v12, v13
    v_min_u32 v14, -2, v14
    s_cbranch_scc1 L_gs_120
    buffer_store_dword v14, v3, s[40:43], s57 offen
L_gb_121:
    s_cbranch_scc1 L_gs_122
    buffer_store_dword v12, v4, s[40:43], s57 offen offset:32
L_gb_123:
    s_branch L_comb_0b
.p2align 5
L_sr_132:
    buffer_load_dwordx4 v[52:55], v11, s[40:43], s65 offen offset:0 sc1
    buffer_load_dwordx4 v[56:59], v11, s[40:43], s65 offen offset:1024 sc1
    s_sub_u32 s56, s56, 1
    s_cbranch_scc1 L_done
    s_waitcnt vmcnt(0)
    s_branch L_sw_131
L_hr_133:
    buffer_load_dwordx4 v[12:15], v11, s[40:43], s58 offen offset:0 sc1
    buffer_load_dwordx4 v[16:19], v11, s[40:43], s58 offen offset:1024 sc1
    s_sub_u32 s56, s56, 1
    s_cbranch_scc1 L_done
    s_and_b32 s64, s56, 31
    s_cbranch_scc0 L_hx_135
    s_waitcnt vmcnt(2)
    v_pk_add_f32 v[20:21], v[12:13], v[16:17]
    v_pk_add_f32 v[22:23], v[14:15], v[18:19]
    s_nop 1
    v_permlane32_swap_b32 v20, v22
    v_permlane32_swap_b32 v21, v23
    v_pk_add_f32 v[20:21], v[20:21], v[22:23]
    s_nop 1
    v_permlane16_swap_b32 v20, v21
    v_add_f32 v20, v20, v21
    v_cmp_u_f32 vcc, v20, v20
    v_sub_f32 v20, v20, v26
    s_cbranch_vccnz L_hr_133
    s_branch L_hk_134
.p2align 5
L_hx_135:
    s_waitcnt vmcnt(0)
    v_max3_u32 v20, v12, v13, v14
    v_max3_u32 v20, v20, v15, v16
    v_max3_u32 v20, v20, v17, v18
    v_max_u32 v20, v20, v19
    v_cmp_eq_u32 vcc, -1, v20
    s_cbranch_vccnz L_hr_133
    v_pk_add_f32 v[20:21], v[12:13], v[16:17]
    v_pk_add_f32 v[22:23], v[14:15], v[18:19]
    s_nop 1
    v_permlane32_swap_b32 v20, v22
    v_permlane32_swap_b32 v21, v23
    v_pk_add_f32 v[20:21], v[20:21], v[22:23]
    s_nop 1
    v_permlane16_swap_b32 v20, v21
    v_add_f32 v20, v20, v21
    v_sub_f32 v20, v20, v26
    s_branch L_hk_134
L_gs_143:
L_pad17:
    s_cbranch_execz L_pad21
    buffer_store_dword v0, v11, s[40:43], s58 offen sc1
    s_branch L_gb_144
.p2align 5
L_typeC_139:
    s_cmp_eq_u32 s30, 6
    s_cbranch_scc0 L_p1
    s_bitcmp1_b32 s3, 0
    s_cbranch_scc0 L_skip_140
    v_and_b32 v11, 3, v0
    v_lshlrev_b32 v11, 7, v11
    v_lshrrev_b32 v60, 2, v0
    v_lshl_add_u32 v11, v60, 24, v11
    s_add_u32 s58, s62, 26116
    s_add_u32 s75, s7, 266244
    v_and_b32 v9, 7, v0
    v_lshlrev_b32 v9, 9, v9
.p2align 5
L_pr_142:
    buffer_load_dword v12, v9, s[40:43], s75 offen sc1
    s_sub_u32 s56, s56, 1
    s_cbranch_scc1 L_done
L_pw_141:
    s_waitcnt vmcnt(0)
    v_cmp_eq_u32 vcc, -1, v12
    s_cbranch_vccnz L_pr_142
    s_cmp_eq_u32 s55, 0
    s_cbranch_scc1 L_gs_143
    buffer_store_dword v0, v11, s[40:43], s58 offen
L_gb_144:
    s_waitcnt vmcnt(1)
    s_branch L_p1
.p2align 5
L_skip_140:
    s_lshl_b32 s59, s31, 9
    s_add_u32 s59, s59, s8
    s_add_u32 s59, s59, 266240
    v_and_b32 v10, 1, v0
    v_lshlrev_b32 v10, 13, v10
    v_lshrrev_b32 v60, 1, v0
    v_lshl_add_u32 v10, v60, 24, v10
    s_cmp_eq_u32 s3, 20
    s_cbranch_scc0 L_skip_145
    s_add_u32 s58, s62, 1568
    v_lshrrev_b32 v9, 3, v0
    v_mul_u32_u24 v9, 1664, v9
    v_and_b32 v60, 7, v0
    v_lshl_add_u32 v9, v60, 2, v9
.p2align 5
L_pr_147:
    buffer_load_dword v12, v9, s[40:43], s58 offen sc1
    s_sub_u32 s56, s56, 1
    s_cbranch_scc1 L_done
L_pw_146:
    s_waitcnt vmcnt(0)
    v_cmp_eq_u32 vcc, -1, v12
    s_cbranch_vccnz L_pr_147
    buffer_store_dword v0, v10, s[40:43], s59 offen offset:0 sc1
L_skip_145:
    s_add_u32 s58, s62, 25856
    v_and_b32 v9, 15, v0
    v_lshlrev_b32 v9, 2, v9
.p2align 5
L_pr_149:
    buffer_load_dword v13, v9, s[40:43], s58 offen sc1
    s_sub_u32 s56, s56, 1
    s_cbranch_scc1 L_done
L_pw_148:
    s_waitcnt vmcnt(0)
    v_cmp_eq_u32 vcc, -1, v13
    s_cbranch_vccnz L_pr_149
    buffer_store_dword v0, v10, s[40:43], s59 offen offset:4 sc1
    s_waitcnt vmcnt(1)
    s_branch L_p1
.p2align 5
L_gs_153:
    buffer_store_dword v12, v49, s[40:43], s60 offen sc1
    s_branch L_gb_154
.p2align 5
L_gs_155:
    buffer_store_dword v12, v11, s[40:43], s59 offen sc1
    s_branch L_gb_156
.p2align 5
L_gr_158:
    s_cbranch_scc1 L_gw_157
    s_waitcnt vmcnt(0)
    v_max3_u32 v32, v12, v13, v14
    v_max3_u32 v32, v32, v15, v16
    v_max3_u32 v32, v32, v17, v18
    v_max3_u32 v32, v32, v19, v20
    v_max3_u32 v32, v32, v21, v22
    v_max3_u32 v32, v32, v23, v24
    v_max3_u32 v32, v32, v25, v26
L_pad18:
    s_cbranch_execz L_pad22
    v_max_u32 v32, v32, v27
    v_cmp_eq_u32 vcc, -1, v32
    s_cbranch_vccnz L_gw_157
    v_pk_add_f32 v[28:29], v[12:13], v[36:37]
    v_pk_add_f32 v[30:31], v[14:15], v[38:39]
    v_pk_add_f32 v[28:29], v[28:29], v[16:17]
    v_pk_add_f32 v[30:31], v[30:31], v[18:19]
    v_pk_add_f32 v[28:29], v[28:29], v[20:21]
    v_pk_add_f32 v[30:31], v[30:31], v[22:23]
    v_pk_add_f32 v[28:29], v[28:29], v[24:25]
    v_pk_add_f32 v[30:31], v[30:31], v[26:27]
    s_nop 1
    v_permlane32_swap_b32 v28, v30
    v_permlane32_swap_b32 v29, v31
    s_branch L_gk_159
L_gs_162:
    buffer_store_dword v33, v34, s[40:43], s67 offen sc1
    s_branch L_gb_163
.p2align 5
L_w7_150:
    v_and_b32 v60, 31, v0
    v_min_u32 v60, 19, v60
    s_mul_i32 s57, s54, 320
    v_lshrrev_b32 v5, 5, v0
    v_lshlrev_b32 v5, 12, v5
    v_add_u32 v5, s57, v5
    v_lshl_add_u32 v5, v60, 4, v5
    v_and_b32 v60, 31, v0
    v_cmp_gt_u32 s[64:65], 20, v60
    v_min_u32 v60, 19, v60
    v_lshrrev_b32 v35, 5, v0
    v_lshlrev_b32 v35, 2, v35
    v_add_u32 v35, 160832, v35
    v_lshl_add_u32 v35, v60, 3, v35
    s_add_u32 s66, s62, 13312
    s_add_u32 s67, s62, 25856
    s_lshl_b32 s57, s54, 3
    v_lshrrev_b32 v34, 5, v0
    v_lshlrev_b32 v34, 2, v34
    v_add_u32 v34, s57, v34
    v_and_b32 v60, 31, v0
    v_mov_b32 v61, 0x7f000000
    v_cmp_ne_u32 vcc, 31, v60
    s_nop 1
    v_cndmask_b32 v34, v34, v61, vcc
    v_mov_b32 v61, 0x3f803f80
    s_add_u32 s57, s7, 0
    s_add_u32 s58, s7, 16384
    s_add_u32 s59, s7, 32768
    s_add_u32 s60, s7, 49152
    v_mov_b64 v[36:37], 0
    v_mov_b64 v[38:39], 0
    s_nop 0
    v_mov_b32_dpp v36, v2 quad_perm:[0,1,2,3] row_mask:0x3 bank_mask:0xf
    v_mov_b32_dpp v37, v3 quad_perm:[0,1,2,3] row_mask:0x3 bank_mask:0xf
    v_mov_b32_dpp v38, v2 quad_perm:[0,1,2,3] row_mask:0xc bank_mask:0xf
    v_mov_b32_dpp v39, v3 quad_perm:[0,1,2,3] row_mask:0xc bank_mask:0xf
    s_add_u32 s75, s7, 266240
    v_and_b32 v9, 7, v0
    v_lshlrev_b32 v9, 9, v9
.p2align 5
L_pr_161:
    buffer_load_dword v12, v9, s[40:43], s75 offen sc1
    s_sub_u32 s56, s56, 1
    s_cbranch_scc1 L_done
L_pw_160:
    s_waitcnt vmcnt(0)
    v_cmp_eq_u32 vcc, -1, v12
    s_cbranch_vccnz L_pr_161
L_gw_157:
    buffer_load_dwordx4 v[12:15], v5, s[40:43], s57 offen sc1
    buffer_load_dwordx4 v[16:19], v5, s[40:43], s58 offen sc1
    buffer_load_dwordx4 v[20:23], v5, s[40:43], s59 offen sc1
    buffer_load_dwordx4 v[24:27], v5, s[40:43], s60 offen sc1
    s_sub_u32 s56, s56, 1
    s_cbranch_scc1 L_done
    s_and_b32 s74, s56, 31
    s_waitcnt vmcnt(3)
    v_pk_add_f32 v[28:29], v[12:13], v[36:37]
    v_pk_add_f32 v[30:31], v[14:15], v[38:39]
    s_waitcnt vmcnt(2)
    v_pk_add_f32 v[28:29], v[28:29], v[16:17]
    v_pk_add_f32 v[30:31], v[30:31], v[18:19]
    s_waitcnt vmcnt(1)
    v_pk_add_f32 v[28:29], v[28:29], v[20:21]
    v_pk_add_f32 v[30:31], v[30:31], v[22:23]
L_pad19:
    s_cbranch_execz L_pad23
    s_waitcnt vmcnt(0)
    v_pk_add_f32 v[28:29], v[28:29], v[24:25]
    v_pk_add_f32 v[30:31], v[30:31], v[26:27]
    v_pk_add_f32 v[32:33], v[28:29], v[30:31]
    v_cmp_u_f32 vcc, v32, v33
    v_permlane32_swap_b32 v28, v30
    v_permlane32_swap_b32 v29, v31
    s_cbranch_vccnz L_gr_158
L_gk_159:
    v_pk_add_f32 v[28:29], v[28:29], v[30:31]
    v_cvt_pk_bf16_f32 v28, v28, v29
    ds_write_b32 v35, v28
    v_cndmask_b32 v29, 0, v28, s[64:65]
    v_dot2_f32_bf16 v33, v29, v61, 0
    v_dot2_f32_bf16 v32, v29, v29, 0
    v_lshlrev_b32 v2, 16, v28
    v_and_b32 v3, 0xffff0000, v28
    s_cmp_eq_u32 s55, 0
    v_permlane32_swap_b32 v33, v32
    v_add_f32 v33, v33, v32
    s_waitcnt lgkmcnt(0)
    s_barrier
    v_add_f32_dpp v33, v33, v33 row_ror:8 row_mask:0xf bank_mask:0xf
    s_nop 1
    v_add_f32_dpp v33, v33, v33 row_ror:4 row_mask:0xf bank_mask:0xf
    s_nop 1
    v_add_f32_dpp v33, v33, v33 row_ror:2 row_mask:0xf bank_mask:0xf
    s_nop 1
    v_add_f32_dpp v33, v33, v33 row_ror:1 row_mask:0xf bank_mask:0xf
    s_nop 1
    v_add_f32_dpp v33, v33, v33 row_bcast:15 row_mask:0xa bank_mask:0xf
    s_cbranch_scc1 L_gs_162
    buffer_store_dword v33, v34, s[40:43], s67 offen
L_gb_163:
    s_waitcnt vmcnt(1)
    s_branch L_se_151
.p2align 5
L_gs_167:
    buffer_store_dword v12, v11, s[40:43], s59 offen sc1
    s_branch L_gb_168
.p2align 5
L_gr_173:
    s_cbranch_scc1 L_gw_172
    s_waitcnt vmcnt(0)
    v_max3_u32 v32, v12, v13, v14
    v_max3_u32 v32, v32, v15, v16
    v_max3_u32 v32, v32, v17, v18
    v_max3_u32 v32, v32, v19, v20
    v_max3_u32 v32, v32, v21, v22
    v_max3_u32 v32, v32, v23, v24
    v_max3_u32 v32, v32, v25, v26
    v_max_u32 v32, v32, v27
    v_cmp_eq_u32 vcc, -1, v32
    s_cbranch_vccnz L_gw_172
    v_pk_add_f32 v[28:29], v[12:13], v[36:37]
    v_pk_add_f32 v[30:31], v[14:15], v[38:39]
    v_pk_add_f32 v[28:29], v[28:29], v[16:17]
    v_pk_add_f32 v[30:31], v[30:31], v[18:19]
    v_pk_add_f32 v[28:29], v[28:29], v[20:21]
    v_pk_add_f32 v[30:31], v[30:31], v[22:23]
    v_pk_add_f32 v[28:29], v[28:29], v[24:25]
    v_pk_add_f32 v[30:31], v[30:31], v[26:27]
    s_nop 1
    v_permlane32_swap_b32 v28, v30
    v_permlane32_swap_b32 v29, v31
    s_branch L_gk_174
.p2align 5
L_gr_176:
    s_cbranch_scc1 L_gw_175
    s_waitcnt vmcnt(0)
    v_max3_u32 v32, v12, v13, v14
    v_max3_u32 v32, v32, v15, v16
    v_max3_u32 v32, v32, v17, v18
    v_max3_u32 v32, v32, v19, v20
    v_max3_u32 v32, v32, v21, v22
    v_max3_u32 v32, v32, v23, v24
    v_max3_u32 v32, v32, v25, v26
    v_max_u32 v32, v32, v27
    v_cmp_eq_u32 vcc, -1, v32
    s_cbranch_vccnz L_gw_175
    v_pk_add_f32 v[28:29], v[12:13], v[36:37]
    v_pk_add_f32 v[30:31], v[14:15], v[38:39]
    v_pk_add_f32 v[28:29], v[28:29], v[16:17]
L_pad20:
    s_cbranch_execz L_pad24
    v_pk_add_f32 v[30:31], v[30:31], v[18:19]
    v_pk_add_f32 v[28:29], v[28:29], v[20:21]
    v_pk_add_f32 v[30:31], v[30:31], v[22:23]
    v_pk_add_f32 v[28:29], v[28:29], v[24:25]
    v_pk_add_f32 v[30:31], v[30:31], v[26:27]
    s_nop 1
    v_permlane32_swap_b32 v28, v30
    v_permlane32_swap_b32 v29, v31
    s_branch L_gk_177
L_gs_180:
    buffer_store_dword v33, v34, s[40:43], s67 offen sc1
    s_branch L_gb_181
.p2align 5
L_w7_164:
    v_and_b32 v60, 31, v0
    v_min_u32 v60, 19, v60
    s_mul_i32 s57, s54, 320
    v_lshrrev_b32 v5, 5, v0
    v_lshlrev_b32 v5, 12, v5
    v_add_u32 v5, s57, v5
    v_lshl_add_u32 v5, v60, 4, v5
    v_and_b32 v60, 31, v0
    v_cmp_gt_u32 s[64:65], 20, v60
    v_min_u32 v60, 19, v60
    v_lshrrev_b32 v35, 5, v0
    v_lshlrev_b32 v35, 2, v35
    v_add_u32 v35, 160832, v35
    v_lshl_add_u32 v35, v60, 3, v35
    s_mul_i32 s66, s53, 6144
    s_add_u32 s66, s66, s62
    s_add_u32 s66, s66, 46080
    s_lshl_b32 s67, s53, 6
    s_add_u32 s67, s67, s62
    s_add_u32 s67, s67, 25600
    s_lshl_b32 s57, s54, 3
    v_lshrrev_b32 v34, 5, v0
    v_lshlrev_b32 v34, 2, v34
    v_add_u32 v34, s57, v34
    v_and_b32 v60, 31, v0
    v_mov_b32 v61, 0x7f000000
    v_cmp_ne_u32 vcc, 31, v60
    s_nop 1
    v_cndmask_b32 v34, v34, v61, vcc
    v_mov_b32 v61, 0x3f803f80
    s_cmp_lg_u32 s53, 3
    s_cbranch_scc0 L_skip_169
    s_add_u32 s57, s62, 25856
    v_mov_b32 v9, 0
.p2align 5
L_pr_171:
    buffer_load_dword v12, v9, s[40:43], s57 offen sc1
    s_sub_u32 s56, s56, 1
    s_cbranch_scc1 L_done
L_pw_170:
    s_waitcnt vmcnt(0)
    v_cmp_eq_u32 vcc, -1, v12
    s_cbranch_vccnz L_pr_171
    s_add_u32 s57, s7, 0
    s_add_u32 s58, s7, 16384
    s_add_u32 s59, s7, 32768
    s_add_u32 s60, s7, 49152
    v_mov_b64 v[36:37], 0
    v_mov_b64 v[38:39], 0
    s_nop 0
    v_mov_b32_dpp v36, v2 quad_perm:[0,1,2,3] row_mask:0x3 bank_mask:0xf
    v_mov_b32_dpp v37, v3 quad_perm:[0,1,2,3] row_mask:0x3 bank_mask:0xf
    v_mov_b32_dpp v38, v2 quad_perm:[0,1,2,3] row_mask:0xc bank_mask:0xf
    v_mov_b32_dpp v39, v3 quad_perm:[0,1,2,3] row_mask:0xc bank_mask:0xf
L_gw_172:
    buffer_load_dwordx4 v[12:15], v5, s[40:43], s57 offen sc1
    buffer_load_dwordx4 v[16:19], v5, s[40:43], s58 offen sc1
    buffer_load_dwordx4 v[20:23], v5, s[40:43], s59 offen sc1
    buffer_load_dwordx4 v[24:27], v5, s[40:43], s60 offen sc1
    s_sub_u32 s56, s56, 1
    s_cbranch_scc1 L_done
    s_and_b32 s74, s56, 31
    s_waitcnt vmcnt(3)
    v_pk_add_f32 v[28:29], v[12:13], v[36:37]
    v_pk_add_f32 v[30:31], v[14:15], v[38:39]
    s_waitcnt vmcnt(2)
    v_pk_add_f32 v[28:29], v[28:29], v[16:17]
    v_pk_add_f32 v[30:31], v[30:31], v[18:19]
    s_waitcnt vmcnt(1)
    v_pk_add_f32 v[28:29], v[28:29], v[20:21]
    v_pk_add_f32 v[30:31], v[30:31], v[22:23]
    s_waitcnt vmcnt(0)
    v_pk_add_f32 v[28:29], v[28:29], v[24:25]
    v_pk_add_f32 v[30:31], v[30:31], v[26:27]
L_pad21:
    s_cbranch_execz L_pad25
    v_pk_add_f32 v[32:33], v[28:29], v[30:31]
    v_cmp_u_f32 vcc, v32, v33
    v_permlane32_swap_b32 v28, v30
    v_permlane32_swap_b32 v29, v31
    s_cbranch_vccnz L_gr_173
L_gk_174:
    v_pk_add_f32 v[28:29], v[28:29], v[30:31]
    v_cvt_pk_bf16_f32 v28, v28, v29
    v_lshlrev_b32 v2, 16, v28
    v_and_b32 v3, 0xffff0000, v28
L_skip_169:
    s_lshl_b32 s74, s53, 7
    s_add_u32 s75, s62, s74
    s_add_u32 s75, s75, 26116
    v_mov_b32 v9, 0
    buffer_load_dword v12, v9, s[40:43], s75 offen sc1
    v_lshlrev_b32 v60, 16, v4
    v_add_f32 v2, v2, v60
    v_and_b32 v60, 0xffff0000, v4
    v_add_f32 v3, v3, v60
    s_add_u32 s57, s7, 66048
    s_add_u32 s58, s7, 82432
    s_add_u32 s59, s7, 98816
    s_add_u32 s60, s7, 115200
    v_mov_b64 v[36:37], 0
    v_mov_b64 v[38:39], 0
    s_nop 0
    v_mov_b32_dpp v36, v2 quad_perm:[0,1,2,3] row_mask:0x3 bank_mask:0xf
    v_mov_b32_dpp v37, v3 quad_perm:[0,1,2,3] row_mask:0x3 bank_mask:0xf
    v_mov_b32_dpp v38, v2 quad_perm:[0,1,2,3] row_mask:0xc bank_mask:0xf
    v_mov_b32_dpp v39, v3 quad_perm:[0,1,2,3] row_mask:0xc bank_mask:0xf
.p2align 5
L_pr_179:
    buffer_load_dword v12, v9, s[40:43], s75 offen sc1
    s_sub_u32 s56, s56, 1
    s_cbranch_scc1 L_done
L_pw_178:
    s_waitcnt vmcnt(1)
    v_cmp_eq_u32 vcc, -1, v12
    s_cbranch_vccnz L_pr_179
L_gw_175:
    buffer_load_dwordx4 v[12:15], v5, s[40:43], s57 offen sc1
    buffer_load_dwordx4 v[16:19], v5, s[40:43], s58 offen sc1
    buffer_load_dwordx4 v[20:23], v5, s[40:43], s59 offen sc1
    buffer_load_dwordx4 v[24:27], v5, s[40:43], s60 offen sc1
    s_sub_u32 s56, s56, 1
    s_cbranch_scc1 L_done
    s_and_b32 s74, s56, 31
    s_waitcnt vmcnt(3)
    v_pk_add_f32 v[28:29], v[12:13], v[36:37]
    v_pk_add_f32 v[30:31], v[14:15], v[38:39]
    s_waitcnt vmcnt(2)
    v_pk_add_f32 v[28:29], v[28:29], v[16:17]
    v_pk_add_f32 v[30:31], v[30:31], v[18:19]
    s_waitcnt vmcnt(1)
    v_pk_add_f32 v[28:29], v[28:29], v[20:21]
    v_pk_add_f32 v[30:31], v[30:31], v[22:23]
    s_waitcnt vmcnt(0)
    v_pk_add_f32 v[28:29], v[28:29], v[24:25]
    v_pk_add_f32 v[30:31], v[30:31], v[26:27]
    v_pk_add_f32 v[32:33], v[28:29], v[30:31]
    v_cmp_u_f32 vcc, v32, v33
    v_permlane32_swap_b32 v28, v30
    v_permlane32_swap_b32 v29, v31
    s_cbranch_vccnz L_gr_176
L_gk_177:
    v_pk_add_f32 v[28:29], v[28:29], v[30:31]
    v_cvt_pk_bf16_f32 v28, v28, v29
    ds_write_b32 v35, v28
    v_cndmask_b32 v29, 0, v28, s[64:65]
    v_dot2_f32_bf16 v33, v29, v61, 0
    v_dot2_f32_bf16 v32, v29, v29, 0
    v_lshlrev_b32 v2, 16, v28
    v_and_b32 v3, 0xffff0000, v28
    s_cmp_eq_u32 s55, 0
    v_permlane32_swap_b32 v33, v32
    v_add_f32 v33, v33, v32
    s_waitcnt lgkmcnt(0)
    s_barrier
    v_add_f32_dpp v33, v33, v33 row_ror:8 row_mask:0xf bank_mask:0xf
    s_nop 1
    v_add_f32_dpp v33, v33, v33 row_ror:4 row_mask:0xf bank_mask:0xf
    s_nop 1
    v_add_f32_dpp v33, v33, v33 row_ror:2 row_mask:0xf bank_mask:0xf
    s_nop 1
    v_add_f32_dpp v33, v33, v33 row_ror:1 row_mask:0xf bank_mask:0xf
    s_nop 1
    v_add_f32_dpp v33, v33, v33 row_bcast:15 row_mask:0xa bank_mask:0xf
    s_cbranch_scc1 L_gs_180
    buffer_store_dword v33, v34, s[40:43], s67 offen
L_gb_181:
L_pad22:
    s_cbranch_execz L_pad26
    s_waitcnt vmcnt(1)
    s_branch L_se_165
.p2align 5
L_hr_186:
    buffer_load_dwordx4 v[40:43], v7, s[40:43], s59 offen offset:0 sc1
    buffer_load_dwordx4 v[44:47], v7, s[40:43], s59 offen offset:1024 sc1
    s_sub_u32 s56, s56, 1
    s_cbranch_scc1 L_done
    s_and_b32 s64, s56, 31
    s_cbranch_scc0 L_hx_188
    s_waitcnt vmcnt(2)
    v_pk_add_f32 v[20:21], v[40:41], v[44:45]
    v_pk_add_f32 v[22:23], v[42:43], v[46:47]
    s_nop 1
    v_permlane32_swap_b32 v20, v22
    v_permlane32_swap_b32 v21, v23
    v_pk_add_f32 v[20:21], v[20:21], v[22:23]
    s_nop 1
    v_permlane16_swap_b32 v20, v21
    v_add_f32 v20, v20, v21
    v_cmp_u_f32 vcc, v20, v20
    v_sub_f32 v20, v20, v50
    s_cbranch_vccnz L_hr_186
    s_branch L_hk_187
.p2align 5
L_hx_188:
    s_waitcnt vmcnt(0)
    v_max3_u32 v20, v40, v41, v42
    v_max3_u32 v20, v20, v43, v44
    v_max3_u32 v20, v20, v45, v46
    v_max_u32 v20, v20, v47
    v_cmp_eq_u32 vcc, -1, v20
    s_cbranch_vccnz L_hr_186
    v_pk_add_f32 v[20:21], v[40:41], v[44:45]
    v_pk_add_f32 v[22:23], v[42:43], v[46:47]
    s_nop 1
    v_permlane32_swap_b32 v20, v22
    v_permlane32_swap_b32 v21, v23
    v_pk_add_f32 v[20:21], v[20:21], v[22:23]
    s_nop 1
    v_permlane16_swap_b32 v20, v21
    v_add_f32 v20, v20, v21
    v_sub_f32 v20, v20, v50
    s_branch L_hk_187
L_qo_182:
    v_mov_b64 v[24:25], 0
    v_mov_b64 v[26:27], 0
    v_mov_b64 v[28:29], 0
    v_mov_b64 v[30:31], 0
    v_mov_b64 v[32:33], 0
    v_mov_b64 v[34:35], 0
    v_mov_b64 v[36:37], 0
    v_mov_b64 v[38:39], 0
    v_lshrrev_b32 v5, 4, v0
    v_lshlrev_b32 v5, 5, v5
    v_bfe_u32 v60, v0, 1, 1
    v_lshl_add_u32 v5, v60, 4, v5
    v_add_u32 v5, 124928, v5
    s_branch L_qb_183
.p2align 5
L_mr_189:
    ds_read_b32 v36, v62
    s_sub_u32 s56, s56, 1
    s_cbranch_scc1 L_done
    s_waitcnt lgkmcnt(0)
    v_cmp_eq_u32 vcc, -1, v36
    s_cbranch_vccnz L_mr_189
    v_max_f32_dpp v37, v36, v36 row_ror:4 row_mask:0xf bank_mask:0xf
    s_nop 1
    v_max_f32_dpp v37, v37, v37 row_ror:2 row_mask:0xf bank_mask:0xf
    s_nop 1
    v_max_f32_dpp v37, v37, v37 row_ror:1 row_mask:0xf bank_mask:0xf
    v_sub_f32 v39, v61, v37
    v_exp_f32 v39, v39
    s_branch L_mk_190
.p2align 5
L_gs_191:
    buffer_store_dword v37, v4, s[40:43], s58 offen sc1
    s_branch L_gb_192
.p2align 5
L_gs_193:
    buffer_store_dword v14, v3, s[40:43], s57 offen sc1
    s_branch L_gb_194
.p2align 5
L_gs_195:
L_pad23:
    s_cbranch_execz L_padback
    buffer_store_dword v12, v4, s[40:43], s57 offen offset:32 sc1
    s_branch L_gb_196
.p2align 5
L_comb_1:
    s_mov_b32 s58, 26624
    s_cmp_eq_u32 s55, 0
    s_cbranch_scc1 L_gs_191
    buffer_store_dword v37, v4, s[40:43], s58 offen
L_gb_192:
    s_mov_b32 s57, 26624
    s_cmp_eq_u32 s55, 0
    s_waitcnt lgkmcnt(0)
    s_barrier
    ds_read2st64_b64 v[12:15], v2 offset0:0 offset1:4
    ds_read2st64_b64 v[16:19], v2 offset0:8 offset1:12
    ds_read2st64_b64 v[20:23], v2 offset0:16 offset1:20
    ds_read2st64_b64 v[24:27], v2 offset0:24 offset1:28
    s_waitcnt lgkmcnt(2)
    v_pk_add_f32 v[12:13], v[12:13], v[14:15]
    v_pk_add_f32 v[16:17], v[16:17], v[18:19]
    v_pk_add_f32 v[12:13], v[12:13], v[16:17]
    s_waitcnt lgkmcnt(0)
    v_pk_add_f32 v[20:21], v[20:21], v[22:23]
    v_pk_add_f32 v[24:25], v[24:25], v[26:27]
    v_pk_add_f32 v[12:13], v[12:13], v[20:21]
    v_pk_add_f32 v[12:13], v[12:13], v[24:25]
    v_cvt_pk_bf16_f32 v14, v12, v13
    v_min_u32 v14, -2, v14
    s_cbranch_scc1 L_gs_193
    buffer_store_dword v14, v3, s[40:43], s57 offen
L_gb_194:
    s_cbranch_scc1 L_gs_195
    buffer_store_dword v12, v4, s[40:43], s57 offen offset:32
L_gb_196:
    s_branch L_comb_1b
.p2align 5
L_sr_206:
    buffer_load_dwordx4 v[52:55], v11, s[40:43], s65 offen offset:0 sc1
    buffer_load_dwordx4 v[56:59], v11, s[40:43], s65 offen offset:1024 sc1
    s_sub_u32 s56, s56, 1
    s_cbranch_scc1 L_done
    s_waitcnt vmcnt(0)
    s_branch L_sw_205
L_hr_207:
    buffer_load_dwordx4 v[12:15], v11, s[40:43], s58 offen offset:0 sc1
    buffer_load_dwordx4 v[16:19], v11, s[40:43], s58 offen offset:1024 sc1
    s_sub_u32 s56, s56, 1
    s_cbranch_scc1 L_done
    s_and_b32 s64, s56, 31
    s_cbranch_scc0 L_hx_209
    s_waitcnt vmcnt(2)
    v_pk_add_f32 v[20:21], v[12:13], v[16:17]
    v_pk_add_f32 v[22:23], v[14:15], v[18:19]
    s_nop 1
    v_permlane32_swap_b32 v20, v22
    v_permlane32_swap_b32 v21, v23
    v_pk_add_f32 v[20:21], v[20:21], v[22:23]
    s_nop 1
    v_permlane16_swap_b32 v20, v21
    v_add_f32 v20, v20, v21
    v_cmp_u_f32 vcc, v20, v20
    v_sub_f32 v20, v20, v26
    s_cbranch_vccnz L_hr_207
    s_branch L_hk_208
.p2align 5
L_hx_209:
    s_waitcnt vmcnt(0)
    v_max3_u32 v20, v12, v13, v14
    v_max3_u32 v20, v20, v15, v16
    v_max3_u32 v20, v20, v17, v18
    v_max_u32 v20, v20, v19
    v_cmp_eq_u32 vcc, -1, v20
    s_cbranch_vccnz L_hr_207
    v_pk_add_f32 v[20:21], v[12:13], v[16:17]
    v_pk_add_f32 v[22:23], v[14:15], v[18:19]
    s_nop 1
    v_permlane32_swap_b32 v20, v22
    v_permlane32_swap_b32 v21, v23
    v_pk_add_f32 v[20:21], v[20:21], v[22:23]
    s_nop 1
    v_permlane16_swap_b32 v20, v21
    v_add_f32 v20, v20, v21
    v_sub_f32 v20, v20, v26
    s_branch L_hk_208
L_typeC_212:
    s_cmp_eq_u32 s30, 6
    s_cbranch_scc0 L_done
    s_cmp_eq_u32 s3, 20
    s_cbranch_scc0 L_done
    s_lshl_b32 s59, s31, 9
    s_add_u32 s59, s59, s8
    s_add_u32 s59, s59, 266240
L_pad24:
    s_cbranch_execz L_padback
    v_and_b32 v10, 1, v0
    v_lshlrev_b32 v10, 13, v10
    v_lshrrev_b32 v60, 1, v0
    v_lshl_add_u32 v10, v60, 24, v10
    s_add_u32 s58, s62, 28192
    v_lshrrev_b32 v9, 3, v0
    v_mul_u32_u24 v9, 1664, v9
    v_and_b32 v60, 7, v0
    v_lshl_add_u32 v9, v60, 2, v9
.p2align 5
L_pr_214:
    buffer_load_dword v12, v9, s[40:43], s58 offen sc1
    s_sub_u32 s56, s56, 1
    s_cbranch_scc1 L_done
L_pw_213:
    s_waitcnt vmcnt(0)
    v_cmp_eq_u32 vcc, -1, v12
    s_cbranch_vccnz L_pr_214
    buffer_store_dword v0, v10, s[40:43], s59 offen offset:8 sc1
    s_add_u32 s58, s62, 25984
    v_and_b32 v9, 15, v0
    v_lshlrev_b32 v9, 2, v9
.p2align 5
L_pr_216:
    buffer_load_dword v13, v9, s[40:43], s58 offen sc1
    s_sub_u32 s56, s56, 1
    s_cbranch_scc1 L_done
L_pw_215:
    s_waitcnt vmcnt(0)
    v_cmp_eq_u32 vcc, -1, v13
    s_cbranch_vccnz L_pr_216
    buffer_store_dword v0, v10, s[40:43], s59 offen offset:12 sc1
    s_waitcnt vmcnt(1)
    s_branch L_done
.p2align 5
L_gs_220:
    buffer_store_dword v12, v11, s[40:43], s59 offen sc1
    s_branch L_gb_221
.p2align 5
L_gr_223:
    s_cbranch_scc1 L_gw_222
    s_waitcnt vmcnt(0)
    v_max3_u32 v32, v12, v13, v14
    v_max3_u32 v32, v32, v15, v16
    v_max3_u32 v32, v32, v17, v18
    v_max3_u32 v32, v32, v19, v20
    v_max3_u32 v32, v32, v21, v22
    v_max3_u32 v32, v32, v23, v24
    v_max3_u32 v32, v32, v25, v26
    v_max_u32 v32, v32, v27
    v_cmp_eq_u32 vcc, -1, v32
    s_cbranch_vccnz L_gw_222
    v_pk_add_f32 v[28:29], v[12:13], v[36:37]
    v_pk_add_f32 v[30:31], v[14:15], v[38:39]
    v_pk_add_f32 v[28:29], v[28:29], v[16:17]
    v_pk_add_f32 v[30:31], v[30:31], v[18:19]
    v_pk_add_f32 v[28:29], v[28:29], v[20:21]
    v_pk_add_f32 v[30:31], v[30:31], v[22:23]
    v_pk_add_f32 v[28:29], v[28:29], v[24:25]
    v_pk_add_f32 v[30:31], v[30:31], v[26:27]
    s_nop 1
    v_permlane32_swap_b32 v28, v30
    v_permlane32_swap_b32 v29, v31
    s_branch L_gk_224
.p2align 5
L_gs_227:
    buffer_store_dword v33, v34, s[40:43], s67 offen sc1
    s_branch L_gb_228
.p2align 5
L_w7_217:
    v_and_b32 v60, 31, v0
    v_min_u32 v60, 19, v60
    s_mul_i32 s57, s54, 320
    v_lshrrev_b32 v5, 5, v0
    v_lshlrev_b32 v5, 12, v5
    v_add_u32 v5, s57, v5
    v_lshl_add_u32 v5, v60, 4, v5
    v_and_b32 v60, 31, v0
    v_cmp_gt_u32 s[64:65], 20, v60
    v_min_u32 v60, 19, v60
    v_lshrrev_b32 v35, 5, v0
    v_lshlrev_b32 v35, 2, v35
    v_add_u32 v35, 160832, v35
    v_lshl_add_u32 v35, v60, 3, v35
    s_add_u32 s66, s62, 39936
    s_add_u32 s67, s62, 25984
    s_lshl_b32 s57, s54, 3
L_pad25:
    s_cbranch_execz L_padback
    v_lshrrev_b32 v34, 5, v0
    v_lshlrev_b32 v34, 2, v34
    v_add_u32 v34, s57, v34
    v_and_b32 v60, 31, v0
    v_mov_b32 v61, 0x7f000000
    v_cmp_ne_u32 vcc, 31, v60
    s_nop 1
    v_cndmask_b32 v34, v34, v61, vcc
    v_mov_b32 v61, 0x3f803f80
    s_add_u32 s57, s7, 132096
    s_add_u32 s58, s7, 148480
    s_add_u32 s59, s7, 164864
    s_add_u32 s60, s7, 181248
    v_mov_b64 v[36:37], 0
    v_mov_b64 v[38:39], 0
    s_nop 0
    v_mov_b32_dpp v36, v2 quad_perm:[0,1,2,3] row_mask:0x3 bank_mask:0xf
    v_mov_b32_dpp v37, v3 quad_perm:[0,1,2,3] row_mask:0x3 bank_mask:0xf
    v_mov_b32_dpp v38, v2 quad_perm:[0,1,2,3] row_mask:0xc bank_mask:0xf
    v_mov_b32_dpp v39, v3 quad_perm:[0,1,2,3] row_mask:0xc bank_mask:0xf
    s_add_u32 s75, s7, 266248
    v_and_b32 v9, 7, v0
    v_lshlrev_b32 v9, 9, v9
.p2align 5
L_pr_226:
    buffer_load_dword v12, v9, s[40:43], s75 offen sc1
    s_sub_u32 s56, s56, 1
    s_cbranch_scc1 L_done
L_pw_225:
    s_waitcnt vmcnt(0)
    v_cmp_eq_u32 vcc, -1, v12
    s_cbranch_vccnz L_pr_226
L_gw_222:
    buffer_load_dwordx4 v[12:15], v5, s[40:43], s57 offen sc1
    buffer_load_dwordx4 v[16:19], v5, s[40:43], s58 offen sc1
    buffer_load_dwordx4 v[20:23], v5, s[40:43], s59 offen sc1
    buffer_load_dwordx4 v[24:27], v5, s[40:43], s60 offen sc1
    s_sub_u32 s56, s56, 1
    s_cbranch_scc1 L_done
    s_and_b32 s74, s56, 31
    s_waitcnt vmcnt(3)
    v_pk_add_f32 v[28:29], v[12:13], v[36:37]
    v_pk_add_f32 v[30:31], v[14:15], v[38:39]
    s_waitcnt vmcnt(2)
    v_pk_add_f32 v[28:29], v[28:29], v[16:17]
    v_pk_add_f32 v[30:31], v[30:31], v[18:19]
    s_waitcnt vmcnt(1)
    v_pk_add_f32 v[28:29], v[28:29], v[20:21]
    v_pk_add_f32 v[30:31], v[30:31], v[22:23]
    s_waitcnt vmcnt(0)
    v_pk_add_f32 v[28:29], v[28:29], v[24:25]
    v_pk_add_f32 v[30:31], v[30:31], v[26:27]
    v_pk_add_f32 v[32:33], v[28:29], v[30:31]
    v_cmp_u_f32 vcc, v32, v33
    v_permlane32_swap_b32 v28, v30
    v_permlane32_swap_b32 v29, v31
    s_cbranch_vccnz L_gr_223
L_gk_224:
    v_pk_add_f32 v[28:29], v[28:29], v[30:31]
    v_cvt_pk_bf16_f32 v28, v28, v29
    ds_write_b32 v35, v28
    v_cndmask_b32 v29, 0, v28, s[64:65]
    v_dot2_f32_bf16 v33, v29, v61, 0
    v_dot2_f32_bf16 v32, v29, v29, 0
    v_lshlrev_b32 v2, 16, v28
    v_and_b32 v3, 0xffff0000, v28
    s_cmp_eq_u32 s55, 0
    v_permlane32_swap_b32 v33, v32
    v_add_f32 v33, v33, v32
    s_waitcnt lgkmcnt(0)
    s_barrier
    v_add_f32_dpp v33, v33, v33 row_ror:8 row_mask:0xf bank_mask:0xf
    s_nop 1
    v_add_f32_dpp v33, v33, v33 row_ror:4 row_mask:0xf bank_mask:0xf
    s_nop 1
    v_add_f32_dpp v33, v33, v33 row_ror:2 row_mask:0xf bank_mask:0xf
    s_nop 1
    v_add_f32_dpp v33, v33, v33 row_ror:1 row_mask:0xf bank_mask:0xf
    s_nop 1
    v_add_f32_dpp v33, v33, v33 row_bcast:15 row_mask:0xa bank_mask:0xf
    s_cbranch_scc1 L_gs_227
    buffer_store_dword v33, v34, s[40:43], s67 offen
L_gb_228:
    s_waitcnt vmcnt(1)
    s_branch L_se_218
.p2align 5
L_gr_230:
L_pad26:
    s_cbranch_execz L_padback
    s_cbranch_scc1 L_gw_229
    s_waitcnt vmcnt(0)
    v_max3_u32 v32, v12, v13, v14
    v_max3_u32 v32, v32, v15, v16
    v_max3_u32 v32, v32, v17, v18
    v_max3_u32 v32, v32, v19, v20
    v_max3_u32 v32, v32, v21, v22
    v_max3_u32 v32, v32, v23, v24
    v_max3_u32 v32, v32, v25, v26
    v_max_u32 v32, v32, v27
    v_cmp_eq_u32 vcc, -1, v32
    s_cbranch_vccnz L_gw_229
    v_pk_add_f32 v[28:29], v[12:13], v[36:37]
    v_pk_add_f32 v[30:31], v[14:15], v[38:39]
    v_pk_add_f32 v[28:29], v[28:29], v[16:17]
    v_pk_add_f32 v[30:31], v[30:31], v[18:19]
    v_pk_add_f32 v[28:29], v[28:29], v[20:21]
    v_pk_add_f32 v[30:31], v[30:31], v[22:23]
    v_pk_add_f32 v[28:29], v[28:29], v[24:25]
    v_pk_add_f32 v[30:31], v[30:31], v[26:27]
    s_nop 1
    v_permlane32_swap_b32 v28, v30
    v_permlane32_swap_b32 v29, v31
    s_branch L_gk_231
L_tail_end:
L_spread:
    s_add_u32 s62, s62, 966656
    s_cmp_eq_u32 s30, 5
    s_cbranch_scc0 L_skip_67
    v_mov_b64 v[12:13], -1
    v_mov_b64 v[14:15], -1
    v_lshlrev_b32 v16, 4, v0
    s_mul_i32 s57, s52, 2208
    s_add_u32 s57, s57, s62
    s_mov_b64 exec, 0x3ff
    buffer_store_dwordx4 v[12:15], v16, s[40:43], s57 offen offset:2048 sc1
    s_mov_b64 exec, -1
    buffer_store_dwordx4 v[12:15], v16, s[40:43], s57 offen offset:0 sc1
    buffer_store_dwordx4 v[12:15], v16, s[40:43], s57 offen offset:1024 sc1
L_skip_67:
    s_cmp_eq_u32 s30, 7
    s_cbranch_scc0 L_skip_68
    v_and_b32 v60, 31, v0
    v_cmp_gt_u32 s[64:65], 20, v60
    v_min_u32 v60, 19, v60
    v_lshrrev_b32 v35, 5, v0
    v_lshlrev_b32 v35, 2, v35
    v_add_u32 v35, 160832, v35
    v_lshl_add_u32 v35, v60, 3, v35
    s_mul_i32 s66, s53, 12416
    s_add_u32 s66, s66, s62
    s_add_u32 s66, s66, 70656
    s_add_u32 s67, s66, 12288
    s_lshl_b32 s57, s54, 3
    v_lshrrev_b32 v34, 5, v0
    v_lshlrev_b32 v34, 2, v34
    v_add_u32 v34, s57, v34
    v_and_b32 v60, 31, v0
    v_mov_b32 v61, 0x7f000000
    v_cmp_ne_u32 vcc, 31, v60
    s_nop 1
    v_cndmask_b32 v34, v34, v61, vcc
    v_mov_b32 v61, 0x3f803f80
    v_cvt_pk_bf16_f32 v28, v2, v3
L_skip_68:
    s_cmp_eq_u32 s30, 7
    s_cbranch_scc0 L_skip_69
    v_cndmask_b32 v29, 0, v28, s[64:65]
    v_dot2_f32_bf16 v33, v29, v61, 0
    v_dot2_f32_bf16 v32, v29, v29, 0
    v_lshlrev_b32 v2, 16, v28
    v_and_b32 v3, 0xffff0000, v28
    s_cmp_eq_u32 s55, 0
    v_permlane32_swap_b32 v33, v32
    v_add_f32 v33, v33, v32
    s_nop 1
    v_add_f32_dpp v33, v33, v33 row_ror:8 row_mask:0xf bank_mask:0xf
    s_nop 1
    v_add_f32_dpp v33, v33, v33 row_ror:4 row_mask:0xf bank_mask:0xf
    s_nop 1
    v_add_f32_dpp v33, v33, v33 row_ror:2 row_mask:0xf bank_mask:0xf
    s_nop 1
    v_add_f32_dpp v33, v33, v33 row_ror:1 row_mask:0xf bank_mask:0xf
    s_nop 1
    v_add_f32_dpp v33, v33, v33 row_bcast:15 row_mask:0xa bank_mask:0xf
    s_cbranch_scc1 L_gs_70
    buffer_store_dword v33, v34, s[40:43], s67 offen
L_gb_71:
    s_waitcnt vmcnt(1)
L_skip_69:
    s_cmp_lt_u32 s30, 6
    s_cbranch_scc0 L_skip_72
    s_lshr_b32 s57, s30, 1
    s_mul_i32 s57, s57, 1024
    s_and_b32 s58, s30, 1
    s_lshl_b32 s58, s58, 6
    s_add_u32 s57, s57, s58
    v_lshrrev_b32 v18, 5, v0
    v_mul_u32_u24 v18, 6144, v18
    v_bfe_u32 v60, v0, 3, 1
    v_mul_u32_u24 v60, 3072, v60
    v_add_u32 v18, v60, v18
    v_bfe_u32 v60, v0, 4, 1
    v_lshl_add_u32 v18, v60, 9, v18
    v_bfe_u32 v60, v0, 2, 1
    v_lshl_add_u32 v18, v60, 7, v18
    v_and_b32 v60, 3, v0
    v_lshl_add_u32 v18, v60, 3, v18
    v_add_u32 v18, s57, v18
    v_bfe_u32 v19, v0, 3, 1
    v_mul_u32_u24 v19, 3072, v19
    v_bfe_u32 v60, v0, 4, 1
    v_lshl_add_u32 v19, v60, 9, v19
    v_bfe_u32 v60, v0, 2, 1
    v_lshl_add_u32 v19, v60, 7, v19
    v_and_b32 v60, 3, v0
    v_lshl_add_u32 v19, v60, 3, v19
    v_lshrrev_b32 v60, 5, v0
    v_lshl_add_u32 v19, v60, 5, v19
    v_add_u32 v19, s57, v19
    v_add_u32 v19, 24576, v19
    ds_read_b64_tr_b16 v[28:29], v18 offset:0
    ds_read_b64_tr_b16 v[30:31], v18 offset:256
    ds_read_b64_tr_b16 v[32:33], v18 offset:12288
    ds_read_b64_tr_b16 v[34:35], v18 offset:12544
    ds_read_b64_tr_b16 v[36:37], v18 offset:32
    ds_read_b64_tr_b16 v[38:39], v18 offset:288
    ds_read_b64_tr_b16 v[40:41], v18 offset:12320
    ds_read_b64_tr_b16 v[42:43], v18 offset:12576
    ds_read_b64_tr_b16 v[24:25], v19 offset:0
    ds_read_b64_tr_b16 v[26:27], v19 offset:256
    v_lshrrev_b32 v49, 4, v0
    v_lshlrev_b32 v49, 5, v49
    v_bfe_u32 v60, v0, 1, 1
    v_lshl_add_u32 v49, v60, 4, v49
    v_bfe_u32 v60, v0, 3, 1
    v_mul_u32_u24 v60, 192, v60
    v_add_u32 v49, v60, v49
    v_add_u32 v49, 160832, v49
    v_bfe_u32 v50, v0, 1, 1
    v_lshlrev_b32 v50, 4, v50
    v_bfe_u32 v60, v0, 3, 1
    v_mul_u32_u24 v60, 192, v60
    v_add_u32 v50, v60, v50
    v_add_u32 v50, 160960, v50
    v_mov_b32 v60, 160992
    v_and_b32 v51, 5, v0
    v_cmp_eq_u32 vcc, 0, v51
    s_nop 1
    v_cndmask_b32 v52, v60, v49, vcc
    v_cmp_eq_u32 vcc, 4, v51
    s_nop 1
    v_cndmask_b32 v53, v60, v49, vcc
    v_lshrrev_b32 v49, 2, v0
    v_and_b32 v49, 12, v49
    v_cmp_eq_u32 vcc, v49, v51
    s_nop 1
    v_cndmask_b32 v48, v60, v50, vcc
    v_mov_b64 v[44:45], 0
    v_mov_b64 v[46:47], 0
    s_lshr_b32 s57, s30, 1
    s_lshl_b32 s57, s57, 11
    s_lshl_b32 s58, s58, 1
    s_add_u32 s57, s57, s58
    s_lshl_b32 s58, s54, 8
    s_add_u32 s57, s57, s58
    v_and_b32 v54, 31, v0
    v_lshlrev_b32 v54, 2, v54
    v_lshrrev_b32 v60, 5, v0
    v_mul_u32_u24 v60, 6144, v60
    v_add_u32 v54, v60, v54
    v_add_u32 v54, s57, v54
    s_mul_i32 s59, s53, 12416
    s_add_u32 s59, s59, s62
    s_add_u32 s59, s59, 70656
    s_add_u32 s60, s59, 12288
    ds_read_b128 v[12:15], v52
    ds_read_b128 v[16:19], v53
    ds_read_b128 v[20:23], v48
    s_waitcnt lgkmcnt(2)
    v_smfmac_f32_16x16x64_bf16 v[44:47], v[12:15], v[28:35], v1
    s_waitcnt lgkmcnt(1)
    v_smfmac_f32_16x16x64_bf16 v[44:47], v[16:19], v[36:43], v1
    s_waitcnt lgkmcnt(0)
    v_smfmac_f32_16x16x64_bf16 v[44:47], v[20:23], v[24:31], v1
    s_cmp_eq_u32 s55, 0
    s_nop 6
    v_add_f32 v12, v44, v46
    s_cbranch_scc1 L_gs_73
    buffer_store_dword v12, v54, s[40:43], s59 offen
L_gb_74:
L_skip_72:
    s_waitcnt vmcnt(0)
    s_barrier
    s_cmp_eq_u32 s30, 5
    s_cbranch_scc0 L_skip_75
    v_mov_b32 v25, 0
    s_lshl_b32 s57, s52, 2
    s_add_u32 s57, s57, s72
    s_mov_b64 exec, 1
    buffer_store_dword v25, v0, s[40:43], s57 offen offset:256 sc1
    s_mov_b64 exec, -1
    v_and_b32 v16, 31, v0
    v_lshlrev_b32 v16, 2, v16
.p2align 5
L_pr_77:
    buffer_load_dword v17, v16, s[40:43], s72 offen offset:256 sc1
    s_sub_u32 s56, s56, 1
    s_cbranch_scc1 L_done
L_pw_76:
    s_waitcnt vmcnt(0)
    v_cmp_eq_u32 vcc, -1, v17
    s_cbranch_vccnz L_pr_77
L_skip_75:
    s_barrier
    s_branch L_spread_back
.p2align 5
L_done:
L_exit:
    s_endpgm
.section .rodata,"a"
.p2align 6
.amdhsa_kernel interleave_layers__sliding_block_cached__dense_activation_gelu__decode_kernel
  .amdhsa_next_free_vgpr 256
  .amdhsa_next_free_sgpr 102
  .amdhsa_accum_offset 256
  .amdhsa_group_segment_fixed_size 0
  .amdhsa_kernarg_size 104
  .amdhsa_user_sgpr_count 2
  .amdhsa_user_sgpr_kernarg_segment_ptr 1
  .amdhsa_system_sgpr_workgroup_id_x 1
  .amdhsa_float_denorm_mode_32 3
.end_amdhsa_kernel
```

```asm
; @launch grid=(256,1,1) block=(512,1,1) lds=157120
.amdgcn_target "amdgcn-amd-amdhsa--gfx950"
.text
.fill 64, 4, 0xbf800000
.globl interleave_layers__sliding_block_cached__dense_activation_gelu__decode_kernel
.p2align 8
.type interleave_layers__sliding_block_cached__dense_activation_gelu__decode_kernel,@function
interleave_layers__sliding_block_cached__dense_activation_gelu__decode_kernel:
    s_load_dwordx16 s[4:19], s[0:1], 0
    s_cmp_ge_u32 s2, 256
    s_cbranch_scc1 L_exit
    v_lshrrev_b32 v5, 6, v0
    v_lshlrev_b32 v62, 6, v0
    v_readfirstlane_b32 s30, v5
    v_and_b32 v0, 63, v0
    s_getpc_b64 s[74:75]
L_pc:
    v_min_u32 v62, L_exit-L_pc, v62
    global_load_dword v63, v62, s[74:75]
    s_cmp_eq_u32 s30, 6
    s_cbranch_scc0 L_skip_1
    s_setprio 3
L_skip_1:
    s_and_b32 s31, s2, 7
    s_lshr_b32 s52, s2, 3
    s_and_b32 s53, s52, 3
    s_lshr_b32 s54, s52, 2
    s_lshl_b32 s73, s31, 2
    s_add_u32 s73, s73, s53
    v_lshrrev_b32 v8, 5, v0
    v_lshlrev_b32 v8, 2, v8
    v_bfe_u32 v60, v0, 4, 1
    v_lshl_add_u32 v8, v60, 0, v8
    v_and_b32 v9, 7, v0
    v_xor_b32 v8, v8, v9
    v_lshrrev_b32 v10, 3, v0
    v_mul_u32_u24 v10, 384, v10
    v_lshl_add_u32 v5, v8, 4, v10
    s_mul_i32 s64, s73, 12582912
    s_mul_i32 s58, s54, 3072
    s_add_u32 s64, s64, s58
    s_add_u32 s64, s64, 11008000
    s_sub_u32 s34, 1574912, s58
    s_mov_b32 s35, 0x20000
    s_mov_b32 s57, 2048
    s_mov_b32 s58, 1152
    s_mov_b32 s59, 256
    s_mov_b32 m0, 92160
    s_cmp_eq_u32 s30, 6
    s_cselect_b64 vcc, -1, 0
    s_waitcnt lgkmcnt(0)
    s_add_u32 s32, s6, s64
    s_addc_u32 s33, s7, 0
    s_load_dwordx8 s[20:27], s[0:1], 64
    s_load_dwordx2 s[28:29], s[0:1], 96
    s_cbranch_vccz L_skip_3
L_dma_2:
    buffer_load_dwordx4 v5, s[32:35], s57 offen offset:0 nt lds
    buffer_load_dwordx4 v5, s[32:35], s58 offen offset:1024 nt lds
    buffer_load_dwordx4 v5, s[32:35], s59 offen offset:2048 nt lds
    s_add_u32 s57, s57, 24576
    s_add_u32 s58, s58, 24576
    s_add_u32 s59, s59, 24576
    s_add_u32 m0, m0, 3072
    s_cmp_lg_u32 m0, 104448
    s_cbranch_scc1 L_dma_2
    s_mov_b32 s57, 100352
    s_mov_b32 s58, 99456
    s_mov_b32 s59, 98560
    s_mov_b32 m0, 104448
L_dma_4:
    s_nop 0
    buffer_load_dwordx4 v5, s[32:35], s57 offen offset:0 nt lds
    buffer_load_dwordx4 v5, s[32:35], s58 offen offset:1024 nt lds
    buffer_load_dwordx4 v5, s[32:35], s59 offen offset:2048 nt lds
    s_add_u32 s57, s57, 24576
    s_add_u32 s58, s58, 24576
    s_add_u32 s59, s59, 24576
    s_add_u32 m0, m0, 3072
    s_cmp_lg_u32 m0, 116736
    s_cbranch_scc1 L_dma_4
L_skip_3:
    s_add_u32 s36, s8, s64
    s_addc_u32 s37, s9, 0
    s_mov_b32 s38, s34
    s_mov_b32 s39, 0x20000
    s_mul_i32 s3, s54, 3
    s_add_u32 s3, s3, s53
    s_cmp_eq_u32 s53, 3
    s_cselect_b32 s3, 31, s3
    v_lshrrev_b32 v8, 4, v0
    v_lshlrev_b32 v8, 1, v8
    v_xor_b32 v8, v8, v9
    v_lshl_add_u32 v7, v8, 4, v10
    v_lshrrev_b32 v2, 3, v0
    v_mul_u32_u24 v2, 12288, v2
    v_and_b32 v60, 7, v0
    v_lshl_add_u32 v2, v60, 4, v2
    s_mul_i32 s59, s73, 384
    s_mul_i32 s60, s54, 983040
    s_add_u32 s59, s59, s60
    s_sub_u32 s60, 7866368, s59
    s_and_b32 s61, s30, 1
    s_mul_i32 s61, s61, 3072
    s_lshr_b32 s9, s30, 1
    s_add_u32 s61, s61, 92160
    s_mul_i32 s62, s31, 120832
    s_add_u32 s62, s62, 299008
    s_lshl_b32 s72, s31, 9
    s_add_u32 s72, s72, 294912
    s_mov_b32 s56, 65536
    s_mov_b32 s55, 1
    s_getreg_b32 s63, hwreg(20, 0, 3)
    v_mov_b32 v3, 0
    v_mov_b32 v4, 0
    v_mov_b32 v11, 0
    v_mov_b32 v24, 0
    v_mov_b32 v34, 0
    v_mov_b64 v[12:13], -1
    v_mov_b64 v[14:15], -1
    v_lshlrev_b32 v10, 4, v0
    s_waitcnt lgkmcnt(0)
    s_mov_b32 s40, s28
    s_mov_b32 s41, s29
    s_mov_b32 s42, 2232320
    s_mov_b32 s43, 0x20000
    s_add_u32 s44, s10, s59
    s_addc_u32 s45, s11, 0
    s_mov_b32 s46, s60
    s_mov_b32 s47, 0x20000
    s_sub_u32 s44, s44, 2048
    s_subb_u32 s45, s45, 0
    s_cmp_lt_u32 s3, 20
    s_cselect_b32 s57, 7864320, 0
    s_add_u32 s58, s54, 1
    s_mul_i32 s58, s58, 245760
    s_cmp_lg_u32 s53, 3
    s_cselect_b64 s[48:49], s[12:13], s[16:17]
    s_cselect_b32 s50, s57, s58
    s_mov_b32 s51, 0x20000
    s_add_u32 s57, s28, 0
    s_sub_u32 s57, 0, s57
    s_and_b32 s57, s57, 0x3fff
    s_add_u32 s57, s57, 0
    s_lshr_b32 s58, s31, 1
    s_lshl_b32 s58, s58, 14
    s_add_u32 s6, s57, s58
    s_and_b32 s58, s31, 1
    s_lshl_b32 s58, s58, 12
    s_add_u32 s6, s6, s58
    s_lshl_b32 s58, s3, 7
    s_add_u32 s6, s6, s58
    s_mov_b32 s8, s57
    s_and_b32 s59, s3, 3
    s_lshl_b32 s58, s31, 2
    s_add_u32 s59, s59, s58
    s_lshl_b32 s59, s59, 7
    s_add_u32 s59, s59, s57
    s_add_u32 s59, s59, 262144
    s_add_u32 s10, s28, s59
    s_addc_u32 s11, s29, 0
    s_lshr_b32 s58, s63, 2
    s_xor_b32 s58, s58, 0
    s_mul_i32 s58, s58, 8192
    s_add_u32 s7, s57, s58
    s_cmp_eq_u32 s30, 5
    s_cbranch_scc0 L_skip_5
    s_cmp_eq_u32 s52, 31
    s_cbranch_scc0 L_skip_6
    s_mov_b64 exec, 0xffffff
    buffer_store_dwordx4 v[12:15], v10, s[40:43], s72 offen sc1
    s_mov_b64 exec, -1
L_skip_6:
    s_cmp_lt_u32 s3, 20
    s_cbranch_scc0 L_skip_7
    v_and_b32 v16, 7, v0
    v_lshlrev_b32 v16, 4, v16
    v_bfe_u32 v17, v0, 3, 1
    v_lshl_add_u32 v16, v17, 13, v16
    v_lshrrev_b32 v17, 4, v0
    v_mul_u32_u24 v17, 66048, v17
    v_add_u32 v16, v17, v16
    buffer_store_dwordx4 v[12:15], v16, s[40:43], s6 offen sc1
L_skip_7:
    s_cmp_eq_u32 s3, 20
    s_cbranch_scc0 L_skip_8
    s_lshl_b32 s58, s31, 9
    s_add_u32 s58, s58, s8
    s_add_u32 s58, s58, 266240
    v_and_b32 v16, 7, v0
    v_lshlrev_b32 v16, 4, v16
    v_bfe_u32 v60, v0, 3, 1
    v_lshl_add_u32 v16, v60, 13, v16
    v_lshrrev_b32 v60, 4, v0
    v_lshl_add_u32 v16, v60, 28, v16
    buffer_store_dwordx4 v[12:15], v16, s[40:43], s58 offen sc1
L_skip_8:
    s_sub_u32 s58, s3, 20
    s_cmp_lt_u32 s58, 4
    s_cselect_b32 s59, s59, 0x7f000000
    v_and_b32 v16, 7, v0
    v_lshlrev_b32 v16, 4, v16
    v_bfe_u32 v60, v0, 3, 1
    v_lshl_add_u32 v16, v60, 13, v16
    v_lshrrev_b32 v60, 4, v0
    v_lshl_add_u32 v16, v60, 28, v16
    buffer_store_dwordx4 v[12:15], v16, s[40:43], s59 offen sc1
    s_mul_i32 s57, s52, 2208
    s_add_u32 s57, s57, s62
    s_mov_b64 exec, 0x3ff
    buffer_store_dwordx4 v[12:15], v10, s[40:43], s57 offen offset:2048
    s_mov_b64 exec, -1
    buffer_store_dwordx4 v[12:15], v10, s[40:43], s57 offen offset:0
    buffer_store_dwordx4 v[12:15], v10, s[40:43], s57 offen offset:1024
    s_mov_b64 exec, -1
    v_lshlrev_b32 v16, 4, v0
    v_add_u32 v16, 155648, v16
    ds_write_b128 v16, v[12:15]
    v_and_b32 v3, 7, v0
    v_lshlrev_b32 v3, 5, v3
L_skip_5:
    s_cmp_eq_u32 s30, 7
    s_cbranch_scc0 L_skip_9
    v_and_b32 v60, 31, v0
    v_min_u32 v60, 19, v60
    s_mul_i32 s57, s54, 160
    v_lshrrev_b32 v16, 5, v0
    v_lshlrev_b32 v16, 2, v16
    v_add_u32 v16, s57, v16
    v_lshl_add_u32 v16, v60, 3, v16
    global_load_dword v28, v16, s[4:5]
    global_load_dword v4, v16, s[22:23]
L_skip_9:
    s_sub_u32 s58, s30, 4
    s_cmp_lt_u32 s58, 3
    s_cbranch_scc0 L_skip_10
    s_mul_i32 s57, s31, 3
    s_add_u32 s57, s57, s58
    s_lshl_b32 s57, s57, 7
    v_and_b32 v16, 15, v0
    v_lshlrev_b32 v16, 3, v16
    v_lshrrev_b32 v60, 4, v0
    v_lshl_add_u32 v16, v60, 1, v16
    v_add_u32 v16, s57, v16
    global_load_short_d16_hi v4, v16, s[18:19]
L_skip_10:
    v_bfe_u32 v8, v0, 3, 1
    v_lshlrev_b32 v8, 2, v8
    v_bfe_u32 v60, v0, 1, 1
    v_lshl_add_u32 v8, v60, 0, v8
    v_lshrrev_b32 v9, 4, v0
    v_xor_b32 v9, v8, v9
    v_bfe_u32 v8, v0, 2, 1
    v_mul_u32_u24 v8, 6144, v8
    v_bfe_u32 v60, v0, 3, 1
    v_lshl_add_u32 v8, v60, 9, v8
    v_and_b32 v60, 3, v0
    v_lshl_add_u32 v8, v60, 7, v8
    v_add_u32 v8, s61, v8
    v_lshl_add_u32 v8, v9, 4, v8
    v_xor_b32 v9, 64, v8
    v_bfe_u32 v1, v0, 1, 1
    v_mul_u32_u24 v1, 43690, v1
    v_add_u32 v1, 17476, v1
    s_cmp_eq_u32 s30, 6
    s_cbranch_scc0 L_skip_11
    s_mov_b32 s57, 2048
    s_mov_b32 s58, 1152
    s_mov_b32 s59, 256
    s_mov_b32 m0, 0
L_dma_12:
    s_waitcnt vmcnt(22)
    buffer_load_dwordx4 v2, s[44:47], s57 offen offset:0 nt lds
    buffer_load_dwordx4 v2, s[44:47], s58 offen offset:1024 nt lds
    buffer_load_dwordx4 v2, s[44:47], s59 offen offset:2048 nt lds
    s_add_u32 s57, s57, 98304
    s_add_u32 s58, s58, 98304
    s_add_u32 s59, s59, 98304
    s_add_u32 m0, m0, 3072
    s_cmp_lg_u32 m0, 15360
    s_cbranch_scc1 L_dma_12
L_skip_11:
    s_cmp_eq_u32 s9, 3
    s_waitcnt vmcnt(27)
    s_barrier
    s_cbranch_scc0 L_skip_13
    ds_read_b128 v[64:67], v8 offset:0
    ds_read_b128 v[68:71], v9 offset:0
    ds_read_b128 v[72:75], v8 offset:1024
    ds_read_b128 v[76:79], v9 offset:1024
    ds_read_b128 v[80:83], v8 offset:2048
    ds_read_b128 v[84:87], v9 offset:2048
L_skip_13:
    s_cmp_eq_u32 s30, 6
    s_cbranch_scc0 L_skip_14
    s_mov_b32 s57, 198656
    s_mov_b32 s58, 197760
    s_mov_b32 s59, 196864
    s_mov_b32 m0, 116736
L_dma_15:
    s_waitcnt vmcnt(22)
    buffer_load_dwordx4 v5, s[32:35], s57 offen offset:0 nt lds
    buffer_load_dwordx4 v5, s[32:35], s58 offen offset:1024 nt lds
    buffer_load_dwordx4 v5, s[32:35], s59 offen offset:2048 nt lds
    s_add_u32 s57, s57, 24576
    s_add_u32 s58, s58, 24576
    s_add_u32 s59, s59, 24576
    s_add_u32 m0, m0, 3072
    s_cmp_lg_u32 m0, 129024
    s_cbranch_scc1 L_dma_15
L_skip_14:
    s_waitcnt lgkmcnt(0)
    s_cmp_eq_u32 s30, 5
    s_cbranch_scc0 L_skip_16
    s_cmp_eq_u32 s52, 31
    s_cbranch_scc0 L_skip_17
    s_lshl_b32 s57, s31, 5
    v_mov_b32 v16, s57
    s_add_u32 s57, s63, 1
    v_mov_b32 v12, s57
    s_waitcnt vmcnt(5)
    s_mov_b64 exec, 0x1
    global_store_dword v16, v12, s[26:27] sc1
    s_mov_b64 exec, -1
L_skip_17:
L_skip_16:
    s_cmp_eq_u32 s9, 3
    s_waitcnt vmcnt(27)
    s_barrier
    s_cbranch_scc0 L_skip_18
    ds_read_b128 v[88:91], v8 offset:12288
    ds_read_b128 v[92:95], v9 offset:12288
    ds_read_b128 v[96:99], v8 offset:13312
    ds_read_b128 v[100:103], v9 offset:13312
    ds_read_b128 v[104:107], v8 offset:14336
    ds_read_b128 v[108:111], v9 offset:14336
L_skip_18:
    s_cmp_eq_u32 s30, 6
    s_cbranch_scc0 L_skip_19
    s_mov_b32 s57, 296960
    s_mov_b32 s58, 296064
    s_mov_b32 s59, 295168
    s_mov_b32 m0, 129024
L_dma_20:
    s_waitcnt vmcnt(22)
    buffer_load_dwordx4 v5, s[32:35], s57 offen offset:0 nt lds
    buffer_load_dwordx4 v5, s[32:35], s58 offen offset:1024 nt lds
    buffer_load_dwordx4 v5, s[32:35], s59 offen offset:2048 nt lds
    s_add_u32 s57, s57, 24576
    s_add_u32 s58, s58, 24576
    s_add_u32 s59, s59, 24576
    s_add_u32 m0, m0, 3072
    s_cmp_lg_u32 m0, 141312
    s_cbranch_scc1 L_dma_20
    s_mov_b32 s57, 493568
    s_mov_b32 s58, 492672
    s_mov_b32 s59, 491776
    s_mov_b32 m0, 15360
L_dma_21:
    s_waitcnt vmcnt(22)
    buffer_load_dwordx4 v2, s[44:47], s57 offen offset:0 nt lds
    buffer_load_dwordx4 v2, s[44:47], s58 offen offset:1024 nt lds
    buffer_load_dwordx4 v2, s[44:47], s59 offen offset:2048 nt lds
    s_add_u32 s57, s57, 98304
    s_add_u32 s58, s58, 98304
    s_add_u32 s59, s59, 98304
    s_add_u32 m0, m0, 3072
    s_cmp_lg_u32 m0, 30720
    s_cbranch_scc1 L_dma_21
L_skip_19:
    s_waitcnt lgkmcnt(0)
    s_cmp_lt_u32 s30, 4
    s_cbranch_scc0 L_skip_22
    s_mov_b64 exec, 0
    s_cmp_eq_u32 s30, 1
    s_cbranch_scc1 L_pad1
    s_cmp_eq_u32 s30, 2
    s_cbranch_scc1 L_pad2
    s_cmp_eq_u32 s30, 3
    s_cbranch_scc1 L_pad3
    s_branch L_pad0
.p2align 5
L_padback:
    s_mov_b64 exec, -1
L_skip_22:
    s_cmp_eq_u32 s9, 0
    s_waitcnt vmcnt(27)
    s_barrier
    s_cbranch_scc0 L_skip_23
    ds_read_b128 v[64:67], v8 offset:24576
    ds_read_b128 v[68:71], v9 offset:24576
    ds_read_b128 v[72:75], v8 offset:25600
    ds_read_b128 v[76:79], v9 offset:25600
    ds_read_b128 v[80:83], v8 offset:26624
    ds_read_b128 v[84:87], v9 offset:26624
L_skip_23:
    s_cmp_eq_u32 s30, 6
    s_cbranch_scc0 L_skip_24
    s_mov_b32 s57, 395264
    s_mov_b32 s58, 394368
    s_mov_b32 s59, 393472
    s_mov_b32 m0, 141312
L_dma_25:
    s_waitcnt vmcnt(22)
    buffer_load_dwordx4 v5, s[32:35], s57 offen offset:0 nt lds
    buffer_load_dwordx4 v5, s[32:35], s58 offen offset:1024 nt lds
    buffer_load_dwordx4 v5, s[32:35], s59 offen offset:2048 nt lds
    s_add_u32 s57, s57, 24576
    s_add_u32 s58, s58, 24576
    s_add_u32 s59, s59, 24576
    s_add_u32 m0, m0, 3072
    s_cmp_lg_u32 m0, 153600
    s_cbranch_scc1 L_dma_25
L_skip_24:
    s_waitcnt lgkmcnt(0)
    s_cmp_eq_u32 s9, 0
    s_waitcnt vmcnt(27)
    s_barrier
    s_cbranch_scc0 L_skip_26
    ds_read_b128 v[88:91], v8 offset:36864
    ds_read_b128 v[92:95], v9 offset:36864
    ds_read_b128 v[96:99], v8 offset:37888
    ds_read_b128 v[100:103], v9 offset:37888
    ds_read_b128 v[104:107], v8 offset:38912
    ds_read_b128 v[108:111], v9 offset:38912
L_skip_26:
    s_cmp_eq_u32 s30, 6
    s_cbranch_scc0 L_skip_27
    s_cmp_lg_u32 s53, 3
    s_cbranch_scc0 L_wb_28
    s_mul_i32 s57, s31, 983040
    s_lshl_b32 s58, s3, 6
    s_add_u32 s57, s57, s58
    v_bfe_u32 v38, v0, 4, 1
    v_lshlrev_b32 v38, 1, v38
    v_xor_b32 v38, v38, v0
    v_and_b32 v38, 3, v38
    v_lshrrev_b32 v3, 5, v0
    v_mul_u32_u24 v3, 10240, v3
    v_bfe_u32 v39, v0, 4, 1
    v_mul_u32_u24 v39, 2560, v39
    v_add_u32 v3, v39, v3
    v_bfe_u32 v39, v0, 3, 1
    v_mul_u32_u24 v39, 5120, v39
    v_add_u32 v3, v39, v3
    v_bfe_u32 v39, v0, 2, 1
    v_mul_u32_u24 v39, 20480, v39
    v_add_u32 v3, v39, v3
    v_add_u32 v3, s57, v3
    v_lshl_add_u32 v3, v38, 4, v3
    s_mov_b32 s14, 40960
    s_mov_b32 s15, 256
    s_branch L_we_29
.p2align 5
L_wb_28:
    s_mul_i32 s57, s31, 384
    s_mul_i32 s58, s54, 245760
    s_add_u32 s57, s57, s58
    v_lshlrev_b32 v3, 4, v0
    v_add_u32 v3, s57, v3
    v_mov_b32 v38, 2688
    v_cmp_lt_u32 vcc, 23, v0
    s_nop 1
    v_cndmask_b32 v38, 0, v38, vcc
    v_add_u32 v3, v38, v3
    v_mov_b32 v38, 0x7f000000
    v_cmp_lt_u32 vcc, 47, v0
    s_nop 1
    v_cndmask_b32 v3, v3, v38, vcc
    s_mov_b32 s14, 12288
    s_mov_b32 s15, 5120
L_we_29:
    s_mul_i32 s57, s14, 0
    s_mov_b32 m0, 30720
    s_nop 0
    buffer_load_dwordx4 v3, s[48:51], s57 offen offset:0 nt lds
    s_mov_b32 s57, 493568
    s_mov_b32 s58, 492672
    s_mov_b32 s59, 491776
    s_mov_b32 m0, 92160
L_dma_30:
    s_waitcnt vmcnt(22)
    buffer_load_dwordx4 v5, s[32:35], s57 offen offset:0 nt lds
    buffer_load_dwordx4 v5, s[32:35], s58 offen offset:1024 nt lds
    buffer_load_dwordx4 v5, s[32:35], s59 offen offset:2048 nt lds
    s_add_u32 s57, s57, 24576
    s_add_u32 s58, s58, 24576
    s_add_u32 s59, s59, 24576
    s_add_u32 m0, m0, 3072
    s_cmp_lg_u32 m0, 104448
    s_cbranch_scc1 L_dma_30
    s_mul_i32 s57, s14, 0
    s_add_u32 s57, s57, s15
    s_mov_b32 m0, 30720
    s_nop 0
    buffer_load_dwordx4 v3, s[48:51], s57 offen offset:1024 nt lds
    s_mov_b32 s57, 591872
    s_mov_b32 s58, 590976
    s_mov_b32 s59, 590080
    s_mov_b32 m0, 104448
L_dma_31:
    s_waitcnt vmcnt(22)
    buffer_load_dwordx4 v5, s[32:35], s57 offen offset:0 nt lds
    buffer_load_dwordx4 v5, s[32:35], s58 offen offset:1024 nt lds
    buffer_load_dwordx4 v5, s[32:35], s59 offen offset:2048 nt lds
    s_add_u32 s57, s57, 24576
    s_add_u32 s58, s58, 24576
    s_add_u32 s59, s59, 24576
    s_add_u32 m0, m0, 3072
    s_cmp_lg_u32 m0, 116736
    s_cbranch_scc1 L_dma_31
L_skip_27:
    s_waitcnt lgkmcnt(0)
    s_cmp_lt_u32 s30, 5
    s_cbranch_scc0 L_skip_32
    s_waitcnt vmcnt(0)
L_skip_32:
    s_cmp_eq_u32 s30, 7
    s_cbranch_scc0 L_skip_33
    v_and_b32 v60, 31, v0
    v_cmp_gt_u32 s[64:65], 20, v60
    v_min_u32 v60, 19, v60
    v_lshrrev_b32 v35, 5, v0
    v_lshlrev_b32 v35, 2, v35
    v_add_u32 v35, 156736, v35
    v_lshl_add_u32 v35, v60, 3, v35
    s_mul_i32 s66, s53, 12416
    s_add_u32 s66, s66, s62
    s_add_u32 s66, s66, 70656
    s_add_u32 s67, s66, 12288
    s_lshl_b32 s57, s54, 3
    v_lshrrev_b32 v34, 5, v0
    v_lshlrev_b32 v34, 2, v34
    v_add_u32 v34, s57, v34
    v_and_b32 v60, 31, v0
    v_mov_b32 v61, 0x7f000000
    v_cmp_ne_u32 vcc, 31, v60
    s_nop 1
    v_cndmask_b32 v34, v34, v61, vcc
    v_mov_b32 v61, 0x3f803f80
    s_waitcnt vmcnt(0)
    ds_write_b32 v35, v28
    s_waitcnt lgkmcnt(0)
L_skip_33:
    s_cmp_eq_u32 s30, 5
    s_cbranch_scc0 L_skip_34
    s_waitcnt vmcnt(0)
    s_lshr_b32 s67, s63, 2
    s_sub_u32 s58, s3, 20
    s_cmp_lt_u32 s58, 4
    s_cbranch_scc0 L_skip_35
    s_mov_b32 s67, 0
    s_load_dword s66, s[10:11], 0
    s_load_dword s67, s[10:11], 8192
    s_waitcnt lgkmcnt(1)
L_skip_35:
    v_subrev_u32 v16, 8, v0
    v_cmp_gt_u32 vcc, 40, v16
    v_mov_b32 v16, 0x3f803f80
    s_nop 0
    v_cndmask_b32 v18, 0, v16, vcc
    v_min_u32 v16, 55, v0
    v_lshlrev_b32 v16, 2, v16
    v_add_u32 v16, 156896, v16
    ds_write_b32 v16, v18
    s_mov_b32 s65, s67
    s_waitcnt lgkmcnt(0)
L_skip_34:
    s_cmp_eq_u32 s9, 1
    s_waitcnt vmcnt(26)
    s_barrier
    s_cbranch_scc0 L_skip_36
    ds_read_b128 v[64:67], v8 offset:49152
    ds_read_b128 v[68:71], v9 offset:49152
    ds_read_b128 v[72:75], v8 offset:50176
    ds_read_b128 v[76:79], v9 offset:50176
    ds_read_b128 v[80:83], v8 offset:51200
    ds_read_b128 v[84:87], v9 offset:51200
L_skip_36:
    s_cmp_eq_u32 s30, 6
    s_cbranch_scc0 L_skip_37
    s_mul_i32 s57, s14, 1
    s_mov_b32 m0, 32768
    s_nop 0
    buffer_load_dwordx4 v3, s[48:51], s57 offen offset:0 nt lds
    s_mov_b32 s57, 690176
    s_mov_b32 s58, 689280
    s_mov_b32 s59, 688384
    s_mov_b32 m0, 116736
L_dma_38:
    s_waitcnt vmcnt(22)
    buffer_load_dwordx4 v5, s[32:35], s57 offen offset:0 nt lds
    buffer_load_dwordx4 v5, s[32:35], s58 offen offset:1024 nt lds
    buffer_load_dwordx4 v5, s[32:35], s59 offen offset:2048 nt lds
    s_add_u32 s57, s57, 24576
    s_add_u32 s58, s58, 24576
    s_add_u32 s59, s59, 24576
    s_add_u32 m0, m0, 3072
    s_cmp_lg_u32 m0, 129024
    s_cbranch_scc1 L_dma_38
L_skip_37:
    s_waitcnt lgkmcnt(0)
    s_cmp_eq_u32 s30, 7
    s_cbranch_scc0 L_skip_39
    v_cndmask_b32 v29, 0, v28, s[64:65]
    v_dot2_f32_bf16 v33, v29, v61, 0
    v_dot2_f32_bf16 v32, v29, v29, 0
    v_lshlrev_b32 v2, 16, v28
    v_and_b32 v3, 0xffff0000, v28
    s_cmp_eq_u32 s55, 0
    v_permlane32_swap_b32 v33, v32
    v_add_f32 v33, v33, v32
    s_nop 1
    v_add_f32_dpp v33, v33, v33 row_ror:8 row_mask:0xf bank_mask:0xf
    s_nop 1
    v_add_f32_dpp v33, v33, v33 row_ror:4 row_mask:0xf bank_mask:0xf
    s_nop 1
    v_add_f32_dpp v33, v33, v33 row_ror:2 row_mask:0xf bank_mask:0xf
    s_nop 1
    v_add_f32_dpp v33, v33, v33 row_ror:1 row_mask:0xf bank_mask:0xf
    s_nop 1
    v_add_f32_dpp v33, v33, v33 row_bcast:15 row_mask:0xa bank_mask:0xf
    s_cbranch_scc1 L_gs_40
    buffer_store_dword v33, v34, s[40:43], s67 offen
L_gb_41:
    s_waitcnt vmcnt(1)
L_skip_39:
    s_cmp_lt_u32 s30, 6
    s_cbranch_scc0 L_skip_42
    s_lshr_b32 s57, s30, 1
    s_mul_i32 s57, s57, 1024
    s_and_b32 s58, s30, 1
    s_lshl_b32 s58, s58, 6
    s_add_u32 s57, s57, s58
    v_lshrrev_b32 v18, 5, v0
    v_mul_u32_u24 v18, 6144, v18
    v_bfe_u32 v60, v0, 3, 1
    v_mul_u32_u24 v60, 3072, v60
    v_add_u32 v18, v60, v18
    v_bfe_u32 v60, v0, 4, 1
    v_lshl_add_u32 v18, v60, 9, v18
    v_bfe_u32 v60, v0, 2, 1
    v_lshl_add_u32 v18, v60, 7, v18
    v_and_b32 v60, 3, v0
    v_lshl_add_u32 v18, v60, 3, v18
    v_add_u32 v18, s57, v18
    v_bfe_u32 v19, v0, 3, 1
    v_mul_u32_u24 v19, 3072, v19
    v_bfe_u32 v60, v0, 4, 1
    v_lshl_add_u32 v19, v60, 9, v19
    v_bfe_u32 v60, v0, 2, 1
    v_lshl_add_u32 v19, v60, 7, v19
    v_and_b32 v60, 3, v0
    v_lshl_add_u32 v19, v60, 3, v19
    v_lshrrev_b32 v60, 5, v0
    v_lshl_add_u32 v19, v60, 5, v19
    v_add_u32 v19, s57, v19
    v_add_u32 v19, 24576, v19
    ds_read_b64_tr_b16 v[28:29], v18 offset:0
    ds_read_b64_tr_b16 v[30:31], v18 offset:256
    ds_read_b64_tr_b16 v[32:33], v18 offset:12288
    ds_read_b64_tr_b16 v[34:35], v18 offset:12544
    ds_read_b64_tr_b16 v[36:37], v18 offset:32
    ds_read_b64_tr_b16 v[38:39], v18 offset:288
    ds_read_b64_tr_b16 v[40:41], v18 offset:12320
    ds_read_b64_tr_b16 v[42:43], v18 offset:12576
    ds_read_b64_tr_b16 v[24:25], v19 offset:0
    ds_read_b64_tr_b16 v[26:27], v19 offset:256
    v_lshrrev_b32 v49, 4, v0
    v_lshlrev_b32 v49, 5, v49
    v_bfe_u32 v60, v0, 1, 1
    v_lshl_add_u32 v49, v60, 4, v49
    v_bfe_u32 v60, v0, 3, 1
    v_mul_u32_u24 v60, 192, v60
    v_add_u32 v49, v60, v49
    v_add_u32 v49, 156736, v49
    v_bfe_u32 v50, v0, 1, 1
    v_lshlrev_b32 v50, 4, v50
    v_bfe_u32 v60, v0, 3, 1
    v_mul_u32_u24 v60, 192, v60
    v_add_u32 v50, v60, v50
    v_add_u32 v50, 156864, v50
    v_mov_b32 v60, 156896
    v_and_b32 v51, 5, v0
    v_cmp_eq_u32 vcc, 0, v51
    s_nop 1
    v_cndmask_b32 v52, v60, v49, vcc
    v_cmp_eq_u32 vcc, 4, v51
    s_nop 1
    v_cndmask_b32 v53, v60, v49, vcc
    v_lshrrev_b32 v49, 2, v0
    v_and_b32 v49, 12, v49
    v_cmp_eq_u32 vcc, v49, v51
    s_nop 1
    v_cndmask_b32 v48, v60, v50, vcc
    v_mov_b64 v[44:45], 0
    v_mov_b64 v[46:47], 0
    s_lshr_b32 s57, s30, 1
    s_lshl_b32 s57, s57, 11
    s_lshl_b32 s58, s58, 1
    s_add_u32 s57, s57, s58
    s_lshl_b32 s58, s54, 8
    s_add_u32 s57, s57, s58
    v_and_b32 v54, 31, v0
    v_lshlrev_b32 v54, 2, v54
    v_lshrrev_b32 v60, 5, v0
    v_mul_u32_u24 v60, 6144, v60
    v_add_u32 v54, v60, v54
    v_add_u32 v54, s57, v54
    s_mul_i32 s59, s53, 12416
    s_add_u32 s59, s59, s62
    s_add_u32 s59, s59, 70656
    s_add_u32 s60, s59, 12288
    ds_read_b128 v[12:15], v52
    ds_read_b128 v[16:19], v53
    ds_read_b128 v[20:23], v48
    s_waitcnt lgkmcnt(2)
    v_smfmac_f32_16x16x64_bf16 v[44:47], v[12:15], v[28:35], v1
    s_waitcnt lgkmcnt(1)
    v_smfmac_f32_16x16x64_bf16 v[44:47], v[16:19], v[36:43], v1
    s_waitcnt lgkmcnt(0)
    v_smfmac_f32_16x16x64_bf16 v[44:47], v[20:23], v[24:31], v1
    s_cmp_eq_u32 s55, 0
    s_nop 6
    v_add_f32 v12, v44, v46
    s_cbranch_scc1 L_gs_43
    buffer_store_dword v12, v54, s[40:43], s59 offen
L_gb_44:
L_skip_42:
    s_cmp_eq_u32 s30, 5
    s_cbranch_scc0 L_skip_45
    global_load_dword v2, v3, s[26:27] sc1
L_skip_45:
    s_cmp_eq_u32 s9, 1
    s_waitcnt vmcnt(26)
    s_barrier
    s_cbranch_scc0 L_skip_46
    ds_read_b128 v[88:91], v8 offset:0
    ds_read_b128 v[92:95], v9 offset:0
    ds_read_b128 v[96:99], v8 offset:1024
    ds_read_b128 v[100:103], v9 offset:1024
    ds_read_b128 v[104:107], v8 offset:2048
    ds_read_b128 v[108:111], v9 offset:2048
L_skip_46:
    s_cmp_eq_u32 s30, 6
    s_cbranch_scc0 L_skip_47
    s_mul_i32 s57, s14, 1
    s_add_u32 s57, s57, s15
    s_mov_b32 m0, 32768
    s_nop 0
    buffer_load_dwordx4 v3, s[48:51], s57 offen offset:1024 nt lds
    s_mov_b32 s57, 788480
    s_mov_b32 s58, 787584
    s_mov_b32 s59, 786688
    s_mov_b32 m0, 129024
L_dma_48:
    s_waitcnt vmcnt(22)
    buffer_load_dwordx4 v5, s[32:35], s57 offen offset:0 nt lds
    buffer_load_dwordx4 v5, s[32:35], s58 offen offset:1024 nt lds
    buffer_load_dwordx4 v5, s[32:35], s59 offen offset:2048 nt lds
    s_add_u32 s57, s57, 24576
    s_add_u32 s58, s58, 24576
    s_add_u32 s59, s59, 24576
    s_add_u32 m0, m0, 3072
    s_cmp_lg_u32 m0, 141312
    s_cbranch_scc1 L_dma_48
L_skip_47:
    s_waitcnt lgkmcnt(0)
    s_cmp_eq_u32 s9, 2
    s_waitcnt vmcnt(26)
    s_barrier
    s_cbranch_scc0 L_skip_49
    ds_read_b128 v[64:67], v8 offset:12288
    ds_read_b128 v[68:71], v9 offset:12288
    ds_read_b128 v[72:75], v8 offset:13312
    ds_read_b128 v[76:79], v9 offset:13312
    ds_read_b128 v[80:83], v8 offset:14336
    ds_read_b128 v[84:87], v9 offset:14336
L_skip_49:
    s_cmp_eq_u32 s30, 6
    s_cbranch_scc0 L_skip_50
    s_mul_i32 s57, s14, 2
    s_mov_b32 m0, 34816
    s_nop 0
    buffer_load_dwordx4 v3, s[48:51], s57 offen offset:0 nt lds
    s_mov_b32 s57, 886784
    s_mov_b32 s58, 885888
    s_mov_b32 s59, 884992
    s_mov_b32 m0, 141312
L_dma_51:
    s_waitcnt vmcnt(22)
    buffer_load_dwordx4 v5, s[32:35], s57 offen offset:0 nt lds
    buffer_load_dwordx4 v5, s[32:35], s58 offen offset:1024 nt lds
    buffer_load_dwordx4 v5, s[32:35], s59 offen offset:2048 nt lds
    s_add_u32 s57, s57, 24576
    s_add_u32 s58, s58, 24576
    s_add_u32 s59, s59, 24576
    s_add_u32 m0, m0, 3072
    s_cmp_lg_u32 m0, 153600
    s_cbranch_scc1 L_dma_51
L_skip_50:
    s_waitcnt lgkmcnt(0)
    s_cmp_eq_u32 s9, 2
    s_waitcnt vmcnt(26)
    s_barrier
    s_cbranch_scc0 L_skip_52
    ds_read_b128 v[88:91], v8 offset:24576
    ds_read_b128 v[92:95], v9 offset:24576
    ds_read_b128 v[96:99], v8 offset:25600
    ds_read_b128 v[100:103], v9 offset:25600
    ds_read_b128 v[104:107], v8 offset:26624
    ds_read_b128 v[108:111], v9 offset:26624
L_skip_52:
    s_cmp_eq_u32 s30, 6
    s_cbranch_scc0 L_skip_53
    s_mul_i32 s57, s14, 2
    s_add_u32 s57, s57, s15
    s_mov_b32 m0, 34816
    s_nop 0
    buffer_load_dwordx4 v3, s[48:51], s57 offen offset:1024 nt lds
    s_mov_b32 s57, 985088
    s_mov_b32 s58, 984192
    s_mov_b32 s59, 983296
    s_mov_b32 m0, 92160
L_dma_54:
    s_waitcnt vmcnt(22)
    buffer_load_dwordx4 v5, s[32:35], s57 offen offset:0 nt lds
    buffer_load_dwordx4 v5, s[32:35], s58 offen offset:1024 nt lds
    buffer_load_dwordx4 v5, s[32:35], s59 offen offset:2048 nt lds
    s_add_u32 s57, s57, 24576
    s_add_u32 s58, s58, 24576
    s_add_u32 s59, s59, 24576
    s_add_u32 m0, m0, 3072
    s_cmp_lg_u32 m0, 104448
    s_cbranch_scc1 L_dma_54
L_skip_53:
    s_waitcnt lgkmcnt(0)
    s_cmp_lg_u32 s30, 6
    s_cbranch_scc0 L_skip_55
    s_waitcnt vmcnt(0)
L_skip_55:
    s_cmp_eq_u32 s9, 3
    s_waitcnt vmcnt(26)
    s_barrier
    s_cbranch_scc0 L_skip_56
    ds_read_b128 v[112:115], v8 offset:36864
    ds_read_b128 v[116:119], v9 offset:36864
    ds_read_b128 v[120:123], v8 offset:37888
    ds_read_b128 v[124:127], v9 offset:37888
    ds_read_b128 v[128:131], v8 offset:38912
    ds_read_b128 v[132:135], v9 offset:38912
L_skip_56:
    s_cmp_eq_u32 s30, 6
    s_cbranch_scc0 L_skip_57
    s_mul_i32 s57, s14, 3
    s_mov_b32 m0, 36864
    s_nop 0
    buffer_load_dwordx4 v3, s[48:51], s57 offen offset:0 nt lds
    s_mov_b32 s57, 1083392
    s_mov_b32 s58, 1082496
    s_mov_b32 s59, 1081600
    s_mov_b32 m0, 104448
L_dma_58:
    s_waitcnt vmcnt(22)
    buffer_load_dwordx4 v5, s[32:35], s57 offen offset:0 nt lds
    buffer_load_dwordx4 v5, s[32:35], s58 offen offset:1024 nt lds
    buffer_load_dwordx4 v5, s[32:35], s59 offen offset:2048 nt lds
    s_add_u32 s57, s57, 24576
    s_add_u32 s58, s58, 24576
    s_add_u32 s59, s59, 24576
    s_add_u32 m0, m0, 3072
    s_cmp_lg_u32 m0, 116736
    s_cbranch_scc1 L_dma_58
L_skip_57:
    s_waitcnt lgkmcnt(0)
    s_cmp_eq_u32 s30, 5
    s_cbranch_scc0 L_skip_59
L_cw_60:
    v_readlane_b32 s57, v2, s31
    s_cmp_eq_u32 s57, 0
    s_cbranch_scc1 L_cr_61
    s_lshr_b32 s58, s63, 2
    s_xor_b32 s58, s58, s65
    s_and_b32 s58, s58, 1
    v_mov_b32 v25, s58
    s_sub_u32 s57, s57, 1
    s_cmp_eq_u32 s57, s63
    s_cselect_b32 s64, 1, 0
    s_cbranch_scc0 L_far_62
    s_lshl_b32 s57, s52, 2
    s_add_u32 s57, s57, s72
    s_mov_b64 exec, 1
    buffer_store_dword v25, v0, s[40:43], s57 offen offset:0
    s_mov_b64 exec, -1
L_fb_63:
L_skip_59:
    s_cmp_eq_u32 s9, 3
    s_waitcnt vmcnt(26)
    s_barrier
    s_cbranch_scc0 L_skip_64
    ds_read_b128 v[136:139], v8 offset:49152
    ds_read_b128 v[140:143], v9 offset:49152
    ds_read_b128 v[144:147], v8 offset:50176
    ds_read_b128 v[148:151], v9 offset:50176
    ds_read_b128 v[152:155], v8 offset:51200
    ds_read_b128 v[156:159], v9 offset:51200
L_skip_64:
    s_cmp_eq_u32 s30, 6
    s_cbranch_scc0 L_skip_65
    s_mul_i32 s57, s14, 3
    s_add_u32 s57, s57, s15
    s_mov_b32 m0, 36864
    s_nop 0
    buffer_load_dwordx4 v3, s[48:51], s57 offen offset:1024 nt lds
    s_mov_b32 s57, 1181696
    s_mov_b32 s58, 1180800
    s_mov_b32 s59, 1179904
    s_mov_b32 m0, 116736
L_dma_66:
    s_waitcnt vmcnt(22)
    buffer_load_dwordx4 v5, s[32:35], s57 offen offset:0 nt lds
    buffer_load_dwordx4 v5, s[32:35], s58 offen offset:1024 nt lds
    buffer_load_dwordx4 v5, s[32:35], s59 offen offset:2048 nt lds
    s_add_u32 s57, s57, 24576
    s_add_u32 s58, s58, 24576
    s_add_u32 s59, s59, 24576
    s_add_u32 m0, m0, 3072
    s_cmp_lg_u32 m0, 129024
    s_cbranch_scc1 L_dma_66
L_skip_65:
    s_waitcnt lgkmcnt(0)
    s_cmp_eq_u32 s9, 0
    s_waitcnt vmcnt(26)
    s_barrier
    s_cbranch_scc0 L_skip_67
    ds_read_b128 v[112:115], v8 offset:0
    ds_read_b128 v[116:119], v9 offset:0
    ds_read_b128 v[120:123], v8 offset:1024
    ds_read_b128 v[124:127], v9 offset:1024
    ds_read_b128 v[128:131], v8 offset:2048
    ds_read_b128 v[132:135], v9 offset:2048
L_skip_67:
    s_cmp_eq_u32 s30, 6
    s_cbranch_scc0 L_skip_68
    s_mul_i32 s57, s14, 4
    s_mov_b32 m0, 38912
    s_nop 0
    buffer_load_dwordx4 v3, s[48:51], s57 offen offset:0 nt lds
    s_mov_b32 s57, 1280000
    s_mov_b32 s58, 1279104
    s_mov_b32 s59, 1278208
    s_mov_b32 m0, 129024
L_dma_69:
    s_waitcnt vmcnt(22)
    buffer_load_dwordx4 v5, s[32:35], s57 offen offset:0 nt lds
    buffer_load_dwordx4 v5, s[32:35], s58 offen offset:1024 nt lds
    buffer_load_dwordx4 v5, s[32:35], s59 offen offset:2048 nt lds
    s_add_u32 s57, s57, 24576
    s_add_u32 s58, s58, 24576
    s_add_u32 s59, s59, 24576
    s_add_u32 m0, m0, 3072
    s_cmp_lg_u32 m0, 141312
    s_cbranch_scc1 L_dma_69
L_skip_68:
    s_waitcnt lgkmcnt(0)
    s_cmp_eq_u32 s9, 0
    s_waitcnt vmcnt(26)
    s_barrier
    s_cbranch_scc0 L_skip_70
    ds_read_b128 v[136:139], v8 offset:12288
    ds_read_b128 v[140:143], v9 offset:12288
    ds_read_b128 v[144:147], v8 offset:13312
    ds_read_b128 v[148:151], v9 offset:13312
    ds_read_b128 v[152:155], v8 offset:14336
    ds_read_b128 v[156:159], v9 offset:14336
L_skip_70:
    s_cmp_eq_u32 s30, 6
    s_cbranch_scc0 L_skip_71
    s_mul_i32 s57, s14, 4
    s_add_u32 s57, s57, s15
    s_mov_b32 m0, 38912
    s_nop 0
    buffer_load_dwordx4 v3, s[48:51], s57 offen offset:1024 nt lds
    s_mov_b32 s57, 1378304
    s_mov_b32 s58, 1377408
    s_mov_b32 s59, 1376512
    s_mov_b32 m0, 141312
L_dma_72:
    s_waitcnt vmcnt(22)
    buffer_load_dwordx4 v5, s[32:35], s57 offen offset:0 nt lds
    buffer_load_dwordx4 v5, s[32:35], s58 offen offset:1024 nt lds
    buffer_load_dwordx4 v5, s[32:35], s59 offen offset:2048 nt lds
    s_add_u32 s57, s57, 24576
    s_add_u32 s58, s58, 24576
    s_add_u32 s59, s59, 24576
    s_add_u32 m0, m0, 3072
    s_cmp_lg_u32 m0, 153600
    s_cbranch_scc1 L_dma_72
L_skip_71:
    s_waitcnt lgkmcnt(0)
    s_cmp_eq_u32 s30, 5
    s_cbranch_scc0 L_skip_73
    v_lshlrev_b32 v24, 2, v0
    buffer_load_dword v2, v24, s[40:43], s72 offen sc1
L_skip_73:
    s_cmp_eq_u32 s9, 1
    s_waitcnt vmcnt(26)
    s_barrier
    s_cbranch_scc0 L_skip_74
    ds_read_b128 v[112:115], v8 offset:24576
    ds_read_b128 v[116:119], v9 offset:24576
    ds_read_b128 v[120:123], v8 offset:25600
    ds_read_b128 v[124:127], v9 offset:25600
    ds_read_b128 v[128:131], v8 offset:26624
    ds_read_b128 v[132:135], v9 offset:26624
L_skip_74:
    s_cmp_eq_u32 s30, 6
    s_cbranch_scc0 L_skip_75
    s_mul_i32 s57, s14, 5
    s_mov_b32 m0, 40960
    s_nop 0
    buffer_load_dwordx4 v3, s[48:51], s57 offen offset:0 nt lds
    s_mov_b32 s57, 1476608
    s_mov_b32 s58, 1475712
    s_mov_b32 s59, 1474816
    s_mov_b32 m0, 92160
L_dma_76:
    s_waitcnt vmcnt(22)
    buffer_load_dwordx4 v5, s[32:35], s57 offen offset:0 nt lds
    buffer_load_dwordx4 v5, s[32:35], s58 offen offset:1024 nt lds
    buffer_load_dwordx4 v5, s[32:35], s59 offen offset:2048 nt lds
    s_add_u32 s57, s57, 24576
    s_add_u32 s58, s58, 24576
    s_add_u32 s59, s59, 24576
    s_add_u32 m0, m0, 3072
    s_cmp_lg_u32 m0, 104448
    s_cbranch_scc1 L_dma_76
L_skip_75:
    s_waitcnt lgkmcnt(0)
    s_cmp_eq_u32 s9, 1
    s_waitcnt vmcnt(26)
    s_barrier
    s_cbranch_scc0 L_skip_77
    ds_read_b128 v[136:139], v8 offset:36864
    ds_read_b128 v[140:143], v9 offset:36864
    ds_read_b128 v[144:147], v8 offset:37888
    ds_read_b128 v[148:151], v9 offset:37888
    ds_read_b128 v[152:155], v8 offset:38912
    ds_read_b128 v[156:159], v9 offset:38912
L_skip_77:
    s_cmp_eq_u32 s30, 6
    s_cbranch_scc0 L_skip_78
    s_mul_i32 s57, s14, 5
    s_add_u32 s57, s57, s15
    s_mov_b32 m0, 40960
    s_nop 0
    buffer_load_dwordx4 v3, s[48:51], s57 offen offset:1024 nt lds
    s_mov_b32 s57, 2048
    s_mov_b32 s58, 1152
    s_mov_b32 s59, 256
    s_mov_b32 s60, 24576
    s_mov_b32 m0, 104448
L_dma_79:
    s_waitcnt vmcnt(22)
    buffer_load_dwordx4 v7, s[36:39], s57 offen offset:0 nt lds
    buffer_load_dwordx4 v7, s[36:39], s58 offen offset:1024 nt lds
    buffer_load_dwordx4 v7, s[36:39], s59 offen offset:2048 nt lds
    s_add_u32 s57, s57, s60
    s_add_u32 s58, s58, s60
    s_add_u32 s59, s59, s60
    s_xor_b32 s60, s60, 81920
    s_add_u32 m0, m0, 3072
    s_cmp_lg_u32 m0, 116736
    s_cbranch_scc1 L_dma_79
L_skip_78:
    s_waitcnt lgkmcnt(0)
    s_cmp_eq_u32 s9, 2
    s_waitcnt vmcnt(26)
    s_barrier
    s_cbranch_scc0 L_skip_80
    ds_read_b128 v[112:115], v8 offset:49152
    ds_read_b128 v[116:119], v9 offset:49152
    ds_read_b128 v[120:123], v8 offset:50176
    ds_read_b128 v[124:127], v9 offset:50176
    ds_read_b128 v[128:131], v8 offset:51200
    ds_read_b128 v[132:135], v9 offset:51200
L_skip_80:
    s_cmp_eq_u32 s30, 6
    s_cbranch_scc0 L_skip_81
    s_mul_i32 s57, s14, 6
    s_mov_b32 m0, 43008
    s_nop 0
    buffer_load_dwordx4 v3, s[48:51], s57 offen offset:0 nt lds
    s_mov_b32 s57, 51200
    s_mov_b32 s58, 50304
    s_mov_b32 s59, 49408
    s_mov_b32 s60, 24576
    s_mov_b32 m0, 116736
L_dma_82:
    s_waitcnt vmcnt(22)
    buffer_load_dwordx4 v7, s[36:39], s57 offen offset:0 nt lds
    buffer_load_dwordx4 v7, s[36:39], s58 offen offset:1024 nt lds
    buffer_load_dwordx4 v7, s[36:39], s59 offen offset:2048 nt lds
    s_add_u32 s57, s57, s60
    s_add_u32 s58, s58, s60
    s_add_u32 s59, s59, s60
    s_xor_b32 s60, s60, 81920
    s_add_u32 m0, m0, 3072
    s_cmp_lg_u32 m0, 129024
    s_cbranch_scc1 L_dma_82
L_skip_81:
    s_waitcnt lgkmcnt(0)
    s_cmp_eq_u32 s30, 5
    s_cbranch_scc0 L_skip_83
L_cw_84:
    s_waitcnt vmcnt(0)
    v_cmp_ne_u32 vcc, -1, v2
    s_mov_b32 s57, 0
    s_mov_b32 s68, 2
    s_cmp_eq_u32 s64, 0
    s_cbranch_scc1 L_cd_86
    s_cmp_lg_u32 vcc_hi, 0
    s_cbranch_scc1 L_cd_86
    s_cmp_lg_u32 vcc_lo, -1
    s_cbranch_scc1 L_cr_85
    v_cmp_eq_u32 vcc, 1, v2
    s_bcnt1_i32_b32 s68, vcc_lo
    s_mov_b32 s57, 1
L_cd_86:
    v_mov_b32 v37, 156672
    v_mov_b32 v38, s57
    ds_write_b32 v37, v38
    s_waitcnt lgkmcnt(0)
L_skip_83:
    s_cmp_eq_u32 s9, 2
    s_waitcnt vmcnt(26)
    s_barrier
    s_cbranch_scc0 L_skip_87
    ds_read_b128 v[136:139], v8 offset:0
    ds_read_b128 v[140:143], v9 offset:0
    ds_read_b128 v[144:147], v8 offset:1024
    ds_read_b128 v[148:151], v9 offset:1024
    ds_read_b128 v[152:155], v8 offset:2048
    ds_read_b128 v[156:159], v9 offset:2048
L_skip_87:
    s_cmp_eq_u32 s30, 6
    s_cbranch_scc0 L_skip_88
    s_mul_i32 s57, s14, 6
    s_add_u32 s57, s57, s15
    s_mov_b32 m0, 43008
    s_nop 0
    buffer_load_dwordx4 v3, s[48:51], s57 offen offset:1024 nt lds
    s_mov_b32 s57, 198656
    s_mov_b32 s58, 197760
    s_mov_b32 s59, 196864
    s_mov_b32 s60, 24576
    s_mov_b32 m0, 129024
L_dma_89:
    s_waitcnt vmcnt(22)
    buffer_load_dwordx4 v7, s[36:39], s57 offen offset:0 nt lds
    buffer_load_dwordx4 v7, s[36:39], s58 offen offset:1024 nt lds
    buffer_load_dwordx4 v7, s[36:39], s59 offen offset:2048 nt lds
    s_add_u32 s57, s57, s60
    s_add_u32 s58, s58, s60
    s_add_u32 s59, s59, s60
    s_xor_b32 s60, s60, 81920
    s_add_u32 m0, m0, 3072
    s_cmp_lg_u32 m0, 141312
    s_cbranch_scc1 L_dma_89
L_skip_88:
    s_waitcnt lgkmcnt(0)
    v_lshrrev_b32 v8, 5, v0
    v_mul_u32_u24 v8, 6144, v8
    v_bfe_u32 v60, v0, 2, 3
    v_lshl_add_u32 v8, v60, 7, v8
    v_bfe_u32 v60, v0, 3, 2
    v_lshl_add_u32 v8, v60, 5, v8
    v_and_b32 v60, 3, v0
    v_lshl_add_u32 v8, v60, 3, v8
    v_add_u32 v8, s61, v8
    v_xor_b32 v9, 32, v8
    v_xor_b32 v10, 64, v8
    v_xor_b32 v11, 96, v8
    v_mov_b32 v41, 156672
    ds_read_b32 v42, v41
    s_waitcnt lgkmcnt(0)
    v_readfirstlane_b32 s55, v42
    s_cmp_eq_u32 s55, 0
    s_cbranch_scc1 L_spread
L_spread_back:
    s_cmp_eq_u32 s30, 5
    s_cbranch_scc0 L_skip_101
    s_cmp_eq_u32 s52, 31
    s_cbranch_scc0 L_skip_102
    s_lshl_b32 s57, s31, 5
    v_mov_b32 v16, s57
    s_add_u32 s57, s68, 1
    v_mov_b32 v12, s57
    s_mov_b64 exec, 0x1
    global_store_dword v16, v12, s[26:27] offset:4 sc1
    s_mov_b64 exec, -1
L_skip_102:
L_skip_101:
    s_sub_u32 s58, s30, 1
    s_cmp_lt_u32 s58, 3
    s_cbranch_scc0 L_skip_103
    s_mul_i32 s59, s53, 12416
    s_add_u32 s59, s59, s62
    s_add_u32 s59, s59, 70656
    s_add_u32 s60, s59, 12288
    s_lshl_b32 s57, s58, 11
    v_lshlrev_b32 v48, 4, v0
    v_add_u32 v48, s57, v48
    v_and_b32 v49, 7, v0
    v_lshlrev_b32 v49, 3, v49
    s_add_u32 s57, s59, 6144
    buffer_load_dwordx4 v[12:15], v48, s[40:43], s59 offen offset:0 sc1 nt
    buffer_load_dwordx4 v[16:19], v48, s[40:43], s59 offen offset:1024 sc1 nt
    buffer_load_dwordx4 v[28:31], v48, s[40:43], s57 offen offset:0 sc1 nt
    buffer_load_dwordx4 v[32:35], v48, s[40:43], s57 offen offset:1024 sc1 nt
    buffer_load_dwordx2 v[24:25], v49, s[40:43], s60 offen sc1 nt
L_skip_103:
    s_cmp_eq_u32 s9, 3
    s_waitcnt vmcnt(26)
    s_barrier
    s_cbranch_scc0 L_skip_104
    ds_read_b64_tr_b16 v[160:161], v8 offset:12288
    ds_read_b64_tr_b16 v[168:169], v9 offset:12288
    ds_read_b64_tr_b16 v[176:177], v10 offset:12288
    ds_read_b64_tr_b16 v[184:185], v11 offset:12288
    ds_read_b64_tr_b16 v[192:193], v8 offset:13312
    ds_read_b64_tr_b16 v[200:201], v9 offset:13312
    ds_read_b64_tr_b16 v[208:209], v10 offset:13312
    ds_read_b64_tr_b16 v[216:217], v11 offset:13312
    ds_read_b64_tr_b16 v[224:225], v8 offset:14336
    ds_read_b64_tr_b16 v[232:233], v9 offset:14336
    ds_read_b64_tr_b16 v[240:241], v10 offset:14336
    ds_read_b64_tr_b16 v[248:249], v11 offset:14336
L_skip_104:
    s_cmp_eq_u32 s30, 6
    s_cbranch_scc0 L_skip_105
    s_mul_i32 s57, s14, 7
    s_mov_b32 m0, 45056
    s_nop 0
    buffer_load_dwordx4 v3, s[48:51], s57 offen offset:0 nt lds
    s_mov_b32 s57, 247808
    s_mov_b32 s58, 246912
    s_mov_b32 s59, 246016
    s_mov_b32 s60, 24576
    s_mov_b32 m0, 141312
L_dma_106:
    s_waitcnt vmcnt(22)
    buffer_load_dwordx4 v7, s[36:39], s57 offen offset:0 nt lds
    buffer_load_dwordx4 v7, s[36:39], s58 offen offset:1024 nt lds
    buffer_load_dwordx4 v7, s[36:39], s59 offen offset:2048 nt lds
    s_add_u32 s57, s57, s60
    s_add_u32 s58, s58, s60
    s_add_u32 s59, s59, s60
    s_xor_b32 s60, s60, 81920
    s_add_u32 m0, m0, 3072
    s_cmp_lg_u32 m0, 153600
    s_cbranch_scc1 L_dma_106
L_skip_105:
    s_waitcnt lgkmcnt(0)
    s_cmp_eq_u32 s9, 3
    s_waitcnt vmcnt(26)
    s_barrier
    s_cbranch_scc0 L_skip_107
    ds_read_b64_tr_b16 v[162:163], v8 offset:24576
    ds_read_b64_tr_b16 v[170:171], v9 offset:24576
    ds_read_b64_tr_b16 v[178:179], v10 offset:24576
    ds_read_b64_tr_b16 v[186:187], v11 offset:24576
    ds_read_b64_tr_b16 v[194:195], v8 offset:25600
    ds_read_b64_tr_b16 v[202:203], v9 offset:25600
    ds_read_b64_tr_b16 v[210:211], v10 offset:25600
    ds_read_b64_tr_b16 v[218:219], v11 offset:25600
    ds_read_b64_tr_b16 v[226:227], v8 offset:26624
    ds_read_b64_tr_b16 v[234:235], v9 offset:26624
    ds_read_b64_tr_b16 v[242:243], v10 offset:26624
    ds_read_b64_tr_b16 v[250:251], v11 offset:26624
L_skip_107:
    s_cmp_eq_u32 s30, 6
    s_cbranch_scc0 L_skip_108
    s_mul_i32 s57, s14, 7
    s_add_u32 s57, s57, s15
    s_mov_b32 m0, 45056
    s_nop 0
    buffer_load_dwordx4 v3, s[48:51], s57 offen offset:1024 nt lds
    s_mov_b32 s57, 395264
    s_mov_b32 s58, 394368
    s_mov_b32 s59, 393472
    s_mov_b32 s60, 24576
    s_mov_b32 m0, 92160
L_dma_109:
    s_waitcnt vmcnt(22)
    buffer_load_dwordx4 v7, s[36:39], s57 offen offset:0 nt lds
    buffer_load_dwordx4 v7, s[36:39], s58 offen offset:1024 nt lds
    buffer_load_dwordx4 v7, s[36:39], s59 offen offset:2048 nt lds
    s_add_u32 s57, s57, s60
    s_add_u32 s58, s58, s60
    s_add_u32 s59, s59, s60
    s_xor_b32 s60, s60, 81920
    s_add_u32 m0, m0, 3072
    s_cmp_lg_u32 m0, 104448
    s_cbranch_scc1 L_dma_109
L_skip_108:
    s_waitcnt lgkmcnt(0)
    s_cmp_eq_u32 s9, 0
    s_waitcnt vmcnt(26)
    s_barrier
    s_cbranch_scc0 L_skip_110
    ds_read_b64_tr_b16 v[160:161], v8 offset:36864
    ds_read_b64_tr_b16 v[168:169], v9 offset:36864
    ds_read_b64_tr_b16 v[176:177], v10 offset:36864
    ds_read_b64_tr_b16 v[184:185], v11 offset:36864
    ds_read_b64_tr_b16 v[192:193], v8 offset:37888
    ds_read_b64_tr_b16 v[200:201], v9 offset:37888
    ds_read_b64_tr_b16 v[208:209], v10 offset:37888
    ds_read_b64_tr_b16 v[216:217], v11 offset:37888
    ds_read_b64_tr_b16 v[224:225], v8 offset:38912
    ds_read_b64_tr_b16 v[232:233], v9 offset:38912
    ds_read_b64_tr_b16 v[240:241], v10 offset:38912
    ds_read_b64_tr_b16 v[248:249], v11 offset:38912
L_skip_110:
    s_cmp_eq_u32 s30, 6
    s_cbranch_scc0 L_skip_111
    s_mul_i32 s57, s14, 8
    s_mov_b32 m0, 47104
    s_nop 0
    buffer_load_dwordx4 v3, s[48:51], s57 offen offset:0 nt lds
    s_mov_b32 s57, 444416
    s_mov_b32 s58, 443520
    s_mov_b32 s59, 442624
    s_mov_b32 s60, 24576
    s_mov_b32 m0, 104448
L_dma_112:
    s_waitcnt vmcnt(22)
    buffer_load_dwordx4 v7, s[36:39], s57 offen offset:0 nt lds
    buffer_load_dwordx4 v7, s[36:39], s58 offen offset:1024 nt lds
    buffer_load_dwordx4 v7, s[36:39], s59 offen offset:2048 nt lds
    s_add_u32 s57, s57, s60
    s_add_u32 s58, s58, s60
    s_add_u32 s59, s59, s60
    s_xor_b32 s60, s60, 81920
    s_add_u32 m0, m0, 3072
    s_cmp_lg_u32 m0, 116736
    s_cbranch_scc1 L_dma_112
L_skip_111:
    s_waitcnt lgkmcnt(0)
    s_sub_u32 s58, s30, 1
    s_cmp_lt_u32 s58, 3
    s_cbranch_scc0 L_skip_113
    s_lshl_b32 s57, s58, 7
    v_bfe_u32 v51, v0, 2, 2
    v_lshlrev_b32 v51, 5, v51
    v_lshrrev_b32 v60, 5, v0
    v_lshl_add_u32 v51, v60, 4, v51
    v_and_b32 v60, 3, v0
    v_lshl_add_u32 v51, v60, 2, v51
    v_bfe_u32 v60, v0, 4, 1
    v_lshl_add_u32 v51, v60, 1, v51
    v_add_u32 v51, s57, v51
    v_add_u32 v51, 153600, v51
    v_mov_b32 v60, 0x3c75e03e
    v_mov_b32 v61, 0x3a71d1e6
    v_mov_b32 v47, 0x3e13985d
    s_waitcnt vmcnt(0)
    v_pk_add_f32 v[36:37], v[28:29], v[32:33]
    v_pk_add_f32 v[38:39], v[30:31], v[34:35]
    s_nop 1
    v_permlane32_swap_b32 v36, v38
    v_permlane32_swap_b32 v37, v39
    v_pk_add_f32 v[36:37], v[36:37], v[38:39]
    s_nop 1
    v_permlane16_swap_b32 v36, v37
    v_add_f32 v36, v36, v37
    v_mul_f32 v6, 0x3dd53b95, v36
    v_add_f32_dpp v48, v24, v24 row_ror:4 row_mask:0xf bank_mask:0xf
    v_add_f32_dpp v49, v25, v25 row_ror:4 row_mask:0xf bank_mask:0xf
    v_pk_add_f32 v[20:21], v[12:13], v[16:17]
    v_pk_add_f32 v[22:23], v[14:15], v[18:19]
    v_add_f32_dpp v48, v48, v48 row_ror:2 row_mask:0xf bank_mask:0xf
    v_add_f32_dpp v49, v49, v49 row_ror:2 row_mask:0xf bank_mask:0xf
    v_permlane32_swap_b32 v20, v22
    v_permlane32_swap_b32 v21, v23
    v_add_f32_dpp v48, v48, v48 row_ror:1 row_mask:0xf bank_mask:0xf
    v_add_f32_dpp v49, v49, v49 row_ror:1 row_mask:0xf bank_mask:0xf
    v_pk_add_f32 v[20:21], v[20:21], v[22:23]
    v_mul_f32 v48, v48, v60
    v_fma_f32 v49, v49, v47, v61
    v_permlane16_swap_b32 v20, v21
    v_fma_f32 v49, -v48, v48, v49
    v_add_f32 v20, v20, v21
    v_max_f32 v49, v49, v61
    v_mul_f32 v50, v6, v48
    v_rsq_f32 v49, v49
    v_cmp_u_f32 vcc, v20, v20
    v_sub_f32 v20, v20, v50
    v_mul_f32 v20, v20, v49
    v_cvt_pk_bf16_f32 v20, v20, v20
    ds_write_b16 v51, v20
    s_waitcnt lgkmcnt(0)
L_skip_113:
    s_lshl_b32 s57, s30, 7
    s_add_u32 s57, s57, 154624
    v_lshrrev_b32 v58, 4, v0
    v_lshlrev_b32 v58, 5, v58
    v_bfe_u32 v60, v0, 1, 1
    v_lshl_add_u32 v58, v60, 4, v58
    v_bfe_u32 v60, v0, 2, 2
    v_lshl_add_u32 v58, v60, 2, v58
    v_and_b32 v60, 1, v0
    v_lshl_add_u32 v58, v60, 1, v58
    v_add_u32 v58, s57, v58
    v_lshrrev_b32 v61, 4, v0
    v_lshlrev_b32 v61, 5, v61
    v_bfe_u32 v60, v0, 1, 1
    v_lshl_add_u32 v61, v60, 4, v61
    v_add_u32 v61, s57, v61
    v_bfe_u32 v62, v0, 2, 2
    v_lshlrev_b32 v62, 1, v62
    v_and_b32 v60, 1, v0
    v_lshl_add_u32 v62, v60, 0, v62
    v_mov_b32 v60, 156896
    v_cmp_eq_u32 vcc, 0, v62
    s_nop 1
    v_cndmask_b32 v52, v60, v61, vcc
    v_cmp_eq_u32 vcc, 1, v62
    s_nop 1
    v_cndmask_b32 v53, v60, v61, vcc
    v_cmp_eq_u32 vcc, 2, v62
    s_nop 1
    v_cndmask_b32 v54, v60, v61, vcc
    v_cmp_eq_u32 vcc, 3, v62
    s_nop 1
    v_cndmask_b32 v55, v60, v61, vcc
    v_cmp_eq_u32 vcc, 4, v62
    s_nop 1
    v_cndmask_b32 v56, v60, v61, vcc
    v_cmp_eq_u32 vcc, 5, v62
    s_nop 1
    v_cndmask_b32 v57, v60, v61, vcc
    s_lshl_b32 s58, s30, 2
    s_add_u32 s58, s58, 155648
    v_mov_b32 v60, s58
    v_lshlrev_b32 v59, 2, v0
    v_add_u32 v59, 154112, v59
    v_cmp_eq_u32 vcc, 63, v0
    s_nop 1
    v_cndmask_b32 v59, v59, v60, vcc
    v_and_b32 v62, 7, v0
    v_lshlrev_b32 v62, 2, v62
    v_add_u32 v62, 155648, v62
    s_lshl_b32 s57, s30, 10
    v_lshlrev_b32 v63, 4, v0
    v_add_u32 v63, s57, v63
    v_add_u32 v63, 79872, v63
    s_cmp_eq_u32 s9, 0
    s_waitcnt vmcnt(26)
    s_barrier
    s_cbranch_scc0 L_skip_114
    ds_read_b64_tr_b16 v[162:163], v8 offset:49152
    ds_read_b64_tr_b16 v[170:171], v9 offset:49152
    ds_read_b64_tr_b16 v[178:179], v10 offset:49152
    ds_read_b64_tr_b16 v[186:187], v11 offset:49152
    ds_read_b64_tr_b16 v[194:195], v8 offset:50176
    ds_read_b64_tr_b16 v[202:203], v9 offset:50176
    ds_read_b64_tr_b16 v[210:211], v10 offset:50176
    ds_read_b64_tr_b16 v[218:219], v11 offset:50176
    ds_read_b64_tr_b16 v[226:227], v8 offset:51200
    ds_read_b64_tr_b16 v[234:235], v9 offset:51200
    ds_read_b64_tr_b16 v[242:243], v10 offset:51200
    ds_read_b64_tr_b16 v[250:251], v11 offset:51200
L_skip_114:
    s_cmp_eq_u32 s30, 6
    s_cbranch_scc0 L_skip_115
    s_mul_i32 s57, s14, 8
    s_add_u32 s57, s57, s15
    s_mov_b32 m0, 47104
    s_nop 0
    buffer_load_dwordx4 v3, s[48:51], s57 offen offset:1024 nt lds
    s_mov_b32 s57, 591872
    s_mov_b32 s58, 590976
    s_mov_b32 s59, 590080
    s_mov_b32 s60, 24576
    s_mov_b32 m0, 116736
L_dma_116:
    s_nop 0
    buffer_load_dwordx4 v7, s[36:39], s57 offen offset:0 nt lds
    buffer_load_dwordx4 v7, s[36:39], s58 offen offset:1024 nt lds
    buffer_load_dwordx4 v7, s[36:39], s59 offen offset:2048 nt lds
    s_add_u32 s57, s57, s60
    s_add_u32 s58, s58, s60
    s_add_u32 s59, s59, s60
    s_xor_b32 s60, s60, 81920
    s_add_u32 m0, m0, 3072
    s_cmp_lg_u32 m0, 129024
    s_cbranch_scc1 L_dma_116
    s_mul_i32 s57, s14, 9
    s_mov_b32 m0, 49152
    s_nop 0
    buffer_load_dwordx4 v3, s[48:51], s57 offen offset:0 nt lds
    s_mov_b32 s57, 641024
    s_mov_b32 s58, 640128
    s_mov_b32 s59, 639232
    s_mov_b32 s60, 24576
    s_mov_b32 m0, 129024
L_dma_117:
    s_nop 0
    buffer_load_dwordx4 v7, s[36:39], s57 offen offset:0 nt lds
    buffer_load_dwordx4 v7, s[36:39], s58 offen offset:1024 nt lds
    buffer_load_dwordx4 v7, s[36:39], s59 offen offset:2048 nt lds
    s_add_u32 s57, s57, s60
    s_add_u32 s58, s58, s60
    s_add_u32 s59, s59, s60
    s_xor_b32 s60, s60, 81920
    s_add_u32 m0, m0, 3072
    s_cmp_lg_u32 m0, 141312
    s_cbranch_scc1 L_dma_117
L_skip_115:
    s_waitcnt lgkmcnt(0)
    v_lshrrev_b32 v5, 4, v0
    v_lshlrev_b32 v5, 5, v5
    v_bfe_u32 v60, v0, 1, 1
    v_lshl_add_u32 v5, v60, 4, v5
    v_add_u32 v5, 153600, v5
    ds_read_b128 v[12:15], v5 offset:0
    ds_read_b128 v[16:19], v5 offset:128
    ds_read_b128 v[20:23], v5 offset:256
    v_mov_b64 v[24:25], 0
    v_mov_b64 v[26:27], 0
    v_mov_b64 v[28:29], 0
    v_mov_b64 v[30:31], 0
    v_mov_b64 v[32:33], 0
    v_mov_b64 v[34:35], 0
    v_mov_b64 v[36:37], 0
    v_mov_b64 v[38:39], 0
    v_mov_b64 v[40:41], 0
    v_mov_b64 v[42:43], 0
    v_mov_b64 v[44:45], 0
    v_mov_b64 v[46:47], 0
    s_waitcnt lgkmcnt(0)
    v_smfmac_f32_16x16x64_bf16 v[24:27], v[12:15], v[64:71], v1
    v_smfmac_f32_16x16x64_bf16 v[24:27], v[16:19], v[72:79], v1
    v_smfmac_f32_16x16x64_bf16 v[24:27], v[20:23], v[80:87], v1
    v_smfmac_f32_16x16x64_bf16 v[28:31], v[12:15], v[88:95], v1
    v_smfmac_f32_16x16x64_bf16 v[28:31], v[16:19], v[96:103], v1
    v_smfmac_f32_16x16x64_bf16 v[28:31], v[20:23], v[104:111], v1
    v_smfmac_f32_16x16x64_bf16 v[32:35], v[12:15], v[112:119], v1
    v_smfmac_f32_16x16x64_bf16 v[32:35], v[16:19], v[120:127], v1
    v_smfmac_f32_16x16x64_bf16 v[32:35], v[20:23], v[128:135], v1
    v_smfmac_f32_16x16x64_bf16 v[36:39], v[12:15], v[136:143], v1
    v_smfmac_f32_16x16x64_bf16 v[36:39], v[16:19], v[144:151], v1
    v_smfmac_f32_16x16x64_bf16 v[36:39], v[20:23], v[152:159], v1
    v_add_f32 v24, v24, v26
    s_nop 0
    v_add_f32 v28, v28, v30
    s_nop 1
    v_add_f32 v32, v32, v34
    v_max3_f32 v61, v24, v28, v32
    v_mov_b32_dpp v24, v28 quad_perm:[0,1,2,3] row_mask:0x2 bank_mask:0xf
    v_add_f32 v36, v36, v38
    v_max_f32 v61, v61, v36
    v_mov_b32_dpp v24, v32 quad_perm:[0,1,2,3] row_mask:0x4 bank_mask:0xf
    s_nop 0
    v_max_f32_dpp v61, v61, v61 row_ror:8 row_mask:0xf bank_mask:0xf
    s_nop 0
    v_mov_b32_dpp v24, v36 quad_perm:[0,1,2,3] row_mask:0x8 bank_mask:0xf
    v_max_f32_dpp v61, v61, v61 row_ror:4 row_mask:0xf bank_mask:0xf
    s_nop 1
    v_max_f32_dpp v61, v61, v61 row_ror:2 row_mask:0xf bank_mask:0xf
    s_nop 1
    v_max_f32_dpp v61, v61, v61 row_ror:1 row_mask:0xf bank_mask:0xf
    v_sub_f32 v36, v24, v61
    ds_write_b32 v59, v61
    v_exp_f32 v36, v36
    s_nop 0
    v_cvt_pk_bf16_f32 v39, v36, v36
    ds_write_b16 v58, v39
    ds_read_b128 v[12:15], v52
    ds_read_b128 v[16:19], v53
    ds_read_b128 v[20:23], v54
    ds_read_b128 v[24:27], v55
    ds_read_b128 v[28:31], v56
    ds_read_b128 v[32:35], v57
    v_add_f32_dpp v38, v36, v36 row_ror:8 row_mask:0xf bank_mask:0xf
    s_nop 1
    v_add_f32_dpp v38, v38, v38 row_ror:4 row_mask:0xf bank_mask:0xf
    s_nop 1
    v_add_f32_dpp v38, v38, v38 row_ror:2 row_mask:0xf bank_mask:0xf
    s_nop 1
    v_add_f32_dpp v38, v38, v38 row_ror:1 row_mask:0xf bank_mask:0xf
    s_nop 1
    v_add_f32_dpp v38, v38, v38 row_bcast:15 row_mask:0xa bank_mask:0xf
    s_nop 1
    v_add_f32_dpp v48, v38, v38 row_bcast:31 row_mask:0x8 bank_mask:0xf
    s_waitcnt lgkmcnt(0)
    s_cmp_eq_u32 s9, 1
    s_waitcnt vmcnt(39)
    s_barrier
    s_cbranch_scc0 L_skip_118
    ds_read_b64_tr_b16 v[160:161], v8 offset:0
    ds_read_b64_tr_b16 v[168:169], v9 offset:0
    ds_read_b64_tr_b16 v[176:177], v10 offset:0
    ds_read_b64_tr_b16 v[184:185], v11 offset:0
    ds_read_b64_tr_b16 v[192:193], v8 offset:1024
    ds_read_b64_tr_b16 v[200:201], v9 offset:1024
    ds_read_b64_tr_b16 v[208:209], v10 offset:1024
    ds_read_b64_tr_b16 v[216:217], v11 offset:1024
    ds_read_b64_tr_b16 v[224:225], v8 offset:2048
    ds_read_b64_tr_b16 v[232:233], v9 offset:2048
    ds_read_b64_tr_b16 v[240:241], v10 offset:2048
    ds_read_b64_tr_b16 v[248:249], v11 offset:2048
L_skip_118:
    s_waitcnt lgkmcnt(0)
    ds_read_b32 v36, v62
    s_waitcnt lgkmcnt(0)
    v_max_f32_dpp v37, v36, v36 row_ror:4 row_mask:0xf bank_mask:0xf
    s_nop 1
    v_max_f32_dpp v37, v37, v37 row_ror:2 row_mask:0xf bank_mask:0xf
    s_nop 1
    v_max_f32_dpp v37, v37, v37 row_ror:1 row_mask:0xf bank_mask:0xf
    v_sub_f32 v39, v61, v37
    v_exp_f32 v39, v39
    s_cmp_lt_u32 s30, 2
    s_cbranch_scc0 L_skip_119
    s_lshl_b32 s57, s30, 3
    v_lshlrev_b32 v2, 4, v0
    v_add_u32 v2, s57, v2
    v_add_u32 v2, 79872, v2
    v_mov_b32 v60, 80880
    v_cmp_le_u32 vcc, 48, v0
    s_nop 1
    v_cndmask_b32 v2, v2, v60, vcc
    s_lshr_b32 s57, s54, 1
    s_lshl_b32 s57, s57, 2
    s_and_b32 s58, s54, 1
    s_add_u32 s57, s57, s58
    s_lshl_b32 s58, s57, 4
    s_lshl_b32 s57, s57, 3
    v_bfe_u32 v3, v0, 3, 2
    v_lshlrev_b32 v3, 8, v3
    v_bfe_u32 v61, v0, 2, 1
    v_lshl_add_u32 v3, v61, 5, v3
    v_and_b32 v61, 3, v0
    v_lshl_add_u32 v3, v61, 2, v3
    v_add_u32 v3, s58, v3
    v_bfe_u32 v60, v0, 3, 1
    v_lshlrev_b32 v60, 8, v60
    v_bfe_u32 v61, v0, 1, 1
    v_lshl_add_u32 v60, v61, 7, v60
    v_bfe_u32 v61, v0, 2, 1
    v_lshl_add_u32 v60, v61, 4, v60
    v_and_b32 v61, 1, v0
    v_lshl_add_u32 v60, v61, 2, v60
    v_add_u32 v60, s57, v60
    v_add_u32 v60, 1024, v60
    v_cmp_gt_u32 vcc, 32, v0
    s_nop 1
    v_cndmask_b32 v3, v60, v3, vcc
    s_lshl_b32 s57, s53, 1
    s_add_u32 s57, s57, s30
    s_mul_i32 s57, s57, 1664
    s_add_u32 s57, s57, s62
    v_add_u32 v3, s57, v3
    v_mov_b32 v60, 0x7f000000
    v_cmp_le_u32 vcc, 48, v0
    s_nop 1
    v_cndmask_b32 v3, v3, v60, vcc
    s_lshl_b32 s58, s54, 2
    s_add_u32 s57, s57, s58
    s_add_u32 s57, s57, 1536
    v_mov_b32 v4, s57
    v_mov_b32 v60, 0x7f000000
    v_cmp_ne_u32 vcc, 48, v0
    s_nop 1
    v_cndmask_b32 v4, v4, v60, vcc
    s_mov_b32 s58, 0
    s_cmp_eq_u32 s55, 0
    s_cbranch_scc1 L_gs_120
    buffer_store_dword v37, v4, s[40:43], s58 offen
L_gb_121:
L_skip_119:
    s_cmp_eq_u32 s30, 2
    s_cbranch_scc0 L_skip_122
    v_lshlrev_b32 v2, 2, v0
    v_add_u32 v2, 153600, v2
    v_and_b32 v3, 15, v0
    v_lshlrev_b32 v3, 2, v3
    v_lshrrev_b32 v60, 5, v0
    v_lshl_add_u32 v3, v60, 6, v3
    v_bfe_u32 v60, v0, 4, 1
    v_lshl_add_u32 v3, v60, 13, v3
L_skip_122:
    s_cmp_eq_u32 s9, 1
    s_waitcnt vmcnt(26)
    s_barrier
    s_cbranch_scc0 L_skip_123
    ds_read_b64_tr_b16 v[162:163], v8 offset:12288
    ds_read_b64_tr_b16 v[170:171], v9 offset:12288
    ds_read_b64_tr_b16 v[178:179], v10 offset:12288
    ds_read_b64_tr_b16 v[186:187], v11 offset:12288
    ds_read_b64_tr_b16 v[194:195], v8 offset:13312
    ds_read_b64_tr_b16 v[202:203], v9 offset:13312
    ds_read_b64_tr_b16 v[210:211], v10 offset:13312
    ds_read_b64_tr_b16 v[218:219], v11 offset:13312
    ds_read_b64_tr_b16 v[226:227], v8 offset:14336
    ds_read_b64_tr_b16 v[234:235], v9 offset:14336
    ds_read_b64_tr_b16 v[242:243], v10 offset:14336
    ds_read_b64_tr_b16 v[250:251], v11 offset:14336
L_skip_123:
    s_cmp_eq_u32 s30, 6
    s_cbranch_scc0 L_skip_124
    s_mul_i32 s57, s14, 9
    s_add_u32 s57, s57, s15
    s_mov_b32 m0, 49152
    s_nop 0
    buffer_load_dwordx4 v3, s[48:51], s57 offen offset:1024 nt lds
    s_mov_b32 s57, 788480
    s_mov_b32 s58, 787584
    s_mov_b32 s59, 786688
    s_mov_b32 s60, 24576
    s_mov_b32 m0, 141312
L_dma_125:
    s_nop 0
    buffer_load_dwordx4 v7, s[36:39], s57 offen offset:0 nt lds
    buffer_load_dwordx4 v7, s[36:39], s58 offen offset:1024 nt lds
    buffer_load_dwordx4 v7, s[36:39], s59 offen offset:2048 nt lds
    s_add_u32 s57, s57, s60
    s_add_u32 s58, s58, s60
    s_add_u32 s59, s59, s60
    s_xor_b32 s60, s60, 81920
    s_add_u32 m0, m0, 3072
    s_cmp_lg_u32 m0, 153600
    s_cbranch_scc1 L_dma_125
    s_mul_i32 s57, s14, 10
    s_mov_b32 m0, 51200
    s_nop 0
    buffer_load_dwordx4 v3, s[48:51], s57 offen offset:0 nt lds
    s_mov_b32 s57, 837632
    s_mov_b32 s58, 836736
    s_mov_b32 s59, 835840
    s_mov_b32 s60, 24576
    s_mov_b32 m0, 92160
L_dma_126:
    s_nop 0
    buffer_load_dwordx4 v7, s[36:39], s57 offen offset:0 nt lds
    buffer_load_dwordx4 v7, s[36:39], s58 offen offset:1024 nt lds
    buffer_load_dwordx4 v7, s[36:39], s59 offen offset:2048 nt lds
    s_add_u32 s57, s57, s60
    s_add_u32 s58, s58, s60
    s_add_u32 s59, s59, s60
    s_xor_b32 s60, s60, 81920
    s_add_u32 m0, m0, 3072
    s_cmp_lg_u32 m0, 104448
    s_cbranch_scc1 L_dma_126
L_skip_124:
    s_waitcnt lgkmcnt(0)
    s_cmp_eq_u32 s30, 5
    s_cbranch_scc0 L_skip_127
    global_load_dword v2, v3, s[26:27] offset:4 sc1
L_skip_127:
    s_cmp_eq_u32 s9, 2
    s_waitcnt vmcnt(39)
    s_barrier
    s_cbranch_scc0 L_skip_128
    ds_read_b64_tr_b16 v[160:161], v8 offset:24576
    ds_read_b64_tr_b16 v[168:169], v9 offset:24576
    ds_read_b64_tr_b16 v[176:177], v10 offset:24576
    ds_read_b64_tr_b16 v[184:185], v11 offset:24576
    ds_read_b64_tr_b16 v[192:193], v8 offset:25600
    ds_read_b64_tr_b16 v[200:201], v9 offset:25600
    ds_read_b64_tr_b16 v[208:209], v10 offset:25600
    ds_read_b64_tr_b16 v[216:217], v11 offset:25600
    ds_read_b64_tr_b16 v[224:225], v8 offset:26624
    ds_read_b64_tr_b16 v[232:233], v9 offset:26624
    ds_read_b64_tr_b16 v[240:241], v10 offset:26624
    ds_read_b64_tr_b16 v[248:249], v11 offset:26624
L_skip_128:
    s_cmp_eq_u32 s30, 6
    s_cbranch_scc0 L_skip_129
    s_mul_i32 s57, s14, 10
    s_add_u32 s57, s57, s15
    s_mov_b32 m0, 51200
    s_nop 0
    buffer_load_dwordx4 v3, s[48:51], s57 offen offset:1024 nt lds
    s_mov_b32 s57, 985088
    s_mov_b32 s58, 984192
    s_mov_b32 s59, 983296
    s_mov_b32 s60, 24576
    s_mov_b32 m0, 104448
L_dma_130:
    s_nop 0
    buffer_load_dwordx4 v7, s[36:39], s57 offen offset:0 nt lds
    buffer_load_dwordx4 v7, s[36:39], s58 offen offset:1024 nt lds
    buffer_load_dwordx4 v7, s[36:39], s59 offen offset:2048 nt lds
    s_add_u32 s57, s57, s60
    s_add_u32 s58, s58, s60
    s_add_u32 s59, s59, s60
    s_xor_b32 s60, s60, 81920
    s_add_u32 m0, m0, 3072
    s_cmp_lg_u32 m0, 116736
    s_cbranch_scc1 L_dma_130
L_skip_129:
    s_waitcnt lgkmcnt(0)
    s_cmp_eq_u32 s9, 2
    s_waitcnt vmcnt(39)
    s_barrier
    s_cbranch_scc0 L_skip_131
    ds_read_b64_tr_b16 v[162:163], v8 offset:36864
    ds_read_b64_tr_b16 v[170:171], v9 offset:36864
    ds_read_b64_tr_b16 v[178:179], v10 offset:36864
    ds_read_b64_tr_b16 v[186:187], v11 offset:36864
    ds_read_b64_tr_b16 v[194:195], v8 offset:37888
    ds_read_b64_tr_b16 v[202:203], v9 offset:37888
    ds_read_b64_tr_b16 v[210:211], v10 offset:37888
    ds_read_b64_tr_b16 v[218:219], v11 offset:37888
    ds_read_b64_tr_b16 v[226:227], v8 offset:38912
    ds_read_b64_tr_b16 v[234:235], v9 offset:38912
    ds_read_b64_tr_b16 v[242:243], v10 offset:38912
    ds_read_b64_tr_b16 v[250:251], v11 offset:38912
L_skip_131:
    s_cmp_eq_u32 s30, 6
    s_cbranch_scc0 L_skip_132
    s_mul_i32 s57, s14, 11
    s_mov_b32 m0, 53248
    s_nop 0
    buffer_load_dwordx4 v3, s[48:51], s57 offen offset:0 nt lds
    s_mov_b32 s57, 1034240
    s_mov_b32 s58, 1033344
    s_mov_b32 s59, 1032448
    s_mov_b32 s60, 24576
    s_mov_b32 m0, 116736
L_dma_133:
    s_nop 0
    buffer_load_dwordx4 v7, s[36:39], s57 offen offset:0 nt lds
    buffer_load_dwordx4 v7, s[36:39], s58 offen offset:1024 nt lds
    buffer_load_dwordx4 v7, s[36:39], s59 offen offset:2048 nt lds
    s_add_u32 s57, s57, s60
    s_add_u32 s58, s58, s60
    s_add_u32 s59, s59, s60
    s_xor_b32 s60, s60, 81920
    s_add_u32 m0, m0, 3072
    s_cmp_lg_u32 m0, 129024
    s_cbranch_scc1 L_dma_133
L_skip_132:
    s_waitcnt lgkmcnt(0)
    s_cmp_eq_u32 s9, 3
    s_waitcnt vmcnt(39)
    s_barrier
    s_cbranch_scc0 L_skip_134
    ds_read_b64_tr_b16 v[164:165], v8 offset:49152
    ds_read_b64_tr_b16 v[172:173], v9 offset:49152
    ds_read_b64_tr_b16 v[180:181], v10 offset:49152
    ds_read_b64_tr_b16 v[188:189], v11 offset:49152
    ds_read_b64_tr_b16 v[196:197], v8 offset:50176
    ds_read_b64_tr_b16 v[204:205], v9 offset:50176
    ds_read_b64_tr_b16 v[212:213], v10 offset:50176
    ds_read_b64_tr_b16 v[220:221], v11 offset:50176
    ds_read_b64_tr_b16 v[228:229], v8 offset:51200
    ds_read_b64_tr_b16 v[236:237], v9 offset:51200
    ds_read_b64_tr_b16 v[244:245], v10 offset:51200
    ds_read_b64_tr_b16 v[252:253], v11 offset:51200
L_skip_134:
    s_cmp_eq_u32 s30, 6
    s_cbranch_scc0 L_skip_135
    s_mul_i32 s57, s14, 11
    s_add_u32 s57, s57, s15
    s_mov_b32 m0, 53248
    s_nop 0
    buffer_load_dwordx4 v3, s[48:51], s57 offen offset:1024 nt lds
    s_mov_b32 s57, 1181696
    s_mov_b32 s58, 1180800
    s_mov_b32 s59, 1179904
    s_mov_b32 s60, 24576
    s_mov_b32 m0, 129024
L_dma_136:
    s_nop 0
    buffer_load_dwordx4 v7, s[36:39], s57 offen offset:0 nt lds
    buffer_load_dwordx4 v7, s[36:39], s58 offen offset:1024 nt lds
    buffer_load_dwordx4 v7, s[36:39], s59 offen offset:2048 nt lds
    s_add_u32 s57, s57, s60
    s_add_u32 s58, s58, s60
    s_add_u32 s59, s59, s60
    s_xor_b32 s60, s60, 81920
    s_add_u32 m0, m0, 3072
    s_cmp_lg_u32 m0, 141312
    s_cbranch_scc1 L_dma_136
L_skip_135:
    s_waitcnt lgkmcnt(0)
    s_cmp_eq_u32 s30, 5
    s_cbranch_scc0 L_skip_137
L_cw_138:
    s_waitcnt vmcnt(0)
    v_cmp_eq_u32 vcc, 0, v2
    s_cbranch_vccnz L_cr_139
    v_add_u32_dpp v2, v2, v2 row_ror:4 row_mask:0xf bank_mask:0xf
    s_nop 1
    v_add_u32_dpp v2, v2, v2 row_ror:2 row_mask:0xf bank_mask:0xf
    s_nop 1
    v_add_u32_dpp v2, v2, v2 row_ror:1 row_mask:0xf bank_mask:0xf
    v_mov_b32 v60, 156676
    ds_write_b32 v60, v2
    s_waitcnt lgkmcnt(0)
L_skip_137:
    s_cmp_eq_u32 s9, 3
    s_waitcnt vmcnt(39)
    s_barrier
    s_cbranch_scc0 L_skip_140
    ds_read_b64_tr_b16 v[166:167], v8 offset:0
    ds_read_b64_tr_b16 v[174:175], v9 offset:0
    ds_read_b64_tr_b16 v[182:183], v10 offset:0
    ds_read_b64_tr_b16 v[190:191], v11 offset:0
    ds_read_b64_tr_b16 v[198:199], v8 offset:1024
    ds_read_b64_tr_b16 v[206:207], v9 offset:1024
    ds_read_b64_tr_b16 v[214:215], v10 offset:1024
    ds_read_b64_tr_b16 v[222:223], v11 offset:1024
    ds_read_b64_tr_b16 v[230:231], v8 offset:2048
    ds_read_b64_tr_b16 v[238:239], v9 offset:2048
    ds_read_b64_tr_b16 v[246:247], v10 offset:2048
    ds_read_b64_tr_b16 v[254:255], v11 offset:2048
L_skip_140:
    s_cmp_eq_u32 s30, 6
    s_cbranch_scc0 L_skip_141
    s_mov_b32 s57, 1230848
    s_mov_b32 s58, 1229952
    s_mov_b32 s59, 1229056
    s_mov_b32 s60, 24576
    s_mov_b32 m0, 141312
L_dma_142:
    s_nop 0
    buffer_load_dwordx4 v7, s[36:39], s57 offen offset:0 nt lds
    buffer_load_dwordx4 v7, s[36:39], s58 offen offset:1024 nt lds
    buffer_load_dwordx4 v7, s[36:39], s59 offen offset:2048 nt lds
    s_add_u32 s57, s57, s60
    s_add_u32 s58, s58, s60
    s_add_u32 s59, s59, s60
    s_xor_b32 s60, s60, 81920
    s_add_u32 m0, m0, 3072
    s_cmp_lg_u32 m0, 153600
    s_cbranch_scc1 L_dma_142
L_skip_141:
    s_cmp_eq_u32 s9, 3
    s_cbranch_scc0 L_skip_143
    s_waitcnt lgkmcnt(8)
    v_smfmac_f32_16x16x64_bf16 v[40:43], v[12:15], v[160:167], v1
    v_smfmac_f32_16x16x64_bf16 v[40:43], v[16:19], v[168:175], v1
    v_smfmac_f32_16x16x64_bf16 v[40:43], v[20:23], v[176:183], v1
    v_smfmac_f32_16x16x64_bf16 v[40:43], v[24:27], v[184:191], v1
    s_waitcnt lgkmcnt(4)
    v_smfmac_f32_16x16x64_bf16 v[40:43], v[28:31], v[192:199], v1
    v_smfmac_f32_16x16x64_bf16 v[40:43], v[32:35], v[200:207], v1
    v_smfmac_f32_16x16x64_bf16 v[44:47], v[12:15], v[208:215], v1
    v_smfmac_f32_16x16x64_bf16 v[44:47], v[16:19], v[216:223], v1
    s_waitcnt lgkmcnt(0)
    v_smfmac_f32_16x16x64_bf16 v[44:47], v[20:23], v[224:231], v1
    v_smfmac_f32_16x16x64_bf16 v[44:47], v[24:27], v[232:239], v1
    v_smfmac_f32_16x16x64_bf16 v[44:47], v[28:31], v[240:247], v1
    v_smfmac_f32_16x16x64_bf16 v[44:47], v[32:35], v[248:255], v1
    s_nop 0
    v_add_f32_dpp v48, v40, v42 quad_perm:[0,1,2,3] row_mask:0x7 bank_mask:0xf
    v_add_f32 v49, v41, v43
    s_nop 4
    v_pk_add_f32 v[50:51], v[44:45], v[46:47]
    v_pk_mul_f32 v[48:49], v[48:49], v[38:39] op_sel:[0,1] op_sel_hi:[1,1]
    v_pk_mul_f32 v[50:51], v[50:51], v[38:39] op_sel:[0,1] op_sel_hi:[1,1]
    ds_write_b128 v63, v[48:51]
L_skip_143:
    s_waitcnt lgkmcnt(0)
    s_cmp_ge_u32 s30, 6
    s_cbranch_scc0 L_skip_144
    v_mov_b32 v60, 156676
    ds_read_b32 v60, v60
    s_lshr_b32 s58, s63, 2
    s_waitcnt lgkmcnt(0)
    v_readfirstlane_b32 s57, v60
    s_cmp_gt_u32 s57, 24
    s_cselect_b32 s57, 1, 0
    s_xor_b32 s57, s57, s58
    s_lshl_b32 s57, s57, 13
    s_add_u32 s7, s8, s57
L_skip_144:
    s_cmp_lt_u32 s3, 20
    s_cbranch_scc0 L_skip_145
    s_mul_i32 s74, s30, 1664
    s_add_u32 s74, s74, s62
    s_add_u32 s74, s74, 0
    v_and_b32 v56, 7, v0
    v_lshlrev_b32 v56, 2, v56
    v_lshrrev_b32 v62, 4, v0
    v_lshlrev_b32 v62, 3, v62
    s_cmp_lg_u32 s30, 6
    s_cbranch_scc0 L_skip_145
    buffer_load_dword v52, v56, s[40:43], s74 offen offset:1536 sc1
    buffer_load_dwordx2 v[54:55], v62, s[40:43], s74 offen offset:1536 sc1
L_skip_145:
    s_cmp_eq_u32 s30, 2
    s_cbranch_scc0 L_skip_146
    s_sub_u32 s57, s3, 20
    s_cmp_lt_u32 s57, 4
    s_cbranch_scc0 L_skip_147
    s_sub_u32 s57, s3, 20
    s_lshl_b32 s57, s57, 6
    v_add_u32 v52, s57, v0
    v_min_u32 v52, 207, v52
    v_lshlrev_b32 v52, 7, v52
    s_add_u32 s57, s62, 0
    buffer_load_dword v52, v52, s[40:43], s57 offen sc1 nt
    s_sub_u32 s57, s3, 20
    s_lshl_b32 s57, s57, 6
    v_add_u32 v53, s57, v0
    v_min_u32 v53, 151, v53
    v_lshlrev_b32 v53, 7, v53
    s_add_u32 s57, s62, 26624
    buffer_load_dword v53, v53, s[40:43], s57 offen sc1 nt
    s_sub_u32 s57, s3, 20
    s_lshl_b32 s57, s57, 6
    v_add_u32 v54, s57, v0
    v_min_u32 v54, 191, v54
    v_lshlrev_b32 v54, 7, v54
    s_add_u32 s57, s62, 46080
    buffer_load_dword v54, v54, s[40:43], s57 offen sc1 nt
L_skip_147:
L_skip_146:
    s_cmp_eq_u32 s9, 0
    s_waitcnt vmcnt(38)
    s_barrier
    s_cbranch_scc0 L_skip_148
    ds_read_b64_tr_b16 v[164:165], v8 offset:12288
    ds_read_b64_tr_b16 v[172:173], v9 offset:12288
    ds_read_b64_tr_b16 v[180:181], v10 offset:12288
    ds_read_b64_tr_b16 v[188:189], v11 offset:12288
    ds_read_b64_tr_b16 v[196:197], v8 offset:13312
    ds_read_b64_tr_b16 v[204:205], v9 offset:13312
    ds_read_b64_tr_b16 v[212:213], v10 offset:13312
    ds_read_b64_tr_b16 v[220:221], v11 offset:13312
    ds_read_b64_tr_b16 v[228:229], v8 offset:14336
    ds_read_b64_tr_b16 v[236:237], v9 offset:14336
    ds_read_b64_tr_b16 v[244:245], v10 offset:14336
    ds_read_b64_tr_b16 v[252:253], v11 offset:14336
L_skip_148:
    s_cmp_eq_u32 s30, 6
    s_cbranch_scc0 L_skip_149
    s_mov_b32 s57, 1378304
    s_mov_b32 s58, 1377408
    s_mov_b32 s59, 1376512
    s_mov_b32 s60, 24576
    s_mov_b32 m0, 92160
L_dma_150:
    s_nop 0
    buffer_load_dwordx4 v7, s[36:39], s57 offen offset:0 nt lds
    buffer_load_dwordx4 v7, s[36:39], s58 offen offset:1024 nt lds
    buffer_load_dwordx4 v7, s[36:39], s59 offen offset:2048 nt lds
    s_add_u32 s57, s57, s60
    s_add_u32 s58, s58, s60
    s_add_u32 s59, s59, s60
    s_xor_b32 s60, s60, 81920
    s_add_u32 m0, m0, 3072
    s_cmp_lg_u32 m0, 104448
    s_cbranch_scc1 L_dma_150
L_skip_149:
    s_waitcnt lgkmcnt(0)
    s_cmp_eq_u32 s9, 0
    s_waitcnt vmcnt(37)
    s_barrier
    s_cbranch_scc0 L_skip_151
    ds_read_b64_tr_b16 v[166:167], v8 offset:24576
    ds_read_b64_tr_b16 v[174:175], v9 offset:24576
    ds_read_b64_tr_b16 v[182:183], v10 offset:24576
    ds_read_b64_tr_b16 v[190:191], v11 offset:24576
    ds_read_b64_tr_b16 v[198:199], v8 offset:25600
    ds_read_b64_tr_b16 v[206:207], v9 offset:25600
    ds_read_b64_tr_b16 v[214:215], v10 offset:25600
    ds_read_b64_tr_b16 v[222:223], v11 offset:25600
    ds_read_b64_tr_b16 v[230:231], v8 offset:26624
    ds_read_b64_tr_b16 v[238:239], v9 offset:26624
    ds_read_b64_tr_b16 v[246:247], v10 offset:26624
    ds_read_b64_tr_b16 v[254:255], v11 offset:26624
    s_waitcnt lgkmcnt(8)
    v_smfmac_f32_16x16x64_bf16 v[40:43], v[12:15], v[160:167], v1
    v_smfmac_f32_16x16x64_bf16 v[40:43], v[16:19], v[168:175], v1
    v_smfmac_f32_16x16x64_bf16 v[40:43], v[20:23], v[176:183], v1
    v_smfmac_f32_16x16x64_bf16 v[40:43], v[24:27], v[184:191], v1
    s_waitcnt lgkmcnt(4)
    v_smfmac_f32_16x16x64_bf16 v[40:43], v[28:31], v[192:199], v1
    v_smfmac_f32_16x16x64_bf16 v[40:43], v[32:35], v[200:207], v1
    v_smfmac_f32_16x16x64_bf16 v[44:47], v[12:15], v[208:215], v1
    v_smfmac_f32_16x16x64_bf16 v[44:47], v[16:19], v[216:223], v1
    s_waitcnt lgkmcnt(0)
    v_smfmac_f32_16x16x64_bf16 v[44:47], v[20:23], v[224:231], v1
    v_smfmac_f32_16x16x64_bf16 v[44:47], v[24:27], v[232:239], v1
    v_smfmac_f32_16x16x64_bf16 v[44:47], v[28:31], v[240:247], v1
    v_smfmac_f32_16x16x64_bf16 v[44:47], v[32:35], v[248:255], v1
    s_nop 0
    v_add_f32_dpp v48, v40, v42 quad_perm:[0,1,2,3] row_mask:0x7 bank_mask:0xf
    v_add_f32 v49, v41, v43
    s_nop 4
    v_pk_add_f32 v[50:51], v[44:45], v[46:47]
    v_pk_mul_f32 v[48:49], v[48:49], v[38:39] op_sel:[0,1] op_sel_hi:[1,1]
    v_pk_mul_f32 v[50:51], v[50:51], v[38:39] op_sel:[0,1] op_sel_hi:[1,1]
    ds_write_b128 v63, v[48:51]
L_skip_151:
    s_cmp_eq_u32 s30, 6
    s_cbranch_scc0 L_skip_152
    s_mov_b32 s57, 1427456
    s_mov_b32 s58, 1426560
    s_mov_b32 s59, 1425664
    s_mov_b32 s60, 24576
    s_mov_b32 m0, 104448
L_dma_153:
    s_nop 0
    buffer_load_dwordx4 v7, s[36:39], s57 offen offset:0 nt lds
    buffer_load_dwordx4 v7, s[36:39], s58 offen offset:1024 nt lds
    buffer_load_dwordx4 v7, s[36:39], s59 offen offset:2048 nt lds
    s_add_u32 s57, s57, s60
    s_add_u32 s58, s58, s60
    s_add_u32 s59, s59, s60
    s_xor_b32 s60, s60, 81920
    s_add_u32 m0, m0, 3072
    s_cmp_lg_u32 m0, 116736
    s_cbranch_scc1 L_dma_153
L_skip_152:
    s_waitcnt lgkmcnt(0)
    s_cmp_eq_u32 s9, 1
    s_waitcnt vmcnt(36)
    s_barrier
    s_cbranch_scc0 L_skip_154
    ds_read_b64_tr_b16 v[164:165], v8 offset:36864
    ds_read_b64_tr_b16 v[172:173], v9 offset:36864
    ds_read_b64_tr_b16 v[180:181], v10 offset:36864
    ds_read_b64_tr_b16 v[188:189], v11 offset:36864
    ds_read_b64_tr_b16 v[196:197], v8 offset:37888
    ds_read_b64_tr_b16 v[204:205], v9 offset:37888
    ds_read_b64_tr_b16 v[212:213], v10 offset:37888
    ds_read_b64_tr_b16 v[220:221], v11 offset:37888
    ds_read_b64_tr_b16 v[228:229], v8 offset:38912
    ds_read_b64_tr_b16 v[236:237], v9 offset:38912
    ds_read_b64_tr_b16 v[244:245], v10 offset:38912
    ds_read_b64_tr_b16 v[252:253], v11 offset:38912
L_skip_154:
    s_cmp_eq_u32 s30, 6
    s_cbranch_scc0 L_skip_155
    s_mul_i32 s57, s14, 12
    s_add_u32 s58, s57, s15
    s_mov_b32 m0, 55296
L_dma_156:
    s_nop 0
    buffer_load_dwordx4 v3, s[48:51], s57 offen offset:0 nt lds
    buffer_load_dwordx4 v3, s[48:51], s58 offen offset:1024 nt lds
    s_add_u32 s57, s57, s14
    s_add_u32 s58, s58, s14
    s_add_u32 m0, m0, 2048
    s_cmp_lg_u32 m0, 67584
    s_cbranch_scc1 L_dma_156
L_skip_155:
    s_waitcnt lgkmcnt(0)
    s_cmp_lt_u32 s30, 5
    s_cbranch_scc0 L_skip_157
    s_waitcnt vmcnt(0)
L_skip_157:
    s_cmp_lt_u32 s3, 20
    s_cbranch_scc0 L_skip_158
    v_lshlrev_b32 v57, 4, v0
    v_lshlrev_b32 v58, 3, v0
    s_mul_i32 s57, s30, 6144
    s_add_u32 s57, s57, 30720
    v_lshrrev_b32 v59, 2, v0
    v_lshlrev_b32 v59, 6, v59
    v_bfe_u32 v53, v0, 4, 1
    v_lshl_add_u32 v59, v53, 5, v59
    v_and_b32 v53, 3, v0
    v_lshl_add_u32 v59, v53, 3, v59
    v_add_u32 v59, s57, v59
    v_xor_b32 v60, 32, v59
    s_lshl_b32 s57, s30, 8
    s_add_u32 s57, s57, 153600
    v_lshl_add_u32 v61, v0, 2, s57
    s_cmp_lg_u32 s30, 6
    s_cbranch_scc0 L_skip_158
L_cw_159:
    s_waitcnt vmcnt(0)
    v_max3_u32 v53, v52, v54, v55
    v_cmp_eq_u32 vcc, -1, v53
    s_cbranch_vccnz L_cr_160
    v_max_f32_dpp v53, v52, v52 row_ror:4 row_mask:0xf bank_mask:0xf
    s_nop 1
    v_max_f32_dpp v53, v53, v53 row_ror:2 row_mask:0xf bank_mask:0xf
    s_nop 1
    v_max_f32_dpp v53, v53, v53 row_ror:1 row_mask:0xf bank_mask:0xf
    v_sub_f32 v52, v52, v53
    v_sub_f32 v54, v54, v53
    v_sub_f32 v55, v55, v53
    v_exp_f32 v52, v52
    v_exp_f32 v54, v54
    v_exp_f32 v55, v55
    s_cmp_eq_u32 s30, 7
    s_cbranch_scc0 L_skip_158
    v_add_u32 v62, 154624, v57
    ds_write_b128 v62, v[52:55]
    s_waitcnt lgkmcnt(0)
L_skip_158:
    s_branch L_tail
.p2align 10
L_tail:
L_pad0:
    s_cbranch_execz L_pad4
    s_cmp_eq_u32 s9, 1
    s_waitcnt vmcnt(36)
    s_barrier
    s_cbranch_scc0 L_skip_161
    ds_read_b64_tr_b16 v[166:167], v8 offset:49152
    ds_read_b64_tr_b16 v[174:175], v9 offset:49152
    ds_read_b64_tr_b16 v[182:183], v10 offset:49152
    ds_read_b64_tr_b16 v[190:191], v11 offset:49152
    ds_read_b64_tr_b16 v[198:199], v8 offset:50176
    ds_read_b64_tr_b16 v[206:207], v9 offset:50176
    ds_read_b64_tr_b16 v[214:215], v10 offset:50176
    ds_read_b64_tr_b16 v[222:223], v11 offset:50176
    ds_read_b64_tr_b16 v[230:231], v8 offset:51200
    ds_read_b64_tr_b16 v[238:239], v9 offset:51200
    ds_read_b64_tr_b16 v[246:247], v10 offset:51200
    ds_read_b64_tr_b16 v[254:255], v11 offset:51200
    s_waitcnt lgkmcnt(8)
    v_smfmac_f32_16x16x64_bf16 v[40:43], v[12:15], v[160:167], v1
    v_smfmac_f32_16x16x64_bf16 v[40:43], v[16:19], v[168:175], v1
    v_smfmac_f32_16x16x64_bf16 v[40:43], v[20:23], v[176:183], v1
    v_smfmac_f32_16x16x64_bf16 v[40:43], v[24:27], v[184:191], v1
    s_waitcnt lgkmcnt(4)
    v_smfmac_f32_16x16x64_bf16 v[40:43], v[28:31], v[192:199], v1
    v_smfmac_f32_16x16x64_bf16 v[40:43], v[32:35], v[200:207], v1
    v_smfmac_f32_16x16x64_bf16 v[44:47], v[12:15], v[208:215], v1
    v_smfmac_f32_16x16x64_bf16 v[44:47], v[16:19], v[216:223], v1
    s_waitcnt lgkmcnt(0)
    v_smfmac_f32_16x16x64_bf16 v[44:47], v[20:23], v[224:231], v1
    v_smfmac_f32_16x16x64_bf16 v[44:47], v[24:27], v[232:239], v1
    v_smfmac_f32_16x16x64_bf16 v[44:47], v[28:31], v[240:247], v1
    v_smfmac_f32_16x16x64_bf16 v[44:47], v[32:35], v[248:255], v1
    s_nop 0
    v_add_f32_dpp v48, v40, v42 quad_perm:[0,1,2,3] row_mask:0x7 bank_mask:0xf
    v_add_f32 v49, v41, v43
    s_nop 4
    v_pk_add_f32 v[50:51], v[44:45], v[46:47]
    v_pk_mul_f32 v[48:49], v[48:49], v[38:39] op_sel:[0,1] op_sel_hi:[1,1]
    v_pk_mul_f32 v[50:51], v[50:51], v[38:39] op_sel:[0,1] op_sel_hi:[1,1]
    ds_write_b128 v63, v[48:51]
L_skip_161:
    s_cmp_eq_u32 s30, 6
    s_cbranch_scc0 L_skip_162
    s_mul_i32 s57, s14, 18
    s_add_u32 s58, s57, s15
    s_mov_b32 m0, 67584
L_dma_163:
    s_nop 0
    buffer_load_dwordx4 v3, s[48:51], s57 offen offset:0 nt lds
    buffer_load_dwordx4 v3, s[48:51], s58 offen offset:1024 nt lds
    s_add_u32 s57, s57, s14
    s_add_u32 s58, s58, s14
    s_add_u32 m0, m0, 2048
    s_cmp_lg_u32 m0, 79872
    s_cbranch_scc1 L_dma_163
L_skip_162:
    s_waitcnt lgkmcnt(0)
    s_cmp_lt_u32 s3, 20
    s_cbranch_scc0 L_skip_164
    s_cmp_eq_u32 s30, 6
    s_cbranch_scc0 L_skip_164
    v_add_u32 v62, 154624, v57
    ds_read_b128 v[52:55], v62
L_skip_164:
    s_cmp_eq_u32 s9, 2
    s_waitcnt vmcnt(36)
    s_barrier
    s_cbranch_scc0 L_skip_165
    ds_read_b64_tr_b16 v[164:165], v8 offset:0
    ds_read_b64_tr_b16 v[172:173], v9 offset:0
    ds_read_b64_tr_b16 v[180:181], v10 offset:0
    ds_read_b64_tr_b16 v[188:189], v11 offset:0
    ds_read_b64_tr_b16 v[196:197], v8 offset:1024
    ds_read_b64_tr_b16 v[204:205], v9 offset:1024
    ds_read_b64_tr_b16 v[212:213], v10 offset:1024
    ds_read_b64_tr_b16 v[220:221], v11 offset:1024
    ds_read_b64_tr_b16 v[228:229], v8 offset:2048
    ds_read_b64_tr_b16 v[236:237], v9 offset:2048
    ds_read_b64_tr_b16 v[244:245], v10 offset:2048
    ds_read_b64_tr_b16 v[252:253], v11 offset:2048
L_skip_165:
    s_waitcnt lgkmcnt(0)
    s_cmp_eq_u32 s9, 2
    s_waitcnt vmcnt(24)
    s_barrier
L_pad1:
    s_cbranch_execz L_pad5
    s_cbranch_scc0 L_skip_166
    ds_read_b64_tr_b16 v[166:167], v8 offset:12288
    ds_read_b64_tr_b16 v[174:175], v9 offset:12288
    ds_read_b64_tr_b16 v[182:183], v10 offset:12288
    ds_read_b64_tr_b16 v[190:191], v11 offset:12288
    ds_read_b64_tr_b16 v[198:199], v8 offset:13312
    ds_read_b64_tr_b16 v[206:207], v9 offset:13312
    ds_read_b64_tr_b16 v[214:215], v10 offset:13312
    ds_read_b64_tr_b16 v[222:223], v11 offset:13312
    ds_read_b64_tr_b16 v[230:231], v8 offset:14336
    ds_read_b64_tr_b16 v[238:239], v9 offset:14336
    ds_read_b64_tr_b16 v[246:247], v10 offset:14336
    ds_read_b64_tr_b16 v[254:255], v11 offset:14336
    s_waitcnt lgkmcnt(8)
    v_smfmac_f32_16x16x64_bf16 v[40:43], v[12:15], v[160:167], v1
    v_smfmac_f32_16x16x64_bf16 v[40:43], v[16:19], v[168:175], v1
    v_smfmac_f32_16x16x64_bf16 v[40:43], v[20:23], v[176:183], v1
    v_smfmac_f32_16x16x64_bf16 v[40:43], v[24:27], v[184:191], v1
    s_waitcnt lgkmcnt(4)
    v_smfmac_f32_16x16x64_bf16 v[40:43], v[28:31], v[192:199], v1
    v_smfmac_f32_16x16x64_bf16 v[40:43], v[32:35], v[200:207], v1
    v_smfmac_f32_16x16x64_bf16 v[44:47], v[12:15], v[208:215], v1
    v_smfmac_f32_16x16x64_bf16 v[44:47], v[16:19], v[216:223], v1
    s_waitcnt lgkmcnt(0)
    v_smfmac_f32_16x16x64_bf16 v[44:47], v[20:23], v[224:231], v1
    v_smfmac_f32_16x16x64_bf16 v[44:47], v[24:27], v[232:239], v1
    v_smfmac_f32_16x16x64_bf16 v[44:47], v[28:31], v[240:247], v1
    v_smfmac_f32_16x16x64_bf16 v[44:47], v[32:35], v[248:255], v1
    s_nop 0
    v_add_f32_dpp v48, v40, v42 quad_perm:[0,1,2,3] row_mask:0x7 bank_mask:0xf
    v_add_f32 v49, v41, v43
    s_nop 4
    v_pk_add_f32 v[50:51], v[44:45], v[46:47]
    v_pk_mul_f32 v[48:49], v[48:49], v[38:39] op_sel:[0,1] op_sel_hi:[1,1]
    v_pk_mul_f32 v[50:51], v[50:51], v[38:39] op_sel:[0,1] op_sel_hi:[1,1]
    ds_write_b128 v63, v[48:51]
L_skip_166:
    s_setprio 0
    s_cmp_lt_u32 s30, 2
    s_cbranch_scc1 L_comb_0
    s_waitcnt lgkmcnt(0)
    s_barrier
.p2align 5
L_comb_0b:
    s_cmp_eq_u32 s30, 6
    s_cbranch_scc0 L_skip_171
    s_waitcnt vmcnt(0)
L_skip_171:
    s_barrier
    s_cmp_lt_u32 s3, 20
    s_cbranch_scc0 L_typeB_0
    buffer_load_dwordx4 v[12:15], v57, s[40:43], s74 offen sc1
    buffer_load_dwordx2 v[16:17], v58, s[40:43], s74 offen offset:1024 sc1
    buffer_load_dword v18, v56, s[40:43], s74 offen offset:1568 sc1
    ds_read_b64_tr_b16 v[28:29], v59 offset:0
    ds_read_b64_tr_b16 v[30:31], v59 offset:1024
    ds_read_b64_tr_b16 v[32:33], v59 offset:2048
    ds_read_b64_tr_b16 v[34:35], v59 offset:3072
    ds_read_b64_tr_b16 v[36:37], v59 offset:4096
    ds_read_b64_tr_b16 v[38:39], v59 offset:5120
    ds_read_b64_tr_b16 v[40:41], v60 offset:0
    ds_read_b64_tr_b16 v[42:43], v60 offset:1024
    ds_read_b64_tr_b16 v[44:45], v60 offset:2048
    ds_read_b64_tr_b16 v[46:47], v60 offset:3072
    ds_read_b64_tr_b16 v[48:49], v60 offset:4096
    ds_read_b64_tr_b16 v[50:51], v60 offset:5120
    v_mov_b64 v[20:21], 0
    v_mov_b64 v[22:23], 0
    v_mov_b64 v[24:25], 0
    v_mov_b64 v[26:27], 0
    s_add_u32 s58, s6, 0
    s_waitcnt lgkmcnt(0)
    s_branch L_ow_172
.p2align 5
L_or_173:
    buffer_load_dwordx4 v[12:15], v57, s[40:43], s74 offen sc1
    buffer_load_dwordx2 v[16:17], v58, s[40:43], s74 offen offset:1024 sc1
    buffer_load_dword v18, v56, s[40:43], s74 offen offset:1568 sc1
    s_sub_u32 s56, s56, 1
    s_cbranch_scc1 L_done
L_pad2:
    s_cbranch_execz L_pad6
    v_mov_b64 v[20:21], 0
    v_mov_b64 v[22:23], 0
    v_mov_b64 v[24:25], 0
    v_mov_b64 v[26:27], 0
L_ow_172:
    s_waitcnt vmcnt(2)
    v_smfmac_f32_16x16x64_bf16 v[20:23], v[12:15], v[28:35], v1
    s_nop 2
    v_smfmac_f32_16x16x64_bf16 v[24:27], v[12:15], v[40:47], v1
    s_waitcnt vmcnt(0)
    v_mul_f32 v53, v52, v18
    v_smfmac_f32_16x16x32_bf16 v[20:23], v[16:17], v[36:39], v1
    s_nop 2
    v_smfmac_f32_16x16x32_bf16 v[24:27], v[16:17], v[48:51], v1
    v_add_f32_dpp v53, v53, v53 row_ror:4 row_mask:0xf bank_mask:0xf
    v_max3_u32 v19, v12, v13, v14
    v_max3_u32 v62, v15, v16, v17
    v_add_f32_dpp v53, v53, v53 row_ror:2 row_mask:0xf bank_mask:0xf
    v_max3_u32 v19, v19, v62, v18
    s_cmp_eq_u32 s30, 2
    v_add_f32_dpp v53, v53, v53 row_ror:1 row_mask:0xf bank_mask:0xf
    v_cmp_eq_u32 vcc, -1, v19
    v_rcp_f32 v53, v53
    s_cbranch_vccnz L_or_173
    v_pk_add_f32 v[20:21], v[20:21], v[22:23]
    v_pk_add_f32 v[24:25], v[24:25], v[26:27]
    v_pk_mul_f32 v[54:55], v[54:55], v[52:53] op_sel:[0,1] op_sel_hi:[1,1]
    v_mul_f32 v20, v20, v54
    v_mul_f32 v24, v24, v54
    v_fmac_f32 v20, v21, v55
    v_fmac_f32 v24, v25, v55
    s_nop 1
    v_permlane32_swap_b32 v20, v24
    v_add_f32 v20, v20, v24
    ds_write_b32 v61, v20
    s_waitcnt lgkmcnt(0)
    s_barrier
    s_cbranch_scc0 L_finb_174
    ds_read2st64_b32 v[12:13], v2 offset0:0 offset1:1
    ds_read2st64_b32 v[14:15], v2 offset0:2 offset1:3
    ds_read2st64_b32 v[16:17], v2 offset0:4 offset1:5
    ds_read2st64_b32 v[18:19], v2 offset0:6 offset1:7
    s_waitcnt lgkmcnt(2)
    v_pk_add_f32 v[12:13], v[12:13], v[14:15]
    s_waitcnt lgkmcnt(0)
    v_pk_add_f32 v[16:17], v[16:17], v[18:19]
    v_pk_add_f32 v[12:13], v[12:13], v[16:17]
    v_add_f32 v14, v12, v13
    v_add_f32 v15, v12, v13
    s_nop 1
    v_permlane16_swap_b32 v14, v15
    v_add_f32 v12, v14, v15
    buffer_store_dword v12, v3, s[40:43], s58 offen sc1
.p2align 5
L_finb_174:
    s_sub_u32 s57, s30, 4
    s_cmp_lt_u32 s57, 3
    s_cbranch_scc0 L_skip_175
    s_sub_u32 s60, s30, 4
    s_lshl_b32 s57, s60, 11
    v_lshlrev_b32 v11, 4, v0
    v_add_u32 v11, s57, v11
    s_add_u32 s65, s62, 19456
    buffer_load_dwordx4 v[52:55], v11, s[40:43], s65 offen offset:0 sc1
    buffer_load_dwordx4 v[56:59], v11, s[40:43], s65 offen offset:1024 sc1
    s_lshl_b32 s59, s60, 12
    s_add_u32 s59, s59, 79872
    s_mov_b32 s44, s20
    s_mov_b32 s45, s21
    s_mov_b32 s46, 1966080
    s_mov_b32 s47, 0x20000
    s_mul_i32 s57, s31, 3
    s_add_u32 s57, s57, s60
    s_mul_i32 s57, s57, 81920
    s_lshl_b32 s64, s3, 6
    s_add_u32 s57, s57, s64
    v_lshrrev_b32 v5, 2, v0
    v_mul_u32_u24 v5, 1280, v5
    v_and_b32 v60, 3, v0
    v_lshl_add_u32 v5, v60, 4, v5
    v_add_u32 v5, s57, v5
    s_add_u32 m0, s59, 0
    s_mov_b32 s57, 0
    buffer_load_dwordx4 v5, s[44:47], s57 offen nt lds
    s_add_u32 m0, s59, 1024
    s_mov_b32 s57, 20480
    buffer_load_dwordx4 v5, s[44:47], s57 offen nt lds
    s_add_u32 m0, s59, 2048
    s_mov_b32 s57, 40960
L_pad3:
    s_cbranch_execz L_pad7
    buffer_load_dwordx4 v5, s[44:47], s57 offen nt lds
    s_add_u32 m0, s59, 3072
    s_mov_b32 s57, 61440
    buffer_load_dwordx4 v5, s[44:47], s57 offen nt lds
    v_bfe_u32 v35, v0, 4, 1
    v_lshlrev_b32 v35, 11, v35
    v_bfe_u32 v60, v0, 2, 2
    v_lshl_add_u32 v35, v60, 8, v35
    v_lshrrev_b32 v60, 5, v0
    v_lshl_add_u32 v35, v60, 6, v35
    v_and_b32 v60, 3, v0
    v_lshl_add_u32 v35, v60, 3, v35
    v_add_u32 v35, s59, v35
    v_mov_b32 v9, 0xbdd2d3e8
    v_mov_b32 v10, 0xc0135761
    s_lshl_b32 s57, s60, 7
    s_add_u32 s57, s57, 155776
    v_lshlrev_b32 v32, 3, v0
    v_add_u32 v32, s57, v32
    v_lshlrev_b32 v33, 3, v0
    v_add_u32 v33, 129024, v33
    v_cmp_gt_u32 vcc, 16, v0
    s_nop 1
    v_cndmask_b32 v32, v33, v32, vcc
    v_and_b32 v33, 15, v0
    v_lshlrev_b32 v33, 3, v33
    v_lshrrev_b32 v60, 5, v0
    v_lshl_add_u32 v33, v60, 2, v33
    v_add_u32 v33, 155776, v33
    v_and_b32 v34, 15, v0
    v_lshlrev_b32 v34, 2, v34
    v_lshrrev_b32 v60, 5, v0
    v_lshl_add_u32 v34, v60, 6, v34
    v_bfe_u32 v60, v0, 4, 1
    v_lshl_add_u32 v34, v60, 13, v34
    s_add_u32 s60, s6, 66048
    s_add_u32 s58, s62, 13312
    s_add_u32 s57, s62, 25856
    v_and_b32 v7, 7, v0
    v_lshlrev_b32 v7, 3, v7
    v_mov_b32 v60, 0x3acccccd
    v_mov_b32 v61, 0x3727c5ac
    s_waitcnt vmcnt(0)
    buffer_load_dwordx2 v[24:25], v7, s[40:43], s57 offen sc1
    buffer_load_dwordx4 v[12:15], v11, s[40:43], s58 offen offset:0 sc1
    buffer_load_dwordx4 v[16:19], v11, s[40:43], s58 offen offset:1024 sc1
    ds_read_b64_tr_b16 v[36:37], v35 offset:0
    ds_read_b64_tr_b16 v[38:39], v35 offset:1024
    ds_read_b64_tr_b16 v[40:41], v35 offset:128
    ds_read_b64_tr_b16 v[42:43], v35 offset:1152
    ds_read_b64_tr_b16 v[44:45], v35 offset:32
    ds_read_b64_tr_b16 v[46:47], v35 offset:1056
    ds_read_b64_tr_b16 v[48:49], v35 offset:160
    ds_read_b64_tr_b16 v[50:51], v35 offset:1184
L_sw_178:
    v_max3_u32 v20, v52, v53, v54
    v_max3_u32 v20, v20, v55, v56
    v_max3_u32 v20, v20, v57, v58
    v_max_u32 v20, v20, v59
    v_cmp_eq_u32 vcc, -1, v20
    s_cbranch_vccnz L_sr_179
    v_pk_add_f32 v[28:29], v[52:53], v[56:57]
    v_pk_add_f32 v[30:31], v[54:55], v[58:59]
    s_nop 1
    v_permlane32_swap_b32 v28, v30
    v_permlane32_swap_b32 v29, v31
    v_pk_add_f32 v[28:29], v[28:29], v[30:31]
    s_nop 1
    v_permlane16_swap_b32 v28, v29
    v_add_f32 v28, v28, v29
    v_mov_b64 v[52:53], 0
    v_mov_b64 v[54:55], 0
    v_mov_b64 v[56:57], 0
    v_mov_b64 v[58:59], 0
    s_waitcnt lgkmcnt(0)
    s_branch L_pw_176
.p2align 5
L_pr_177:
    buffer_load_dwordx2 v[24:25], v7, s[40:43], s57 offen sc1
    buffer_load_dwordx4 v[12:15], v11, s[40:43], s58 offen offset:0 sc1
    buffer_load_dwordx4 v[16:19], v11, s[40:43], s58 offen offset:1024 sc1
    s_sub_u32 s56, s56, 1
    s_cbranch_scc1 L_done
L_pw_176:
L_pad4:
    s_cbranch_execz L_pad8
    s_waitcnt vmcnt(0)
    v_max_u32 v20, v24, v25
    v_cmp_eq_u32 vcc, -1, v20
    s_cbranch_vccnz L_pr_177
    buffer_load_dwordx4 v[12:15], v11, s[40:43], s58 offen offset:0 sc1
    buffer_load_dwordx4 v[16:19], v11, s[40:43], s58 offen offset:1024 sc1
    v_add_f32_dpp v2, v24, v24 row_ror:4 row_mask:0xf bank_mask:0xf
    v_add_f32_dpp v3, v25, v25 row_ror:4 row_mask:0xf bank_mask:0xf
    v_pk_add_f32 v[20:21], v[12:13], v[16:17]
    v_pk_add_f32 v[22:23], v[14:15], v[18:19]
    v_add_f32_dpp v2, v2, v2 row_ror:2 row_mask:0xf bank_mask:0xf
    v_add_f32_dpp v3, v3, v3 row_ror:2 row_mask:0xf bank_mask:0xf
    v_permlane32_swap_b32 v20, v22
    v_permlane32_swap_b32 v21, v23
    v_add_f32_dpp v2, v2, v2 row_ror:1 row_mask:0xf bank_mask:0xf
    v_add_f32_dpp v3, v3, v3 row_ror:1 row_mask:0xf bank_mask:0xf
    v_pk_add_f32 v[20:21], v[20:21], v[22:23]
    v_mul_f32 v2, v2, v60
    v_fma_f32 v3, v3, v60, v61
    v_permlane16_swap_b32 v20, v21
    v_fma_f32 v3, -v2, v2, v3
    v_add_f32 v20, v20, v21
    v_max_f32 v3, v3, v61
    v_mul_f32 v26, v28, v2
    v_rsq_f32 v3, v3
    v_cmp_u_f32 vcc, v20, v20
    v_sub_f32 v20, v20, v26
    s_cbranch_vccnz L_hr_180
L_hk_181:
    v_fma_f32 v20, v20, v3, v4
    v_mul_f32 v21, v20, v20
    v_mul_f32 v22, v20, v9
    v_mul_f32 v23, v20, v10
    v_fma_f32 v21, v21, v22, v23
    v_exp_f32 v21, v21
    s_nop 0
    v_add_f32 v21, 1.0, v21
    v_rcp_f32 v21, v21
    s_nop 0
    v_mul_f32 v20, v20, v21
    s_nop 1
    v_mov_b32_dpp v21, v20 row_shl:1 row_mask:0xf bank_mask:0xf bound_ctrl:0
    v_cvt_pk_bf16_f32 v28, v20, v21
    s_nop 1
    v_mov_b32_dpp v29, v28 row_shl:4 row_mask:0xf bank_mask:0xf bound_ctrl:0
    v_mov_b32_dpp v30, v28 row_shl:8 row_mask:0xf bank_mask:0xf bound_ctrl:0
    v_mov_b32_dpp v31, v28 row_shl:12 row_mask:0xf bank_mask:0xf bound_ctrl:0
    s_nop 1
    v_smfmac_f32_16x16x64_bf16 v[52:55], v[28:31], v[36:43], v1
    v_smfmac_f32_16x16x64_bf16 v[56:59], v[28:31], v[44:51], v1
    s_cmp_eq_u32 s30, 4
    s_nop 5
    v_add_f32 v22, v52, v54
    v_add_f32 v23, v56, v58
    ds_write_b64 v32, v[22:23]
    s_cbranch_scc0 L_skip_183
L_xw_184:
    ds_read2_b32 v[20:21], v33 offset0:0 offset1:32
    ds_read_b32 v22, v33 offset:256
    s_sub_u32 s56, s56, 1
    s_cbranch_scc1 L_done
    s_waitcnt lgkmcnt(0)
    v_max3_u32 v23, v20, v21, v22
    v_add_f32 v20, v20, v21
    v_cmp_eq_u32 vcc, -1, v23
    v_add_f32 v20, v20, v22
    s_cbranch_vccnz L_xw_184
    buffer_store_dword v20, v34, s[40:43], s60 offen sc1
    s_waitcnt vmcnt(1)
    s_branch L_pe_185
L_skip_183:
    s_waitcnt vmcnt(0)
L_pe_185:
L_skip_175:
    s_branch L_p1
.p2align 5
L_typeB_0:
    s_cmp_eq_u32 s53, 3
    s_cbranch_scc0 L_typeC_186
    s_cmp_eq_u32 s30, 7
    s_cbranch_scc1 L_w7_197
    s_cmp_lt_u32 s30, 6
    s_cbranch_scc0 L_skip_199
    s_lshr_b32 s57, s30, 1
    s_mul_i32 s57, s57, 128
    s_and_b32 s58, s30, 1
    s_lshl_b32 s58, s58, 6
    s_add_u32 s57, s57, s58
    v_lshrrev_b32 v18, 5, v0
    v_lshlrev_b32 v18, 13, v18
    v_bfe_u32 v60, v0, 3, 1
    v_lshl_add_u32 v18, v60, 12, v18
    v_bfe_u32 v60, v0, 4, 1
    v_lshl_add_u32 v18, v60, 11, v18
    v_bfe_u32 v60, v0, 2, 1
L_pad5:
    s_cbranch_execz L_pad9
    v_mul_u32_u24 v60, 384, v60
    v_add_u32 v18, v60, v18
    v_and_b32 v60, 3, v0
    v_lshl_add_u32 v18, v60, 3, v18
    v_add_u32 v18, s57, v18
    v_add_u32 v18, 30720, v18
    v_bfe_u32 v19, v0, 3, 1
    v_lshlrev_b32 v19, 12, v19
    v_bfe_u32 v60, v0, 4, 1
    v_lshl_add_u32 v19, v60, 11, v19
    v_bfe_u32 v60, v0, 2, 1
    v_mul_u32_u24 v60, 384, v60
    v_add_u32 v19, v60, v19
    v_and_b32 v60, 3, v0
    v_lshl_add_u32 v19, v60, 3, v19
    v_lshrrev_b32 v60, 5, v0
    v_lshl_add_u32 v19, v60, 5, v19
    v_add_u32 v19, s57, v19
    v_add_u32 v19, 63488, v19
    ds_read_b64_tr_b16 v[28:29], v18 offset:0
    ds_read_b64_tr_b16 v[30:31], v18 offset:1024
    ds_read_b64_tr_b16 v[32:33], v18 offset:16384
    ds_read_b64_tr_b16 v[34:35], v18 offset:17408
    ds_read_b64_tr_b16 v[36:37], v18 offset:32
    ds_read_b64_tr_b16 v[38:39], v18 offset:1056
    ds_read_b64_tr_b16 v[40:41], v18 offset:16416
    ds_read_b64_tr_b16 v[42:43], v18 offset:17440
    ds_read_b64_tr_b16 v[24:25], v19 offset:0
    ds_read_b64_tr_b16 v[26:27], v19 offset:1024
    v_lshrrev_b32 v49, 4, v0
    v_lshlrev_b32 v49, 5, v49
    v_bfe_u32 v60, v0, 1, 1
    v_lshl_add_u32 v49, v60, 4, v49
    v_bfe_u32 v60, v0, 3, 1
    v_mul_u32_u24 v60, 192, v60
    v_add_u32 v49, v60, v49
    v_add_u32 v49, 156736, v49
    v_bfe_u32 v50, v0, 1, 1
    v_lshlrev_b32 v50, 4, v50
    v_bfe_u32 v60, v0, 3, 1
    v_mul_u32_u24 v60, 192, v60
    v_add_u32 v50, v60, v50
    v_add_u32 v50, 156864, v50
    v_mov_b32 v60, 156896
    v_and_b32 v51, 5, v0
    v_cmp_eq_u32 vcc, 0, v51
    s_nop 1
    v_cndmask_b32 v9, v60, v49, vcc
    v_cmp_eq_u32 vcc, 4, v51
    s_nop 1
    v_cndmask_b32 v10, v60, v49, vcc
    v_lshrrev_b32 v49, 2, v0
    v_and_b32 v49, 12, v49
    v_cmp_eq_u32 vcc, v49, v51
    s_nop 1
    v_cndmask_b32 v48, v60, v50, vcc
    v_mov_b64 v[44:45], 0
    v_mov_b64 v[46:47], 0
    s_lshr_b32 s57, s30, 1
    s_lshl_b32 s57, s57, 11
    s_lshl_b32 s58, s58, 1
    s_add_u32 s57, s57, s58
    s_lshl_b32 s58, s54, 8
    s_add_u32 s57, s57, s58
    v_and_b32 v11, 31, v0
    v_lshlrev_b32 v11, 2, v11
    v_lshrrev_b32 v60, 5, v0
    v_lshl_add_u32 v11, v60, 30, v11
    v_add_u32 v11, s57, v11
    v_xor_b32 v49, 0x40000000, v11
    s_add_u32 s59, s62, 13312
    s_add_u32 s60, s62, 25856
    ds_read_b128 v[12:15], v9
    ds_read_b128 v[16:19], v10
    ds_read_b128 v[20:23], v48
    s_waitcnt lgkmcnt(2)
    v_smfmac_f32_16x16x64_bf16 v[44:47], v[12:15], v[28:35], v1
    s_waitcnt lgkmcnt(1)
    v_smfmac_f32_16x16x64_bf16 v[44:47], v[16:19], v[36:43], v1
    s_waitcnt lgkmcnt(0)
    v_smfmac_f32_16x16x64_bf16 v[44:47], v[20:23], v[24:31], v1
    s_add_u32 s60, s62, 19456
    s_cmp_eq_u32 s55, 0
    s_nop 5
    v_add_f32 v12, v44, v46
    s_cbranch_scc1 L_gs_200
L_pad6:
    s_cbranch_execz L_pad10
    buffer_store_dword v12, v49, s[40:43], s60 offen
L_gb_201:
    v_mov_b64 v[44:45], 0
    v_mov_b64 v[46:47], 0
L_skip_199:
    s_cmp_lt_u32 s30, 6
    s_barrier
    s_cbranch_scc0 L_se_198
    ds_read_b128 v[12:15], v9
    ds_read_b128 v[16:19], v10
    ds_read_b128 v[20:23], v48
    s_waitcnt lgkmcnt(2)
    v_smfmac_f32_16x16x64_bf16 v[44:47], v[12:15], v[28:35], v1
    s_waitcnt lgkmcnt(1)
    v_smfmac_f32_16x16x64_bf16 v[44:47], v[16:19], v[36:43], v1
    s_waitcnt lgkmcnt(0)
    v_smfmac_f32_16x16x64_bf16 v[44:47], v[20:23], v[24:31], v1
    s_cmp_eq_u32 s55, 0
    s_nop 6
    v_add_f32 v12, v44, v46
    s_cbranch_scc1 L_gs_202
    buffer_store_dword v12, v11, s[40:43], s59 offen
L_gb_203:
.p2align 5
L_se_198:
L_p1:
    s_lshl_b32 s57, s30, 7
    s_add_u32 s57, s57, 154624
    v_lshrrev_b32 v58, 4, v0
    v_lshlrev_b32 v58, 5, v58
    v_bfe_u32 v60, v0, 1, 1
    v_lshl_add_u32 v58, v60, 4, v58
    v_bfe_u32 v60, v0, 2, 2
    v_lshl_add_u32 v58, v60, 2, v58
    v_and_b32 v60, 1, v0
    v_lshl_add_u32 v58, v60, 1, v58
    v_add_u32 v58, s57, v58
    v_lshrrev_b32 v61, 4, v0
    v_lshlrev_b32 v61, 5, v61
    v_bfe_u32 v60, v0, 1, 1
    v_lshl_add_u32 v61, v60, 4, v61
    v_add_u32 v61, s57, v61
    v_bfe_u32 v62, v0, 2, 2
    v_lshlrev_b32 v62, 1, v62
    v_and_b32 v60, 1, v0
    v_lshl_add_u32 v62, v60, 0, v62
    v_mov_b32 v60, 156896
    v_cmp_eq_u32 vcc, 0, v62
    s_nop 1
    v_cndmask_b32 v52, v60, v61, vcc
    v_cmp_eq_u32 vcc, 1, v62
    s_nop 1
    v_cndmask_b32 v53, v60, v61, vcc
    v_cmp_eq_u32 vcc, 2, v62
    s_nop 1
    v_cndmask_b32 v54, v60, v61, vcc
    v_cmp_eq_u32 vcc, 3, v62
    s_nop 1
    v_cndmask_b32 v55, v60, v61, vcc
    v_cmp_eq_u32 vcc, 4, v62
    s_nop 1
    v_cndmask_b32 v56, v60, v61, vcc
    v_cmp_eq_u32 vcc, 5, v62
    s_nop 1
    v_cndmask_b32 v57, v60, v61, vcc
    s_lshl_b32 s58, s30, 2
    s_add_u32 s58, s58, 155712
    v_mov_b32 v60, s58
    v_lshlrev_b32 v59, 2, v0
    v_add_u32 v59, 154112, v59
    v_cmp_eq_u32 vcc, 63, v0
    s_nop 1
    v_cndmask_b32 v59, v59, v60, vcc
    v_and_b32 v62, 7, v0
    v_lshlrev_b32 v62, 2, v62
    v_add_u32 v62, 155712, v62
    s_lshl_b32 s57, s30, 10
    v_lshlrev_b32 v63, 4, v0
    v_add_u32 v63, s57, v63
    v_add_u32 v63, 92160, v63
    s_sub_u32 s57, s30, 1
    s_lshl_b32 s58, s57, 11
    v_lshlrev_b32 v7, 4, v0
    v_add_u32 v7, s58, v7
    s_lshl_b32 s58, s57, 7
    v_bfe_u32 v8, v0, 2, 2
    v_lshlrev_b32 v8, 5, v8
    v_lshrrev_b32 v60, 5, v0
    v_lshl_add_u32 v8, v60, 4, v8
    v_and_b32 v60, 3, v0
    v_lshl_add_u32 v8, v60, 2, v8
    v_bfe_u32 v60, v0, 4, 1
    v_lshl_add_u32 v8, v60, 1, v8
    v_add_u32 v8, s58, v8
    v_add_u32 v8, 124928, v8
    s_cmp_eq_u32 s30, 7
    s_cbranch_scc1 L_w7_211
    s_cmp_lt_u32 s30, 6
    s_cbranch_scc0 L_skip_213
    s_lshr_b32 s57, s30, 1
    s_mul_i32 s57, s57, 1024
L_pad7:
    s_cbranch_execz L_pad11
    s_and_b32 s58, s30, 1
    s_lshl_b32 s58, s58, 6
    s_add_u32 s57, s57, s58
    v_lshrrev_b32 v18, 5, v0
    v_mul_u32_u24 v18, 6144, v18
    v_bfe_u32 v60, v0, 3, 1
    v_mul_u32_u24 v60, 3072, v60
    v_add_u32 v18, v60, v18
    v_bfe_u32 v60, v0, 4, 1
    v_lshl_add_u32 v18, v60, 9, v18
    v_bfe_u32 v60, v0, 2, 1
    v_lshl_add_u32 v18, v60, 7, v18
    v_and_b32 v60, 3, v0
    v_lshl_add_u32 v18, v60, 3, v18
    v_add_u32 v18, s57, v18
    v_bfe_u32 v19, v0, 3, 1
    v_mul_u32_u24 v19, 3072, v19
    v_bfe_u32 v60, v0, 4, 1
    v_lshl_add_u32 v19, v60, 9, v19
    v_bfe_u32 v60, v0, 2, 1
    v_lshl_add_u32 v19, v60, 7, v19
    v_and_b32 v60, 3, v0
    v_lshl_add_u32 v19, v60, 3, v19
    v_lshrrev_b32 v60, 5, v0
    v_lshl_add_u32 v19, v60, 5, v19
    v_add_u32 v19, s57, v19
    v_add_u32 v19, 24576, v19
    ds_read_b64_tr_b16 v[28:29], v18 offset:0
    ds_read_b64_tr_b16 v[30:31], v18 offset:256
    ds_read_b64_tr_b16 v[32:33], v18 offset:12288
    ds_read_b64_tr_b16 v[34:35], v18 offset:12544
    ds_read_b64_tr_b16 v[36:37], v18 offset:32
    ds_read_b64_tr_b16 v[38:39], v18 offset:288
    ds_read_b64_tr_b16 v[40:41], v18 offset:12320
    ds_read_b64_tr_b16 v[42:43], v18 offset:12576
    ds_read_b64_tr_b16 v[24:25], v19 offset:0
    ds_read_b64_tr_b16 v[26:27], v19 offset:256
    v_lshrrev_b32 v49, 4, v0
    v_lshlrev_b32 v49, 5, v49
    v_bfe_u32 v60, v0, 1, 1
    v_lshl_add_u32 v49, v60, 4, v49
    v_bfe_u32 v60, v0, 3, 1
    v_mul_u32_u24 v60, 192, v60
    v_add_u32 v49, v60, v49
    v_add_u32 v49, 156736, v49
    v_bfe_u32 v50, v0, 1, 1
    v_lshlrev_b32 v50, 4, v50
    v_bfe_u32 v60, v0, 3, 1
    v_mul_u32_u24 v60, 192, v60
    v_add_u32 v50, v60, v50
    v_add_u32 v50, 156864, v50
    v_mov_b32 v60, 156896
    v_and_b32 v51, 5, v0
    v_cmp_eq_u32 vcc, 0, v51
    s_nop 1
    v_cndmask_b32 v9, v60, v49, vcc
    v_cmp_eq_u32 vcc, 4, v51
    s_nop 1
    v_cndmask_b32 v10, v60, v49, vcc
    v_lshrrev_b32 v49, 2, v0
    v_and_b32 v49, 12, v49
    v_cmp_eq_u32 vcc, v49, v51
    s_nop 1
    v_cndmask_b32 v48, v60, v50, vcc
    v_mov_b64 v[44:45], 0
    v_mov_b64 v[46:47], 0
    s_lshr_b32 s57, s30, 1
    s_lshl_b32 s57, s57, 11
    s_lshl_b32 s58, s58, 1
    s_add_u32 s57, s57, s58
    s_lshl_b32 s58, s54, 8
    s_add_u32 s57, s57, s58
    v_and_b32 v11, 31, v0
    v_lshlrev_b32 v11, 2, v11
    v_lshrrev_b32 v60, 5, v0
    v_lshl_add_u32 v11, v60, 30, v11
    v_add_u32 v11, s57, v11
    s_mul_i32 s59, s53, 6144
    s_add_u32 s59, s59, s62
    s_add_u32 s59, s59, 46080
    s_lshl_b32 s60, s53, 6
    s_add_u32 s60, s60, s62
    s_add_u32 s60, s60, 25600
L_skip_213:
    s_cmp_lt_u32 s30, 6
    s_barrier
L_pad8:
    s_cbranch_execz L_pad12
    s_cbranch_scc0 L_se_212
    ds_read_b128 v[12:15], v9
    ds_read_b128 v[16:19], v10
    ds_read_b128 v[20:23], v48
    s_waitcnt lgkmcnt(2)
    v_smfmac_f32_16x16x64_bf16 v[44:47], v[12:15], v[28:35], v1
    s_waitcnt lgkmcnt(1)
    v_smfmac_f32_16x16x64_bf16 v[44:47], v[16:19], v[36:43], v1
    s_waitcnt lgkmcnt(0)
    v_smfmac_f32_16x16x64_bf16 v[44:47], v[20:23], v[24:31], v1
    s_cmp_eq_u32 s55, 0
    s_nop 6
    v_add_f32 v12, v44, v46
    s_cbranch_scc1 L_gs_214
    buffer_store_dword v12, v11, s[40:43], s59 offen
L_gb_215:
.p2align 5
L_se_212:
    s_sub_u32 s57, s30, 1
    s_cmp_lt_u32 s57, 3
    s_cbranch_scc0 L_qo_229
    v_and_b32 v9, 7, v0
    v_lshlrev_b32 v9, 3, v9
    buffer_load_dwordx2 v[10:11], v9, s[40:43], s60 offen sc1
    buffer_load_dwordx4 v[40:43], v7, s[40:43], s59 offen offset:0 sc1
    buffer_load_dwordx4 v[44:47], v7, s[40:43], s59 offen offset:1024 sc1
    v_mov_b64 v[24:25], 0
    v_mov_b64 v[26:27], 0
    v_mov_b64 v[28:29], 0
    v_mov_b64 v[30:31], 0
    v_mov_b64 v[32:33], 0
    v_mov_b64 v[34:35], 0
    v_mov_b64 v[36:37], 0
    v_mov_b64 v[38:39], 0
    v_lshrrev_b32 v5, 4, v0
    v_lshlrev_b32 v5, 5, v5
    v_bfe_u32 v60, v0, 1, 1
    v_lshl_add_u32 v5, v60, 4, v5
    v_add_u32 v5, 124928, v5
    v_mov_b32 v60, 0x3c75e03e
    v_mov_b32 v61, 0x3a71d1e6
    v_mov_b32 v51, 0x3e13985d
    s_branch L_pw_231
.p2align 5
L_pr_232:
    buffer_load_dwordx2 v[10:11], v9, s[40:43], s60 offen sc1
    buffer_load_dwordx4 v[40:43], v7, s[40:43], s59 offen offset:0 sc1
    buffer_load_dwordx4 v[44:47], v7, s[40:43], s59 offen offset:1024 sc1
    s_sub_u32 s56, s56, 1
    s_cbranch_scc1 L_done
L_pw_231:
    s_waitcnt vmcnt(0)
    v_max_u32 v20, v10, v11
    v_cmp_eq_u32 vcc, -1, v20
    s_cbranch_vccnz L_pr_232
    buffer_load_dwordx4 v[40:43], v7, s[40:43], s59 offen offset:0 sc1
    buffer_load_dwordx4 v[44:47], v7, s[40:43], s59 offen offset:1024 sc1
    v_add_f32_dpp v48, v10, v10 row_ror:4 row_mask:0xf bank_mask:0xf
    v_add_f32_dpp v49, v11, v11 row_ror:4 row_mask:0xf bank_mask:0xf
    v_pk_add_f32 v[20:21], v[40:41], v[44:45]
    v_pk_add_f32 v[22:23], v[42:43], v[46:47]
    v_add_f32_dpp v48, v48, v48 row_ror:2 row_mask:0xf bank_mask:0xf
    v_add_f32_dpp v49, v49, v49 row_ror:2 row_mask:0xf bank_mask:0xf
    v_permlane32_swap_b32 v20, v22
    v_permlane32_swap_b32 v21, v23
    v_add_f32_dpp v48, v48, v48 row_ror:1 row_mask:0xf bank_mask:0xf
    v_add_f32_dpp v49, v49, v49 row_ror:1 row_mask:0xf bank_mask:0xf
    v_pk_add_f32 v[20:21], v[20:21], v[22:23]
    v_mul_f32 v48, v48, v60
    v_fma_f32 v49, v49, v51, v61
    v_permlane16_swap_b32 v20, v21
    v_fma_f32 v49, -v48, v48, v49
    v_add_f32 v20, v20, v21
    v_max_f32 v49, v49, v61
    v_mul_f32 v50, v6, v48
    v_rsq_f32 v49, v49
    v_cmp_u_f32 vcc, v20, v20
    v_sub_f32 v20, v20, v50
    s_cbranch_vccnz L_hr_233
L_hk_234:
    v_mul_f32 v20, v20, v49
    v_cvt_pk_bf16_f32 v20, v20, v20
    ds_write_b16 v8, v20
L_qb_230:
    s_waitcnt lgkmcnt(0)
    s_barrier
    ds_read_b128 v[12:15], v5 offset:0
    ds_read_b128 v[16:19], v5 offset:128
    ds_read_b128 v[20:23], v5 offset:256
    s_cmp_lt_u32 s30, 4
    s_waitcnt lgkmcnt(0)
L_pad9:
    s_cbranch_execz L_pad13
    v_smfmac_f32_16x16x64_bf16 v[24:27], v[12:15], v[64:71], v1
    v_smfmac_f32_16x16x64_bf16 v[24:27], v[16:19], v[72:79], v1
    v_smfmac_f32_16x16x64_bf16 v[24:27], v[20:23], v[80:87], v1
    v_smfmac_f32_16x16x64_bf16 v[28:31], v[12:15], v[88:95], v1
    v_smfmac_f32_16x16x64_bf16 v[28:31], v[16:19], v[96:103], v1
    v_smfmac_f32_16x16x64_bf16 v[28:31], v[20:23], v[104:111], v1
    v_smfmac_f32_16x16x64_bf16 v[32:35], v[12:15], v[112:119], v1
    v_smfmac_f32_16x16x64_bf16 v[32:35], v[16:19], v[120:127], v1
    v_smfmac_f32_16x16x64_bf16 v[32:35], v[20:23], v[128:135], v1
    v_smfmac_f32_16x16x64_bf16 v[36:39], v[12:15], v[136:143], v1
    v_smfmac_f32_16x16x64_bf16 v[36:39], v[16:19], v[144:151], v1
    v_smfmac_f32_16x16x64_bf16 v[36:39], v[20:23], v[152:159], v1
    v_add_f32 v24, v24, v26
    s_waitcnt vmcnt(0)
    v_add_f32 v28, v28, v30
    s_nop 1
    v_add_f32 v32, v32, v34
    v_max3_f32 v61, v24, v28, v32
    v_mov_b32_dpp v24, v28 quad_perm:[0,1,2,3] row_mask:0x2 bank_mask:0xf
    v_add_f32 v36, v36, v38
    v_max_f32 v61, v61, v36
    v_mov_b32_dpp v24, v32 quad_perm:[0,1,2,3] row_mask:0x4 bank_mask:0xf
    s_nop 0
    v_max_f32_dpp v61, v61, v61 row_ror:8 row_mask:0xf bank_mask:0xf
    s_nop 0
    v_mov_b32_dpp v24, v36 quad_perm:[0,1,2,3] row_mask:0x8 bank_mask:0xf
    v_max_f32_dpp v61, v61, v61 row_ror:4 row_mask:0xf bank_mask:0xf
    s_nop 1
    v_max_f32_dpp v61, v61, v61 row_ror:2 row_mask:0xf bank_mask:0xf
    s_nop 1
    v_max_f32_dpp v61, v61, v61 row_ror:1 row_mask:0xf bank_mask:0xf
    v_sub_f32 v36, v24, v61
    ds_write_b32 v59, v61
    v_exp_f32 v36, v36
    s_nop 0
    v_cvt_pk_bf16_f32 v39, v36, v36
    ds_write_b16 v58, v39
    ds_read_b128 v[12:15], v52
    ds_read_b128 v[16:19], v53
    ds_read_b128 v[20:23], v54
    ds_read_b128 v[24:27], v55
    ds_read_b128 v[28:31], v56
    ds_read_b128 v[32:35], v57
    v_add_f32_dpp v38, v36, v36 row_ror:8 row_mask:0xf bank_mask:0xf
    v_mov_b64 v[40:41], 0
    v_mov_b64 v[42:43], 0
    v_add_f32_dpp v38, v38, v38 row_ror:4 row_mask:0xf bank_mask:0xf
    v_mov_b64 v[44:45], 0
    v_mov_b64 v[46:47], 0
    s_waitcnt lgkmcnt(5)
    v_smfmac_f32_16x16x64_bf16 v[40:43], v[12:15], v[160:167], v1
    v_add_f32_dpp v38, v38, v38 row_ror:2 row_mask:0xf bank_mask:0xf
    v_smfmac_f32_16x16x64_bf16 v[44:47], v[12:15], v[208:215], v1
    ds_read_b32 v36, v62
    s_waitcnt lgkmcnt(5)
    v_smfmac_f32_16x16x64_bf16 v[40:43], v[16:19], v[168:175], v1
    v_add_f32_dpp v38, v38, v38 row_ror:1 row_mask:0xf bank_mask:0xf
    v_smfmac_f32_16x16x64_bf16 v[44:47], v[16:19], v[216:223], v1
    s_waitcnt lgkmcnt(4)
    v_smfmac_f32_16x16x64_bf16 v[40:43], v[20:23], v[176:183], v1
    v_add_f32_dpp v38, v38, v38 row_bcast:15 row_mask:0xa bank_mask:0xf
    v_smfmac_f32_16x16x64_bf16 v[44:47], v[20:23], v[224:231], v1
    s_waitcnt lgkmcnt(0)
    v_max_f32_dpp v37, v36, v36 row_ror:4 row_mask:0xf bank_mask:0xf
    v_smfmac_f32_16x16x64_bf16 v[40:43], v[24:27], v[184:191], v1
    v_add_f32_dpp v48, v38, v38 row_bcast:31 row_mask:0x8 bank_mask:0xf
    v_smfmac_f32_16x16x64_bf16 v[44:47], v[24:27], v[232:239], v1
    v_max_f32_dpp v37, v37, v37 row_ror:2 row_mask:0xf bank_mask:0xf
    v_smfmac_f32_16x16x64_bf16 v[40:43], v[28:31], v[192:199], v1
    v_cmp_eq_u32 vcc, -1, v36
    v_smfmac_f32_16x16x64_bf16 v[44:47], v[28:31], v[240:247], v1
    v_max_f32_dpp v37, v37, v37 row_ror:1 row_mask:0xf bank_mask:0xf
    v_smfmac_f32_16x16x64_bf16 v[40:43], v[32:35], v[200:207], v1
    v_sub_f32 v39, v61, v37
    v_smfmac_f32_16x16x64_bf16 v[44:47], v[32:35], v[248:255], v1
    v_exp_f32 v39, v39
L_pad10:
    s_cbranch_execz L_pad14
    s_cbranch_vccnz L_mr_236
L_mk_237:
    s_cmp_lt_u32 s30, 2
    s_nop 2
    v_add_f32_dpp v48, v40, v42 quad_perm:[0,1,2,3] row_mask:0x7 bank_mask:0xf
    v_add_f32 v49, v41, v43
    v_pk_add_f32 v[50:51], v[44:45], v[46:47]
    v_pk_mul_f32 v[48:49], v[48:49], v[38:39] op_sel:[0,1] op_sel_hi:[1,1]
    v_pk_mul_f32 v[50:51], v[50:51], v[38:39] op_sel:[0,1] op_sel_hi:[1,1]
    ds_write_b128 v63, v[48:51]
    s_cbranch_scc1 L_comb_1
    s_waitcnt lgkmcnt(0)
    s_barrier
.p2align 5
L_comb_1b:
    s_cmp_lt_u32 s3, 20
    s_cbranch_scc0 L_typeB_1
    s_mul_i32 s74, s30, 1664
    s_add_u32 s74, s74, s62
    s_add_u32 s74, s74, 26624
    v_and_b32 v56, 7, v0
    v_lshlrev_b32 v56, 2, v56
    v_lshrrev_b32 v62, 4, v0
    v_lshlrev_b32 v62, 3, v62
    buffer_load_dword v52, v56, s[40:43], s74 offen offset:1536 sc1
    buffer_load_dwordx2 v[54:55], v62, s[40:43], s74 offen offset:1536 sc1
    v_lshlrev_b32 v57, 4, v0
    v_lshlrev_b32 v58, 3, v0
    s_mul_i32 s57, s30, 6144
    s_add_u32 s57, s57, 30720
    v_lshrrev_b32 v59, 2, v0
    v_lshlrev_b32 v59, 6, v59
    v_bfe_u32 v53, v0, 4, 1
    v_lshl_add_u32 v59, v53, 5, v59
    v_and_b32 v53, 3, v0
    v_lshl_add_u32 v59, v53, 3, v59
    v_add_u32 v59, s57, v59
    v_xor_b32 v60, 32, v59
    s_lshl_b32 s57, s30, 8
    s_add_u32 s57, s57, 153600
    v_lshl_add_u32 v61, v0, 2, s57
    ds_read_b64_tr_b16 v[28:29], v59 offset:0
    ds_read_b64_tr_b16 v[30:31], v59 offset:1024
    ds_read_b64_tr_b16 v[32:33], v59 offset:2048
    ds_read_b64_tr_b16 v[34:35], v59 offset:3072
    ds_read_b64_tr_b16 v[36:37], v59 offset:4096
    ds_read_b64_tr_b16 v[38:39], v59 offset:5120
    ds_read_b64_tr_b16 v[40:41], v60 offset:0
    ds_read_b64_tr_b16 v[42:43], v60 offset:1024
    ds_read_b64_tr_b16 v[44:45], v60 offset:2048
    ds_read_b64_tr_b16 v[46:47], v60 offset:3072
    ds_read_b64_tr_b16 v[48:49], v60 offset:4096
    ds_read_b64_tr_b16 v[50:51], v60 offset:5120
    v_mov_b64 v[20:21], 0
    v_mov_b64 v[22:23], 0
    v_mov_b64 v[24:25], 0
    v_mov_b64 v[26:27], 0
    s_add_u32 s58, s6, 132096
    s_branch L_pw_244
.p2align 5
L_pr_245:
    buffer_load_dword v52, v56, s[40:43], s74 offen offset:1536 sc1
    buffer_load_dwordx2 v[54:55], v62, s[40:43], s74 offen offset:1536 sc1
    s_sub_u32 s56, s56, 1
    s_cbranch_scc1 L_done
L_pw_244:
    s_waitcnt vmcnt(0)
    v_max3_u32 v53, v52, v54, v55
    v_cmp_eq_u32 vcc, -1, v53
    s_cbranch_vccnz L_pr_245
    buffer_load_dwordx4 v[12:15], v57, s[40:43], s74 offen sc1
    buffer_load_dwordx2 v[16:17], v58, s[40:43], s74 offen offset:1024 sc1
    buffer_load_dword v18, v56, s[40:43], s74 offen offset:1568 sc1
    v_max_f32_dpp v53, v52, v52 row_ror:4 row_mask:0xf bank_mask:0xf
    s_nop 1
    v_max_f32_dpp v53, v53, v53 row_ror:2 row_mask:0xf bank_mask:0xf
    s_nop 1
    v_max_f32_dpp v53, v53, v53 row_ror:1 row_mask:0xf bank_mask:0xf
    v_sub_f32 v52, v52, v53
    v_sub_f32 v54, v54, v53
    v_sub_f32 v55, v55, v53
    v_exp_f32 v52, v52
    v_exp_f32 v54, v54
    v_exp_f32 v55, v55
    s_waitcnt lgkmcnt(0)
L_pad11:
    s_cbranch_execz L_pad15
    s_branch L_ow_246
.p2align 5
L_or_247:
    buffer_load_dwordx4 v[12:15], v57, s[40:43], s74 offen sc1
    buffer_load_dwordx2 v[16:17], v58, s[40:43], s74 offen offset:1024 sc1
    buffer_load_dword v18, v56, s[40:43], s74 offen offset:1568 sc1
    s_sub_u32 s56, s56, 1
    s_cbranch_scc1 L_done
    v_mov_b64 v[20:21], 0
    v_mov_b64 v[22:23], 0
    v_mov_b64 v[24:25], 0
    v_mov_b64 v[26:27], 0
L_ow_246:
    s_waitcnt vmcnt(2)
    v_smfmac_f32_16x16x64_bf16 v[20:23], v[12:15], v[28:35], v1
    s_nop 2
    v_smfmac_f32_16x16x64_bf16 v[24:27], v[12:15], v[40:47], v1
    s_waitcnt vmcnt(0)
    v_mul_f32 v53, v52, v18
    v_smfmac_f32_16x16x32_bf16 v[20:23], v[16:17], v[36:39], v1
    s_nop 2
    v_smfmac_f32_16x16x32_bf16 v[24:27], v[16:17], v[48:51], v1
    v_add_f32_dpp v53, v53, v53 row_ror:4 row_mask:0xf bank_mask:0xf
    v_max3_u32 v19, v12, v13, v14
    v_max3_u32 v62, v15, v16, v17
    v_add_f32_dpp v53, v53, v53 row_ror:2 row_mask:0xf bank_mask:0xf
    v_max3_u32 v19, v19, v62, v18
    s_cmp_eq_u32 s30, 2
    v_add_f32_dpp v53, v53, v53 row_ror:1 row_mask:0xf bank_mask:0xf
    v_cmp_eq_u32 vcc, -1, v19
    v_rcp_f32 v53, v53
    s_cbranch_vccnz L_or_247
    v_pk_add_f32 v[20:21], v[20:21], v[22:23]
    v_pk_add_f32 v[24:25], v[24:25], v[26:27]
    v_pk_mul_f32 v[54:55], v[54:55], v[52:53] op_sel:[0,1] op_sel_hi:[1,1]
    v_mul_f32 v20, v20, v54
    v_mul_f32 v24, v24, v54
    v_fmac_f32 v20, v21, v55
    v_fmac_f32 v24, v25, v55
    s_nop 1
    v_permlane32_swap_b32 v20, v24
    v_add_f32 v20, v20, v24
    ds_write_b32 v61, v20
    s_waitcnt lgkmcnt(0)
    s_barrier
    s_cbranch_scc0 L_finb_248
    ds_read2st64_b32 v[12:13], v2 offset0:0 offset1:1
    ds_read2st64_b32 v[14:15], v2 offset0:2 offset1:3
    ds_read2st64_b32 v[16:17], v2 offset0:4 offset1:5
    ds_read2st64_b32 v[18:19], v2 offset0:6 offset1:7
    s_waitcnt lgkmcnt(2)
    v_pk_add_f32 v[12:13], v[12:13], v[14:15]
    s_waitcnt lgkmcnt(0)
    v_pk_add_f32 v[16:17], v[16:17], v[18:19]
    v_pk_add_f32 v[12:13], v[12:13], v[16:17]
    v_add_f32 v14, v12, v13
    v_add_f32 v15, v12, v13
    s_nop 1
    v_permlane16_swap_b32 v14, v15
    v_add_f32 v12, v14, v15
    buffer_store_dword v12, v3, s[40:43], s58 offen sc1
.p2align 5
L_finb_248:
    s_sub_u32 s57, s30, 4
    s_cmp_lt_u32 s57, 3
    s_cbranch_scc0 L_skip_249
    s_sub_u32 s60, s30, 4
    s_lshl_b32 s57, s60, 11
    v_lshlrev_b32 v11, 4, v0
    v_add_u32 v11, s57, v11
    s_add_u32 s65, s62, 19456
    buffer_load_dwordx4 v[52:55], v11, s[40:43], s65 offen offset:0 sc1
    buffer_load_dwordx4 v[56:59], v11, s[40:43], s65 offen offset:1024 sc1
    s_lshl_b32 s59, s60, 12
    s_add_u32 s59, s59, 79872
    v_bfe_u32 v35, v0, 4, 1
    v_lshlrev_b32 v35, 11, v35
    v_bfe_u32 v60, v0, 2, 2
    v_lshl_add_u32 v35, v60, 8, v35
    v_lshrrev_b32 v60, 5, v0
    v_lshl_add_u32 v35, v60, 6, v35
    v_and_b32 v60, 3, v0
    v_lshl_add_u32 v35, v60, 3, v35
    v_add_u32 v35, s59, v35
    v_mov_b32 v9, 0xbdd2d3e8
L_pad12:
    s_cbranch_execz L_pad16
    v_mov_b32 v10, 0xc0135761
    s_lshl_b32 s57, s60, 7
    s_add_u32 s57, s57, 156160
    v_lshlrev_b32 v32, 3, v0
    v_add_u32 v32, s57, v32
    v_lshlrev_b32 v33, 3, v0
    v_add_u32 v33, 129024, v33
    v_cmp_gt_u32 vcc, 16, v0
    s_nop 1
    v_cndmask_b32 v32, v33, v32, vcc
    v_and_b32 v33, 15, v0
    v_lshlrev_b32 v33, 3, v33
    v_lshrrev_b32 v60, 5, v0
    v_lshl_add_u32 v33, v60, 2, v33
    v_add_u32 v33, 156160, v33
    v_and_b32 v34, 15, v0
    v_lshlrev_b32 v34, 2, v34
    v_lshrrev_b32 v60, 5, v0
    v_lshl_add_u32 v34, v60, 6, v34
    v_bfe_u32 v60, v0, 4, 1
    v_lshl_add_u32 v34, v60, 13, v34
    s_add_u32 s60, s6, 198144
    s_add_u32 s58, s62, 39936
    s_add_u32 s57, s62, 25984
    v_and_b32 v7, 7, v0
    v_lshlrev_b32 v7, 3, v7
    v_mov_b32 v60, 0x3acccccd
    v_mov_b32 v61, 0x3727c5ac
    s_waitcnt vmcnt(0)
    buffer_load_dwordx2 v[24:25], v7, s[40:43], s57 offen sc1
    buffer_load_dwordx4 v[12:15], v11, s[40:43], s58 offen offset:0 sc1
    buffer_load_dwordx4 v[16:19], v11, s[40:43], s58 offen offset:1024 sc1
    ds_read_b64_tr_b16 v[36:37], v35 offset:0
    ds_read_b64_tr_b16 v[38:39], v35 offset:1024
    ds_read_b64_tr_b16 v[40:41], v35 offset:128
    ds_read_b64_tr_b16 v[42:43], v35 offset:1152
    ds_read_b64_tr_b16 v[44:45], v35 offset:32
    ds_read_b64_tr_b16 v[46:47], v35 offset:1056
    ds_read_b64_tr_b16 v[48:49], v35 offset:160
    ds_read_b64_tr_b16 v[50:51], v35 offset:1184
L_sw_252:
    v_max3_u32 v20, v52, v53, v54
    v_max3_u32 v20, v20, v55, v56
    v_max3_u32 v20, v20, v57, v58
    v_max_u32 v20, v20, v59
    v_cmp_eq_u32 vcc, -1, v20
    s_cbranch_vccnz L_sr_253
    v_pk_add_f32 v[28:29], v[52:53], v[56:57]
    v_pk_add_f32 v[30:31], v[54:55], v[58:59]
    s_nop 1
    v_permlane32_swap_b32 v28, v30
    v_permlane32_swap_b32 v29, v31
    v_pk_add_f32 v[28:29], v[28:29], v[30:31]
    s_nop 1
    v_permlane16_swap_b32 v28, v29
    v_add_f32 v28, v28, v29
    v_mov_b64 v[52:53], 0
    v_mov_b64 v[54:55], 0
    v_mov_b64 v[56:57], 0
    v_mov_b64 v[58:59], 0
    s_waitcnt lgkmcnt(0)
    s_branch L_pw_250
.p2align 5
L_pr_251:
    buffer_load_dwordx2 v[24:25], v7, s[40:43], s57 offen sc1
    buffer_load_dwordx4 v[12:15], v11, s[40:43], s58 offen offset:0 sc1
    buffer_load_dwordx4 v[16:19], v11, s[40:43], s58 offen offset:1024 sc1
    s_sub_u32 s56, s56, 1
    s_cbranch_scc1 L_done
L_pw_250:
    s_waitcnt vmcnt(0)
    v_max_u32 v20, v24, v25
    v_cmp_eq_u32 vcc, -1, v20
    s_cbranch_vccnz L_pr_251
    buffer_load_dwordx4 v[12:15], v11, s[40:43], s58 offen offset:0 sc1
    buffer_load_dwordx4 v[16:19], v11, s[40:43], s58 offen offset:1024 sc1
    v_add_f32_dpp v2, v24, v24 row_ror:4 row_mask:0xf bank_mask:0xf
    v_add_f32_dpp v3, v25, v25 row_ror:4 row_mask:0xf bank_mask:0xf
    v_pk_add_f32 v[20:21], v[12:13], v[16:17]
    v_pk_add_f32 v[22:23], v[14:15], v[18:19]
    v_add_f32_dpp v2, v2, v2 row_ror:2 row_mask:0xf bank_mask:0xf
    v_add_f32_dpp v3, v3, v3 row_ror:2 row_mask:0xf bank_mask:0xf
    v_permlane32_swap_b32 v20, v22
    v_permlane32_swap_b32 v21, v23
    v_add_f32_dpp v2, v2, v2 row_ror:1 row_mask:0xf bank_mask:0xf
L_pad13:
    s_cbranch_execz L_pad17
    v_add_f32_dpp v3, v3, v3 row_ror:1 row_mask:0xf bank_mask:0xf
    v_pk_add_f32 v[20:21], v[20:21], v[22:23]
    v_mul_f32 v2, v2, v60
    v_fma_f32 v3, v3, v60, v61
    v_permlane16_swap_b32 v20, v21
    v_fma_f32 v3, -v2, v2, v3
    v_add_f32 v20, v20, v21
    v_max_f32 v3, v3, v61
    v_mul_f32 v26, v28, v2
    v_rsq_f32 v3, v3
    v_cmp_u_f32 vcc, v20, v20
    v_sub_f32 v20, v20, v26
    s_cbranch_vccnz L_hr_254
L_hk_255:
    v_fma_f32 v20, v20, v3, v4
    v_mul_f32 v21, v20, v20
    v_mul_f32 v22, v20, v9
    v_mul_f32 v23, v20, v10
    v_fma_f32 v21, v21, v22, v23
    v_exp_f32 v21, v21
    s_nop 0
    v_add_f32 v21, 1.0, v21
    v_rcp_f32 v21, v21
    s_nop 0
    v_mul_f32 v20, v20, v21
    s_nop 1
    v_mov_b32_dpp v21, v20 row_shl:1 row_mask:0xf bank_mask:0xf bound_ctrl:0
    v_cvt_pk_bf16_f32 v28, v20, v21
    s_nop 1
    v_mov_b32_dpp v29, v28 row_shl:4 row_mask:0xf bank_mask:0xf bound_ctrl:0
    v_mov_b32_dpp v30, v28 row_shl:8 row_mask:0xf bank_mask:0xf bound_ctrl:0
    v_mov_b32_dpp v31, v28 row_shl:12 row_mask:0xf bank_mask:0xf bound_ctrl:0
    s_nop 1
    v_smfmac_f32_16x16x64_bf16 v[52:55], v[28:31], v[36:43], v1
    v_smfmac_f32_16x16x64_bf16 v[56:59], v[28:31], v[44:51], v1
    s_cmp_eq_u32 s30, 4
    s_nop 5
    v_add_f32 v22, v52, v54
    v_add_f32 v23, v56, v58
    ds_write_b64 v32, v[22:23]
    s_cbranch_scc0 L_skip_257
L_xw_258:
    ds_read2_b32 v[20:21], v33 offset0:0 offset1:32
    ds_read_b32 v22, v33 offset:256
    s_sub_u32 s56, s56, 1
    s_cbranch_scc1 L_done
    s_waitcnt lgkmcnt(0)
    v_max3_u32 v23, v20, v21, v22
    v_add_f32 v20, v20, v21
    v_cmp_eq_u32 vcc, -1, v23
    v_add_f32 v20, v20, v22
    s_cbranch_vccnz L_xw_258
    buffer_store_dword v20, v34, s[40:43], s60 offen sc1
L_skip_257:
L_skip_249:
    s_branch L_done
.p2align 5
L_typeB_1:
    s_cmp_eq_u32 s53, 3
    s_cbranch_scc0 L_typeC_259
    s_cmp_eq_u32 s30, 7
    s_cbranch_scc1 L_w7_264
    s_cmp_lt_u32 s30, 6
    s_cbranch_scc0 L_skip_266
    s_lshr_b32 s57, s30, 1
    s_mul_i32 s57, s57, 128
    s_and_b32 s58, s30, 1
    s_lshl_b32 s58, s58, 6
    s_add_u32 s57, s57, s58
    v_lshrrev_b32 v18, 5, v0
    v_lshlrev_b32 v18, 13, v18
    v_bfe_u32 v60, v0, 3, 1
    v_lshl_add_u32 v18, v60, 12, v18
    v_bfe_u32 v60, v0, 4, 1
    v_lshl_add_u32 v18, v60, 11, v18
    v_bfe_u32 v60, v0, 2, 1
    v_mul_u32_u24 v60, 384, v60
    v_add_u32 v18, v60, v18
    v_and_b32 v60, 3, v0
    v_lshl_add_u32 v18, v60, 3, v18
    v_add_u32 v18, s57, v18
    v_add_u32 v18, 30720, v18
    v_bfe_u32 v19, v0, 3, 1
    v_lshlrev_b32 v19, 12, v19
    v_bfe_u32 v60, v0, 4, 1
    v_lshl_add_u32 v19, v60, 11, v19
    v_bfe_u32 v60, v0, 2, 1
    v_mul_u32_u24 v60, 384, v60
    v_add_u32 v19, v60, v19
    v_and_b32 v60, 3, v0
    v_lshl_add_u32 v19, v60, 3, v19
    v_lshrrev_b32 v60, 5, v0
    v_lshl_add_u32 v19, v60, 5, v19
    v_add_u32 v19, s57, v19
    v_add_u32 v19, 63488, v19
    ds_read_b64_tr_b16 v[28:29], v18 offset:0
L_pad14:
    s_cbranch_execz L_pad18
    ds_read_b64_tr_b16 v[30:31], v18 offset:1024
    ds_read_b64_tr_b16 v[32:33], v18 offset:16384
    ds_read_b64_tr_b16 v[34:35], v18 offset:17408
    ds_read_b64_tr_b16 v[36:37], v18 offset:32
    ds_read_b64_tr_b16 v[38:39], v18 offset:1056
    ds_read_b64_tr_b16 v[40:41], v18 offset:16416
    ds_read_b64_tr_b16 v[42:43], v18 offset:17440
    ds_read_b64_tr_b16 v[24:25], v19 offset:0
    ds_read_b64_tr_b16 v[26:27], v19 offset:1024
    v_lshrrev_b32 v49, 4, v0
    v_lshlrev_b32 v49, 5, v49
    v_bfe_u32 v60, v0, 1, 1
    v_lshl_add_u32 v49, v60, 4, v49
    v_bfe_u32 v60, v0, 3, 1
    v_mul_u32_u24 v60, 192, v60
    v_add_u32 v49, v60, v49
    v_add_u32 v49, 156736, v49
    v_bfe_u32 v50, v0, 1, 1
    v_lshlrev_b32 v50, 4, v50
    v_bfe_u32 v60, v0, 3, 1
    v_mul_u32_u24 v60, 192, v60
    v_add_u32 v50, v60, v50
    v_add_u32 v50, 156864, v50
    v_mov_b32 v60, 156896
    v_and_b32 v51, 5, v0
    v_cmp_eq_u32 vcc, 0, v51
    s_nop 1
    v_cndmask_b32 v9, v60, v49, vcc
    v_cmp_eq_u32 vcc, 4, v51
    s_nop 1
    v_cndmask_b32 v10, v60, v49, vcc
    v_lshrrev_b32 v49, 2, v0
    v_and_b32 v49, 12, v49
    v_cmp_eq_u32 vcc, v49, v51
    s_nop 1
    v_cndmask_b32 v48, v60, v50, vcc
    v_mov_b64 v[44:45], 0
    v_mov_b64 v[46:47], 0
    s_lshr_b32 s57, s30, 1
    s_lshl_b32 s57, s57, 11
    s_lshl_b32 s58, s58, 1
    s_add_u32 s57, s57, s58
    s_lshl_b32 s58, s54, 8
    s_add_u32 s57, s57, s58
    v_and_b32 v11, 31, v0
    v_lshlrev_b32 v11, 2, v11
    v_lshrrev_b32 v60, 5, v0
    v_lshl_add_u32 v11, v60, 30, v11
    v_add_u32 v11, s57, v11
    s_add_u32 s59, s62, 39936
    s_add_u32 s60, s62, 25984
L_skip_266:
    s_cmp_lt_u32 s30, 6
    s_barrier
    s_cbranch_scc0 L_se_265
    ds_read_b128 v[12:15], v9
    ds_read_b128 v[16:19], v10
    ds_read_b128 v[20:23], v48
    s_waitcnt lgkmcnt(2)
    v_smfmac_f32_16x16x64_bf16 v[44:47], v[12:15], v[28:35], v1
    s_waitcnt lgkmcnt(1)
    v_smfmac_f32_16x16x64_bf16 v[44:47], v[16:19], v[36:43], v1
    s_waitcnt lgkmcnt(0)
    v_smfmac_f32_16x16x64_bf16 v[44:47], v[20:23], v[24:31], v1
    s_cmp_eq_u32 s55, 0
    s_nop 6
    v_add_f32 v12, v44, v46
    s_cbranch_scc1 L_gs_267
    buffer_store_dword v12, v11, s[40:43], s59 offen
L_gb_268:
.p2align 5
L_se_265:
    s_cmp_eq_u32 s30, 7
    s_cbranch_scc0 L_done
    s_cmp_eq_u32 s31, 0
    s_cbranch_scc0 L_done
    v_lshlrev_b32 v60, 16, v4
    v_add_f32 v2, v2, v60
    v_and_b32 v60, 0xffff0000, v4
    v_add_f32 v3, v3, v60
    v_and_b32 v60, 31, v0
    v_min_u32 v60, 19, v60
    s_mul_i32 s57, s54, 160
    v_lshrrev_b32 v7, 5, v0
    v_lshlrev_b32 v7, 2, v7
    v_add_u32 v7, s57, v7
    v_lshl_add_u32 v7, v60, 3, v7
    s_add_u32 s57, s7, 198144
    s_add_u32 s58, s7, 214528
    s_add_u32 s59, s7, 230912
L_pad15:
    s_cbranch_execz L_pad19
    s_add_u32 s60, s7, 247296
    v_mov_b64 v[36:37], 0
    v_mov_b64 v[38:39], 0
    s_nop 0
    v_mov_b32_dpp v36, v2 quad_perm:[0,1,2,3] row_mask:0x3 bank_mask:0xf
    v_mov_b32_dpp v37, v3 quad_perm:[0,1,2,3] row_mask:0x3 bank_mask:0xf
    v_mov_b32_dpp v38, v2 quad_perm:[0,1,2,3] row_mask:0xc bank_mask:0xf
    v_mov_b32_dpp v39, v3 quad_perm:[0,1,2,3] row_mask:0xc bank_mask:0xf
    s_add_u32 s75, s7, 266252
    v_and_b32 v9, 7, v0
    v_lshlrev_b32 v9, 9, v9
.p2align 5
L_pr_280:
    buffer_load_dword v12, v9, s[40:43], s75 offen sc1
    s_sub_u32 s56, s56, 1
    s_cbranch_scc1 L_done
L_pw_279:
    s_waitcnt vmcnt(0)
    v_cmp_eq_u32 vcc, -1, v12
    s_cbranch_vccnz L_pr_280
L_gw_276:
    buffer_load_dwordx4 v[12:15], v5, s[40:43], s57 offen sc1
    buffer_load_dwordx4 v[16:19], v5, s[40:43], s58 offen sc1
    buffer_load_dwordx4 v[20:23], v5, s[40:43], s59 offen sc1
    buffer_load_dwordx4 v[24:27], v5, s[40:43], s60 offen sc1
    s_sub_u32 s56, s56, 1
    s_cbranch_scc1 L_done
    s_and_b32 s74, s56, 31
    s_waitcnt vmcnt(3)
    v_pk_add_f32 v[28:29], v[12:13], v[36:37]
    v_pk_add_f32 v[30:31], v[14:15], v[38:39]
    s_waitcnt vmcnt(2)
    v_pk_add_f32 v[28:29], v[28:29], v[16:17]
    v_pk_add_f32 v[30:31], v[30:31], v[18:19]
    s_waitcnt vmcnt(1)
    v_pk_add_f32 v[28:29], v[28:29], v[20:21]
    v_pk_add_f32 v[30:31], v[30:31], v[22:23]
    s_waitcnt vmcnt(0)
    v_pk_add_f32 v[28:29], v[28:29], v[24:25]
    v_pk_add_f32 v[30:31], v[30:31], v[26:27]
    v_pk_add_f32 v[32:33], v[28:29], v[30:31]
    v_cmp_u_f32 vcc, v32, v33
    v_permlane32_swap_b32 v28, v30
    v_permlane32_swap_b32 v29, v31
    s_cbranch_vccnz L_gr_277
L_gk_278:
    v_pk_add_f32 v[28:29], v[28:29], v[30:31]
    v_cvt_pk_bf16_f32 v28, v28, v29
    global_store_dword v7, v28, s[24:25]
    s_branch L_done
.p2align 5
L_gs_40:
    buffer_store_dword v33, v34, s[40:43], s67 offen sc1
    s_branch L_gb_41
.p2align 5
L_gs_43:
    buffer_store_dword v12, v54, s[40:43], s59 offen sc1
    s_branch L_gb_44
.p2align 5
L_cr_61:
    s_sub_u32 s56, s56, 1
    s_cbranch_scc1 L_done
    global_load_dword v2, v3, s[26:27] sc1
    s_waitcnt vmcnt(0)
    s_branch L_cw_60
.p2align 5
L_far_62:
    s_lshl_b32 s57, s52, 2
    s_add_u32 s57, s57, s72
    s_mov_b64 exec, 1
    buffer_store_dword v25, v0, s[40:43], s57 offen offset:128 sc1
    s_mov_b64 exec, -1
    s_branch L_fb_63
.p2align 5
L_cr_85:
    s_sub_u32 s56, s56, 1
    s_cbranch_scc1 L_done
    buffer_load_dword v2, v24, s[40:43], s72 offen sc1
    s_branch L_cw_84
.p2align 5
L_gs_93:
    buffer_store_dword v33, v34, s[40:43], s67 offen sc1
    s_branch L_gb_94
.p2align 5
L_gs_96:
L_pad16:
    s_cbranch_execz L_pad20
    buffer_store_dword v12, v54, s[40:43], s59 offen sc1
    s_branch L_gb_97
.p2align 5
L_gs_120:
    buffer_store_dword v37, v4, s[40:43], s58 offen sc1
    s_branch L_gb_121
.p2align 5
L_cr_139:
    s_sub_u32 s56, s56, 1
    s_cbranch_scc1 L_done
    global_load_dword v2, v3, s[26:27] offset:4 sc1
    s_branch L_cw_138
.p2align 5
L_cr_160:
    buffer_load_dword v52, v56, s[40:43], s74 offen offset:1536 sc1
    buffer_load_dwordx2 v[54:55], v62, s[40:43], s74 offen offset:1536 sc1
    s_sub_u32 s56, s56, 1
    s_cbranch_scc1 L_done
    s_branch L_cw_159
.p2align 5
L_gs_167:
    buffer_store_dword v14, v3, s[40:43], s57 offen sc1
    s_branch L_gb_168
.p2align 5
L_gs_169:
    buffer_store_dword v12, v4, s[40:43], s57 offen offset:32 sc1
    s_branch L_gb_170
.p2align 5
L_comb_0:
    s_mov_b32 s57, 0
    s_cmp_eq_u32 s55, 0
    s_waitcnt lgkmcnt(0)
    s_barrier
    ds_read2st64_b64 v[12:15], v2 offset0:0 offset1:2
    ds_read2st64_b64 v[16:19], v2 offset0:4 offset1:6
    ds_read2st64_b64 v[20:23], v2 offset0:8 offset1:10
    ds_read2st64_b64 v[24:27], v2 offset0:12 offset1:14
    s_waitcnt lgkmcnt(2)
    v_pk_add_f32 v[12:13], v[12:13], v[14:15]
    v_pk_add_f32 v[16:17], v[16:17], v[18:19]
    v_pk_add_f32 v[12:13], v[12:13], v[16:17]
    s_waitcnt lgkmcnt(0)
    v_pk_add_f32 v[20:21], v[20:21], v[22:23]
    v_pk_add_f32 v[24:25], v[24:25], v[26:27]
    v_pk_add_f32 v[12:13], v[12:13], v[20:21]
    v_pk_add_f32 v[12:13], v[12:13], v[24:25]
    v_cvt_pk_bf16_f32 v14, v12, v13
    v_min_u32 v14, -2, v14
    s_cbranch_scc1 L_gs_167
    buffer_store_dword v14, v3, s[40:43], s57 offen
L_gb_168:
    s_cbranch_scc1 L_gs_169
    buffer_store_dword v12, v4, s[40:43], s57 offen offset:32
L_gb_170:
    s_branch L_comb_0b
.p2align 5
L_sr_179:
    buffer_load_dwordx4 v[52:55], v11, s[40:43], s65 offen offset:0 sc1
    buffer_load_dwordx4 v[56:59], v11, s[40:43], s65 offen offset:1024 sc1
    s_sub_u32 s56, s56, 1
    s_cbranch_scc1 L_done
    s_waitcnt vmcnt(0)
    s_branch L_sw_178
L_hr_180:
    buffer_load_dwordx4 v[12:15], v11, s[40:43], s58 offen offset:0 sc1
    buffer_load_dwordx4 v[16:19], v11, s[40:43], s58 offen offset:1024 sc1
    s_sub_u32 s56, s56, 1
    s_cbranch_scc1 L_done
    s_and_b32 s64, s56, 31
    s_cbranch_scc0 L_hx_182
    s_waitcnt vmcnt(2)
    v_pk_add_f32 v[20:21], v[12:13], v[16:17]
    v_pk_add_f32 v[22:23], v[14:15], v[18:19]
    s_nop 1
    v_permlane32_swap_b32 v20, v22
    v_permlane32_swap_b32 v21, v23
    v_pk_add_f32 v[20:21], v[20:21], v[22:23]
    s_nop 1
    v_permlane16_swap_b32 v20, v21
    v_add_f32 v20, v20, v21
    v_cmp_u_f32 vcc, v20, v20
    v_sub_f32 v20, v20, v26
    s_cbranch_vccnz L_hr_180
    s_branch L_hk_181
.p2align 5
L_hx_182:
L_pad17:
    s_cbranch_execz L_pad21
    s_waitcnt vmcnt(0)
    v_max3_u32 v20, v12, v13, v14
    v_max3_u32 v20, v20, v15, v16
    v_max3_u32 v20, v20, v17, v18
    v_max_u32 v20, v20, v19
    v_cmp_eq_u32 vcc, -1, v20
    s_cbranch_vccnz L_hr_180
    v_pk_add_f32 v[20:21], v[12:13], v[16:17]
    v_pk_add_f32 v[22:23], v[14:15], v[18:19]
    s_nop 1
    v_permlane32_swap_b32 v20, v22
    v_permlane32_swap_b32 v21, v23
    v_pk_add_f32 v[20:21], v[20:21], v[22:23]
    s_nop 1
    v_permlane16_swap_b32 v20, v21
    v_add_f32 v20, v20, v21
    v_sub_f32 v20, v20, v26
    s_branch L_hk_181
.p2align 5
L_gs_190:
    buffer_store_dword v0, v11, s[40:43], s58 offen sc1
    s_branch L_gb_191
.p2align 5
L_typeC_186:
    s_cmp_eq_u32 s30, 6
    s_cbranch_scc0 L_p1
    s_bitcmp1_b32 s3, 0
    s_cbranch_scc0 L_skip_187
    v_and_b32 v11, 3, v0
    v_lshlrev_b32 v11, 7, v11
    v_lshrrev_b32 v60, 2, v0
    v_lshl_add_u32 v11, v60, 24, v11
    s_add_u32 s58, s62, 26116
    s_add_u32 s75, s7, 266244
    v_and_b32 v9, 7, v0
    v_lshlrev_b32 v9, 9, v9
.p2align 5
L_pr_189:
    buffer_load_dword v12, v9, s[40:43], s75 offen sc1
    s_sub_u32 s56, s56, 1
    s_cbranch_scc1 L_done
L_pw_188:
    s_waitcnt vmcnt(0)
    v_cmp_eq_u32 vcc, -1, v12
    s_cbranch_vccnz L_pr_189
    s_cmp_eq_u32 s55, 0
    s_cbranch_scc1 L_gs_190
    buffer_store_dword v0, v11, s[40:43], s58 offen
L_gb_191:
    s_waitcnt vmcnt(1)
    s_branch L_p1
.p2align 5
L_skip_187:
    s_lshl_b32 s59, s31, 9
    s_add_u32 s59, s59, s8
    s_add_u32 s59, s59, 266240
    v_and_b32 v10, 1, v0
    v_lshlrev_b32 v10, 13, v10
    v_lshrrev_b32 v60, 1, v0
    v_lshl_add_u32 v10, v60, 24, v10
    s_cmp_eq_u32 s3, 20
    s_cbranch_scc0 L_skip_192
    s_add_u32 s58, s62, 1568
    v_lshrrev_b32 v9, 3, v0
    v_mul_u32_u24 v9, 1664, v9
    v_and_b32 v60, 7, v0
    v_lshl_add_u32 v9, v60, 2, v9
.p2align 5
L_pr_194:
    buffer_load_dword v12, v9, s[40:43], s58 offen sc1
    s_sub_u32 s56, s56, 1
    s_cbranch_scc1 L_done
L_pw_193:
    s_waitcnt vmcnt(0)
    v_cmp_eq_u32 vcc, -1, v12
    s_cbranch_vccnz L_pr_194
    buffer_store_dword v0, v10, s[40:43], s59 offen offset:0 sc1
L_skip_192:
    s_add_u32 s58, s62, 25856
    v_and_b32 v9, 15, v0
    v_lshlrev_b32 v9, 2, v9
.p2align 5
L_pr_196:
    buffer_load_dword v13, v9, s[40:43], s58 offen sc1
    s_sub_u32 s56, s56, 1
    s_cbranch_scc1 L_done
L_pw_195:
    s_waitcnt vmcnt(0)
    v_cmp_eq_u32 vcc, -1, v13
    s_cbranch_vccnz L_pr_196
    buffer_store_dword v0, v10, s[40:43], s59 offen offset:4 sc1
    s_waitcnt vmcnt(1)
    s_branch L_p1
.p2align 5
L_gs_200:
L_pad18:
    s_cbranch_execz L_pad22
    buffer_store_dword v12, v49, s[40:43], s60 offen sc1
    s_branch L_gb_201
.p2align 5
L_gs_202:
    buffer_store_dword v12, v11, s[40:43], s59 offen sc1
    s_branch L_gb_203
.p2align 5
L_gr_205:
    s_cbranch_scc1 L_gw_204
    s_waitcnt vmcnt(0)
    v_max3_u32 v32, v12, v13, v14
    v_max3_u32 v32, v32, v15, v16
    v_max3_u32 v32, v32, v17, v18
    v_max3_u32 v32, v32, v19, v20
    v_max3_u32 v32, v32, v21, v22
    v_max3_u32 v32, v32, v23, v24
    v_max3_u32 v32, v32, v25, v26
    v_max_u32 v32, v32, v27
    v_cmp_eq_u32 vcc, -1, v32
    s_cbranch_vccnz L_gw_204
    v_pk_add_f32 v[28:29], v[12:13], v[36:37]
    v_pk_add_f32 v[30:31], v[14:15], v[38:39]
    v_pk_add_f32 v[28:29], v[28:29], v[16:17]
    v_pk_add_f32 v[30:31], v[30:31], v[18:19]
    v_pk_add_f32 v[28:29], v[28:29], v[20:21]
    v_pk_add_f32 v[30:31], v[30:31], v[22:23]
    v_pk_add_f32 v[28:29], v[28:29], v[24:25]
    v_pk_add_f32 v[30:31], v[30:31], v[26:27]
    s_nop 1
    v_permlane32_swap_b32 v28, v30
    v_permlane32_swap_b32 v29, v31
    s_branch L_gk_206
.p2align 5
L_gs_209:
    buffer_store_dword v33, v34, s[40:43], s67 offen sc1
    s_branch L_gb_210
.p2align 5
L_w7_197:
    v_and_b32 v60, 31, v0
    v_min_u32 v60, 19, v60
    s_mul_i32 s57, s54, 320
    v_lshrrev_b32 v5, 5, v0
    v_lshlrev_b32 v5, 12, v5
    v_add_u32 v5, s57, v5
    v_lshl_add_u32 v5, v60, 4, v5
    v_and_b32 v60, 31, v0
    v_cmp_gt_u32 s[64:65], 20, v60
    v_min_u32 v60, 19, v60
    v_lshrrev_b32 v35, 5, v0
    v_lshlrev_b32 v35, 2, v35
    v_add_u32 v35, 156736, v35
    v_lshl_add_u32 v35, v60, 3, v35
    s_add_u32 s66, s62, 13312
    s_add_u32 s67, s62, 25856
    s_lshl_b32 s57, s54, 3
    v_lshrrev_b32 v34, 5, v0
    v_lshlrev_b32 v34, 2, v34
    v_add_u32 v34, s57, v34
    v_and_b32 v60, 31, v0
    v_mov_b32 v61, 0x7f000000
    v_cmp_ne_u32 vcc, 31, v60
    s_nop 1
    v_cndmask_b32 v34, v34, v61, vcc
    v_mov_b32 v61, 0x3f803f80
    s_add_u32 s57, s7, 0
    s_add_u32 s58, s7, 16384
    s_add_u32 s59, s7, 32768
    s_add_u32 s60, s7, 49152
    v_mov_b64 v[36:37], 0
    v_mov_b64 v[38:39], 0
    s_nop 0
    v_mov_b32_dpp v36, v2 quad_perm:[0,1,2,3] row_mask:0x3 bank_mask:0xf
    v_mov_b32_dpp v37, v3 quad_perm:[0,1,2,3] row_mask:0x3 bank_mask:0xf
    v_mov_b32_dpp v38, v2 quad_perm:[0,1,2,3] row_mask:0xc bank_mask:0xf
    v_mov_b32_dpp v39, v3 quad_perm:[0,1,2,3] row_mask:0xc bank_mask:0xf
    s_add_u32 s75, s7, 266240
    v_and_b32 v9, 7, v0
    v_lshlrev_b32 v9, 9, v9
.p2align 5
L_pr_208:
L_pad19:
    s_cbranch_execz L_pad23
    buffer_load_dword v12, v9, s[40:43], s75 offen sc1
    s_sub_u32 s56, s56, 1
    s_cbranch_scc1 L_done
L_pw_207:
    s_waitcnt vmcnt(0)
    v_cmp_eq_u32 vcc, -1, v12
    s_cbranch_vccnz L_pr_208
L_gw_204:
    buffer_load_dwordx4 v[12:15], v5, s[40:43], s57 offen sc1
    buffer_load_dwordx4 v[16:19], v5, s[40:43], s58 offen sc1
    buffer_load_dwordx4 v[20:23], v5, s[40:43], s59 offen sc1
    buffer_load_dwordx4 v[24:27], v5, s[40:43], s60 offen sc1
    s_sub_u32 s56, s56, 1
    s_cbranch_scc1 L_done
    s_and_b32 s74, s56, 31
    s_waitcnt vmcnt(3)
    v_pk_add_f32 v[28:29], v[12:13], v[36:37]
    v_pk_add_f32 v[30:31], v[14:15], v[38:39]
    s_waitcnt vmcnt(2)
    v_pk_add_f32 v[28:29], v[28:29], v[16:17]
    v_pk_add_f32 v[30:31], v[30:31], v[18:19]
    s_waitcnt vmcnt(1)
    v_pk_add_f32 v[28:29], v[28:29], v[20:21]
    v_pk_add_f32 v[30:31], v[30:31], v[22:23]
    s_waitcnt vmcnt(0)
    v_pk_add_f32 v[28:29], v[28:29], v[24:25]
    v_pk_add_f32 v[30:31], v[30:31], v[26:27]
    v_pk_add_f32 v[32:33], v[28:29], v[30:31]
    v_cmp_u_f32 vcc, v32, v33
    v_permlane32_swap_b32 v28, v30
    v_permlane32_swap_b32 v29, v31
    s_cbranch_vccnz L_gr_205
L_gk_206:
    v_pk_add_f32 v[28:29], v[28:29], v[30:31]
    v_cvt_pk_bf16_f32 v28, v28, v29
    ds_write_b32 v35, v28
    v_cndmask_b32 v29, 0, v28, s[64:65]
    v_dot2_f32_bf16 v33, v29, v61, 0
    v_dot2_f32_bf16 v32, v29, v29, 0
    v_lshlrev_b32 v2, 16, v28
    v_and_b32 v3, 0xffff0000, v28
    s_cmp_eq_u32 s55, 0
    v_permlane32_swap_b32 v33, v32
    v_add_f32 v33, v33, v32
    s_waitcnt lgkmcnt(0)
    s_barrier
    v_add_f32_dpp v33, v33, v33 row_ror:8 row_mask:0xf bank_mask:0xf
    s_nop 1
    v_add_f32_dpp v33, v33, v33 row_ror:4 row_mask:0xf bank_mask:0xf
    s_nop 1
    v_add_f32_dpp v33, v33, v33 row_ror:2 row_mask:0xf bank_mask:0xf
    s_nop 1
    v_add_f32_dpp v33, v33, v33 row_ror:1 row_mask:0xf bank_mask:0xf
    s_nop 1
    v_add_f32_dpp v33, v33, v33 row_bcast:15 row_mask:0xa bank_mask:0xf
    s_cbranch_scc1 L_gs_209
    buffer_store_dword v33, v34, s[40:43], s67 offen
L_gb_210:
    s_waitcnt vmcnt(1)
    s_branch L_se_198
.p2align 5
L_gs_214:
    buffer_store_dword v12, v11, s[40:43], s59 offen sc1
    s_branch L_gb_215
.p2align 5
L_gr_220:
    s_cbranch_scc1 L_gw_219
    s_waitcnt vmcnt(0)
    v_max3_u32 v32, v12, v13, v14
    v_max3_u32 v32, v32, v15, v16
    v_max3_u32 v32, v32, v17, v18
    v_max3_u32 v32, v32, v19, v20
    v_max3_u32 v32, v32, v21, v22
    v_max3_u32 v32, v32, v23, v24
    v_max3_u32 v32, v32, v25, v26
    v_max_u32 v32, v32, v27
    v_cmp_eq_u32 vcc, -1, v32
    s_cbranch_vccnz L_gw_219
    v_pk_add_f32 v[28:29], v[12:13], v[36:37]
    v_pk_add_f32 v[30:31], v[14:15], v[38:39]
    v_pk_add_f32 v[28:29], v[28:29], v[16:17]
    v_pk_add_f32 v[30:31], v[30:31], v[18:19]
    v_pk_add_f32 v[28:29], v[28:29], v[20:21]
    v_pk_add_f32 v[30:31], v[30:31], v[22:23]
    v_pk_add_f32 v[28:29], v[28:29], v[24:25]
L_pad20:
    s_cbranch_execz L_pad24
    v_pk_add_f32 v[30:31], v[30:31], v[26:27]
    s_nop 1
    v_permlane32_swap_b32 v28, v30
    v_permlane32_swap_b32 v29, v31
    s_branch L_gk_221
L_gr_223:
    s_cbranch_scc1 L_gw_222
    s_waitcnt vmcnt(0)
    v_max3_u32 v32, v12, v13, v14
    v_max3_u32 v32, v32, v15, v16
    v_max3_u32 v32, v32, v17, v18
    v_max3_u32 v32, v32, v19, v20
    v_max3_u32 v32, v32, v21, v22
    v_max3_u32 v32, v32, v23, v24
    v_max3_u32 v32, v32, v25, v26
    v_max_u32 v32, v32, v27
    v_cmp_eq_u32 vcc, -1, v32
    s_cbranch_vccnz L_gw_222
    v_pk_add_f32 v[28:29], v[12:13], v[36:37]
    v_pk_add_f32 v[30:31], v[14:15], v[38:39]
    v_pk_add_f32 v[28:29], v[28:29], v[16:17]
    v_pk_add_f32 v[30:31], v[30:31], v[18:19]
    v_pk_add_f32 v[28:29], v[28:29], v[20:21]
    v_pk_add_f32 v[30:31], v[30:31], v[22:23]
    v_pk_add_f32 v[28:29], v[28:29], v[24:25]
    v_pk_add_f32 v[30:31], v[30:31], v[26:27]
    s_nop 1
    v_permlane32_swap_b32 v28, v30
    v_permlane32_swap_b32 v29, v31
    s_branch L_gk_224
.p2align 5
L_gs_227:
    buffer_store_dword v33, v34, s[40:43], s67 offen sc1
    s_branch L_gb_228
.p2align 5
L_w7_211:
    v_and_b32 v60, 31, v0
    v_min_u32 v60, 19, v60
    s_mul_i32 s57, s54, 320
    v_lshrrev_b32 v5, 5, v0
    v_lshlrev_b32 v5, 12, v5
    v_add_u32 v5, s57, v5
    v_lshl_add_u32 v5, v60, 4, v5
    v_and_b32 v60, 31, v0
    v_cmp_gt_u32 s[64:65], 20, v60
    v_min_u32 v60, 19, v60
    v_lshrrev_b32 v35, 5, v0
    v_lshlrev_b32 v35, 2, v35
    v_add_u32 v35, 156736, v35
    v_lshl_add_u32 v35, v60, 3, v35
    s_mul_i32 s66, s53, 6144
    s_add_u32 s66, s66, s62
    s_add_u32 s66, s66, 46080
    s_lshl_b32 s67, s53, 6
    s_add_u32 s67, s67, s62
    s_add_u32 s67, s67, 25600
    s_lshl_b32 s57, s54, 3
    v_lshrrev_b32 v34, 5, v0
    v_lshlrev_b32 v34, 2, v34
    v_add_u32 v34, s57, v34
    v_and_b32 v60, 31, v0
    v_mov_b32 v61, 0x7f000000
    v_cmp_ne_u32 vcc, 31, v60
    s_nop 1
    v_cndmask_b32 v34, v34, v61, vcc
    v_mov_b32 v61, 0x3f803f80
    s_cmp_lg_u32 s53, 3
    s_cbranch_scc0 L_skip_216
    s_add_u32 s57, s62, 25856
    v_mov_b32 v9, 0
.p2align 5
L_pr_218:
    buffer_load_dword v12, v9, s[40:43], s57 offen sc1
    s_sub_u32 s56, s56, 1
    s_cbranch_scc1 L_done
L_pw_217:
    s_waitcnt vmcnt(0)
    v_cmp_eq_u32 vcc, -1, v12
    s_cbranch_vccnz L_pr_218
    s_add_u32 s57, s7, 0
    s_add_u32 s58, s7, 16384
    s_add_u32 s59, s7, 32768
    s_add_u32 s60, s7, 49152
    v_mov_b64 v[36:37], 0
    v_mov_b64 v[38:39], 0
    s_nop 0
    v_mov_b32_dpp v36, v2 quad_perm:[0,1,2,3] row_mask:0x3 bank_mask:0xf
    v_mov_b32_dpp v37, v3 quad_perm:[0,1,2,3] row_mask:0x3 bank_mask:0xf
    v_mov_b32_dpp v38, v2 quad_perm:[0,1,2,3] row_mask:0xc bank_mask:0xf
    v_mov_b32_dpp v39, v3 quad_perm:[0,1,2,3] row_mask:0xc bank_mask:0xf
L_gw_219:
L_pad21:
    s_cbranch_execz L_pad25
    buffer_load_dwordx4 v[12:15], v5, s[40:43], s57 offen sc1
    buffer_load_dwordx4 v[16:19], v5, s[40:43], s58 offen sc1
    buffer_load_dwordx4 v[20:23], v5, s[40:43], s59 offen sc1
    buffer_load_dwordx4 v[24:27], v5, s[40:43], s60 offen sc1
    s_sub_u32 s56, s56, 1
    s_cbranch_scc1 L_done
    s_and_b32 s74, s56, 31
    s_waitcnt vmcnt(3)
    v_pk_add_f32 v[28:29], v[12:13], v[36:37]
    v_pk_add_f32 v[30:31], v[14:15], v[38:39]
    s_waitcnt vmcnt(2)
    v_pk_add_f32 v[28:29], v[28:29], v[16:17]
    v_pk_add_f32 v[30:31], v[30:31], v[18:19]
    s_waitcnt vmcnt(1)
    v_pk_add_f32 v[28:29], v[28:29], v[20:21]
    v_pk_add_f32 v[30:31], v[30:31], v[22:23]
    s_waitcnt vmcnt(0)
    v_pk_add_f32 v[28:29], v[28:29], v[24:25]
    v_pk_add_f32 v[30:31], v[30:31], v[26:27]
    v_pk_add_f32 v[32:33], v[28:29], v[30:31]
    v_cmp_u_f32 vcc, v32, v33
    v_permlane32_swap_b32 v28, v30
    v_permlane32_swap_b32 v29, v31
    s_cbranch_vccnz L_gr_220
L_gk_221:
    v_pk_add_f32 v[28:29], v[28:29], v[30:31]
    v_cvt_pk_bf16_f32 v28, v28, v29
    v_lshlrev_b32 v2, 16, v28
    v_and_b32 v3, 0xffff0000, v28
L_skip_216:
    s_lshl_b32 s74, s53, 7
    s_add_u32 s75, s62, s74
    s_add_u32 s75, s75, 26116
    v_mov_b32 v9, 0
    buffer_load_dword v12, v9, s[40:43], s75 offen sc1
    v_lshlrev_b32 v60, 16, v4
    v_add_f32 v2, v2, v60
    v_and_b32 v60, 0xffff0000, v4
    v_add_f32 v3, v3, v60
    s_add_u32 s57, s7, 66048
    s_add_u32 s58, s7, 82432
    s_add_u32 s59, s7, 98816
    s_add_u32 s60, s7, 115200
    v_mov_b64 v[36:37], 0
    v_mov_b64 v[38:39], 0
    s_nop 0
    v_mov_b32_dpp v36, v2 quad_perm:[0,1,2,3] row_mask:0x3 bank_mask:0xf
    v_mov_b32_dpp v37, v3 quad_perm:[0,1,2,3] row_mask:0x3 bank_mask:0xf
    v_mov_b32_dpp v38, v2 quad_perm:[0,1,2,3] row_mask:0xc bank_mask:0xf
    v_mov_b32_dpp v39, v3 quad_perm:[0,1,2,3] row_mask:0xc bank_mask:0xf
.p2align 5
L_pr_226:
    buffer_load_dword v12, v9, s[40:43], s75 offen sc1
    s_sub_u32 s56, s56, 1
    s_cbranch_scc1 L_done
L_pw_225:
    s_waitcnt vmcnt(1)
    v_cmp_eq_u32 vcc, -1, v12
    s_cbranch_vccnz L_pr_226
L_gw_222:
    buffer_load_dwordx4 v[12:15], v5, s[40:43], s57 offen sc1
    buffer_load_dwordx4 v[16:19], v5, s[40:43], s58 offen sc1
    buffer_load_dwordx4 v[20:23], v5, s[40:43], s59 offen sc1
    buffer_load_dwordx4 v[24:27], v5, s[40:43], s60 offen sc1
    s_sub_u32 s56, s56, 1
    s_cbranch_scc1 L_done
    s_and_b32 s74, s56, 31
    s_waitcnt vmcnt(3)
    v_pk_add_f32 v[28:29], v[12:13], v[36:37]
    v_pk_add_f32 v[30:31], v[14:15], v[38:39]
    s_waitcnt vmcnt(2)
    v_pk_add_f32 v[28:29], v[28:29], v[16:17]
    v_pk_add_f32 v[30:31], v[30:31], v[18:19]
    s_waitcnt vmcnt(1)
    v_pk_add_f32 v[28:29], v[28:29], v[20:21]
    v_pk_add_f32 v[30:31], v[30:31], v[22:23]
    s_waitcnt vmcnt(0)
    v_pk_add_f32 v[28:29], v[28:29], v[24:25]
    v_pk_add_f32 v[30:31], v[30:31], v[26:27]
    v_pk_add_f32 v[32:33], v[28:29], v[30:31]
    v_cmp_u_f32 vcc, v32, v33
    v_permlane32_swap_b32 v28, v30
    v_permlane32_swap_b32 v29, v31
    s_cbranch_vccnz L_gr_223
L_gk_224:
    v_pk_add_f32 v[28:29], v[28:29], v[30:31]
    v_cvt_pk_bf16_f32 v28, v28, v29
L_pad22:
    s_cbranch_execz L_pad26
    ds_write_b32 v35, v28
    v_cndmask_b32 v29, 0, v28, s[64:65]
    v_dot2_f32_bf16 v33, v29, v61, 0
    v_dot2_f32_bf16 v32, v29, v29, 0
    v_lshlrev_b32 v2, 16, v28
    v_and_b32 v3, 0xffff0000, v28
    s_cmp_eq_u32 s55, 0
    v_permlane32_swap_b32 v33, v32
    v_add_f32 v33, v33, v32
    s_waitcnt lgkmcnt(0)
    s_barrier
    v_add_f32_dpp v33, v33, v33 row_ror:8 row_mask:0xf bank_mask:0xf
    s_nop 1
    v_add_f32_dpp v33, v33, v33 row_ror:4 row_mask:0xf bank_mask:0xf
    s_nop 1
    v_add_f32_dpp v33, v33, v33 row_ror:2 row_mask:0xf bank_mask:0xf
    s_nop 1
    v_add_f32_dpp v33, v33, v33 row_ror:1 row_mask:0xf bank_mask:0xf
    s_nop 1
    v_add_f32_dpp v33, v33, v33 row_bcast:15 row_mask:0xa bank_mask:0xf
    s_cbranch_scc1 L_gs_227
    buffer_store_dword v33, v34, s[40:43], s67 offen
L_gb_228:
    s_waitcnt vmcnt(1)
    s_branch L_se_212
.p2align 5
L_hr_233:
    buffer_load_dwordx4 v[40:43], v7, s[40:43], s59 offen offset:0 sc1
    buffer_load_dwordx4 v[44:47], v7, s[40:43], s59 offen offset:1024 sc1
    s_sub_u32 s56, s56, 1
    s_cbranch_scc1 L_done
    s_and_b32 s64, s56, 31
    s_cbranch_scc0 L_hx_235
    s_waitcnt vmcnt(2)
    v_pk_add_f32 v[20:21], v[40:41], v[44:45]
    v_pk_add_f32 v[22:23], v[42:43], v[46:47]
    s_nop 1
    v_permlane32_swap_b32 v20, v22
    v_permlane32_swap_b32 v21, v23
    v_pk_add_f32 v[20:21], v[20:21], v[22:23]
    s_nop 1
    v_permlane16_swap_b32 v20, v21
    v_add_f32 v20, v20, v21
    v_cmp_u_f32 vcc, v20, v20
    v_sub_f32 v20, v20, v50
    s_cbranch_vccnz L_hr_233
    s_branch L_hk_234
.p2align 5
L_hx_235:
    s_waitcnt vmcnt(0)
    v_max3_u32 v20, v40, v41, v42
    v_max3_u32 v20, v20, v43, v44
    v_max3_u32 v20, v20, v45, v46
    v_max_u32 v20, v20, v47
    v_cmp_eq_u32 vcc, -1, v20
    s_cbranch_vccnz L_hr_233
    v_pk_add_f32 v[20:21], v[40:41], v[44:45]
    v_pk_add_f32 v[22:23], v[42:43], v[46:47]
    s_nop 1
    v_permlane32_swap_b32 v20, v22
    v_permlane32_swap_b32 v21, v23
    v_pk_add_f32 v[20:21], v[20:21], v[22:23]
    s_nop 1
    v_permlane16_swap_b32 v20, v21
    v_add_f32 v20, v20, v21
    v_sub_f32 v20, v20, v50
    s_branch L_hk_234
L_qo_229:
    v_mov_b64 v[24:25], 0
    v_mov_b64 v[26:27], 0
    v_mov_b64 v[28:29], 0
    v_mov_b64 v[30:31], 0
    v_mov_b64 v[32:33], 0
    v_mov_b64 v[34:35], 0
    v_mov_b64 v[36:37], 0
    v_mov_b64 v[38:39], 0
    v_lshrrev_b32 v5, 4, v0
    v_lshlrev_b32 v5, 5, v5
    v_bfe_u32 v60, v0, 1, 1
    v_lshl_add_u32 v5, v60, 4, v5
    v_add_u32 v5, 124928, v5
    s_branch L_qb_230
.p2align 5
L_mr_236:
    ds_read_b32 v36, v62
    s_sub_u32 s56, s56, 1
    s_cbranch_scc1 L_done
    s_waitcnt lgkmcnt(0)
    v_cmp_eq_u32 vcc, -1, v36
    s_cbranch_vccnz L_mr_236
    v_max_f32_dpp v37, v36, v36 row_ror:4 row_mask:0xf bank_mask:0xf
L_pad23:
    s_cbranch_execz L_padback
    s_nop 1
    v_max_f32_dpp v37, v37, v37 row_ror:2 row_mask:0xf bank_mask:0xf
    s_nop 1
    v_max_f32_dpp v37, v37, v37 row_ror:1 row_mask:0xf bank_mask:0xf
    v_sub_f32 v39, v61, v37
    v_exp_f32 v39, v39
    s_branch L_mk_237
.p2align 5
L_gs_238:
    buffer_store_dword v37, v4, s[40:43], s58 offen sc1
    s_branch L_gb_239
.p2align 5
L_gs_240:
    buffer_store_dword v14, v3, s[40:43], s57 offen sc1
    s_branch L_gb_241
.p2align 5
L_gs_242:
    buffer_store_dword v12, v4, s[40:43], s57 offen offset:32 sc1
    s_branch L_gb_243
.p2align 5
L_comb_1:
    s_mov_b32 s58, 26624
    s_cmp_eq_u32 s55, 0
    s_cbranch_scc1 L_gs_238
    buffer_store_dword v37, v4, s[40:43], s58 offen
L_gb_239:
    s_mov_b32 s57, 26624
    s_cmp_eq_u32 s55, 0
    s_waitcnt lgkmcnt(0)
    s_barrier
    ds_read2st64_b64 v[12:15], v2 offset0:24 offset1:26
    ds_read2st64_b64 v[16:19], v2 offset0:28 offset1:30
    ds_read2st64_b64 v[20:23], v2 offset0:32 offset1:34
    ds_read2st64_b64 v[24:27], v2 offset0:36 offset1:38
    s_waitcnt lgkmcnt(2)
    v_pk_add_f32 v[12:13], v[12:13], v[14:15]
    v_pk_add_f32 v[16:17], v[16:17], v[18:19]
    v_pk_add_f32 v[12:13], v[12:13], v[16:17]
    s_waitcnt lgkmcnt(0)
    v_pk_add_f32 v[20:21], v[20:21], v[22:23]
    v_pk_add_f32 v[24:25], v[24:25], v[26:27]
    v_pk_add_f32 v[12:13], v[12:13], v[20:21]
    v_pk_add_f32 v[12:13], v[12:13], v[24:25]
    v_cvt_pk_bf16_f32 v14, v12, v13
    v_min_u32 v14, -2, v14
    s_cbranch_scc1 L_gs_240
    buffer_store_dword v14, v3, s[40:43], s57 offen
L_gb_241:
    s_cbranch_scc1 L_gs_242
    buffer_store_dword v12, v4, s[40:43], s57 offen offset:32
L_gb_243:
    s_branch L_comb_1b
.p2align 5
L_sr_253:
    buffer_load_dwordx4 v[52:55], v11, s[40:43], s65 offen offset:0 sc1
    buffer_load_dwordx4 v[56:59], v11, s[40:43], s65 offen offset:1024 sc1
    s_sub_u32 s56, s56, 1
    s_cbranch_scc1 L_done
    s_waitcnt vmcnt(0)
    s_branch L_sw_252
L_hr_254:
    buffer_load_dwordx4 v[12:15], v11, s[40:43], s58 offen offset:0 sc1
    buffer_load_dwordx4 v[16:19], v11, s[40:43], s58 offen offset:1024 sc1
    s_sub_u32 s56, s56, 1
    s_cbranch_scc1 L_done
    s_and_b32 s64, s56, 31
    s_cbranch_scc0 L_hx_256
    s_waitcnt vmcnt(2)
    v_pk_add_f32 v[20:21], v[12:13], v[16:17]
    v_pk_add_f32 v[22:23], v[14:15], v[18:19]
    s_nop 1
    v_permlane32_swap_b32 v20, v22
    v_permlane32_swap_b32 v21, v23
    v_pk_add_f32 v[20:21], v[20:21], v[22:23]
    s_nop 1
    v_permlane16_swap_b32 v20, v21
    v_add_f32 v20, v20, v21
    v_cmp_u_f32 vcc, v20, v20
    v_sub_f32 v20, v20, v26
    s_cbranch_vccnz L_hr_254
    s_branch L_hk_255
.p2align 5
L_hx_256:
L_pad24:
    s_cbranch_execz L_padback
    s_waitcnt vmcnt(0)
    v_max3_u32 v20, v12, v13, v14
    v_max3_u32 v20, v20, v15, v16
    v_max3_u32 v20, v20, v17, v18
    v_max_u32 v20, v20, v19
    v_cmp_eq_u32 vcc, -1, v20
    s_cbranch_vccnz L_hr_254
    v_pk_add_f32 v[20:21], v[12:13], v[16:17]
    v_pk_add_f32 v[22:23], v[14:15], v[18:19]
    s_nop 1
    v_permlane32_swap_b32 v20, v22
    v_permlane32_swap_b32 v21, v23
    v_pk_add_f32 v[20:21], v[20:21], v[22:23]
    s_nop 1
    v_permlane16_swap_b32 v20, v21
    v_add_f32 v20, v20, v21
    v_sub_f32 v20, v20, v26
    s_branch L_hk_255
.p2align 5
L_typeC_259:
    s_cmp_eq_u32 s30, 6
    s_cbranch_scc0 L_done
    s_cmp_eq_u32 s3, 20
    s_cbranch_scc0 L_done
    s_lshl_b32 s59, s31, 9
    s_add_u32 s59, s59, s8
    s_add_u32 s59, s59, 266240
    v_and_b32 v10, 1, v0
    v_lshlrev_b32 v10, 13, v10
    v_lshrrev_b32 v60, 1, v0
    v_lshl_add_u32 v10, v60, 24, v10
    s_add_u32 s58, s62, 28192
    v_lshrrev_b32 v9, 3, v0
    v_mul_u32_u24 v9, 1664, v9
    v_and_b32 v60, 7, v0
    v_lshl_add_u32 v9, v60, 2, v9
.p2align 5
L_pr_261:
    buffer_load_dword v12, v9, s[40:43], s58 offen sc1
    s_sub_u32 s56, s56, 1
    s_cbranch_scc1 L_done
L_pw_260:
    s_waitcnt vmcnt(0)
    v_cmp_eq_u32 vcc, -1, v12
    s_cbranch_vccnz L_pr_261
    buffer_store_dword v0, v10, s[40:43], s59 offen offset:8 sc1
    s_add_u32 s58, s62, 25984
    v_and_b32 v9, 15, v0
    v_lshlrev_b32 v9, 2, v9
.p2align 5
L_pr_263:
    buffer_load_dword v13, v9, s[40:43], s58 offen sc1
    s_sub_u32 s56, s56, 1
    s_cbranch_scc1 L_done
L_pw_262:
    s_waitcnt vmcnt(0)
    v_cmp_eq_u32 vcc, -1, v13
    s_cbranch_vccnz L_pr_263
    buffer_store_dword v0, v10, s[40:43], s59 offen offset:12 sc1
    s_waitcnt vmcnt(1)
    s_branch L_done
.p2align 5
L_gs_267:
    buffer_store_dword v12, v11, s[40:43], s59 offen sc1
    s_branch L_gb_268
.p2align 5
L_gr_270:
    s_cbranch_scc1 L_gw_269
    s_waitcnt vmcnt(0)
    v_max3_u32 v32, v12, v13, v14
    v_max3_u32 v32, v32, v15, v16
    v_max3_u32 v32, v32, v17, v18
    v_max3_u32 v32, v32, v19, v20
    v_max3_u32 v32, v32, v21, v22
    v_max3_u32 v32, v32, v23, v24
    v_max3_u32 v32, v32, v25, v26
    v_max_u32 v32, v32, v27
    v_cmp_eq_u32 vcc, -1, v32
    s_cbranch_vccnz L_gw_269
    v_pk_add_f32 v[28:29], v[12:13], v[36:37]
    v_pk_add_f32 v[30:31], v[14:15], v[38:39]
    v_pk_add_f32 v[28:29], v[28:29], v[16:17]
    v_pk_add_f32 v[30:31], v[30:31], v[18:19]
    v_pk_add_f32 v[28:29], v[28:29], v[20:21]
    v_pk_add_f32 v[30:31], v[30:31], v[22:23]
    v_pk_add_f32 v[28:29], v[28:29], v[24:25]
L_pad25:
    s_cbranch_execz L_padback
    v_pk_add_f32 v[30:31], v[30:31], v[26:27]
    s_nop 1
    v_permlane32_swap_b32 v28, v30
    v_permlane32_swap_b32 v29, v31
    s_branch L_gk_271
L_gs_274:
    buffer_store_dword v33, v34, s[40:43], s67 offen sc1
    s_branch L_gb_275
.p2align 5
L_w7_264:
    v_and_b32 v60, 31, v0
    v_min_u32 v60, 19, v60
    s_mul_i32 s57, s54, 320
    v_lshrrev_b32 v5, 5, v0
    v_lshlrev_b32 v5, 12, v5
    v_add_u32 v5, s57, v5
    v_lshl_add_u32 v5, v60, 4, v5
    v_and_b32 v60, 31, v0
    v_cmp_gt_u32 s[64:65], 20, v60
    v_min_u32 v60, 19, v60
    v_lshrrev_b32 v35, 5, v0
    v_lshlrev_b32 v35, 2, v35
    v_add_u32 v35, 156736, v35
    v_lshl_add_u32 v35, v60, 3, v35
    s_add_u32 s66, s62, 39936
    s_add_u32 s67, s62, 25984
    s_lshl_b32 s57, s54, 3
    v_lshrrev_b32 v34, 5, v0
    v_lshlrev_b32 v34, 2, v34
    v_add_u32 v34, s57, v34
    v_and_b32 v60, 31, v0
    v_mov_b32 v61, 0x7f000000
    v_cmp_ne_u32 vcc, 31, v60
    s_nop 1
    v_cndmask_b32 v34, v34, v61, vcc
    v_mov_b32 v61, 0x3f803f80
    s_add_u32 s57, s7, 132096
    s_add_u32 s58, s7, 148480
    s_add_u32 s59, s7, 164864
    s_add_u32 s60, s7, 181248
    v_mov_b64 v[36:37], 0
    v_mov_b64 v[38:39], 0
    s_nop 0
    v_mov_b32_dpp v36, v2 quad_perm:[0,1,2,3] row_mask:0x3 bank_mask:0xf
    v_mov_b32_dpp v37, v3 quad_perm:[0,1,2,3] row_mask:0x3 bank_mask:0xf
    v_mov_b32_dpp v38, v2 quad_perm:[0,1,2,3] row_mask:0xc bank_mask:0xf
    v_mov_b32_dpp v39, v3 quad_perm:[0,1,2,3] row_mask:0xc bank_mask:0xf
    s_add_u32 s75, s7, 266248
    v_and_b32 v9, 7, v0
    v_lshlrev_b32 v9, 9, v9
.p2align 5
L_pr_273:
    buffer_load_dword v12, v9, s[40:43], s75 offen sc1
    s_sub_u32 s56, s56, 1
    s_cbranch_scc1 L_done
L_pw_272:
    s_waitcnt vmcnt(0)
    v_cmp_eq_u32 vcc, -1, v12
    s_cbranch_vccnz L_pr_273
L_gw_269:
    buffer_load_dwordx4 v[12:15], v5, s[40:43], s57 offen sc1
    buffer_load_dwordx4 v[16:19], v5, s[40:43], s58 offen sc1
    buffer_load_dwordx4 v[20:23], v5, s[40:43], s59 offen sc1
    buffer_load_dwordx4 v[24:27], v5, s[40:43], s60 offen sc1
    s_sub_u32 s56, s56, 1
    s_cbranch_scc1 L_done
    s_and_b32 s74, s56, 31
    s_waitcnt vmcnt(3)
    v_pk_add_f32 v[28:29], v[12:13], v[36:37]
    v_pk_add_f32 v[30:31], v[14:15], v[38:39]
    s_waitcnt vmcnt(2)
    v_pk_add_f32 v[28:29], v[28:29], v[16:17]
    v_pk_add_f32 v[30:31], v[30:31], v[18:19]
    s_waitcnt vmcnt(1)
    v_pk_add_f32 v[28:29], v[28:29], v[20:21]
    v_pk_add_f32 v[30:31], v[30:31], v[22:23]
    s_waitcnt vmcnt(0)
    v_pk_add_f32 v[28:29], v[28:29], v[24:25]
    v_pk_add_f32 v[30:31], v[30:31], v[26:27]
    v_pk_add_f32 v[32:33], v[28:29], v[30:31]
    v_cmp_u_f32 vcc, v32, v33
    v_permlane32_swap_b32 v28, v30
    v_permlane32_swap_b32 v29, v31
    s_cbranch_vccnz L_gr_270
L_gk_271:
    v_pk_add_f32 v[28:29], v[28:29], v[30:31]
    v_cvt_pk_bf16_f32 v28, v28, v29
L_pad26:
    s_cbranch_execz L_padback
    ds_write_b32 v35, v28
    v_cndmask_b32 v29, 0, v28, s[64:65]
    v_dot2_f32_bf16 v33, v29, v61, 0
    v_dot2_f32_bf16 v32, v29, v29, 0
    v_lshlrev_b32 v2, 16, v28
    v_and_b32 v3, 0xffff0000, v28
    s_cmp_eq_u32 s55, 0
    v_permlane32_swap_b32 v33, v32
    v_add_f32 v33, v33, v32
    s_waitcnt lgkmcnt(0)
    s_barrier
    v_add_f32_dpp v33, v33, v33 row_ror:8 row_mask:0xf bank_mask:0xf
    s_nop 1
    v_add_f32_dpp v33, v33, v33 row_ror:4 row_mask:0xf bank_mask:0xf
    s_nop 1
    v_add_f32_dpp v33, v33, v33 row_ror:2 row_mask:0xf bank_mask:0xf
    s_nop 1
    v_add_f32_dpp v33, v33, v33 row_ror:1 row_mask:0xf bank_mask:0xf
    s_nop 1
    v_add_f32_dpp v33, v33, v33 row_bcast:15 row_mask:0xa bank_mask:0xf
    s_cbranch_scc1 L_gs_274
    buffer_store_dword v33, v34, s[40:43], s67 offen
L_gb_275:
    s_waitcnt vmcnt(1)
    s_branch L_se_265
.p2align 5
L_gr_277:
    s_cbranch_scc1 L_gw_276
    s_waitcnt vmcnt(0)
    v_max3_u32 v32, v12, v13, v14
    v_max3_u32 v32, v32, v15, v16
    v_max3_u32 v32, v32, v17, v18
    v_max3_u32 v32, v32, v19, v20
    v_max3_u32 v32, v32, v21, v22
    v_max3_u32 v32, v32, v23, v24
    v_max3_u32 v32, v32, v25, v26
    v_max_u32 v32, v32, v27
    v_cmp_eq_u32 vcc, -1, v32
    s_cbranch_vccnz L_gw_276
    v_pk_add_f32 v[28:29], v[12:13], v[36:37]
    v_pk_add_f32 v[30:31], v[14:15], v[38:39]
    v_pk_add_f32 v[28:29], v[28:29], v[16:17]
    v_pk_add_f32 v[30:31], v[30:31], v[18:19]
    v_pk_add_f32 v[28:29], v[28:29], v[20:21]
    v_pk_add_f32 v[30:31], v[30:31], v[22:23]
    v_pk_add_f32 v[28:29], v[28:29], v[24:25]
    v_pk_add_f32 v[30:31], v[30:31], v[26:27]
    s_nop 1
    v_permlane32_swap_b32 v28, v30
    v_permlane32_swap_b32 v29, v31
    s_branch L_gk_278
L_tail_end:
.p2align 5
L_spread:
    s_add_u32 s62, s62, 966656
    s_cmp_eq_u32 s30, 5
    s_cbranch_scc0 L_skip_90
    v_mov_b64 v[12:13], -1
    v_mov_b64 v[14:15], -1
    v_lshlrev_b32 v16, 4, v0
    s_mul_i32 s57, s52, 2208
    s_add_u32 s57, s57, s62
    s_mov_b64 exec, 0x3ff
    buffer_store_dwordx4 v[12:15], v16, s[40:43], s57 offen offset:2048 sc1
    s_mov_b64 exec, -1
    buffer_store_dwordx4 v[12:15], v16, s[40:43], s57 offen offset:0 sc1
    buffer_store_dwordx4 v[12:15], v16, s[40:43], s57 offen offset:1024 sc1
L_skip_90:
    s_cmp_eq_u32 s30, 7
    s_cbranch_scc0 L_skip_91
    v_and_b32 v60, 31, v0
    v_cmp_gt_u32 s[64:65], 20, v60
    v_min_u32 v60, 19, v60
    v_lshrrev_b32 v35, 5, v0
    v_lshlrev_b32 v35, 2, v35
    v_add_u32 v35, 156736, v35
    v_lshl_add_u32 v35, v60, 3, v35
    s_mul_i32 s66, s53, 12416
    s_add_u32 s66, s66, s62
    s_add_u32 s66, s66, 70656
    s_add_u32 s67, s66, 12288
    s_lshl_b32 s57, s54, 3
    v_lshrrev_b32 v34, 5, v0
    v_lshlrev_b32 v34, 2, v34
    v_add_u32 v34, s57, v34
    v_and_b32 v60, 31, v0
    v_mov_b32 v61, 0x7f000000
    v_cmp_ne_u32 vcc, 31, v60
    s_nop 1
    v_cndmask_b32 v34, v34, v61, vcc
    v_mov_b32 v61, 0x3f803f80
    v_cvt_pk_bf16_f32 v28, v2, v3
L_skip_91:
    s_cmp_eq_u32 s30, 7
    s_cbranch_scc0 L_skip_92
    v_cndmask_b32 v29, 0, v28, s[64:65]
    v_dot2_f32_bf16 v33, v29, v61, 0
    v_dot2_f32_bf16 v32, v29, v29, 0
    v_lshlrev_b32 v2, 16, v28
    v_and_b32 v3, 0xffff0000, v28
    s_cmp_eq_u32 s55, 0
    v_permlane32_swap_b32 v33, v32
    v_add_f32 v33, v33, v32
    s_nop 1
    v_add_f32_dpp v33, v33, v33 row_ror:8 row_mask:0xf bank_mask:0xf
    s_nop 1
    v_add_f32_dpp v33, v33, v33 row_ror:4 row_mask:0xf bank_mask:0xf
    s_nop 1
    v_add_f32_dpp v33, v33, v33 row_ror:2 row_mask:0xf bank_mask:0xf
    s_nop 1
    v_add_f32_dpp v33, v33, v33 row_ror:1 row_mask:0xf bank_mask:0xf
    s_nop 1
    v_add_f32_dpp v33, v33, v33 row_bcast:15 row_mask:0xa bank_mask:0xf
    s_cbranch_scc1 L_gs_93
    buffer_store_dword v33, v34, s[40:43], s67 offen
L_gb_94:
    s_waitcnt vmcnt(1)
L_skip_92:
    s_cmp_lt_u32 s30, 6
    s_cbranch_scc0 L_skip_95
    s_lshr_b32 s57, s30, 1
    s_mul_i32 s57, s57, 1024
    s_and_b32 s58, s30, 1
    s_lshl_b32 s58, s58, 6
    s_add_u32 s57, s57, s58
    v_lshrrev_b32 v18, 5, v0
    v_mul_u32_u24 v18, 6144, v18
    v_bfe_u32 v60, v0, 3, 1
    v_mul_u32_u24 v60, 3072, v60
    v_add_u32 v18, v60, v18
    v_bfe_u32 v60, v0, 4, 1
    v_lshl_add_u32 v18, v60, 9, v18
    v_bfe_u32 v60, v0, 2, 1
    v_lshl_add_u32 v18, v60, 7, v18
    v_and_b32 v60, 3, v0
    v_lshl_add_u32 v18, v60, 3, v18
    v_add_u32 v18, s57, v18
    v_bfe_u32 v19, v0, 3, 1
    v_mul_u32_u24 v19, 3072, v19
    v_bfe_u32 v60, v0, 4, 1
    v_lshl_add_u32 v19, v60, 9, v19
    v_bfe_u32 v60, v0, 2, 1
    v_lshl_add_u32 v19, v60, 7, v19
    v_and_b32 v60, 3, v0
    v_lshl_add_u32 v19, v60, 3, v19
    v_lshrrev_b32 v60, 5, v0
    v_lshl_add_u32 v19, v60, 5, v19
    v_add_u32 v19, s57, v19
    v_add_u32 v19, 24576, v19
    ds_read_b64_tr_b16 v[28:29], v18 offset:0
    ds_read_b64_tr_b16 v[30:31], v18 offset:256
    ds_read_b64_tr_b16 v[32:33], v18 offset:12288
    ds_read_b64_tr_b16 v[34:35], v18 offset:12544
    ds_read_b64_tr_b16 v[36:37], v18 offset:32
    ds_read_b64_tr_b16 v[38:39], v18 offset:288
    ds_read_b64_tr_b16 v[40:41], v18 offset:12320
    ds_read_b64_tr_b16 v[42:43], v18 offset:12576
    ds_read_b64_tr_b16 v[24:25], v19 offset:0
    ds_read_b64_tr_b16 v[26:27], v19 offset:256
    v_lshrrev_b32 v49, 4, v0
    v_lshlrev_b32 v49, 5, v49
    v_bfe_u32 v60, v0, 1, 1
    v_lshl_add_u32 v49, v60, 4, v49
    v_bfe_u32 v60, v0, 3, 1
    v_mul_u32_u24 v60, 192, v60
    v_add_u32 v49, v60, v49
    v_add_u32 v49, 156736, v49
    v_bfe_u32 v50, v0, 1, 1
    v_lshlrev_b32 v50, 4, v50
    v_bfe_u32 v60, v0, 3, 1
    v_mul_u32_u24 v60, 192, v60
    v_add_u32 v50, v60, v50
    v_add_u32 v50, 156864, v50
    v_mov_b32 v60, 156896
    v_and_b32 v51, 5, v0
    v_cmp_eq_u32 vcc, 0, v51
    s_nop 1
    v_cndmask_b32 v52, v60, v49, vcc
    v_cmp_eq_u32 vcc, 4, v51
    s_nop 1
    v_cndmask_b32 v53, v60, v49, vcc
    v_lshrrev_b32 v49, 2, v0
    v_and_b32 v49, 12, v49
    v_cmp_eq_u32 vcc, v49, v51
    s_nop 1
    v_cndmask_b32 v48, v60, v50, vcc
    v_mov_b64 v[44:45], 0
    v_mov_b64 v[46:47], 0
    s_lshr_b32 s57, s30, 1
    s_lshl_b32 s57, s57, 11
    s_lshl_b32 s58, s58, 1
    s_add_u32 s57, s57, s58
    s_lshl_b32 s58, s54, 8
    s_add_u32 s57, s57, s58
    v_and_b32 v54, 31, v0
    v_lshlrev_b32 v54, 2, v54
    v_lshrrev_b32 v60, 5, v0
    v_mul_u32_u24 v60, 6144, v60
    v_add_u32 v54, v60, v54
    v_add_u32 v54, s57, v54
    s_mul_i32 s59, s53, 12416
    s_add_u32 s59, s59, s62
    s_add_u32 s59, s59, 70656
    s_add_u32 s60, s59, 12288
    ds_read_b128 v[12:15], v52
    ds_read_b128 v[16:19], v53
    ds_read_b128 v[20:23], v48
    s_waitcnt lgkmcnt(2)
    v_smfmac_f32_16x16x64_bf16 v[44:47], v[12:15], v[28:35], v1
    s_waitcnt lgkmcnt(1)
    v_smfmac_f32_16x16x64_bf16 v[44:47], v[16:19], v[36:43], v1
    s_waitcnt lgkmcnt(0)
    v_smfmac_f32_16x16x64_bf16 v[44:47], v[20:23], v[24:31], v1
    s_cmp_eq_u32 s55, 0
    s_nop 6
    v_add_f32 v12, v44, v46
    s_cbranch_scc1 L_gs_96
    buffer_store_dword v12, v54, s[40:43], s59 offen
L_gb_97:
L_skip_95:
    s_waitcnt vmcnt(0)
    s_barrier
    s_cmp_eq_u32 s30, 5
    s_cbranch_scc0 L_skip_98
    v_mov_b32 v25, 0
    s_lshl_b32 s57, s52, 2
    s_add_u32 s57, s57, s72
    s_mov_b64 exec, 1
    buffer_store_dword v25, v0, s[40:43], s57 offen offset:256 sc1
    s_mov_b64 exec, -1
    v_and_b32 v16, 31, v0
    v_lshlrev_b32 v16, 2, v16
.p2align 5
L_pr_100:
    buffer_load_dword v17, v16, s[40:43], s72 offen offset:256 sc1
    s_sub_u32 s56, s56, 1
    s_cbranch_scc1 L_done
L_pw_99:
    s_waitcnt vmcnt(0)
    v_cmp_eq_u32 vcc, -1, v17
    s_cbranch_vccnz L_pr_100
L_skip_98:
    s_barrier
    s_branch L_spread_back
.p2align 5
L_done:
L_exit:
    s_endpgm
.section .rodata,"a"
.p2align 6
.amdhsa_kernel interleave_layers__sliding_block_cached__dense_activation_gelu__decode_kernel
  .amdhsa_next_free_vgpr 256
  .amdhsa_next_free_sgpr 102
  .amdhsa_accum_offset 256
  .amdhsa_group_segment_fixed_size 0
  .amdhsa_kernarg_size 104
  .amdhsa_user_sgpr_count 2
  .amdhsa_user_sgpr_kernarg_segment_ptr 1
  .amdhsa_system_sgpr_workgroup_id_x 1
  .amdhsa_float_denorm_mode_32 3
.end_amdhsa_kernel
```

```asm
; @launch grid=(256,1,1) block=(512,1,1) lds=157120
.amdgcn_target "amdgcn-amd-amdhsa--gfx950"
.text
.fill 64, 4, 0xbf800000
.globl interleave_layers__sliding_block_cached__dense_activation_gelu__decode_kernel
.p2align 8
.type interleave_layers__sliding_block_cached__dense_activation_gelu__decode_kernel,@function
interleave_layers__sliding_block_cached__dense_activation_gelu__decode_kernel:
    s_load_dwordx16 s[4:19], s[0:1], 0
    s_cmp_ge_u32 s2, 256
    s_cbranch_scc1 L_exit
    v_lshrrev_b32 v5, 6, v0
    v_lshlrev_b32 v62, 6, v0
    v_readfirstlane_b32 s30, v5
    v_and_b32 v0, 63, v0
    s_getpc_b64 s[74:75]
L_pc:
    v_min_u32 v62, L_exit-L_pc, v62
    global_load_dword v63, v62, s[74:75]
    s_cmp_eq_u32 s30, 6
    s_cbranch_scc0 L_skip_1
    s_setprio 3
L_skip_1:
    s_and_b32 s31, s2, 7
    s_lshr_b32 s52, s2, 3
    s_and_b32 s53, s52, 3
    s_lshr_b32 s54, s52, 2
    s_lshl_b32 s73, s31, 2
    s_add_u32 s73, s73, s53
    v_lshrrev_b32 v2, 3, v0
    v_mul_u32_u24 v2, 12288, v2
    v_and_b32 v60, 7, v0
    v_lshl_add_u32 v2, v60, 4, v2
    s_mul_i32 s65, s73, 384
    s_mul_i32 s60, s54, 983040
    s_add_u32 s65, s65, s60
    s_sub_u32 s46, 7866368, s65
    s_mov_b32 s47, 0x20000
    v_lshrrev_b32 v8, 5, v0
    v_lshlrev_b32 v8, 2, v8
    v_bfe_u32 v60, v0, 4, 1
    v_lshl_add_u32 v8, v60, 0, v8
    v_and_b32 v9, 7, v0
    v_xor_b32 v8, v8, v9
    v_lshrrev_b32 v10, 3, v0
    v_mul_u32_u24 v10, 384, v10
    v_lshl_add_u32 v5, v8, 4, v10
    s_mul_i32 s64, s73, 12582912
    s_mul_i32 s58, s54, 3072
    s_add_u32 s64, s64, s58
    s_add_u32 s64, s64, 11008000
    s_sub_u32 s34, 1574912, s58
    s_mov_b32 s35, 0x20000
    s_mov_b32 s57, 2048
    s_mov_b32 s58, 1152
    s_mov_b32 s59, 256
    s_mov_b32 m0, 0
    s_cmp_eq_u32 s30, 6
    s_cselect_b64 vcc, -1, 0
    s_waitcnt lgkmcnt(0)
    s_add_u32 s44, s10, s65
    s_addc_u32 s45, s11, 0
    s_sub_u32 s44, s44, 2048
    s_subb_u32 s45, s45, 0
    s_load_dwordx8 s[20:27], s[0:1], 64
    s_load_dwordx2 s[28:29], s[0:1], 96
    s_cbranch_vccz L_skip_3
L_dma_2:
    buffer_load_dwordx4 v2, s[44:47], s57 offen offset:0 nt lds
    buffer_load_dwordx4 v2, s[44:47], s58 offen offset:1024 nt lds
    buffer_load_dwordx4 v2, s[44:47], s59 offen offset:2048 nt lds
    s_add_u32 s57, s57, 98304
    s_add_u32 s58, s58, 98304
    s_add_u32 s59, s59, 98304
    s_add_u32 m0, m0, 3072
    s_cmp_lg_u32 m0, 24576
    s_cbranch_scc1 L_dma_2
L_skip_3:
    s_add_u32 s32, s6, s64
    s_addc_u32 s33, s7, 0
    s_add_u32 s36, s8, s64
    s_addc_u32 s37, s9, 0
    s_mov_b32 s38, s34
    s_mov_b32 s39, 0x20000
    s_mul_i32 s3, s54, 3
    s_add_u32 s3, s3, s53
    s_cmp_eq_u32 s53, 3
    s_cselect_b32 s3, 31, s3
    v_lshrrev_b32 v8, 4, v0
    v_lshlrev_b32 v8, 1, v8
    v_xor_b32 v8, v8, v9
    v_lshl_add_u32 v7, v8, 4, v10
    s_and_b32 s61, s30, 1
    s_mul_i32 s61, s61, 3072
    s_lshr_b32 s9, s30, 1
    s_add_u32 s61, s61, 92160
    s_mul_i32 s62, s31, 120832
    s_add_u32 s62, s62, 299008
    s_lshl_b32 s72, s31, 9
    s_add_u32 s72, s72, 294912
    s_mov_b32 s56, 65536
    s_mov_b32 s55, 1
    s_getreg_b32 s63, hwreg(20, 0, 3)
    v_mov_b32 v3, 0
    v_mov_b32 v4, 0
    v_mov_b32 v11, 0
    v_mov_b32 v24, 0
    v_mov_b32 v34, 0
    v_mov_b64 v[12:13], -1
    v_mov_b64 v[14:15], -1
    v_lshlrev_b32 v10, 4, v0
    s_waitcnt lgkmcnt(0)
    s_mov_b32 s40, s28
    s_mov_b32 s41, s29
    s_mov_b32 s42, 2232320
    s_mov_b32 s43, 0x20000
    s_cmp_lt_u32 s3, 20
    s_cselect_b32 s57, 7864320, 0
    s_add_u32 s58, s54, 1
    s_mul_i32 s58, s58, 245760
    s_cmp_lg_u32 s53, 3
    s_cselect_b64 s[48:49], s[12:13], s[16:17]
    s_cselect_b32 s50, s57, s58
    s_mov_b32 s51, 0x20000
    s_add_u32 s57, s28, 0
    s_sub_u32 s57, 0, s57
    s_and_b32 s57, s57, 0x3fff
    s_add_u32 s57, s57, 0
    s_lshr_b32 s58, s31, 1
    s_lshl_b32 s58, s58, 14
    s_add_u32 s6, s57, s58
    s_and_b32 s58, s31, 1
    s_lshl_b32 s58, s58, 12
    s_add_u32 s6, s6, s58
    s_lshl_b32 s58, s3, 7
    s_add_u32 s6, s6, s58
    s_mov_b32 s8, s57
    s_and_b32 s59, s3, 3
    s_lshl_b32 s58, s31, 2
    s_add_u32 s59, s59, s58
    s_lshl_b32 s59, s59, 7
    s_add_u32 s59, s59, s57
    s_add_u32 s59, s59, 262144
    s_add_u32 s10, s28, s59
    s_addc_u32 s11, s29, 0
    s_lshr_b32 s58, s63, 2
    s_xor_b32 s58, s58, 0
    s_mul_i32 s58, s58, 8192
    s_add_u32 s7, s57, s58
    s_cmp_eq_u32 s30, 5
    s_cbranch_scc0 L_skip_4
    s_cmp_eq_u32 s52, 31
    s_cbranch_scc0 L_skip_5
    s_mov_b64 exec, 0xffffff
    buffer_store_dwordx4 v[12:15], v10, s[40:43], s72 offen sc1
    s_mov_b64 exec, -1
L_skip_5:
    s_cmp_lt_u32 s3, 20
    s_cbranch_scc0 L_skip_6
    v_and_b32 v16, 7, v0
    v_lshlrev_b32 v16, 4, v16
    v_bfe_u32 v17, v0, 3, 1
    v_lshl_add_u32 v16, v17, 13, v16
    v_lshrrev_b32 v17, 4, v0
    v_mul_u32_u24 v17, 66048, v17
    v_add_u32 v16, v17, v16
    buffer_store_dwordx4 v[12:15], v16, s[40:43], s6 offen sc1
L_skip_6:
    s_cmp_eq_u32 s3, 20
    s_cbranch_scc0 L_skip_7
    s_lshl_b32 s58, s31, 9
    s_add_u32 s58, s58, s8
    s_add_u32 s58, s58, 266240
    v_and_b32 v16, 7, v0
    v_lshlrev_b32 v16, 4, v16
    v_bfe_u32 v60, v0, 3, 1
    v_lshl_add_u32 v16, v60, 13, v16
    v_lshrrev_b32 v60, 4, v0
    v_lshl_add_u32 v16, v60, 28, v16
    buffer_store_dwordx4 v[12:15], v16, s[40:43], s58 offen sc1
L_skip_7:
    s_sub_u32 s58, s3, 20
    s_cmp_lt_u32 s58, 4
    s_cselect_b32 s59, s59, 0x7f000000
    v_and_b32 v16, 7, v0
    v_lshlrev_b32 v16, 4, v16
    v_bfe_u32 v60, v0, 3, 1
    v_lshl_add_u32 v16, v60, 13, v16
    v_lshrrev_b32 v60, 4, v0
    v_lshl_add_u32 v16, v60, 28, v16
    buffer_store_dwordx4 v[12:15], v16, s[40:43], s59 offen sc1
    s_mul_i32 s57, s52, 2208
    s_add_u32 s57, s57, s62
    s_mov_b64 exec, 0x3ff
    buffer_store_dwordx4 v[12:15], v10, s[40:43], s57 offen offset:2048
    s_mov_b64 exec, -1
    buffer_store_dwordx4 v[12:15], v10, s[40:43], s57 offen offset:0
    buffer_store_dwordx4 v[12:15], v10, s[40:43], s57 offen offset:1024
    s_mov_b64 exec, -1
    v_lshlrev_b32 v16, 4, v0
    v_add_u32 v16, 155648, v16
    ds_write_b128 v16, v[12:15]
    v_and_b32 v3, 7, v0
    v_lshlrev_b32 v3, 5, v3
L_skip_4:
    s_cmp_eq_u32 s30, 7
    s_cbranch_scc0 L_skip_8
    v_and_b32 v60, 31, v0
    v_min_u32 v60, 19, v60
    s_mul_i32 s57, s54, 160
    v_lshrrev_b32 v16, 5, v0
    v_lshlrev_b32 v16, 2, v16
    v_add_u32 v16, s57, v16
    v_lshl_add_u32 v16, v60, 3, v16
    global_load_dword v28, v16, s[4:5]
    global_load_dword v4, v16, s[22:23]
L_skip_8:
    s_sub_u32 s58, s30, 4
    s_cmp_lt_u32 s58, 3
    s_cbranch_scc0 L_skip_9
    s_mul_i32 s57, s31, 3
    s_add_u32 s57, s57, s58
    s_lshl_b32 s57, s57, 7
    v_and_b32 v16, 15, v0
    v_lshlrev_b32 v16, 3, v16
    v_lshrrev_b32 v60, 4, v0
    v_lshl_add_u32 v16, v60, 1, v16
    v_add_u32 v16, s57, v16
    global_load_short_d16_hi v4, v16, s[18:19]
L_skip_9:
    v_bfe_u32 v8, v0, 3, 1
    v_lshlrev_b32 v8, 2, v8
    v_bfe_u32 v60, v0, 1, 1
    v_lshl_add_u32 v8, v60, 0, v8
    v_lshrrev_b32 v9, 4, v0
    v_xor_b32 v9, v8, v9
    v_bfe_u32 v8, v0, 2, 1
    v_mul_u32_u24 v8, 6144, v8
    v_bfe_u32 v60, v0, 3, 1
    v_lshl_add_u32 v8, v60, 9, v8
    v_and_b32 v60, 3, v0
    v_lshl_add_u32 v8, v60, 7, v8
    v_add_u32 v8, s61, v8
    v_lshl_add_u32 v8, v9, 4, v8
    v_xor_b32 v9, 64, v8
    v_bfe_u32 v1, v0, 1, 1
    v_mul_u32_u24 v1, 43690, v1
    v_add_u32 v1, 17476, v1
    s_cmp_eq_u32 s30, 6
    s_cbranch_scc0 L_skip_10
    s_cmp_lg_u32 s53, 3
    s_cbranch_scc0 L_wb_11
    s_mul_i32 s57, s31, 983040
    s_lshl_b32 s58, s3, 6
    s_add_u32 s57, s57, s58
    v_bfe_u32 v38, v0, 4, 1
    v_lshlrev_b32 v38, 1, v38
    v_xor_b32 v38, v38, v0
    v_and_b32 v38, 3, v38
    v_lshrrev_b32 v3, 5, v0
    v_mul_u32_u24 v3, 10240, v3
    v_bfe_u32 v39, v0, 4, 1
    v_mul_u32_u24 v39, 2560, v39
    v_add_u32 v3, v39, v3
    v_bfe_u32 v39, v0, 3, 1
    v_mul_u32_u24 v39, 5120, v39
    v_add_u32 v3, v39, v3
    v_bfe_u32 v39, v0, 2, 1
    v_mul_u32_u24 v39, 20480, v39
    v_add_u32 v3, v39, v3
    v_add_u32 v3, s57, v3
    v_lshl_add_u32 v3, v38, 4, v3
    s_mov_b32 s14, 40960
    s_mov_b32 s15, 256
    s_branch L_we_12
.p2align 5
L_wb_11:
    s_mul_i32 s57, s31, 384
    s_mul_i32 s58, s54, 245760
    s_add_u32 s57, s57, s58
    v_lshlrev_b32 v3, 4, v0
    v_add_u32 v3, s57, v3
    v_mov_b32 v38, 2688
    v_cmp_lt_u32 vcc, 23, v0
    s_nop 1
    v_cndmask_b32 v38, 0, v38, vcc
    v_add_u32 v3, v38, v3
    v_mov_b32 v38, 0x7f000000
    v_cmp_lt_u32 vcc, 47, v0
    s_nop 1
    v_cndmask_b32 v3, v3, v38, vcc
    s_mov_b32 s14, 12288
    s_mov_b32 s15, 5120
L_we_12:
L_skip_10:
    s_cmp_eq_u32 s30, 6
    s_cbranch_scc0 L_skip_13
    s_mov_b32 s57, 788480
    s_mov_b32 s58, 787584
    s_mov_b32 s59, 786688
    s_mov_b32 m0, 24576
L_dma_14:
    s_waitcnt vmcnt(22)
    buffer_load_dwordx4 v2, s[44:47], s57 offen offset:0 nt lds
    buffer_load_dwordx4 v2, s[44:47], s58 offen offset:1024 nt lds
    buffer_load_dwordx4 v2, s[44:47], s59 offen offset:2048 nt lds
    s_add_u32 s57, s57, 98304
    s_add_u32 s58, s58, 98304
    s_add_u32 s59, s59, 98304
    s_add_u32 m0, m0, 3072
    s_cmp_lg_u32 m0, 30720
    s_cbranch_scc1 L_dma_14
    s_mov_b32 s57, 2048
    s_mov_b32 s58, 1152
    s_mov_b32 s59, 256
    s_mov_b32 m0, 92160
L_dma_15:
    s_waitcnt vmcnt(22)
    buffer_load_dwordx4 v5, s[32:35], s57 offen offset:0 nt lds
    buffer_load_dwordx4 v5, s[32:35], s58 offen offset:1024 nt lds
    buffer_load_dwordx4 v5, s[32:35], s59 offen offset:2048 nt lds
    s_add_u32 s57, s57, 24576
    s_add_u32 s58, s58, 24576
    s_add_u32 s59, s59, 24576
    s_add_u32 m0, m0, 3072
    s_cmp_lg_u32 m0, 104448
    s_cbranch_scc1 L_dma_15
    s_mul_i32 s57, s14, 0
    s_add_u32 s58, s57, s15
    s_mov_b32 m0, 30720
L_dma_16:
    s_waitcnt vmcnt(22)
    buffer_load_dwordx4 v3, s[48:51], s57 offen offset:0 nt lds
    buffer_load_dwordx4 v3, s[48:51], s58 offen offset:1024 nt lds
    s_add_u32 s57, s57, s14
    s_add_u32 s58, s58, s14
    s_add_u32 m0, m0, 2048
    s_cmp_lg_u32 m0, 43008
    s_cbranch_scc1 L_dma_16
    s_mov_b32 s57, 100352
    s_mov_b32 s58, 99456
    s_mov_b32 s59, 98560
    s_mov_b32 m0, 104448
L_dma_17:
    s_waitcnt vmcnt(22)
    buffer_load_dwordx4 v5, s[32:35], s57 offen offset:0 nt lds
    buffer_load_dwordx4 v5, s[32:35], s58 offen offset:1024 nt lds
    buffer_load_dwordx4 v5, s[32:35], s59 offen offset:2048 nt lds
    s_add_u32 s57, s57, 24576
    s_add_u32 s58, s58, 24576
    s_add_u32 s59, s59, 24576
    s_add_u32 m0, m0, 3072
    s_cmp_lg_u32 m0, 116736
    s_cbranch_scc1 L_dma_17
L_skip_13:
    s_cmp_eq_u32 s9, 3
    s_waitcnt vmcnt(24)
    s_barrier
    s_cbranch_scc0 L_skip_18
    ds_read_b128 v[64:67], v8 offset:0
    ds_read_b128 v[68:71], v9 offset:0
    ds_read_b128 v[72:75], v8 offset:1024
    ds_read_b128 v[76:79], v9 offset:1024
    ds_read_b128 v[80:83], v8 offset:2048
    ds_read_b128 v[84:87], v9 offset:2048
L_skip_18:
    s_cmp_eq_u32 s30, 6
    s_cbranch_scc0 L_skip_19
    s_mul_i32 s57, s14, 6
    s_add_u32 s58, s57, s15
    s_mov_b32 m0, 43008
L_dma_20:
    s_waitcnt vmcnt(22)
    buffer_load_dwordx4 v3, s[48:51], s57 offen offset:0 nt lds
    buffer_load_dwordx4 v3, s[48:51], s58 offen offset:1024 nt lds
    s_add_u32 s57, s57, s14
    s_add_u32 s58, s58, s14
    s_add_u32 m0, m0, 2048
    s_cmp_lg_u32 m0, 55296
    s_cbranch_scc1 L_dma_20
    s_mov_b32 s57, 198656
    s_mov_b32 s58, 197760
    s_mov_b32 s59, 196864
    s_mov_b32 m0, 116736
L_dma_21:
    s_waitcnt vmcnt(22)
    buffer_load_dwordx4 v5, s[32:35], s57 offen offset:0 nt lds
    buffer_load_dwordx4 v5, s[32:35], s58 offen offset:1024 nt lds
    buffer_load_dwordx4 v5, s[32:35], s59 offen offset:2048 nt lds
    s_add_u32 s57, s57, 24576
    s_add_u32 s58, s58, 24576
    s_add_u32 s59, s59, 24576
    s_add_u32 m0, m0, 3072
    s_cmp_lg_u32 m0, 129024
    s_cbranch_scc1 L_dma_21
L_skip_19:
    s_waitcnt lgkmcnt(0)
    s_cmp_eq_u32 s30, 5
    s_cbranch_scc0 L_skip_22
    s_cmp_eq_u32 s52, 31
    s_cbranch_scc0 L_skip_23
    s_lshl_b32 s57, s31, 5
    v_mov_b32 v16, s57
    s_add_u32 s57, s63, 1
    v_mov_b32 v12, s57
    s_waitcnt vmcnt(5)
    s_mov_b64 exec, 0x1
    global_store_dword v16, v12, s[26:27] sc1
    s_mov_b64 exec, -1
L_skip_23:
L_skip_22:
    s_cmp_eq_u32 s9, 3
    s_waitcnt vmcnt(24)
    s_barrier
    s_cbranch_scc0 L_skip_24
    ds_read_b128 v[88:91], v8 offset:12288
    ds_read_b128 v[92:95], v9 offset:12288
    ds_read_b128 v[96:99], v8 offset:13312
    ds_read_b128 v[100:103], v9 offset:13312
    ds_read_b128 v[104:107], v8 offset:14336
    ds_read_b128 v[108:111], v9 offset:14336
L_skip_24:
    s_cmp_eq_u32 s30, 6
    s_cbranch_scc0 L_skip_25
    s_mov_b32 s57, 296960
    s_mov_b32 s58, 296064
    s_mov_b32 s59, 295168
    s_mov_b32 m0, 129024
L_dma_26:
    s_waitcnt vmcnt(22)
    buffer_load_dwordx4 v5, s[32:35], s57 offen offset:0 nt lds
    buffer_load_dwordx4 v5, s[32:35], s58 offen offset:1024 nt lds
    buffer_load_dwordx4 v5, s[32:35], s59 offen offset:2048 nt lds
    s_add_u32 s57, s57, 24576
    s_add_u32 s58, s58, 24576
    s_add_u32 s59, s59, 24576
    s_add_u32 m0, m0, 3072
    s_cmp_lg_u32 m0, 141312
    s_cbranch_scc1 L_dma_26
    s_mov_b32 s57, 395264
    s_mov_b32 s58, 394368
    s_mov_b32 s59, 393472
    s_mov_b32 m0, 141312
L_dma_27:
    s_waitcnt vmcnt(22)
    buffer_load_dwordx4 v5, s[32:35], s57 offen offset:0 nt lds
    buffer_load_dwordx4 v5, s[32:35], s58 offen offset:1024 nt lds
    buffer_load_dwordx4 v5, s[32:35], s59 offen offset:2048 nt lds
    s_add_u32 s57, s57, 24576
    s_add_u32 s58, s58, 24576
    s_add_u32 s59, s59, 24576
    s_add_u32 m0, m0, 3072
    s_cmp_lg_u32 m0, 153600
    s_cbranch_scc1 L_dma_27
L_skip_25:
    s_waitcnt lgkmcnt(0)
    s_cmp_lt_u32 s30, 4
    s_cbranch_scc0 L_skip_28
    s_mov_b64 exec, 0
    s_cmp_eq_u32 s30, 1
    s_cbranch_scc1 L_pad1
    s_cmp_eq_u32 s30, 2
    s_cbranch_scc1 L_pad2
    s_cmp_eq_u32 s30, 3
    s_cbranch_scc1 L_pad3
    s_branch L_pad0
.p2align 5
L_padback:
    s_mov_b64 exec, -1
L_skip_28:
    s_cmp_eq_u32 s9, 0
    s_waitcnt vmcnt(24)
    s_barrier
    s_cbranch_scc0 L_skip_29
    ds_read_b128 v[64:67], v8 offset:24576
    ds_read_b128 v[68:71], v9 offset:24576
    ds_read_b128 v[72:75], v8 offset:25600
    ds_read_b128 v[76:79], v9 offset:25600
    ds_read_b128 v[80:83], v8 offset:26624
    ds_read_b128 v[84:87], v9 offset:26624
L_skip_29:
    s_cmp_eq_u32 s30, 6
    s_cbranch_scc0 L_skip_30
    s_mov_b32 s57, 493568
    s_mov_b32 s58, 492672
    s_mov_b32 s59, 491776
    s_mov_b32 m0, 92160
L_dma_31:
    s_waitcnt vmcnt(22)
    buffer_load_dwordx4 v5, s[32:35], s57 offen offset:0 nt lds
    buffer_load_dwordx4 v5, s[32:35], s58 offen offset:1024 nt lds
    buffer_load_dwordx4 v5, s[32:35], s59 offen offset:2048 nt lds
    s_add_u32 s57, s57, 24576
    s_add_u32 s58, s58, 24576
    s_add_u32 s59, s59, 24576
    s_add_u32 m0, m0, 3072
    s_cmp_lg_u32 m0, 104448
    s_cbranch_scc1 L_dma_31
L_skip_30:
    s_waitcnt lgkmcnt(0)
    s_cmp_eq_u32 s9, 0
    s_waitcnt vmcnt(24)
    s_barrier
    s_cbranch_scc0 L_skip_32
    ds_read_b128 v[88:91], v8 offset:36864
    ds_read_b128 v[92:95], v9 offset:36864
    ds_read_b128 v[96:99], v8 offset:37888
    ds_read_b128 v[100:103], v9 offset:37888
    ds_read_b128 v[104:107], v8 offset:38912
    ds_read_b128 v[108:111], v9 offset:38912
L_skip_32:
    s_cmp_eq_u32 s30, 6
    s_cbranch_scc0 L_skip_33
    s_mov_b32 s57, 591872
    s_mov_b32 s58, 590976
    s_mov_b32 s59, 590080
    s_mov_b32 m0, 104448
L_dma_34:
    s_waitcnt vmcnt(22)
    buffer_load_dwordx4 v5, s[32:35], s57 offen offset:0 nt lds
    buffer_load_dwordx4 v5, s[32:35], s58 offen offset:1024 nt lds
    buffer_load_dwordx4 v5, s[32:35], s59 offen offset:2048 nt lds
    s_add_u32 s57, s57, 24576
    s_add_u32 s58, s58, 24576
    s_add_u32 s59, s59, 24576
    s_add_u32 m0, m0, 3072
    s_cmp_lg_u32 m0, 116736
    s_cbranch_scc1 L_dma_34
L_skip_33:
    s_waitcnt lgkmcnt(0)
    s_cmp_lt_u32 s30, 5
    s_cbranch_scc0 L_skip_35
    s_waitcnt vmcnt(0)
L_skip_35:
    s_cmp_eq_u32 s30, 7
    s_cbranch_scc0 L_skip_36
    v_and_b32 v60, 31, v0
    v_cmp_gt_u32 s[64:65], 20, v60
    v_min_u32 v60, 19, v60
    v_lshrrev_b32 v35, 5, v0
    v_lshlrev_b32 v35, 2, v35
    v_add_u32 v35, 156736, v35
    v_lshl_add_u32 v35, v60, 3, v35
    s_mul_i32 s66, s53, 12416
    s_add_u32 s66, s66, s62
    s_add_u32 s66, s66, 70656
    s_add_u32 s67, s66, 12288
    s_lshl_b32 s57, s54, 3
    v_lshrrev_b32 v34, 5, v0
    v_lshlrev_b32 v34, 2, v34
    v_add_u32 v34, s57, v34
    v_and_b32 v60, 31, v0
    v_mov_b32 v61, 0x7f000000
    v_cmp_ne_u32 vcc, 31, v60
    s_nop 1
    v_cndmask_b32 v34, v34, v61, vcc
    v_mov_b32 v61, 0x3f803f80
    s_waitcnt vmcnt(0)
    ds_write_b32 v35, v28
    s_waitcnt lgkmcnt(0)
L_skip_36:
    s_cmp_eq_u32 s30, 5
    s_cbranch_scc0 L_skip_37
    s_waitcnt vmcnt(0)
    s_lshr_b32 s67, s63, 2
    s_sub_u32 s58, s3, 20
    s_cmp_lt_u32 s58, 4
    s_cbranch_scc0 L_skip_38
    s_mov_b32 s67, 0
    s_load_dword s66, s[10:11], 0
    s_load_dword s67, s[10:11], 8192
    s_waitcnt lgkmcnt(1)
L_skip_38:
    v_subrev_u32 v16, 8, v0
    v_cmp_gt_u32 vcc, 40, v16
    v_mov_b32 v16, 0x3f803f80
    s_nop 0
    v_cndmask_b32 v18, 0, v16, vcc
    v_min_u32 v16, 55, v0
    v_lshlrev_b32 v16, 2, v16
    v_add_u32 v16, 156896, v16
    ds_write_b32 v16, v18
    s_mov_b32 s65, s67
    s_waitcnt lgkmcnt(0)
L_skip_37:
    s_cmp_eq_u32 s9, 1
    s_waitcnt vmcnt(24)
    s_barrier
    s_cbranch_scc0 L_skip_39
    ds_read_b128 v[64:67], v8 offset:49152
    ds_read_b128 v[68:71], v9 offset:49152
    ds_read_b128 v[72:75], v8 offset:50176
    ds_read_b128 v[76:79], v9 offset:50176
    ds_read_b128 v[80:83], v8 offset:51200
    ds_read_b128 v[84:87], v9 offset:51200
L_skip_39:
    s_cmp_eq_u32 s30, 6
    s_cbranch_scc0 L_skip_40
    s_mov_b32 s57, 690176
    s_mov_b32 s58, 689280
    s_mov_b32 s59, 688384
    s_mov_b32 m0, 116736
L_dma_41:
    s_waitcnt vmcnt(22)
    buffer_load_dwordx4 v5, s[32:35], s57 offen offset:0 nt lds
    buffer_load_dwordx4 v5, s[32:35], s58 offen offset:1024 nt lds
    buffer_load_dwordx4 v5, s[32:35], s59 offen offset:2048 nt lds
    s_add_u32 s57, s57, 24576
    s_add_u32 s58, s58, 24576
    s_add_u32 s59, s59, 24576
    s_add_u32 m0, m0, 3072
    s_cmp_lg_u32 m0, 129024
    s_cbranch_scc1 L_dma_41
L_skip_40:
    s_waitcnt lgkmcnt(0)
    s_cmp_eq_u32 s30, 7
    s_cbranch_scc0 L_skip_42
    v_cndmask_b32 v29, 0, v28, s[64:65]
    v_dot2_f32_bf16 v33, v29, v61, 0
    v_dot2_f32_bf16 v32, v29, v29, 0
    v_lshlrev_b32 v2, 16, v28
    v_and_b32 v3, 0xffff0000, v28
    s_cmp_eq_u32 s55, 0
    v_permlane32_swap_b32 v33, v32
    v_add_f32 v33, v33, v32
    s_nop 1
    v_add_f32_dpp v33, v33, v33 row_ror:8 row_mask:0xf bank_mask:0xf
    s_nop 1
    v_add_f32_dpp v33, v33, v33 row_ror:4 row_mask:0xf bank_mask:0xf
    s_nop 1
    v_add_f32_dpp v33, v33, v33 row_ror:2 row_mask:0xf bank_mask:0xf
    s_nop 1
    v_add_f32_dpp v33, v33, v33 row_ror:1 row_mask:0xf bank_mask:0xf
    s_nop 1
    v_add_f32_dpp v33, v33, v33 row_bcast:15 row_mask:0xa bank_mask:0xf
    s_cbranch_scc1 L_gs_43
    buffer_store_dword v33, v34, s[40:43], s67 offen
L_gb_44:
    s_waitcnt vmcnt(1)
L_skip_42:
    s_cmp_lt_u32 s30, 6
    s_cbranch_scc0 L_skip_45
    s_lshr_b32 s57, s30, 1
    s_mul_i32 s57, s57, 1024
    s_and_b32 s58, s30, 1
    s_lshl_b32 s58, s58, 6
    s_add_u32 s57, s57, s58
    v_lshrrev_b32 v18, 5, v0
    v_mul_u32_u24 v18, 6144, v18
    v_bfe_u32 v60, v0, 3, 1
    v_mul_u32_u24 v60, 3072, v60
    v_add_u32 v18, v60, v18
    v_bfe_u32 v60, v0, 4, 1
    v_lshl_add_u32 v18, v60, 9, v18
    v_bfe_u32 v60, v0, 2, 1
    v_lshl_add_u32 v18, v60, 7, v18
    v_and_b32 v60, 3, v0
    v_lshl_add_u32 v18, v60, 3, v18
    v_add_u32 v18, s57, v18
    v_bfe_u32 v19, v0, 3, 1
    v_mul_u32_u24 v19, 3072, v19
    v_bfe_u32 v60, v0, 4, 1
    v_lshl_add_u32 v19, v60, 9, v19
    v_bfe_u32 v60, v0, 2, 1
    v_lshl_add_u32 v19, v60, 7, v19
    v_and_b32 v60, 3, v0
    v_lshl_add_u32 v19, v60, 3, v19
    v_lshrrev_b32 v60, 5, v0
    v_lshl_add_u32 v19, v60, 5, v19
    v_add_u32 v19, s57, v19
    v_add_u32 v19, 24576, v19
    ds_read_b64_tr_b16 v[28:29], v18 offset:0
    ds_read_b64_tr_b16 v[30:31], v18 offset:256
    ds_read_b64_tr_b16 v[32:33], v18 offset:12288
    ds_read_b64_tr_b16 v[34:35], v18 offset:12544
    ds_read_b64_tr_b16 v[36:37], v18 offset:32
    ds_read_b64_tr_b16 v[38:39], v18 offset:288
    ds_read_b64_tr_b16 v[40:41], v18 offset:12320
    ds_read_b64_tr_b16 v[42:43], v18 offset:12576
    ds_read_b64_tr_b16 v[24:25], v19 offset:0
    ds_read_b64_tr_b16 v[26:27], v19 offset:256
    v_lshrrev_b32 v49, 4, v0
    v_lshlrev_b32 v49, 5, v49
    v_bfe_u32 v60, v0, 1, 1
    v_lshl_add_u32 v49, v60, 4, v49
    v_bfe_u32 v60, v0, 3, 1
    v_mul_u32_u24 v60, 192, v60
    v_add_u32 v49, v60, v49
    v_add_u32 v49, 156736, v49
    v_bfe_u32 v50, v0, 1, 1
    v_lshlrev_b32 v50, 4, v50
    v_bfe_u32 v60, v0, 3, 1
    v_mul_u32_u24 v60, 192, v60
    v_add_u32 v50, v60, v50
    v_add_u32 v50, 156864, v50
    v_mov_b32 v60, 156896
    v_and_b32 v51, 5, v0
    v_cmp_eq_u32 vcc, 0, v51
    s_nop 1
    v_cndmask_b32 v52, v60, v49, vcc
    v_cmp_eq_u32 vcc, 4, v51
    s_nop 1
    v_cndmask_b32 v53, v60, v49, vcc
    v_lshrrev_b32 v49, 2, v0
    v_and_b32 v49, 12, v49
    v_cmp_eq_u32 vcc, v49, v51
    s_nop 1
    v_cndmask_b32 v48, v60, v50, vcc
    v_mov_b64 v[44:45], 0
    v_mov_b64 v[46:47], 0
    s_lshr_b32 s57, s30, 1
    s_lshl_b32 s57, s57, 11
    s_lshl_b32 s58, s58, 1
    s_add_u32 s57, s57, s58
    s_lshl_b32 s58, s54, 8
    s_add_u32 s57, s57, s58
    v_and_b32 v54, 31, v0
    v_lshlrev_b32 v54, 2, v54
    v_lshrrev_b32 v60, 5, v0
    v_mul_u32_u24 v60, 6144, v60
    v_add_u32 v54, v60, v54
    v_add_u32 v54, s57, v54
    s_mul_i32 s59, s53, 12416
    s_add_u32 s59, s59, s62
    s_add_u32 s59, s59, 70656
    s_add_u32 s60, s59, 12288
    ds_read_b128 v[12:15], v52
    ds_read_b128 v[16:19], v53
    ds_read_b128 v[20:23], v48
    s_waitcnt lgkmcnt(2)
    v_smfmac_f32_16x16x64_bf16 v[44:47], v[12:15], v[28:35], v1
    s_waitcnt lgkmcnt(1)
    v_smfmac_f32_16x16x64_bf16 v[44:47], v[16:19], v[36:43], v1
    s_waitcnt lgkmcnt(0)
    v_smfmac_f32_16x16x64_bf16 v[44:47], v[20:23], v[24:31], v1
    s_cmp_eq_u32 s55, 0
    s_nop 6
    v_add_f32 v12, v44, v46
    s_cbranch_scc1 L_gs_46
    buffer_store_dword v12, v54, s[40:43], s59 offen
L_gb_47:
L_skip_45:
    s_cmp_eq_u32 s30, 5
    s_cbranch_scc0 L_skip_48
    global_load_dword v2, v3, s[26:27] sc1
L_skip_48:
    s_cmp_eq_u32 s9, 1
    s_waitcnt vmcnt(24)
    s_barrier
    s_cbranch_scc0 L_skip_49
    ds_read_b128 v[88:91], v8 offset:0
    ds_read_b128 v[92:95], v9 offset:0
    ds_read_b128 v[96:99], v8 offset:1024
    ds_read_b128 v[100:103], v9 offset:1024
    ds_read_b128 v[104:107], v8 offset:2048
    ds_read_b128 v[108:111], v9 offset:2048
L_skip_49:
    s_cmp_eq_u32 s30, 6
    s_cbranch_scc0 L_skip_50
    s_mov_b32 s57, 788480
    s_mov_b32 s58, 787584
    s_mov_b32 s59, 786688
    s_mov_b32 m0, 129024
L_dma_51:
    s_waitcnt vmcnt(22)
    buffer_load_dwordx4 v5, s[32:35], s57 offen offset:0 nt lds
    buffer_load_dwordx4 v5, s[32:35], s58 offen offset:1024 nt lds
    buffer_load_dwordx4 v5, s[32:35], s59 offen offset:2048 nt lds
    s_add_u32 s57, s57, 24576
    s_add_u32 s58, s58, 24576
    s_add_u32 s59, s59, 24576
    s_add_u32 m0, m0, 3072
    s_cmp_lg_u32 m0, 141312
    s_cbranch_scc1 L_dma_51
L_skip_50:
    s_waitcnt lgkmcnt(0)
    s_cmp_eq_u32 s9, 2
    s_waitcnt vmcnt(24)
    s_barrier
    s_cbranch_scc0 L_skip_52
    ds_read_b128 v[64:67], v8 offset:12288
    ds_read_b128 v[68:71], v9 offset:12288
    ds_read_b128 v[72:75], v8 offset:13312
    ds_read_b128 v[76:79], v9 offset:13312
    ds_read_b128 v[80:83], v8 offset:14336
    ds_read_b128 v[84:87], v9 offset:14336
L_skip_52:
    s_cmp_eq_u32 s30, 6
    s_cbranch_scc0 L_skip_53
    s_mov_b32 s57, 886784
    s_mov_b32 s58, 885888
    s_mov_b32 s59, 884992
    s_mov_b32 m0, 141312
L_dma_54:
    s_waitcnt vmcnt(22)
    buffer_load_dwordx4 v5, s[32:35], s57 offen offset:0 nt lds
    buffer_load_dwordx4 v5, s[32:35], s58 offen offset:1024 nt lds
    buffer_load_dwordx4 v5, s[32:35], s59 offen offset:2048 nt lds
    s_add_u32 s57, s57, 24576
    s_add_u32 s58, s58, 24576
    s_add_u32 s59, s59, 24576
    s_add_u32 m0, m0, 3072
    s_cmp_lg_u32 m0, 153600
    s_cbranch_scc1 L_dma_54
L_skip_53:
    s_waitcnt lgkmcnt(0)
    s_cmp_eq_u32 s9, 2
    s_waitcnt vmcnt(24)
    s_barrier
    s_cbranch_scc0 L_skip_55
    ds_read_b128 v[88:91], v8 offset:24576
    ds_read_b128 v[92:95], v9 offset:24576
    ds_read_b128 v[96:99], v8 offset:25600
    ds_read_b128 v[100:103], v9 offset:25600
    ds_read_b128 v[104:107], v8 offset:26624
    ds_read_b128 v[108:111], v9 offset:26624
L_skip_55:
    s_cmp_eq_u32 s30, 6
    s_cbranch_scc0 L_skip_56
    s_mov_b32 s57, 985088
    s_mov_b32 s58, 984192
    s_mov_b32 s59, 983296
    s_mov_b32 m0, 92160
L_dma_57:
    s_waitcnt vmcnt(22)
    buffer_load_dwordx4 v5, s[32:35], s57 offen offset:0 nt lds
    buffer_load_dwordx4 v5, s[32:35], s58 offen offset:1024 nt lds
    buffer_load_dwordx4 v5, s[32:35], s59 offen offset:2048 nt lds
    s_add_u32 s57, s57, 24576
    s_add_u32 s58, s58, 24576
    s_add_u32 s59, s59, 24576
    s_add_u32 m0, m0, 3072
    s_cmp_lg_u32 m0, 104448
    s_cbranch_scc1 L_dma_57
L_skip_56:
    s_waitcnt lgkmcnt(0)
    s_cmp_lg_u32 s30, 6
    s_cbranch_scc0 L_skip_58
    s_waitcnt vmcnt(0)
L_skip_58:
    s_cmp_eq_u32 s9, 3
    s_waitcnt vmcnt(24)
    s_barrier
    s_cbranch_scc0 L_skip_59
    ds_read_b128 v[112:115], v8 offset:36864
    ds_read_b128 v[116:119], v9 offset:36864
    ds_read_b128 v[120:123], v8 offset:37888
    ds_read_b128 v[124:127], v9 offset:37888
    ds_read_b128 v[128:131], v8 offset:38912
    ds_read_b128 v[132:135], v9 offset:38912
L_skip_59:
    s_cmp_eq_u32 s30, 6
    s_cbranch_scc0 L_skip_60
    s_mov_b32 s57, 1083392
    s_mov_b32 s58, 1082496
    s_mov_b32 s59, 1081600
    s_mov_b32 m0, 104448
L_dma_61:
    s_waitcnt vmcnt(22)
    buffer_load_dwordx4 v5, s[32:35], s57 offen offset:0 nt lds
    buffer_load_dwordx4 v5, s[32:35], s58 offen offset:1024 nt lds
    buffer_load_dwordx4 v5, s[32:35], s59 offen offset:2048 nt lds
    s_add_u32 s57, s57, 24576
    s_add_u32 s58, s58, 24576
    s_add_u32 s59, s59, 24576
    s_add_u32 m0, m0, 3072
    s_cmp_lg_u32 m0, 116736
    s_cbranch_scc1 L_dma_61
L_skip_60:
    s_waitcnt lgkmcnt(0)
    s_cmp_eq_u32 s30, 5
    s_cbranch_scc0 L_skip_62
L_cw_63:
    v_readlane_b32 s57, v2, s31
    s_cmp_eq_u32 s57, 0
    s_cbranch_scc1 L_cr_64
    s_lshr_b32 s58, s63, 2
    s_xor_b32 s58, s58, s65
    s_and_b32 s58, s58, 1
    v_mov_b32 v25, s58
    s_sub_u32 s57, s57, 1
    s_cmp_eq_u32 s57, s63
    s_cselect_b32 s64, 1, 0
    s_cbranch_scc0 L_far_65
    s_lshl_b32 s57, s52, 2
    s_add_u32 s57, s57, s72
    s_mov_b64 exec, 1
    buffer_store_dword v25, v0, s[40:43], s57 offen offset:0
    s_mov_b64 exec, -1
L_fb_66:
L_skip_62:
    s_cmp_eq_u32 s9, 3
    s_waitcnt vmcnt(24)
    s_barrier
    s_cbranch_scc0 L_skip_67
    ds_read_b128 v[136:139], v8 offset:49152
    ds_read_b128 v[140:143], v9 offset:49152
    ds_read_b128 v[144:147], v8 offset:50176
    ds_read_b128 v[148:151], v9 offset:50176
    ds_read_b128 v[152:155], v8 offset:51200
    ds_read_b128 v[156:159], v9 offset:51200
L_skip_67:
    s_cmp_eq_u32 s30, 6
    s_cbranch_scc0 L_skip_68
    s_mov_b32 s57, 1181696
    s_mov_b32 s58, 1180800
    s_mov_b32 s59, 1179904
    s_mov_b32 m0, 116736
L_dma_69:
    s_waitcnt vmcnt(22)
    buffer_load_dwordx4 v5, s[32:35], s57 offen offset:0 nt lds
    buffer_load_dwordx4 v5, s[32:35], s58 offen offset:1024 nt lds
    buffer_load_dwordx4 v5, s[32:35], s59 offen offset:2048 nt lds
    s_add_u32 s57, s57, 24576
    s_add_u32 s58, s58, 24576
    s_add_u32 s59, s59, 24576
    s_add_u32 m0, m0, 3072
    s_cmp_lg_u32 m0, 129024
    s_cbranch_scc1 L_dma_69
L_skip_68:
    s_waitcnt lgkmcnt(0)
    s_cmp_eq_u32 s9, 0
    s_waitcnt vmcnt(24)
    s_barrier
    s_cbranch_scc0 L_skip_70
    ds_read_b128 v[112:115], v8 offset:0
    ds_read_b128 v[116:119], v9 offset:0
    ds_read_b128 v[120:123], v8 offset:1024
    ds_read_b128 v[124:127], v9 offset:1024
    ds_read_b128 v[128:131], v8 offset:2048
    ds_read_b128 v[132:135], v9 offset:2048
L_skip_70:
    s_cmp_eq_u32 s30, 6
    s_cbranch_scc0 L_skip_71
    s_mov_b32 s57, 1280000
    s_mov_b32 s58, 1279104
    s_mov_b32 s59, 1278208
    s_mov_b32 m0, 129024
L_dma_72:
    s_waitcnt vmcnt(22)
    buffer_load_dwordx4 v5, s[32:35], s57 offen offset:0 nt lds
    buffer_load_dwordx4 v5, s[32:35], s58 offen offset:1024 nt lds
    buffer_load_dwordx4 v5, s[32:35], s59 offen offset:2048 nt lds
    s_add_u32 s57, s57, 24576
    s_add_u32 s58, s58, 24576
    s_add_u32 s59, s59, 24576
    s_add_u32 m0, m0, 3072
    s_cmp_lg_u32 m0, 141312
    s_cbranch_scc1 L_dma_72
L_skip_71:
    s_waitcnt lgkmcnt(0)
    s_cmp_eq_u32 s9, 0
    s_waitcnt vmcnt(24)
    s_barrier
    s_cbranch_scc0 L_skip_73
    ds_read_b128 v[136:139], v8 offset:12288
    ds_read_b128 v[140:143], v9 offset:12288
    ds_read_b128 v[144:147], v8 offset:13312
    ds_read_b128 v[148:151], v9 offset:13312
    ds_read_b128 v[152:155], v8 offset:14336
    ds_read_b128 v[156:159], v9 offset:14336
L_skip_73:
    s_cmp_eq_u32 s30, 6
    s_cbranch_scc0 L_skip_74
    s_mov_b32 s57, 1378304
    s_mov_b32 s58, 1377408
    s_mov_b32 s59, 1376512
    s_mov_b32 m0, 141312
L_dma_75:
    s_waitcnt vmcnt(22)
    buffer_load_dwordx4 v5, s[32:35], s57 offen offset:0 nt lds
    buffer_load_dwordx4 v5, s[32:35], s58 offen offset:1024 nt lds
    buffer_load_dwordx4 v5, s[32:35], s59 offen offset:2048 nt lds
    s_add_u32 s57, s57, 24576
    s_add_u32 s58, s58, 24576
    s_add_u32 s59, s59, 24576
    s_add_u32 m0, m0, 3072
    s_cmp_lg_u32 m0, 153600
    s_cbranch_scc1 L_dma_75
L_skip_74:
    s_waitcnt lgkmcnt(0)
    s_cmp_eq_u32 s30, 5
    s_cbranch_scc0 L_skip_76
    v_lshlrev_b32 v24, 2, v0
    buffer_load_dword v2, v24, s[40:43], s72 offen sc1
L_skip_76:
    s_cmp_eq_u32 s9, 1
    s_waitcnt vmcnt(24)
    s_barrier
    s_cbranch_scc0 L_skip_77
    ds_read_b128 v[112:115], v8 offset:24576
    ds_read_b128 v[116:119], v9 offset:24576
    ds_read_b128 v[120:123], v8 offset:25600
    ds_read_b128 v[124:127], v9 offset:25600
    ds_read_b128 v[128:131], v8 offset:26624
    ds_read_b128 v[132:135], v9 offset:26624
L_skip_77:
    s_cmp_eq_u32 s30, 6
    s_cbranch_scc0 L_skip_78
    s_mov_b32 s57, 1476608
    s_mov_b32 s58, 1475712
    s_mov_b32 s59, 1474816
    s_mov_b32 m0, 92160
L_dma_79:
    s_waitcnt vmcnt(22)
    buffer_load_dwordx4 v5, s[32:35], s57 offen offset:0 nt lds
    buffer_load_dwordx4 v5, s[32:35], s58 offen offset:1024 nt lds
    buffer_load_dwordx4 v5, s[32:35], s59 offen offset:2048 nt lds
    s_add_u32 s57, s57, 24576
    s_add_u32 s58, s58, 24576
    s_add_u32 s59, s59, 24576
    s_add_u32 m0, m0, 3072
    s_cmp_lg_u32 m0, 104448
    s_cbranch_scc1 L_dma_79
L_skip_78:
    s_waitcnt lgkmcnt(0)
    s_cmp_eq_u32 s9, 1
    s_waitcnt vmcnt(24)
    s_barrier
    s_cbranch_scc0 L_skip_80
    ds_read_b128 v[136:139], v8 offset:36864
    ds_read_b128 v[140:143], v9 offset:36864
    ds_read_b128 v[144:147], v8 offset:37888
    ds_read_b128 v[148:151], v9 offset:37888
    ds_read_b128 v[152:155], v8 offset:38912
    ds_read_b128 v[156:159], v9 offset:38912
L_skip_80:
    s_cmp_eq_u32 s30, 6
    s_cbranch_scc0 L_skip_81
    s_mov_b32 s57, 2048
    s_mov_b32 s58, 1152
    s_mov_b32 s59, 256
    s_mov_b32 s60, 24576
    s_mov_b32 m0, 104448
L_dma_82:
    s_waitcnt vmcnt(22)
    buffer_load_dwordx4 v7, s[36:39], s57 offen offset:0 nt lds
    buffer_load_dwordx4 v7, s[36:39], s58 offen offset:1024 nt lds
    buffer_load_dwordx4 v7, s[36:39], s59 offen offset:2048 nt lds
    s_add_u32 s57, s57, s60
    s_add_u32 s58, s58, s60
    s_add_u32 s59, s59, s60
    s_xor_b32 s60, s60, 81920
    s_add_u32 m0, m0, 3072
    s_cmp_lg_u32 m0, 116736
    s_cbranch_scc1 L_dma_82
L_skip_81:
    s_waitcnt lgkmcnt(0)
    s_cmp_eq_u32 s9, 2
    s_waitcnt vmcnt(24)
    s_barrier
    s_cbranch_scc0 L_skip_83
    ds_read_b128 v[112:115], v8 offset:49152
    ds_read_b128 v[116:119], v9 offset:49152
    ds_read_b128 v[120:123], v8 offset:50176
    ds_read_b128 v[124:127], v9 offset:50176
    ds_read_b128 v[128:131], v8 offset:51200
    ds_read_b128 v[132:135], v9 offset:51200
L_skip_83:
    s_cmp_eq_u32 s30, 6
    s_cbranch_scc0 L_skip_84
    s_mov_b32 s57, 51200
    s_mov_b32 s58, 50304
    s_mov_b32 s59, 49408
    s_mov_b32 s60, 24576
    s_mov_b32 m0, 116736
L_dma_85:
    s_waitcnt vmcnt(22)
    buffer_load_dwordx4 v7, s[36:39], s57 offen offset:0 nt lds
    buffer_load_dwordx4 v7, s[36:39], s58 offen offset:1024 nt lds
    buffer_load_dwordx4 v7, s[36:39], s59 offen offset:2048 nt lds
    s_add_u32 s57, s57, s60
    s_add_u32 s58, s58, s60
    s_add_u32 s59, s59, s60
    s_xor_b32 s60, s60, 81920
    s_add_u32 m0, m0, 3072
    s_cmp_lg_u32 m0, 129024
    s_cbranch_scc1 L_dma_85
L_skip_84:
    s_waitcnt lgkmcnt(0)
    s_cmp_eq_u32 s30, 5
    s_cbranch_scc0 L_skip_86
L_cw_87:
    s_waitcnt vmcnt(0)
    v_cmp_ne_u32 vcc, -1, v2
    s_mov_b32 s57, 0
    s_mov_b32 s68, 2
    s_cmp_eq_u32 s64, 0
    s_cbranch_scc1 L_cd_89
    s_cmp_lg_u32 vcc_hi, 0
    s_cbranch_scc1 L_cd_89
    s_cmp_lg_u32 vcc_lo, -1
    s_cbranch_scc1 L_cr_88
    v_cmp_eq_u32 vcc, 1, v2
    s_bcnt1_i32_b32 s68, vcc_lo
    s_mov_b32 s57, 1
L_cd_89:
    v_mov_b32 v37, 156672
    v_mov_b32 v38, s57
    ds_write_b32 v37, v38
    s_waitcnt lgkmcnt(0)
L_skip_86:
    s_cmp_eq_u32 s9, 2
    s_waitcnt vmcnt(24)
    s_barrier
    s_cbranch_scc0 L_skip_90
    ds_read_b128 v[136:139], v8 offset:0
    ds_read_b128 v[140:143], v9 offset:0
    ds_read_b128 v[144:147], v8 offset:1024
    ds_read_b128 v[148:151], v9 offset:1024
    ds_read_b128 v[152:155], v8 offset:2048
    ds_read_b128 v[156:159], v9 offset:2048
L_skip_90:
    s_cmp_eq_u32 s30, 6
    s_cbranch_scc0 L_skip_91
    s_mov_b32 s57, 198656
    s_mov_b32 s58, 197760
    s_mov_b32 s59, 196864
    s_mov_b32 s60, 24576
    s_mov_b32 m0, 129024
L_dma_92:
    s_waitcnt vmcnt(22)
    buffer_load_dwordx4 v7, s[36:39], s57 offen offset:0 nt lds
    buffer_load_dwordx4 v7, s[36:39], s58 offen offset:1024 nt lds
    buffer_load_dwordx4 v7, s[36:39], s59 offen offset:2048 nt lds
    s_add_u32 s57, s57, s60
    s_add_u32 s58, s58, s60
    s_add_u32 s59, s59, s60
    s_xor_b32 s60, s60, 81920
    s_add_u32 m0, m0, 3072
    s_cmp_lg_u32 m0, 141312
    s_cbranch_scc1 L_dma_92
L_skip_91:
    s_waitcnt lgkmcnt(0)
    v_lshrrev_b32 v8, 5, v0
    v_mul_u32_u24 v8, 6144, v8
    v_bfe_u32 v60, v0, 2, 3
    v_lshl_add_u32 v8, v60, 7, v8
    v_bfe_u32 v60, v0, 3, 2
    v_lshl_add_u32 v8, v60, 5, v8
    v_and_b32 v60, 3, v0
    v_lshl_add_u32 v8, v60, 3, v8
    v_add_u32 v8, s61, v8
    v_xor_b32 v9, 32, v8
    v_xor_b32 v10, 64, v8
    v_xor_b32 v11, 96, v8
    v_mov_b32 v41, 156672
    ds_read_b32 v42, v41
    s_waitcnt lgkmcnt(0)
    v_readfirstlane_b32 s55, v42
    s_cmp_eq_u32 s55, 0
    s_cbranch_scc1 L_spread
L_spread_back:
    s_cmp_eq_u32 s30, 5
    s_cbranch_scc0 L_skip_104
    s_cmp_eq_u32 s52, 31
    s_cbranch_scc0 L_skip_105
    s_lshl_b32 s57, s31, 5
    v_mov_b32 v16, s57
    s_add_u32 s57, s68, 1
    v_mov_b32 v12, s57
    s_mov_b64 exec, 0x1
    global_store_dword v16, v12, s[26:27] offset:4 sc1
    s_mov_b64 exec, -1
L_skip_105:
L_skip_104:
    s_sub_u32 s58, s30, 1
    s_cmp_lt_u32 s58, 3
    s_cbranch_scc0 L_skip_106
    s_mul_i32 s59, s53, 12416
    s_add_u32 s59, s59, s62
    s_add_u32 s59, s59, 70656
    s_add_u32 s60, s59, 12288
    s_lshl_b32 s57, s58, 11
    v_lshlrev_b32 v48, 4, v0
    v_add_u32 v48, s57, v48
    v_and_b32 v49, 7, v0
    v_lshlrev_b32 v49, 3, v49
    s_add_u32 s57, s59, 6144
    buffer_load_dwordx4 v[12:15], v48, s[40:43], s59 offen offset:0 sc1 nt
    buffer_load_dwordx4 v[16:19], v48, s[40:43], s59 offen offset:1024 sc1 nt
    buffer_load_dwordx4 v[28:31], v48, s[40:43], s57 offen offset:0 sc1 nt
    buffer_load_dwordx4 v[32:35], v48, s[40:43], s57 offen offset:1024 sc1 nt
    buffer_load_dwordx2 v[24:25], v49, s[40:43], s60 offen sc1 nt
L_skip_106:
    s_cmp_eq_u32 s9, 3
    s_waitcnt vmcnt(24)
    s_barrier
    s_cbranch_scc0 L_skip_107
    ds_read_b64_tr_b16 v[160:161], v8 offset:12288
    ds_read_b64_tr_b16 v[168:169], v9 offset:12288
    ds_read_b64_tr_b16 v[176:177], v10 offset:12288
    ds_read_b64_tr_b16 v[184:185], v11 offset:12288
    ds_read_b64_tr_b16 v[192:193], v8 offset:13312
    ds_read_b64_tr_b16 v[200:201], v9 offset:13312
    ds_read_b64_tr_b16 v[208:209], v10 offset:13312
    ds_read_b64_tr_b16 v[216:217], v11 offset:13312
    ds_read_b64_tr_b16 v[224:225], v8 offset:14336
    ds_read_b64_tr_b16 v[232:233], v9 offset:14336
    ds_read_b64_tr_b16 v[240:241], v10 offset:14336
    ds_read_b64_tr_b16 v[248:249], v11 offset:14336
L_skip_107:
    s_cmp_eq_u32 s30, 6
    s_cbranch_scc0 L_skip_108
    s_mov_b32 s57, 247808
    s_mov_b32 s58, 246912
    s_mov_b32 s59, 246016
    s_mov_b32 s60, 24576
    s_mov_b32 m0, 141312
L_dma_109:
    s_waitcnt vmcnt(22)
    buffer_load_dwordx4 v7, s[36:39], s57 offen offset:0 nt lds
    buffer_load_dwordx4 v7, s[36:39], s58 offen offset:1024 nt lds
    buffer_load_dwordx4 v7, s[36:39], s59 offen offset:2048 nt lds
    s_add_u32 s57, s57, s60
    s_add_u32 s58, s58, s60
    s_add_u32 s59, s59, s60
    s_xor_b32 s60, s60, 81920
    s_add_u32 m0, m0, 3072
    s_cmp_lg_u32 m0, 153600
    s_cbranch_scc1 L_dma_109
L_skip_108:
    s_waitcnt lgkmcnt(0)
    s_cmp_eq_u32 s9, 3
    s_waitcnt vmcnt(24)
    s_barrier
    s_cbranch_scc0 L_skip_110
    ds_read_b64_tr_b16 v[162:163], v8 offset:24576
    ds_read_b64_tr_b16 v[170:171], v9 offset:24576
    ds_read_b64_tr_b16 v[178:179], v10 offset:24576
    ds_read_b64_tr_b16 v[186:187], v11 offset:24576
    ds_read_b64_tr_b16 v[194:195], v8 offset:25600
    ds_read_b64_tr_b16 v[202:203], v9 offset:25600
    ds_read_b64_tr_b16 v[210:211], v10 offset:25600
    ds_read_b64_tr_b16 v[218:219], v11 offset:25600
    ds_read_b64_tr_b16 v[226:227], v8 offset:26624
    ds_read_b64_tr_b16 v[234:235], v9 offset:26624
    ds_read_b64_tr_b16 v[242:243], v10 offset:26624
    ds_read_b64_tr_b16 v[250:251], v11 offset:26624
L_skip_110:
    s_cmp_eq_u32 s30, 6
    s_cbranch_scc0 L_skip_111
    s_mov_b32 s57, 395264
    s_mov_b32 s58, 394368
    s_mov_b32 s59, 393472
    s_mov_b32 s60, 24576
    s_mov_b32 m0, 92160
L_dma_112:
    s_waitcnt vmcnt(22)
    buffer_load_dwordx4 v7, s[36:39], s57 offen offset:0 nt lds
    buffer_load_dwordx4 v7, s[36:39], s58 offen offset:1024 nt lds
    buffer_load_dwordx4 v7, s[36:39], s59 offen offset:2048 nt lds
    s_add_u32 s57, s57, s60
    s_add_u32 s58, s58, s60
    s_add_u32 s59, s59, s60
    s_xor_b32 s60, s60, 81920
    s_add_u32 m0, m0, 3072
    s_cmp_lg_u32 m0, 104448
    s_cbranch_scc1 L_dma_112
L_skip_111:
    s_waitcnt lgkmcnt(0)
    s_cmp_eq_u32 s9, 0
    s_waitcnt vmcnt(24)
    s_barrier
    s_cbranch_scc0 L_skip_113
    ds_read_b64_tr_b16 v[160:161], v8 offset:36864
    ds_read_b64_tr_b16 v[168:169], v9 offset:36864
    ds_read_b64_tr_b16 v[176:177], v10 offset:36864
    ds_read_b64_tr_b16 v[184:185], v11 offset:36864
    ds_read_b64_tr_b16 v[192:193], v8 offset:37888
    ds_read_b64_tr_b16 v[200:201], v9 offset:37888
    ds_read_b64_tr_b16 v[208:209], v10 offset:37888
    ds_read_b64_tr_b16 v[216:217], v11 offset:37888
    ds_read_b64_tr_b16 v[224:225], v8 offset:38912
    ds_read_b64_tr_b16 v[232:233], v9 offset:38912
    ds_read_b64_tr_b16 v[240:241], v10 offset:38912
    ds_read_b64_tr_b16 v[248:249], v11 offset:38912
L_skip_113:
    s_cmp_eq_u32 s30, 6
    s_cbranch_scc0 L_skip_114
    s_mov_b32 s57, 444416
    s_mov_b32 s58, 443520
    s_mov_b32 s59, 442624
    s_mov_b32 s60, 24576
    s_mov_b32 m0, 104448
L_dma_115:
    s_waitcnt vmcnt(22)
    buffer_load_dwordx4 v7, s[36:39], s57 offen offset:0 nt lds
    buffer_load_dwordx4 v7, s[36:39], s58 offen offset:1024 nt lds
    buffer_load_dwordx4 v7, s[36:39], s59 offen offset:2048 nt lds
    s_add_u32 s57, s57, s60
    s_add_u32 s58, s58, s60
    s_add_u32 s59, s59, s60
    s_xor_b32 s60, s60, 81920
    s_add_u32 m0, m0, 3072
    s_cmp_lg_u32 m0, 116736
    s_cbranch_scc1 L_dma_115
L_skip_114:
    s_waitcnt lgkmcnt(0)
    s_sub_u32 s58, s30, 1
    s_cmp_lt_u32 s58, 3
    s_cbranch_scc0 L_skip_116
    s_lshl_b32 s57, s58, 7
    v_bfe_u32 v51, v0, 2, 2
    v_lshlrev_b32 v51, 5, v51
    v_lshrrev_b32 v60, 5, v0
    v_lshl_add_u32 v51, v60, 4, v51
    v_and_b32 v60, 3, v0
    v_lshl_add_u32 v51, v60, 2, v51
    v_bfe_u32 v60, v0, 4, 1
    v_lshl_add_u32 v51, v60, 1, v51
    v_add_u32 v51, s57, v51
    v_add_u32 v51, 153600, v51
    v_mov_b32 v60, 0x3c75e03e
    v_mov_b32 v61, 0x3a71d1e6
    v_mov_b32 v47, 0x3e13985d
    s_waitcnt vmcnt(0)
    v_pk_add_f32 v[36:37], v[28:29], v[32:33]
    v_pk_add_f32 v[38:39], v[30:31], v[34:35]
    s_nop 1
    v_permlane32_swap_b32 v36, v38
    v_permlane32_swap_b32 v37, v39
    v_pk_add_f32 v[36:37], v[36:37], v[38:39]
    s_nop 1
    v_permlane16_swap_b32 v36, v37
    v_add_f32 v36, v36, v37
    v_mul_f32 v6, 0x3dd53b95, v36
    v_add_f32_dpp v48, v24, v24 row_ror:4 row_mask:0xf bank_mask:0xf
    v_add_f32_dpp v49, v25, v25 row_ror:4 row_mask:0xf bank_mask:0xf
    v_pk_add_f32 v[20:21], v[12:13], v[16:17]
    v_pk_add_f32 v[22:23], v[14:15], v[18:19]
    v_add_f32_dpp v48, v48, v48 row_ror:2 row_mask:0xf bank_mask:0xf
    v_add_f32_dpp v49, v49, v49 row_ror:2 row_mask:0xf bank_mask:0xf
    v_permlane32_swap_b32 v20, v22
    v_permlane32_swap_b32 v21, v23
    v_add_f32_dpp v48, v48, v48 row_ror:1 row_mask:0xf bank_mask:0xf
    v_add_f32_dpp v49, v49, v49 row_ror:1 row_mask:0xf bank_mask:0xf
    v_pk_add_f32 v[20:21], v[20:21], v[22:23]
    v_mul_f32 v48, v48, v60
    v_fma_f32 v49, v49, v47, v61
    v_permlane16_swap_b32 v20, v21
    v_fma_f32 v49, -v48, v48, v49
    v_add_f32 v20, v20, v21
    v_max_f32 v49, v49, v61
    v_mul_f32 v50, v6, v48
    v_rsq_f32 v49, v49
    v_cmp_u_f32 vcc, v20, v20
    v_sub_f32 v20, v20, v50
    v_mul_f32 v20, v20, v49
    v_cvt_pk_bf16_f32 v20, v20, v20
    ds_write_b16 v51, v20
    s_waitcnt lgkmcnt(0)
L_skip_116:
    s_lshl_b32 s57, s30, 7
    s_add_u32 s57, s57, 154624
    v_lshrrev_b32 v58, 4, v0
    v_lshlrev_b32 v58, 5, v58
    v_bfe_u32 v60, v0, 1, 1
    v_lshl_add_u32 v58, v60, 4, v58
    v_bfe_u32 v60, v0, 2, 2
    v_lshl_add_u32 v58, v60, 2, v58
    v_and_b32 v60, 1, v0
    v_lshl_add_u32 v58, v60, 1, v58
    v_add_u32 v58, s57, v58
    v_lshrrev_b32 v61, 4, v0
    v_lshlrev_b32 v61, 5, v61
    v_bfe_u32 v60, v0, 1, 1
    v_lshl_add_u32 v61, v60, 4, v61
    v_add_u32 v61, s57, v61
    v_bfe_u32 v62, v0, 2, 2
    v_lshlrev_b32 v62, 1, v62
    v_and_b32 v60, 1, v0
    v_lshl_add_u32 v62, v60, 0, v62
    v_mov_b32 v60, 156896
    v_cmp_eq_u32 vcc, 0, v62
    s_nop 1
    v_cndmask_b32 v52, v60, v61, vcc
    v_cmp_eq_u32 vcc, 1, v62
    s_nop 1
    v_cndmask_b32 v53, v60, v61, vcc
    v_cmp_eq_u32 vcc, 2, v62
    s_nop 1
    v_cndmask_b32 v54, v60, v61, vcc
    v_cmp_eq_u32 vcc, 3, v62
    s_nop 1
    v_cndmask_b32 v55, v60, v61, vcc
    v_cmp_eq_u32 vcc, 4, v62
    s_nop 1
    v_cndmask_b32 v56, v60, v61, vcc
    v_cmp_eq_u32 vcc, 5, v62
    s_nop 1
    v_cndmask_b32 v57, v60, v61, vcc
    s_lshl_b32 s58, s30, 2
    s_add_u32 s58, s58, 155648
    v_mov_b32 v60, s58
    v_lshlrev_b32 v59, 2, v0
    v_add_u32 v59, 154112, v59
    v_cmp_eq_u32 vcc, 63, v0
    s_nop 1
    v_cndmask_b32 v59, v59, v60, vcc
    v_and_b32 v62, 7, v0
    v_lshlrev_b32 v62, 2, v62
    v_add_u32 v62, 155648, v62
    s_lshl_b32 s57, s30, 10
    v_lshlrev_b32 v63, 4, v0
    v_add_u32 v63, s57, v63
    v_add_u32 v63, 79872, v63
    s_cmp_eq_u32 s9, 0
    s_waitcnt vmcnt(24)
    s_barrier
    s_cbranch_scc0 L_skip_117
    ds_read_b64_tr_b16 v[162:163], v8 offset:49152
    ds_read_b64_tr_b16 v[170:171], v9 offset:49152
    ds_read_b64_tr_b16 v[178:179], v10 offset:49152
    ds_read_b64_tr_b16 v[186:187], v11 offset:49152
    ds_read_b64_tr_b16 v[194:195], v8 offset:50176
    ds_read_b64_tr_b16 v[202:203], v9 offset:50176
    ds_read_b64_tr_b16 v[210:211], v10 offset:50176
    ds_read_b64_tr_b16 v[218:219], v11 offset:50176
    ds_read_b64_tr_b16 v[226:227], v8 offset:51200
    ds_read_b64_tr_b16 v[234:235], v9 offset:51200
    ds_read_b64_tr_b16 v[242:243], v10 offset:51200
    ds_read_b64_tr_b16 v[250:251], v11 offset:51200
L_skip_117:
    s_cmp_eq_u32 s30, 6
    s_cbranch_scc0 L_skip_118
    s_mov_b32 s57, 591872
    s_mov_b32 s58, 590976
    s_mov_b32 s59, 590080
    s_mov_b32 s60, 24576
    s_mov_b32 m0, 116736
L_dma_119:
    s_nop 0
    buffer_load_dwordx4 v7, s[36:39], s57 offen offset:0 nt lds
    buffer_load_dwordx4 v7, s[36:39], s58 offen offset:1024 nt lds
    buffer_load_dwordx4 v7, s[36:39], s59 offen offset:2048 nt lds
    s_add_u32 s57, s57, s60
    s_add_u32 s58, s58, s60
    s_add_u32 s59, s59, s60
    s_xor_b32 s60, s60, 81920
    s_add_u32 m0, m0, 3072
    s_cmp_lg_u32 m0, 129024
    s_cbranch_scc1 L_dma_119
    s_mov_b32 s57, 641024
    s_mov_b32 s58, 640128
    s_mov_b32 s59, 639232
    s_mov_b32 s60, 24576
    s_mov_b32 m0, 129024
L_dma_120:
    s_nop 0
    buffer_load_dwordx4 v7, s[36:39], s57 offen offset:0 nt lds
    buffer_load_dwordx4 v7, s[36:39], s58 offen offset:1024 nt lds
    buffer_load_dwordx4 v7, s[36:39], s59 offen offset:2048 nt lds
    s_add_u32 s57, s57, s60
    s_add_u32 s58, s58, s60
    s_add_u32 s59, s59, s60
    s_xor_b32 s60, s60, 81920
    s_add_u32 m0, m0, 3072
    s_cmp_lg_u32 m0, 141312
    s_cbranch_scc1 L_dma_120
L_skip_118:
    s_waitcnt lgkmcnt(0)
    v_lshrrev_b32 v5, 4, v0
    v_lshlrev_b32 v5, 5, v5
    v_bfe_u32 v60, v0, 1, 1
    v_lshl_add_u32 v5, v60, 4, v5
    v_add_u32 v5, 153600, v5
    ds_read_b128 v[12:15], v5 offset:0
    ds_read_b128 v[16:19], v5 offset:128
    ds_read_b128 v[20:23], v5 offset:256
    v_mov_b64 v[24:25], 0
    v_mov_b64 v[26:27], 0
    v_mov_b64 v[28:29], 0
    v_mov_b64 v[30:31], 0
    v_mov_b64 v[32:33], 0
    v_mov_b64 v[34:35], 0
    v_mov_b64 v[36:37], 0
    v_mov_b64 v[38:39], 0
    v_mov_b64 v[40:41], 0
    v_mov_b64 v[42:43], 0
    v_mov_b64 v[44:45], 0
    v_mov_b64 v[46:47], 0
    s_waitcnt lgkmcnt(0)
    v_smfmac_f32_16x16x64_bf16 v[24:27], v[12:15], v[64:71], v1
    v_smfmac_f32_16x16x64_bf16 v[24:27], v[16:19], v[72:79], v1
    v_smfmac_f32_16x16x64_bf16 v[24:27], v[20:23], v[80:87], v1
    v_smfmac_f32_16x16x64_bf16 v[28:31], v[12:15], v[88:95], v1
    v_smfmac_f32_16x16x64_bf16 v[28:31], v[16:19], v[96:103], v1
    v_smfmac_f32_16x16x64_bf16 v[28:31], v[20:23], v[104:111], v1
    v_smfmac_f32_16x16x64_bf16 v[32:35], v[12:15], v[112:119], v1
    v_smfmac_f32_16x16x64_bf16 v[32:35], v[16:19], v[120:127], v1
    v_smfmac_f32_16x16x64_bf16 v[32:35], v[20:23], v[128:135], v1
    v_smfmac_f32_16x16x64_bf16 v[36:39], v[12:15], v[136:143], v1
    v_smfmac_f32_16x16x64_bf16 v[36:39], v[16:19], v[144:151], v1
    v_smfmac_f32_16x16x64_bf16 v[36:39], v[20:23], v[152:159], v1
    v_add_f32 v24, v24, v26
    s_nop 0
    v_add_f32 v28, v28, v30
    s_nop 1
    v_add_f32 v32, v32, v34
    v_max3_f32 v61, v24, v28, v32
    v_mov_b32_dpp v24, v28 quad_perm:[0,1,2,3] row_mask:0x2 bank_mask:0xf
    v_add_f32 v36, v36, v38
    v_max_f32 v61, v61, v36
    v_mov_b32_dpp v24, v32 quad_perm:[0,1,2,3] row_mask:0x4 bank_mask:0xf
    s_nop 0
    v_max_f32_dpp v61, v61, v61 row_ror:8 row_mask:0xf bank_mask:0xf
    s_nop 0
    v_mov_b32_dpp v24, v36 quad_perm:[0,1,2,3] row_mask:0x8 bank_mask:0xf
    v_max_f32_dpp v61, v61, v61 row_ror:4 row_mask:0xf bank_mask:0xf
    s_nop 1
    v_max_f32_dpp v61, v61, v61 row_ror:2 row_mask:0xf bank_mask:0xf
    s_nop 1
    v_max_f32_dpp v61, v61, v61 row_ror:1 row_mask:0xf bank_mask:0xf
    v_sub_f32 v36, v24, v61
    ds_write_b32 v59, v61
    v_exp_f32 v36, v36
    s_nop 0
    v_cvt_pk_bf16_f32 v39, v36, v36
    ds_write_b16 v58, v39
    ds_read_b128 v[12:15], v52
    ds_read_b128 v[16:19], v53
    ds_read_b128 v[20:23], v54
    ds_read_b128 v[24:27], v55
    ds_read_b128 v[28:31], v56
    ds_read_b128 v[32:35], v57
    v_add_f32_dpp v38, v36, v36 row_ror:8 row_mask:0xf bank_mask:0xf
    s_nop 1
    v_add_f32_dpp v38, v38, v38 row_ror:4 row_mask:0xf bank_mask:0xf
    s_nop 1
    v_add_f32_dpp v38, v38, v38 row_ror:2 row_mask:0xf bank_mask:0xf
    s_nop 1
    v_add_f32_dpp v38, v38, v38 row_ror:1 row_mask:0xf bank_mask:0xf
    s_nop 1
    v_add_f32_dpp v38, v38, v38 row_bcast:15 row_mask:0xa bank_mask:0xf
    s_nop 1
    v_add_f32_dpp v48, v38, v38 row_bcast:31 row_mask:0x8 bank_mask:0xf
    s_waitcnt lgkmcnt(0)
    s_cmp_eq_u32 s9, 1
    s_waitcnt vmcnt(36)
    s_barrier
    s_cbranch_scc0 L_skip_121
    ds_read_b64_tr_b16 v[160:161], v8 offset:0
    ds_read_b64_tr_b16 v[168:169], v9 offset:0
    ds_read_b64_tr_b16 v[176:177], v10 offset:0
    ds_read_b64_tr_b16 v[184:185], v11 offset:0
    ds_read_b64_tr_b16 v[192:193], v8 offset:1024
    ds_read_b64_tr_b16 v[200:201], v9 offset:1024
    ds_read_b64_tr_b16 v[208:209], v10 offset:1024
    ds_read_b64_tr_b16 v[216:217], v11 offset:1024
    ds_read_b64_tr_b16 v[224:225], v8 offset:2048
    ds_read_b64_tr_b16 v[232:233], v9 offset:2048
    ds_read_b64_tr_b16 v[240:241], v10 offset:2048
    ds_read_b64_tr_b16 v[248:249], v11 offset:2048
L_skip_121:
    s_waitcnt lgkmcnt(0)
    ds_read_b32 v36, v62
    s_waitcnt lgkmcnt(0)
    v_max_f32_dpp v37, v36, v36 row_ror:4 row_mask:0xf bank_mask:0xf
    s_nop 1
    v_max_f32_dpp v37, v37, v37 row_ror:2 row_mask:0xf bank_mask:0xf
    s_nop 1
    v_max_f32_dpp v37, v37, v37 row_ror:1 row_mask:0xf bank_mask:0xf
    v_sub_f32 v39, v61, v37
    v_exp_f32 v39, v39
    s_cmp_lt_u32 s30, 2
    s_cbranch_scc0 L_skip_122
    s_lshl_b32 s57, s30, 3
    v_lshlrev_b32 v2, 4, v0
    v_add_u32 v2, s57, v2
    v_add_u32 v2, 79872, v2
    v_mov_b32 v60, 80880
    v_cmp_le_u32 vcc, 48, v0
    s_nop 1
    v_cndmask_b32 v2, v2, v60, vcc
    s_lshr_b32 s57, s54, 1
    s_lshl_b32 s57, s57, 2
    s_and_b32 s58, s54, 1
    s_add_u32 s57, s57, s58
    s_lshl_b32 s58, s57, 4
    s_lshl_b32 s57, s57, 3
    v_bfe_u32 v3, v0, 3, 2
    v_lshlrev_b32 v3, 8, v3
    v_bfe_u32 v61, v0, 2, 1
    v_lshl_add_u32 v3, v61, 5, v3
    v_and_b32 v61, 3, v0
    v_lshl_add_u32 v3, v61, 2, v3
    v_add_u32 v3, s58, v3
    v_bfe_u32 v60, v0, 3, 1
    v_lshlrev_b32 v60, 8, v60
    v_bfe_u32 v61, v0, 1, 1
    v_lshl_add_u32 v60, v61, 7, v60
    v_bfe_u32 v61, v0, 2, 1
    v_lshl_add_u32 v60, v61, 4, v60
    v_and_b32 v61, 1, v0
    v_lshl_add_u32 v60, v61, 2, v60
    v_add_u32 v60, s57, v60
    v_add_u32 v60, 1024, v60
    v_cmp_gt_u32 vcc, 32, v0
    s_nop 1
    v_cndmask_b32 v3, v60, v3, vcc
    s_lshl_b32 s57, s53, 1
    s_add_u32 s57, s57, s30
    s_mul_i32 s57, s57, 1664
    s_add_u32 s57, s57, s62
    v_add_u32 v3, s57, v3
    v_mov_b32 v60, 0x7f000000
    v_cmp_le_u32 vcc, 48, v0
    s_nop 1
    v_cndmask_b32 v3, v3, v60, vcc
    s_lshl_b32 s58, s54, 2
    s_add_u32 s57, s57, s58
    s_add_u32 s57, s57, 1536
    v_mov_b32 v4, s57
    v_mov_b32 v60, 0x7f000000
    v_cmp_ne_u32 vcc, 48, v0
    s_nop 1
    v_cndmask_b32 v4, v4, v60, vcc
    s_mov_b32 s58, 0
    s_cmp_eq_u32 s55, 0
    s_cbranch_scc1 L_gs_123
    buffer_store_dword v37, v4, s[40:43], s58 offen
L_gb_124:
L_skip_122:
    s_cmp_eq_u32 s30, 2
    s_cbranch_scc0 L_skip_125
    v_lshlrev_b32 v2, 2, v0
    v_add_u32 v2, 153600, v2
    v_and_b32 v3, 15, v0
    v_lshlrev_b32 v3, 2, v3
    v_lshrrev_b32 v60, 5, v0
    v_lshl_add_u32 v3, v60, 6, v3
    v_bfe_u32 v60, v0, 4, 1
    v_lshl_add_u32 v3, v60, 13, v3
L_skip_125:
    s_cmp_eq_u32 s9, 1
    s_waitcnt vmcnt(24)
    s_barrier
    s_cbranch_scc0 L_skip_126
    ds_read_b64_tr_b16 v[162:163], v8 offset:12288
    ds_read_b64_tr_b16 v[170:171], v9 offset:12288
    ds_read_b64_tr_b16 v[178:179], v10 offset:12288
    ds_read_b64_tr_b16 v[186:187], v11 offset:12288
    ds_read_b64_tr_b16 v[194:195], v8 offset:13312
    ds_read_b64_tr_b16 v[202:203], v9 offset:13312
    ds_read_b64_tr_b16 v[210:211], v10 offset:13312
    ds_read_b64_tr_b16 v[218:219], v11 offset:13312
    ds_read_b64_tr_b16 v[226:227], v8 offset:14336
    ds_read_b64_tr_b16 v[234:235], v9 offset:14336
    ds_read_b64_tr_b16 v[242:243], v10 offset:14336
    ds_read_b64_tr_b16 v[250:251], v11 offset:14336
L_skip_126:
    s_cmp_eq_u32 s30, 6
    s_cbranch_scc0 L_skip_127
    s_mov_b32 s57, 788480
    s_mov_b32 s58, 787584
    s_mov_b32 s59, 786688
    s_mov_b32 s60, 24576
    s_mov_b32 m0, 141312
L_dma_128:
    s_nop 0
    buffer_load_dwordx4 v7, s[36:39], s57 offen offset:0 nt lds
    buffer_load_dwordx4 v7, s[36:39], s58 offen offset:1024 nt lds
    buffer_load_dwordx4 v7, s[36:39], s59 offen offset:2048 nt lds
    s_add_u32 s57, s57, s60
    s_add_u32 s58, s58, s60
    s_add_u32 s59, s59, s60
    s_xor_b32 s60, s60, 81920
    s_add_u32 m0, m0, 3072
    s_cmp_lg_u32 m0, 153600
    s_cbranch_scc1 L_dma_128
    s_mov_b32 s57, 837632
    s_mov_b32 s58, 836736
    s_mov_b32 s59, 835840
    s_mov_b32 s60, 24576
    s_mov_b32 m0, 92160
L_dma_129:
    s_nop 0
    buffer_load_dwordx4 v7, s[36:39], s57 offen offset:0 nt lds
    buffer_load_dwordx4 v7, s[36:39], s58 offen offset:1024 nt lds
    buffer_load_dwordx4 v7, s[36:39], s59 offen offset:2048 nt lds
    s_add_u32 s57, s57, s60
    s_add_u32 s58, s58, s60
    s_add_u32 s59, s59, s60
    s_xor_b32 s60, s60, 81920
    s_add_u32 m0, m0, 3072
    s_cmp_lg_u32 m0, 104448
    s_cbranch_scc1 L_dma_129
L_skip_127:
    s_waitcnt lgkmcnt(0)
    s_cmp_eq_u32 s30, 5
    s_cbranch_scc0 L_skip_130
    global_load_dword v2, v3, s[26:27] offset:4 sc1
L_skip_130:
    s_cmp_eq_u32 s9, 2
    s_waitcnt vmcnt(36)
    s_barrier
    s_cbranch_scc0 L_skip_131
    ds_read_b64_tr_b16 v[160:161], v8 offset:24576
    ds_read_b64_tr_b16 v[168:169], v9 offset:24576
    ds_read_b64_tr_b16 v[176:177], v10 offset:24576
    ds_read_b64_tr_b16 v[184:185], v11 offset:24576
    ds_read_b64_tr_b16 v[192:193], v8 offset:25600
    ds_read_b64_tr_b16 v[200:201], v9 offset:25600
    ds_read_b64_tr_b16 v[208:209], v10 offset:25600
    ds_read_b64_tr_b16 v[216:217], v11 offset:25600
    ds_read_b64_tr_b16 v[224:225], v8 offset:26624
    ds_read_b64_tr_b16 v[232:233], v9 offset:26624
    ds_read_b64_tr_b16 v[240:241], v10 offset:26624
    ds_read_b64_tr_b16 v[248:249], v11 offset:26624
L_skip_131:
    s_cmp_eq_u32 s30, 6
    s_cbranch_scc0 L_skip_132
    s_mov_b32 s57, 985088
    s_mov_b32 s58, 984192
    s_mov_b32 s59, 983296
    s_mov_b32 s60, 24576
    s_mov_b32 m0, 104448
L_dma_133:
    s_nop 0
    buffer_load_dwordx4 v7, s[36:39], s57 offen offset:0 nt lds
    buffer_load_dwordx4 v7, s[36:39], s58 offen offset:1024 nt lds
    buffer_load_dwordx4 v7, s[36:39], s59 offen offset:2048 nt lds
    s_add_u32 s57, s57, s60
    s_add_u32 s58, s58, s60
    s_add_u32 s59, s59, s60
    s_xor_b32 s60, s60, 81920
    s_add_u32 m0, m0, 3072
    s_cmp_lg_u32 m0, 116736
    s_cbranch_scc1 L_dma_133
L_skip_132:
    s_waitcnt lgkmcnt(0)
    s_cmp_eq_u32 s9, 2
    s_waitcnt vmcnt(36)
    s_barrier
    s_cbranch_scc0 L_skip_134
    ds_read_b64_tr_b16 v[162:163], v8 offset:36864
    ds_read_b64_tr_b16 v[170:171], v9 offset:36864
    ds_read_b64_tr_b16 v[178:179], v10 offset:36864
    ds_read_b64_tr_b16 v[186:187], v11 offset:36864
    ds_read_b64_tr_b16 v[194:195], v8 offset:37888
    ds_read_b64_tr_b16 v[202:203], v9 offset:37888
    ds_read_b64_tr_b16 v[210:211], v10 offset:37888
    ds_read_b64_tr_b16 v[218:219], v11 offset:37888
    ds_read_b64_tr_b16 v[226:227], v8 offset:38912
    ds_read_b64_tr_b16 v[234:235], v9 offset:38912
    ds_read_b64_tr_b16 v[242:243], v10 offset:38912
    ds_read_b64_tr_b16 v[250:251], v11 offset:38912
L_skip_134:
    s_cmp_eq_u32 s30, 6
    s_cbranch_scc0 L_skip_135
    s_mov_b32 s57, 1034240
    s_mov_b32 s58, 1033344
    s_mov_b32 s59, 1032448
    s_mov_b32 s60, 24576
    s_mov_b32 m0, 116736
L_dma_136:
    s_nop 0
    buffer_load_dwordx4 v7, s[36:39], s57 offen offset:0 nt lds
    buffer_load_dwordx4 v7, s[36:39], s58 offen offset:1024 nt lds
    buffer_load_dwordx4 v7, s[36:39], s59 offen offset:2048 nt lds
    s_add_u32 s57, s57, s60
    s_add_u32 s58, s58, s60
    s_add_u32 s59, s59, s60
    s_xor_b32 s60, s60, 81920
    s_add_u32 m0, m0, 3072
    s_cmp_lg_u32 m0, 129024
    s_cbranch_scc1 L_dma_136
L_skip_135:
    s_waitcnt lgkmcnt(0)
    s_cmp_eq_u32 s9, 3
    s_waitcnt vmcnt(36)
    s_barrier
    s_cbranch_scc0 L_skip_137
    ds_read_b64_tr_b16 v[164:165], v8 offset:49152
    ds_read_b64_tr_b16 v[172:173], v9 offset:49152
    ds_read_b64_tr_b16 v[180:181], v10 offset:49152
    ds_read_b64_tr_b16 v[188:189], v11 offset:49152
    ds_read_b64_tr_b16 v[196:197], v8 offset:50176
    ds_read_b64_tr_b16 v[204:205], v9 offset:50176
    ds_read_b64_tr_b16 v[212:213], v10 offset:50176
    ds_read_b64_tr_b16 v[220:221], v11 offset:50176
    ds_read_b64_tr_b16 v[228:229], v8 offset:51200
    ds_read_b64_tr_b16 v[236:237], v9 offset:51200
    ds_read_b64_tr_b16 v[244:245], v10 offset:51200
    ds_read_b64_tr_b16 v[252:253], v11 offset:51200
L_skip_137:
    s_cmp_eq_u32 s30, 6
    s_cbranch_scc0 L_skip_138
    s_mov_b32 s57, 1181696
    s_mov_b32 s58, 1180800
    s_mov_b32 s59, 1179904
    s_mov_b32 s60, 24576
    s_mov_b32 m0, 129024
L_dma_139:
    s_nop 0
    buffer_load_dwordx4 v7, s[36:39], s57 offen offset:0 nt lds
    buffer_load_dwordx4 v7, s[36:39], s58 offen offset:1024 nt lds
    buffer_load_dwordx4 v7, s[36:39], s59 offen offset:2048 nt lds
    s_add_u32 s57, s57, s60
    s_add_u32 s58, s58, s60
    s_add_u32 s59, s59, s60
    s_xor_b32 s60, s60, 81920
    s_add_u32 m0, m0, 3072
    s_cmp_lg_u32 m0, 141312
    s_cbranch_scc1 L_dma_139
L_skip_138:
    s_waitcnt lgkmcnt(0)
    s_cmp_eq_u32 s30, 5
    s_cbranch_scc0 L_skip_140
L_cw_141:
    s_waitcnt vmcnt(0)
    v_cmp_eq_u32 vcc, 0, v2
    s_cbranch_vccnz L_cr_142
    v_add_u32_dpp v2, v2, v2 row_ror:4 row_mask:0xf bank_mask:0xf
    s_nop 1
    v_add_u32_dpp v2, v2, v2 row_ror:2 row_mask:0xf bank_mask:0xf
    s_nop 1
    v_add_u32_dpp v2, v2, v2 row_ror:1 row_mask:0xf bank_mask:0xf
    v_mov_b32 v60, 156676
    ds_write_b32 v60, v2
    s_waitcnt lgkmcnt(0)
L_skip_140:
    s_cmp_eq_u32 s9, 3
    s_waitcnt vmcnt(36)
    s_barrier
    s_cbranch_scc0 L_skip_143
    ds_read_b64_tr_b16 v[166:167], v8 offset:0
    ds_read_b64_tr_b16 v[174:175], v9 offset:0
    ds_read_b64_tr_b16 v[182:183], v10 offset:0
    ds_read_b64_tr_b16 v[190:191], v11 offset:0
    ds_read_b64_tr_b16 v[198:199], v8 offset:1024
    ds_read_b64_tr_b16 v[206:207], v9 offset:1024
    ds_read_b64_tr_b16 v[214:215], v10 offset:1024
    ds_read_b64_tr_b16 v[222:223], v11 offset:1024
    ds_read_b64_tr_b16 v[230:231], v8 offset:2048
    ds_read_b64_tr_b16 v[238:239], v9 offset:2048
    ds_read_b64_tr_b16 v[246:247], v10 offset:2048
    ds_read_b64_tr_b16 v[254:255], v11 offset:2048
L_skip_143:
    s_cmp_eq_u32 s30, 6
    s_cbranch_scc0 L_skip_144
    s_mov_b32 s57, 1230848
    s_mov_b32 s58, 1229952
    s_mov_b32 s59, 1229056
    s_mov_b32 s60, 24576
    s_mov_b32 m0, 141312
L_dma_145:
    s_nop 0
    buffer_load_dwordx4 v7, s[36:39], s57 offen offset:0 nt lds
    buffer_load_dwordx4 v7, s[36:39], s58 offen offset:1024 nt lds
    buffer_load_dwordx4 v7, s[36:39], s59 offen offset:2048 nt lds
    s_add_u32 s57, s57, s60
    s_add_u32 s58, s58, s60
    s_add_u32 s59, s59, s60
    s_xor_b32 s60, s60, 81920
    s_add_u32 m0, m0, 3072
    s_cmp_lg_u32 m0, 153600
    s_cbranch_scc1 L_dma_145
L_skip_144:
    s_cmp_eq_u32 s9, 3
    s_cbranch_scc0 L_skip_146
    s_waitcnt lgkmcnt(8)
    v_smfmac_f32_16x16x64_bf16 v[40:43], v[12:15], v[160:167], v1
    v_smfmac_f32_16x16x64_bf16 v[40:43], v[16:19], v[168:175], v1
    v_smfmac_f32_16x16x64_bf16 v[40:43], v[20:23], v[176:183], v1
    v_smfmac_f32_16x16x64_bf16 v[40:43], v[24:27], v[184:191], v1
    s_waitcnt lgkmcnt(4)
    v_smfmac_f32_16x16x64_bf16 v[40:43], v[28:31], v[192:199], v1
    v_smfmac_f32_16x16x64_bf16 v[40:43], v[32:35], v[200:207], v1
    v_smfmac_f32_16x16x64_bf16 v[44:47], v[12:15], v[208:215], v1
    v_smfmac_f32_16x16x64_bf16 v[44:47], v[16:19], v[216:223], v1
    s_waitcnt lgkmcnt(0)
    v_smfmac_f32_16x16x64_bf16 v[44:47], v[20:23], v[224:231], v1
    v_smfmac_f32_16x16x64_bf16 v[44:47], v[24:27], v[232:239], v1
    v_smfmac_f32_16x16x64_bf16 v[44:47], v[28:31], v[240:247], v1
    v_smfmac_f32_16x16x64_bf16 v[44:47], v[32:35], v[248:255], v1
    s_nop 0
    v_add_f32_dpp v48, v40, v42 quad_perm:[0,1,2,3] row_mask:0x7 bank_mask:0xf
    v_add_f32 v49, v41, v43
    s_nop 4
    v_pk_add_f32 v[50:51], v[44:45], v[46:47]
    v_pk_mul_f32 v[48:49], v[48:49], v[38:39] op_sel:[0,1] op_sel_hi:[1,1]
    v_pk_mul_f32 v[50:51], v[50:51], v[38:39] op_sel:[0,1] op_sel_hi:[1,1]
    ds_write_b128 v63, v[48:51]
L_skip_146:
    s_waitcnt lgkmcnt(0)
    s_cmp_ge_u32 s30, 6
    s_cbranch_scc0 L_skip_147
    v_mov_b32 v60, 156676
    ds_read_b32 v60, v60
    s_lshr_b32 s58, s63, 2
    s_waitcnt lgkmcnt(0)
    v_readfirstlane_b32 s57, v60
    s_cmp_gt_u32 s57, 24
    s_cselect_b32 s57, 1, 0
    s_xor_b32 s57, s57, s58
    s_lshl_b32 s57, s57, 13
    s_add_u32 s7, s8, s57
L_skip_147:
    s_cmp_lt_u32 s3, 20
    s_cbranch_scc0 L_skip_148
    s_mul_i32 s74, s30, 1664
    s_add_u32 s74, s74, s62
    s_add_u32 s74, s74, 0
    v_and_b32 v56, 7, v0
    v_lshlrev_b32 v56, 2, v56
    v_lshrrev_b32 v62, 4, v0
    v_lshlrev_b32 v62, 3, v62
    s_cmp_lg_u32 s30, 6
    s_cbranch_scc0 L_skip_148
    buffer_load_dword v52, v56, s[40:43], s74 offen offset:1536 sc1
    buffer_load_dwordx2 v[54:55], v62, s[40:43], s74 offen offset:1536 sc1
L_skip_148:
    s_cmp_eq_u32 s30, 2
    s_cbranch_scc0 L_skip_149
    s_sub_u32 s57, s3, 20
    s_cmp_lt_u32 s57, 4
    s_cbranch_scc0 L_skip_150
    s_sub_u32 s57, s3, 20
    s_lshl_b32 s57, s57, 6
    v_add_u32 v52, s57, v0
    v_min_u32 v52, 207, v52
    v_lshlrev_b32 v52, 7, v52
    s_add_u32 s57, s62, 0
    buffer_load_dword v52, v52, s[40:43], s57 offen sc1 nt
    s_sub_u32 s57, s3, 20
    s_lshl_b32 s57, s57, 6
    v_add_u32 v53, s57, v0
    v_min_u32 v53, 151, v53
    v_lshlrev_b32 v53, 7, v53
    s_add_u32 s57, s62, 26624
    buffer_load_dword v53, v53, s[40:43], s57 offen sc1 nt
    s_sub_u32 s57, s3, 20
    s_lshl_b32 s57, s57, 6
    v_add_u32 v54, s57, v0
    v_min_u32 v54, 191, v54
    v_lshlrev_b32 v54, 7, v54
    s_add_u32 s57, s62, 46080
    buffer_load_dword v54, v54, s[40:43], s57 offen sc1 nt
L_skip_150:
L_skip_149:
    s_cmp_eq_u32 s9, 0
    s_waitcnt vmcnt(36)
    s_barrier
    s_cbranch_scc0 L_skip_151
    ds_read_b64_tr_b16 v[164:165], v8 offset:12288
    ds_read_b64_tr_b16 v[172:173], v9 offset:12288
    ds_read_b64_tr_b16 v[180:181], v10 offset:12288
    ds_read_b64_tr_b16 v[188:189], v11 offset:12288
    ds_read_b64_tr_b16 v[196:197], v8 offset:13312
    ds_read_b64_tr_b16 v[204:205], v9 offset:13312
    ds_read_b64_tr_b16 v[212:213], v10 offset:13312
    ds_read_b64_tr_b16 v[220:221], v11 offset:13312
    ds_read_b64_tr_b16 v[228:229], v8 offset:14336
    ds_read_b64_tr_b16 v[236:237], v9 offset:14336
    ds_read_b64_tr_b16 v[244:245], v10 offset:14336
    ds_read_b64_tr_b16 v[252:253], v11 offset:14336
L_skip_151:
    s_cmp_eq_u32 s30, 6
    s_cbranch_scc0 L_skip_152
    s_mov_b32 s57, 1378304
    s_mov_b32 s58, 1377408
    s_mov_b32 s59, 1376512
    s_mov_b32 s60, 24576
    s_mov_b32 m0, 92160
L_dma_153:
    s_nop 0
    buffer_load_dwordx4 v7, s[36:39], s57 offen offset:0 nt lds
    buffer_load_dwordx4 v7, s[36:39], s58 offen offset:1024 nt lds
    buffer_load_dwordx4 v7, s[36:39], s59 offen offset:2048 nt lds
    s_add_u32 s57, s57, s60
    s_add_u32 s58, s58, s60
    s_add_u32 s59, s59, s60
    s_xor_b32 s60, s60, 81920
    s_add_u32 m0, m0, 3072
    s_cmp_lg_u32 m0, 104448
    s_cbranch_scc1 L_dma_153
L_skip_152:
    s_waitcnt lgkmcnt(0)
    s_cmp_eq_u32 s9, 0
    s_waitcnt vmcnt(36)
    s_barrier
    s_cbranch_scc0 L_skip_154
    ds_read_b64_tr_b16 v[166:167], v8 offset:24576
    ds_read_b64_tr_b16 v[174:175], v9 offset:24576
    ds_read_b64_tr_b16 v[182:183], v10 offset:24576
    ds_read_b64_tr_b16 v[190:191], v11 offset:24576
    ds_read_b64_tr_b16 v[198:199], v8 offset:25600
    ds_read_b64_tr_b16 v[206:207], v9 offset:25600
    ds_read_b64_tr_b16 v[214:215], v10 offset:25600
    ds_read_b64_tr_b16 v[222:223], v11 offset:25600
    ds_read_b64_tr_b16 v[230:231], v8 offset:26624
    ds_read_b64_tr_b16 v[238:239], v9 offset:26624
    ds_read_b64_tr_b16 v[246:247], v10 offset:26624
    ds_read_b64_tr_b16 v[254:255], v11 offset:26624
    s_waitcnt lgkmcnt(8)
    v_smfmac_f32_16x16x64_bf16 v[40:43], v[12:15], v[160:167], v1
    v_smfmac_f32_16x16x64_bf16 v[40:43], v[16:19], v[168:175], v1
    v_smfmac_f32_16x16x64_bf16 v[40:43], v[20:23], v[176:183], v1
    v_smfmac_f32_16x16x64_bf16 v[40:43], v[24:27], v[184:191], v1
    s_waitcnt lgkmcnt(4)
    v_smfmac_f32_16x16x64_bf16 v[40:43], v[28:31], v[192:199], v1
    v_smfmac_f32_16x16x64_bf16 v[40:43], v[32:35], v[200:207], v1
    v_smfmac_f32_16x16x64_bf16 v[44:47], v[12:15], v[208:215], v1
    v_smfmac_f32_16x16x64_bf16 v[44:47], v[16:19], v[216:223], v1
    s_waitcnt lgkmcnt(0)
    v_smfmac_f32_16x16x64_bf16 v[44:47], v[20:23], v[224:231], v1
    v_smfmac_f32_16x16x64_bf16 v[44:47], v[24:27], v[232:239], v1
    v_smfmac_f32_16x16x64_bf16 v[44:47], v[28:31], v[240:247], v1
    v_smfmac_f32_16x16x64_bf16 v[44:47], v[32:35], v[248:255], v1
    s_nop 0
    v_add_f32_dpp v48, v40, v42 quad_perm:[0,1,2,3] row_mask:0x7 bank_mask:0xf
    v_add_f32 v49, v41, v43
    s_nop 4
    v_pk_add_f32 v[50:51], v[44:45], v[46:47]
    v_pk_mul_f32 v[48:49], v[48:49], v[38:39] op_sel:[0,1] op_sel_hi:[1,1]
    v_pk_mul_f32 v[50:51], v[50:51], v[38:39] op_sel:[0,1] op_sel_hi:[1,1]
    ds_write_b128 v63, v[48:51]
L_skip_154:
    s_cmp_eq_u32 s30, 6
    s_cbranch_scc0 L_skip_155
    s_mov_b32 s57, 1427456
    s_mov_b32 s58, 1426560
    s_mov_b32 s59, 1425664
    s_mov_b32 s60, 24576
    s_mov_b32 m0, 104448
L_dma_156:
    s_nop 0
    buffer_load_dwordx4 v7, s[36:39], s57 offen offset:0 nt lds
    buffer_load_dwordx4 v7, s[36:39], s58 offen offset:1024 nt lds
    buffer_load_dwordx4 v7, s[36:39], s59 offen offset:2048 nt lds
    s_add_u32 s57, s57, s60
    s_add_u32 s58, s58, s60
    s_add_u32 s59, s59, s60
    s_xor_b32 s60, s60, 81920
    s_add_u32 m0, m0, 3072
    s_cmp_lg_u32 m0, 116736
    s_cbranch_scc1 L_dma_156
L_skip_155:
    s_waitcnt lgkmcnt(0)
    s_cmp_eq_u32 s9, 1
    s_waitcnt vmcnt(36)
    s_barrier
    s_cbranch_scc0 L_skip_157
    ds_read_b64_tr_b16 v[164:165], v8 offset:36864
    ds_read_b64_tr_b16 v[172:173], v9 offset:36864
    ds_read_b64_tr_b16 v[180:181], v10 offset:36864
    ds_read_b64_tr_b16 v[188:189], v11 offset:36864
    ds_read_b64_tr_b16 v[196:197], v8 offset:37888
    ds_read_b64_tr_b16 v[204:205], v9 offset:37888
    ds_read_b64_tr_b16 v[212:213], v10 offset:37888
    ds_read_b64_tr_b16 v[220:221], v11 offset:37888
    ds_read_b64_tr_b16 v[228:229], v8 offset:38912
    ds_read_b64_tr_b16 v[236:237], v9 offset:38912
    ds_read_b64_tr_b16 v[244:245], v10 offset:38912
    ds_read_b64_tr_b16 v[252:253], v11 offset:38912
L_skip_157:
    s_cmp_eq_u32 s30, 6
    s_cbranch_scc0 L_skip_158
    s_mul_i32 s57, s14, 12
    s_add_u32 s58, s57, s15
    s_mov_b32 m0, 55296
L_dma_159:
    s_nop 0
    buffer_load_dwordx4 v3, s[48:51], s57 offen offset:0 nt lds
    buffer_load_dwordx4 v3, s[48:51], s58 offen offset:1024 nt lds
    s_add_u32 s57, s57, s14
    s_add_u32 s58, s58, s14
    s_add_u32 m0, m0, 2048
    s_cmp_lg_u32 m0, 67584
    s_cbranch_scc1 L_dma_159
L_skip_158:
    s_waitcnt lgkmcnt(0)
    s_cmp_lt_u32 s30, 5
    s_cbranch_scc0 L_skip_160
    s_waitcnt vmcnt(0)
L_skip_160:
    s_cmp_lt_u32 s3, 20
    s_cbranch_scc0 L_skip_161
    v_lshlrev_b32 v57, 4, v0
    v_lshlrev_b32 v58, 3, v0
    s_mul_i32 s57, s30, 6144
    s_add_u32 s57, s57, 30720
    v_lshrrev_b32 v59, 2, v0
    v_lshlrev_b32 v59, 6, v59
    v_bfe_u32 v53, v0, 4, 1
    v_lshl_add_u32 v59, v53, 5, v59
    v_and_b32 v53, 3, v0
    v_lshl_add_u32 v59, v53, 3, v59
    v_add_u32 v59, s57, v59
    v_xor_b32 v60, 32, v59
    s_lshl_b32 s57, s30, 8
    s_add_u32 s57, s57, 153600
    v_lshl_add_u32 v61, v0, 2, s57
    s_cmp_lg_u32 s30, 6
    s_cbranch_scc0 L_skip_161
L_cw_162:
    s_waitcnt vmcnt(0)
    v_max3_u32 v53, v52, v54, v55
    v_cmp_eq_u32 vcc, -1, v53
    s_cbranch_vccnz L_cr_163
    v_max_f32_dpp v53, v52, v52 row_ror:4 row_mask:0xf bank_mask:0xf
    s_nop 1
    v_max_f32_dpp v53, v53, v53 row_ror:2 row_mask:0xf bank_mask:0xf
    s_nop 1
    v_max_f32_dpp v53, v53, v53 row_ror:1 row_mask:0xf bank_mask:0xf
    v_sub_f32 v52, v52, v53
    v_sub_f32 v54, v54, v53
    v_sub_f32 v55, v55, v53
    v_exp_f32 v52, v52
    v_exp_f32 v54, v54
    v_exp_f32 v55, v55
    s_cmp_eq_u32 s30, 7
    s_cbranch_scc0 L_skip_161
    v_add_u32 v62, 154624, v57
    ds_write_b128 v62, v[52:55]
    s_waitcnt lgkmcnt(0)
L_skip_161:
    s_branch L_tail
.p2align 10
L_tail:
L_pad0:
    s_cbranch_execz L_pad4
    s_cmp_eq_u32 s9, 1
    s_waitcnt vmcnt(36)
    s_barrier
    s_cbranch_scc0 L_skip_164
    ds_read_b64_tr_b16 v[166:167], v8 offset:49152
    ds_read_b64_tr_b16 v[174:175], v9 offset:49152
    ds_read_b64_tr_b16 v[182:183], v10 offset:49152
    ds_read_b64_tr_b16 v[190:191], v11 offset:49152
    ds_read_b64_tr_b16 v[198:199], v8 offset:50176
    ds_read_b64_tr_b16 v[206:207], v9 offset:50176
    ds_read_b64_tr_b16 v[214:215], v10 offset:50176
    ds_read_b64_tr_b16 v[222:223], v11 offset:50176
    ds_read_b64_tr_b16 v[230:231], v8 offset:51200
    ds_read_b64_tr_b16 v[238:239], v9 offset:51200
    ds_read_b64_tr_b16 v[246:247], v10 offset:51200
    ds_read_b64_tr_b16 v[254:255], v11 offset:51200
    s_waitcnt lgkmcnt(8)
    v_smfmac_f32_16x16x64_bf16 v[40:43], v[12:15], v[160:167], v1
    v_smfmac_f32_16x16x64_bf16 v[40:43], v[16:19], v[168:175], v1
    v_smfmac_f32_16x16x64_bf16 v[40:43], v[20:23], v[176:183], v1
    v_smfmac_f32_16x16x64_bf16 v[40:43], v[24:27], v[184:191], v1
    s_waitcnt lgkmcnt(4)
    v_smfmac_f32_16x16x64_bf16 v[40:43], v[28:31], v[192:199], v1
    v_smfmac_f32_16x16x64_bf16 v[40:43], v[32:35], v[200:207], v1
    v_smfmac_f32_16x16x64_bf16 v[44:47], v[12:15], v[208:215], v1
    v_smfmac_f32_16x16x64_bf16 v[44:47], v[16:19], v[216:223], v1
    s_waitcnt lgkmcnt(0)
    v_smfmac_f32_16x16x64_bf16 v[44:47], v[20:23], v[224:231], v1
    v_smfmac_f32_16x16x64_bf16 v[44:47], v[24:27], v[232:239], v1
    v_smfmac_f32_16x16x64_bf16 v[44:47], v[28:31], v[240:247], v1
    v_smfmac_f32_16x16x64_bf16 v[44:47], v[32:35], v[248:255], v1
    s_nop 0
    v_add_f32_dpp v48, v40, v42 quad_perm:[0,1,2,3] row_mask:0x7 bank_mask:0xf
    v_add_f32 v49, v41, v43
    s_nop 4
    v_pk_add_f32 v[50:51], v[44:45], v[46:47]
    v_pk_mul_f32 v[48:49], v[48:49], v[38:39] op_sel:[0,1] op_sel_hi:[1,1]
    v_pk_mul_f32 v[50:51], v[50:51], v[38:39] op_sel:[0,1] op_sel_hi:[1,1]
    ds_write_b128 v63, v[48:51]
L_skip_164:
    s_cmp_eq_u32 s30, 6
    s_cbranch_scc0 L_skip_165
    s_mul_i32 s57, s14, 18
    s_add_u32 s58, s57, s15
    s_mov_b32 m0, 67584
L_dma_166:
    s_nop 0
    buffer_load_dwordx4 v3, s[48:51], s57 offen offset:0 nt lds
    buffer_load_dwordx4 v3, s[48:51], s58 offen offset:1024 nt lds
    s_add_u32 s57, s57, s14
    s_add_u32 s58, s58, s14
    s_add_u32 m0, m0, 2048
    s_cmp_lg_u32 m0, 79872
    s_cbranch_scc1 L_dma_166
L_skip_165:
    s_waitcnt lgkmcnt(0)
    s_cmp_lt_u32 s3, 20
    s_cbranch_scc0 L_skip_167
    s_cmp_eq_u32 s30, 6
    s_cbranch_scc0 L_skip_167
    v_add_u32 v62, 154624, v57
    ds_read_b128 v[52:55], v62
L_skip_167:
    s_cmp_eq_u32 s9, 2
    s_waitcnt vmcnt(36)
    s_barrier
    s_cbranch_scc0 L_skip_168
    ds_read_b64_tr_b16 v[164:165], v8 offset:0
    ds_read_b64_tr_b16 v[172:173], v9 offset:0
    ds_read_b64_tr_b16 v[180:181], v10 offset:0
    ds_read_b64_tr_b16 v[188:189], v11 offset:0
    ds_read_b64_tr_b16 v[196:197], v8 offset:1024
    ds_read_b64_tr_b16 v[204:205], v9 offset:1024
    ds_read_b64_tr_b16 v[212:213], v10 offset:1024
    ds_read_b64_tr_b16 v[220:221], v11 offset:1024
    ds_read_b64_tr_b16 v[228:229], v8 offset:2048
    ds_read_b64_tr_b16 v[236:237], v9 offset:2048
    ds_read_b64_tr_b16 v[244:245], v10 offset:2048
    ds_read_b64_tr_b16 v[252:253], v11 offset:2048
L_skip_168:
    s_waitcnt lgkmcnt(0)
    s_cmp_eq_u32 s9, 2
    s_waitcnt vmcnt(24)
    s_barrier
L_pad1:
    s_cbranch_execz L_pad5
    s_cbranch_scc0 L_skip_169
    ds_read_b64_tr_b16 v[166:167], v8 offset:12288
    ds_read_b64_tr_b16 v[174:175], v9 offset:12288
    ds_read_b64_tr_b16 v[182:183], v10 offset:12288
    ds_read_b64_tr_b16 v[190:191], v11 offset:12288
    ds_read_b64_tr_b16 v[198:199], v8 offset:13312
    ds_read_b64_tr_b16 v[206:207], v9 offset:13312
    ds_read_b64_tr_b16 v[214:215], v10 offset:13312
    ds_read_b64_tr_b16 v[222:223], v11 offset:13312
    ds_read_b64_tr_b16 v[230:231], v8 offset:14336
    ds_read_b64_tr_b16 v[238:239], v9 offset:14336
    ds_read_b64_tr_b16 v[246:247], v10 offset:14336
    ds_read_b64_tr_b16 v[254:255], v11 offset:14336
    s_waitcnt lgkmcnt(8)
    v_smfmac_f32_16x16x64_bf16 v[40:43], v[12:15], v[160:167], v1
    v_smfmac_f32_16x16x64_bf16 v[40:43], v[16:19], v[168:175], v1
    v_smfmac_f32_16x16x64_bf16 v[40:43], v[20:23], v[176:183], v1
    v_smfmac_f32_16x16x64_bf16 v[40:43], v[24:27], v[184:191], v1
    s_waitcnt lgkmcnt(4)
    v_smfmac_f32_16x16x64_bf16 v[40:43], v[28:31], v[192:199], v1
    v_smfmac_f32_16x16x64_bf16 v[40:43], v[32:35], v[200:207], v1
    v_smfmac_f32_16x16x64_bf16 v[44:47], v[12:15], v[208:215], v1
    v_smfmac_f32_16x16x64_bf16 v[44:47], v[16:19], v[216:223], v1
    s_waitcnt lgkmcnt(0)
    v_smfmac_f32_16x16x64_bf16 v[44:47], v[20:23], v[224:231], v1
    v_smfmac_f32_16x16x64_bf16 v[44:47], v[24:27], v[232:239], v1
    v_smfmac_f32_16x16x64_bf16 v[44:47], v[28:31], v[240:247], v1
    v_smfmac_f32_16x16x64_bf16 v[44:47], v[32:35], v[248:255], v1
    s_nop 0
    v_add_f32_dpp v48, v40, v42 quad_perm:[0,1,2,3] row_mask:0x7 bank_mask:0xf
    v_add_f32 v49, v41, v43
    s_nop 4
    v_pk_add_f32 v[50:51], v[44:45], v[46:47]
    v_pk_mul_f32 v[48:49], v[48:49], v[38:39] op_sel:[0,1] op_sel_hi:[1,1]
    v_pk_mul_f32 v[50:51], v[50:51], v[38:39] op_sel:[0,1] op_sel_hi:[1,1]
    ds_write_b128 v63, v[48:51]
L_skip_169:
    s_setprio 0
    s_cmp_lt_u32 s30, 2
    s_cbranch_scc1 L_comb_0
    s_waitcnt lgkmcnt(0)
    s_barrier
.p2align 5
L_comb_0b:
    s_cmp_eq_u32 s30, 6
    s_cbranch_scc0 L_skip_174
    s_waitcnt vmcnt(0)
L_skip_174:
    s_barrier
    s_cmp_lt_u32 s3, 20
    s_cbranch_scc0 L_typeB_0
    buffer_load_dwordx4 v[12:15], v57, s[40:43], s74 offen sc1
    buffer_load_dwordx2 v[16:17], v58, s[40:43], s74 offen offset:1024 sc1
    buffer_load_dword v18, v56, s[40:43], s74 offen offset:1568 sc1
    ds_read_b64_tr_b16 v[28:29], v59 offset:0
    ds_read_b64_tr_b16 v[30:31], v59 offset:1024
    ds_read_b64_tr_b16 v[32:33], v59 offset:2048
    ds_read_b64_tr_b16 v[34:35], v59 offset:3072
    ds_read_b64_tr_b16 v[36:37], v59 offset:4096
    ds_read_b64_tr_b16 v[38:39], v59 offset:5120
    ds_read_b64_tr_b16 v[40:41], v60 offset:0
    ds_read_b64_tr_b16 v[42:43], v60 offset:1024
    ds_read_b64_tr_b16 v[44:45], v60 offset:2048
    ds_read_b64_tr_b16 v[46:47], v60 offset:3072
    ds_read_b64_tr_b16 v[48:49], v60 offset:4096
    ds_read_b64_tr_b16 v[50:51], v60 offset:5120
    v_mov_b64 v[20:21], 0
    v_mov_b64 v[22:23], 0
    v_mov_b64 v[24:25], 0
    v_mov_b64 v[26:27], 0
    s_add_u32 s58, s6, 0
    s_waitcnt lgkmcnt(0)
    s_branch L_ow_175
.p2align 5
L_or_176:
    buffer_load_dwordx4 v[12:15], v57, s[40:43], s74 offen sc1
    buffer_load_dwordx2 v[16:17], v58, s[40:43], s74 offen offset:1024 sc1
    buffer_load_dword v18, v56, s[40:43], s74 offen offset:1568 sc1
    s_sub_u32 s56, s56, 1
    s_cbranch_scc1 L_done
L_pad2:
    s_cbranch_execz L_pad6
    v_mov_b64 v[20:21], 0
    v_mov_b64 v[22:23], 0
    v_mov_b64 v[24:25], 0
    v_mov_b64 v[26:27], 0
L_ow_175:
    s_waitcnt vmcnt(2)
    v_smfmac_f32_16x16x64_bf16 v[20:23], v[12:15], v[28:35], v1
    s_nop 2
    v_smfmac_f32_16x16x64_bf16 v[24:27], v[12:15], v[40:47], v1
    s_waitcnt vmcnt(0)
    v_mul_f32 v53, v52, v18
    v_smfmac_f32_16x16x32_bf16 v[20:23], v[16:17], v[36:39], v1
    s_nop 2
    v_smfmac_f32_16x16x32_bf16 v[24:27], v[16:17], v[48:51], v1
    v_add_f32_dpp v53, v53, v53 row_ror:4 row_mask:0xf bank_mask:0xf
    v_max3_u32 v19, v12, v13, v14
    v_max3_u32 v62, v15, v16, v17
    v_add_f32_dpp v53, v53, v53 row_ror:2 row_mask:0xf bank_mask:0xf
    v_max3_u32 v19, v19, v62, v18
    s_cmp_eq_u32 s30, 2
    v_add_f32_dpp v53, v53, v53 row_ror:1 row_mask:0xf bank_mask:0xf
    v_cmp_eq_u32 vcc, -1, v19
    v_rcp_f32 v53, v53
    s_cbranch_vccnz L_or_176
    v_pk_add_f32 v[20:21], v[20:21], v[22:23]
    v_pk_add_f32 v[24:25], v[24:25], v[26:27]
    v_pk_mul_f32 v[54:55], v[54:55], v[52:53] op_sel:[0,1] op_sel_hi:[1,1]
    v_mul_f32 v20, v20, v54
    v_mul_f32 v24, v24, v54
    v_fmac_f32 v20, v21, v55
    v_fmac_f32 v24, v25, v55
    s_nop 1
    v_permlane32_swap_b32 v20, v24
    v_add_f32 v20, v20, v24
    ds_write_b32 v61, v20
    s_waitcnt lgkmcnt(0)
    s_barrier
    s_cbranch_scc0 L_finb_177
    ds_read2st64_b32 v[12:13], v2 offset0:0 offset1:1
    ds_read2st64_b32 v[14:15], v2 offset0:2 offset1:3
    ds_read2st64_b32 v[16:17], v2 offset0:4 offset1:5
    ds_read2st64_b32 v[18:19], v2 offset0:6 offset1:7
    s_waitcnt lgkmcnt(2)
    v_pk_add_f32 v[12:13], v[12:13], v[14:15]
    s_waitcnt lgkmcnt(0)
    v_pk_add_f32 v[16:17], v[16:17], v[18:19]
    v_pk_add_f32 v[12:13], v[12:13], v[16:17]
    v_add_f32 v14, v12, v13
    v_add_f32 v15, v12, v13
    s_nop 1
    v_permlane16_swap_b32 v14, v15
    v_add_f32 v12, v14, v15
    buffer_store_dword v12, v3, s[40:43], s58 offen sc1
.p2align 5
L_finb_177:
    s_sub_u32 s57, s30, 4
    s_cmp_lt_u32 s57, 3
    s_cbranch_scc0 L_skip_178
    s_sub_u32 s60, s30, 4
    s_lshl_b32 s57, s60, 11
    v_lshlrev_b32 v11, 4, v0
    v_add_u32 v11, s57, v11
    s_add_u32 s65, s62, 19456
    buffer_load_dwordx4 v[52:55], v11, s[40:43], s65 offen offset:0 sc1
    buffer_load_dwordx4 v[56:59], v11, s[40:43], s65 offen offset:1024 sc1
    s_lshl_b32 s59, s60, 12
    s_add_u32 s59, s59, 79872
    s_mov_b32 s44, s20
    s_mov_b32 s45, s21
    s_mov_b32 s46, 1966080
    s_mov_b32 s47, 0x20000
    s_mul_i32 s57, s31, 3
    s_add_u32 s57, s57, s60
    s_mul_i32 s57, s57, 81920
    s_lshl_b32 s64, s3, 6
    s_add_u32 s57, s57, s64
    v_lshrrev_b32 v5, 2, v0
    v_mul_u32_u24 v5, 1280, v5
    v_and_b32 v60, 3, v0
    v_lshl_add_u32 v5, v60, 4, v5
    v_add_u32 v5, s57, v5
    s_add_u32 m0, s59, 0
    s_mov_b32 s57, 0
    buffer_load_dwordx4 v5, s[44:47], s57 offen nt lds
    s_add_u32 m0, s59, 1024
    s_mov_b32 s57, 20480
    buffer_load_dwordx4 v5, s[44:47], s57 offen nt lds
    s_add_u32 m0, s59, 2048
    s_mov_b32 s57, 40960
L_pad3:
    s_cbranch_execz L_pad7
    buffer_load_dwordx4 v5, s[44:47], s57 offen nt lds
    s_add_u32 m0, s59, 3072
    s_mov_b32 s57, 61440
    buffer_load_dwordx4 v5, s[44:47], s57 offen nt lds
    v_bfe_u32 v35, v0, 4, 1
    v_lshlrev_b32 v35, 11, v35
    v_bfe_u32 v60, v0, 2, 2
    v_lshl_add_u32 v35, v60, 8, v35
    v_lshrrev_b32 v60, 5, v0
    v_lshl_add_u32 v35, v60, 6, v35
    v_and_b32 v60, 3, v0
    v_lshl_add_u32 v35, v60, 3, v35
    v_add_u32 v35, s59, v35
    v_mov_b32 v9, 0xbdd2d3e8
    v_mov_b32 v10, 0xc0135761
    s_lshl_b32 s57, s60, 7
    s_add_u32 s57, s57, 155776
    v_lshlrev_b32 v32, 3, v0
    v_add_u32 v32, s57, v32
    v_lshlrev_b32 v33, 3, v0
    v_add_u32 v33, 129024, v33
    v_cmp_gt_u32 vcc, 16, v0
    s_nop 1
    v_cndmask_b32 v32, v33, v32, vcc
    v_and_b32 v33, 15, v0
    v_lshlrev_b32 v33, 3, v33
    v_lshrrev_b32 v60, 5, v0
    v_lshl_add_u32 v33, v60, 2, v33
    v_add_u32 v33, 155776, v33
    v_and_b32 v34, 15, v0
    v_lshlrev_b32 v34, 2, v34
    v_lshrrev_b32 v60, 5, v0
    v_lshl_add_u32 v34, v60, 6, v34
    v_bfe_u32 v60, v0, 4, 1
    v_lshl_add_u32 v34, v60, 13, v34
    s_add_u32 s60, s6, 66048
    s_add_u32 s58, s62, 13312
    s_add_u32 s57, s62, 25856
    v_and_b32 v7, 7, v0
    v_lshlrev_b32 v7, 3, v7
    v_mov_b32 v60, 0x3acccccd
    v_mov_b32 v61, 0x3727c5ac
    s_waitcnt vmcnt(0)
    buffer_load_dwordx2 v[24:25], v7, s[40:43], s57 offen sc1
    buffer_load_dwordx4 v[12:15], v11, s[40:43], s58 offen offset:0 sc1
    buffer_load_dwordx4 v[16:19], v11, s[40:43], s58 offen offset:1024 sc1
    ds_read_b64_tr_b16 v[36:37], v35 offset:0
    ds_read_b64_tr_b16 v[38:39], v35 offset:1024
    ds_read_b64_tr_b16 v[40:41], v35 offset:128
    ds_read_b64_tr_b16 v[42:43], v35 offset:1152
    ds_read_b64_tr_b16 v[44:45], v35 offset:32
    ds_read_b64_tr_b16 v[46:47], v35 offset:1056
    ds_read_b64_tr_b16 v[48:49], v35 offset:160
    ds_read_b64_tr_b16 v[50:51], v35 offset:1184
L_sw_181:
    v_max3_u32 v20, v52, v53, v54
    v_max3_u32 v20, v20, v55, v56
    v_max3_u32 v20, v20, v57, v58
    v_max_u32 v20, v20, v59
    v_cmp_eq_u32 vcc, -1, v20
    s_cbranch_vccnz L_sr_182
    v_pk_add_f32 v[28:29], v[52:53], v[56:57]
    v_pk_add_f32 v[30:31], v[54:55], v[58:59]
    s_nop 1
    v_permlane32_swap_b32 v28, v30
    v_permlane32_swap_b32 v29, v31
    v_pk_add_f32 v[28:29], v[28:29], v[30:31]
    s_nop 1
    v_permlane16_swap_b32 v28, v29
    v_add_f32 v28, v28, v29
    v_mov_b64 v[52:53], 0
    v_mov_b64 v[54:55], 0
    v_mov_b64 v[56:57], 0
    v_mov_b64 v[58:59], 0
    s_waitcnt lgkmcnt(0)
    s_branch L_pw_179
.p2align 5
L_pr_180:
    buffer_load_dwordx2 v[24:25], v7, s[40:43], s57 offen sc1
    buffer_load_dwordx4 v[12:15], v11, s[40:43], s58 offen offset:0 sc1
    buffer_load_dwordx4 v[16:19], v11, s[40:43], s58 offen offset:1024 sc1
    s_sub_u32 s56, s56, 1
    s_cbranch_scc1 L_done
L_pw_179:
L_pad4:
    s_cbranch_execz L_pad8
    s_waitcnt vmcnt(0)
    v_max_u32 v20, v24, v25
    v_cmp_eq_u32 vcc, -1, v20
    s_cbranch_vccnz L_pr_180
    buffer_load_dwordx4 v[12:15], v11, s[40:43], s58 offen offset:0 sc1
    buffer_load_dwordx4 v[16:19], v11, s[40:43], s58 offen offset:1024 sc1
    v_add_f32_dpp v2, v24, v24 row_ror:4 row_mask:0xf bank_mask:0xf
    v_add_f32_dpp v3, v25, v25 row_ror:4 row_mask:0xf bank_mask:0xf
    v_pk_add_f32 v[20:21], v[12:13], v[16:17]
    v_pk_add_f32 v[22:23], v[14:15], v[18:19]
    v_add_f32_dpp v2, v2, v2 row_ror:2 row_mask:0xf bank_mask:0xf
    v_add_f32_dpp v3, v3, v3 row_ror:2 row_mask:0xf bank_mask:0xf
    v_permlane32_swap_b32 v20, v22
    v_permlane32_swap_b32 v21, v23
    v_add_f32_dpp v2, v2, v2 row_ror:1 row_mask:0xf bank_mask:0xf
    v_add_f32_dpp v3, v3, v3 row_ror:1 row_mask:0xf bank_mask:0xf
    v_pk_add_f32 v[20:21], v[20:21], v[22:23]
    v_mul_f32 v2, v2, v60
    v_fma_f32 v3, v3, v60, v61
    v_permlane16_swap_b32 v20, v21
    v_fma_f32 v3, -v2, v2, v3
    v_add_f32 v20, v20, v21
    v_max_f32 v3, v3, v61
    v_mul_f32 v26, v28, v2
    v_rsq_f32 v3, v3
    v_cmp_u_f32 vcc, v20, v20
    v_sub_f32 v20, v20, v26
    s_cbranch_vccnz L_hr_183
L_hk_184:
    v_fma_f32 v20, v20, v3, v4
    v_mul_f32 v21, v20, v20
    v_mul_f32 v22, v20, v9
    v_mul_f32 v23, v20, v10
    v_fma_f32 v21, v21, v22, v23
    v_exp_f32 v21, v21
    s_nop 0
    v_add_f32 v21, 1.0, v21
    v_rcp_f32 v21, v21
    s_nop 0
    v_mul_f32 v20, v20, v21
    s_nop 1
    v_mov_b32_dpp v21, v20 row_shl:1 row_mask:0xf bank_mask:0xf bound_ctrl:0
    v_cvt_pk_bf16_f32 v28, v20, v21
    s_nop 1
    v_mov_b32_dpp v29, v28 row_shl:4 row_mask:0xf bank_mask:0xf bound_ctrl:0
    v_mov_b32_dpp v30, v28 row_shl:8 row_mask:0xf bank_mask:0xf bound_ctrl:0
    v_mov_b32_dpp v31, v28 row_shl:12 row_mask:0xf bank_mask:0xf bound_ctrl:0
    s_nop 1
    v_smfmac_f32_16x16x64_bf16 v[52:55], v[28:31], v[36:43], v1
    v_smfmac_f32_16x16x64_bf16 v[56:59], v[28:31], v[44:51], v1
    s_cmp_eq_u32 s30, 4
    s_nop 5
    v_add_f32 v22, v52, v54
    v_add_f32 v23, v56, v58
    ds_write_b64 v32, v[22:23]
    s_cbranch_scc0 L_skip_186
L_xw_187:
    ds_read2_b32 v[20:21], v33 offset0:0 offset1:32
    ds_read_b32 v22, v33 offset:256
    s_sub_u32 s56, s56, 1
    s_cbranch_scc1 L_done
    s_waitcnt lgkmcnt(0)
    v_max3_u32 v23, v20, v21, v22
    v_add_f32 v20, v20, v21
    v_cmp_eq_u32 vcc, -1, v23
    v_add_f32 v20, v20, v22
    s_cbranch_vccnz L_xw_187
    buffer_store_dword v20, v34, s[40:43], s60 offen sc1
    s_waitcnt vmcnt(1)
    s_branch L_pe_188
L_skip_186:
    s_waitcnt vmcnt(0)
L_pe_188:
L_skip_178:
    s_branch L_p1
.p2align 5
L_typeB_0:
    s_cmp_eq_u32 s53, 3
    s_cbranch_scc0 L_typeC_189
    s_cmp_eq_u32 s30, 7
    s_cbranch_scc1 L_w7_200
    s_cmp_lt_u32 s30, 6
    s_cbranch_scc0 L_skip_202
    s_lshr_b32 s57, s30, 1
    s_mul_i32 s57, s57, 128
    s_and_b32 s58, s30, 1
    s_lshl_b32 s58, s58, 6
    s_add_u32 s57, s57, s58
    v_lshrrev_b32 v18, 5, v0
    v_lshlrev_b32 v18, 13, v18
    v_bfe_u32 v60, v0, 3, 1
    v_lshl_add_u32 v18, v60, 12, v18
    v_bfe_u32 v60, v0, 4, 1
    v_lshl_add_u32 v18, v60, 11, v18
    v_bfe_u32 v60, v0, 2, 1
L_pad5:
    s_cbranch_execz L_pad9
    v_mul_u32_u24 v60, 384, v60
    v_add_u32 v18, v60, v18
    v_and_b32 v60, 3, v0
    v_lshl_add_u32 v18, v60, 3, v18
    v_add_u32 v18, s57, v18
    v_add_u32 v18, 30720, v18
    v_bfe_u32 v19, v0, 3, 1
    v_lshlrev_b32 v19, 12, v19
    v_bfe_u32 v60, v0, 4, 1
    v_lshl_add_u32 v19, v60, 11, v19
    v_bfe_u32 v60, v0, 2, 1
    v_mul_u32_u24 v60, 384, v60
    v_add_u32 v19, v60, v19
    v_and_b32 v60, 3, v0
    v_lshl_add_u32 v19, v60, 3, v19
    v_lshrrev_b32 v60, 5, v0
    v_lshl_add_u32 v19, v60, 5, v19
    v_add_u32 v19, s57, v19
    v_add_u32 v19, 63488, v19
    ds_read_b64_tr_b16 v[28:29], v18 offset:0
    ds_read_b64_tr_b16 v[30:31], v18 offset:1024
    ds_read_b64_tr_b16 v[32:33], v18 offset:16384
    ds_read_b64_tr_b16 v[34:35], v18 offset:17408
    ds_read_b64_tr_b16 v[36:37], v18 offset:32
    ds_read_b64_tr_b16 v[38:39], v18 offset:1056
    ds_read_b64_tr_b16 v[40:41], v18 offset:16416
    ds_read_b64_tr_b16 v[42:43], v18 offset:17440
    ds_read_b64_tr_b16 v[24:25], v19 offset:0
    ds_read_b64_tr_b16 v[26:27], v19 offset:1024
    v_lshrrev_b32 v49, 4, v0
    v_lshlrev_b32 v49, 5, v49
    v_bfe_u32 v60, v0, 1, 1
    v_lshl_add_u32 v49, v60, 4, v49
    v_bfe_u32 v60, v0, 3, 1
    v_mul_u32_u24 v60, 192, v60
    v_add_u32 v49, v60, v49
    v_add_u32 v49, 156736, v49
    v_bfe_u32 v50, v0, 1, 1
    v_lshlrev_b32 v50, 4, v50
    v_bfe_u32 v60, v0, 3, 1
    v_mul_u32_u24 v60, 192, v60
    v_add_u32 v50, v60, v50
    v_add_u32 v50, 156864, v50
    v_mov_b32 v60, 156896
    v_and_b32 v51, 5, v0
    v_cmp_eq_u32 vcc, 0, v51
    s_nop 1
    v_cndmask_b32 v9, v60, v49, vcc
    v_cmp_eq_u32 vcc, 4, v51
    s_nop 1
    v_cndmask_b32 v10, v60, v49, vcc
    v_lshrrev_b32 v49, 2, v0
    v_and_b32 v49, 12, v49
    v_cmp_eq_u32 vcc, v49, v51
    s_nop 1
    v_cndmask_b32 v48, v60, v50, vcc
    v_mov_b64 v[44:45], 0
    v_mov_b64 v[46:47], 0
    s_lshr_b32 s57, s30, 1
    s_lshl_b32 s57, s57, 11
    s_lshl_b32 s58, s58, 1
    s_add_u32 s57, s57, s58
    s_lshl_b32 s58, s54, 8
    s_add_u32 s57, s57, s58
    v_and_b32 v11, 31, v0
    v_lshlrev_b32 v11, 2, v11
    v_lshrrev_b32 v60, 5, v0
    v_lshl_add_u32 v11, v60, 30, v11
    v_add_u32 v11, s57, v11
    v_xor_b32 v49, 0x40000000, v11
    s_add_u32 s59, s62, 13312
    s_add_u32 s60, s62, 25856
    ds_read_b128 v[12:15], v9
    ds_read_b128 v[16:19], v10
    ds_read_b128 v[20:23], v48
    s_waitcnt lgkmcnt(2)
    v_smfmac_f32_16x16x64_bf16 v[44:47], v[12:15], v[28:35], v1
    s_waitcnt lgkmcnt(1)
    v_smfmac_f32_16x16x64_bf16 v[44:47], v[16:19], v[36:43], v1
    s_waitcnt lgkmcnt(0)
    v_smfmac_f32_16x16x64_bf16 v[44:47], v[20:23], v[24:31], v1
    s_add_u32 s60, s62, 19456
    s_cmp_eq_u32 s55, 0
    s_nop 5
    v_add_f32 v12, v44, v46
    s_cbranch_scc1 L_gs_203
L_pad6:
    s_cbranch_execz L_pad10
    buffer_store_dword v12, v49, s[40:43], s60 offen
L_gb_204:
    v_mov_b64 v[44:45], 0
    v_mov_b64 v[46:47], 0
L_skip_202:
    s_cmp_lt_u32 s30, 6
    s_barrier
    s_cbranch_scc0 L_se_201
    ds_read_b128 v[12:15], v9
    ds_read_b128 v[16:19], v10
    ds_read_b128 v[20:23], v48
    s_waitcnt lgkmcnt(2)
    v_smfmac_f32_16x16x64_bf16 v[44:47], v[12:15], v[28:35], v1
    s_waitcnt lgkmcnt(1)
    v_smfmac_f32_16x16x64_bf16 v[44:47], v[16:19], v[36:43], v1
    s_waitcnt lgkmcnt(0)
    v_smfmac_f32_16x16x64_bf16 v[44:47], v[20:23], v[24:31], v1
    s_cmp_eq_u32 s55, 0
    s_nop 6
    v_add_f32 v12, v44, v46
    s_cbranch_scc1 L_gs_205
    buffer_store_dword v12, v11, s[40:43], s59 offen
L_gb_206:
.p2align 5
L_se_201:
L_p1:
    s_lshl_b32 s57, s30, 7
    s_add_u32 s57, s57, 154624
    v_lshrrev_b32 v58, 4, v0
    v_lshlrev_b32 v58, 5, v58
    v_bfe_u32 v60, v0, 1, 1
    v_lshl_add_u32 v58, v60, 4, v58
    v_bfe_u32 v60, v0, 2, 2
    v_lshl_add_u32 v58, v60, 2, v58
    v_and_b32 v60, 1, v0
    v_lshl_add_u32 v58, v60, 1, v58
    v_add_u32 v58, s57, v58
    v_lshrrev_b32 v61, 4, v0
    v_lshlrev_b32 v61, 5, v61
    v_bfe_u32 v60, v0, 1, 1
    v_lshl_add_u32 v61, v60, 4, v61
    v_add_u32 v61, s57, v61
    v_bfe_u32 v62, v0, 2, 2
    v_lshlrev_b32 v62, 1, v62
    v_and_b32 v60, 1, v0
    v_lshl_add_u32 v62, v60, 0, v62
    v_mov_b32 v60, 156896
    v_cmp_eq_u32 vcc, 0, v62
    s_nop 1
    v_cndmask_b32 v52, v60, v61, vcc
    v_cmp_eq_u32 vcc, 1, v62
    s_nop 1
    v_cndmask_b32 v53, v60, v61, vcc
    v_cmp_eq_u32 vcc, 2, v62
    s_nop 1
    v_cndmask_b32 v54, v60, v61, vcc
    v_cmp_eq_u32 vcc, 3, v62
    s_nop 1
    v_cndmask_b32 v55, v60, v61, vcc
    v_cmp_eq_u32 vcc, 4, v62
    s_nop 1
    v_cndmask_b32 v56, v60, v61, vcc
    v_cmp_eq_u32 vcc, 5, v62
    s_nop 1
    v_cndmask_b32 v57, v60, v61, vcc
    s_lshl_b32 s58, s30, 2
    s_add_u32 s58, s58, 155712
    v_mov_b32 v60, s58
    v_lshlrev_b32 v59, 2, v0
    v_add_u32 v59, 154112, v59
    v_cmp_eq_u32 vcc, 63, v0
    s_nop 1
    v_cndmask_b32 v59, v59, v60, vcc
    v_and_b32 v62, 7, v0
    v_lshlrev_b32 v62, 2, v62
    v_add_u32 v62, 155712, v62
    s_lshl_b32 s57, s30, 10
    v_lshlrev_b32 v63, 4, v0
    v_add_u32 v63, s57, v63
    v_add_u32 v63, 92160, v63
    s_sub_u32 s57, s30, 1
    s_lshl_b32 s58, s57, 11
    v_lshlrev_b32 v7, 4, v0
    v_add_u32 v7, s58, v7
    s_lshl_b32 s58, s57, 7
    v_bfe_u32 v8, v0, 2, 2
    v_lshlrev_b32 v8, 5, v8
    v_lshrrev_b32 v60, 5, v0
    v_lshl_add_u32 v8, v60, 4, v8
    v_and_b32 v60, 3, v0
    v_lshl_add_u32 v8, v60, 2, v8
    v_bfe_u32 v60, v0, 4, 1
    v_lshl_add_u32 v8, v60, 1, v8
    v_add_u32 v8, s58, v8
    v_add_u32 v8, 124928, v8
    s_cmp_eq_u32 s30, 7
    s_cbranch_scc1 L_w7_214
    s_cmp_lt_u32 s30, 6
    s_cbranch_scc0 L_skip_216
    s_lshr_b32 s57, s30, 1
    s_mul_i32 s57, s57, 1024
L_pad7:
    s_cbranch_execz L_pad11
    s_and_b32 s58, s30, 1
    s_lshl_b32 s58, s58, 6
    s_add_u32 s57, s57, s58
    v_lshrrev_b32 v18, 5, v0
    v_mul_u32_u24 v18, 6144, v18
    v_bfe_u32 v60, v0, 3, 1
    v_mul_u32_u24 v60, 3072, v60
    v_add_u32 v18, v60, v18
    v_bfe_u32 v60, v0, 4, 1
    v_lshl_add_u32 v18, v60, 9, v18
    v_bfe_u32 v60, v0, 2, 1
    v_lshl_add_u32 v18, v60, 7, v18
    v_and_b32 v60, 3, v0
    v_lshl_add_u32 v18, v60, 3, v18
    v_add_u32 v18, s57, v18
    v_bfe_u32 v19, v0, 3, 1
    v_mul_u32_u24 v19, 3072, v19
    v_bfe_u32 v60, v0, 4, 1
    v_lshl_add_u32 v19, v60, 9, v19
    v_bfe_u32 v60, v0, 2, 1
    v_lshl_add_u32 v19, v60, 7, v19
    v_and_b32 v60, 3, v0
    v_lshl_add_u32 v19, v60, 3, v19
    v_lshrrev_b32 v60, 5, v0
    v_lshl_add_u32 v19, v60, 5, v19
    v_add_u32 v19, s57, v19
    v_add_u32 v19, 24576, v19
    ds_read_b64_tr_b16 v[28:29], v18 offset:0
    ds_read_b64_tr_b16 v[30:31], v18 offset:256
    ds_read_b64_tr_b16 v[32:33], v18 offset:12288
    ds_read_b64_tr_b16 v[34:35], v18 offset:12544
    ds_read_b64_tr_b16 v[36:37], v18 offset:32
    ds_read_b64_tr_b16 v[38:39], v18 offset:288
    ds_read_b64_tr_b16 v[40:41], v18 offset:12320
    ds_read_b64_tr_b16 v[42:43], v18 offset:12576
    ds_read_b64_tr_b16 v[24:25], v19 offset:0
    ds_read_b64_tr_b16 v[26:27], v19 offset:256
    v_lshrrev_b32 v49, 4, v0
    v_lshlrev_b32 v49, 5, v49
    v_bfe_u32 v60, v0, 1, 1
    v_lshl_add_u32 v49, v60, 4, v49
    v_bfe_u32 v60, v0, 3, 1
    v_mul_u32_u24 v60, 192, v60
    v_add_u32 v49, v60, v49
    v_add_u32 v49, 156736, v49
    v_bfe_u32 v50, v0, 1, 1
    v_lshlrev_b32 v50, 4, v50
    v_bfe_u32 v60, v0, 3, 1
    v_mul_u32_u24 v60, 192, v60
    v_add_u32 v50, v60, v50
    v_add_u32 v50, 156864, v50
    v_mov_b32 v60, 156896
    v_and_b32 v51, 5, v0
    v_cmp_eq_u32 vcc, 0, v51
    s_nop 1
    v_cndmask_b32 v9, v60, v49, vcc
    v_cmp_eq_u32 vcc, 4, v51
    s_nop 1
    v_cndmask_b32 v10, v60, v49, vcc
    v_lshrrev_b32 v49, 2, v0
    v_and_b32 v49, 12, v49
    v_cmp_eq_u32 vcc, v49, v51
    s_nop 1
    v_cndmask_b32 v48, v60, v50, vcc
    v_mov_b64 v[44:45], 0
    v_mov_b64 v[46:47], 0
    s_lshr_b32 s57, s30, 1
    s_lshl_b32 s57, s57, 11
    s_lshl_b32 s58, s58, 1
    s_add_u32 s57, s57, s58
    s_lshl_b32 s58, s54, 8
    s_add_u32 s57, s57, s58
    v_and_b32 v11, 31, v0
    v_lshlrev_b32 v11, 2, v11
    v_lshrrev_b32 v60, 5, v0
    v_lshl_add_u32 v11, v60, 30, v11
    v_add_u32 v11, s57, v11
    s_mul_i32 s59, s53, 6144
    s_add_u32 s59, s59, s62
    s_add_u32 s59, s59, 46080
    s_lshl_b32 s60, s53, 6
    s_add_u32 s60, s60, s62
    s_add_u32 s60, s60, 25600
L_skip_216:
    s_cmp_lt_u32 s30, 6
    s_barrier
L_pad8:
    s_cbranch_execz L_pad12
    s_cbranch_scc0 L_se_215
    ds_read_b128 v[12:15], v9
    ds_read_b128 v[16:19], v10
    ds_read_b128 v[20:23], v48
    s_waitcnt lgkmcnt(2)
    v_smfmac_f32_16x16x64_bf16 v[44:47], v[12:15], v[28:35], v1
    s_waitcnt lgkmcnt(1)
    v_smfmac_f32_16x16x64_bf16 v[44:47], v[16:19], v[36:43], v1
    s_waitcnt lgkmcnt(0)
    v_smfmac_f32_16x16x64_bf16 v[44:47], v[20:23], v[24:31], v1
    s_cmp_eq_u32 s55, 0
    s_nop 6
    v_add_f32 v12, v44, v46
    s_cbranch_scc1 L_gs_217
    buffer_store_dword v12, v11, s[40:43], s59 offen
L_gb_218:
.p2align 5
L_se_215:
    s_sub_u32 s57, s30, 1
    s_cmp_lt_u32 s57, 3
    s_cbranch_scc0 L_qo_232
    v_and_b32 v9, 7, v0
    v_lshlrev_b32 v9, 3, v9
    buffer_load_dwordx2 v[10:11], v9, s[40:43], s60 offen sc1
    buffer_load_dwordx4 v[40:43], v7, s[40:43], s59 offen offset:0 sc1
    buffer_load_dwordx4 v[44:47], v7, s[40:43], s59 offen offset:1024 sc1
    v_mov_b64 v[24:25], 0
    v_mov_b64 v[26:27], 0
    v_mov_b64 v[28:29], 0
    v_mov_b64 v[30:31], 0
    v_mov_b64 v[32:33], 0
    v_mov_b64 v[34:35], 0
    v_mov_b64 v[36:37], 0
    v_mov_b64 v[38:39], 0
    v_lshrrev_b32 v5, 4, v0
    v_lshlrev_b32 v5, 5, v5
    v_bfe_u32 v60, v0, 1, 1
    v_lshl_add_u32 v5, v60, 4, v5
    v_add_u32 v5, 124928, v5
    v_mov_b32 v60, 0x3c75e03e
    v_mov_b32 v61, 0x3a71d1e6
    v_mov_b32 v51, 0x3e13985d
    s_branch L_pw_234
.p2align 5
L_pr_235:
    buffer_load_dwordx2 v[10:11], v9, s[40:43], s60 offen sc1
    buffer_load_dwordx4 v[40:43], v7, s[40:43], s59 offen offset:0 sc1
    buffer_load_dwordx4 v[44:47], v7, s[40:43], s59 offen offset:1024 sc1
    s_sub_u32 s56, s56, 1
    s_cbranch_scc1 L_done
L_pw_234:
    s_waitcnt vmcnt(0)
    v_max_u32 v20, v10, v11
    v_cmp_eq_u32 vcc, -1, v20
    s_cbranch_vccnz L_pr_235
    buffer_load_dwordx4 v[40:43], v7, s[40:43], s59 offen offset:0 sc1
    buffer_load_dwordx4 v[44:47], v7, s[40:43], s59 offen offset:1024 sc1
    v_add_f32_dpp v48, v10, v10 row_ror:4 row_mask:0xf bank_mask:0xf
    v_add_f32_dpp v49, v11, v11 row_ror:4 row_mask:0xf bank_mask:0xf
    v_pk_add_f32 v[20:21], v[40:41], v[44:45]
    v_pk_add_f32 v[22:23], v[42:43], v[46:47]
    v_add_f32_dpp v48, v48, v48 row_ror:2 row_mask:0xf bank_mask:0xf
    v_add_f32_dpp v49, v49, v49 row_ror:2 row_mask:0xf bank_mask:0xf
    v_permlane32_swap_b32 v20, v22
    v_permlane32_swap_b32 v21, v23
    v_add_f32_dpp v48, v48, v48 row_ror:1 row_mask:0xf bank_mask:0xf
    v_add_f32_dpp v49, v49, v49 row_ror:1 row_mask:0xf bank_mask:0xf
    v_pk_add_f32 v[20:21], v[20:21], v[22:23]
    v_mul_f32 v48, v48, v60
    v_fma_f32 v49, v49, v51, v61
    v_permlane16_swap_b32 v20, v21
    v_fma_f32 v49, -v48, v48, v49
    v_add_f32 v20, v20, v21
    v_max_f32 v49, v49, v61
    v_mul_f32 v50, v6, v48
    v_rsq_f32 v49, v49
    v_cmp_u_f32 vcc, v20, v20
    v_sub_f32 v20, v20, v50
    s_cbranch_vccnz L_hr_236
L_hk_237:
    v_mul_f32 v20, v20, v49
    v_cvt_pk_bf16_f32 v20, v20, v20
    ds_write_b16 v8, v20
L_qb_233:
    s_waitcnt lgkmcnt(0)
    s_barrier
    ds_read_b128 v[12:15], v5 offset:0
    ds_read_b128 v[16:19], v5 offset:128
    ds_read_b128 v[20:23], v5 offset:256
    s_cmp_lt_u32 s30, 4
    s_waitcnt lgkmcnt(0)
L_pad9:
    s_cbranch_execz L_pad13
    v_smfmac_f32_16x16x64_bf16 v[24:27], v[12:15], v[64:71], v1
    v_smfmac_f32_16x16x64_bf16 v[24:27], v[16:19], v[72:79], v1
    v_smfmac_f32_16x16x64_bf16 v[24:27], v[20:23], v[80:87], v1
    v_smfmac_f32_16x16x64_bf16 v[28:31], v[12:15], v[88:95], v1
    v_smfmac_f32_16x16x64_bf16 v[28:31], v[16:19], v[96:103], v1
    v_smfmac_f32_16x16x64_bf16 v[28:31], v[20:23], v[104:111], v1
    v_smfmac_f32_16x16x64_bf16 v[32:35], v[12:15], v[112:119], v1
    v_smfmac_f32_16x16x64_bf16 v[32:35], v[16:19], v[120:127], v1
    v_smfmac_f32_16x16x64_bf16 v[32:35], v[20:23], v[128:135], v1
    v_smfmac_f32_16x16x64_bf16 v[36:39], v[12:15], v[136:143], v1
    v_smfmac_f32_16x16x64_bf16 v[36:39], v[16:19], v[144:151], v1
    v_smfmac_f32_16x16x64_bf16 v[36:39], v[20:23], v[152:159], v1
    v_add_f32 v24, v24, v26
    s_waitcnt vmcnt(0)
    v_add_f32 v28, v28, v30
    s_nop 1
    v_add_f32 v32, v32, v34
    v_max3_f32 v61, v24, v28, v32
    v_mov_b32_dpp v24, v28 quad_perm:[0,1,2,3] row_mask:0x2 bank_mask:0xf
    v_add_f32 v36, v36, v38
    v_max_f32 v61, v61, v36
    v_mov_b32_dpp v24, v32 quad_perm:[0,1,2,3] row_mask:0x4 bank_mask:0xf
    s_nop 0
    v_max_f32_dpp v61, v61, v61 row_ror:8 row_mask:0xf bank_mask:0xf
    s_nop 0
    v_mov_b32_dpp v24, v36 quad_perm:[0,1,2,3] row_mask:0x8 bank_mask:0xf
    v_max_f32_dpp v61, v61, v61 row_ror:4 row_mask:0xf bank_mask:0xf
    s_nop 1
    v_max_f32_dpp v61, v61, v61 row_ror:2 row_mask:0xf bank_mask:0xf
    s_nop 1
    v_max_f32_dpp v61, v61, v61 row_ror:1 row_mask:0xf bank_mask:0xf
    v_sub_f32 v36, v24, v61
    ds_write_b32 v59, v61
    v_exp_f32 v36, v36
    s_nop 0
    v_cvt_pk_bf16_f32 v39, v36, v36
    ds_write_b16 v58, v39
    ds_read_b128 v[12:15], v52
    ds_read_b128 v[16:19], v53
    ds_read_b128 v[20:23], v54
    ds_read_b128 v[24:27], v55
    ds_read_b128 v[28:31], v56
    ds_read_b128 v[32:35], v57
    v_add_f32_dpp v38, v36, v36 row_ror:8 row_mask:0xf bank_mask:0xf
    v_mov_b64 v[40:41], 0
    v_mov_b64 v[42:43], 0
    v_add_f32_dpp v38, v38, v38 row_ror:4 row_mask:0xf bank_mask:0xf
    v_mov_b64 v[44:45], 0
    v_mov_b64 v[46:47], 0
    s_waitcnt lgkmcnt(5)
    v_smfmac_f32_16x16x64_bf16 v[40:43], v[12:15], v[160:167], v1
    v_add_f32_dpp v38, v38, v38 row_ror:2 row_mask:0xf bank_mask:0xf
    v_smfmac_f32_16x16x64_bf16 v[44:47], v[12:15], v[208:215], v1
    ds_read_b32 v36, v62
    s_waitcnt lgkmcnt(5)
    v_smfmac_f32_16x16x64_bf16 v[40:43], v[16:19], v[168:175], v1
    v_add_f32_dpp v38, v38, v38 row_ror:1 row_mask:0xf bank_mask:0xf
    v_smfmac_f32_16x16x64_bf16 v[44:47], v[16:19], v[216:223], v1
    s_waitcnt lgkmcnt(4)
    v_smfmac_f32_16x16x64_bf16 v[40:43], v[20:23], v[176:183], v1
    v_add_f32_dpp v38, v38, v38 row_bcast:15 row_mask:0xa bank_mask:0xf
    v_smfmac_f32_16x16x64_bf16 v[44:47], v[20:23], v[224:231], v1
    s_waitcnt lgkmcnt(0)
    v_max_f32_dpp v37, v36, v36 row_ror:4 row_mask:0xf bank_mask:0xf
    v_smfmac_f32_16x16x64_bf16 v[40:43], v[24:27], v[184:191], v1
    v_add_f32_dpp v48, v38, v38 row_bcast:31 row_mask:0x8 bank_mask:0xf
    v_smfmac_f32_16x16x64_bf16 v[44:47], v[24:27], v[232:239], v1
    v_max_f32_dpp v37, v37, v37 row_ror:2 row_mask:0xf bank_mask:0xf
    v_smfmac_f32_16x16x64_bf16 v[40:43], v[28:31], v[192:199], v1
    v_cmp_eq_u32 vcc, -1, v36
    v_smfmac_f32_16x16x64_bf16 v[44:47], v[28:31], v[240:247], v1
    v_max_f32_dpp v37, v37, v37 row_ror:1 row_mask:0xf bank_mask:0xf
    v_smfmac_f32_16x16x64_bf16 v[40:43], v[32:35], v[200:207], v1
    v_sub_f32 v39, v61, v37
    v_smfmac_f32_16x16x64_bf16 v[44:47], v[32:35], v[248:255], v1
    v_exp_f32 v39, v39
L_pad10:
    s_cbranch_execz L_pad14
    s_cbranch_vccnz L_mr_239
L_mk_240:
    s_cmp_lt_u32 s30, 2
    s_nop 2
    v_add_f32_dpp v48, v40, v42 quad_perm:[0,1,2,3] row_mask:0x7 bank_mask:0xf
    v_add_f32 v49, v41, v43
    v_pk_add_f32 v[50:51], v[44:45], v[46:47]
    v_pk_mul_f32 v[48:49], v[48:49], v[38:39] op_sel:[0,1] op_sel_hi:[1,1]
    v_pk_mul_f32 v[50:51], v[50:51], v[38:39] op_sel:[0,1] op_sel_hi:[1,1]
    ds_write_b128 v63, v[48:51]
    s_cbranch_scc1 L_comb_1
    s_waitcnt lgkmcnt(0)
    s_barrier
.p2align 5
L_comb_1b:
    s_cmp_lt_u32 s3, 20
    s_cbranch_scc0 L_typeB_1
    s_mul_i32 s74, s30, 1664
    s_add_u32 s74, s74, s62
    s_add_u32 s74, s74, 26624
    v_and_b32 v56, 7, v0
    v_lshlrev_b32 v56, 2, v56
    v_lshrrev_b32 v62, 4, v0
    v_lshlrev_b32 v62, 3, v62
    buffer_load_dword v52, v56, s[40:43], s74 offen offset:1536 sc1
    buffer_load_dwordx2 v[54:55], v62, s[40:43], s74 offen offset:1536 sc1
    v_lshlrev_b32 v57, 4, v0
    v_lshlrev_b32 v58, 3, v0
    s_mul_i32 s57, s30, 6144
    s_add_u32 s57, s57, 30720
    v_lshrrev_b32 v59, 2, v0
    v_lshlrev_b32 v59, 6, v59
    v_bfe_u32 v53, v0, 4, 1
    v_lshl_add_u32 v59, v53, 5, v59
    v_and_b32 v53, 3, v0
    v_lshl_add_u32 v59, v53, 3, v59
    v_add_u32 v59, s57, v59
    v_xor_b32 v60, 32, v59
    s_lshl_b32 s57, s30, 8
    s_add_u32 s57, s57, 153600
    v_lshl_add_u32 v61, v0, 2, s57
    ds_read_b64_tr_b16 v[28:29], v59 offset:0
    ds_read_b64_tr_b16 v[30:31], v59 offset:1024
    ds_read_b64_tr_b16 v[32:33], v59 offset:2048
    ds_read_b64_tr_b16 v[34:35], v59 offset:3072
    ds_read_b64_tr_b16 v[36:37], v59 offset:4096
    ds_read_b64_tr_b16 v[38:39], v59 offset:5120
    ds_read_b64_tr_b16 v[40:41], v60 offset:0
    ds_read_b64_tr_b16 v[42:43], v60 offset:1024
    ds_read_b64_tr_b16 v[44:45], v60 offset:2048
    ds_read_b64_tr_b16 v[46:47], v60 offset:3072
    ds_read_b64_tr_b16 v[48:49], v60 offset:4096
    ds_read_b64_tr_b16 v[50:51], v60 offset:5120
    v_mov_b64 v[20:21], 0
    v_mov_b64 v[22:23], 0
    v_mov_b64 v[24:25], 0
    v_mov_b64 v[26:27], 0
    s_add_u32 s58, s6, 132096
    s_branch L_pw_247
.p2align 5
L_pr_248:
    buffer_load_dword v52, v56, s[40:43], s74 offen offset:1536 sc1
    buffer_load_dwordx2 v[54:55], v62, s[40:43], s74 offen offset:1536 sc1
    s_sub_u32 s56, s56, 1
    s_cbranch_scc1 L_done
L_pw_247:
    s_waitcnt vmcnt(0)
    v_max3_u32 v53, v52, v54, v55
    v_cmp_eq_u32 vcc, -1, v53
    s_cbranch_vccnz L_pr_248
    buffer_load_dwordx4 v[12:15], v57, s[40:43], s74 offen sc1
    buffer_load_dwordx2 v[16:17], v58, s[40:43], s74 offen offset:1024 sc1
    buffer_load_dword v18, v56, s[40:43], s74 offen offset:1568 sc1
    v_max_f32_dpp v53, v52, v52 row_ror:4 row_mask:0xf bank_mask:0xf
    s_nop 1
    v_max_f32_dpp v53, v53, v53 row_ror:2 row_mask:0xf bank_mask:0xf
    s_nop 1
    v_max_f32_dpp v53, v53, v53 row_ror:1 row_mask:0xf bank_mask:0xf
    v_sub_f32 v52, v52, v53
    v_sub_f32 v54, v54, v53
    v_sub_f32 v55, v55, v53
    v_exp_f32 v52, v52
    v_exp_f32 v54, v54
    v_exp_f32 v55, v55
    s_waitcnt lgkmcnt(0)
L_pad11:
    s_cbranch_execz L_pad15
    s_branch L_ow_249
.p2align 5
L_or_250:
    buffer_load_dwordx4 v[12:15], v57, s[40:43], s74 offen sc1
    buffer_load_dwordx2 v[16:17], v58, s[40:43], s74 offen offset:1024 sc1
    buffer_load_dword v18, v56, s[40:43], s74 offen offset:1568 sc1
    s_sub_u32 s56, s56, 1
    s_cbranch_scc1 L_done
    v_mov_b64 v[20:21], 0
    v_mov_b64 v[22:23], 0
    v_mov_b64 v[24:25], 0
    v_mov_b64 v[26:27], 0
L_ow_249:
    s_waitcnt vmcnt(2)
    v_smfmac_f32_16x16x64_bf16 v[20:23], v[12:15], v[28:35], v1
    s_nop 2
    v_smfmac_f32_16x16x64_bf16 v[24:27], v[12:15], v[40:47], v1
    s_waitcnt vmcnt(0)
    v_mul_f32 v53, v52, v18
    v_smfmac_f32_16x16x32_bf16 v[20:23], v[16:17], v[36:39], v1
    s_nop 2
    v_smfmac_f32_16x16x32_bf16 v[24:27], v[16:17], v[48:51], v1
    v_add_f32_dpp v53, v53, v53 row_ror:4 row_mask:0xf bank_mask:0xf
    v_max3_u32 v19, v12, v13, v14
    v_max3_u32 v62, v15, v16, v17
    v_add_f32_dpp v53, v53, v53 row_ror:2 row_mask:0xf bank_mask:0xf
    v_max3_u32 v19, v19, v62, v18
    s_cmp_eq_u32 s30, 2
    v_add_f32_dpp v53, v53, v53 row_ror:1 row_mask:0xf bank_mask:0xf
    v_cmp_eq_u32 vcc, -1, v19
    v_rcp_f32 v53, v53
    s_cbranch_vccnz L_or_250
    v_pk_add_f32 v[20:21], v[20:21], v[22:23]
    v_pk_add_f32 v[24:25], v[24:25], v[26:27]
    v_pk_mul_f32 v[54:55], v[54:55], v[52:53] op_sel:[0,1] op_sel_hi:[1,1]
    v_mul_f32 v20, v20, v54
    v_mul_f32 v24, v24, v54
    v_fmac_f32 v20, v21, v55
    v_fmac_f32 v24, v25, v55
    s_nop 1
    v_permlane32_swap_b32 v20, v24
    v_add_f32 v20, v20, v24
    ds_write_b32 v61, v20
    s_waitcnt lgkmcnt(0)
    s_barrier
    s_cbranch_scc0 L_finb_251
    ds_read2st64_b32 v[12:13], v2 offset0:0 offset1:1
    ds_read2st64_b32 v[14:15], v2 offset0:2 offset1:3
    ds_read2st64_b32 v[16:17], v2 offset0:4 offset1:5
    ds_read2st64_b32 v[18:19], v2 offset0:6 offset1:7
    s_waitcnt lgkmcnt(2)
    v_pk_add_f32 v[12:13], v[12:13], v[14:15]
    s_waitcnt lgkmcnt(0)
    v_pk_add_f32 v[16:17], v[16:17], v[18:19]
    v_pk_add_f32 v[12:13], v[12:13], v[16:17]
    v_add_f32 v14, v12, v13
    v_add_f32 v15, v12, v13
    s_nop 1
    v_permlane16_swap_b32 v14, v15
    v_add_f32 v12, v14, v15
    buffer_store_dword v12, v3, s[40:43], s58 offen sc1
.p2align 5
L_finb_251:
    s_sub_u32 s57, s30, 4
    s_cmp_lt_u32 s57, 3
    s_cbranch_scc0 L_skip_252
    s_sub_u32 s60, s30, 4
    s_lshl_b32 s57, s60, 11
    v_lshlrev_b32 v11, 4, v0
    v_add_u32 v11, s57, v11
    s_add_u32 s65, s62, 19456
    buffer_load_dwordx4 v[52:55], v11, s[40:43], s65 offen offset:0 sc1
    buffer_load_dwordx4 v[56:59], v11, s[40:43], s65 offen offset:1024 sc1
    s_lshl_b32 s59, s60, 12
    s_add_u32 s59, s59, 79872
    v_bfe_u32 v35, v0, 4, 1
    v_lshlrev_b32 v35, 11, v35
    v_bfe_u32 v60, v0, 2, 2
    v_lshl_add_u32 v35, v60, 8, v35
    v_lshrrev_b32 v60, 5, v0
    v_lshl_add_u32 v35, v60, 6, v35
    v_and_b32 v60, 3, v0
    v_lshl_add_u32 v35, v60, 3, v35
    v_add_u32 v35, s59, v35
    v_mov_b32 v9, 0xbdd2d3e8
L_pad12:
    s_cbranch_execz L_pad16
    v_mov_b32 v10, 0xc0135761
    s_lshl_b32 s57, s60, 7
    s_add_u32 s57, s57, 156160
    v_lshlrev_b32 v32, 3, v0
    v_add_u32 v32, s57, v32
    v_lshlrev_b32 v33, 3, v0
    v_add_u32 v33, 129024, v33
    v_cmp_gt_u32 vcc, 16, v0
    s_nop 1
    v_cndmask_b32 v32, v33, v32, vcc
    v_and_b32 v33, 15, v0
    v_lshlrev_b32 v33, 3, v33
    v_lshrrev_b32 v60, 5, v0
    v_lshl_add_u32 v33, v60, 2, v33
    v_add_u32 v33, 156160, v33
    v_and_b32 v34, 15, v0
    v_lshlrev_b32 v34, 2, v34
    v_lshrrev_b32 v60, 5, v0
    v_lshl_add_u32 v34, v60, 6, v34
    v_bfe_u32 v60, v0, 4, 1
    v_lshl_add_u32 v34, v60, 13, v34
    s_add_u32 s60, s6, 198144
    s_add_u32 s58, s62, 39936
    s_add_u32 s57, s62, 25984
    v_and_b32 v7, 7, v0
    v_lshlrev_b32 v7, 3, v7
    v_mov_b32 v60, 0x3acccccd
    v_mov_b32 v61, 0x3727c5ac
    s_waitcnt vmcnt(0)
    buffer_load_dwordx2 v[24:25], v7, s[40:43], s57 offen sc1
    buffer_load_dwordx4 v[12:15], v11, s[40:43], s58 offen offset:0 sc1
    buffer_load_dwordx4 v[16:19], v11, s[40:43], s58 offen offset:1024 sc1
    ds_read_b64_tr_b16 v[36:37], v35 offset:0
    ds_read_b64_tr_b16 v[38:39], v35 offset:1024
    ds_read_b64_tr_b16 v[40:41], v35 offset:128
    ds_read_b64_tr_b16 v[42:43], v35 offset:1152
    ds_read_b64_tr_b16 v[44:45], v35 offset:32
    ds_read_b64_tr_b16 v[46:47], v35 offset:1056
    ds_read_b64_tr_b16 v[48:49], v35 offset:160
    ds_read_b64_tr_b16 v[50:51], v35 offset:1184
L_sw_255:
    v_max3_u32 v20, v52, v53, v54
    v_max3_u32 v20, v20, v55, v56
    v_max3_u32 v20, v20, v57, v58
    v_max_u32 v20, v20, v59
    v_cmp_eq_u32 vcc, -1, v20
    s_cbranch_vccnz L_sr_256
    v_pk_add_f32 v[28:29], v[52:53], v[56:57]
    v_pk_add_f32 v[30:31], v[54:55], v[58:59]
    s_nop 1
    v_permlane32_swap_b32 v28, v30
    v_permlane32_swap_b32 v29, v31
    v_pk_add_f32 v[28:29], v[28:29], v[30:31]
    s_nop 1
    v_permlane16_swap_b32 v28, v29
    v_add_f32 v28, v28, v29
    v_mov_b64 v[52:53], 0
    v_mov_b64 v[54:55], 0
    v_mov_b64 v[56:57], 0
    v_mov_b64 v[58:59], 0
    s_waitcnt lgkmcnt(0)
    s_branch L_pw_253
.p2align 5
L_pr_254:
    buffer_load_dwordx2 v[24:25], v7, s[40:43], s57 offen sc1
    buffer_load_dwordx4 v[12:15], v11, s[40:43], s58 offen offset:0 sc1
    buffer_load_dwordx4 v[16:19], v11, s[40:43], s58 offen offset:1024 sc1
    s_sub_u32 s56, s56, 1
    s_cbranch_scc1 L_done
L_pw_253:
    s_waitcnt vmcnt(0)
    v_max_u32 v20, v24, v25
    v_cmp_eq_u32 vcc, -1, v20
    s_cbranch_vccnz L_pr_254
    buffer_load_dwordx4 v[12:15], v11, s[40:43], s58 offen offset:0 sc1
    buffer_load_dwordx4 v[16:19], v11, s[40:43], s58 offen offset:1024 sc1
    v_add_f32_dpp v2, v24, v24 row_ror:4 row_mask:0xf bank_mask:0xf
    v_add_f32_dpp v3, v25, v25 row_ror:4 row_mask:0xf bank_mask:0xf
    v_pk_add_f32 v[20:21], v[12:13], v[16:17]
    v_pk_add_f32 v[22:23], v[14:15], v[18:19]
    v_add_f32_dpp v2, v2, v2 row_ror:2 row_mask:0xf bank_mask:0xf
    v_add_f32_dpp v3, v3, v3 row_ror:2 row_mask:0xf bank_mask:0xf
    v_permlane32_swap_b32 v20, v22
    v_permlane32_swap_b32 v21, v23
    v_add_f32_dpp v2, v2, v2 row_ror:1 row_mask:0xf bank_mask:0xf
L_pad13:
    s_cbranch_execz L_pad17
    v_add_f32_dpp v3, v3, v3 row_ror:1 row_mask:0xf bank_mask:0xf
    v_pk_add_f32 v[20:21], v[20:21], v[22:23]
    v_mul_f32 v2, v2, v60
    v_fma_f32 v3, v3, v60, v61
    v_permlane16_swap_b32 v20, v21
    v_fma_f32 v3, -v2, v2, v3
    v_add_f32 v20, v20, v21
    v_max_f32 v3, v3, v61
    v_mul_f32 v26, v28, v2
    v_rsq_f32 v3, v3
    v_cmp_u_f32 vcc, v20, v20
    v_sub_f32 v20, v20, v26
    s_cbranch_vccnz L_hr_257
L_hk_258:
    v_fma_f32 v20, v20, v3, v4
    v_mul_f32 v21, v20, v20
    v_mul_f32 v22, v20, v9
    v_mul_f32 v23, v20, v10
    v_fma_f32 v21, v21, v22, v23
    v_exp_f32 v21, v21
    s_nop 0
    v_add_f32 v21, 1.0, v21
    v_rcp_f32 v21, v21
    s_nop 0
    v_mul_f32 v20, v20, v21
    s_nop 1
    v_mov_b32_dpp v21, v20 row_shl:1 row_mask:0xf bank_mask:0xf bound_ctrl:0
    v_cvt_pk_bf16_f32 v28, v20, v21
    s_nop 1
    v_mov_b32_dpp v29, v28 row_shl:4 row_mask:0xf bank_mask:0xf bound_ctrl:0
    v_mov_b32_dpp v30, v28 row_shl:8 row_mask:0xf bank_mask:0xf bound_ctrl:0
    v_mov_b32_dpp v31, v28 row_shl:12 row_mask:0xf bank_mask:0xf bound_ctrl:0
    s_nop 1
    v_smfmac_f32_16x16x64_bf16 v[52:55], v[28:31], v[36:43], v1
    v_smfmac_f32_16x16x64_bf16 v[56:59], v[28:31], v[44:51], v1
    s_cmp_eq_u32 s30, 4
    s_nop 5
    v_add_f32 v22, v52, v54
    v_add_f32 v23, v56, v58
    ds_write_b64 v32, v[22:23]
    s_cbranch_scc0 L_skip_260
L_xw_261:
    ds_read2_b32 v[20:21], v33 offset0:0 offset1:32
    ds_read_b32 v22, v33 offset:256
    s_sub_u32 s56, s56, 1
    s_cbranch_scc1 L_done
    s_waitcnt lgkmcnt(0)
    v_max3_u32 v23, v20, v21, v22
    v_add_f32 v20, v20, v21
    v_cmp_eq_u32 vcc, -1, v23
    v_add_f32 v20, v20, v22
    s_cbranch_vccnz L_xw_261
    buffer_store_dword v20, v34, s[40:43], s60 offen sc1
L_skip_260:
L_skip_252:
    s_branch L_done
.p2align 5
L_typeB_1:
    s_cmp_eq_u32 s53, 3
    s_cbranch_scc0 L_typeC_262
    s_cmp_eq_u32 s30, 7
    s_cbranch_scc1 L_w7_267
    s_cmp_lt_u32 s30, 6
    s_cbranch_scc0 L_skip_269
    s_lshr_b32 s57, s30, 1
    s_mul_i32 s57, s57, 128
    s_and_b32 s58, s30, 1
    s_lshl_b32 s58, s58, 6
    s_add_u32 s57, s57, s58
    v_lshrrev_b32 v18, 5, v0
    v_lshlrev_b32 v18, 13, v18
    v_bfe_u32 v60, v0, 3, 1
    v_lshl_add_u32 v18, v60, 12, v18
    v_bfe_u32 v60, v0, 4, 1
    v_lshl_add_u32 v18, v60, 11, v18
    v_bfe_u32 v60, v0, 2, 1
    v_mul_u32_u24 v60, 384, v60
    v_add_u32 v18, v60, v18
    v_and_b32 v60, 3, v0
    v_lshl_add_u32 v18, v60, 3, v18
    v_add_u32 v18, s57, v18
    v_add_u32 v18, 30720, v18
    v_bfe_u32 v19, v0, 3, 1
    v_lshlrev_b32 v19, 12, v19
    v_bfe_u32 v60, v0, 4, 1
    v_lshl_add_u32 v19, v60, 11, v19
    v_bfe_u32 v60, v0, 2, 1
    v_mul_u32_u24 v60, 384, v60
    v_add_u32 v19, v60, v19
    v_and_b32 v60, 3, v0
    v_lshl_add_u32 v19, v60, 3, v19
    v_lshrrev_b32 v60, 5, v0
    v_lshl_add_u32 v19, v60, 5, v19
    v_add_u32 v19, s57, v19
    v_add_u32 v19, 63488, v19
    ds_read_b64_tr_b16 v[28:29], v18 offset:0
L_pad14:
    s_cbranch_execz L_pad18
    ds_read_b64_tr_b16 v[30:31], v18 offset:1024
    ds_read_b64_tr_b16 v[32:33], v18 offset:16384
    ds_read_b64_tr_b16 v[34:35], v18 offset:17408
    ds_read_b64_tr_b16 v[36:37], v18 offset:32
    ds_read_b64_tr_b16 v[38:39], v18 offset:1056
    ds_read_b64_tr_b16 v[40:41], v18 offset:16416
    ds_read_b64_tr_b16 v[42:43], v18 offset:17440
    ds_read_b64_tr_b16 v[24:25], v19 offset:0
    ds_read_b64_tr_b16 v[26:27], v19 offset:1024
    v_lshrrev_b32 v49, 4, v0
    v_lshlrev_b32 v49, 5, v49
    v_bfe_u32 v60, v0, 1, 1
    v_lshl_add_u32 v49, v60, 4, v49
    v_bfe_u32 v60, v0, 3, 1
    v_mul_u32_u24 v60, 192, v60
    v_add_u32 v49, v60, v49
    v_add_u32 v49, 156736, v49
    v_bfe_u32 v50, v0, 1, 1
    v_lshlrev_b32 v50, 4, v50
    v_bfe_u32 v60, v0, 3, 1
    v_mul_u32_u24 v60, 192, v60
    v_add_u32 v50, v60, v50
    v_add_u32 v50, 156864, v50
    v_mov_b32 v60, 156896
    v_and_b32 v51, 5, v0
    v_cmp_eq_u32 vcc, 0, v51
    s_nop 1
    v_cndmask_b32 v9, v60, v49, vcc
    v_cmp_eq_u32 vcc, 4, v51
    s_nop 1
    v_cndmask_b32 v10, v60, v49, vcc
    v_lshrrev_b32 v49, 2, v0
    v_and_b32 v49, 12, v49
    v_cmp_eq_u32 vcc, v49, v51
    s_nop 1
    v_cndmask_b32 v48, v60, v50, vcc
    v_mov_b64 v[44:45], 0
    v_mov_b64 v[46:47], 0
    s_lshr_b32 s57, s30, 1
    s_lshl_b32 s57, s57, 11
    s_lshl_b32 s58, s58, 1
    s_add_u32 s57, s57, s58
    s_lshl_b32 s58, s54, 8
    s_add_u32 s57, s57, s58
    v_and_b32 v11, 31, v0
    v_lshlrev_b32 v11, 2, v11
    v_lshrrev_b32 v60, 5, v0
    v_lshl_add_u32 v11, v60, 30, v11
    v_add_u32 v11, s57, v11
    s_add_u32 s59, s62, 39936
    s_add_u32 s60, s62, 25984
L_skip_269:
    s_cmp_lt_u32 s30, 6
    s_barrier
    s_cbranch_scc0 L_se_268
    ds_read_b128 v[12:15], v9
    ds_read_b128 v[16:19], v10
    ds_read_b128 v[20:23], v48
    s_waitcnt lgkmcnt(2)
    v_smfmac_f32_16x16x64_bf16 v[44:47], v[12:15], v[28:35], v1
    s_waitcnt lgkmcnt(1)
    v_smfmac_f32_16x16x64_bf16 v[44:47], v[16:19], v[36:43], v1
    s_waitcnt lgkmcnt(0)
    v_smfmac_f32_16x16x64_bf16 v[44:47], v[20:23], v[24:31], v1
    s_cmp_eq_u32 s55, 0
    s_nop 6
    v_add_f32 v12, v44, v46
    s_cbranch_scc1 L_gs_270
    buffer_store_dword v12, v11, s[40:43], s59 offen
L_gb_271:
.p2align 5
L_se_268:
    s_cmp_eq_u32 s30, 7
    s_cbranch_scc0 L_done
    s_cmp_eq_u32 s31, 0
    s_cbranch_scc0 L_done
    v_lshlrev_b32 v60, 16, v4
    v_add_f32 v2, v2, v60
    v_and_b32 v60, 0xffff0000, v4
    v_add_f32 v3, v3, v60
    v_and_b32 v60, 31, v0
    v_min_u32 v60, 19, v60
    s_mul_i32 s57, s54, 160
    v_lshrrev_b32 v7, 5, v0
    v_lshlrev_b32 v7, 2, v7
    v_add_u32 v7, s57, v7
    v_lshl_add_u32 v7, v60, 3, v7
    s_add_u32 s57, s7, 198144
    s_add_u32 s58, s7, 214528
    s_add_u32 s59, s7, 230912
L_pad15:
    s_cbranch_execz L_pad19
    s_add_u32 s60, s7, 247296
    v_mov_b64 v[36:37], 0
    v_mov_b64 v[38:39], 0
    s_nop 0
    v_mov_b32_dpp v36, v2 quad_perm:[0,1,2,3] row_mask:0x3 bank_mask:0xf
    v_mov_b32_dpp v37, v3 quad_perm:[0,1,2,3] row_mask:0x3 bank_mask:0xf
    v_mov_b32_dpp v38, v2 quad_perm:[0,1,2,3] row_mask:0xc bank_mask:0xf
    v_mov_b32_dpp v39, v3 quad_perm:[0,1,2,3] row_mask:0xc bank_mask:0xf
    s_add_u32 s75, s7, 266252
    v_and_b32 v9, 7, v0
    v_lshlrev_b32 v9, 9, v9
.p2align 5
L_pr_283:
    buffer_load_dword v12, v9, s[40:43], s75 offen sc1
    s_sub_u32 s56, s56, 1
    s_cbranch_scc1 L_done
L_pw_282:
    s_waitcnt vmcnt(0)
    v_cmp_eq_u32 vcc, -1, v12
    s_cbranch_vccnz L_pr_283
L_gw_279:
    buffer_load_dwordx4 v[12:15], v5, s[40:43], s57 offen sc1
    buffer_load_dwordx4 v[16:19], v5, s[40:43], s58 offen sc1
    buffer_load_dwordx4 v[20:23], v5, s[40:43], s59 offen sc1
    buffer_load_dwordx4 v[24:27], v5, s[40:43], s60 offen sc1
    s_sub_u32 s56, s56, 1
    s_cbranch_scc1 L_done
    s_and_b32 s74, s56, 31
    s_waitcnt vmcnt(3)
    v_pk_add_f32 v[28:29], v[12:13], v[36:37]
    v_pk_add_f32 v[30:31], v[14:15], v[38:39]
    s_waitcnt vmcnt(2)
    v_pk_add_f32 v[28:29], v[28:29], v[16:17]
    v_pk_add_f32 v[30:31], v[30:31], v[18:19]
    s_waitcnt vmcnt(1)
    v_pk_add_f32 v[28:29], v[28:29], v[20:21]
    v_pk_add_f32 v[30:31], v[30:31], v[22:23]
    s_waitcnt vmcnt(0)
    v_pk_add_f32 v[28:29], v[28:29], v[24:25]
    v_pk_add_f32 v[30:31], v[30:31], v[26:27]
    v_pk_add_f32 v[32:33], v[28:29], v[30:31]
    v_cmp_u_f32 vcc, v32, v33
    v_permlane32_swap_b32 v28, v30
    v_permlane32_swap_b32 v29, v31
    s_cbranch_vccnz L_gr_280
L_gk_281:
    v_pk_add_f32 v[28:29], v[28:29], v[30:31]
    v_cvt_pk_bf16_f32 v28, v28, v29
    global_store_dword v7, v28, s[24:25]
    s_branch L_done
.p2align 5
L_gs_43:
    buffer_store_dword v33, v34, s[40:43], s67 offen sc1
    s_branch L_gb_44
.p2align 5
L_gs_46:
    buffer_store_dword v12, v54, s[40:43], s59 offen sc1
    s_branch L_gb_47
.p2align 5
L_cr_64:
    s_sub_u32 s56, s56, 1
    s_cbranch_scc1 L_done
    global_load_dword v2, v3, s[26:27] sc1
    s_waitcnt vmcnt(0)
    s_branch L_cw_63
.p2align 5
L_far_65:
    s_lshl_b32 s57, s52, 2
    s_add_u32 s57, s57, s72
    s_mov_b64 exec, 1
    buffer_store_dword v25, v0, s[40:43], s57 offen offset:128 sc1
    s_mov_b64 exec, -1
    s_branch L_fb_66
.p2align 5
L_cr_88:
    s_sub_u32 s56, s56, 1
    s_cbranch_scc1 L_done
    buffer_load_dword v2, v24, s[40:43], s72 offen sc1
    s_branch L_cw_87
.p2align 5
L_gs_96:
    buffer_store_dword v33, v34, s[40:43], s67 offen sc1
    s_branch L_gb_97
.p2align 5
L_gs_99:
L_pad16:
    s_cbranch_execz L_pad20
    buffer_store_dword v12, v54, s[40:43], s59 offen sc1
    s_branch L_gb_100
.p2align 5
L_gs_123:
    buffer_store_dword v37, v4, s[40:43], s58 offen sc1
    s_branch L_gb_124
.p2align 5
L_cr_142:
    s_sub_u32 s56, s56, 1
    s_cbranch_scc1 L_done
    global_load_dword v2, v3, s[26:27] offset:4 sc1
    s_branch L_cw_141
.p2align 5
L_cr_163:
    buffer_load_dword v52, v56, s[40:43], s74 offen offset:1536 sc1
    buffer_load_dwordx2 v[54:55], v62, s[40:43], s74 offen offset:1536 sc1
    s_sub_u32 s56, s56, 1
    s_cbranch_scc1 L_done
    s_branch L_cw_162
.p2align 5
L_gs_170:
    buffer_store_dword v14, v3, s[40:43], s57 offen sc1
    s_branch L_gb_171
.p2align 5
L_gs_172:
    buffer_store_dword v12, v4, s[40:43], s57 offen offset:32 sc1
    s_branch L_gb_173
.p2align 5
L_comb_0:
    s_mov_b32 s57, 0
    s_cmp_eq_u32 s55, 0
    s_waitcnt lgkmcnt(0)
    s_barrier
    ds_read2st64_b64 v[12:15], v2 offset0:0 offset1:2
    ds_read2st64_b64 v[16:19], v2 offset0:4 offset1:6
    ds_read2st64_b64 v[20:23], v2 offset0:8 offset1:10
    ds_read2st64_b64 v[24:27], v2 offset0:12 offset1:14
    s_waitcnt lgkmcnt(2)
    v_pk_add_f32 v[12:13], v[12:13], v[14:15]
    v_pk_add_f32 v[16:17], v[16:17], v[18:19]
    v_pk_add_f32 v[12:13], v[12:13], v[16:17]
    s_waitcnt lgkmcnt(0)
    v_pk_add_f32 v[20:21], v[20:21], v[22:23]
    v_pk_add_f32 v[24:25], v[24:25], v[26:27]
    v_pk_add_f32 v[12:13], v[12:13], v[20:21]
    v_pk_add_f32 v[12:13], v[12:13], v[24:25]
    v_cvt_pk_bf16_f32 v14, v12, v13
    v_min_u32 v14, -2, v14
    s_cbranch_scc1 L_gs_170
    buffer_store_dword v14, v3, s[40:43], s57 offen
L_gb_171:
    s_cbranch_scc1 L_gs_172
    buffer_store_dword v12, v4, s[40:43], s57 offen offset:32
L_gb_173:
    s_branch L_comb_0b
.p2align 5
L_sr_182:
    buffer_load_dwordx4 v[52:55], v11, s[40:43], s65 offen offset:0 sc1
    buffer_load_dwordx4 v[56:59], v11, s[40:43], s65 offen offset:1024 sc1
    s_sub_u32 s56, s56, 1
    s_cbranch_scc1 L_done
    s_waitcnt vmcnt(0)
    s_branch L_sw_181
L_hr_183:
    buffer_load_dwordx4 v[12:15], v11, s[40:43], s58 offen offset:0 sc1
    buffer_load_dwordx4 v[16:19], v11, s[40:43], s58 offen offset:1024 sc1
    s_sub_u32 s56, s56, 1
    s_cbranch_scc1 L_done
    s_and_b32 s64, s56, 31
    s_cbranch_scc0 L_hx_185
    s_waitcnt vmcnt(2)
    v_pk_add_f32 v[20:21], v[12:13], v[16:17]
    v_pk_add_f32 v[22:23], v[14:15], v[18:19]
    s_nop 1
    v_permlane32_swap_b32 v20, v22
    v_permlane32_swap_b32 v21, v23
    v_pk_add_f32 v[20:21], v[20:21], v[22:23]
    s_nop 1
    v_permlane16_swap_b32 v20, v21
    v_add_f32 v20, v20, v21
    v_cmp_u_f32 vcc, v20, v20
    v_sub_f32 v20, v20, v26
    s_cbranch_vccnz L_hr_183
    s_branch L_hk_184
.p2align 5
L_hx_185:
L_pad17:
    s_cbranch_execz L_pad21
    s_waitcnt vmcnt(0)
    v_max3_u32 v20, v12, v13, v14
    v_max3_u32 v20, v20, v15, v16
    v_max3_u32 v20, v20, v17, v18
    v_max_u32 v20, v20, v19
    v_cmp_eq_u32 vcc, -1, v20
    s_cbranch_vccnz L_hr_183
    v_pk_add_f32 v[20:21], v[12:13], v[16:17]
    v_pk_add_f32 v[22:23], v[14:15], v[18:19]
    s_nop 1
    v_permlane32_swap_b32 v20, v22
    v_permlane32_swap_b32 v21, v23
    v_pk_add_f32 v[20:21], v[20:21], v[22:23]
    s_nop 1
    v_permlane16_swap_b32 v20, v21
    v_add_f32 v20, v20, v21
    v_sub_f32 v20, v20, v26
    s_branch L_hk_184
.p2align 5
L_gs_193:
    buffer_store_dword v0, v11, s[40:43], s58 offen sc1
    s_branch L_gb_194
.p2align 5
L_typeC_189:
    s_cmp_eq_u32 s30, 6
    s_cbranch_scc0 L_p1
    s_bitcmp1_b32 s3, 0
    s_cbranch_scc0 L_skip_190
    v_and_b32 v11, 3, v0
    v_lshlrev_b32 v11, 7, v11
    v_lshrrev_b32 v60, 2, v0
    v_lshl_add_u32 v11, v60, 24, v11
    s_add_u32 s58, s62, 26116
    s_add_u32 s75, s7, 266244
    v_and_b32 v9, 7, v0
    v_lshlrev_b32 v9, 9, v9
.p2align 5
L_pr_192:
    buffer_load_dword v12, v9, s[40:43], s75 offen sc1
    s_sub_u32 s56, s56, 1
    s_cbranch_scc1 L_done
L_pw_191:
    s_waitcnt vmcnt(0)
    v_cmp_eq_u32 vcc, -1, v12
    s_cbranch_vccnz L_pr_192
    s_cmp_eq_u32 s55, 0
    s_cbranch_scc1 L_gs_193
    buffer_store_dword v0, v11, s[40:43], s58 offen
L_gb_194:
    s_waitcnt vmcnt(1)
    s_branch L_p1
.p2align 5
L_skip_190:
    s_lshl_b32 s59, s31, 9
    s_add_u32 s59, s59, s8
    s_add_u32 s59, s59, 266240
    v_and_b32 v10, 1, v0
    v_lshlrev_b32 v10, 13, v10
    v_lshrrev_b32 v60, 1, v0
    v_lshl_add_u32 v10, v60, 24, v10
    s_cmp_eq_u32 s3, 20
    s_cbranch_scc0 L_skip_195
    s_add_u32 s58, s62, 1568
    v_lshrrev_b32 v9, 3, v0
    v_mul_u32_u24 v9, 1664, v9
    v_and_b32 v60, 7, v0
    v_lshl_add_u32 v9, v60, 2, v9
.p2align 5
L_pr_197:
    buffer_load_dword v12, v9, s[40:43], s58 offen sc1
    s_sub_u32 s56, s56, 1
    s_cbranch_scc1 L_done
L_pw_196:
    s_waitcnt vmcnt(0)
    v_cmp_eq_u32 vcc, -1, v12
    s_cbranch_vccnz L_pr_197
    buffer_store_dword v0, v10, s[40:43], s59 offen offset:0 sc1
L_skip_195:
    s_add_u32 s58, s62, 25856
    v_and_b32 v9, 15, v0
    v_lshlrev_b32 v9, 2, v9
.p2align 5
L_pr_199:
    buffer_load_dword v13, v9, s[40:43], s58 offen sc1
    s_sub_u32 s56, s56, 1
    s_cbranch_scc1 L_done
L_pw_198:
    s_waitcnt vmcnt(0)
    v_cmp_eq_u32 vcc, -1, v13
    s_cbranch_vccnz L_pr_199
    buffer_store_dword v0, v10, s[40:43], s59 offen offset:4 sc1
    s_waitcnt vmcnt(1)
    s_branch L_p1
.p2align 5
L_gs_203:
L_pad18:
    s_cbranch_execz L_pad22
    buffer_store_dword v12, v49, s[40:43], s60 offen sc1
    s_branch L_gb_204
.p2align 5
L_gs_205:
    buffer_store_dword v12, v11, s[40:43], s59 offen sc1
    s_branch L_gb_206
.p2align 5
L_gr_208:
    s_cbranch_scc1 L_gw_207
    s_waitcnt vmcnt(0)
    v_max3_u32 v32, v12, v13, v14
    v_max3_u32 v32, v32, v15, v16
    v_max3_u32 v32, v32, v17, v18
    v_max3_u32 v32, v32, v19, v20
    v_max3_u32 v32, v32, v21, v22
    v_max3_u32 v32, v32, v23, v24
    v_max3_u32 v32, v32, v25, v26
    v_max_u32 v32, v32, v27
    v_cmp_eq_u32 vcc, -1, v32
    s_cbranch_vccnz L_gw_207
    v_pk_add_f32 v[28:29], v[12:13], v[36:37]
    v_pk_add_f32 v[30:31], v[14:15], v[38:39]
    v_pk_add_f32 v[28:29], v[28:29], v[16:17]
    v_pk_add_f32 v[30:31], v[30:31], v[18:19]
    v_pk_add_f32 v[28:29], v[28:29], v[20:21]
    v_pk_add_f32 v[30:31], v[30:31], v[22:23]
    v_pk_add_f32 v[28:29], v[28:29], v[24:25]
    v_pk_add_f32 v[30:31], v[30:31], v[26:27]
    s_nop 1
    v_permlane32_swap_b32 v28, v30
    v_permlane32_swap_b32 v29, v31
    s_branch L_gk_209
.p2align 5
L_gs_212:
    buffer_store_dword v33, v34, s[40:43], s67 offen sc1
    s_branch L_gb_213
.p2align 5
L_w7_200:
    v_and_b32 v60, 31, v0
    v_min_u32 v60, 19, v60
    s_mul_i32 s57, s54, 320
    v_lshrrev_b32 v5, 5, v0
    v_lshlrev_b32 v5, 12, v5
    v_add_u32 v5, s57, v5
    v_lshl_add_u32 v5, v60, 4, v5
    v_and_b32 v60, 31, v0
    v_cmp_gt_u32 s[64:65], 20, v60
    v_min_u32 v60, 19, v60
    v_lshrrev_b32 v35, 5, v0
    v_lshlrev_b32 v35, 2, v35
    v_add_u32 v35, 156736, v35
    v_lshl_add_u32 v35, v60, 3, v35
    s_add_u32 s66, s62, 13312
    s_add_u32 s67, s62, 25856
    s_lshl_b32 s57, s54, 3
    v_lshrrev_b32 v34, 5, v0
    v_lshlrev_b32 v34, 2, v34
    v_add_u32 v34, s57, v34
    v_and_b32 v60, 31, v0
    v_mov_b32 v61, 0x7f000000
    v_cmp_ne_u32 vcc, 31, v60
    s_nop 1
    v_cndmask_b32 v34, v34, v61, vcc
    v_mov_b32 v61, 0x3f803f80
    s_add_u32 s57, s7, 0
    s_add_u32 s58, s7, 16384
    s_add_u32 s59, s7, 32768
    s_add_u32 s60, s7, 49152
    v_mov_b64 v[36:37], 0
    v_mov_b64 v[38:39], 0
    s_nop 0
    v_mov_b32_dpp v36, v2 quad_perm:[0,1,2,3] row_mask:0x3 bank_mask:0xf
    v_mov_b32_dpp v37, v3 quad_perm:[0,1,2,3] row_mask:0x3 bank_mask:0xf
    v_mov_b32_dpp v38, v2 quad_perm:[0,1,2,3] row_mask:0xc bank_mask:0xf
    v_mov_b32_dpp v39, v3 quad_perm:[0,1,2,3] row_mask:0xc bank_mask:0xf
    s_add_u32 s75, s7, 266240
    v_and_b32 v9, 7, v0
    v_lshlrev_b32 v9, 9, v9
.p2align 5
L_pr_211:
L_pad19:
    s_cbranch_execz L_pad23
    buffer_load_dword v12, v9, s[40:43], s75 offen sc1
    s_sub_u32 s56, s56, 1
    s_cbranch_scc1 L_done
L_pw_210:
    s_waitcnt vmcnt(0)
    v_cmp_eq_u32 vcc, -1, v12
    s_cbranch_vccnz L_pr_211
L_gw_207:
    buffer_load_dwordx4 v[12:15], v5, s[40:43], s57 offen sc1
    buffer_load_dwordx4 v[16:19], v5, s[40:43], s58 offen sc1
    buffer_load_dwordx4 v[20:23], v5, s[40:43], s59 offen sc1
    buffer_load_dwordx4 v[24:27], v5, s[40:43], s60 offen sc1
    s_sub_u32 s56, s56, 1
    s_cbranch_scc1 L_done
    s_and_b32 s74, s56, 31
    s_waitcnt vmcnt(3)
    v_pk_add_f32 v[28:29], v[12:13], v[36:37]
    v_pk_add_f32 v[30:31], v[14:15], v[38:39]
    s_waitcnt vmcnt(2)
    v_pk_add_f32 v[28:29], v[28:29], v[16:17]
    v_pk_add_f32 v[30:31], v[30:31], v[18:19]
    s_waitcnt vmcnt(1)
    v_pk_add_f32 v[28:29], v[28:29], v[20:21]
    v_pk_add_f32 v[30:31], v[30:31], v[22:23]
    s_waitcnt vmcnt(0)
    v_pk_add_f32 v[28:29], v[28:29], v[24:25]
    v_pk_add_f32 v[30:31], v[30:31], v[26:27]
    v_pk_add_f32 v[32:33], v[28:29], v[30:31]
    v_cmp_u_f32 vcc, v32, v33
    v_permlane32_swap_b32 v28, v30
    v_permlane32_swap_b32 v29, v31
    s_cbranch_vccnz L_gr_208
L_gk_209:
    v_pk_add_f32 v[28:29], v[28:29], v[30:31]
    v_cvt_pk_bf16_f32 v28, v28, v29
    ds_write_b32 v35, v28
    v_cndmask_b32 v29, 0, v28, s[64:65]
    v_dot2_f32_bf16 v33, v29, v61, 0
    v_dot2_f32_bf16 v32, v29, v29, 0
    v_lshlrev_b32 v2, 16, v28
    v_and_b32 v3, 0xffff0000, v28
    s_cmp_eq_u32 s55, 0
    v_permlane32_swap_b32 v33, v32
    v_add_f32 v33, v33, v32
    s_waitcnt lgkmcnt(0)
    s_barrier
    v_add_f32_dpp v33, v33, v33 row_ror:8 row_mask:0xf bank_mask:0xf
    s_nop 1
    v_add_f32_dpp v33, v33, v33 row_ror:4 row_mask:0xf bank_mask:0xf
    s_nop 1
    v_add_f32_dpp v33, v33, v33 row_ror:2 row_mask:0xf bank_mask:0xf
    s_nop 1
    v_add_f32_dpp v33, v33, v33 row_ror:1 row_mask:0xf bank_mask:0xf
    s_nop 1
    v_add_f32_dpp v33, v33, v33 row_bcast:15 row_mask:0xa bank_mask:0xf
    s_cbranch_scc1 L_gs_212
    buffer_store_dword v33, v34, s[40:43], s67 offen
L_gb_213:
    s_waitcnt vmcnt(1)
    s_branch L_se_201
.p2align 5
L_gs_217:
    buffer_store_dword v12, v11, s[40:43], s59 offen sc1
    s_branch L_gb_218
.p2align 5
L_gr_223:
    s_cbranch_scc1 L_gw_222
    s_waitcnt vmcnt(0)
    v_max3_u32 v32, v12, v13, v14
    v_max3_u32 v32, v32, v15, v16
    v_max3_u32 v32, v32, v17, v18
    v_max3_u32 v32, v32, v19, v20
    v_max3_u32 v32, v32, v21, v22
    v_max3_u32 v32, v32, v23, v24
    v_max3_u32 v32, v32, v25, v26
    v_max_u32 v32, v32, v27
    v_cmp_eq_u32 vcc, -1, v32
    s_cbranch_vccnz L_gw_222
    v_pk_add_f32 v[28:29], v[12:13], v[36:37]
    v_pk_add_f32 v[30:31], v[14:15], v[38:39]
    v_pk_add_f32 v[28:29], v[28:29], v[16:17]
    v_pk_add_f32 v[30:31], v[30:31], v[18:19]
    v_pk_add_f32 v[28:29], v[28:29], v[20:21]
    v_pk_add_f32 v[30:31], v[30:31], v[22:23]
    v_pk_add_f32 v[28:29], v[28:29], v[24:25]
L_pad20:
    s_cbranch_execz L_pad24
    v_pk_add_f32 v[30:31], v[30:31], v[26:27]
    s_nop 1
    v_permlane32_swap_b32 v28, v30
    v_permlane32_swap_b32 v29, v31
    s_branch L_gk_224
L_gr_226:
    s_cbranch_scc1 L_gw_225
    s_waitcnt vmcnt(0)
    v_max3_u32 v32, v12, v13, v14
    v_max3_u32 v32, v32, v15, v16
    v_max3_u32 v32, v32, v17, v18
    v_max3_u32 v32, v32, v19, v20
    v_max3_u32 v32, v32, v21, v22
    v_max3_u32 v32, v32, v23, v24
    v_max3_u32 v32, v32, v25, v26
    v_max_u32 v32, v32, v27
    v_cmp_eq_u32 vcc, -1, v32
    s_cbranch_vccnz L_gw_225
    v_pk_add_f32 v[28:29], v[12:13], v[36:37]
    v_pk_add_f32 v[30:31], v[14:15], v[38:39]
    v_pk_add_f32 v[28:29], v[28:29], v[16:17]
    v_pk_add_f32 v[30:31], v[30:31], v[18:19]
    v_pk_add_f32 v[28:29], v[28:29], v[20:21]
    v_pk_add_f32 v[30:31], v[30:31], v[22:23]
    v_pk_add_f32 v[28:29], v[28:29], v[24:25]
    v_pk_add_f32 v[30:31], v[30:31], v[26:27]
    s_nop 1
    v_permlane32_swap_b32 v28, v30
    v_permlane32_swap_b32 v29, v31
    s_branch L_gk_227
.p2align 5
L_gs_230:
    buffer_store_dword v33, v34, s[40:43], s67 offen sc1
    s_branch L_gb_231
.p2align 5
L_w7_214:
    v_and_b32 v60, 31, v0
    v_min_u32 v60, 19, v60
    s_mul_i32 s57, s54, 320
    v_lshrrev_b32 v5, 5, v0
    v_lshlrev_b32 v5, 12, v5
    v_add_u32 v5, s57, v5
    v_lshl_add_u32 v5, v60, 4, v5
    v_and_b32 v60, 31, v0
    v_cmp_gt_u32 s[64:65], 20, v60
    v_min_u32 v60, 19, v60
    v_lshrrev_b32 v35, 5, v0
    v_lshlrev_b32 v35, 2, v35
    v_add_u32 v35, 156736, v35
    v_lshl_add_u32 v35, v60, 3, v35
    s_mul_i32 s66, s53, 6144
    s_add_u32 s66, s66, s62
    s_add_u32 s66, s66, 46080
    s_lshl_b32 s67, s53, 6
    s_add_u32 s67, s67, s62
    s_add_u32 s67, s67, 25600
    s_lshl_b32 s57, s54, 3
    v_lshrrev_b32 v34, 5, v0
    v_lshlrev_b32 v34, 2, v34
    v_add_u32 v34, s57, v34
    v_and_b32 v60, 31, v0
    v_mov_b32 v61, 0x7f000000
    v_cmp_ne_u32 vcc, 31, v60
    s_nop 1
    v_cndmask_b32 v34, v34, v61, vcc
    v_mov_b32 v61, 0x3f803f80
    s_cmp_lg_u32 s53, 3
    s_cbranch_scc0 L_skip_219
    s_add_u32 s57, s62, 25856
    v_mov_b32 v9, 0
.p2align 5
L_pr_221:
    buffer_load_dword v12, v9, s[40:43], s57 offen sc1
    s_sub_u32 s56, s56, 1
    s_cbranch_scc1 L_done
L_pw_220:
    s_waitcnt vmcnt(0)
    v_cmp_eq_u32 vcc, -1, v12
    s_cbranch_vccnz L_pr_221
    s_add_u32 s57, s7, 0
    s_add_u32 s58, s7, 16384
    s_add_u32 s59, s7, 32768
    s_add_u32 s60, s7, 49152
    v_mov_b64 v[36:37], 0
    v_mov_b64 v[38:39], 0
    s_nop 0
    v_mov_b32_dpp v36, v2 quad_perm:[0,1,2,3] row_mask:0x3 bank_mask:0xf
    v_mov_b32_dpp v37, v3 quad_perm:[0,1,2,3] row_mask:0x3 bank_mask:0xf
    v_mov_b32_dpp v38, v2 quad_perm:[0,1,2,3] row_mask:0xc bank_mask:0xf
    v_mov_b32_dpp v39, v3 quad_perm:[0,1,2,3] row_mask:0xc bank_mask:0xf
L_gw_222:
L_pad21:
    s_cbranch_execz L_pad25
    buffer_load_dwordx4 v[12:15], v5, s[40:43], s57 offen sc1
    buffer_load_dwordx4 v[16:19], v5, s[40:43], s58 offen sc1
    buffer_load_dwordx4 v[20:23], v5, s[40:43], s59 offen sc1
    buffer_load_dwordx4 v[24:27], v5, s[40:43], s60 offen sc1
    s_sub_u32 s56, s56, 1
    s_cbranch_scc1 L_done
    s_and_b32 s74, s56, 31
    s_waitcnt vmcnt(3)
    v_pk_add_f32 v[28:29], v[12:13], v[36:37]
    v_pk_add_f32 v[30:31], v[14:15], v[38:39]
    s_waitcnt vmcnt(2)
    v_pk_add_f32 v[28:29], v[28:29], v[16:17]
    v_pk_add_f32 v[30:31], v[30:31], v[18:19]
    s_waitcnt vmcnt(1)
    v_pk_add_f32 v[28:29], v[28:29], v[20:21]
    v_pk_add_f32 v[30:31], v[30:31], v[22:23]
    s_waitcnt vmcnt(0)
    v_pk_add_f32 v[28:29], v[28:29], v[24:25]
    v_pk_add_f32 v[30:31], v[30:31], v[26:27]
    v_pk_add_f32 v[32:33], v[28:29], v[30:31]
    v_cmp_u_f32 vcc, v32, v33
    v_permlane32_swap_b32 v28, v30
    v_permlane32_swap_b32 v29, v31
    s_cbranch_vccnz L_gr_223
L_gk_224:
    v_pk_add_f32 v[28:29], v[28:29], v[30:31]
    v_cvt_pk_bf16_f32 v28, v28, v29
    v_lshlrev_b32 v2, 16, v28
    v_and_b32 v3, 0xffff0000, v28
L_skip_219:
    s_lshl_b32 s74, s53, 7
    s_add_u32 s75, s62, s74
    s_add_u32 s75, s75, 26116
    v_mov_b32 v9, 0
    buffer_load_dword v12, v9, s[40:43], s75 offen sc1
    v_lshlrev_b32 v60, 16, v4
    v_add_f32 v2, v2, v60
    v_and_b32 v60, 0xffff0000, v4
    v_add_f32 v3, v3, v60
    s_add_u32 s57, s7, 66048
    s_add_u32 s58, s7, 82432
    s_add_u32 s59, s7, 98816
    s_add_u32 s60, s7, 115200
    v_mov_b64 v[36:37], 0
    v_mov_b64 v[38:39], 0
    s_nop 0
    v_mov_b32_dpp v36, v2 quad_perm:[0,1,2,3] row_mask:0x3 bank_mask:0xf
    v_mov_b32_dpp v37, v3 quad_perm:[0,1,2,3] row_mask:0x3 bank_mask:0xf
    v_mov_b32_dpp v38, v2 quad_perm:[0,1,2,3] row_mask:0xc bank_mask:0xf
    v_mov_b32_dpp v39, v3 quad_perm:[0,1,2,3] row_mask:0xc bank_mask:0xf
.p2align 5
L_pr_229:
    buffer_load_dword v12, v9, s[40:43], s75 offen sc1
    s_sub_u32 s56, s56, 1
    s_cbranch_scc1 L_done
L_pw_228:
    s_waitcnt vmcnt(1)
    v_cmp_eq_u32 vcc, -1, v12
    s_cbranch_vccnz L_pr_229
L_gw_225:
    buffer_load_dwordx4 v[12:15], v5, s[40:43], s57 offen sc1
    buffer_load_dwordx4 v[16:19], v5, s[40:43], s58 offen sc1
    buffer_load_dwordx4 v[20:23], v5, s[40:43], s59 offen sc1
    buffer_load_dwordx4 v[24:27], v5, s[40:43], s60 offen sc1
    s_sub_u32 s56, s56, 1
    s_cbranch_scc1 L_done
    s_and_b32 s74, s56, 31
    s_waitcnt vmcnt(3)
    v_pk_add_f32 v[28:29], v[12:13], v[36:37]
    v_pk_add_f32 v[30:31], v[14:15], v[38:39]
    s_waitcnt vmcnt(2)
    v_pk_add_f32 v[28:29], v[28:29], v[16:17]
    v_pk_add_f32 v[30:31], v[30:31], v[18:19]
    s_waitcnt vmcnt(1)
    v_pk_add_f32 v[28:29], v[28:29], v[20:21]
    v_pk_add_f32 v[30:31], v[30:31], v[22:23]
    s_waitcnt vmcnt(0)
    v_pk_add_f32 v[28:29], v[28:29], v[24:25]
    v_pk_add_f32 v[30:31], v[30:31], v[26:27]
    v_pk_add_f32 v[32:33], v[28:29], v[30:31]
    v_cmp_u_f32 vcc, v32, v33
    v_permlane32_swap_b32 v28, v30
    v_permlane32_swap_b32 v29, v31
    s_cbranch_vccnz L_gr_226
L_gk_227:
    v_pk_add_f32 v[28:29], v[28:29], v[30:31]
    v_cvt_pk_bf16_f32 v28, v28, v29
L_pad22:
    s_cbranch_execz L_pad26
    ds_write_b32 v35, v28
    v_cndmask_b32 v29, 0, v28, s[64:65]
    v_dot2_f32_bf16 v33, v29, v61, 0
    v_dot2_f32_bf16 v32, v29, v29, 0
    v_lshlrev_b32 v2, 16, v28
    v_and_b32 v3, 0xffff0000, v28
    s_cmp_eq_u32 s55, 0
    v_permlane32_swap_b32 v33, v32
    v_add_f32 v33, v33, v32
    s_waitcnt lgkmcnt(0)
    s_barrier
    v_add_f32_dpp v33, v33, v33 row_ror:8 row_mask:0xf bank_mask:0xf
    s_nop 1
    v_add_f32_dpp v33, v33, v33 row_ror:4 row_mask:0xf bank_mask:0xf
    s_nop 1
    v_add_f32_dpp v33, v33, v33 row_ror:2 row_mask:0xf bank_mask:0xf
    s_nop 1
    v_add_f32_dpp v33, v33, v33 row_ror:1 row_mask:0xf bank_mask:0xf
    s_nop 1
    v_add_f32_dpp v33, v33, v33 row_bcast:15 row_mask:0xa bank_mask:0xf
    s_cbranch_scc1 L_gs_230
    buffer_store_dword v33, v34, s[40:43], s67 offen
L_gb_231:
    s_waitcnt vmcnt(1)
    s_branch L_se_215
.p2align 5
L_hr_236:
    buffer_load_dwordx4 v[40:43], v7, s[40:43], s59 offen offset:0 sc1
    buffer_load_dwordx4 v[44:47], v7, s[40:43], s59 offen offset:1024 sc1
    s_sub_u32 s56, s56, 1
    s_cbranch_scc1 L_done
    s_and_b32 s64, s56, 31
    s_cbranch_scc0 L_hx_238
    s_waitcnt vmcnt(2)
    v_pk_add_f32 v[20:21], v[40:41], v[44:45]
    v_pk_add_f32 v[22:23], v[42:43], v[46:47]
    s_nop 1
    v_permlane32_swap_b32 v20, v22
    v_permlane32_swap_b32 v21, v23
    v_pk_add_f32 v[20:21], v[20:21], v[22:23]
    s_nop 1
    v_permlane16_swap_b32 v20, v21
    v_add_f32 v20, v20, v21
    v_cmp_u_f32 vcc, v20, v20
    v_sub_f32 v20, v20, v50
    s_cbranch_vccnz L_hr_236
    s_branch L_hk_237
.p2align 5
L_hx_238:
    s_waitcnt vmcnt(0)
    v_max3_u32 v20, v40, v41, v42
    v_max3_u32 v20, v20, v43, v44
    v_max3_u32 v20, v20, v45, v46
    v_max_u32 v20, v20, v47
    v_cmp_eq_u32 vcc, -1, v20
    s_cbranch_vccnz L_hr_236
    v_pk_add_f32 v[20:21], v[40:41], v[44:45]
    v_pk_add_f32 v[22:23], v[42:43], v[46:47]
    s_nop 1
    v_permlane32_swap_b32 v20, v22
    v_permlane32_swap_b32 v21, v23
    v_pk_add_f32 v[20:21], v[20:21], v[22:23]
    s_nop 1
    v_permlane16_swap_b32 v20, v21
    v_add_f32 v20, v20, v21
    v_sub_f32 v20, v20, v50
    s_branch L_hk_237
L_qo_232:
    v_mov_b64 v[24:25], 0
    v_mov_b64 v[26:27], 0
    v_mov_b64 v[28:29], 0
    v_mov_b64 v[30:31], 0
    v_mov_b64 v[32:33], 0
    v_mov_b64 v[34:35], 0
    v_mov_b64 v[36:37], 0
    v_mov_b64 v[38:39], 0
    v_lshrrev_b32 v5, 4, v0
    v_lshlrev_b32 v5, 5, v5
    v_bfe_u32 v60, v0, 1, 1
    v_lshl_add_u32 v5, v60, 4, v5
    v_add_u32 v5, 124928, v5
    s_branch L_qb_233
.p2align 5
L_mr_239:
    ds_read_b32 v36, v62
    s_sub_u32 s56, s56, 1
    s_cbranch_scc1 L_done
    s_waitcnt lgkmcnt(0)
    v_cmp_eq_u32 vcc, -1, v36
    s_cbranch_vccnz L_mr_239
    v_max_f32_dpp v37, v36, v36 row_ror:4 row_mask:0xf bank_mask:0xf
L_pad23:
    s_cbranch_execz L_padback
    s_nop 1
    v_max_f32_dpp v37, v37, v37 row_ror:2 row_mask:0xf bank_mask:0xf
    s_nop 1
    v_max_f32_dpp v37, v37, v37 row_ror:1 row_mask:0xf bank_mask:0xf
    v_sub_f32 v39, v61, v37
    v_exp_f32 v39, v39
    s_branch L_mk_240
.p2align 5
L_gs_241:
    buffer_store_dword v37, v4, s[40:43], s58 offen sc1
    s_branch L_gb_242
.p2align 5
L_gs_243:
    buffer_store_dword v14, v3, s[40:43], s57 offen sc1
    s_branch L_gb_244
.p2align 5
L_gs_245:
    buffer_store_dword v12, v4, s[40:43], s57 offen offset:32 sc1
    s_branch L_gb_246
.p2align 5
L_comb_1:
    s_mov_b32 s58, 26624
    s_cmp_eq_u32 s55, 0
    s_cbranch_scc1 L_gs_241
    buffer_store_dword v37, v4, s[40:43], s58 offen
L_gb_242:
    s_mov_b32 s57, 26624
    s_cmp_eq_u32 s55, 0
    s_waitcnt lgkmcnt(0)
    s_barrier
    ds_read2st64_b64 v[12:15], v2 offset0:24 offset1:26
    ds_read2st64_b64 v[16:19], v2 offset0:28 offset1:30
    ds_read2st64_b64 v[20:23], v2 offset0:32 offset1:34
    ds_read2st64_b64 v[24:27], v2 offset0:36 offset1:38
    s_waitcnt lgkmcnt(2)
    v_pk_add_f32 v[12:13], v[12:13], v[14:15]
    v_pk_add_f32 v[16:17], v[16:17], v[18:19]
    v_pk_add_f32 v[12:13], v[12:13], v[16:17]
    s_waitcnt lgkmcnt(0)
    v_pk_add_f32 v[20:21], v[20:21], v[22:23]
    v_pk_add_f32 v[24:25], v[24:25], v[26:27]
    v_pk_add_f32 v[12:13], v[12:13], v[20:21]
    v_pk_add_f32 v[12:13], v[12:13], v[24:25]
    v_cvt_pk_bf16_f32 v14, v12, v13
    v_min_u32 v14, -2, v14
    s_cbranch_scc1 L_gs_243
    buffer_store_dword v14, v3, s[40:43], s57 offen
L_gb_244:
    s_cbranch_scc1 L_gs_245
    buffer_store_dword v12, v4, s[40:43], s57 offen offset:32
L_gb_246:
    s_branch L_comb_1b
.p2align 5
L_sr_256:
    buffer_load_dwordx4 v[52:55], v11, s[40:43], s65 offen offset:0 sc1
    buffer_load_dwordx4 v[56:59], v11, s[40:43], s65 offen offset:1024 sc1
    s_sub_u32 s56, s56, 1
    s_cbranch_scc1 L_done
    s_waitcnt vmcnt(0)
    s_branch L_sw_255
L_hr_257:
    buffer_load_dwordx4 v[12:15], v11, s[40:43], s58 offen offset:0 sc1
    buffer_load_dwordx4 v[16:19], v11, s[40:43], s58 offen offset:1024 sc1
    s_sub_u32 s56, s56, 1
    s_cbranch_scc1 L_done
    s_and_b32 s64, s56, 31
    s_cbranch_scc0 L_hx_259
    s_waitcnt vmcnt(2)
    v_pk_add_f32 v[20:21], v[12:13], v[16:17]
    v_pk_add_f32 v[22:23], v[14:15], v[18:19]
    s_nop 1
    v_permlane32_swap_b32 v20, v22
    v_permlane32_swap_b32 v21, v23
    v_pk_add_f32 v[20:21], v[20:21], v[22:23]
    s_nop 1
    v_permlane16_swap_b32 v20, v21
    v_add_f32 v20, v20, v21
    v_cmp_u_f32 vcc, v20, v20
    v_sub_f32 v20, v20, v26
    s_cbranch_vccnz L_hr_257
    s_branch L_hk_258
.p2align 5
L_hx_259:
L_pad24:
    s_cbranch_execz L_padback
    s_waitcnt vmcnt(0)
    v_max3_u32 v20, v12, v13, v14
    v_max3_u32 v20, v20, v15, v16
    v_max3_u32 v20, v20, v17, v18
    v_max_u32 v20, v20, v19
    v_cmp_eq_u32 vcc, -1, v20
    s_cbranch_vccnz L_hr_257
    v_pk_add_f32 v[20:21], v[12:13], v[16:17]
    v_pk_add_f32 v[22:23], v[14:15], v[18:19]
    s_nop 1
    v_permlane32_swap_b32 v20, v22
    v_permlane32_swap_b32 v21, v23
    v_pk_add_f32 v[20:21], v[20:21], v[22:23]
    s_nop 1
    v_permlane16_swap_b32 v20, v21
    v_add_f32 v20, v20, v21
    v_sub_f32 v20, v20, v26
    s_branch L_hk_258
.p2align 5
L_typeC_262:
    s_cmp_eq_u32 s30, 6
    s_cbranch_scc0 L_done
    s_cmp_eq_u32 s3, 20
    s_cbranch_scc0 L_done
    s_lshl_b32 s59, s31, 9
    s_add_u32 s59, s59, s8
    s_add_u32 s59, s59, 266240
    v_and_b32 v10, 1, v0
    v_lshlrev_b32 v10, 13, v10
    v_lshrrev_b32 v60, 1, v0
    v_lshl_add_u32 v10, v60, 24, v10
    s_add_u32 s58, s62, 28192
    v_lshrrev_b32 v9, 3, v0
    v_mul_u32_u24 v9, 1664, v9
    v_and_b32 v60, 7, v0
    v_lshl_add_u32 v9, v60, 2, v9
.p2align 5
L_pr_264:
    buffer_load_dword v12, v9, s[40:43], s58 offen sc1
    s_sub_u32 s56, s56, 1
    s_cbranch_scc1 L_done
L_pw_263:
    s_waitcnt vmcnt(0)
    v_cmp_eq_u32 vcc, -1, v12
    s_cbranch_vccnz L_pr_264
    buffer_store_dword v0, v10, s[40:43], s59 offen offset:8 sc1
    s_add_u32 s58, s62, 25984
    v_and_b32 v9, 15, v0
    v_lshlrev_b32 v9, 2, v9
.p2align 5
L_pr_266:
    buffer_load_dword v13, v9, s[40:43], s58 offen sc1
    s_sub_u32 s56, s56, 1
    s_cbranch_scc1 L_done
L_pw_265:
    s_waitcnt vmcnt(0)
    v_cmp_eq_u32 vcc, -1, v13
    s_cbranch_vccnz L_pr_266
    buffer_store_dword v0, v10, s[40:43], s59 offen offset:12 sc1
    s_waitcnt vmcnt(1)
    s_branch L_done
.p2align 5
L_gs_270:
    buffer_store_dword v12, v11, s[40:43], s59 offen sc1
    s_branch L_gb_271
.p2align 5
L_gr_273:
    s_cbranch_scc1 L_gw_272
    s_waitcnt vmcnt(0)
    v_max3_u32 v32, v12, v13, v14
    v_max3_u32 v32, v32, v15, v16
    v_max3_u32 v32, v32, v17, v18
    v_max3_u32 v32, v32, v19, v20
    v_max3_u32 v32, v32, v21, v22
    v_max3_u32 v32, v32, v23, v24
    v_max3_u32 v32, v32, v25, v26
    v_max_u32 v32, v32, v27
    v_cmp_eq_u32 vcc, -1, v32
    s_cbranch_vccnz L_gw_272
    v_pk_add_f32 v[28:29], v[12:13], v[36:37]
    v_pk_add_f32 v[30:31], v[14:15], v[38:39]
    v_pk_add_f32 v[28:29], v[28:29], v[16:17]
    v_pk_add_f32 v[30:31], v[30:31], v[18:19]
    v_pk_add_f32 v[28:29], v[28:29], v[20:21]
    v_pk_add_f32 v[30:31], v[30:31], v[22:23]
    v_pk_add_f32 v[28:29], v[28:29], v[24:25]
L_pad25:
    s_cbranch_execz L_padback
    v_pk_add_f32 v[30:31], v[30:31], v[26:27]
    s_nop 1
    v_permlane32_swap_b32 v28, v30
    v_permlane32_swap_b32 v29, v31
    s_branch L_gk_274
L_gs_277:
    buffer_store_dword v33, v34, s[40:43], s67 offen sc1
    s_branch L_gb_278
.p2align 5
L_w7_267:
    v_and_b32 v60, 31, v0
    v_min_u32 v60, 19, v60
    s_mul_i32 s57, s54, 320
    v_lshrrev_b32 v5, 5, v0
    v_lshlrev_b32 v5, 12, v5
    v_add_u32 v5, s57, v5
    v_lshl_add_u32 v5, v60, 4, v5
    v_and_b32 v60, 31, v0
    v_cmp_gt_u32 s[64:65], 20, v60
    v_min_u32 v60, 19, v60
    v_lshrrev_b32 v35, 5, v0
    v_lshlrev_b32 v35, 2, v35
    v_add_u32 v35, 156736, v35
    v_lshl_add_u32 v35, v60, 3, v35
    s_add_u32 s66, s62, 39936
    s_add_u32 s67, s62, 25984
    s_lshl_b32 s57, s54, 3
    v_lshrrev_b32 v34, 5, v0
    v_lshlrev_b32 v34, 2, v34
    v_add_u32 v34, s57, v34
    v_and_b32 v60, 31, v0
    v_mov_b32 v61, 0x7f000000
    v_cmp_ne_u32 vcc, 31, v60
    s_nop 1
    v_cndmask_b32 v34, v34, v61, vcc
    v_mov_b32 v61, 0x3f803f80
    s_add_u32 s57, s7, 132096
    s_add_u32 s58, s7, 148480
    s_add_u32 s59, s7, 164864
    s_add_u32 s60, s7, 181248
    v_mov_b64 v[36:37], 0
    v_mov_b64 v[38:39], 0
    s_nop 0
    v_mov_b32_dpp v36, v2 quad_perm:[0,1,2,3] row_mask:0x3 bank_mask:0xf
    v_mov_b32_dpp v37, v3 quad_perm:[0,1,2,3] row_mask:0x3 bank_mask:0xf
    v_mov_b32_dpp v38, v2 quad_perm:[0,1,2,3] row_mask:0xc bank_mask:0xf
    v_mov_b32_dpp v39, v3 quad_perm:[0,1,2,3] row_mask:0xc bank_mask:0xf
    s_add_u32 s75, s7, 266248
    v_and_b32 v9, 7, v0
    v_lshlrev_b32 v9, 9, v9
.p2align 5
L_pr_276:
    buffer_load_dword v12, v9, s[40:43], s75 offen sc1
    s_sub_u32 s56, s56, 1
    s_cbranch_scc1 L_done
L_pw_275:
    s_waitcnt vmcnt(0)
    v_cmp_eq_u32 vcc, -1, v12
    s_cbranch_vccnz L_pr_276
L_gw_272:
    buffer_load_dwordx4 v[12:15], v5, s[40:43], s57 offen sc1
    buffer_load_dwordx4 v[16:19], v5, s[40:43], s58 offen sc1
    buffer_load_dwordx4 v[20:23], v5, s[40:43], s59 offen sc1
    buffer_load_dwordx4 v[24:27], v5, s[40:43], s60 offen sc1
    s_sub_u32 s56, s56, 1
    s_cbranch_scc1 L_done
    s_and_b32 s74, s56, 31
    s_waitcnt vmcnt(3)
    v_pk_add_f32 v[28:29], v[12:13], v[36:37]
    v_pk_add_f32 v[30:31], v[14:15], v[38:39]
    s_waitcnt vmcnt(2)
    v_pk_add_f32 v[28:29], v[28:29], v[16:17]
    v_pk_add_f32 v[30:31], v[30:31], v[18:19]
    s_waitcnt vmcnt(1)
    v_pk_add_f32 v[28:29], v[28:29], v[20:21]
    v_pk_add_f32 v[30:31], v[30:31], v[22:23]
    s_waitcnt vmcnt(0)
    v_pk_add_f32 v[28:29], v[28:29], v[24:25]
    v_pk_add_f32 v[30:31], v[30:31], v[26:27]
    v_pk_add_f32 v[32:33], v[28:29], v[30:31]
    v_cmp_u_f32 vcc, v32, v33
    v_permlane32_swap_b32 v28, v30
    v_permlane32_swap_b32 v29, v31
    s_cbranch_vccnz L_gr_273
L_gk_274:
    v_pk_add_f32 v[28:29], v[28:29], v[30:31]
    v_cvt_pk_bf16_f32 v28, v28, v29
L_pad26:
    s_cbranch_execz L_padback
    ds_write_b32 v35, v28
    v_cndmask_b32 v29, 0, v28, s[64:65]
    v_dot2_f32_bf16 v33, v29, v61, 0
    v_dot2_f32_bf16 v32, v29, v29, 0
    v_lshlrev_b32 v2, 16, v28
    v_and_b32 v3, 0xffff0000, v28
    s_cmp_eq_u32 s55, 0
    v_permlane32_swap_b32 v33, v32
    v_add_f32 v33, v33, v32
    s_waitcnt lgkmcnt(0)
    s_barrier
    v_add_f32_dpp v33, v33, v33 row_ror:8 row_mask:0xf bank_mask:0xf
    s_nop 1
    v_add_f32_dpp v33, v33, v33 row_ror:4 row_mask:0xf bank_mask:0xf
    s_nop 1
    v_add_f32_dpp v33, v33, v33 row_ror:2 row_mask:0xf bank_mask:0xf
    s_nop 1
    v_add_f32_dpp v33, v33, v33 row_ror:1 row_mask:0xf bank_mask:0xf
    s_nop 1
    v_add_f32_dpp v33, v33, v33 row_bcast:15 row_mask:0xa bank_mask:0xf
    s_cbranch_scc1 L_gs_277
    buffer_store_dword v33, v34, s[40:43], s67 offen
L_gb_278:
    s_waitcnt vmcnt(1)
    s_branch L_se_268
.p2align 5
L_gr_280:
    s_cbranch_scc1 L_gw_279
    s_waitcnt vmcnt(0)
    v_max3_u32 v32, v12, v13, v14
    v_max3_u32 v32, v32, v15, v16
    v_max3_u32 v32, v32, v17, v18
    v_max3_u32 v32, v32, v19, v20
    v_max3_u32 v32, v32, v21, v22
    v_max3_u32 v32, v32, v23, v24
    v_max3_u32 v32, v32, v25, v26
    v_max_u32 v32, v32, v27
    v_cmp_eq_u32 vcc, -1, v32
    s_cbranch_vccnz L_gw_279
    v_pk_add_f32 v[28:29], v[12:13], v[36:37]
    v_pk_add_f32 v[30:31], v[14:15], v[38:39]
    v_pk_add_f32 v[28:29], v[28:29], v[16:17]
    v_pk_add_f32 v[30:31], v[30:31], v[18:19]
    v_pk_add_f32 v[28:29], v[28:29], v[20:21]
    v_pk_add_f32 v[30:31], v[30:31], v[22:23]
    v_pk_add_f32 v[28:29], v[28:29], v[24:25]
    v_pk_add_f32 v[30:31], v[30:31], v[26:27]
    s_nop 1
    v_permlane32_swap_b32 v28, v30
    v_permlane32_swap_b32 v29, v31
    s_branch L_gk_281
L_tail_end:
.p2align 5
L_spread:
    s_add_u32 s62, s62, 966656
    s_cmp_eq_u32 s30, 5
    s_cbranch_scc0 L_skip_93
    v_mov_b64 v[12:13], -1
    v_mov_b64 v[14:15], -1
    v_lshlrev_b32 v16, 4, v0
    s_mul_i32 s57, s52, 2208
    s_add_u32 s57, s57, s62
    s_mov_b64 exec, 0x3ff
    buffer_store_dwordx4 v[12:15], v16, s[40:43], s57 offen offset:2048 sc1
    s_mov_b64 exec, -1
    buffer_store_dwordx4 v[12:15], v16, s[40:43], s57 offen offset:0 sc1
    buffer_store_dwordx4 v[12:15], v16, s[40:43], s57 offen offset:1024 sc1
L_skip_93:
    s_cmp_eq_u32 s30, 7
    s_cbranch_scc0 L_skip_94
    v_and_b32 v60, 31, v0
    v_cmp_gt_u32 s[64:65], 20, v60
    v_min_u32 v60, 19, v60
    v_lshrrev_b32 v35, 5, v0
    v_lshlrev_b32 v35, 2, v35
    v_add_u32 v35, 156736, v35
    v_lshl_add_u32 v35, v60, 3, v35
    s_mul_i32 s66, s53, 12416
    s_add_u32 s66, s66, s62
    s_add_u32 s66, s66, 70656
    s_add_u32 s67, s66, 12288
    s_lshl_b32 s57, s54, 3
    v_lshrrev_b32 v34, 5, v0
    v_lshlrev_b32 v34, 2, v34
    v_add_u32 v34, s57, v34
    v_and_b32 v60, 31, v0
    v_mov_b32 v61, 0x7f000000
    v_cmp_ne_u32 vcc, 31, v60
    s_nop 1
    v_cndmask_b32 v34, v34, v61, vcc
    v_mov_b32 v61, 0x3f803f80
    v_cvt_pk_bf16_f32 v28, v2, v3
L_skip_94:
    s_cmp_eq_u32 s30, 7
    s_cbranch_scc0 L_skip_95
    v_cndmask_b32 v29, 0, v28, s[64:65]
    v_dot2_f32_bf16 v33, v29, v61, 0
    v_dot2_f32_bf16 v32, v29, v29, 0
    v_lshlrev_b32 v2, 16, v28
    v_and_b32 v3, 0xffff0000, v28
    s_cmp_eq_u32 s55, 0
    v_permlane32_swap_b32 v33, v32
    v_add_f32 v33, v33, v32
    s_nop 1
    v_add_f32_dpp v33, v33, v33 row_ror:8 row_mask:0xf bank_mask:0xf
    s_nop 1
    v_add_f32_dpp v33, v33, v33 row_ror:4 row_mask:0xf bank_mask:0xf
    s_nop 1
    v_add_f32_dpp v33, v33, v33 row_ror:2 row_mask:0xf bank_mask:0xf
    s_nop 1
    v_add_f32_dpp v33, v33, v33 row_ror:1 row_mask:0xf bank_mask:0xf
    s_nop 1
    v_add_f32_dpp v33, v33, v33 row_bcast:15 row_mask:0xa bank_mask:0xf
    s_cbranch_scc1 L_gs_96
    buffer_store_dword v33, v34, s[40:43], s67 offen
L_gb_97:
    s_waitcnt vmcnt(1)
L_skip_95:
    s_cmp_lt_u32 s30, 6
    s_cbranch_scc0 L_skip_98
    s_lshr_b32 s57, s30, 1
    s_mul_i32 s57, s57, 1024
    s_and_b32 s58, s30, 1
    s_lshl_b32 s58, s58, 6
    s_add_u32 s57, s57, s58
    v_lshrrev_b32 v18, 5, v0
    v_mul_u32_u24 v18, 6144, v18
    v_bfe_u32 v60, v0, 3, 1
    v_mul_u32_u24 v60, 3072, v60
    v_add_u32 v18, v60, v18
    v_bfe_u32 v60, v0, 4, 1
    v_lshl_add_u32 v18, v60, 9, v18
    v_bfe_u32 v60, v0, 2, 1
    v_lshl_add_u32 v18, v60, 7, v18
    v_and_b32 v60, 3, v0
    v_lshl_add_u32 v18, v60, 3, v18
    v_add_u32 v18, s57, v18
    v_bfe_u32 v19, v0, 3, 1
    v_mul_u32_u24 v19, 3072, v19
    v_bfe_u32 v60, v0, 4, 1
    v_lshl_add_u32 v19, v60, 9, v19
    v_bfe_u32 v60, v0, 2, 1
    v_lshl_add_u32 v19, v60, 7, v19
    v_and_b32 v60, 3, v0
    v_lshl_add_u32 v19, v60, 3, v19
    v_lshrrev_b32 v60, 5, v0
    v_lshl_add_u32 v19, v60, 5, v19
    v_add_u32 v19, s57, v19
    v_add_u32 v19, 24576, v19
    ds_read_b64_tr_b16 v[28:29], v18 offset:0
    ds_read_b64_tr_b16 v[30:31], v18 offset:256
    ds_read_b64_tr_b16 v[32:33], v18 offset:12288
    ds_read_b64_tr_b16 v[34:35], v18 offset:12544
    ds_read_b64_tr_b16 v[36:37], v18 offset:32
    ds_read_b64_tr_b16 v[38:39], v18 offset:288
    ds_read_b64_tr_b16 v[40:41], v18 offset:12320
    ds_read_b64_tr_b16 v[42:43], v18 offset:12576
    ds_read_b64_tr_b16 v[24:25], v19 offset:0
    ds_read_b64_tr_b16 v[26:27], v19 offset:256
    v_lshrrev_b32 v49, 4, v0
    v_lshlrev_b32 v49, 5, v49
    v_bfe_u32 v60, v0, 1, 1
    v_lshl_add_u32 v49, v60, 4, v49
    v_bfe_u32 v60, v0, 3, 1
    v_mul_u32_u24 v60, 192, v60
    v_add_u32 v49, v60, v49
    v_add_u32 v49, 156736, v49
    v_bfe_u32 v50, v0, 1, 1
    v_lshlrev_b32 v50, 4, v50
    v_bfe_u32 v60, v0, 3, 1
    v_mul_u32_u24 v60, 192, v60
    v_add_u32 v50, v60, v50
    v_add_u32 v50, 156864, v50
    v_mov_b32 v60, 156896
    v_and_b32 v51, 5, v0
    v_cmp_eq_u32 vcc, 0, v51
    s_nop 1
    v_cndmask_b32 v52, v60, v49, vcc
    v_cmp_eq_u32 vcc, 4, v51
    s_nop 1
    v_cndmask_b32 v53, v60, v49, vcc
    v_lshrrev_b32 v49, 2, v0
    v_and_b32 v49, 12, v49
    v_cmp_eq_u32 vcc, v49, v51
    s_nop 1
    v_cndmask_b32 v48, v60, v50, vcc
    v_mov_b64 v[44:45], 0
    v_mov_b64 v[46:47], 0
    s_lshr_b32 s57, s30, 1
    s_lshl_b32 s57, s57, 11
    s_lshl_b32 s58, s58, 1
    s_add_u32 s57, s57, s58
    s_lshl_b32 s58, s54, 8
    s_add_u32 s57, s57, s58
    v_and_b32 v54, 31, v0
    v_lshlrev_b32 v54, 2, v54
    v_lshrrev_b32 v60, 5, v0
    v_mul_u32_u24 v60, 6144, v60
    v_add_u32 v54, v60, v54
    v_add_u32 v54, s57, v54
    s_mul_i32 s59, s53, 12416
    s_add_u32 s59, s59, s62
    s_add_u32 s59, s59, 70656
    s_add_u32 s60, s59, 12288
    ds_read_b128 v[12:15], v52
    ds_read_b128 v[16:19], v53
    ds_read_b128 v[20:23], v48
    s_waitcnt lgkmcnt(2)
    v_smfmac_f32_16x16x64_bf16 v[44:47], v[12:15], v[28:35], v1
    s_waitcnt lgkmcnt(1)
    v_smfmac_f32_16x16x64_bf16 v[44:47], v[16:19], v[36:43], v1
    s_waitcnt lgkmcnt(0)
    v_smfmac_f32_16x16x64_bf16 v[44:47], v[20:23], v[24:31], v1
    s_cmp_eq_u32 s55, 0
    s_nop 6
    v_add_f32 v12, v44, v46
    s_cbranch_scc1 L_gs_99
    buffer_store_dword v12, v54, s[40:43], s59 offen
L_gb_100:
L_skip_98:
    s_waitcnt vmcnt(0)
    s_barrier
    s_cmp_eq_u32 s30, 5
    s_cbranch_scc0 L_skip_101
    v_mov_b32 v25, 0
    s_lshl_b32 s57, s52, 2
    s_add_u32 s57, s57, s72
    s_mov_b64 exec, 1
    buffer_store_dword v25, v0, s[40:43], s57 offen offset:256 sc1
    s_mov_b64 exec, -1
    v_and_b32 v16, 31, v0
    v_lshlrev_b32 v16, 2, v16
.p2align 5
L_pr_103:
    buffer_load_dword v17, v16, s[40:43], s72 offen offset:256 sc1
    s_sub_u32 s56, s56, 1
    s_cbranch_scc1 L_done
L_pw_102:
    s_waitcnt vmcnt(0)
    v_cmp_eq_u32 vcc, -1, v17
    s_cbranch_vccnz L_pr_103
L_skip_101:
    s_barrier
    s_branch L_spread_back
.p2align 5
L_done:
L_exit:
    s_endpgm
.section .rodata,"a"
.p2align 6
.amdhsa_kernel interleave_layers__sliding_block_cached__dense_activation_gelu__decode_kernel
  .amdhsa_next_free_vgpr 256
  .amdhsa_next_free_sgpr 102
  .amdhsa_accum_offset 256
  .amdhsa_group_segment_fixed_size 0
  .amdhsa_kernarg_size 104
  .amdhsa_user_sgpr_count 2
  .amdhsa_user_sgpr_kernarg_segment_ptr 1
  .amdhsa_system_sgpr_workgroup_id_x 1
  .amdhsa_float_denorm_mode_32 3
.end_amdhsa_kernel
```
